```python
import torch

def _softmax(x, axis=-1):
    return torch.softmax(x, dim=axis)

def _gelu(x):
    return torch.nn.functional.gelu(x, approximate='tanh')

def _silu(x):
    return torch.nn.functional.silu(x)

def _sigmoid(x):
    return torch.sigmoid(x)

def _layernorm(x, axis=-1, eps=1e-05):
    m = x.mean(dim=axis, keepdim=True)
    v = x.var(dim=axis, keepdim=True, unbiased=False)
    return (x - m) / torch.sqrt(v + eps)

def _scatter_add(tgt, idx, src, axis=0):
    return tgt.clone().index_add_(axis, idx, src)

def _segment_sum(src, seg, n):
    out = torch.zeros((n,) + src.shape[1:], dtype=src.dtype)
    return out.index_add_(0, seg, src)

def _pad(x, pw):
    flat = tuple((v for pair in reversed(pw) for v in pair))
    return torch.nn.functional.pad(x, flat)
kernel_name = 'recurrent_scan__memory_aug_recurrent_mem_tr__mixer_token_mlp__prompt'

def setup_inputs():

    _w = lambda a: (lambda t: t.to(torch.bfloat16) if t.is_floating_point() else t)(torch.as_tensor(a))

    def _A_setup():
        B, S, Dm = (1, 2048, 1024)
        H, Dh = (32, 128)
        M, seg = (8, 32)
        seg = min(seg, S)
        S = S // seg * seg
        return {'x': _w((lambda *s: torch.randn(*s, dtype=torch.bfloat16) * 0.05)(B, S, Dm)), 'mem0': _w((lambda *s: torch.randn(*s, dtype=torch.bfloat16) * 0.8)(B, M, Dm)), 'Wq': _w((lambda *s: torch.randn(*s, dtype=torch.bfloat16) * 1.6)(Dm, H, Dh) * Dm ** (-0.5)), 'Wk': _w((lambda *s: torch.randn(*s, dtype=torch.bfloat16) * 1.6)(Dm, H, Dh) * Dm ** (-0.5)), 'Wv': _w((lambda *s: torch.randn(*s, dtype=torch.bfloat16) * 0.8)(Dm, H, Dh) * Dm ** (-0.5)), 'Wo': _w((lambda *s: torch.randn(*s, dtype=torch.bfloat16) * 0.8)(H, Dh, Dm) * (H * Dh) ** (-0.5)), 'seg_len': seg}
    _A_in = _A_setup()

    def _B_setup():
        B, S, D, F = (1, 2048, 1024, 3584)
        return {'x': _w((lambda *s: torch.randn(*s, dtype=torch.bfloat16) * 0.05)(B, S, D)), 'w1': _w((lambda *s: torch.randn(*s, dtype=torch.bfloat16) * 0.8)(S, F) * S ** (-0.5)), 'b1': _w((lambda *s: torch.randn(*s, dtype=torch.bfloat16) * 12.8)(F) * 0.02), 'w2': _w((lambda *s: torch.randn(*s, dtype=torch.bfloat16) * 0.2)(F, S) * F ** (-0.5)), 'b2': _w((lambda *s: torch.randn(*s, dtype=torch.bfloat16) * 1.6)(S) * 0.02)}
    _B_in = _B_setup()
    return {'A_x': _A_in['x'], 'A_mem0': _A_in['mem0'], 'A_Wq': _A_in['Wq'], 'A_Wk': _A_in['Wk'], 'A_Wv': _A_in['Wv'], 'A_Wo': _A_in['Wo'], 'A_seg_len': _A_in['seg_len'], 'B_x': _B_in['x'], 'B_w1': _B_in['w1'], 'B_b1': _B_in['b1'], 'B_w2': _B_in['w2'], 'B_b2': _B_in['b2']}

def reference(A_x, A_mem0, A_Wq, A_Wk, A_Wv, A_Wo, A_seg_len, B_x, B_w1, B_b1, B_w2, B_b2):

    def _A_ref(x, mem0, Wq, Wk, Wv, Wo, seg_len):
        B, S, Dm = x.shape
        H, Dh = (Wq.shape[1], Wq.shape[2])
        M = mem0.shape[1]
        scale = Dh ** (-0.5)
        n_seg = S // seg_len
        L = M + seg_len
        idx = torch.arange(L)
        mask = (idx[:, None] < M) | (idx[:, None] >= idx[None, :])
        mem = mem0
        outs = []
        for s in range(n_seg):
            xs = x[:, s * seg_len:(s + 1) * seg_len, :].clone()
            h = torch.concatenate([mem, xs], axis=1)
            q = torch.einsum('btd,dhe->bhte', h, Wq)
            k = torch.einsum('btd,dhe->bhte', h, Wk)
            v = torch.einsum('btd,dhe->bhte', h, Wv)
            scores = torch.einsum('bhqe,bhke->bhqk', q, k) * scale
            scores = torch.where(mask[None, None], scores, -1000000000.0)
            p = _softmax(scores, axis=-1)
            o = torch.einsum('bhqk,bhke->bhqe', p, v)
            o = torch.einsum('bhte,hed->btd', o, Wo)
            mem = o[:, :M, :].clone()
            outs.append(o[:, M:, :])
        return torch.concatenate(outs, axis=1)

    def _B_ref(x, w1, b1, w2, b2):
        B, S, D = x.shape
        h = _layernorm(x, axis=-1)
        u = torch.einsum('bsd,sf->bdf', h, w1) + b1
        u = _gelu(u)
        y = torch.einsum('bdf,fs->bds', u, w2) + b2
        return (lambda x, *d: x.permute(*d))(y, 0, 2, 1)
    x = A_x
    xn = _layernorm(x, axis=-1)
    s = _A_ref(xn, A_mem0, A_Wq, A_Wk, A_Wv, A_Wo, A_seg_len)
    g = _silu(_B_ref(xn, B_w1, B_b1, B_w2, B_b2))
    return x + s * g
```

```asm
; @launch grid=(256,1,1) block=(256,1,1) lds=163840
.amdgcn_target "amdgcn-amd-amdhsa--gfx950"
.text
.globl recurrent_scan__memory_aug_recurrent_mem_tr__mixer_token_mlp__prompt_kernel
.p2align 8
.type recurrent_scan__memory_aug_recurrent_mem_tr__mixer_token_mlp__prompt_kernel,@function
recurrent_scan__memory_aug_recurrent_mem_tr__mixer_token_mlp__prompt_kernel:
s_cmp_ge_u32 s2, 256
s_cbranch_scc1 M_end0
s_getpc_b64 s[90:91]
M_pc0:
s_lshr_b32 s92, s2, 3
s_and_b32 s92, s92, 31
s_min_u32 s92, s92, (M_tab-M_pc0)/4096-1
s_lshl_b32 s92, s92, 12
v_lshlrev_b32 v2, 4, v0
v_add_u32 v2, s92, v2
global_load_dwordx4 v[200:203], v2, s[90:91]
s_load_dwordx2 s[4:5], s[0:1], 16
s_load_dwordx2 s[6:7], s[0:1], 24
s_load_dwordx2 s[8:9], s[0:1], 32
s_load_dwordx2 s[10:11], s[0:1], 40
s_load_dwordx2 s[12:13], s[0:1], 8
s_load_dwordx2 s[14:15], s[0:1], 104
s_load_dwordx2 s[16:17], s[0:1], 112
s_waitcnt lgkmcnt(0)
s_getreg_b32 s18, hwreg(HW_REG_XCC_ID, 0, 4)
v_lshrrev_b32 v2, 6, v0
s_nop 0
v_readfirstlane_b32 s20, v2
v_mov_b32 v6, 163836
s_cmp_lg_u32 s20, 0
s_cbranch_scc1 C_tk
s_lshl_b32 s40, s18, 2
v_mov_b32 v3, s40
v_mov_b32 v4, 1
s_mov_b64 exec, 1
global_atomic_add v5, v3, v4, s[14:15] sc0
s_waitcnt vmcnt(0)
ds_write_b32 v6, v5
s_waitcnt lgkmcnt(0)
s_mov_b64 exec, -1
C_tk:
s_barrier
ds_read_b32 v5, v6
s_waitcnt lgkmcnt(0)
v_readfirstlane_b32 s19, v5
s_barrier
s_cmp_ge_u32 s19, 32
s_cbranch_scc1 M_exit0
s_cmp_ge_u32 s18, 4
s_cbranch_scc1 M_worker
v_and_b32 v1, 63, v0
v_lshrrev_b32 v26, 6, v0
s_nop 0
v_readfirstlane_b32 s20, v26
v_and_b32 v2, 15, v1
v_lshrrev_b32 v3, 4, v1
v_lshlrev_b32 v4, 4, v1
s_lshr_b32 s40, s19, 2
s_lshl_b32 s21, s18, 3
s_add_u32 s21, s21, s40
s_and_b32 s22, s19, 3
s_mov_b32 s48, 0x00ff00ff
s_mov_b32 s49, 0x00ff00ff
s_mov_b32 s50, 0
s_mov_b32 s51, -1
s_mov_b32 s46, 0x3e0293ee
v_mov_b32 v16, -1
v_mov_b32 v17, -1
v_mov_b32 v18, -1
v_mov_b32 v19, -1
v_mov_b32 v26, 0xeeee
v_mov_b32 v27, 0x4444
v_cndmask_b32 v14, v26, v27, s[48:49]
s_lshl_b32 s40, s20, 12
v_add_u32 v32, s40, v4
s_lshl_b32 s40, s20, 11
v_add_u32 v36, s40, v4
s_lshl_b32 s40, s20, 10
v_add_u32 v37, s40, v4
v_lshrrev_b32 v26, 3, v1
v_and_b32 v27, 7, v1
v_lshrrev_b32 v28, 2, v26
v_lshlrev_b32 v28, 8, v28
v_lshl_add_u32 v28, v27, 5, v28
v_and_b32 v29, 3, v26
v_lshl_add_u32 v28, v29, 2, v28
s_lshr_b32 s40, s20, 1
s_lshl_b32 s40, s40, 10
s_and_b32 s41, s20, 1
s_lshl_b32 s41, s41, 9
s_add_u32 s40, s40, s41
v_add_u32 v112, s40, v28
v_add_u32 v113, 2048, v112
v_add_u32 v114, 2048, v113
v_add_u32 v115, 2048, v114
v_lshrrev_b32 v28, 2, v27
v_lshlrev_b32 v28, 7, v28
v_lshl_add_u32 v28, v26, 4, v28
v_and_b32 v29, 3, v27
v_lshl_add_u32 v28, v29, 2, v28
s_lshr_b32 s40, s20, 1
s_lshl_b32 s40, s40, 11
s_lshl_b32 s41, s22, 9
s_add_u32 s40, s40, s41
s_and_b32 s41, s20, 1
s_lshl_b32 s41, s41, 8
s_add_u32 s40, s40, s41
v_add_u32 v5, s40, v28
v_and_b32 v26, 7, v1
v_lshlrev_b32 v26, 4, v26
v_lshl_add_u32 v6, v3, 7, v26
s_lshl_b32 s40, s21, 13
v_add_u32 v7, s40, v4
v_add_u32 v8, 4096, v7
s_lshl_b32 s41, s22, 11
s_add_u32 s40, s40, s41
v_add_u32 v9, s40, v4
v_lshrrev_b32 v26, 3, v2
v_lshlrev_b32 v26, 4, v26
v_and_b32 v27, 7, v2
v_add_u32 v26, v26, v27
v_lshlrev_b32 v26, 4, v26
v_lshl_add_u32 v26, v3, 2, v26
s_lshl_b32 s40, s19, 9
v_add_u32 v11, s40, v26
v_lshrrev_b32 v26, 5, v1
v_lshlrev_b32 v26, 4, v26
v_bfe_u32 v27, v1, 3, 1
v_lshl_add_u32 v26, v27, 2, v26
v_bfe_u32 v27, v1, 1, 2
v_add_u32 v26, v26, v27
v_and_b32 v27, 1, v1
v_lshl_add_u32 v26, v27, 3, v26
v_lshlrev_b32 v26, 4, v26
v_bfe_u32 v27, v1, 4, 1
v_lshl_add_u32 v26, v27, 3, v26
v_add_u32 v12, s40, v26
v_and_b32 v26, 1, v1
v_bfe_u32 v27, v1, 1, 1
v_lshl_add_u32 v26, v27, 2, v26
v_bfe_u32 v27, v1, 2, 1
v_lshl_add_u32 v26, v27, 1, v26
v_lshrrev_b32 v27, 5, v1
v_lshl_add_u32 v26, v27, 4, v26
v_lshlrev_b32 v26, 4, v26
v_bfe_u32 v27, v1, 3, 2
v_lshl_add_u32 v26, v27, 2, v26
s_lshr_b32 s40, s20, 1
s_lshl_b32 s40, s40, 9
s_and_b32 s41, s20, 1
s_lshl_b32 s41, s41, 7
s_add_u32 s40, s40, s41
v_add_u32 v15, s40, v26
s_lshl_b32 s40, s18, 10
s_lshl_b32 s41, s20, 8
s_add_u32 s40, s40, s41
v_lshlrev_b32 v26, 2, v1
v_add_u32 v33, s40, v26
s_lshl_b32 s40, s19, 9
v_add_u32 v20, s40, v4
v_mov_b32 v22, v20
v_and_b32 v26, 31, v1
v_lshlrev_b32 v26, 4, v26
v_lshrrev_b32 v27, 5, v1
v_lshl_add_u32 v26, v27, 11, v26
s_lshl_b32 s41, s22, 9
v_add_u32 v21, s41, v26
s_lshl_b32 s41, s18, 10
v_add_u32 v23, s41, v4
v_and_b32 v26, 31, v1
v_lshlrev_b32 v26, 3, v26
s_lshl_b32 s41, s22, 9
v_add_u32 v24, s41, v26
v_and_b32 v26, 31, v1
v_lshlrev_b32 v25, 4, v26
s_mul_i32 s40, s18, 1114112
s_add_u32 s40, s40, 117440512
s_add_u32 s24, s16, s40
s_addc_u32 s25, s17, 0
s_mul_i32 s40, s18, 2162688
s_add_u32 s40, s40, 125829120
s_lshr_b32 s41, s19, 2
s_lshl_b32 s41, s41, 12
s_add_u32 s40, s40, s41
s_add_u32 s26, s16, s40
s_addc_u32 s27, s17, 0
s_mul_i32 s40, s18, 1114112
s_add_u32 s40, s40, 138412032
s_add_u32 s28, s16, s40
s_addc_u32 s29, s17, 0
s_lshl_b32 s40, s19, 12
s_add_u32 s40, s40, 146800640
s_add_u32 s30, s16, s40
s_addc_u32 s31, s17, 0
s_add_u32 s32, s16, 33554432
s_addc_u32 s33, s17, 0
s_add_u32 s34, s16, 50331648
s_addc_u32 s35, s17, 0
s_lshl_b32 s40, s21, 11
s_add_u32 s41, s40, 100663296
s_add_u32 s36, s16, s41
s_addc_u32 s37, s17, 0
s_add_u32 s41, s40, 104857600
s_add_u32 s38, s16, s41
s_addc_u32 s39, s17, 0
s_mov_b64 s[56:57], s[24:25]
s_mov_b64 s[58:59], s[26:27]
s_mov_b64 s[96:97], s[28:29]
s_lshr_b32 s40, s19, 1
s_lshl_b32 s40, s40, 14
s_and_b32 s41, s19, 1
s_lshl_b32 s41, s41, 12
s_add_u32 s40, s40, s41
s_add_u32 s40, s40, 150994944
s_add_u32 s98, s16, s40
s_addc_u32 s99, s17, 0
s_mov_b32 s23, 0
s_cmp_lg_u32 s20, 1
s_cbranch_scc1 M_nf_1
s_add_u32 s42, s23, 0
s_and_b32 s42, s42, 3
s_mul_i32 s42, s42, 32768
s_add_u32 s40, s58, s42
s_addc_u32 s41, s59, 0
global_store_dwordx4 v21, v[16:19], s[40:41]
s_add_u32 s42, s23, 0
s_and_b32 s42, s42, 3
s_mul_i32 s42, s42, 262144
s_add_u32 s40, s98, s42
s_addc_u32 s41, s99, 0
global_store_dwordx4 v23, v[16:19], s[40:41] sc1
s_mov_b32 exec_hi, 0
s_add_u32 s42, s23, 1
s_and_b32 s42, s42, 3
s_mul_i32 s42, s42, 16384
s_add_u32 s40, s56, s42
s_addc_u32 s41, s57, 0
global_store_dwordx4 v20, v[16:19], s[40:41]
s_add_u32 s42, s23, 0
s_and_b32 s42, s42, 3
s_mul_i32 s42, s42, 16384
s_add_u32 s40, s96, s42
s_addc_u32 s41, s97, 0
global_store_dwordx4 v22, v[16:19], s[40:41]
s_mov_b64 exec, -1
s_add_u32 s42, s23, 1
s_and_b32 s42, s42, 3
s_mul_i32 s42, s42, 32768
s_add_u32 s40, s58, s42
s_addc_u32 s41, s59, 0
global_store_dwordx4 v21, v[16:19], s[40:41]
s_add_u32 s42, s23, 1
s_and_b32 s42, s42, 3
s_mul_i32 s42, s42, 262144
s_add_u32 s40, s98, s42
s_addc_u32 s41, s99, 0
global_store_dwordx4 v23, v[16:19], s[40:41] sc1
s_mov_b32 exec_hi, 0
s_add_u32 s42, s23, 2
s_and_b32 s42, s42, 3
s_mul_i32 s42, s42, 16384
s_add_u32 s40, s56, s42
s_addc_u32 s41, s57, 0
global_store_dwordx4 v20, v[16:19], s[40:41]
s_add_u32 s42, s23, 1
s_and_b32 s42, s42, 3
s_mul_i32 s42, s42, 16384
s_add_u32 s40, s96, s42
s_addc_u32 s41, s97, 0
global_store_dwordx4 v22, v[16:19], s[40:41]
s_mov_b64 exec, -1
s_add_u32 s42, s23, 2
s_and_b32 s42, s42, 3
s_mul_i32 s42, s42, 32768
s_add_u32 s40, s58, s42
s_addc_u32 s41, s59, 0
global_store_dwordx4 v21, v[16:19], s[40:41]
s_add_u32 s42, s23, 2
s_and_b32 s42, s42, 3
s_mul_i32 s42, s42, 262144
s_add_u32 s40, s98, s42
s_addc_u32 s41, s99, 0
global_store_dwordx4 v23, v[16:19], s[40:41] sc1
s_mov_b32 exec_hi, 0
s_add_u32 s42, s23, 3
s_and_b32 s42, s42, 3
s_mul_i32 s42, s42, 16384
s_add_u32 s40, s56, s42
s_addc_u32 s41, s57, 0
global_store_dwordx4 v20, v[16:19], s[40:41]
s_add_u32 s42, s23, 2
s_and_b32 s42, s42, 3
s_mul_i32 s42, s42, 16384
s_add_u32 s40, s96, s42
s_addc_u32 s41, s97, 0
global_store_dwordx4 v22, v[16:19], s[40:41]
s_mov_b64 exec, -1
s_add_u32 s42, s23, 3
s_and_b32 s42, s42, 3
s_mul_i32 s42, s42, 32768
s_add_u32 s40, s58, s42
s_addc_u32 s41, s59, 0
global_store_dwordx4 v21, v[16:19], s[40:41]
s_add_u32 s42, s23, 3
s_and_b32 s42, s42, 3
s_mul_i32 s42, s42, 262144
s_add_u32 s40, s98, s42
s_addc_u32 s41, s99, 0
global_store_dwordx4 v23, v[16:19], s[40:41] sc1
s_mov_b32 exec_hi, 0
s_add_u32 s42, s23, 4
s_and_b32 s42, s42, 3
s_mul_i32 s42, s42, 16384
s_add_u32 s40, s56, s42
s_addc_u32 s41, s57, 0
global_store_dwordx4 v20, v[16:19], s[40:41]
s_add_u32 s42, s23, 3
s_and_b32 s42, s42, 3
s_mul_i32 s42, s42, 16384
s_add_u32 s40, s96, s42
s_addc_u32 s41, s97, 0
global_store_dwordx4 v22, v[16:19], s[40:41]
s_mov_b64 exec, -1
s_add_u32 s42, s23, 0
s_and_b32 s42, s42, 3
s_mul_i32 s42, s42, 262144
s_add_u32 s40, s98, s42
s_addc_u32 s41, s99, 0
s_add_u32 s40, s40, 8192
s_addc_u32 s41, s41, 0
global_store_dwordx4 v23, v[16:19], s[40:41] sc1
s_add_u32 s42, s23, 1
s_and_b32 s42, s42, 3
s_mul_i32 s42, s42, 262144
s_add_u32 s40, s98, s42
s_addc_u32 s41, s99, 0
s_add_u32 s40, s40, 8192
s_addc_u32 s41, s41, 0
global_store_dwordx4 v23, v[16:19], s[40:41] sc1
s_add_u32 s42, s23, 2
s_and_b32 s42, s42, 3
s_mul_i32 s42, s42, 262144
s_add_u32 s40, s98, s42
s_addc_u32 s41, s99, 0
s_add_u32 s40, s40, 8192
s_addc_u32 s41, s41, 0
global_store_dwordx4 v23, v[16:19], s[40:41] sc1
s_add_u32 s42, s23, 3
s_and_b32 s42, s42, 3
s_mul_i32 s42, s42, 262144
s_add_u32 s40, s98, s42
s_addc_u32 s41, s99, 0
s_add_u32 s40, s40, 8192
s_addc_u32 s41, s41, 0
global_store_dwordx4 v23, v[16:19], s[40:41] sc1
M_nf_1:
s_or_b32 s40, s18, s19
s_cmp_lg_u32 s40, 0
s_cbranch_scc1 M_zc_2
s_cmp_lg_u32 s20, 2
s_cbranch_scc1 M_zc_2
v_mov_b32 v80, 0
v_mov_b32 v81, 0
v_mov_b32 v82, 0
v_mov_b32 v83, 0
v_add_u32 v84, 176160768, v4
global_store_dwordx4 v84, v[80:83], s[16:17] sc1
M_zc_2:
s_cmp_lg_u32 s20, 3
s_cbranch_scc1 M_tf_3
s_lshl_b32 s42, s19, 16
s_lshl_b32 s43, s18, 14
s_add_u32 s42, s42, s43
s_add_u32 s42, s42, 159383552
s_add_u32 s40, s16, s42
s_addc_u32 s41, s17, 0
global_store_dwordx4 v4, v[16:19], s[40:41] offset:0 sc1
global_store_dwordx4 v4, v[16:19], s[40:41] offset:1024 sc1
global_store_dwordx4 v4, v[16:19], s[40:41] offset:2048 sc1
global_store_dwordx4 v4, v[16:19], s[40:41] offset:3072 sc1
s_add_u32 s40, s40, 4096
s_addc_u32 s41, s41, 0
global_store_dwordx4 v4, v[16:19], s[40:41] offset:0 sc1
global_store_dwordx4 v4, v[16:19], s[40:41] offset:1024 sc1
global_store_dwordx4 v4, v[16:19], s[40:41] offset:2048 sc1
global_store_dwordx4 v4, v[16:19], s[40:41] offset:3072 sc1
s_add_u32 s40, s40, 4096
s_addc_u32 s41, s41, 0
global_store_dwordx4 v4, v[16:19], s[40:41] offset:0 sc1
global_store_dwordx4 v4, v[16:19], s[40:41] offset:1024 sc1
global_store_dwordx4 v4, v[16:19], s[40:41] offset:2048 sc1
global_store_dwordx4 v4, v[16:19], s[40:41] offset:3072 sc1
s_add_u32 s40, s40, 4096
s_addc_u32 s41, s41, 0
global_store_dwordx4 v4, v[16:19], s[40:41] offset:0 sc1
global_store_dwordx4 v4, v[16:19], s[40:41] offset:1024 sc1
global_store_dwordx4 v4, v[16:19], s[40:41] offset:2048 sc1
global_store_dwordx4 v4, v[16:19], s[40:41] offset:3072 sc1
M_tf_3:
v_lshrrev_b32 v28, 2, v1
v_and_b32 v29, 3, v1
v_lshlrev_b32 v29, 4, v29
v_lshl_add_u32 v26, v28, 13, v29
v_lshl_add_u32 v30, v28, 11, v29
v_lshrrev_b32 v28, 2, v2
v_lshl_add_u32 v28, v3, 3, v28
v_lshlrev_b32 v28, 6, v28
v_and_b32 v29, 3, v2
v_lshl_add_u32 v27, v29, 3, v28
s_lshl_b32 s40, s20, 15
v_add_u32 v27, s40, v27
s_lshl_b32 s40, s21, 8
s_lshl_b32 s41, s22, 6
s_add_u32 s40, s40, s41
s_lshl_b32 s41, s20, 21
s_add_u32 s40, s40, s41
s_add_u32 s24, s4, s40
s_addc_u32 s25, s5, 0
s_add_u32 s26, s6, s40
s_addc_u32 s27, s7, 0
s_add_u32 s36, s8, s40
s_addc_u32 s37, s9, 0
s_lshl_b32 s40, s18, 21
s_lshl_b32 s41, s20, 19
s_add_u32 s40, s40, s41
s_lshl_b32 s41, s19, 6
s_add_u32 s40, s40, s41
s_add_u32 s28, s10, s40
s_addc_u32 s29, s11, 0
s_lshl_b32 s43, s20, 15
s_mov_b32 s42, 0
M_wl_4:
s_add_u32 s41, s42, s19
s_and_b32 s41, s41, 15
s_lshl_b32 m0, s41, 10
s_add_u32 m0, m0, s43
s_mul_i32 s41, s41, 131072
s_add_u32 s40, s24, s41
s_addc_u32 s41, s25, 0
global_load_lds_dwordx4 v26, s[40:41]
s_add_u32 s42, s42, 1
s_cmp_lt_u32 s42, 16
s_cbranch_scc1 M_wl_4
s_mov_b32 s42, 0
M_wl_5:
s_add_u32 s41, s42, s19
s_and_b32 s41, s41, 15
s_lshl_b32 m0, s41, 10
s_add_u32 m0, m0, s43
s_add_u32 m0, m0, 16384
s_mul_i32 s41, s41, 131072
s_add_u32 s40, s26, s41
s_addc_u32 s41, s27, 0
global_load_lds_dwordx4 v26, s[40:41]
s_add_u32 s42, s42, 1
s_cmp_lt_u32 s42, 16
s_cbranch_scc1 M_wl_5
s_waitcnt vmcnt(0)
s_cmp_lg_u32 s20, 1
s_cbranch_scc1 M_nt_6
s_add_u32 s42, s23, 0
s_and_b32 s42, s42, 3
s_mul_i32 s42, s42, 32768
s_add_u32 s40, s58, s42
s_addc_u32 s41, s59, 0
global_load_dwordx4 v[40:43], v21, s[40:41] sc1
s_mov_b32 exec_hi, 0
s_add_u32 s42, s23, 1
s_and_b32 s42, s42, 3
s_mul_i32 s42, s42, 16384
s_add_u32 s40, s56, s42
s_addc_u32 s41, s57, 0
global_load_dwordx4 v[40:43], v20, s[40:41] sc1
s_add_u32 s42, s23, 0
s_and_b32 s42, s42, 3
s_mul_i32 s42, s42, 16384
s_add_u32 s40, s96, s42
s_addc_u32 s41, s97, 0
global_load_dwordx4 v[40:43], v22, s[40:41] sc1
s_mov_b64 exec, -1
s_add_u32 s42, s23, 1
s_and_b32 s42, s42, 3
s_mul_i32 s42, s42, 32768
s_add_u32 s40, s58, s42
s_addc_u32 s41, s59, 0
global_load_dwordx4 v[40:43], v21, s[40:41] sc1
s_mov_b32 exec_hi, 0
s_add_u32 s42, s23, 2
s_and_b32 s42, s42, 3
s_mul_i32 s42, s42, 16384
s_add_u32 s40, s56, s42
s_addc_u32 s41, s57, 0
global_load_dwordx4 v[40:43], v20, s[40:41] sc1
s_add_u32 s42, s23, 1
s_and_b32 s42, s42, 3
s_mul_i32 s42, s42, 16384
s_add_u32 s40, s96, s42
s_addc_u32 s41, s97, 0
global_load_dwordx4 v[40:43], v22, s[40:41] sc1
s_mov_b64 exec, -1
s_add_u32 s42, s23, 2
s_and_b32 s42, s42, 3
s_mul_i32 s42, s42, 32768
s_add_u32 s40, s58, s42
s_addc_u32 s41, s59, 0
global_load_dwordx4 v[40:43], v21, s[40:41] sc1
s_mov_b32 exec_hi, 0
s_add_u32 s42, s23, 3
s_and_b32 s42, s42, 3
s_mul_i32 s42, s42, 16384
s_add_u32 s40, s56, s42
s_addc_u32 s41, s57, 0
global_load_dwordx4 v[40:43], v20, s[40:41] sc1
s_add_u32 s42, s23, 2
s_and_b32 s42, s42, 3
s_mul_i32 s42, s42, 16384
s_add_u32 s40, s96, s42
s_addc_u32 s41, s97, 0
global_load_dwordx4 v[40:43], v22, s[40:41] sc1
s_mov_b64 exec, -1
s_add_u32 s42, s23, 3
s_and_b32 s42, s42, 3
s_mul_i32 s42, s42, 32768
s_add_u32 s40, s58, s42
s_addc_u32 s41, s59, 0
global_load_dwordx4 v[40:43], v21, s[40:41] sc1
s_mov_b32 exec_hi, 0
s_add_u32 s42, s23, 4
s_and_b32 s42, s42, 3
s_mul_i32 s42, s42, 16384
s_add_u32 s40, s56, s42
s_addc_u32 s41, s57, 0
global_load_dwordx4 v[40:43], v20, s[40:41] sc1
s_add_u32 s42, s23, 3
s_and_b32 s42, s42, 3
s_mul_i32 s42, s42, 16384
s_add_u32 s40, s96, s42
s_addc_u32 s41, s97, 0
global_load_dwordx4 v[40:43], v22, s[40:41] sc1
s_mov_b64 exec, -1
M_nt_6:
ds_read_b64_tr_b16 a[0:1], v27 offset:0
ds_read_b64_tr_b16 a[2:3], v27 offset:256
ds_read_b64_tr_b16 a[4:5], v27 offset:2048
ds_read_b64_tr_b16 a[6:7], v27 offset:2304
ds_read_b64_tr_b16 a[8:9], v27 offset:32
ds_read_b64_tr_b16 a[10:11], v27 offset:288
ds_read_b64_tr_b16 a[12:13], v27 offset:2080
ds_read_b64_tr_b16 a[14:15], v27 offset:2336
ds_read_b64_tr_b16 a[16:17], v27 offset:16384
ds_read_b64_tr_b16 a[18:19], v27 offset:16640
ds_read_b64_tr_b16 a[20:21], v27 offset:18432
ds_read_b64_tr_b16 a[22:23], v27 offset:18688
ds_read_b64_tr_b16 a[24:25], v27 offset:16416
ds_read_b64_tr_b16 a[26:27], v27 offset:16672
ds_read_b64_tr_b16 a[28:29], v27 offset:18464
ds_read_b64_tr_b16 a[30:31], v27 offset:18720
ds_read_b64_tr_b16 a[48:49], v27 offset:4096
ds_read_b64_tr_b16 a[50:51], v27 offset:4352
ds_read_b64_tr_b16 a[52:53], v27 offset:6144
ds_read_b64_tr_b16 a[54:55], v27 offset:6400
ds_read_b64_tr_b16 a[56:57], v27 offset:4128
ds_read_b64_tr_b16 a[58:59], v27 offset:4384
ds_read_b64_tr_b16 a[60:61], v27 offset:6176
ds_read_b64_tr_b16 a[62:63], v27 offset:6432
ds_read_b64_tr_b16 a[64:65], v27 offset:20480
ds_read_b64_tr_b16 a[66:67], v27 offset:20736
ds_read_b64_tr_b16 a[68:69], v27 offset:22528
ds_read_b64_tr_b16 a[70:71], v27 offset:22784
ds_read_b64_tr_b16 a[72:73], v27 offset:20512
ds_read_b64_tr_b16 a[74:75], v27 offset:20768
ds_read_b64_tr_b16 a[76:77], v27 offset:22560
ds_read_b64_tr_b16 a[78:79], v27 offset:22816
ds_read_b64_tr_b16 a[96:97], v27 offset:8192
ds_read_b64_tr_b16 a[98:99], v27 offset:8448
ds_read_b64_tr_b16 a[100:101], v27 offset:10240
ds_read_b64_tr_b16 a[102:103], v27 offset:10496
ds_read_b64_tr_b16 a[104:105], v27 offset:8224
ds_read_b64_tr_b16 a[106:107], v27 offset:8480
ds_read_b64_tr_b16 a[108:109], v27 offset:10272
ds_read_b64_tr_b16 a[110:111], v27 offset:10528
ds_read_b64_tr_b16 a[112:113], v27 offset:24576
ds_read_b64_tr_b16 a[114:115], v27 offset:24832
ds_read_b64_tr_b16 a[116:117], v27 offset:26624
ds_read_b64_tr_b16 a[118:119], v27 offset:26880
ds_read_b64_tr_b16 a[120:121], v27 offset:24608
ds_read_b64_tr_b16 a[122:123], v27 offset:24864
ds_read_b64_tr_b16 a[124:125], v27 offset:26656
ds_read_b64_tr_b16 a[126:127], v27 offset:26912
ds_read_b64_tr_b16 a[144:145], v27 offset:12288
ds_read_b64_tr_b16 a[146:147], v27 offset:12544
ds_read_b64_tr_b16 a[148:149], v27 offset:14336
ds_read_b64_tr_b16 a[150:151], v27 offset:14592
ds_read_b64_tr_b16 a[152:153], v27 offset:12320
ds_read_b64_tr_b16 a[154:155], v27 offset:12576
ds_read_b64_tr_b16 a[156:157], v27 offset:14368
ds_read_b64_tr_b16 a[158:159], v27 offset:14624
ds_read_b64_tr_b16 a[160:161], v27 offset:28672
ds_read_b64_tr_b16 a[162:163], v27 offset:28928
ds_read_b64_tr_b16 a[164:165], v27 offset:30720
ds_read_b64_tr_b16 a[166:167], v27 offset:30976
ds_read_b64_tr_b16 a[168:169], v27 offset:28704
ds_read_b64_tr_b16 a[170:171], v27 offset:28960
ds_read_b64_tr_b16 a[172:173], v27 offset:30752
ds_read_b64_tr_b16 a[174:175], v27 offset:31008
s_waitcnt lgkmcnt(0)
s_mov_b32 s42, 0
M_wl_7:
s_add_u32 s41, s42, s19
s_and_b32 s41, s41, 15
s_lshl_b32 m0, s41, 10
s_add_u32 m0, m0, s43
s_mul_i32 s41, s41, 131072
s_add_u32 s40, s36, s41
s_addc_u32 s41, s37, 0
global_load_lds_dwordx4 v26, s[40:41]
s_add_u32 s42, s42, 1
s_cmp_lt_u32 s42, 16
s_cbranch_scc1 M_wl_7
s_mov_b32 s42, 0
M_wl_8:
s_add_u32 s41, s42, s19
s_and_b32 s41, s41, 15
s_lshl_b32 m0, s41, 10
s_add_u32 m0, m0, s43
s_add_u32 m0, m0, 16384
s_mul_i32 s41, s41, 32768
s_add_u32 s40, s28, s41
s_addc_u32 s41, s29, 0
global_load_lds_dwordx4 v30, s[40:41]
s_add_u32 s42, s42, 1
s_cmp_lt_u32 s42, 16
s_cbranch_scc1 M_wl_8
s_waitcnt vmcnt(0)
ds_read_b64_tr_b16 a[32:33], v27 offset:0
ds_read_b64_tr_b16 a[34:35], v27 offset:256
ds_read_b64_tr_b16 a[36:37], v27 offset:2048
ds_read_b64_tr_b16 a[38:39], v27 offset:2304
ds_read_b64_tr_b16 a[40:41], v27 offset:32
ds_read_b64_tr_b16 a[42:43], v27 offset:288
ds_read_b64_tr_b16 a[44:45], v27 offset:2080
ds_read_b64_tr_b16 a[46:47], v27 offset:2336
ds_read_b64_tr_b16 a[192:193], v27 offset:16384
ds_read_b64_tr_b16 a[194:195], v27 offset:16640
ds_read_b64_tr_b16 a[196:197], v27 offset:18432
ds_read_b64_tr_b16 a[198:199], v27 offset:18688
ds_read_b64_tr_b16 a[200:201], v27 offset:16416
ds_read_b64_tr_b16 a[202:203], v27 offset:16672
ds_read_b64_tr_b16 a[204:205], v27 offset:18464
ds_read_b64_tr_b16 a[206:207], v27 offset:18720
ds_read_b64_tr_b16 a[80:81], v27 offset:4096
ds_read_b64_tr_b16 a[82:83], v27 offset:4352
ds_read_b64_tr_b16 a[84:85], v27 offset:6144
ds_read_b64_tr_b16 a[86:87], v27 offset:6400
ds_read_b64_tr_b16 a[88:89], v27 offset:4128
ds_read_b64_tr_b16 a[90:91], v27 offset:4384
ds_read_b64_tr_b16 a[92:93], v27 offset:6176
ds_read_b64_tr_b16 a[94:95], v27 offset:6432
ds_read_b64_tr_b16 a[208:209], v27 offset:20480
ds_read_b64_tr_b16 a[210:211], v27 offset:20736
ds_read_b64_tr_b16 a[212:213], v27 offset:22528
ds_read_b64_tr_b16 a[214:215], v27 offset:22784
ds_read_b64_tr_b16 a[216:217], v27 offset:20512
ds_read_b64_tr_b16 a[218:219], v27 offset:20768
ds_read_b64_tr_b16 a[220:221], v27 offset:22560
ds_read_b64_tr_b16 a[222:223], v27 offset:22816
ds_read_b64_tr_b16 a[128:129], v27 offset:8192
ds_read_b64_tr_b16 a[130:131], v27 offset:8448
ds_read_b64_tr_b16 a[132:133], v27 offset:10240
ds_read_b64_tr_b16 a[134:135], v27 offset:10496
ds_read_b64_tr_b16 a[136:137], v27 offset:8224
ds_read_b64_tr_b16 a[138:139], v27 offset:8480
ds_read_b64_tr_b16 a[140:141], v27 offset:10272
ds_read_b64_tr_b16 a[142:143], v27 offset:10528
ds_read_b64_tr_b16 a[224:225], v27 offset:24576
ds_read_b64_tr_b16 a[226:227], v27 offset:24832
ds_read_b64_tr_b16 a[228:229], v27 offset:26624
ds_read_b64_tr_b16 a[230:231], v27 offset:26880
ds_read_b64_tr_b16 a[232:233], v27 offset:24608
ds_read_b64_tr_b16 a[234:235], v27 offset:24864
ds_read_b64_tr_b16 a[236:237], v27 offset:26656
ds_read_b64_tr_b16 a[238:239], v27 offset:26912
ds_read_b64_tr_b16 a[176:177], v27 offset:12288
ds_read_b64_tr_b16 a[178:179], v27 offset:12544
ds_read_b64_tr_b16 a[180:181], v27 offset:14336
ds_read_b64_tr_b16 a[182:183], v27 offset:14592
ds_read_b64_tr_b16 a[184:185], v27 offset:12320
ds_read_b64_tr_b16 a[186:187], v27 offset:12576
ds_read_b64_tr_b16 a[188:189], v27 offset:14368
ds_read_b64_tr_b16 a[190:191], v27 offset:14624
ds_read_b64_tr_b16 a[240:241], v27 offset:28672
ds_read_b64_tr_b16 a[242:243], v27 offset:28928
ds_read_b64_tr_b16 a[244:245], v27 offset:30720
ds_read_b64_tr_b16 a[246:247], v27 offset:30976
ds_read_b64_tr_b16 a[248:249], v27 offset:28704
ds_read_b64_tr_b16 a[250:251], v27 offset:28960
ds_read_b64_tr_b16 a[252:253], v27 offset:30752
ds_read_b64_tr_b16 a[254:255], v27 offset:31008
s_waitcnt lgkmcnt(0)
s_cmp_ge_u32 s19, 8
s_cbranch_scc1 M_cal_9
s_cmp_lg_u32 s20, 2
s_cbranch_scc1 M_cal_9
s_mov_b64 exec, 1
s_lshl_b32 s40, s18, 3
s_add_u32 s40, s40, s19
s_lshl_b32 s40, s40, 14
s_add_u32 s40, s40, 152043520
v_mov_b32 v80, s40
v_add_u32 v82, 8192, v80
s_mov_b32 s94, -1
s_mov_b32 s95, -1
s_mov_b32 s42, 3
M_call_10:
s_memtime s[90:91]
s_waitcnt lgkmcnt(0)
global_store_dword v80, v80, s[16:17] sc1
s_waitcnt vmcnt(0)
global_load_dword v84, v80, s[16:17] sc1
s_waitcnt vmcnt(0)
s_memtime s[92:93]
s_waitcnt lgkmcnt(0)
s_sub_u32 s92, s92, s90
s_min_u32 s94, s94, s92
s_memtime s[90:91]
s_waitcnt lgkmcnt(0)
global_store_dword v82, v82, s[16:17] sc1
s_waitcnt vmcnt(0)
global_load_dword v84, v82, s[16:17] sc1
s_waitcnt vmcnt(0)
s_memtime s[92:93]
s_waitcnt lgkmcnt(0)
s_sub_u32 s92, s92, s90
s_min_u32 s95, s95, s92
s_sub_u32 s42, s42, 1
s_cmp_lg_u32 s42, 0
s_cbranch_scc1 M_call_10
s_cmp_lt_u32 s95, s94
s_mov_b32 s40, 0x100
s_cmp_lt_u32 s95, s94
s_cselect_b32 s40, 1, s40
v_mov_b32 v80, 248
v_mov_b32 v81, s40
global_atomic_add v80, v81, s[14:15]
s_waitcnt vmcnt(0)
s_mov_b64 exec, -1
M_cal_9:
s_mul_i32 s40, s18, 1114112
s_add_u32 s40, s40, 117440512
s_add_u32 s24, s16, s40
s_addc_u32 s25, s17, 0
s_mul_i32 s40, s18, 2162688
s_add_u32 s40, s40, 125829120
s_lshr_b32 s41, s19, 2
s_lshl_b32 s41, s41, 12
s_add_u32 s40, s40, s41
s_add_u32 s26, s16, s40
s_addc_u32 s27, s17, 0
s_mul_i32 s40, s18, 1114112
s_add_u32 s40, s40, 138412032
s_add_u32 s28, s16, s40
s_addc_u32 s29, s17, 0
s_lshl_b32 s40, s19, 12
s_add_u32 s40, s40, 146800640
s_add_u32 s30, s16, s40
s_addc_u32 s31, s17, 0
s_add_u32 s32, s16, 33554432
s_addc_u32 s33, s17, 0
s_add_u32 s34, s16, 50331648
s_addc_u32 s35, s17, 0
s_lshl_b32 s40, s21, 11
s_add_u32 s41, s40, 100663296
s_add_u32 s36, s16, s41
s_addc_u32 s37, s17, 0
s_add_u32 s41, s40, 104857600
s_add_u32 s38, s16, s41
s_addc_u32 s39, s17, 0
s_waitcnt vmcnt(0)
s_barrier
v_mov_b32 v26, 32
v_mov_b32 v27, 1
s_cmp_lg_u32 s20, 0
s_cbranch_scc1 M_cbw_13
s_mov_b64 exec, 1
global_atomic_add v26, v27, s[14:15]
s_mov_b32 s47, 0
M_cb_11:
global_load_dword v28, v26, s[14:15] sc1
s_waitcnt vmcnt(0)
v_readfirstlane_b32 s40, v28
s_cmp_ge_u32 s40, 128
s_cbranch_scc1 M_cbd_12
s_sleep 16
s_add_u32 s47, s47, 1
s_cmp_lt_u32 s47, 300000
s_cbranch_scc1 M_cb_11
s_mov_b64 exec, -1
s_branch M_exit0
M_cbd_12:
s_mov_b64 exec, -1
M_cbw_13:
s_barrier
v_mov_b32 v26, 248
s_mov_b32 s47, 0
M_pb_14:
global_load_dword v27, v26, s[14:15] sc1
s_waitcnt vmcnt(0)
v_readfirstlane_b32 s41, v27
s_and_b32 s42, s41, 0xff
s_lshr_b32 s41, s41, 8
s_add_u32 s43, s41, s42
s_cmp_ge_u32 s43, 32
s_cbranch_scc1 M_pbd_15
s_sleep 8
s_add_u32 s47, s47, 1
s_cmp_lt_u32 s47, 300000
s_cbranch_scc1 M_pb_14
s_branch M_exit0
M_pbd_15:
s_cmp_gt_u32 s42, s41
s_cselect_b32 s41, 8192, 0
s_add_u32 s98, s98, s41
s_addc_u32 s99, s99, 0
s_and_b32 s43, s23, 3
s_mul_i32 s42, s43, 16384
s_add_u32 s24, s56, s42
s_addc_u32 s25, s57, 0
s_mul_i32 s42, s43, 32768
s_add_u32 s26, s58, s42
s_addc_u32 s27, s59, 0
s_mul_i32 s42, s43, 16384
s_add_u32 s28, s96, s42
s_addc_u32 s29, s97, 0
s_mul_i32 s42, s43, 262144
s_add_u32 s30, s98, s42
s_addc_u32 s31, s99, 0
s_cmp_lg_u32 s20, 0
s_cbranch_scc1 M_nm0_16
v_bfe_u32 v80, v1, 3, 1
v_lshlrev_b32 v80, 2, v80
v_bfe_u32 v81, v1, 1, 2
v_add_u32 v80, v80, v81
v_lshlrev_b32 v80, 11, v80
v_lshrrev_b32 v81, 5, v1
v_lshl_add_u32 v80, v81, 5, v80
v_bfe_u32 v81, v1, 4, 1
v_lshl_add_u32 v80, v81, 4, v80
v_and_b32 v81, 1, v1
v_lshl_add_u32 v80, v81, 2, v80
s_lshl_b32 s40, s19, 6
v_add_u32 v80, s40, v80
global_load_dword v82, v80, s[12:13]
global_load_dword v83, v80, s[12:13] offset:8
s_waitcnt vmcnt(0)
global_store_dwordx2 v12, v[82:83], s[24:25]
M_nm0_16:
s_cmp_lg_u32 s20, 3
s_cbranch_scc1 M_npf_17
s_mov_b32 s42, 0
s_lshr_b32 s43, s42, 3
s_lshl_b32 s43, s43, 2
s_add_u32 s43, s43, 96
v_mov_b32 v26, s43
s_mov_b32 s47, 0
M_kvp_18:
global_load_dword v27, v26, s[14:15] sc1
s_waitcnt vmcnt(0)
v_readfirstlane_b32 s43, v27
s_cmp_ge_u32 s43, 128
s_cbranch_scc1 M_kvd_19
s_sleep 32
s_add_u32 s47, s47, 1
s_cmp_lt_u32 s47, 400000
s_cbranch_scc1 M_kvp_18
s_branch M_exit0
M_kvd_19:
global_load_dwordx4 v[128:131], v7, s[32:33] offset:0 sc1
global_load_dwordx4 v[132:135], v7, s[32:33] offset:1024 sc1
global_load_dwordx4 v[136:139], v7, s[32:33] offset:2048 sc1
global_load_dwordx4 v[140:143], v7, s[32:33] offset:3072 sc1
global_load_dwordx4 v[144:147], v8, s[32:33] offset:0 sc1
global_load_dwordx4 v[148:151], v8, s[32:33] offset:1024 sc1
global_load_dwordx4 v[152:155], v8, s[32:33] offset:2048 sc1
global_load_dwordx4 v[156:159], v8, s[32:33] offset:3072 sc1
global_load_dwordx4 v[160:163], v9, s[34:35] offset:0 sc1
global_load_dwordx4 v[164:167], v9, s[34:35] offset:1024 sc1
M_npf_17:
s_mov_b32 s23, 0
C_step:
s_sleep 3
s_mov_b32 s47, 0
global_load_dwordx4 v[40:43], v32, s[24:25] offset:0 sc1
v_mov_b32 v56, 0
v_mov_b32 v57, 0
v_mov_b32 v58, 0
v_mov_b32 v59, 0
v_mov_b32 v60, 0
v_mov_b32 v61, 0
v_mov_b32 v62, 0
v_mov_b32 v63, 0
global_load_dwordx4 v[44:47], v32, s[24:25] offset:1024 sc1
v_mov_b32 v64, 0
v_mov_b32 v65, 0
v_mov_b32 v66, 0
v_mov_b32 v67, 0
v_mov_b32 v68, 0
v_mov_b32 v69, 0
v_mov_b32 v70, 0
v_mov_b32 v71, 0
global_load_dwordx4 v[48:51], v32, s[24:25] offset:2048 sc1
v_mov_b32 v72, 0
v_mov_b32 v73, 0
v_mov_b32 v74, 0
v_mov_b32 v75, 0
v_mov_b32 v76, 0
v_mov_b32 v77, 0
v_mov_b32 v78, 0
v_mov_b32 v79, 0
global_load_dwordx4 v[52:55], v32, s[24:25] offset:3072 sc1
s_waitcnt vmcnt(3)
v_max3_u32 v26, v40, v41, v42
v_max_u32 v26, v26, v43
v_cmp_eq_u32 vcc, -1, v26
s_cbranch_vccnz M_rt_20
M_bd_24:
v_smfmac_f32_16x16x64_bf16 v[56:59], v[40:43], a[0:7], v14
s_waitcnt vmcnt(2)
v_max3_u32 v26, v44, v45, v46
v_smfmac_f32_16x16x64_bf16 v[60:63], v[40:43], a[8:15], v14
v_max_u32 v26, v26, v47
v_smfmac_f32_16x16x64_bf16 v[64:67], v[40:43], a[16:23], v14
v_cmp_eq_u32 vcc, -1, v26
v_smfmac_f32_16x16x64_bf16 v[68:71], v[40:43], a[24:31], v14
s_cbranch_vccnz M_rt_21
M_bd_25:
v_smfmac_f32_16x16x64_bf16 v[56:59], v[44:47], a[48:55], v14
s_waitcnt vmcnt(1)
v_max3_u32 v26, v48, v49, v50
v_smfmac_f32_16x16x64_bf16 v[60:63], v[44:47], a[56:63], v14
v_max_u32 v26, v26, v51
v_smfmac_f32_16x16x64_bf16 v[64:67], v[44:47], a[64:71], v14
v_cmp_eq_u32 vcc, -1, v26
v_smfmac_f32_16x16x64_bf16 v[68:71], v[44:47], a[72:79], v14
s_cbranch_vccnz M_rt_22
M_bd_26:
v_smfmac_f32_16x16x64_bf16 v[56:59], v[48:51], a[96:103], v14
s_waitcnt vmcnt(0)
v_max3_u32 v26, v52, v53, v54
v_smfmac_f32_16x16x64_bf16 v[60:63], v[48:51], a[104:111], v14
v_max_u32 v26, v26, v55
v_smfmac_f32_16x16x64_bf16 v[64:67], v[48:51], a[112:119], v14
v_cmp_eq_u32 vcc, -1, v26
v_smfmac_f32_16x16x64_bf16 v[68:71], v[48:51], a[120:127], v14
s_cbranch_vccnz M_rt_23
M_bd_27:
v_smfmac_f32_16x16x64_bf16 v[56:59], v[52:55], a[144:151], v14
v_smfmac_f32_16x16x64_bf16 v[60:63], v[52:55], a[152:159], v14
v_smfmac_f32_16x16x64_bf16 v[64:67], v[52:55], a[160:167], v14
v_smfmac_f32_16x16x64_bf16 v[68:71], v[52:55], a[168:175], v14
s_branch M_cdone_28
M_rt_20:
s_add_u32 s47, s47, 1
s_cmp_ge_u32 s47, 300000
s_cbranch_scc1 M_exit0
global_load_dwordx4 v[40:43], v32, s[24:25] offset:0 sc1
global_load_dwordx4 v[44:47], v32, s[24:25] offset:1024 sc1
global_load_dwordx4 v[48:51], v32, s[24:25] offset:2048 sc1
global_load_dwordx4 v[52:55], v32, s[24:25] offset:3072 sc1
s_waitcnt vmcnt(3)
v_max3_u32 v26, v40, v41, v42
v_max_u32 v26, v26, v43
v_cmp_eq_u32 vcc, -1, v26
s_cbranch_vccnz M_rt_20
s_branch M_bd_24
M_rt_21:
s_add_u32 s47, s47, 1
s_cmp_ge_u32 s47, 300000
s_cbranch_scc1 M_exit0
global_load_dwordx4 v[44:47], v32, s[24:25] offset:1024 sc1
global_load_dwordx4 v[48:51], v32, s[24:25] offset:2048 sc1
global_load_dwordx4 v[52:55], v32, s[24:25] offset:3072 sc1
s_waitcnt vmcnt(2)
v_max3_u32 v26, v44, v45, v46
v_max_u32 v26, v26, v47
v_cmp_eq_u32 vcc, -1, v26
s_cbranch_vccnz M_rt_21
s_branch M_bd_25
M_rt_22:
s_add_u32 s47, s47, 1
s_cmp_ge_u32 s47, 300000
s_cbranch_scc1 M_exit0
global_load_dwordx4 v[48:51], v32, s[24:25] offset:2048 sc1
global_load_dwordx4 v[52:55], v32, s[24:25] offset:3072 sc1
s_waitcnt vmcnt(1)
v_max3_u32 v26, v48, v49, v50
v_max_u32 v26, v26, v51
v_cmp_eq_u32 vcc, -1, v26
s_cbranch_vccnz M_rt_22
s_branch M_bd_26
M_rt_23:
s_add_u32 s47, s47, 1
s_cmp_ge_u32 s47, 300000
s_cbranch_scc1 M_exit0
global_load_dwordx4 v[52:55], v32, s[24:25] offset:3072 sc1
s_waitcnt vmcnt(0)
v_max3_u32 v26, v52, v53, v54
v_max_u32 v26, v26, v55
v_cmp_eq_u32 vcc, -1, v26
s_cbranch_vccnz M_rt_23
s_branch M_bd_27
M_cdone_28:
v_smfmac_f32_16x16x64_bf16 v[72:75], v[40:43], a[32:39], v14
v_smfmac_f32_16x16x64_bf16 v[76:79], v[40:43], a[40:47], v14
s_nop 2
v_permlane32_swap_b32 v56, v60
v_permlane32_swap_b32 v57, v61
v_permlane32_swap_b32 v58, v62
v_permlane32_swap_b32 v59, v63
v_smfmac_f32_16x16x64_bf16 v[72:75], v[44:47], a[80:87], v14
v_pk_add_f32 v[56:57], v[56:57], v[60:61]
v_pk_add_f32 v[58:59], v[58:59], v[62:63]
v_permlane32_swap_b32 v64, v68
v_permlane32_swap_b32 v65, v69
ds_write_b128 v36, v[56:59] offset:0
v_smfmac_f32_16x16x64_bf16 v[76:79], v[44:47], a[88:95], v14
v_permlane32_swap_b32 v66, v70
v_permlane32_swap_b32 v67, v71
v_pk_add_f32 v[64:65], v[64:65], v[68:69]
v_pk_add_f32 v[66:67], v[66:67], v[70:71]
ds_write_b128 v36, v[64:67] offset:1024
v_smfmac_f32_16x16x64_bf16 v[72:75], v[48:51], a[128:135], v14
s_waitcnt lgkmcnt(0)
s_barrier
ds_read2_b32 v[80:81], v112 offset0:0 offset1:4
ds_read2_b32 v[82:83], v113 offset0:0 offset1:4
ds_read2_b32 v[84:85], v114 offset0:0 offset1:4
ds_read2_b32 v[86:87], v115 offset0:0 offset1:4
v_smfmac_f32_16x16x64_bf16 v[76:79], v[48:51], a[136:143], v14
v_smfmac_f32_16x16x64_bf16 v[72:75], v[52:55], a[176:183], v14
v_smfmac_f32_16x16x64_bf16 v[76:79], v[52:55], a[184:191], v14
s_waitcnt lgkmcnt(0)
v_pk_add_f32 v[80:81], v[80:81], v[82:83]
v_pk_add_f32 v[84:85], v[84:85], v[86:87]
v_pk_add_f32 v[80:81], v[80:81], v[84:85]
v_cvt_pk_bf16_f32 v34, v80, v81
global_store_dword v5, v34, s[26:27]
s_nop 1
v_permlane32_swap_b32 v72, v76
v_permlane32_swap_b32 v73, v77
v_permlane32_swap_b32 v74, v78
v_permlane32_swap_b32 v75, v79
v_pk_add_f32 v[72:73], v[72:73], v[76:77]
v_pk_add_f32 v[74:75], v[74:75], v[78:79]
ds_write_b128 v37, v[72:75] offset:8192
s_waitcnt lgkmcnt(0)
s_barrier
s_cmp_lg_u32 s23, 63
s_cbranch_scc1 M_nl_30
s_cmp_lg_u32 s20, 3
s_cbranch_scc1 C_last
ds_read_b128 v[80:83], v25 offset:8192
ds_read_b128 v[84:87], v25 offset:9216
ds_read_b128 v[88:91], v25 offset:10240
ds_read_b128 v[92:95], v25 offset:11264
ds_read_b128 v[96:99], v25 offset:8704
ds_read_b128 v[100:103], v25 offset:9728
ds_read_b128 v[104:107], v25 offset:10752
ds_read_b128 v[108:111], v25 offset:11776
s_waitcnt lgkmcnt(0)
v_pk_add_f32 v[80:81], v[80:81], v[84:85]
v_pk_add_f32 v[88:89], v[88:89], v[92:93]
v_pk_add_f32 v[82:83], v[82:83], v[86:87]
v_pk_add_f32 v[90:91], v[90:91], v[94:95]
v_pk_add_f32 v[80:81], v[80:81], v[88:89]
v_pk_add_f32 v[82:83], v[82:83], v[90:91]
v_cvt_pk_bf16_f32 v218, v80, v81
v_cvt_pk_bf16_f32 v219, v82, v83
v_pk_add_f32 v[96:97], v[96:97], v[100:101]
v_pk_add_f32 v[104:105], v[104:105], v[108:109]
v_pk_add_f32 v[98:99], v[98:99], v[102:103]
v_pk_add_f32 v[106:107], v[106:107], v[110:111]
v_pk_add_f32 v[96:97], v[96:97], v[104:105]
v_pk_add_f32 v[98:99], v[98:99], v[106:107]
v_cvt_pk_bf16_f32 v220, v96, v97
v_cvt_pk_bf16_f32 v221, v98, v99
s_branch C_last
M_nl_30:
s_cmp_lg_u32 s20, 3
s_cbranch_scc1 M_noatt_29
ds_read_b128 v[80:83], v25 offset:8192
ds_read_b128 v[84:87], v25 offset:9216
ds_read_b128 v[88:91], v25 offset:10240
ds_read_b128 v[92:95], v25 offset:11264
ds_read_b128 v[96:99], v25 offset:8704
ds_read_b128 v[100:103], v25 offset:9728
ds_read_b128 v[104:107], v25 offset:10752
ds_read_b128 v[108:111], v25 offset:11776
s_waitcnt lgkmcnt(0)
global_load_dwordx4 v[168:171], v6, s[26:27] offset:0 sc1
global_load_dwordx4 v[172:175], v6, s[26:27] offset:512 sc1
global_load_dwordx4 v[176:179], v6, s[26:27] offset:1024 sc1
global_load_dwordx4 v[180:183], v6, s[26:27] offset:1536 sc1
global_load_dwordx4 v[184:187], v6, s[26:27] offset:2048 sc1
global_load_dwordx4 v[188:191], v6, s[26:27] offset:2560 sc1
global_load_dwordx4 v[192:195], v6, s[26:27] offset:3072 sc1
global_load_dwordx4 v[196:199], v6, s[26:27] offset:3584 sc1
v_pk_add_f32 v[80:81], v[80:81], v[84:85]
v_pk_add_f32 v[88:89], v[88:89], v[92:93]
v_pk_add_f32 v[82:83], v[82:83], v[86:87]
v_pk_add_f32 v[90:91], v[90:91], v[94:95]
v_pk_add_f32 v[80:81], v[80:81], v[88:89]
v_pk_add_f32 v[82:83], v[82:83], v[90:91]
v_cvt_pk_bf16_f32 v218, v80, v81
v_cvt_pk_bf16_f32 v219, v82, v83
v_pk_add_f32 v[96:97], v[96:97], v[100:101]
v_pk_add_f32 v[104:105], v[104:105], v[108:109]
v_pk_add_f32 v[98:99], v[98:99], v[102:103]
v_pk_add_f32 v[106:107], v[106:107], v[110:111]
v_pk_add_f32 v[96:97], v[96:97], v[104:105]
v_pk_add_f32 v[98:99], v[98:99], v[106:107]
v_cvt_pk_bf16_f32 v220, v96, v97
v_cvt_pk_bf16_f32 v221, v98, v99
s_mov_b32 s47, 0
M_qp_31:
s_waitcnt vmcnt(4)
v_mfma_f32_16x16x32_bf16 v[200:203], v[128:131], v[168:171], 0
v_max3_u32 v232, v168, v169, v170
v_mfma_f32_16x16x32_bf16 v[200:203], v[132:135], v[172:175], v[200:203]
v_max3_u32 v233, v171, v172, v173
v_mfma_f32_16x16x32_bf16 v[200:203], v[136:139], v[176:179], v[200:203]
v_max3_u32 v232, v232, v174, v175
v_mfma_f32_16x16x32_bf16 v[200:203], v[140:143], v[180:183], v[200:203]
v_max3_u32 v233, v233, v176, v177
v_mfma_f32_16x16x32_bf16 v[204:207], v[144:147], v[168:171], 0
v_max3_u32 v232, v232, v178, v179
v_mfma_f32_16x16x32_bf16 v[204:207], v[148:151], v[172:175], v[204:207]
v_max3_u32 v233, v233, v180, v181
v_mfma_f32_16x16x32_bf16 v[204:207], v[152:155], v[176:179], v[204:207]
v_max3_u32 v232, v232, v182, v183
v_mfma_f32_16x16x32_bf16 v[204:207], v[156:159], v[180:183], v[204:207]
s_waitcnt vmcnt(0)
v_mfma_f32_16x16x32_bf16 v[208:211], v[184:187], v[168:171], 0
v_max3_u32 v232, v232, v184, v185
v_max3_u32 v233, v233, v186, v187
v_max3_u32 v232, v232, v188, v189
v_mfma_f32_16x16x32_bf16 v[208:211], v[188:191], v[172:175], v[208:211]
v_max3_u32 v233, v233, v190, v191
v_max3_u32 v232, v232, v192, v193
v_max3_u32 v233, v233, v194, v195
v_max3_f32 v230, v200, v201, v202
v_mfma_f32_16x16x32_bf16 v[208:211], v[192:195], v[176:179], v[208:211]
v_max3_u32 v232, v232, v196, v197
v_max3_u32 v233, v233, v198, v199
v_max_u32 v232, v232, v233
v_mov_b32 v231, 0xff800000
v_max3_f32 v230, v230, v203, v204
v_mfma_f32_16x16x32_bf16 v[208:211], v[196:199], v[180:183], v[208:211]
v_cmp_eq_u32 vcc, -1, v232
s_cbranch_vccz M_qpd_32
s_add_u32 s47, s47, 1
s_cmp_ge_u32 s47, 300000
s_cbranch_scc1 M_exit0
global_load_dwordx4 v[168:171], v6, s[26:27] offset:0 sc1
global_load_dwordx4 v[172:175], v6, s[26:27] offset:512 sc1
global_load_dwordx4 v[176:179], v6, s[26:27] offset:1024 sc1
global_load_dwordx4 v[180:183], v6, s[26:27] offset:1536 sc1
global_load_dwordx4 v[184:187], v6, s[26:27] offset:2048 sc1
global_load_dwordx4 v[188:191], v6, s[26:27] offset:2560 sc1
global_load_dwordx4 v[192:195], v6, s[26:27] offset:3072 sc1
global_load_dwordx4 v[196:199], v6, s[26:27] offset:3584 sc1
s_branch M_qp_31
M_qpd_32:
v_max3_f32 v230, v230, v205, v206
v_max_f32 v230, v230, v207
s_nop 3
v_cndmask_b32 v208, v208, v231, s[50:51]
v_cndmask_b32 v209, v209, v231, s[50:51]
v_cndmask_b32 v210, v210, v231, s[50:51]
v_cndmask_b32 v211, v211, v231, s[50:51]
v_max3_f32 v230, v230, v208, v209
v_max3_f32 v230, v230, v210, v211
v_mov_b32 v231, v230
s_nop 1
v_permlane16_swap_b32 v230, v231
v_max_f32 v230, v230, v231
v_mov_b32 v231, v230
s_nop 1
v_permlane32_swap_b32 v230, v231
v_max_f32 v230, v230, v231
v_mul_f32 v230, s46, v230
v_fma_f32 v200, v200, s46, -v230
v_fma_f32 v201, v201, s46, -v230
v_fma_f32 v202, v202, s46, -v230
v_fma_f32 v203, v203, s46, -v230
v_fma_f32 v204, v204, s46, -v230
v_fma_f32 v205, v205, s46, -v230
v_fma_f32 v206, v206, s46, -v230
v_fma_f32 v207, v207, s46, -v230
v_fma_f32 v208, v208, s46, -v230
v_fma_f32 v209, v209, s46, -v230
v_fma_f32 v210, v210, s46, -v230
v_fma_f32 v211, v211, s46, -v230
v_exp_f32 v200, v200
v_exp_f32 v201, v201
v_exp_f32 v202, v202
v_exp_f32 v203, v203
v_exp_f32 v204, v204
v_exp_f32 v205, v205
v_exp_f32 v206, v206
v_exp_f32 v207, v207
v_exp_f32 v208, v208
v_exp_f32 v209, v209
v_exp_f32 v210, v210
v_exp_f32 v211, v211
v_cvt_pk_bf16_f32 v212, v200, v201
v_cvt_pk_bf16_f32 v213, v202, v203
v_cvt_pk_bf16_f32 v214, v204, v205
v_cvt_pk_bf16_f32 v215, v206, v207
v_cvt_pk_bf16_f32 v216, v208, v209
v_cvt_pk_bf16_f32 v217, v210, v211
s_nop 1
v_mfma_f32_16x16x16_bf16 v[222:225], v[218:219], v[216:217], 0
v_add_f32 v200, v200, v206
v_add_f32 v201, v201, v207
v_add_f32 v202, v202, v208
v_mfma_f32_16x16x16_bf16 v[226:229], v[220:221], v[216:217], 0
v_add_f32 v203, v203, v209
v_add_f32 v204, v204, v210
v_add_f32 v205, v205, v211
v_add_f32 v200, v200, v203
v_add_f32 v201, v201, v204
v_add_f32 v202, v202, v205
v_mfma_f32_16x16x32_bf16 v[222:225], v[160:163], v[212:215], v[222:225]
v_add_f32 v200, v200, v201
v_add_f32 v230, v200, v202
v_mfma_f32_16x16x32_bf16 v[226:229], v[164:167], v[212:215], v[226:229]
v_mov_b32 v231, v230
s_nop 1
v_permlane16_swap_b32 v230, v231
v_add_f32 v230, v230, v231
v_mov_b32 v231, v230
s_nop 1
v_permlane32_swap_b32 v230, v231
v_add_f32 v230, v230, v231
v_rcp_f32 v230, v230
v_cndmask_b32 v232, v226, v222, s[48:49]
v_cndmask_b32 v233, v227, v223, s[48:49]
v_cndmask_b32 v234, v228, v224, s[48:49]
v_cndmask_b32 v235, v229, v225, s[48:49]
v_mul_f32 v232, v232, v230
v_mul_f32 v233, v233, v230
v_mul_f32 v234, v234, v230
v_mul_f32 v235, v235, v230
v_cvt_pk_bf16_f32 v236, v232, v233
v_cvt_pk_bf16_f32 v237, v234, v235
global_store_dword v11, v236, s[28:29]
global_store_dword v11, v237, s[28:29] offset:128
M_noatt_29:
s_barrier
s_sleep 1
s_mov_b32 s47, 0
global_load_dwordx4 v[40:43], v32, s[28:29] offset:0 sc1
v_mov_b32 v56, 0
v_mov_b32 v57, 0
v_mov_b32 v58, 0
v_mov_b32 v59, 0
v_mov_b32 v60, 0
v_mov_b32 v61, 0
v_mov_b32 v62, 0
v_mov_b32 v63, 0
global_load_dwordx4 v[44:47], v32, s[28:29] offset:1024 sc1
v_nop
v_nop
v_nop
v_nop
v_nop
v_nop
v_nop
v_nop
global_load_dwordx4 v[48:51], v32, s[28:29] offset:2048 sc1
v_nop
v_nop
v_nop
v_nop
v_nop
v_nop
v_nop
v_nop
global_load_dwordx4 v[52:55], v32, s[28:29] offset:3072 sc1
s_waitcnt vmcnt(3)
v_max3_u32 v26, v40, v41, v42
v_max_u32 v26, v26, v43
v_cmp_eq_u32 vcc, -1, v26
s_cbranch_vccnz M_rt_33
M_bd_37:
v_smfmac_f32_16x16x64_bf16 v[56:59], v[40:43], a[192:199], v14
s_waitcnt vmcnt(2)
v_max3_u32 v26, v44, v45, v46
v_smfmac_f32_16x16x64_bf16 v[60:63], v[40:43], a[200:207], v14
v_max_u32 v26, v26, v47
v_cmp_eq_u32 vcc, -1, v26
s_cbranch_vccnz M_rt_34
M_bd_38:
v_smfmac_f32_16x16x64_bf16 v[56:59], v[44:47], a[208:215], v14
s_waitcnt vmcnt(1)
v_max3_u32 v26, v48, v49, v50
v_smfmac_f32_16x16x64_bf16 v[60:63], v[44:47], a[216:223], v14
v_max_u32 v26, v26, v51
v_cmp_eq_u32 vcc, -1, v26
s_cbranch_vccnz M_rt_35
M_bd_39:
v_smfmac_f32_16x16x64_bf16 v[56:59], v[48:51], a[224:231], v14
s_waitcnt vmcnt(0)
v_max3_u32 v26, v52, v53, v54
v_smfmac_f32_16x16x64_bf16 v[60:63], v[48:51], a[232:239], v14
v_max_u32 v26, v26, v55
v_cmp_eq_u32 vcc, -1, v26
s_cbranch_vccnz M_rt_36
M_bd_40:
v_smfmac_f32_16x16x64_bf16 v[56:59], v[52:55], a[240:247], v14
v_smfmac_f32_16x16x64_bf16 v[60:63], v[52:55], a[248:255], v14
s_branch M_cdone_41
M_rt_33:
s_add_u32 s47, s47, 1
s_cmp_ge_u32 s47, 300000
s_cbranch_scc1 M_exit0
global_load_dwordx4 v[40:43], v32, s[28:29] offset:0 sc1
global_load_dwordx4 v[44:47], v32, s[28:29] offset:1024 sc1
global_load_dwordx4 v[48:51], v32, s[28:29] offset:2048 sc1
global_load_dwordx4 v[52:55], v32, s[28:29] offset:3072 sc1
s_waitcnt vmcnt(3)
v_max3_u32 v26, v40, v41, v42
v_max_u32 v26, v26, v43
v_cmp_eq_u32 vcc, -1, v26
s_cbranch_vccnz M_rt_33
s_branch M_bd_37
M_rt_34:
s_add_u32 s47, s47, 1
s_cmp_ge_u32 s47, 300000
s_cbranch_scc1 M_exit0
global_load_dwordx4 v[44:47], v32, s[28:29] offset:1024 sc1
global_load_dwordx4 v[48:51], v32, s[28:29] offset:2048 sc1
global_load_dwordx4 v[52:55], v32, s[28:29] offset:3072 sc1
s_waitcnt vmcnt(2)
v_max3_u32 v26, v44, v45, v46
v_max_u32 v26, v26, v47
v_cmp_eq_u32 vcc, -1, v26
s_cbranch_vccnz M_rt_34
s_branch M_bd_38
M_rt_35:
s_add_u32 s47, s47, 1
s_cmp_ge_u32 s47, 300000
s_cbranch_scc1 M_exit0
global_load_dwordx4 v[48:51], v32, s[28:29] offset:2048 sc1
global_load_dwordx4 v[52:55], v32, s[28:29] offset:3072 sc1
s_waitcnt vmcnt(1)
v_max3_u32 v26, v48, v49, v50
v_max_u32 v26, v26, v51
v_cmp_eq_u32 vcc, -1, v26
s_cbranch_vccnz M_rt_35
s_branch M_bd_39
M_rt_36:
s_add_u32 s47, s47, 1
s_cmp_ge_u32 s47, 300000
s_cbranch_scc1 M_exit0
global_load_dwordx4 v[52:55], v32, s[28:29] offset:3072 sc1
s_waitcnt vmcnt(0)
v_max3_u32 v26, v52, v53, v54
v_max_u32 v26, v26, v55
v_cmp_eq_u32 vcc, -1, v26
s_cbranch_vccnz M_rt_36
s_branch M_bd_40
M_cdone_41:
s_nop 6
v_permlane32_swap_b32 v56, v60
v_permlane32_swap_b32 v57, v61
v_permlane32_swap_b32 v58, v62
v_permlane32_swap_b32 v59, v63
v_pk_add_f32 v[56:57], v[56:57], v[60:61]
v_pk_add_f32 v[58:59], v[58:59], v[62:63]
ds_write_b128 v37, v[56:59] offset:12288
s_waitcnt lgkmcnt(0)
s_barrier
ds_read_b32 v80, v15 offset:12288
ds_read_b32 v81, v15 offset:13312
ds_read_b32 v82, v15 offset:14336
ds_read_b32 v83, v15 offset:15360
s_waitcnt lgkmcnt(0)
v_pk_add_f32 v[80:81], v[80:81], v[82:83]
v_add_f32 v80, v80, v81
global_store_dword v33, v80, s[30:31] sc1
s_cmp_lg_u32 s20, 0
s_cbranch_scc1 M_notw0_42
s_add_u32 s42, s23, 1
s_and_b32 s42, s42, 3
s_mul_i32 s42, s42, 16384
s_add_u32 s92, s56, s42
s_addc_u32 s93, s57, 0
s_mov_b32 s47, 0
s_sleep 5
M_poll_46:
global_load_dwordx4 v[40:43], v4, s[30:31] offset:0 sc1
global_load_dwordx4 v[44:47], v4, s[30:31] offset:1024 sc1
global_load_dwordx4 v[48:51], v4, s[30:31] offset:2048 sc1
global_load_dwordx4 v[52:55], v4, s[30:31] offset:3072 sc1
s_waitcnt vmcnt(0)
v_max3_u32 v26, v40, v41, v42
v_max3_u32 v26, v26, v43, v44
v_max3_u32 v26, v26, v45, v46
v_max3_u32 v26, v26, v47, v48
v_max3_u32 v26, v26, v49, v50
v_max3_u32 v26, v26, v51, v52
v_max3_u32 v26, v26, v53, v54
v_max_u32 v26, v26, v55
v_cmp_eq_u32 vcc, -1, v26
s_cbranch_vccz M_polld_47
s_sleep 1
s_add_u32 s47, s47, 1
s_cmp_lt_u32 s47, 300000
s_cbranch_scc1 M_poll_46
s_branch M_exit0
M_polld_47:
v_pk_add_f32 v[40:41], v[40:41], v[44:45]
v_pk_add_f32 v[48:49], v[48:49], v[52:53]
v_pk_add_f32 v[42:43], v[42:43], v[46:47]
v_pk_add_f32 v[50:51], v[50:51], v[54:55]
v_pk_add_f32 v[40:41], v[40:41], v[48:49]
v_pk_add_f32 v[42:43], v[42:43], v[50:51]
v_cvt_pk_bf16_f32 v80, v40, v41
v_cvt_pk_bf16_f32 v81, v42, v43
global_store_dwordx2 v12, v[80:81], s[92:93]
s_branch M_endD_43
M_notw0_42:
s_sleep 2
s_cmp_lg_u32 s20, 1
s_cbranch_scc1 M_notw1_44
s_add_u32 s42, s23, 2
s_and_b32 s42, s42, 3
s_mul_i32 s42, s42, 32768
s_add_u32 s40, s58, s42
s_addc_u32 s41, s59, 0
global_store_dwordx4 v21, v[16:19], s[40:41]
s_add_u32 s42, s23, 2
s_and_b32 s42, s42, 3
s_mul_i32 s42, s42, 262144
s_add_u32 s40, s98, s42
s_addc_u32 s41, s99, 0
global_store_dwordx4 v23, v[16:19], s[40:41] sc1
s_mov_b32 exec_hi, 0
s_add_u32 s42, s23, 3
s_and_b32 s42, s42, 3
s_mul_i32 s42, s42, 16384
s_add_u32 s40, s56, s42
s_addc_u32 s41, s57, 0
global_store_dwordx4 v20, v[16:19], s[40:41]
s_add_u32 s42, s23, 2
s_and_b32 s42, s42, 3
s_mul_i32 s42, s42, 16384
s_add_u32 s40, s96, s42
s_addc_u32 s41, s97, 0
global_store_dwordx4 v22, v[16:19], s[40:41]
s_mov_b64 exec, -1
s_branch M_endD_43
M_notw1_44:
s_cmp_lg_u32 s20, 2
s_cbranch_scc1 M_nh2_48
s_cmp_lt_u32 s23, 2
s_cbranch_scc1 M_ns_49
s_cmp_lg_u32 s19, 0
s_cbranch_scc1 M_ns_49
s_lshl_b32 s42, s18, 2
s_add_u32 s42, s42, 224
v_mov_b32 v26, s42
v_mov_b32 v27, 32
s_mov_b64 exec, 1
global_atomic_add v26, v27, s[14:15]
s_mov_b64 exec, -1
M_ns_49:
M_nh2_48:
global_store_dword v5, v34, s[36:37] offset:-2048 sc1
s_cmp_lg_u32 s20, 3
s_cbranch_scc1 M_endD_43
s_mov_b32 exec_hi, 0
global_store_dwordx2 v24, v[218:219], s[38:39] offset:0 sc1
global_store_dwordx2 v24, v[220:221], s[38:39] offset:256 sc1
s_mov_b64 exec, -1
s_cmp_ge_u32 s23, 63
s_cbranch_scc1 M_endD_43
s_add_u32 s32, s32, 262144
s_addc_u32 s33, s33, 0
s_add_u32 s34, s34, 262144
s_addc_u32 s35, s35, 0
s_add_u32 s42, s23, 1
s_and_b32 s43, s42, 7
s_cmp_lg_u32 s43, 0
s_cbranch_scc1 M_kvw_50
s_lshr_b32 s43, s42, 3
s_lshl_b32 s43, s43, 2
s_add_u32 s43, s43, 96
v_mov_b32 v26, s43
s_mov_b32 s47, 0
M_kvp_51:
global_load_dword v27, v26, s[14:15] sc1
s_waitcnt vmcnt(0)
v_readfirstlane_b32 s43, v27
s_cmp_ge_u32 s43, 128
s_cbranch_scc1 M_kvd_52
s_sleep 32
s_add_u32 s47, s47, 1
s_cmp_lt_u32 s47, 400000
s_cbranch_scc1 M_kvp_51
s_branch M_exit0
M_kvd_52:
M_kvw_50:
global_load_dwordx4 v[128:131], v7, s[32:33] offset:0 sc1
global_load_dwordx4 v[132:135], v7, s[32:33] offset:1024 sc1
global_load_dwordx4 v[136:139], v7, s[32:33] offset:2048 sc1
global_load_dwordx4 v[140:143], v7, s[32:33] offset:3072 sc1
global_load_dwordx4 v[144:147], v8, s[32:33] offset:0 sc1
global_load_dwordx4 v[148:151], v8, s[32:33] offset:1024 sc1
global_load_dwordx4 v[152:155], v8, s[32:33] offset:2048 sc1
global_load_dwordx4 v[156:159], v8, s[32:33] offset:3072 sc1
global_load_dwordx4 v[160:163], v9, s[34:35] offset:0 sc1
global_load_dwordx4 v[164:167], v9, s[34:35] offset:1024 sc1
M_endD_43:
s_barrier
s_add_u32 s36, s36, 65536
s_addc_u32 s37, s37, 0
s_add_u32 s38, s38, 65536
s_addc_u32 s39, s39, 0
s_add_u32 s23, s23, 1
s_and_b32 s43, s23, 3
s_mul_i32 s42, s43, 16384
s_add_u32 s24, s56, s42
s_addc_u32 s25, s57, 0
s_mul_i32 s42, s43, 32768
s_add_u32 s26, s58, s42
s_addc_u32 s27, s59, 0
s_mul_i32 s42, s43, 16384
s_add_u32 s28, s96, s42
s_addc_u32 s29, s97, 0
s_mul_i32 s42, s43, 262144
s_add_u32 s30, s98, s42
s_addc_u32 s31, s99, 0
s_cmp_lt_u32 s23, 64
s_cbranch_scc1 C_step
C_last:
s_cmp_lt_u32 s20, 2
s_cbranch_scc1 M_lk_53
global_store_dword v5, v34, s[36:37] offset:-2048 sc1
s_cmp_lg_u32 s20, 3
s_cbranch_scc1 M_lk_53
s_mov_b32 exec_hi, 0
global_store_dwordx2 v24, v[218:219], s[38:39] offset:0 sc1
global_store_dwordx2 v24, v[220:221], s[38:39] offset:256 sc1
s_mov_b64 exec, -1
M_lk_53:
s_waitcnt vmcnt(0)
s_barrier
s_cmp_lg_u32 s20, 2
s_cbranch_scc1 M_ls_54
s_lshl_b32 s42, s18, 2
s_add_u32 s42, s42, 224
v_mov_b32 v26, s42
v_mov_b32 v27, 3
s_mov_b64 exec, 1
global_atomic_add v26, v27, s[14:15]
s_mov_b64 exec, -1
M_ls_54:
M_pre:
s_load_dwordx2 s[30:31], s[0:1], 0
s_load_dwordx2 s[32:33], s[0:1], 96
s_waitcnt lgkmcnt(0)
v_and_b32 v1, 63, v0
v_and_b32 v2, 15, v1
v_lshrrev_b32 v3, 4, v1
v_lshlrev_b32 v4, 4, v1
s_cmp_lg_u32 s20, 0
s_cbranch_scc1 M_tw_55
s_lshl_b32 s42, s18, 2
s_add_u32 s42, s42, 176161248
v_lshlrev_b32 v26, 4, v1
v_add_u32 v26, s42, v26
s_mov_b32 s47, 0
s_mov_b64 exec, 3
M_tp_56:
global_load_dword v27, v26, s[16:17] sc1
s_waitcnt vmcnt(0)
v_cmp_gt_u32 vcc, 4, v27
s_cbranch_vccz M_tpd_57
s_sleep 4
s_add_u32 s47, s47, 1
s_cmp_lt_u32 s47, 1200000
s_cbranch_scc1 M_tp_56
s_mov_b64 exec, -1
s_branch M_exit0
M_tpd_57:
s_mov_b64 exec, -1
v_mov_b32 v26, 220
s_mov_b32 s47, 0
s_mov_b64 exec, 1
M_tp_58:
global_load_dword v27, v26, s[14:15] sc1
s_waitcnt vmcnt(0)
v_cmp_gt_u32 vcc, 8, v27
s_cbranch_vccz M_tpd_59
s_sleep 4
s_add_u32 s47, s47, 1
s_cmp_lt_u32 s47, 1200000
s_cbranch_scc1 M_tp_58
s_mov_b64 exec, -1
s_branch M_exit0
M_tpd_59:
s_mov_b64 exec, -1
M_tw_55:
s_barrier
v_lshrrev_b32 v26, 2, v2
v_lshrrev_b32 v27, 1, v26
v_xor_b32 v26, v26, v27
v_and_b32 v26, 1, v26
v_lshl_add_u32 v27, v26, 1, v27
v_xor_b32 v27, v27, v3
v_lshlrev_b32 v27, 4, v27
v_lshl_add_u32 v52, v2, 6, v27
v_add_u32 v53, 131072, v52
v_add_u32 v54, 131072, v53
v_add_u32 v55, 131072, v54
v_add_u32 v56, 131072, v55
v_add_u32 v57, 131072, v56
v_add_u32 v58, 131072, v57
v_add_u32 v59, 131072, v58
s_lshl_b32 s42, s18, 5
s_lshl_b32 s43, s20, 3
s_add_u32 s42, s42, s43
s_lshl_b32 s42, s42, 17
s_add_u32 s42, s42, 84008960
s_add_u32 s24, s16, s42
s_addc_u32 s25, s17, 0
s_lshl_b32 s42, s18, 1
s_lshr_b32 s43, s20, 1
s_add_u32 s42, s42, s43
s_lshl_b32 s42, s42, 15
s_add_u32 s42, s42, 3932160
s_lshl_b32 s43, s19, 6
s_add_u32 s42, s42, s43
s_and_b32 s43, s20, 1
s_lshl_b32 s43, s43, 5
s_add_u32 s42, s42, s43
v_lshlrev_b32 v48, 13, v3
v_lshl_add_u32 v48, v2, 1, v48
v_add_u32 v48, s42, v48
v_add_u32 v49, 4096, v48
v_add_u32 v50, 75497472, v48
v_add_u32 v51, 75497472, v49
global_load_ushort v40, v50, s[16:17] offset:0 sc1
global_load_ushort v44, v48, s[30:31] offset:0
global_load_ushort v41, v50, s[16:17] offset:2048 sc1
global_load_ushort v45, v48, s[30:31] offset:2048
global_load_ushort v42, v51, s[16:17] offset:0 sc1
global_load_ushort v46, v49, s[30:31] offset:0
global_load_ushort v43, v51, s[16:17] offset:2048 sc1
global_load_ushort v47, v49, s[30:31] offset:2048
global_load_dwordx4 v[128:131], v52, s[24:25] offset:0 sc1
global_load_dwordx4 v[132:135], v53, s[24:25] offset:0 sc1
global_load_dwordx4 v[136:139], v54, s[24:25] offset:0 sc1
global_load_dwordx4 v[140:143], v55, s[24:25] offset:0 sc1
global_load_dwordx4 v[144:147], v56, s[24:25] offset:0 sc1
global_load_dwordx4 v[148:151], v57, s[24:25] offset:0 sc1
global_load_dwordx4 v[152:155], v58, s[24:25] offset:0 sc1
global_load_dwordx4 v[156:159], v59, s[24:25] offset:0 sc1
global_load_dwordx4 v[160:163], v52, s[24:25] offset:1024 sc1
global_load_dwordx4 v[164:167], v53, s[24:25] offset:1024 sc1
global_load_dwordx4 v[168:171], v54, s[24:25] offset:1024 sc1
global_load_dwordx4 v[172:175], v55, s[24:25] offset:1024 sc1
global_load_dwordx4 v[176:179], v56, s[24:25] offset:1024 sc1
global_load_dwordx4 v[180:183], v57, s[24:25] offset:1024 sc1
global_load_dwordx4 v[184:187], v58, s[24:25] offset:1024 sc1
global_load_dwordx4 v[188:191], v59, s[24:25] offset:1024 sc1
global_load_dwordx4 v[192:195], v52, s[24:25] offset:2048 sc1
global_load_dwordx4 v[196:199], v53, s[24:25] offset:2048 sc1
global_load_dwordx4 v[200:203], v54, s[24:25] offset:2048 sc1
global_load_dwordx4 v[204:207], v55, s[24:25] offset:2048 sc1
global_load_dwordx4 v[208:211], v56, s[24:25] offset:2048 sc1
global_load_dwordx4 v[212:215], v57, s[24:25] offset:2048 sc1
global_load_dwordx4 v[216:219], v58, s[24:25] offset:2048 sc1
global_load_dwordx4 v[220:223], v59, s[24:25] offset:2048 sc1
global_load_dwordx4 v[224:227], v52, s[24:25] offset:3072 sc1
global_load_dwordx4 v[228:231], v53, s[24:25] offset:3072 sc1
global_load_dwordx4 v[232:235], v54, s[24:25] offset:3072 sc1
global_load_dwordx4 v[236:239], v55, s[24:25] offset:3072 sc1
global_load_dwordx4 v[240:243], v56, s[24:25] offset:3072 sc1
global_load_dwordx4 v[244:247], v57, s[24:25] offset:3072 sc1
global_load_dwordx4 v[248:251], v58, s[24:25] offset:3072 sc1
global_load_dwordx4 v[252:255], v59, s[24:25] offset:3072 sc1
s_waitcnt vmcnt(24)
v_mfma_f32_16x16x32_bf16 v[64:67], v[128:131], a[192:195], 0
v_mfma_f32_16x16x32_bf16 v[68:71], v[128:131], a[200:203], 0
v_mfma_f32_16x16x32_bf16 v[64:67], v[132:135], a[196:199], v[64:67]
v_mfma_f32_16x16x32_bf16 v[68:71], v[132:135], a[204:207], v[68:71]
v_mfma_f32_16x16x32_bf16 v[64:67], v[136:139], a[208:211], v[64:67]
v_mfma_f32_16x16x32_bf16 v[68:71], v[136:139], a[216:219], v[68:71]
v_mfma_f32_16x16x32_bf16 v[64:67], v[140:143], a[212:215], v[64:67]
v_mfma_f32_16x16x32_bf16 v[68:71], v[140:143], a[220:223], v[68:71]
v_mfma_f32_16x16x32_bf16 v[64:67], v[144:147], a[224:227], v[64:67]
v_mfma_f32_16x16x32_bf16 v[68:71], v[144:147], a[232:235], v[68:71]
v_mfma_f32_16x16x32_bf16 v[64:67], v[148:151], a[228:231], v[64:67]
v_mfma_f32_16x16x32_bf16 v[68:71], v[148:151], a[236:239], v[68:71]
v_mfma_f32_16x16x32_bf16 v[64:67], v[152:155], a[240:243], v[64:67]
v_mfma_f32_16x16x32_bf16 v[68:71], v[152:155], a[248:251], v[68:71]
v_mfma_f32_16x16x32_bf16 v[64:67], v[156:159], a[244:247], v[64:67]
v_mfma_f32_16x16x32_bf16 v[68:71], v[156:159], a[252:255], v[68:71]
s_waitcnt vmcnt(16)
v_mfma_f32_16x16x32_bf16 v[72:75], v[160:163], a[192:195], 0
v_mfma_f32_16x16x32_bf16 v[76:79], v[160:163], a[200:203], 0
v_mfma_f32_16x16x32_bf16 v[72:75], v[164:167], a[196:199], v[72:75]
v_mfma_f32_16x16x32_bf16 v[76:79], v[164:167], a[204:207], v[76:79]
v_mfma_f32_16x16x32_bf16 v[72:75], v[168:171], a[208:211], v[72:75]
v_mfma_f32_16x16x32_bf16 v[76:79], v[168:171], a[216:219], v[76:79]
v_mfma_f32_16x16x32_bf16 v[72:75], v[172:175], a[212:215], v[72:75]
v_mfma_f32_16x16x32_bf16 v[76:79], v[172:175], a[220:223], v[76:79]
v_mfma_f32_16x16x32_bf16 v[72:75], v[176:179], a[224:227], v[72:75]
v_mfma_f32_16x16x32_bf16 v[76:79], v[176:179], a[232:235], v[76:79]
v_mfma_f32_16x16x32_bf16 v[72:75], v[180:183], a[228:231], v[72:75]
v_mfma_f32_16x16x32_bf16 v[76:79], v[180:183], a[236:239], v[76:79]
v_mfma_f32_16x16x32_bf16 v[72:75], v[184:187], a[240:243], v[72:75]
v_mfma_f32_16x16x32_bf16 v[76:79], v[184:187], a[248:251], v[76:79]
v_mfma_f32_16x16x32_bf16 v[72:75], v[188:191], a[244:247], v[72:75]
v_mfma_f32_16x16x32_bf16 v[76:79], v[188:191], a[252:255], v[76:79]
s_waitcnt vmcnt(8)
v_mfma_f32_16x16x32_bf16 v[80:83], v[192:195], a[192:195], 0
v_mfma_f32_16x16x32_bf16 v[84:87], v[192:195], a[200:203], 0
v_mfma_f32_16x16x32_bf16 v[80:83], v[196:199], a[196:199], v[80:83]
v_mfma_f32_16x16x32_bf16 v[84:87], v[196:199], a[204:207], v[84:87]
v_mfma_f32_16x16x32_bf16 v[80:83], v[200:203], a[208:211], v[80:83]
v_mfma_f32_16x16x32_bf16 v[84:87], v[200:203], a[216:219], v[84:87]
v_mfma_f32_16x16x32_bf16 v[80:83], v[204:207], a[212:215], v[80:83]
v_mfma_f32_16x16x32_bf16 v[84:87], v[204:207], a[220:223], v[84:87]
v_mfma_f32_16x16x32_bf16 v[80:83], v[208:211], a[224:227], v[80:83]
v_mfma_f32_16x16x32_bf16 v[84:87], v[208:211], a[232:235], v[84:87]
v_mfma_f32_16x16x32_bf16 v[80:83], v[212:215], a[228:231], v[80:83]
v_mfma_f32_16x16x32_bf16 v[84:87], v[212:215], a[236:239], v[84:87]
v_mfma_f32_16x16x32_bf16 v[80:83], v[216:219], a[240:243], v[80:83]
v_mfma_f32_16x16x32_bf16 v[84:87], v[216:219], a[248:251], v[84:87]
v_mfma_f32_16x16x32_bf16 v[80:83], v[220:223], a[244:247], v[80:83]
v_mfma_f32_16x16x32_bf16 v[84:87], v[220:223], a[252:255], v[84:87]
s_waitcnt vmcnt(0)
v_mfma_f32_16x16x32_bf16 v[88:91], v[224:227], a[192:195], 0
v_mfma_f32_16x16x32_bf16 v[92:95], v[224:227], a[200:203], 0
v_mfma_f32_16x16x32_bf16 v[88:91], v[228:231], a[196:199], v[88:91]
v_mfma_f32_16x16x32_bf16 v[92:95], v[228:231], a[204:207], v[92:95]
v_mfma_f32_16x16x32_bf16 v[88:91], v[232:235], a[208:211], v[88:91]
v_mfma_f32_16x16x32_bf16 v[92:95], v[232:235], a[216:219], v[92:95]
v_mfma_f32_16x16x32_bf16 v[88:91], v[236:239], a[212:215], v[88:91]
v_mfma_f32_16x16x32_bf16 v[92:95], v[236:239], a[220:223], v[92:95]
v_mfma_f32_16x16x32_bf16 v[88:91], v[240:243], a[224:227], v[88:91]
v_mfma_f32_16x16x32_bf16 v[92:95], v[240:243], a[232:235], v[92:95]
v_mfma_f32_16x16x32_bf16 v[88:91], v[244:247], a[228:231], v[88:91]
v_mfma_f32_16x16x32_bf16 v[92:95], v[244:247], a[236:239], v[92:95]
v_mfma_f32_16x16x32_bf16 v[88:91], v[248:251], a[240:243], v[88:91]
v_mfma_f32_16x16x32_bf16 v[92:95], v[248:251], a[248:251], v[92:95]
v_mfma_f32_16x16x32_bf16 v[88:91], v[252:255], a[244:247], v[88:91]
v_mfma_f32_16x16x32_bf16 v[92:95], v[252:255], a[252:255], v[92:95]
s_add_u32 s24, s24, 4096
s_addc_u32 s25, s25, 0
global_load_dwordx4 v[128:131], v52, s[24:25] offset:0 sc1
global_load_dwordx4 v[132:135], v53, s[24:25] offset:0 sc1
global_load_dwordx4 v[136:139], v54, s[24:25] offset:0 sc1
global_load_dwordx4 v[140:143], v55, s[24:25] offset:0 sc1
global_load_dwordx4 v[144:147], v56, s[24:25] offset:0 sc1
global_load_dwordx4 v[148:151], v57, s[24:25] offset:0 sc1
global_load_dwordx4 v[152:155], v58, s[24:25] offset:0 sc1
global_load_dwordx4 v[156:159], v59, s[24:25] offset:0 sc1
global_load_dwordx4 v[160:163], v52, s[24:25] offset:1024 sc1
global_load_dwordx4 v[164:167], v53, s[24:25] offset:1024 sc1
global_load_dwordx4 v[168:171], v54, s[24:25] offset:1024 sc1
global_load_dwordx4 v[172:175], v55, s[24:25] offset:1024 sc1
global_load_dwordx4 v[176:179], v56, s[24:25] offset:1024 sc1
global_load_dwordx4 v[180:183], v57, s[24:25] offset:1024 sc1
global_load_dwordx4 v[184:187], v58, s[24:25] offset:1024 sc1
global_load_dwordx4 v[188:191], v59, s[24:25] offset:1024 sc1
global_load_dwordx4 v[192:195], v52, s[24:25] offset:2048 sc1
global_load_dwordx4 v[196:199], v53, s[24:25] offset:2048 sc1
global_load_dwordx4 v[200:203], v54, s[24:25] offset:2048 sc1
global_load_dwordx4 v[204:207], v55, s[24:25] offset:2048 sc1
global_load_dwordx4 v[208:211], v56, s[24:25] offset:2048 sc1
global_load_dwordx4 v[212:215], v57, s[24:25] offset:2048 sc1
global_load_dwordx4 v[216:219], v58, s[24:25] offset:2048 sc1
global_load_dwordx4 v[220:223], v59, s[24:25] offset:2048 sc1
global_load_dwordx4 v[224:227], v52, s[24:25] offset:3072 sc1
global_load_dwordx4 v[228:231], v53, s[24:25] offset:3072 sc1
global_load_dwordx4 v[232:235], v54, s[24:25] offset:3072 sc1
global_load_dwordx4 v[236:239], v55, s[24:25] offset:3072 sc1
global_load_dwordx4 v[240:243], v56, s[24:25] offset:3072 sc1
global_load_dwordx4 v[244:247], v57, s[24:25] offset:3072 sc1
global_load_dwordx4 v[248:251], v58, s[24:25] offset:3072 sc1
global_load_dwordx4 v[252:255], v59, s[24:25] offset:3072 sc1
s_waitcnt vmcnt(24)
v_mfma_f32_16x16x32_bf16 v[96:99], v[128:131], a[192:195], 0
v_mfma_f32_16x16x32_bf16 v[100:103], v[128:131], a[200:203], 0
v_mfma_f32_16x16x32_bf16 v[96:99], v[132:135], a[196:199], v[96:99]
v_mfma_f32_16x16x32_bf16 v[100:103], v[132:135], a[204:207], v[100:103]
v_mfma_f32_16x16x32_bf16 v[96:99], v[136:139], a[208:211], v[96:99]
v_mfma_f32_16x16x32_bf16 v[100:103], v[136:139], a[216:219], v[100:103]
v_mfma_f32_16x16x32_bf16 v[96:99], v[140:143], a[212:215], v[96:99]
v_mfma_f32_16x16x32_bf16 v[100:103], v[140:143], a[220:223], v[100:103]
v_mfma_f32_16x16x32_bf16 v[96:99], v[144:147], a[224:227], v[96:99]
v_mfma_f32_16x16x32_bf16 v[100:103], v[144:147], a[232:235], v[100:103]
v_mfma_f32_16x16x32_bf16 v[96:99], v[148:151], a[228:231], v[96:99]
v_mfma_f32_16x16x32_bf16 v[100:103], v[148:151], a[236:239], v[100:103]
v_mfma_f32_16x16x32_bf16 v[96:99], v[152:155], a[240:243], v[96:99]
v_mfma_f32_16x16x32_bf16 v[100:103], v[152:155], a[248:251], v[100:103]
v_mfma_f32_16x16x32_bf16 v[96:99], v[156:159], a[244:247], v[96:99]
v_mfma_f32_16x16x32_bf16 v[100:103], v[156:159], a[252:255], v[100:103]
s_waitcnt vmcnt(16)
v_mfma_f32_16x16x32_bf16 v[104:107], v[160:163], a[192:195], 0
v_mfma_f32_16x16x32_bf16 v[108:111], v[160:163], a[200:203], 0
v_mfma_f32_16x16x32_bf16 v[104:107], v[164:167], a[196:199], v[104:107]
v_mfma_f32_16x16x32_bf16 v[108:111], v[164:167], a[204:207], v[108:111]
v_mfma_f32_16x16x32_bf16 v[104:107], v[168:171], a[208:211], v[104:107]
v_mfma_f32_16x16x32_bf16 v[108:111], v[168:171], a[216:219], v[108:111]
v_mfma_f32_16x16x32_bf16 v[104:107], v[172:175], a[212:215], v[104:107]
v_mfma_f32_16x16x32_bf16 v[108:111], v[172:175], a[220:223], v[108:111]
v_mfma_f32_16x16x32_bf16 v[104:107], v[176:179], a[224:227], v[104:107]
v_mfma_f32_16x16x32_bf16 v[108:111], v[176:179], a[232:235], v[108:111]
v_mfma_f32_16x16x32_bf16 v[104:107], v[180:183], a[228:231], v[104:107]
v_mfma_f32_16x16x32_bf16 v[108:111], v[180:183], a[236:239], v[108:111]
v_mfma_f32_16x16x32_bf16 v[104:107], v[184:187], a[240:243], v[104:107]
v_mfma_f32_16x16x32_bf16 v[108:111], v[184:187], a[248:251], v[108:111]
v_mfma_f32_16x16x32_bf16 v[104:107], v[188:191], a[244:247], v[104:107]
v_mfma_f32_16x16x32_bf16 v[108:111], v[188:191], a[252:255], v[108:111]
s_waitcnt vmcnt(8)
v_mfma_f32_16x16x32_bf16 v[112:115], v[192:195], a[192:195], 0
v_mfma_f32_16x16x32_bf16 v[116:119], v[192:195], a[200:203], 0
v_mfma_f32_16x16x32_bf16 v[112:115], v[196:199], a[196:199], v[112:115]
v_mfma_f32_16x16x32_bf16 v[116:119], v[196:199], a[204:207], v[116:119]
v_mfma_f32_16x16x32_bf16 v[112:115], v[200:203], a[208:211], v[112:115]
v_mfma_f32_16x16x32_bf16 v[116:119], v[200:203], a[216:219], v[116:119]
v_mfma_f32_16x16x32_bf16 v[112:115], v[204:207], a[212:215], v[112:115]
v_mfma_f32_16x16x32_bf16 v[116:119], v[204:207], a[220:223], v[116:119]
v_mfma_f32_16x16x32_bf16 v[112:115], v[208:211], a[224:227], v[112:115]
v_mfma_f32_16x16x32_bf16 v[116:119], v[208:211], a[232:235], v[116:119]
v_mfma_f32_16x16x32_bf16 v[112:115], v[212:215], a[228:231], v[112:115]
v_mfma_f32_16x16x32_bf16 v[116:119], v[212:215], a[236:239], v[116:119]
v_mfma_f32_16x16x32_bf16 v[112:115], v[216:219], a[240:243], v[112:115]
v_mfma_f32_16x16x32_bf16 v[116:119], v[216:219], a[248:251], v[116:119]
v_mfma_f32_16x16x32_bf16 v[112:115], v[220:223], a[244:247], v[112:115]
v_mfma_f32_16x16x32_bf16 v[116:119], v[220:223], a[252:255], v[116:119]
s_waitcnt vmcnt(0)
v_mfma_f32_16x16x32_bf16 v[120:123], v[224:227], a[192:195], 0
v_mfma_f32_16x16x32_bf16 v[124:127], v[224:227], a[200:203], 0
v_mfma_f32_16x16x32_bf16 v[120:123], v[228:231], a[196:199], v[120:123]
v_mfma_f32_16x16x32_bf16 v[124:127], v[228:231], a[204:207], v[124:127]
v_mfma_f32_16x16x32_bf16 v[120:123], v[232:235], a[208:211], v[120:123]
v_mfma_f32_16x16x32_bf16 v[124:127], v[232:235], a[216:219], v[124:127]
v_mfma_f32_16x16x32_bf16 v[120:123], v[236:239], a[212:215], v[120:123]
v_mfma_f32_16x16x32_bf16 v[124:127], v[236:239], a[220:223], v[124:127]
v_mfma_f32_16x16x32_bf16 v[120:123], v[240:243], a[224:227], v[120:123]
v_mfma_f32_16x16x32_bf16 v[124:127], v[240:243], a[232:235], v[124:127]
v_mfma_f32_16x16x32_bf16 v[120:123], v[244:247], a[228:231], v[120:123]
v_mfma_f32_16x16x32_bf16 v[124:127], v[244:247], a[236:239], v[124:127]
v_mfma_f32_16x16x32_bf16 v[120:123], v[248:251], a[240:243], v[120:123]
v_mfma_f32_16x16x32_bf16 v[124:127], v[248:251], a[248:251], v[124:127]
v_mfma_f32_16x16x32_bf16 v[120:123], v[252:255], a[244:247], v[120:123]
v_mfma_f32_16x16x32_bf16 v[124:127], v[252:255], a[252:255], v[124:127]
s_lshl_b32 s42, s20, 14
v_add_u32 v26, s42, v4
ds_write_b128 v26, v[64:67] offset:0
ds_write_b128 v26, v[68:71] offset:1024
ds_write_b128 v26, v[72:75] offset:2048
ds_write_b128 v26, v[76:79] offset:3072
ds_write_b128 v26, v[80:83] offset:4096
ds_write_b128 v26, v[84:87] offset:5120
ds_write_b128 v26, v[88:91] offset:6144
ds_write_b128 v26, v[92:95] offset:7168
ds_write_b128 v26, v[96:99] offset:8192
ds_write_b128 v26, v[100:103] offset:9216
ds_write_b128 v26, v[104:107] offset:10240
ds_write_b128 v26, v[108:111] offset:11264
ds_write_b128 v26, v[112:115] offset:12288
ds_write_b128 v26, v[116:119] offset:13312
ds_write_b128 v26, v[120:123] offset:14336
ds_write_b128 v26, v[124:127] offset:15360
s_waitcnt lgkmcnt(0)
s_barrier
s_lshl_b32 s42, s20, 12
v_add_u32 v26, s42, v4
ds_read_b128 v[128:131], v26 offset:0
ds_read_b128 v[132:135], v26 offset:16384
ds_read_b128 v[136:139], v26 offset:32768
ds_read_b128 v[140:143], v26 offset:49152
ds_read_b128 v[144:147], v26 offset:1024
ds_read_b128 v[148:151], v26 offset:17408
ds_read_b128 v[152:155], v26 offset:33792
ds_read_b128 v[156:159], v26 offset:50176
ds_read_b128 v[160:163], v26 offset:2048
ds_read_b128 v[164:167], v26 offset:18432
ds_read_b128 v[168:171], v26 offset:34816
ds_read_b128 v[172:175], v26 offset:51200
ds_read_b128 v[176:179], v26 offset:3072
ds_read_b128 v[180:183], v26 offset:19456
ds_read_b128 v[184:187], v26 offset:35840
ds_read_b128 v[188:191], v26 offset:52224
s_waitcnt lgkmcnt(0)
s_lshl_b32 s42, s19, 16
s_add_u32 s42, s42, 159383552
s_add_u32 s24, s16, s42
s_addc_u32 s25, s17, 0
s_lshl_b32 s42, s18, 14
s_lshl_b32 s43, s20, 12
s_add_u32 s42, s42, s43
v_add_u32 v26, s42, v4
v_pk_add_f32 v[128:129], v[128:129], v[132:133]
v_pk_add_f32 v[136:137], v[136:137], v[140:141]
v_pk_add_f32 v[130:131], v[130:131], v[134:135]
v_pk_add_f32 v[138:139], v[138:139], v[142:143]
v_pk_add_f32 v[128:129], v[128:129], v[136:137]
v_pk_add_f32 v[130:131], v[130:131], v[138:139]
global_store_dwordx4 v26, v[128:131], s[24:25] offset:0 sc1
v_pk_add_f32 v[144:145], v[144:145], v[148:149]
v_pk_add_f32 v[152:153], v[152:153], v[156:157]
v_pk_add_f32 v[146:147], v[146:147], v[150:151]
v_pk_add_f32 v[154:155], v[154:155], v[158:159]
v_pk_add_f32 v[144:145], v[144:145], v[152:153]
v_pk_add_f32 v[146:147], v[146:147], v[154:155]
global_store_dwordx4 v26, v[144:147], s[24:25] offset:1024 sc1
v_pk_add_f32 v[160:161], v[160:161], v[164:165]
v_pk_add_f32 v[168:169], v[168:169], v[172:173]
v_pk_add_f32 v[162:163], v[162:163], v[166:167]
v_pk_add_f32 v[170:171], v[170:171], v[174:175]
v_pk_add_f32 v[160:161], v[160:161], v[168:169]
v_pk_add_f32 v[162:163], v[162:163], v[170:171]
global_store_dwordx4 v26, v[160:163], s[24:25] offset:2048 sc1
v_pk_add_f32 v[176:177], v[176:177], v[180:181]
v_pk_add_f32 v[184:185], v[184:185], v[188:189]
v_pk_add_f32 v[178:179], v[178:179], v[182:183]
v_pk_add_f32 v[186:187], v[186:187], v[190:191]
v_pk_add_f32 v[176:177], v[176:177], v[184:185]
v_pk_add_f32 v[178:179], v[178:179], v[186:187]
global_store_dwordx4 v26, v[176:179], s[24:25] offset:3072 sc1
s_lshl_b32 s42, s18, 2
s_add_u32 s42, s42, s20
s_lshl_b32 s42, s42, 10
v_add_u32 v52, s42, v4
v_add_u32 v53, 16384, v52
v_add_u32 v54, 16384, v53
v_add_u32 v55, 16384, v54
s_sleep 4
s_mov_b32 s47, 0
M_poll_60:
global_load_dwordx4 v[64:67], v52, s[24:25] sc1
global_load_dwordx4 v[68:71], v53, s[24:25] sc1
global_load_dwordx4 v[72:75], v54, s[24:25] sc1
global_load_dwordx4 v[76:79], v55, s[24:25] sc1
s_waitcnt vmcnt(0)
v_max3_u32 v26, v64, v65, v66
v_max3_u32 v26, v26, v67, v68
v_max3_u32 v26, v26, v69, v70
v_max3_u32 v26, v26, v71, v72
v_max3_u32 v26, v26, v73, v74
v_max3_u32 v26, v26, v75, v76
v_max3_u32 v26, v26, v77, v78
v_max_u32 v26, v26, v79
v_cmp_eq_u32 vcc, -1, v26
s_cbranch_vccz M_polld_61
s_add_u32 s47, s47, 1
s_cmp_lt_u32 s47, 300000
s_cbranch_scc1 M_poll_60
s_branch M_exit0
M_polld_61:
v_pk_add_f32 v[64:65], v[64:65], v[68:69]
v_pk_add_f32 v[72:73], v[72:73], v[76:77]
v_pk_add_f32 v[66:67], v[66:67], v[70:71]
v_pk_add_f32 v[74:75], v[74:75], v[78:79]
v_pk_add_f32 v[64:65], v[64:65], v[72:73]
v_pk_add_f32 v[66:67], v[66:67], v[74:75]
v_cvt_pk_bf16_f32 v68, v64, v64
v_lshlrev_b32 v68, 16, v68
v_lshlrev_b32 v40, 16, v40
v_mul_f32 v68, v68, v40
v_cvt_pk_bf16_f32 v68, v68, v68
v_lshlrev_b32 v68, 16, v68
v_lshlrev_b32 v44, 16, v44
v_add_f32 v68, v68, v44
v_cvt_pk_bf16_f32 v69, v68, v68
v_cvt_pk_bf16_f32 v68, v65, v65
v_lshlrev_b32 v68, 16, v68
v_lshlrev_b32 v41, 16, v41
v_mul_f32 v68, v68, v41
v_cvt_pk_bf16_f32 v68, v68, v68
v_lshlrev_b32 v68, 16, v68
v_lshlrev_b32 v45, 16, v45
v_add_f32 v68, v68, v45
v_cvt_pk_bf16_f32 v70, v68, v68
v_cvt_pk_bf16_f32 v68, v66, v66
v_lshlrev_b32 v68, 16, v68
v_lshlrev_b32 v42, 16, v42
v_mul_f32 v68, v68, v42
v_cvt_pk_bf16_f32 v68, v68, v68
v_lshlrev_b32 v68, 16, v68
v_lshlrev_b32 v46, 16, v46
v_add_f32 v68, v68, v46
v_cvt_pk_bf16_f32 v71, v68, v68
v_cvt_pk_bf16_f32 v68, v67, v67
v_lshlrev_b32 v68, 16, v68
v_lshlrev_b32 v43, 16, v43
v_mul_f32 v68, v68, v43
v_cvt_pk_bf16_f32 v68, v68, v68
v_lshlrev_b32 v68, 16, v68
v_lshlrev_b32 v47, 16, v47
v_add_f32 v68, v68, v47
v_cvt_pk_bf16_f32 v72, v68, v68
global_store_short v48, v69, s[32:33] offset:0
global_store_short v48, v70, s[32:33] offset:2048
global_store_short v49, v71, s[32:33] offset:0
global_store_short v49, v72, s[32:33] offset:2048
s_waitcnt vmcnt(0)
s_barrier
s_endpgm
M_join:
s_add_u32 s18, s18, 4
s_mov_b32 s99, 1
s_mov_b32 s98, 0
s_branch M_worker2
M_exit0:
s_load_dwordx2 s[4:5], s[0:1], 104
s_waitcnt lgkmcnt(0)
v_mov_b32 v2, 36
v_mov_b32 v3, 1
s_mov_b64 exec, 1
global_atomic_add v2, v3, s[4:5]
M_end0:
s_endpgm
M_worker:
s_mov_b32 s99, 0
M_worker2:
s_load_dwordx2 s[40:41], s[0:1], 112
s_load_dwordx2 s[42:43], s[0:1], 16
s_load_dwordx2 s[44:45], s[0:1], 24
s_load_dwordx2 s[46:47], s[0:1], 32
s_load_dwordx2 s[48:49], s[0:1], 64
s_load_dwordx2 s[50:51], s[0:1], 72
s_load_dwordx2 s[52:53], s[0:1], 80
s_load_dwordx2 s[54:55], s[0:1], 88
s_load_dwordx2 s[56:57], s[0:1], 104
s_load_dwordx2 s[70:71], s[0:1], 40
s_load_dwordx2 s[72:73], s[0:1], 0
s_load_dwordx2 s[74:75], s[0:1], 96
s_waitcnt lgkmcnt(0)
s_sub_u32 s58, s18, 4
s_mov_b32 s59, 500
s_mov_b32 s96, 0
s_mov_b32 s97, 0
s_mov_b32 s93, 0
s_mov_b32 s92, 0
s_getpc_b64 s[68:69]
M_pc:
s_add_u32 s68, s68, M_tab-M_pc
s_addc_u32 s69, s69, 0
v_and_b32 v1, 63, v0
v_lshrrev_b32 v42, 6, v0
s_nop 0
v_readfirstlane_b32 s20, v42
s_lshl_b32 s25, s20, 12
s_add_u32 s26, s25, 16384
s_cmp_eq_u32 s99, 1
s_cbranch_scc1 W_first
s_lshl_b32 s76, s58, 5
s_add_u32 s76, s76, s19
s_lshr_b32 s61, s76, 6
s_lshl_b32 s64, s76, 2
s_add_u32 s66, s64, s20
s_load_dwordx2 s[4:5], s[0:1], 0
s_waitcnt lgkmcnt(0)
v_and_b32 v1, 63, v0
v_lshlrev_b32 v4, 4, v1
s_lshl_b32 s32, s66, 11
v_add_u32 v2, s32, v4
v_lshrrev_b32 v5, 2, v1
v_lshlrev_b32 v5, 17, v5
v_and_b32 v6, 3, v1
v_add_u32 v60, 0, v2
global_load_dwordx4 v[64:67], v60, s[4:5]
global_load_dwordx4 v[68:71], v60, s[4:5] offset:1024
s_add_u32 s32, s66, 0
s_bfe_u32 s33, s32, 0x20002
s_lshr_b32 s34, s33, 1
s_xor_b32 s33, s33, s34
s_and_b32 s33, s33, 1
s_lshl_b32 s33, s33, 1
s_add_u32 s33, s33, s34
v_xor_b32 v7, s33, v6
v_lshl_add_u32 v7, v7, 4, v5
s_lshl_b32 s32, s32, 6
s_add_u32 s32, s32, 0
v_add_u32 v7, s32, v7
s_waitcnt vmcnt(0)
v_lshlrev_b32 v24, 16, v64
v_and_b32 v25, 0xffff0000, v64
v_lshlrev_b32 v26, 16, v65
v_and_b32 v27, 0xffff0000, v65
v_lshlrev_b32 v28, 16, v66
v_and_b32 v29, 0xffff0000, v66
v_lshlrev_b32 v30, 16, v67
v_and_b32 v31, 0xffff0000, v67
v_lshlrev_b32 v32, 16, v68
v_and_b32 v33, 0xffff0000, v68
v_lshlrev_b32 v34, 16, v69
v_and_b32 v35, 0xffff0000, v69
v_lshlrev_b32 v36, 16, v70
v_and_b32 v37, 0xffff0000, v70
v_lshlrev_b32 v38, 16, v71
v_and_b32 v39, 0xffff0000, v71
v_add_f32 v40, v24, v25
v_add_f32 v40, v40, v26
v_add_f32 v40, v40, v27
v_add_f32 v40, v40, v28
v_add_f32 v40, v40, v29
v_add_f32 v40, v40, v30
v_add_f32 v40, v40, v31
v_add_f32 v40, v40, v32
v_add_f32 v40, v40, v33
v_add_f32 v40, v40, v34
v_add_f32 v40, v40, v35
v_add_f32 v40, v40, v36
v_add_f32 v40, v40, v37
v_add_f32 v40, v40, v38
v_add_f32 v40, v40, v39
s_nop 1
v_add_f32_dpp v40, v40, v40 row_ror:1 row_mask:0xf bank_mask:0xf
s_nop 1
v_add_f32_dpp v40, v40, v40 row_ror:2 row_mask:0xf bank_mask:0xf
s_nop 1
v_add_f32_dpp v40, v40, v40 row_ror:4 row_mask:0xf bank_mask:0xf
s_nop 1
v_add_f32_dpp v40, v40, v40 row_ror:8 row_mask:0xf bank_mask:0xf
v_mov_b32 v41, v40
s_nop 1
v_permlane16_swap_b32 v40, v41
v_add_f32 v40, v40, v41
v_mov_b32 v41, v40
s_nop 1
v_permlane32_swap_b32 v40, v41
v_add_f32 v40, v40, v41
v_mul_f32 v40, 0x3a800000, v40
v_sub_f32 v42, v24, v40
v_mul_f32 v41, v42, v42
v_sub_f32 v42, v25, v40
v_fmac_f32 v41, v42, v42
v_sub_f32 v42, v26, v40
v_fmac_f32 v41, v42, v42
v_sub_f32 v42, v27, v40
v_fmac_f32 v41, v42, v42
v_sub_f32 v42, v28, v40
v_fmac_f32 v41, v42, v42
v_sub_f32 v42, v29, v40
v_fmac_f32 v41, v42, v42
v_sub_f32 v42, v30, v40
v_fmac_f32 v41, v42, v42
v_sub_f32 v42, v31, v40
v_fmac_f32 v41, v42, v42
v_sub_f32 v42, v32, v40
v_fmac_f32 v41, v42, v42
v_sub_f32 v42, v33, v40
v_fmac_f32 v41, v42, v42
v_sub_f32 v42, v34, v40
v_fmac_f32 v41, v42, v42
v_sub_f32 v42, v35, v40
v_fmac_f32 v41, v42, v42
v_sub_f32 v42, v36, v40
v_fmac_f32 v41, v42, v42
v_sub_f32 v42, v37, v40
v_fmac_f32 v41, v42, v42
v_sub_f32 v42, v38, v40
v_fmac_f32 v41, v42, v42
v_sub_f32 v42, v39, v40
v_fmac_f32 v41, v42, v42
s_nop 1
v_add_f32_dpp v41, v41, v41 row_ror:1 row_mask:0xf bank_mask:0xf
s_nop 1
v_add_f32_dpp v41, v41, v41 row_ror:2 row_mask:0xf bank_mask:0xf
s_nop 1
v_add_f32_dpp v41, v41, v41 row_ror:4 row_mask:0xf bank_mask:0xf
s_nop 1
v_add_f32_dpp v41, v41, v41 row_ror:8 row_mask:0xf bank_mask:0xf
v_mov_b32 v42, v41
s_nop 1
v_permlane16_swap_b32 v41, v42
v_add_f32 v41, v41, v42
v_mov_b32 v42, v41
s_nop 1
v_permlane32_swap_b32 v41, v42
v_add_f32 v41, v41, v42
v_mul_f32 v41, 0x3a800000, v41
v_cvt_pk_bf16_f32 v42, v40, v40
v_lshlrev_b32 v40, 16, v42
v_cvt_pk_bf16_f32 v42, v41, v41
v_lshlrev_b32 v41, 16, v42
v_add_f32 v41, 0x3727c5ac, v41
v_cvt_pk_bf16_f32 v42, v41, v41
v_lshlrev_b32 v41, 16, v42
v_sqrt_f32 v41, v41
s_nop 0
v_cvt_pk_bf16_f32 v42, v41, v41
v_lshlrev_b32 v41, 16, v42
v_rcp_f32 v41, v41
v_sub_f32 v24, v24, v40
v_sub_f32 v25, v25, v40
v_cvt_pk_bf16_f32 v42, v24, v25
v_lshlrev_b32 v24, 16, v42
v_and_b32 v25, 0xffff0000, v42
v_mul_f32 v24, v24, v41
v_mul_f32 v25, v25, v41
v_cvt_pk_bf16_f32 v44, v24, v25
v_lshlrev_b32 v24, 16, v44
v_and_b32 v25, 0xffff0000, v44
v_sub_f32 v26, v26, v40
v_sub_f32 v27, v27, v40
v_cvt_pk_bf16_f32 v42, v26, v27
v_lshlrev_b32 v26, 16, v42
v_and_b32 v27, 0xffff0000, v42
v_mul_f32 v26, v26, v41
v_mul_f32 v27, v27, v41
v_cvt_pk_bf16_f32 v45, v26, v27
v_lshlrev_b32 v26, 16, v45
v_and_b32 v27, 0xffff0000, v45
v_sub_f32 v28, v28, v40
v_sub_f32 v29, v29, v40
v_cvt_pk_bf16_f32 v42, v28, v29
v_lshlrev_b32 v28, 16, v42
v_and_b32 v29, 0xffff0000, v42
v_mul_f32 v28, v28, v41
v_mul_f32 v29, v29, v41
v_cvt_pk_bf16_f32 v46, v28, v29
v_lshlrev_b32 v28, 16, v46
v_and_b32 v29, 0xffff0000, v46
v_sub_f32 v30, v30, v40
v_sub_f32 v31, v31, v40
v_cvt_pk_bf16_f32 v42, v30, v31
v_lshlrev_b32 v30, 16, v42
v_and_b32 v31, 0xffff0000, v42
v_mul_f32 v30, v30, v41
v_mul_f32 v31, v31, v41
v_cvt_pk_bf16_f32 v47, v30, v31
v_lshlrev_b32 v30, 16, v47
v_and_b32 v31, 0xffff0000, v47
v_sub_f32 v32, v32, v40
v_sub_f32 v33, v33, v40
v_cvt_pk_bf16_f32 v42, v32, v33
v_lshlrev_b32 v32, 16, v42
v_and_b32 v33, 0xffff0000, v42
v_mul_f32 v32, v32, v41
v_mul_f32 v33, v33, v41
v_cvt_pk_bf16_f32 v48, v32, v33
v_lshlrev_b32 v32, 16, v48
v_and_b32 v33, 0xffff0000, v48
v_sub_f32 v34, v34, v40
v_sub_f32 v35, v35, v40
v_cvt_pk_bf16_f32 v42, v34, v35
v_lshlrev_b32 v34, 16, v42
v_and_b32 v35, 0xffff0000, v42
v_mul_f32 v34, v34, v41
v_mul_f32 v35, v35, v41
v_cvt_pk_bf16_f32 v49, v34, v35
v_lshlrev_b32 v34, 16, v49
v_and_b32 v35, 0xffff0000, v49
v_sub_f32 v36, v36, v40
v_sub_f32 v37, v37, v40
v_cvt_pk_bf16_f32 v42, v36, v37
v_lshlrev_b32 v36, 16, v42
v_and_b32 v37, 0xffff0000, v42
v_mul_f32 v36, v36, v41
v_mul_f32 v37, v37, v41
v_cvt_pk_bf16_f32 v50, v36, v37
v_lshlrev_b32 v36, 16, v50
v_and_b32 v37, 0xffff0000, v50
v_sub_f32 v38, v38, v40
v_sub_f32 v39, v39, v40
v_cvt_pk_bf16_f32 v42, v38, v39
v_lshlrev_b32 v38, 16, v42
v_and_b32 v39, 0xffff0000, v42
v_mul_f32 v38, v38, v41
v_mul_f32 v39, v39, v41
v_cvt_pk_bf16_f32 v51, v38, v39
v_lshlrev_b32 v38, 16, v51
v_and_b32 v39, 0xffff0000, v51
global_store_dwordx4 v7, v[44:47], s[40:41] sc1
v_add_u32 v7, 0x200000, v7
global_store_dwordx4 v7, v[48:51], s[40:41] sc1
v_add_f32 v40, v24, v25
v_add_f32 v40, v40, v26
v_add_f32 v40, v40, v27
v_add_f32 v40, v40, v28
v_add_f32 v40, v40, v29
v_add_f32 v40, v40, v30
v_add_f32 v40, v40, v31
v_add_f32 v40, v40, v32
v_add_f32 v40, v40, v33
v_add_f32 v40, v40, v34
v_add_f32 v40, v40, v35
v_add_f32 v40, v40, v36
v_add_f32 v40, v40, v37
v_add_f32 v40, v40, v38
v_add_f32 v40, v40, v39
s_nop 1
v_add_f32_dpp v40, v40, v40 row_ror:1 row_mask:0xf bank_mask:0xf
s_nop 1
v_add_f32_dpp v40, v40, v40 row_ror:2 row_mask:0xf bank_mask:0xf
s_nop 1
v_add_f32_dpp v40, v40, v40 row_ror:4 row_mask:0xf bank_mask:0xf
s_nop 1
v_add_f32_dpp v40, v40, v40 row_ror:8 row_mask:0xf bank_mask:0xf
v_mov_b32 v41, v40
s_nop 1
v_permlane16_swap_b32 v40, v41
v_add_f32 v40, v40, v41
v_mov_b32 v41, v40
s_nop 1
v_permlane32_swap_b32 v40, v41
v_add_f32 v40, v40, v41
v_mul_f32 v40, 0x3a800000, v40
v_sub_f32 v42, v24, v40
v_mul_f32 v41, v42, v42
v_sub_f32 v42, v25, v40
v_fmac_f32 v41, v42, v42
v_sub_f32 v42, v26, v40
v_fmac_f32 v41, v42, v42
v_sub_f32 v42, v27, v40
v_fmac_f32 v41, v42, v42
v_sub_f32 v42, v28, v40
v_fmac_f32 v41, v42, v42
v_sub_f32 v42, v29, v40
v_fmac_f32 v41, v42, v42
v_sub_f32 v42, v30, v40
v_fmac_f32 v41, v42, v42
v_sub_f32 v42, v31, v40
v_fmac_f32 v41, v42, v42
v_sub_f32 v42, v32, v40
v_fmac_f32 v41, v42, v42
v_sub_f32 v42, v33, v40
v_fmac_f32 v41, v42, v42
v_sub_f32 v42, v34, v40
v_fmac_f32 v41, v42, v42
v_sub_f32 v42, v35, v40
v_fmac_f32 v41, v42, v42
v_sub_f32 v42, v36, v40
v_fmac_f32 v41, v42, v42
v_sub_f32 v42, v37, v40
v_fmac_f32 v41, v42, v42
v_sub_f32 v42, v38, v40
v_fmac_f32 v41, v42, v42
v_sub_f32 v42, v39, v40
v_fmac_f32 v41, v42, v42
s_nop 1
v_add_f32_dpp v41, v41, v41 row_ror:1 row_mask:0xf bank_mask:0xf
s_nop 1
v_add_f32_dpp v41, v41, v41 row_ror:2 row_mask:0xf bank_mask:0xf
s_nop 1
v_add_f32_dpp v41, v41, v41 row_ror:4 row_mask:0xf bank_mask:0xf
s_nop 1
v_add_f32_dpp v41, v41, v41 row_ror:8 row_mask:0xf bank_mask:0xf
v_mov_b32 v42, v41
s_nop 1
v_permlane16_swap_b32 v41, v42
v_add_f32 v41, v41, v42
v_mov_b32 v42, v41
s_nop 1
v_permlane32_swap_b32 v41, v42
v_add_f32 v41, v41, v42
v_mul_f32 v41, 0x3a800000, v41
v_cvt_pk_bf16_f32 v42, v40, v40
v_lshlrev_b32 v40, 16, v42
v_cvt_pk_bf16_f32 v42, v41, v41
v_lshlrev_b32 v41, 16, v42
v_add_f32 v41, 0x3727c5ac, v41
v_cvt_pk_bf16_f32 v42, v41, v41
v_lshlrev_b32 v41, 16, v42
v_sqrt_f32 v41, v41
s_nop 0
v_cvt_pk_bf16_f32 v42, v41, v41
v_lshlrev_b32 v41, 16, v42
v_rcp_f32 v41, v41
v_sub_f32 v24, v24, v40
v_sub_f32 v25, v25, v40
v_cvt_pk_bf16_f32 v42, v24, v25
v_lshlrev_b32 v24, 16, v42
v_and_b32 v25, 0xffff0000, v42
v_mul_f32 v24, v24, v41
v_mul_f32 v25, v25, v41
v_cvt_pk_bf16_f32 v52, v24, v25
v_lshlrev_b32 v24, 16, v52
v_and_b32 v25, 0xffff0000, v52
v_sub_f32 v26, v26, v40
v_sub_f32 v27, v27, v40
v_cvt_pk_bf16_f32 v42, v26, v27
v_lshlrev_b32 v26, 16, v42
v_and_b32 v27, 0xffff0000, v42
v_mul_f32 v26, v26, v41
v_mul_f32 v27, v27, v41
v_cvt_pk_bf16_f32 v53, v26, v27
v_lshlrev_b32 v26, 16, v53
v_and_b32 v27, 0xffff0000, v53
v_sub_f32 v28, v28, v40
v_sub_f32 v29, v29, v40
v_cvt_pk_bf16_f32 v42, v28, v29
v_lshlrev_b32 v28, 16, v42
v_and_b32 v29, 0xffff0000, v42
v_mul_f32 v28, v28, v41
v_mul_f32 v29, v29, v41
v_cvt_pk_bf16_f32 v54, v28, v29
v_lshlrev_b32 v28, 16, v54
v_and_b32 v29, 0xffff0000, v54
v_sub_f32 v30, v30, v40
v_sub_f32 v31, v31, v40
v_cvt_pk_bf16_f32 v42, v30, v31
v_lshlrev_b32 v30, 16, v42
v_and_b32 v31, 0xffff0000, v42
v_mul_f32 v30, v30, v41
v_mul_f32 v31, v31, v41
v_cvt_pk_bf16_f32 v55, v30, v31
v_lshlrev_b32 v30, 16, v55
v_and_b32 v31, 0xffff0000, v55
v_sub_f32 v32, v32, v40
v_sub_f32 v33, v33, v40
v_cvt_pk_bf16_f32 v42, v32, v33
v_lshlrev_b32 v32, 16, v42
v_and_b32 v33, 0xffff0000, v42
v_mul_f32 v32, v32, v41
v_mul_f32 v33, v33, v41
v_cvt_pk_bf16_f32 v56, v32, v33
v_lshlrev_b32 v32, 16, v56
v_and_b32 v33, 0xffff0000, v56
v_sub_f32 v34, v34, v40
v_sub_f32 v35, v35, v40
v_cvt_pk_bf16_f32 v42, v34, v35
v_lshlrev_b32 v34, 16, v42
v_and_b32 v35, 0xffff0000, v42
v_mul_f32 v34, v34, v41
v_mul_f32 v35, v35, v41
v_cvt_pk_bf16_f32 v57, v34, v35
v_lshlrev_b32 v34, 16, v57
v_and_b32 v35, 0xffff0000, v57
v_sub_f32 v36, v36, v40
v_sub_f32 v37, v37, v40
v_cvt_pk_bf16_f32 v42, v36, v37
v_lshlrev_b32 v36, 16, v42
v_and_b32 v37, 0xffff0000, v42
v_mul_f32 v36, v36, v41
v_mul_f32 v37, v37, v41
v_cvt_pk_bf16_f32 v58, v36, v37
v_lshlrev_b32 v36, 16, v58
v_and_b32 v37, 0xffff0000, v58
v_sub_f32 v38, v38, v40
v_sub_f32 v39, v39, v40
v_cvt_pk_bf16_f32 v42, v38, v39
v_lshlrev_b32 v38, 16, v42
v_and_b32 v39, 0xffff0000, v42
v_mul_f32 v38, v38, v41
v_mul_f32 v39, v39, v41
v_cvt_pk_bf16_f32 v59, v38, v39
v_lshlrev_b32 v38, 16, v59
v_and_b32 v39, 0xffff0000, v59
v_add_u32 v3, 4194304, v60
global_store_dwordx4 v3, v[52:55], s[40:41] sc1
global_store_dwordx4 v3, v[56:59], s[40:41] offset:1024 sc1
s_waitcnt vmcnt(0)
s_barrier
s_cmp_lg_u32 s20, 0
s_cbranch_scc1 M_sg_62
s_lshl_b32 s64, s61, 2
s_add_u32 s64, s64, 144
v_mov_b32 v42, s64
v_mov_b32 v43, 1
s_mov_b64 exec, 1
global_atomic_add v42, v43, s[56:57]
s_mov_b64 exec, -1
M_sg_62:
s_mov_b32 s98, 1
v_and_b32 v1, 63, v0
v_lshrrev_b32 v42, 6, v0
s_nop 0
v_readfirstlane_b32 s20, v42
s_lshl_b32 s25, s20, 12
s_add_u32 s26, s25, 16384
s_mov_b32 s59, s19
s_branch W_have
W_loop:
s_cmp_lg_u32 s98, 1
s_cbranch_scc1 W_first
s_mov_b32 s98, 0
v_and_b32 v1, 63, v0
v_lshrrev_b32 v42, 6, v0
s_nop 0
v_readfirstlane_b32 s20, v42
s_lshl_b32 s25, s20, 12
s_add_u32 s26, s25, 16384
s_lshl_b32 s64, s76, 2
s_add_u32 s66, s64, s20
s_add_u32 s66, s66, 512
s_mov_b64 s[4:5], s[72:73]
v_and_b32 v1, 63, v0
v_lshlrev_b32 v4, 4, v1
s_lshl_b32 s32, s66, 11
v_add_u32 v2, s32, v4
v_lshrrev_b32 v5, 2, v1
v_lshlrev_b32 v5, 17, v5
v_and_b32 v6, 3, v1
v_add_u32 v60, 0, v2
v_add_u32 v61, 1048576, v2
v_add_u32 v62, 2097152, v2
global_load_dwordx4 v[64:67], v60, s[4:5]
global_load_dwordx4 v[68:71], v60, s[4:5] offset:1024
global_load_dwordx4 v[72:75], v61, s[4:5]
global_load_dwordx4 v[76:79], v61, s[4:5] offset:1024
global_load_dwordx4 v[80:83], v62, s[4:5]
global_load_dwordx4 v[84:87], v62, s[4:5] offset:1024
s_add_u32 s32, s66, 0
s_bfe_u32 s33, s32, 0x20002
s_lshr_b32 s34, s33, 1
s_xor_b32 s33, s33, s34
s_and_b32 s33, s33, 1
s_lshl_b32 s33, s33, 1
s_add_u32 s33, s33, s34
v_xor_b32 v7, s33, v6
v_lshl_add_u32 v7, v7, 4, v5
s_lshl_b32 s32, s32, 6
s_add_u32 s32, s32, 0
v_add_u32 v7, s32, v7
s_waitcnt vmcnt(4)
v_lshlrev_b32 v24, 16, v64
v_and_b32 v25, 0xffff0000, v64
v_lshlrev_b32 v26, 16, v65
v_and_b32 v27, 0xffff0000, v65
v_lshlrev_b32 v28, 16, v66
v_and_b32 v29, 0xffff0000, v66
v_lshlrev_b32 v30, 16, v67
v_and_b32 v31, 0xffff0000, v67
v_lshlrev_b32 v32, 16, v68
v_and_b32 v33, 0xffff0000, v68
v_lshlrev_b32 v34, 16, v69
v_and_b32 v35, 0xffff0000, v69
v_lshlrev_b32 v36, 16, v70
v_and_b32 v37, 0xffff0000, v70
v_lshlrev_b32 v38, 16, v71
v_and_b32 v39, 0xffff0000, v71
v_add_f32 v40, v24, v25
v_add_f32 v40, v40, v26
v_add_f32 v40, v40, v27
v_add_f32 v40, v40, v28
v_add_f32 v40, v40, v29
v_add_f32 v40, v40, v30
v_add_f32 v40, v40, v31
v_add_f32 v40, v40, v32
v_add_f32 v40, v40, v33
v_add_f32 v40, v40, v34
v_add_f32 v40, v40, v35
v_add_f32 v40, v40, v36
v_add_f32 v40, v40, v37
v_add_f32 v40, v40, v38
v_add_f32 v40, v40, v39
s_nop 1
v_add_f32_dpp v40, v40, v40 row_ror:1 row_mask:0xf bank_mask:0xf
s_nop 1
v_add_f32_dpp v40, v40, v40 row_ror:2 row_mask:0xf bank_mask:0xf
s_nop 1
v_add_f32_dpp v40, v40, v40 row_ror:4 row_mask:0xf bank_mask:0xf
s_nop 1
v_add_f32_dpp v40, v40, v40 row_ror:8 row_mask:0xf bank_mask:0xf
v_mov_b32 v41, v40
s_nop 1
v_permlane16_swap_b32 v40, v41
v_add_f32 v40, v40, v41
v_mov_b32 v41, v40
s_nop 1
v_permlane32_swap_b32 v40, v41
v_add_f32 v40, v40, v41
v_mul_f32 v40, 0x3a800000, v40
v_sub_f32 v42, v24, v40
v_mul_f32 v41, v42, v42
v_sub_f32 v42, v25, v40
v_fmac_f32 v41, v42, v42
v_sub_f32 v42, v26, v40
v_fmac_f32 v41, v42, v42
v_sub_f32 v42, v27, v40
v_fmac_f32 v41, v42, v42
v_sub_f32 v42, v28, v40
v_fmac_f32 v41, v42, v42
v_sub_f32 v42, v29, v40
v_fmac_f32 v41, v42, v42
v_sub_f32 v42, v30, v40
v_fmac_f32 v41, v42, v42
v_sub_f32 v42, v31, v40
v_fmac_f32 v41, v42, v42
v_sub_f32 v42, v32, v40
v_fmac_f32 v41, v42, v42
v_sub_f32 v42, v33, v40
v_fmac_f32 v41, v42, v42
v_sub_f32 v42, v34, v40
v_fmac_f32 v41, v42, v42
v_sub_f32 v42, v35, v40
v_fmac_f32 v41, v42, v42
v_sub_f32 v42, v36, v40
v_fmac_f32 v41, v42, v42
v_sub_f32 v42, v37, v40
v_fmac_f32 v41, v42, v42
v_sub_f32 v42, v38, v40
v_fmac_f32 v41, v42, v42
v_sub_f32 v42, v39, v40
v_fmac_f32 v41, v42, v42
s_nop 1
v_add_f32_dpp v41, v41, v41 row_ror:1 row_mask:0xf bank_mask:0xf
s_nop 1
v_add_f32_dpp v41, v41, v41 row_ror:2 row_mask:0xf bank_mask:0xf
s_nop 1
v_add_f32_dpp v41, v41, v41 row_ror:4 row_mask:0xf bank_mask:0xf
s_nop 1
v_add_f32_dpp v41, v41, v41 row_ror:8 row_mask:0xf bank_mask:0xf
v_mov_b32 v42, v41
s_nop 1
v_permlane16_swap_b32 v41, v42
v_add_f32 v41, v41, v42
v_mov_b32 v42, v41
s_nop 1
v_permlane32_swap_b32 v41, v42
v_add_f32 v41, v41, v42
v_mul_f32 v41, 0x3a800000, v41
v_cvt_pk_bf16_f32 v42, v40, v40
v_lshlrev_b32 v40, 16, v42
v_cvt_pk_bf16_f32 v42, v41, v41
v_lshlrev_b32 v41, 16, v42
v_add_f32 v41, 0x3727c5ac, v41
v_cvt_pk_bf16_f32 v42, v41, v41
v_lshlrev_b32 v41, 16, v42
v_sqrt_f32 v41, v41
s_nop 0
v_cvt_pk_bf16_f32 v42, v41, v41
v_lshlrev_b32 v41, 16, v42
v_rcp_f32 v41, v41
v_sub_f32 v24, v24, v40
v_sub_f32 v25, v25, v40
v_cvt_pk_bf16_f32 v42, v24, v25
v_lshlrev_b32 v24, 16, v42
v_and_b32 v25, 0xffff0000, v42
v_mul_f32 v24, v24, v41
v_mul_f32 v25, v25, v41
v_cvt_pk_bf16_f32 v44, v24, v25
v_lshlrev_b32 v24, 16, v44
v_and_b32 v25, 0xffff0000, v44
v_sub_f32 v26, v26, v40
v_sub_f32 v27, v27, v40
v_cvt_pk_bf16_f32 v42, v26, v27
v_lshlrev_b32 v26, 16, v42
v_and_b32 v27, 0xffff0000, v42
v_mul_f32 v26, v26, v41
v_mul_f32 v27, v27, v41
v_cvt_pk_bf16_f32 v45, v26, v27
v_lshlrev_b32 v26, 16, v45
v_and_b32 v27, 0xffff0000, v45
v_sub_f32 v28, v28, v40
v_sub_f32 v29, v29, v40
v_cvt_pk_bf16_f32 v42, v28, v29
v_lshlrev_b32 v28, 16, v42
v_and_b32 v29, 0xffff0000, v42
v_mul_f32 v28, v28, v41
v_mul_f32 v29, v29, v41
v_cvt_pk_bf16_f32 v46, v28, v29
v_lshlrev_b32 v28, 16, v46
v_and_b32 v29, 0xffff0000, v46
v_sub_f32 v30, v30, v40
v_sub_f32 v31, v31, v40
v_cvt_pk_bf16_f32 v42, v30, v31
v_lshlrev_b32 v30, 16, v42
v_and_b32 v31, 0xffff0000, v42
v_mul_f32 v30, v30, v41
v_mul_f32 v31, v31, v41
v_cvt_pk_bf16_f32 v47, v30, v31
v_lshlrev_b32 v30, 16, v47
v_and_b32 v31, 0xffff0000, v47
v_sub_f32 v32, v32, v40
v_sub_f32 v33, v33, v40
v_cvt_pk_bf16_f32 v42, v32, v33
v_lshlrev_b32 v32, 16, v42
v_and_b32 v33, 0xffff0000, v42
v_mul_f32 v32, v32, v41
v_mul_f32 v33, v33, v41
v_cvt_pk_bf16_f32 v48, v32, v33
v_lshlrev_b32 v32, 16, v48
v_and_b32 v33, 0xffff0000, v48
v_sub_f32 v34, v34, v40
v_sub_f32 v35, v35, v40
v_cvt_pk_bf16_f32 v42, v34, v35
v_lshlrev_b32 v34, 16, v42
v_and_b32 v35, 0xffff0000, v42
v_mul_f32 v34, v34, v41
v_mul_f32 v35, v35, v41
v_cvt_pk_bf16_f32 v49, v34, v35
v_lshlrev_b32 v34, 16, v49
v_and_b32 v35, 0xffff0000, v49
v_sub_f32 v36, v36, v40
v_sub_f32 v37, v37, v40
v_cvt_pk_bf16_f32 v42, v36, v37
v_lshlrev_b32 v36, 16, v42
v_and_b32 v37, 0xffff0000, v42
v_mul_f32 v36, v36, v41
v_mul_f32 v37, v37, v41
v_cvt_pk_bf16_f32 v50, v36, v37
v_lshlrev_b32 v36, 16, v50
v_and_b32 v37, 0xffff0000, v50
v_sub_f32 v38, v38, v40
v_sub_f32 v39, v39, v40
v_cvt_pk_bf16_f32 v42, v38, v39
v_lshlrev_b32 v38, 16, v42
v_and_b32 v39, 0xffff0000, v42
v_mul_f32 v38, v38, v41
v_mul_f32 v39, v39, v41
v_cvt_pk_bf16_f32 v51, v38, v39
v_lshlrev_b32 v38, 16, v51
v_and_b32 v39, 0xffff0000, v51
global_store_dwordx4 v7, v[44:47], s[40:41] sc1
v_add_u32 v7, 0x200000, v7
global_store_dwordx4 v7, v[48:51], s[40:41] sc1
v_add_f32 v40, v24, v25
v_add_f32 v40, v40, v26
v_add_f32 v40, v40, v27
v_add_f32 v40, v40, v28
v_add_f32 v40, v40, v29
v_add_f32 v40, v40, v30
v_add_f32 v40, v40, v31
v_add_f32 v40, v40, v32
v_add_f32 v40, v40, v33
v_add_f32 v40, v40, v34
v_add_f32 v40, v40, v35
v_add_f32 v40, v40, v36
v_add_f32 v40, v40, v37
v_add_f32 v40, v40, v38
v_add_f32 v40, v40, v39
s_nop 1
v_add_f32_dpp v40, v40, v40 row_ror:1 row_mask:0xf bank_mask:0xf
s_nop 1
v_add_f32_dpp v40, v40, v40 row_ror:2 row_mask:0xf bank_mask:0xf
s_nop 1
v_add_f32_dpp v40, v40, v40 row_ror:4 row_mask:0xf bank_mask:0xf
s_nop 1
v_add_f32_dpp v40, v40, v40 row_ror:8 row_mask:0xf bank_mask:0xf
v_mov_b32 v41, v40
s_nop 1
v_permlane16_swap_b32 v40, v41
v_add_f32 v40, v40, v41
v_mov_b32 v41, v40
s_nop 1
v_permlane32_swap_b32 v40, v41
v_add_f32 v40, v40, v41
v_mul_f32 v40, 0x3a800000, v40
v_sub_f32 v42, v24, v40
v_mul_f32 v41, v42, v42
v_sub_f32 v42, v25, v40
v_fmac_f32 v41, v42, v42
v_sub_f32 v42, v26, v40
v_fmac_f32 v41, v42, v42
v_sub_f32 v42, v27, v40
v_fmac_f32 v41, v42, v42
v_sub_f32 v42, v28, v40
v_fmac_f32 v41, v42, v42
v_sub_f32 v42, v29, v40
v_fmac_f32 v41, v42, v42
v_sub_f32 v42, v30, v40
v_fmac_f32 v41, v42, v42
v_sub_f32 v42, v31, v40
v_fmac_f32 v41, v42, v42
v_sub_f32 v42, v32, v40
v_fmac_f32 v41, v42, v42
v_sub_f32 v42, v33, v40
v_fmac_f32 v41, v42, v42
v_sub_f32 v42, v34, v40
v_fmac_f32 v41, v42, v42
v_sub_f32 v42, v35, v40
v_fmac_f32 v41, v42, v42
v_sub_f32 v42, v36, v40
v_fmac_f32 v41, v42, v42
v_sub_f32 v42, v37, v40
v_fmac_f32 v41, v42, v42
v_sub_f32 v42, v38, v40
v_fmac_f32 v41, v42, v42
v_sub_f32 v42, v39, v40
v_fmac_f32 v41, v42, v42
s_nop 1
v_add_f32_dpp v41, v41, v41 row_ror:1 row_mask:0xf bank_mask:0xf
s_nop 1
v_add_f32_dpp v41, v41, v41 row_ror:2 row_mask:0xf bank_mask:0xf
s_nop 1
v_add_f32_dpp v41, v41, v41 row_ror:4 row_mask:0xf bank_mask:0xf
s_nop 1
v_add_f32_dpp v41, v41, v41 row_ror:8 row_mask:0xf bank_mask:0xf
v_mov_b32 v42, v41
s_nop 1
v_permlane16_swap_b32 v41, v42
v_add_f32 v41, v41, v42
v_mov_b32 v42, v41
s_nop 1
v_permlane32_swap_b32 v41, v42
v_add_f32 v41, v41, v42
v_mul_f32 v41, 0x3a800000, v41
v_cvt_pk_bf16_f32 v42, v40, v40
v_lshlrev_b32 v40, 16, v42
v_cvt_pk_bf16_f32 v42, v41, v41
v_lshlrev_b32 v41, 16, v42
v_add_f32 v41, 0x3727c5ac, v41
v_cvt_pk_bf16_f32 v42, v41, v41
v_lshlrev_b32 v41, 16, v42
v_sqrt_f32 v41, v41
s_nop 0
v_cvt_pk_bf16_f32 v42, v41, v41
v_lshlrev_b32 v41, 16, v42
v_rcp_f32 v41, v41
v_sub_f32 v24, v24, v40
v_sub_f32 v25, v25, v40
v_cvt_pk_bf16_f32 v42, v24, v25
v_lshlrev_b32 v24, 16, v42
v_and_b32 v25, 0xffff0000, v42
v_mul_f32 v24, v24, v41
v_mul_f32 v25, v25, v41
v_cvt_pk_bf16_f32 v52, v24, v25
v_lshlrev_b32 v24, 16, v52
v_and_b32 v25, 0xffff0000, v52
v_sub_f32 v26, v26, v40
v_sub_f32 v27, v27, v40
v_cvt_pk_bf16_f32 v42, v26, v27
v_lshlrev_b32 v26, 16, v42
v_and_b32 v27, 0xffff0000, v42
v_mul_f32 v26, v26, v41
v_mul_f32 v27, v27, v41
v_cvt_pk_bf16_f32 v53, v26, v27
v_lshlrev_b32 v26, 16, v53
v_and_b32 v27, 0xffff0000, v53
v_sub_f32 v28, v28, v40
v_sub_f32 v29, v29, v40
v_cvt_pk_bf16_f32 v42, v28, v29
v_lshlrev_b32 v28, 16, v42
v_and_b32 v29, 0xffff0000, v42
v_mul_f32 v28, v28, v41
v_mul_f32 v29, v29, v41
v_cvt_pk_bf16_f32 v54, v28, v29
v_lshlrev_b32 v28, 16, v54
v_and_b32 v29, 0xffff0000, v54
v_sub_f32 v30, v30, v40
v_sub_f32 v31, v31, v40
v_cvt_pk_bf16_f32 v42, v30, v31
v_lshlrev_b32 v30, 16, v42
v_and_b32 v31, 0xffff0000, v42
v_mul_f32 v30, v30, v41
v_mul_f32 v31, v31, v41
v_cvt_pk_bf16_f32 v55, v30, v31
v_lshlrev_b32 v30, 16, v55
v_and_b32 v31, 0xffff0000, v55
v_sub_f32 v32, v32, v40
v_sub_f32 v33, v33, v40
v_cvt_pk_bf16_f32 v42, v32, v33
v_lshlrev_b32 v32, 16, v42
v_and_b32 v33, 0xffff0000, v42
v_mul_f32 v32, v32, v41
v_mul_f32 v33, v33, v41
v_cvt_pk_bf16_f32 v56, v32, v33
v_lshlrev_b32 v32, 16, v56
v_and_b32 v33, 0xffff0000, v56
v_sub_f32 v34, v34, v40
v_sub_f32 v35, v35, v40
v_cvt_pk_bf16_f32 v42, v34, v35
v_lshlrev_b32 v34, 16, v42
v_and_b32 v35, 0xffff0000, v42
v_mul_f32 v34, v34, v41
v_mul_f32 v35, v35, v41
v_cvt_pk_bf16_f32 v57, v34, v35
v_lshlrev_b32 v34, 16, v57
v_and_b32 v35, 0xffff0000, v57
v_sub_f32 v36, v36, v40
v_sub_f32 v37, v37, v40
v_cvt_pk_bf16_f32 v42, v36, v37
v_lshlrev_b32 v36, 16, v42
v_and_b32 v37, 0xffff0000, v42
v_mul_f32 v36, v36, v41
v_mul_f32 v37, v37, v41
v_cvt_pk_bf16_f32 v58, v36, v37
v_lshlrev_b32 v36, 16, v58
v_and_b32 v37, 0xffff0000, v58
v_sub_f32 v38, v38, v40
v_sub_f32 v39, v39, v40
v_cvt_pk_bf16_f32 v42, v38, v39
v_lshlrev_b32 v38, 16, v42
v_and_b32 v39, 0xffff0000, v42
v_mul_f32 v38, v38, v41
v_mul_f32 v39, v39, v41
v_cvt_pk_bf16_f32 v59, v38, v39
v_lshlrev_b32 v38, 16, v59
v_and_b32 v39, 0xffff0000, v59
v_add_u32 v3, 4194304, v60
global_store_dwordx4 v3, v[52:55], s[40:41] sc1
global_store_dwordx4 v3, v[56:59], s[40:41] offset:1024 sc1
s_add_u32 s32, s66, 512
s_bfe_u32 s33, s32, 0x20002
s_lshr_b32 s34, s33, 1
s_xor_b32 s33, s33, s34
s_and_b32 s33, s33, 1
s_lshl_b32 s33, s33, 1
s_add_u32 s33, s33, s34
v_xor_b32 v7, s33, v6
v_lshl_add_u32 v7, v7, 4, v5
s_lshl_b32 s32, s32, 6
s_add_u32 s32, s32, 0
v_add_u32 v7, s32, v7
s_waitcnt vmcnt(6)
v_lshlrev_b32 v24, 16, v72
v_and_b32 v25, 0xffff0000, v72
v_lshlrev_b32 v26, 16, v73
v_and_b32 v27, 0xffff0000, v73
v_lshlrev_b32 v28, 16, v74
v_and_b32 v29, 0xffff0000, v74
v_lshlrev_b32 v30, 16, v75
v_and_b32 v31, 0xffff0000, v75
v_lshlrev_b32 v32, 16, v76
v_and_b32 v33, 0xffff0000, v76
v_lshlrev_b32 v34, 16, v77
v_and_b32 v35, 0xffff0000, v77
v_lshlrev_b32 v36, 16, v78
v_and_b32 v37, 0xffff0000, v78
v_lshlrev_b32 v38, 16, v79
v_and_b32 v39, 0xffff0000, v79
v_add_f32 v40, v24, v25
v_add_f32 v40, v40, v26
v_add_f32 v40, v40, v27
v_add_f32 v40, v40, v28
v_add_f32 v40, v40, v29
v_add_f32 v40, v40, v30
v_add_f32 v40, v40, v31
v_add_f32 v40, v40, v32
v_add_f32 v40, v40, v33
v_add_f32 v40, v40, v34
v_add_f32 v40, v40, v35
v_add_f32 v40, v40, v36
v_add_f32 v40, v40, v37
v_add_f32 v40, v40, v38
v_add_f32 v40, v40, v39
s_nop 1
v_add_f32_dpp v40, v40, v40 row_ror:1 row_mask:0xf bank_mask:0xf
s_nop 1
v_add_f32_dpp v40, v40, v40 row_ror:2 row_mask:0xf bank_mask:0xf
s_nop 1
v_add_f32_dpp v40, v40, v40 row_ror:4 row_mask:0xf bank_mask:0xf
s_nop 1
v_add_f32_dpp v40, v40, v40 row_ror:8 row_mask:0xf bank_mask:0xf
v_mov_b32 v41, v40
s_nop 1
v_permlane16_swap_b32 v40, v41
v_add_f32 v40, v40, v41
v_mov_b32 v41, v40
s_nop 1
v_permlane32_swap_b32 v40, v41
v_add_f32 v40, v40, v41
v_mul_f32 v40, 0x3a800000, v40
v_sub_f32 v42, v24, v40
v_mul_f32 v41, v42, v42
v_sub_f32 v42, v25, v40
v_fmac_f32 v41, v42, v42
v_sub_f32 v42, v26, v40
v_fmac_f32 v41, v42, v42
v_sub_f32 v42, v27, v40
v_fmac_f32 v41, v42, v42
v_sub_f32 v42, v28, v40
v_fmac_f32 v41, v42, v42
v_sub_f32 v42, v29, v40
v_fmac_f32 v41, v42, v42
v_sub_f32 v42, v30, v40
v_fmac_f32 v41, v42, v42
v_sub_f32 v42, v31, v40
v_fmac_f32 v41, v42, v42
v_sub_f32 v42, v32, v40
v_fmac_f32 v41, v42, v42
v_sub_f32 v42, v33, v40
v_fmac_f32 v41, v42, v42
v_sub_f32 v42, v34, v40
v_fmac_f32 v41, v42, v42
v_sub_f32 v42, v35, v40
v_fmac_f32 v41, v42, v42
v_sub_f32 v42, v36, v40
v_fmac_f32 v41, v42, v42
v_sub_f32 v42, v37, v40
v_fmac_f32 v41, v42, v42
v_sub_f32 v42, v38, v40
v_fmac_f32 v41, v42, v42
v_sub_f32 v42, v39, v40
v_fmac_f32 v41, v42, v42
s_nop 1
v_add_f32_dpp v41, v41, v41 row_ror:1 row_mask:0xf bank_mask:0xf
s_nop 1
v_add_f32_dpp v41, v41, v41 row_ror:2 row_mask:0xf bank_mask:0xf
s_nop 1
v_add_f32_dpp v41, v41, v41 row_ror:4 row_mask:0xf bank_mask:0xf
s_nop 1
v_add_f32_dpp v41, v41, v41 row_ror:8 row_mask:0xf bank_mask:0xf
v_mov_b32 v42, v41
s_nop 1
v_permlane16_swap_b32 v41, v42
v_add_f32 v41, v41, v42
v_mov_b32 v42, v41
s_nop 1
v_permlane32_swap_b32 v41, v42
v_add_f32 v41, v41, v42
v_mul_f32 v41, 0x3a800000, v41
v_cvt_pk_bf16_f32 v42, v40, v40
v_lshlrev_b32 v40, 16, v42
v_cvt_pk_bf16_f32 v42, v41, v41
v_lshlrev_b32 v41, 16, v42
v_add_f32 v41, 0x3727c5ac, v41
v_cvt_pk_bf16_f32 v42, v41, v41
v_lshlrev_b32 v41, 16, v42
v_sqrt_f32 v41, v41
s_nop 0
v_cvt_pk_bf16_f32 v42, v41, v41
v_lshlrev_b32 v41, 16, v42
v_rcp_f32 v41, v41
v_sub_f32 v24, v24, v40
v_sub_f32 v25, v25, v40
v_cvt_pk_bf16_f32 v42, v24, v25
v_lshlrev_b32 v24, 16, v42
v_and_b32 v25, 0xffff0000, v42
v_mul_f32 v24, v24, v41
v_mul_f32 v25, v25, v41
v_cvt_pk_bf16_f32 v44, v24, v25
v_lshlrev_b32 v24, 16, v44
v_and_b32 v25, 0xffff0000, v44
v_sub_f32 v26, v26, v40
v_sub_f32 v27, v27, v40
v_cvt_pk_bf16_f32 v42, v26, v27
v_lshlrev_b32 v26, 16, v42
v_and_b32 v27, 0xffff0000, v42
v_mul_f32 v26, v26, v41
v_mul_f32 v27, v27, v41
v_cvt_pk_bf16_f32 v45, v26, v27
v_lshlrev_b32 v26, 16, v45
v_and_b32 v27, 0xffff0000, v45
v_sub_f32 v28, v28, v40
v_sub_f32 v29, v29, v40
v_cvt_pk_bf16_f32 v42, v28, v29
v_lshlrev_b32 v28, 16, v42
v_and_b32 v29, 0xffff0000, v42
v_mul_f32 v28, v28, v41
v_mul_f32 v29, v29, v41
v_cvt_pk_bf16_f32 v46, v28, v29
v_lshlrev_b32 v28, 16, v46
v_and_b32 v29, 0xffff0000, v46
v_sub_f32 v30, v30, v40
v_sub_f32 v31, v31, v40
v_cvt_pk_bf16_f32 v42, v30, v31
v_lshlrev_b32 v30, 16, v42
v_and_b32 v31, 0xffff0000, v42
v_mul_f32 v30, v30, v41
v_mul_f32 v31, v31, v41
v_cvt_pk_bf16_f32 v47, v30, v31
v_lshlrev_b32 v30, 16, v47
v_and_b32 v31, 0xffff0000, v47
v_sub_f32 v32, v32, v40
v_sub_f32 v33, v33, v40
v_cvt_pk_bf16_f32 v42, v32, v33
v_lshlrev_b32 v32, 16, v42
v_and_b32 v33, 0xffff0000, v42
v_mul_f32 v32, v32, v41
v_mul_f32 v33, v33, v41
v_cvt_pk_bf16_f32 v48, v32, v33
v_lshlrev_b32 v32, 16, v48
v_and_b32 v33, 0xffff0000, v48
v_sub_f32 v34, v34, v40
v_sub_f32 v35, v35, v40
v_cvt_pk_bf16_f32 v42, v34, v35
v_lshlrev_b32 v34, 16, v42
v_and_b32 v35, 0xffff0000, v42
v_mul_f32 v34, v34, v41
v_mul_f32 v35, v35, v41
v_cvt_pk_bf16_f32 v49, v34, v35
v_lshlrev_b32 v34, 16, v49
v_and_b32 v35, 0xffff0000, v49
v_sub_f32 v36, v36, v40
v_sub_f32 v37, v37, v40
v_cvt_pk_bf16_f32 v42, v36, v37
v_lshlrev_b32 v36, 16, v42
v_and_b32 v37, 0xffff0000, v42
v_mul_f32 v36, v36, v41
v_mul_f32 v37, v37, v41
v_cvt_pk_bf16_f32 v50, v36, v37
v_lshlrev_b32 v36, 16, v50
v_and_b32 v37, 0xffff0000, v50
v_sub_f32 v38, v38, v40
v_sub_f32 v39, v39, v40
v_cvt_pk_bf16_f32 v42, v38, v39
v_lshlrev_b32 v38, 16, v42
v_and_b32 v39, 0xffff0000, v42
v_mul_f32 v38, v38, v41
v_mul_f32 v39, v39, v41
v_cvt_pk_bf16_f32 v51, v38, v39
v_lshlrev_b32 v38, 16, v51
v_and_b32 v39, 0xffff0000, v51
global_store_dwordx4 v7, v[44:47], s[40:41] sc1
v_add_u32 v7, 0x200000, v7
global_store_dwordx4 v7, v[48:51], s[40:41] sc1
v_add_f32 v40, v24, v25
v_add_f32 v40, v40, v26
v_add_f32 v40, v40, v27
v_add_f32 v40, v40, v28
v_add_f32 v40, v40, v29
v_add_f32 v40, v40, v30
v_add_f32 v40, v40, v31
v_add_f32 v40, v40, v32
v_add_f32 v40, v40, v33
v_add_f32 v40, v40, v34
v_add_f32 v40, v40, v35
v_add_f32 v40, v40, v36
v_add_f32 v40, v40, v37
v_add_f32 v40, v40, v38
v_add_f32 v40, v40, v39
s_nop 1
v_add_f32_dpp v40, v40, v40 row_ror:1 row_mask:0xf bank_mask:0xf
s_nop 1
v_add_f32_dpp v40, v40, v40 row_ror:2 row_mask:0xf bank_mask:0xf
s_nop 1
v_add_f32_dpp v40, v40, v40 row_ror:4 row_mask:0xf bank_mask:0xf
s_nop 1
v_add_f32_dpp v40, v40, v40 row_ror:8 row_mask:0xf bank_mask:0xf
v_mov_b32 v41, v40
s_nop 1
v_permlane16_swap_b32 v40, v41
v_add_f32 v40, v40, v41
v_mov_b32 v41, v40
s_nop 1
v_permlane32_swap_b32 v40, v41
v_add_f32 v40, v40, v41
v_mul_f32 v40, 0x3a800000, v40
v_sub_f32 v42, v24, v40
v_mul_f32 v41, v42, v42
v_sub_f32 v42, v25, v40
v_fmac_f32 v41, v42, v42
v_sub_f32 v42, v26, v40
v_fmac_f32 v41, v42, v42
v_sub_f32 v42, v27, v40
v_fmac_f32 v41, v42, v42
v_sub_f32 v42, v28, v40
v_fmac_f32 v41, v42, v42
v_sub_f32 v42, v29, v40
v_fmac_f32 v41, v42, v42
v_sub_f32 v42, v30, v40
v_fmac_f32 v41, v42, v42
v_sub_f32 v42, v31, v40
v_fmac_f32 v41, v42, v42
v_sub_f32 v42, v32, v40
v_fmac_f32 v41, v42, v42
v_sub_f32 v42, v33, v40
v_fmac_f32 v41, v42, v42
v_sub_f32 v42, v34, v40
v_fmac_f32 v41, v42, v42
v_sub_f32 v42, v35, v40
v_fmac_f32 v41, v42, v42
v_sub_f32 v42, v36, v40
v_fmac_f32 v41, v42, v42
v_sub_f32 v42, v37, v40
v_fmac_f32 v41, v42, v42
v_sub_f32 v42, v38, v40
v_fmac_f32 v41, v42, v42
v_sub_f32 v42, v39, v40
v_fmac_f32 v41, v42, v42
s_nop 1
v_add_f32_dpp v41, v41, v41 row_ror:1 row_mask:0xf bank_mask:0xf
s_nop 1
v_add_f32_dpp v41, v41, v41 row_ror:2 row_mask:0xf bank_mask:0xf
s_nop 1
v_add_f32_dpp v41, v41, v41 row_ror:4 row_mask:0xf bank_mask:0xf
s_nop 1
v_add_f32_dpp v41, v41, v41 row_ror:8 row_mask:0xf bank_mask:0xf
v_mov_b32 v42, v41
s_nop 1
v_permlane16_swap_b32 v41, v42
v_add_f32 v41, v41, v42
v_mov_b32 v42, v41
s_nop 1
v_permlane32_swap_b32 v41, v42
v_add_f32 v41, v41, v42
v_mul_f32 v41, 0x3a800000, v41
v_cvt_pk_bf16_f32 v42, v40, v40
v_lshlrev_b32 v40, 16, v42
v_cvt_pk_bf16_f32 v42, v41, v41
v_lshlrev_b32 v41, 16, v42
v_add_f32 v41, 0x3727c5ac, v41
v_cvt_pk_bf16_f32 v42, v41, v41
v_lshlrev_b32 v41, 16, v42
v_sqrt_f32 v41, v41
s_nop 0
v_cvt_pk_bf16_f32 v42, v41, v41
v_lshlrev_b32 v41, 16, v42
v_rcp_f32 v41, v41
v_sub_f32 v24, v24, v40
v_sub_f32 v25, v25, v40
v_cvt_pk_bf16_f32 v42, v24, v25
v_lshlrev_b32 v24, 16, v42
v_and_b32 v25, 0xffff0000, v42
v_mul_f32 v24, v24, v41
v_mul_f32 v25, v25, v41
v_cvt_pk_bf16_f32 v52, v24, v25
v_lshlrev_b32 v24, 16, v52
v_and_b32 v25, 0xffff0000, v52
v_sub_f32 v26, v26, v40
v_sub_f32 v27, v27, v40
v_cvt_pk_bf16_f32 v42, v26, v27
v_lshlrev_b32 v26, 16, v42
v_and_b32 v27, 0xffff0000, v42
v_mul_f32 v26, v26, v41
v_mul_f32 v27, v27, v41
v_cvt_pk_bf16_f32 v53, v26, v27
v_lshlrev_b32 v26, 16, v53
v_and_b32 v27, 0xffff0000, v53
v_sub_f32 v28, v28, v40
v_sub_f32 v29, v29, v40
v_cvt_pk_bf16_f32 v42, v28, v29
v_lshlrev_b32 v28, 16, v42
v_and_b32 v29, 0xffff0000, v42
v_mul_f32 v28, v28, v41
v_mul_f32 v29, v29, v41
v_cvt_pk_bf16_f32 v54, v28, v29
v_lshlrev_b32 v28, 16, v54
v_and_b32 v29, 0xffff0000, v54
v_sub_f32 v30, v30, v40
v_sub_f32 v31, v31, v40
v_cvt_pk_bf16_f32 v42, v30, v31
v_lshlrev_b32 v30, 16, v42
v_and_b32 v31, 0xffff0000, v42
v_mul_f32 v30, v30, v41
v_mul_f32 v31, v31, v41
v_cvt_pk_bf16_f32 v55, v30, v31
v_lshlrev_b32 v30, 16, v55
v_and_b32 v31, 0xffff0000, v55
v_sub_f32 v32, v32, v40
v_sub_f32 v33, v33, v40
v_cvt_pk_bf16_f32 v42, v32, v33
v_lshlrev_b32 v32, 16, v42
v_and_b32 v33, 0xffff0000, v42
v_mul_f32 v32, v32, v41
v_mul_f32 v33, v33, v41
v_cvt_pk_bf16_f32 v56, v32, v33
v_lshlrev_b32 v32, 16, v56
v_and_b32 v33, 0xffff0000, v56
v_sub_f32 v34, v34, v40
v_sub_f32 v35, v35, v40
v_cvt_pk_bf16_f32 v42, v34, v35
v_lshlrev_b32 v34, 16, v42
v_and_b32 v35, 0xffff0000, v42
v_mul_f32 v34, v34, v41
v_mul_f32 v35, v35, v41
v_cvt_pk_bf16_f32 v57, v34, v35
v_lshlrev_b32 v34, 16, v57
v_and_b32 v35, 0xffff0000, v57
v_sub_f32 v36, v36, v40
v_sub_f32 v37, v37, v40
v_cvt_pk_bf16_f32 v42, v36, v37
v_lshlrev_b32 v36, 16, v42
v_and_b32 v37, 0xffff0000, v42
v_mul_f32 v36, v36, v41
v_mul_f32 v37, v37, v41
v_cvt_pk_bf16_f32 v58, v36, v37
v_lshlrev_b32 v36, 16, v58
v_and_b32 v37, 0xffff0000, v58
v_sub_f32 v38, v38, v40
v_sub_f32 v39, v39, v40
v_cvt_pk_bf16_f32 v42, v38, v39
v_lshlrev_b32 v38, 16, v42
v_and_b32 v39, 0xffff0000, v42
v_mul_f32 v38, v38, v41
v_mul_f32 v39, v39, v41
v_cvt_pk_bf16_f32 v59, v38, v39
v_lshlrev_b32 v38, 16, v59
v_and_b32 v39, 0xffff0000, v59
v_add_u32 v3, 4194304, v61
global_store_dwordx4 v3, v[52:55], s[40:41] sc1
global_store_dwordx4 v3, v[56:59], s[40:41] offset:1024 sc1
s_add_u32 s32, s66, 1024
s_bfe_u32 s33, s32, 0x20002
s_lshr_b32 s34, s33, 1
s_xor_b32 s33, s33, s34
s_and_b32 s33, s33, 1
s_lshl_b32 s33, s33, 1
s_add_u32 s33, s33, s34
v_xor_b32 v7, s33, v6
v_lshl_add_u32 v7, v7, 4, v5
s_lshl_b32 s32, s32, 6
s_add_u32 s32, s32, 0
v_add_u32 v7, s32, v7
s_waitcnt vmcnt(8)
v_lshlrev_b32 v24, 16, v80
v_and_b32 v25, 0xffff0000, v80
v_lshlrev_b32 v26, 16, v81
v_and_b32 v27, 0xffff0000, v81
v_lshlrev_b32 v28, 16, v82
v_and_b32 v29, 0xffff0000, v82
v_lshlrev_b32 v30, 16, v83
v_and_b32 v31, 0xffff0000, v83
v_lshlrev_b32 v32, 16, v84
v_and_b32 v33, 0xffff0000, v84
v_lshlrev_b32 v34, 16, v85
v_and_b32 v35, 0xffff0000, v85
v_lshlrev_b32 v36, 16, v86
v_and_b32 v37, 0xffff0000, v86
v_lshlrev_b32 v38, 16, v87
v_and_b32 v39, 0xffff0000, v87
v_add_f32 v40, v24, v25
v_add_f32 v40, v40, v26
v_add_f32 v40, v40, v27
v_add_f32 v40, v40, v28
v_add_f32 v40, v40, v29
v_add_f32 v40, v40, v30
v_add_f32 v40, v40, v31
v_add_f32 v40, v40, v32
v_add_f32 v40, v40, v33
v_add_f32 v40, v40, v34
v_add_f32 v40, v40, v35
v_add_f32 v40, v40, v36
v_add_f32 v40, v40, v37
v_add_f32 v40, v40, v38
v_add_f32 v40, v40, v39
s_nop 1
v_add_f32_dpp v40, v40, v40 row_ror:1 row_mask:0xf bank_mask:0xf
s_nop 1
v_add_f32_dpp v40, v40, v40 row_ror:2 row_mask:0xf bank_mask:0xf
s_nop 1
v_add_f32_dpp v40, v40, v40 row_ror:4 row_mask:0xf bank_mask:0xf
s_nop 1
v_add_f32_dpp v40, v40, v40 row_ror:8 row_mask:0xf bank_mask:0xf
v_mov_b32 v41, v40
s_nop 1
v_permlane16_swap_b32 v40, v41
v_add_f32 v40, v40, v41
v_mov_b32 v41, v40
s_nop 1
v_permlane32_swap_b32 v40, v41
v_add_f32 v40, v40, v41
v_mul_f32 v40, 0x3a800000, v40
v_sub_f32 v42, v24, v40
v_mul_f32 v41, v42, v42
v_sub_f32 v42, v25, v40
v_fmac_f32 v41, v42, v42
v_sub_f32 v42, v26, v40
v_fmac_f32 v41, v42, v42
v_sub_f32 v42, v27, v40
v_fmac_f32 v41, v42, v42
v_sub_f32 v42, v28, v40
v_fmac_f32 v41, v42, v42
v_sub_f32 v42, v29, v40
v_fmac_f32 v41, v42, v42
v_sub_f32 v42, v30, v40
v_fmac_f32 v41, v42, v42
v_sub_f32 v42, v31, v40
v_fmac_f32 v41, v42, v42
v_sub_f32 v42, v32, v40
v_fmac_f32 v41, v42, v42
v_sub_f32 v42, v33, v40
v_fmac_f32 v41, v42, v42
v_sub_f32 v42, v34, v40
v_fmac_f32 v41, v42, v42
v_sub_f32 v42, v35, v40
v_fmac_f32 v41, v42, v42
v_sub_f32 v42, v36, v40
v_fmac_f32 v41, v42, v42
v_sub_f32 v42, v37, v40
v_fmac_f32 v41, v42, v42
v_sub_f32 v42, v38, v40
v_fmac_f32 v41, v42, v42
v_sub_f32 v42, v39, v40
v_fmac_f32 v41, v42, v42
s_nop 1
v_add_f32_dpp v41, v41, v41 row_ror:1 row_mask:0xf bank_mask:0xf
s_nop 1
v_add_f32_dpp v41, v41, v41 row_ror:2 row_mask:0xf bank_mask:0xf
s_nop 1
v_add_f32_dpp v41, v41, v41 row_ror:4 row_mask:0xf bank_mask:0xf
s_nop 1
v_add_f32_dpp v41, v41, v41 row_ror:8 row_mask:0xf bank_mask:0xf
v_mov_b32 v42, v41
s_nop 1
v_permlane16_swap_b32 v41, v42
v_add_f32 v41, v41, v42
v_mov_b32 v42, v41
s_nop 1
v_permlane32_swap_b32 v41, v42
v_add_f32 v41, v41, v42
v_mul_f32 v41, 0x3a800000, v41
v_cvt_pk_bf16_f32 v42, v40, v40
v_lshlrev_b32 v40, 16, v42
v_cvt_pk_bf16_f32 v42, v41, v41
v_lshlrev_b32 v41, 16, v42
v_add_f32 v41, 0x3727c5ac, v41
v_cvt_pk_bf16_f32 v42, v41, v41
v_lshlrev_b32 v41, 16, v42
v_sqrt_f32 v41, v41
s_nop 0
v_cvt_pk_bf16_f32 v42, v41, v41
v_lshlrev_b32 v41, 16, v42
v_rcp_f32 v41, v41
v_sub_f32 v24, v24, v40
v_sub_f32 v25, v25, v40
v_cvt_pk_bf16_f32 v42, v24, v25
v_lshlrev_b32 v24, 16, v42
v_and_b32 v25, 0xffff0000, v42
v_mul_f32 v24, v24, v41
v_mul_f32 v25, v25, v41
v_cvt_pk_bf16_f32 v44, v24, v25
v_lshlrev_b32 v24, 16, v44
v_and_b32 v25, 0xffff0000, v44
v_sub_f32 v26, v26, v40
v_sub_f32 v27, v27, v40
v_cvt_pk_bf16_f32 v42, v26, v27
v_lshlrev_b32 v26, 16, v42
v_and_b32 v27, 0xffff0000, v42
v_mul_f32 v26, v26, v41
v_mul_f32 v27, v27, v41
v_cvt_pk_bf16_f32 v45, v26, v27
v_lshlrev_b32 v26, 16, v45
v_and_b32 v27, 0xffff0000, v45
v_sub_f32 v28, v28, v40
v_sub_f32 v29, v29, v40
v_cvt_pk_bf16_f32 v42, v28, v29
v_lshlrev_b32 v28, 16, v42
v_and_b32 v29, 0xffff0000, v42
v_mul_f32 v28, v28, v41
v_mul_f32 v29, v29, v41
v_cvt_pk_bf16_f32 v46, v28, v29
v_lshlrev_b32 v28, 16, v46
v_and_b32 v29, 0xffff0000, v46
v_sub_f32 v30, v30, v40
v_sub_f32 v31, v31, v40
v_cvt_pk_bf16_f32 v42, v30, v31
v_lshlrev_b32 v30, 16, v42
v_and_b32 v31, 0xffff0000, v42
v_mul_f32 v30, v30, v41
v_mul_f32 v31, v31, v41
v_cvt_pk_bf16_f32 v47, v30, v31
v_lshlrev_b32 v30, 16, v47
v_and_b32 v31, 0xffff0000, v47
v_sub_f32 v32, v32, v40
v_sub_f32 v33, v33, v40
v_cvt_pk_bf16_f32 v42, v32, v33
v_lshlrev_b32 v32, 16, v42
v_and_b32 v33, 0xffff0000, v42
v_mul_f32 v32, v32, v41
v_mul_f32 v33, v33, v41
v_cvt_pk_bf16_f32 v48, v32, v33
v_lshlrev_b32 v32, 16, v48
v_and_b32 v33, 0xffff0000, v48
v_sub_f32 v34, v34, v40
v_sub_f32 v35, v35, v40
v_cvt_pk_bf16_f32 v42, v34, v35
v_lshlrev_b32 v34, 16, v42
v_and_b32 v35, 0xffff0000, v42
v_mul_f32 v34, v34, v41
v_mul_f32 v35, v35, v41
v_cvt_pk_bf16_f32 v49, v34, v35
v_lshlrev_b32 v34, 16, v49
v_and_b32 v35, 0xffff0000, v49
v_sub_f32 v36, v36, v40
v_sub_f32 v37, v37, v40
v_cvt_pk_bf16_f32 v42, v36, v37
v_lshlrev_b32 v36, 16, v42
v_and_b32 v37, 0xffff0000, v42
v_mul_f32 v36, v36, v41
v_mul_f32 v37, v37, v41
v_cvt_pk_bf16_f32 v50, v36, v37
v_lshlrev_b32 v36, 16, v50
v_and_b32 v37, 0xffff0000, v50
v_sub_f32 v38, v38, v40
v_sub_f32 v39, v39, v40
v_cvt_pk_bf16_f32 v42, v38, v39
v_lshlrev_b32 v38, 16, v42
v_and_b32 v39, 0xffff0000, v42
v_mul_f32 v38, v38, v41
v_mul_f32 v39, v39, v41
v_cvt_pk_bf16_f32 v51, v38, v39
v_lshlrev_b32 v38, 16, v51
v_and_b32 v39, 0xffff0000, v51
global_store_dwordx4 v7, v[44:47], s[40:41] sc1
v_add_u32 v7, 0x200000, v7
global_store_dwordx4 v7, v[48:51], s[40:41] sc1
v_add_f32 v40, v24, v25
v_add_f32 v40, v40, v26
v_add_f32 v40, v40, v27
v_add_f32 v40, v40, v28
v_add_f32 v40, v40, v29
v_add_f32 v40, v40, v30
v_add_f32 v40, v40, v31
v_add_f32 v40, v40, v32
v_add_f32 v40, v40, v33
v_add_f32 v40, v40, v34
v_add_f32 v40, v40, v35
v_add_f32 v40, v40, v36
v_add_f32 v40, v40, v37
v_add_f32 v40, v40, v38
v_add_f32 v40, v40, v39
s_nop 1
v_add_f32_dpp v40, v40, v40 row_ror:1 row_mask:0xf bank_mask:0xf
s_nop 1
v_add_f32_dpp v40, v40, v40 row_ror:2 row_mask:0xf bank_mask:0xf
s_nop 1
v_add_f32_dpp v40, v40, v40 row_ror:4 row_mask:0xf bank_mask:0xf
s_nop 1
v_add_f32_dpp v40, v40, v40 row_ror:8 row_mask:0xf bank_mask:0xf
v_mov_b32 v41, v40
s_nop 1
v_permlane16_swap_b32 v40, v41
v_add_f32 v40, v40, v41
v_mov_b32 v41, v40
s_nop 1
v_permlane32_swap_b32 v40, v41
v_add_f32 v40, v40, v41
v_mul_f32 v40, 0x3a800000, v40
v_sub_f32 v42, v24, v40
v_mul_f32 v41, v42, v42
v_sub_f32 v42, v25, v40
v_fmac_f32 v41, v42, v42
v_sub_f32 v42, v26, v40
v_fmac_f32 v41, v42, v42
v_sub_f32 v42, v27, v40
v_fmac_f32 v41, v42, v42
v_sub_f32 v42, v28, v40
v_fmac_f32 v41, v42, v42
v_sub_f32 v42, v29, v40
v_fmac_f32 v41, v42, v42
v_sub_f32 v42, v30, v40
v_fmac_f32 v41, v42, v42
v_sub_f32 v42, v31, v40
v_fmac_f32 v41, v42, v42
v_sub_f32 v42, v32, v40
v_fmac_f32 v41, v42, v42
v_sub_f32 v42, v33, v40
v_fmac_f32 v41, v42, v42
v_sub_f32 v42, v34, v40
v_fmac_f32 v41, v42, v42
v_sub_f32 v42, v35, v40
v_fmac_f32 v41, v42, v42
v_sub_f32 v42, v36, v40
v_fmac_f32 v41, v42, v42
v_sub_f32 v42, v37, v40
v_fmac_f32 v41, v42, v42
v_sub_f32 v42, v38, v40
v_fmac_f32 v41, v42, v42
v_sub_f32 v42, v39, v40
v_fmac_f32 v41, v42, v42
s_nop 1
v_add_f32_dpp v41, v41, v41 row_ror:1 row_mask:0xf bank_mask:0xf
s_nop 1
v_add_f32_dpp v41, v41, v41 row_ror:2 row_mask:0xf bank_mask:0xf
s_nop 1
v_add_f32_dpp v41, v41, v41 row_ror:4 row_mask:0xf bank_mask:0xf
s_nop 1
v_add_f32_dpp v41, v41, v41 row_ror:8 row_mask:0xf bank_mask:0xf
v_mov_b32 v42, v41
s_nop 1
v_permlane16_swap_b32 v41, v42
v_add_f32 v41, v41, v42
v_mov_b32 v42, v41
s_nop 1
v_permlane32_swap_b32 v41, v42
v_add_f32 v41, v41, v42
v_mul_f32 v41, 0x3a800000, v41
v_cvt_pk_bf16_f32 v42, v40, v40
v_lshlrev_b32 v40, 16, v42
v_cvt_pk_bf16_f32 v42, v41, v41
v_lshlrev_b32 v41, 16, v42
v_add_f32 v41, 0x3727c5ac, v41
v_cvt_pk_bf16_f32 v42, v41, v41
v_lshlrev_b32 v41, 16, v42
v_sqrt_f32 v41, v41
s_nop 0
v_cvt_pk_bf16_f32 v42, v41, v41
v_lshlrev_b32 v41, 16, v42
v_rcp_f32 v41, v41
v_sub_f32 v24, v24, v40
v_sub_f32 v25, v25, v40
v_cvt_pk_bf16_f32 v42, v24, v25
v_lshlrev_b32 v24, 16, v42
v_and_b32 v25, 0xffff0000, v42
v_mul_f32 v24, v24, v41
v_mul_f32 v25, v25, v41
v_cvt_pk_bf16_f32 v52, v24, v25
v_lshlrev_b32 v24, 16, v52
v_and_b32 v25, 0xffff0000, v52
v_sub_f32 v26, v26, v40
v_sub_f32 v27, v27, v40
v_cvt_pk_bf16_f32 v42, v26, v27
v_lshlrev_b32 v26, 16, v42
v_and_b32 v27, 0xffff0000, v42
v_mul_f32 v26, v26, v41
v_mul_f32 v27, v27, v41
v_cvt_pk_bf16_f32 v53, v26, v27
v_lshlrev_b32 v26, 16, v53
v_and_b32 v27, 0xffff0000, v53
v_sub_f32 v28, v28, v40
v_sub_f32 v29, v29, v40
v_cvt_pk_bf16_f32 v42, v28, v29
v_lshlrev_b32 v28, 16, v42
v_and_b32 v29, 0xffff0000, v42
v_mul_f32 v28, v28, v41
v_mul_f32 v29, v29, v41
v_cvt_pk_bf16_f32 v54, v28, v29
v_lshlrev_b32 v28, 16, v54
v_and_b32 v29, 0xffff0000, v54
v_sub_f32 v30, v30, v40
v_sub_f32 v31, v31, v40
v_cvt_pk_bf16_f32 v42, v30, v31
v_lshlrev_b32 v30, 16, v42
v_and_b32 v31, 0xffff0000, v42
v_mul_f32 v30, v30, v41
v_mul_f32 v31, v31, v41
v_cvt_pk_bf16_f32 v55, v30, v31
v_lshlrev_b32 v30, 16, v55
v_and_b32 v31, 0xffff0000, v55
v_sub_f32 v32, v32, v40
v_sub_f32 v33, v33, v40
v_cvt_pk_bf16_f32 v42, v32, v33
v_lshlrev_b32 v32, 16, v42
v_and_b32 v33, 0xffff0000, v42
v_mul_f32 v32, v32, v41
v_mul_f32 v33, v33, v41
v_cvt_pk_bf16_f32 v56, v32, v33
v_lshlrev_b32 v32, 16, v56
v_and_b32 v33, 0xffff0000, v56
v_sub_f32 v34, v34, v40
v_sub_f32 v35, v35, v40
v_cvt_pk_bf16_f32 v42, v34, v35
v_lshlrev_b32 v34, 16, v42
v_and_b32 v35, 0xffff0000, v42
v_mul_f32 v34, v34, v41
v_mul_f32 v35, v35, v41
v_cvt_pk_bf16_f32 v57, v34, v35
v_lshlrev_b32 v34, 16, v57
v_and_b32 v35, 0xffff0000, v57
v_sub_f32 v36, v36, v40
v_sub_f32 v37, v37, v40
v_cvt_pk_bf16_f32 v42, v36, v37
v_lshlrev_b32 v36, 16, v42
v_and_b32 v37, 0xffff0000, v42
v_mul_f32 v36, v36, v41
v_mul_f32 v37, v37, v41
v_cvt_pk_bf16_f32 v58, v36, v37
v_lshlrev_b32 v36, 16, v58
v_and_b32 v37, 0xffff0000, v58
v_sub_f32 v38, v38, v40
v_sub_f32 v39, v39, v40
v_cvt_pk_bf16_f32 v42, v38, v39
v_lshlrev_b32 v38, 16, v42
v_and_b32 v39, 0xffff0000, v42
v_mul_f32 v38, v38, v41
v_mul_f32 v39, v39, v41
v_cvt_pk_bf16_f32 v59, v38, v39
v_lshlrev_b32 v38, 16, v59
v_and_b32 v39, 0xffff0000, v59
v_add_u32 v3, 4194304, v62
global_store_dwordx4 v3, v[52:55], s[40:41] sc1
global_store_dwordx4 v3, v[56:59], s[40:41] offset:1024 sc1
s_waitcnt vmcnt(0)
s_barrier
s_cmp_lg_u32 s20, 0
s_cbranch_scc1 M_sg_63
v_mov_b32 v42, 132
v_mov_b32 v43, 1
s_mov_b64 exec, 1
global_atomic_add v42, v43, s[56:57]
s_mov_b64 exec, -1
M_sg_63:
W_first:
v_and_b32 v1, 63, v0
v_lshrrev_b32 v42, 6, v0
s_nop 0
v_readfirstlane_b32 s20, v42
s_lshl_b32 s25, s20, 12
s_add_u32 s26, s25, 16384
s_cmp_eq_u32 s96, 1
s_cbranch_scc1 M_nt0_65
s_cmp_lg_u32 s20, 0
s_cbranch_scc1 M_ci_66
s_lshl_b32 s64, s58, 2
s_add_u32 s64, s64, 48
v_mov_b32 v42, s64
v_mov_b32 v43, 1
s_mov_b64 exec, 1
global_atomic_add v55, v42, v43, s[56:57] sc0
s_mov_b64 exec, -1
M_ci_66:
M_nt0_65:
s_mov_b32 s96, 0
v_mov_b32 v44, 163824
s_cmp_lg_u32 s20, 0
s_cbranch_scc1 M_nt_64
s_waitcnt vmcnt(0)
s_mov_b64 exec, 1
ds_write_b32 v44, v55
s_waitcnt lgkmcnt(0)
s_mov_b64 exec, -1
M_nt_64:
s_barrier
ds_read_b32 v45, v44
s_waitcnt lgkmcnt(0)
v_readfirstlane_b32 s59, v45
s_barrier
s_add_u32 s59, s59, 32
W_have:
s_cmp_ge_u32 s59, 274
s_cbranch_scc1 M_end0
s_lshl_b32 s64, s59, 2
s_load_dword s65, s[68:69], s64
s_waitcnt lgkmcnt(0)
s_and_b32 s60, s65, 0xff
s_bfe_u32 s61, s65, 0x80008
s_bfe_u32 s62, s65, 0x80010
s_cmp_eq_u32 s60, 3
s_cbranch_scc1 W_m1
s_cmp_eq_u32 s60, 4
s_cbranch_scc1 W_m2
s_cmp_eq_u32 s60, 7
s_cbranch_scc1 W_at
s_cmp_eq_u32 s60, 8
s_cbranch_scc1 W_op
s_cmp_eq_u32 s60, 9
s_cbranch_scc1 W_opp
s_cmp_eq_u32 s60, 10
s_cbranch_scc1 W_at1
s_cmp_eq_u32 s60, 11
s_cbranch_scc1 W_fin
s_lshl_b32 s62, s62, 2
s_add_u32 s62, s62, s58
s_cmp_eq_u32 s60, 1
s_cbranch_scc1 W_v
s_cmp_eq_u32 s60, 5
s_cbranch_scc1 W_ks
s_cmp_eq_u32 s60, 6
s_cbranch_scc1 W_vs
s_lshr_b32 s63, s61, 0
s_cmp_ge_u32 s63, 2
s_cbranch_scc1 M_lb_67
s_cmp_lg_u32 s20, 0
s_cbranch_scc1 M_wcd_70
s_lshl_b32 s64, s63, 2
s_add_u32 s64, s64, 144
v_mov_b32 v42, s64
s_mov_b32 s65, 0
s_mov_b64 exec, 1
M_wc_69:
global_load_dword v43, v42, s[56:57] sc1
s_waitcnt vmcnt(0)
v_readfirstlane_b32 s64, v43
s_cmp_ge_u32 s64, 64
s_cbranch_scc1 M_wcd_70_x
s_sleep 20
s_add_u32 s65, s65, 1
s_cmp_lt_u32 s65, 400000
s_cbranch_scc1 M_wc_69
s_mov_b64 exec, -1
s_branch M_exit0
M_wcd_70_x:
s_mov_b64 exec, -1
M_wcd_70:
s_barrier
s_branch M_lbd_68
M_lb_67:
s_cmp_eq_u32 s97, 1
s_cbranch_scc1 M_wo_71
s_cmp_lg_u32 s20, 0
s_cbranch_scc1 M_wcd_73
v_mov_b32 v42, 132
s_mov_b32 s65, 0
s_mov_b64 exec, 1
M_wc_72:
global_load_dword v43, v42, s[56:57] sc1
s_waitcnt vmcnt(0)
v_readfirstlane_b32 s64, v43
s_cmp_ge_u32 s64, 128
s_cbranch_scc1 M_wcd_73_x
s_sleep 32
s_add_u32 s65, s65, 1
s_cmp_lt_u32 s65, 400000
s_cbranch_scc1 M_wc_72
s_mov_b64 exec, -1
s_branch M_exit0
M_wcd_73_x:
s_mov_b64 exec, -1
M_wcd_73:
s_barrier
s_mov_b32 s97, 1
M_wo_71:
M_lbd_68:
s_cmp_eq_u32 s60, 0
s_cselect_b32 s66, s44, s42
s_cselect_b32 s67, s45, s43
s_lshl_b32 s64, s62, 9
s_add_u32 s6, s66, s64
s_addc_u32 s7, s67, 0
s_mul_i32 s64, s61, 16384
s_add_u32 s64, s64, 0
s_add_u32 s4, s40, s64
s_addc_u32 s5, s41, 0
s_mov_b32 s8, 131072
s_mov_b32 s31, 8192
s_mov_b32 s9, 262144
s_mov_b32 s10, 32
s_mul_i32 s64, s61, 2097152
s_lshl_b32 s65, s62, 14
s_add_u32 s64, s64, s65
s_mov_b32 s65, 16777216
s_cmp_eq_u32 s60, 0
s_cselect_b32 s65, 33554432, s65
s_add_u32 s64, s64, s65
s_add_u32 s12, s40, s64
s_addc_u32 s13, s41, 0
s_mul_i32 s21, s20, 4096
v_lshlrev_b32 v42, 4, v1
v_add_u32 v2, s21, v42
v_add_u32 v3, 1024, v2
v_add_u32 v4, 1024, v3
v_add_u32 v5, 1024, v4
v_lshrrev_b32 v42, 5, v1
s_lshl_b32 s21, s20, 3
v_add_u32 v43, s21, v42
v_mul_lo_u32 v43, v43, s31
v_and_b32 v44, 31, v1
s_and_b32 s21, s20, 1
s_lshl_b32 s21, s21, 3
v_lshl_add_u32 v42, v42, 1, s21
v_xor_b32 v45, v44, v42
v_xor_b32 v46, 4, v45
v_lshl_add_u32 v45, v45, 4, v43
v_lshl_add_u32 v46, v46, 4, v43
s_lshl_b32 s22, s31, 1
s_mov_b32 s21, 0
v_add_u32 v6, s21, v45
s_add_u32 s21, s21, s22
v_add_u32 v7, s21, v46
s_add_u32 s21, s21, s22
v_add_u32 v8, s21, v45
s_add_u32 s21, s21, s22
v_add_u32 v9, s21, v46
s_mul_i32 s29, s20, 4096
s_add_u32 m0, s25, 0
s_nop 0
global_load_lds_dwordx4 v2, s[4:5] sc1
s_add_u32 m0, s25, 1024
s_nop 0
global_load_lds_dwordx4 v3, s[4:5] sc1
s_add_u32 m0, s25, 2048
s_nop 0
global_load_lds_dwordx4 v4, s[4:5] sc1
s_add_u32 m0, s25, 3072
s_nop 0
global_load_lds_dwordx4 v5, s[4:5] sc1
s_add_u32 m0, s26, 0
s_nop 0
global_load_lds_dwordx4 v6, s[6:7]
s_add_u32 m0, s26, 1024
s_nop 0
global_load_lds_dwordx4 v7, s[6:7]
s_add_u32 m0, s26, 2048
s_nop 0
global_load_lds_dwordx4 v8, s[6:7]
s_add_u32 m0, s26, 3072
s_nop 0
global_load_lds_dwordx4 v9, s[6:7]
s_add_u32 s4, s4, s8
s_addc_u32 s5, s5, 0
s_add_u32 s6, s6, s9
s_addc_u32 s7, s7, 0
s_add_u32 m0, s25, 32768
s_nop 0
global_load_lds_dwordx4 v2, s[4:5] sc1
s_add_u32 m0, s25, 33792
s_nop 0
global_load_lds_dwordx4 v3, s[4:5] sc1
s_add_u32 m0, s25, 34816
s_nop 0
global_load_lds_dwordx4 v4, s[4:5] sc1
s_add_u32 m0, s25, 35840
s_nop 0
global_load_lds_dwordx4 v5, s[4:5] sc1
s_add_u32 m0, s26, 32768
s_nop 0
global_load_lds_dwordx4 v6, s[6:7]
s_add_u32 m0, s26, 33792
s_nop 0
global_load_lds_dwordx4 v7, s[6:7]
s_add_u32 m0, s26, 34816
s_nop 0
global_load_lds_dwordx4 v8, s[6:7]
s_add_u32 m0, s26, 35840
s_nop 0
global_load_lds_dwordx4 v9, s[6:7]
s_add_u32 s4, s4, s8
s_addc_u32 s5, s5, 0
s_add_u32 s6, s6, s9
s_addc_u32 s7, s7, 0
s_add_u32 m0, s25, 65536
s_nop 0
global_load_lds_dwordx4 v2, s[4:5] sc1
s_add_u32 m0, s25, 66560
s_nop 0
global_load_lds_dwordx4 v3, s[4:5] sc1
s_add_u32 m0, s25, 67584
s_nop 0
global_load_lds_dwordx4 v4, s[4:5] sc1
s_add_u32 m0, s25, 68608
s_nop 0
global_load_lds_dwordx4 v5, s[4:5] sc1
s_add_u32 m0, s26, 65536
s_nop 0
global_load_lds_dwordx4 v6, s[6:7]
s_add_u32 m0, s26, 66560
s_nop 0
global_load_lds_dwordx4 v7, s[6:7]
s_add_u32 m0, s26, 67584
s_nop 0
global_load_lds_dwordx4 v8, s[6:7]
s_add_u32 m0, s26, 68608
s_nop 0
global_load_lds_dwordx4 v9, s[6:7]
s_add_u32 s4, s4, s8
s_addc_u32 s5, s5, 0
s_add_u32 s6, s6, s9
s_addc_u32 s7, s7, 0
s_add_u32 m0, s25, 98304
s_nop 0
global_load_lds_dwordx4 v2, s[4:5] sc1
s_add_u32 m0, s25, 99328
s_nop 0
global_load_lds_dwordx4 v3, s[4:5] sc1
s_add_u32 m0, s25, 100352
s_nop 0
global_load_lds_dwordx4 v4, s[4:5] sc1
s_add_u32 m0, s25, 101376
s_nop 0
global_load_lds_dwordx4 v5, s[4:5] sc1
s_add_u32 m0, s26, 98304
s_nop 0
global_load_lds_dwordx4 v6, s[6:7]
s_add_u32 m0, s26, 99328
s_nop 0
global_load_lds_dwordx4 v7, s[6:7]
s_add_u32 m0, s26, 100352
s_nop 0
global_load_lds_dwordx4 v8, s[6:7]
s_add_u32 m0, s26, 101376
s_nop 0
global_load_lds_dwordx4 v9, s[6:7]
s_add_u32 s4, s4, s8
s_addc_u32 s5, s5, 0
s_add_u32 s6, s6, s9
s_addc_u32 s7, s7, 0
s_lshr_b32 s21, s20, 1
s_mul_i32 s21, s21, 8192
v_and_b32 v42, 15, v1
v_lshlrev_b32 v43, 6, v42
v_add_u32 v43, s21, v43
v_lshrrev_b32 v42, 2, v42
v_lshrrev_b32 v44, 1, v42
v_xor_b32 v45, v42, v44
v_and_b32 v45, 1, v45
v_lshl_add_u32 v44, v45, 1, v44
v_lshrrev_b32 v45, 4, v1
v_xor_b32 v44, v44, v45
v_lshl_add_u32 v10, v44, 4, v43
v_add_u32 v11, 0x10000, v10
s_and_b32 s21, s20, 1
v_and_b32 v42, 15, v1
v_lshrrev_b32 v43, 2, v42
v_lshrrev_b32 v44, 4, v1
v_lshl_add_u32 v45, v44, 3, v43
v_lshlrev_b32 v45, 9, v45
v_and_b32 v46, 1, v42
v_lshl_add_u32 v45, v46, 3, v45
v_bfe_u32 v46, v42, 1, 1
v_lshl_add_u32 v45, v46, 4, v45
v_add_u32 v45, 16384, v45
v_and_b32 v44, 1, v44
v_lshl_add_u32 v43, v44, 2, v43
s_mul_i32 s22, s21, 8
s_add_u32 s23, s22, 0
s_and_b32 s24, s23, 7
s_and_b32 s23, s23, 8
v_xor_b32 v46, s24, v43
v_add_u32 v46, s23, v46
v_lshl_add_u32 v26, v46, 5, v45
v_add_u32 v34, 0x10000, v26
s_add_u32 s23, s22, 1
s_and_b32 s24, s23, 7
s_and_b32 s23, s23, 8
v_xor_b32 v46, s24, v43
v_add_u32 v46, s23, v46
v_lshl_add_u32 v27, v46, 5, v45
v_add_u32 v35, 0x10000, v27
s_add_u32 s23, s22, 2
s_and_b32 s24, s23, 7
s_and_b32 s23, s23, 8
v_xor_b32 v46, s24, v43
v_add_u32 v46, s23, v46
v_lshl_add_u32 v28, v46, 5, v45
v_add_u32 v36, 0x10000, v28
s_add_u32 s23, s22, 3
s_and_b32 s24, s23, 7
s_and_b32 s23, s23, 8
v_xor_b32 v46, s24, v43
v_add_u32 v46, s23, v46
v_lshl_add_u32 v29, v46, 5, v45
v_add_u32 v37, 0x10000, v29
s_add_u32 s23, s22, 4
s_and_b32 s24, s23, 7
s_and_b32 s23, s23, 8
v_xor_b32 v46, s24, v43
v_add_u32 v46, s23, v46
v_lshl_add_u32 v30, v46, 5, v45
v_add_u32 v38, 0x10000, v30
s_add_u32 s23, s22, 5
s_and_b32 s24, s23, 7
s_and_b32 s23, s23, 8
v_xor_b32 v46, s24, v43
v_add_u32 v46, s23, v46
v_lshl_add_u32 v31, v46, 5, v45
v_add_u32 v39, 0x10000, v31
s_add_u32 s23, s22, 6
s_and_b32 s24, s23, 7
s_and_b32 s23, s23, 8
v_xor_b32 v46, s24, v43
v_add_u32 v46, s23, v46
v_lshl_add_u32 v32, v46, 5, v45
v_add_u32 v40, 0x10000, v32
s_add_u32 s23, s22, 7
s_and_b32 s24, s23, 7
s_and_b32 s23, s23, 8
v_xor_b32 v46, s24, v43
v_add_u32 v46, s23, v46
v_lshl_add_u32 v33, v46, 5, v45
v_add_u32 v41, 0x10000, v33
s_waitcnt vmcnt(0)
s_barrier
ds_read_b64_tr_b16 v[160:161], v26 offset:0
ds_read_b64_tr_b16 v[162:163], v26 offset:2048
ds_read_b128 v[128:131], v10 offset:0
ds_read_b128 v[132:135], v10 offset:1024
ds_read_b128 v[136:139], v10 offset:2048
ds_read_b128 v[140:143], v10 offset:3072
ds_read_b128 v[144:147], v10 offset:4096
ds_read_b128 v[148:151], v10 offset:5120
ds_read_b128 v[152:155], v10 offset:6144
ds_read_b128 v[156:159], v10 offset:7168
ds_read_b64_tr_b16 v[164:165], v27 offset:0
ds_read_b64_tr_b16 v[166:167], v27 offset:2048
ds_read_b64_tr_b16 v[168:169], v28 offset:0
ds_read_b64_tr_b16 v[170:171], v28 offset:2048
ds_read_b64_tr_b16 v[172:173], v29 offset:0
ds_read_b64_tr_b16 v[174:175], v29 offset:2048
ds_read_b64_tr_b16 v[176:177], v30 offset:0
ds_read_b64_tr_b16 v[178:179], v30 offset:2048
ds_read_b64_tr_b16 v[180:181], v31 offset:0
ds_read_b64_tr_b16 v[182:183], v31 offset:2048
ds_read_b64_tr_b16 v[184:185], v32 offset:0
ds_read_b64_tr_b16 v[186:187], v32 offset:2048
ds_read_b64_tr_b16 v[188:189], v33 offset:0
ds_read_b64_tr_b16 v[190:191], v33 offset:2048
s_lshr_b32 s11, s10, 2
s_sub_u32 s11, s11, 1
s_waitcnt lgkmcnt(0)
v_mfma_f32_16x16x32_bf16 a[0:3], v[160:163], v[128:131], 0
v_mfma_f32_16x16x32_bf16 a[4:7], v[160:163], v[132:135], 0
v_mfma_f32_16x16x32_bf16 a[8:11], v[160:163], v[136:139], 0
v_mfma_f32_16x16x32_bf16 a[12:15], v[160:163], v[140:143], 0
v_mfma_f32_16x16x32_bf16 a[16:19], v[160:163], v[144:147], 0
v_mfma_f32_16x16x32_bf16 a[20:23], v[160:163], v[148:151], 0
v_mfma_f32_16x16x32_bf16 a[24:27], v[160:163], v[152:155], 0
v_mfma_f32_16x16x32_bf16 a[28:31], v[160:163], v[156:159], 0
v_mfma_f32_16x16x32_bf16 a[32:35], v[164:167], v[128:131], 0
v_mfma_f32_16x16x32_bf16 a[36:39], v[164:167], v[132:135], 0
v_mfma_f32_16x16x32_bf16 a[40:43], v[164:167], v[136:139], 0
v_mfma_f32_16x16x32_bf16 a[44:47], v[164:167], v[140:143], 0
v_mfma_f32_16x16x32_bf16 a[48:51], v[164:167], v[144:147], 0
v_mfma_f32_16x16x32_bf16 a[52:55], v[164:167], v[148:151], 0
v_mfma_f32_16x16x32_bf16 a[56:59], v[164:167], v[152:155], 0
v_mfma_f32_16x16x32_bf16 a[60:63], v[164:167], v[156:159], 0
v_mfma_f32_16x16x32_bf16 a[64:67], v[168:171], v[128:131], 0
v_mfma_f32_16x16x32_bf16 a[68:71], v[168:171], v[132:135], 0
v_mfma_f32_16x16x32_bf16 a[72:75], v[168:171], v[136:139], 0
v_mfma_f32_16x16x32_bf16 a[76:79], v[168:171], v[140:143], 0
v_mfma_f32_16x16x32_bf16 a[80:83], v[168:171], v[144:147], 0
v_mfma_f32_16x16x32_bf16 a[84:87], v[168:171], v[148:151], 0
v_mfma_f32_16x16x32_bf16 a[88:91], v[168:171], v[152:155], 0
v_mfma_f32_16x16x32_bf16 a[92:95], v[168:171], v[156:159], 0
v_mfma_f32_16x16x32_bf16 a[96:99], v[172:175], v[128:131], 0
v_mfma_f32_16x16x32_bf16 a[100:103], v[172:175], v[132:135], 0
v_mfma_f32_16x16x32_bf16 a[104:107], v[172:175], v[136:139], 0
v_mfma_f32_16x16x32_bf16 a[108:111], v[172:175], v[140:143], 0
v_mfma_f32_16x16x32_bf16 a[112:115], v[172:175], v[144:147], 0
v_mfma_f32_16x16x32_bf16 a[116:119], v[172:175], v[148:151], 0
v_mfma_f32_16x16x32_bf16 a[120:123], v[172:175], v[152:155], 0
v_mfma_f32_16x16x32_bf16 a[124:127], v[172:175], v[156:159], 0
s_barrier
v_mfma_f32_16x16x32_bf16 a[128:131], v[176:179], v[128:131], 0
ds_read_b64_tr_b16 v[224:225], v26 offset:32768
v_mfma_f32_16x16x32_bf16 a[132:135], v[176:179], v[132:135], 0
s_add_u32 m0, s25, 0
ds_read_b64_tr_b16 v[226:227], v26 offset:34816
v_mfma_f32_16x16x32_bf16 a[136:139], v[176:179], v[136:139], 0
global_load_lds_dwordx4 v2, s[4:5] sc1
ds_read_b128 v[192:195], v10 offset:32768
v_mfma_f32_16x16x32_bf16 a[140:143], v[176:179], v[140:143], 0
ds_read_b128 v[196:199], v10 offset:33792
v_mfma_f32_16x16x32_bf16 a[144:147], v[176:179], v[144:147], 0
ds_read_b128 v[200:203], v10 offset:34816
v_mfma_f32_16x16x32_bf16 a[148:151], v[176:179], v[148:151], 0
ds_read_b128 v[204:207], v10 offset:35840
v_mfma_f32_16x16x32_bf16 a[152:155], v[176:179], v[152:155], 0
ds_read_b128 v[208:211], v10 offset:36864
v_mfma_f32_16x16x32_bf16 a[156:159], v[176:179], v[156:159], 0
ds_read_b128 v[212:215], v10 offset:37888
v_mfma_f32_16x16x32_bf16 a[160:163], v[180:183], v[128:131], 0
ds_read_b128 v[216:219], v10 offset:38912
v_mfma_f32_16x16x32_bf16 a[164:167], v[180:183], v[132:135], 0
s_add_u32 m0, s25, 1024
ds_read_b128 v[220:223], v10 offset:39936
v_mfma_f32_16x16x32_bf16 a[168:171], v[180:183], v[136:139], 0
global_load_lds_dwordx4 v3, s[4:5] sc1
ds_read_b64_tr_b16 v[228:229], v27 offset:32768
v_mfma_f32_16x16x32_bf16 a[172:175], v[180:183], v[140:143], 0
ds_read_b64_tr_b16 v[230:231], v27 offset:34816
v_mfma_f32_16x16x32_bf16 a[176:179], v[180:183], v[144:147], 0
ds_read_b64_tr_b16 v[232:233], v28 offset:32768
v_mfma_f32_16x16x32_bf16 a[180:183], v[180:183], v[148:151], 0
ds_read_b64_tr_b16 v[234:235], v28 offset:34816
v_mfma_f32_16x16x32_bf16 a[184:187], v[180:183], v[152:155], 0
ds_read_b64_tr_b16 v[236:237], v29 offset:32768
v_mfma_f32_16x16x32_bf16 a[188:191], v[180:183], v[156:159], 0
ds_read_b64_tr_b16 v[238:239], v29 offset:34816
v_mfma_f32_16x16x32_bf16 a[192:195], v[184:187], v[128:131], 0
ds_read_b64_tr_b16 v[240:241], v30 offset:32768
v_mfma_f32_16x16x32_bf16 a[196:199], v[184:187], v[132:135], 0
s_add_u32 m0, s25, 2048
ds_read_b64_tr_b16 v[242:243], v30 offset:34816
v_mfma_f32_16x16x32_bf16 a[200:203], v[184:187], v[136:139], 0
global_load_lds_dwordx4 v4, s[4:5] sc1
ds_read_b64_tr_b16 v[244:245], v31 offset:32768
v_mfma_f32_16x16x32_bf16 a[204:207], v[184:187], v[140:143], 0
ds_read_b64_tr_b16 v[246:247], v31 offset:34816
v_mfma_f32_16x16x32_bf16 a[208:211], v[184:187], v[144:147], 0
ds_read_b64_tr_b16 v[248:249], v32 offset:32768
v_mfma_f32_16x16x32_bf16 a[212:215], v[184:187], v[148:151], 0
ds_read_b64_tr_b16 v[250:251], v32 offset:34816
v_mfma_f32_16x16x32_bf16 a[216:219], v[184:187], v[152:155], 0
ds_read_b64_tr_b16 v[252:253], v33 offset:32768
v_mfma_f32_16x16x32_bf16 a[220:223], v[184:187], v[156:159], 0
ds_read_b64_tr_b16 v[254:255], v33 offset:34816
v_mfma_f32_16x16x32_bf16 a[224:227], v[188:191], v[128:131], 0
v_mfma_f32_16x16x32_bf16 a[228:231], v[188:191], v[132:135], 0
s_add_u32 m0, s25, 3072
v_mfma_f32_16x16x32_bf16 a[232:235], v[188:191], v[136:139], 0
global_load_lds_dwordx4 v5, s[4:5] sc1
v_mfma_f32_16x16x32_bf16 a[236:239], v[188:191], v[140:143], 0
v_mfma_f32_16x16x32_bf16 a[240:243], v[188:191], v[144:147], 0
v_mfma_f32_16x16x32_bf16 a[244:247], v[188:191], v[148:151], 0
v_mfma_f32_16x16x32_bf16 a[248:251], v[188:191], v[152:155], 0
v_mfma_f32_16x16x32_bf16 a[252:255], v[188:191], v[156:159], 0
s_add_u32 s4, s4, s8
s_addc_u32 s5, s5, 0
M_gl_74:
s_waitcnt lgkmcnt(0)
v_mfma_f32_16x16x32_bf16 a[0:3], v[224:227], v[192:195], a[0:3]
v_mfma_f32_16x16x32_bf16 a[4:7], v[224:227], v[196:199], a[4:7]
s_add_u32 m0, s26, 0
v_mfma_f32_16x16x32_bf16 a[8:11], v[224:227], v[200:203], a[8:11]
global_load_lds_dwordx4 v6, s[6:7]
v_mfma_f32_16x16x32_bf16 a[12:15], v[224:227], v[204:207], a[12:15]
v_mfma_f32_16x16x32_bf16 a[16:19], v[224:227], v[208:211], a[16:19]
v_mfma_f32_16x16x32_bf16 a[20:23], v[224:227], v[212:215], a[20:23]
v_mfma_f32_16x16x32_bf16 a[24:27], v[224:227], v[216:219], a[24:27]
v_mfma_f32_16x16x32_bf16 a[28:31], v[224:227], v[220:223], a[28:31]
v_mfma_f32_16x16x32_bf16 a[32:35], v[228:231], v[192:195], a[32:35]
v_mfma_f32_16x16x32_bf16 a[36:39], v[228:231], v[196:199], a[36:39]
s_add_u32 m0, s26, 1024
v_mfma_f32_16x16x32_bf16 a[40:43], v[228:231], v[200:203], a[40:43]
global_load_lds_dwordx4 v7, s[6:7]
v_mfma_f32_16x16x32_bf16 a[44:47], v[228:231], v[204:207], a[44:47]
v_mfma_f32_16x16x32_bf16 a[48:51], v[228:231], v[208:211], a[48:51]
v_mfma_f32_16x16x32_bf16 a[52:55], v[228:231], v[212:215], a[52:55]
v_mfma_f32_16x16x32_bf16 a[56:59], v[228:231], v[216:219], a[56:59]
v_mfma_f32_16x16x32_bf16 a[60:63], v[228:231], v[220:223], a[60:63]
v_mfma_f32_16x16x32_bf16 a[64:67], v[232:235], v[192:195], a[64:67]
v_mfma_f32_16x16x32_bf16 a[68:71], v[232:235], v[196:199], a[68:71]
s_add_u32 m0, s26, 2048
v_mfma_f32_16x16x32_bf16 a[72:75], v[232:235], v[200:203], a[72:75]
global_load_lds_dwordx4 v8, s[6:7]
v_mfma_f32_16x16x32_bf16 a[76:79], v[232:235], v[204:207], a[76:79]
v_mfma_f32_16x16x32_bf16 a[80:83], v[232:235], v[208:211], a[80:83]
v_mfma_f32_16x16x32_bf16 a[84:87], v[232:235], v[212:215], a[84:87]
v_mfma_f32_16x16x32_bf16 a[88:91], v[232:235], v[216:219], a[88:91]
v_mfma_f32_16x16x32_bf16 a[92:95], v[232:235], v[220:223], a[92:95]
v_mfma_f32_16x16x32_bf16 a[96:99], v[236:239], v[192:195], a[96:99]
v_mfma_f32_16x16x32_bf16 a[100:103], v[236:239], v[196:199], a[100:103]
s_add_u32 m0, s26, 3072
v_mfma_f32_16x16x32_bf16 a[104:107], v[236:239], v[200:203], a[104:107]
global_load_lds_dwordx4 v9, s[6:7]
v_mfma_f32_16x16x32_bf16 a[108:111], v[236:239], v[204:207], a[108:111]
v_mfma_f32_16x16x32_bf16 a[112:115], v[236:239], v[208:211], a[112:115]
v_mfma_f32_16x16x32_bf16 a[116:119], v[236:239], v[212:215], a[116:119]
v_mfma_f32_16x16x32_bf16 a[120:123], v[236:239], v[216:219], a[120:123]
v_mfma_f32_16x16x32_bf16 a[124:127], v[236:239], v[220:223], a[124:127]
s_add_u32 s6, s6, s9
s_addc_u32 s7, s7, 0
s_waitcnt vmcnt(16)
s_barrier
v_mfma_f32_16x16x32_bf16 a[128:131], v[240:243], v[192:195], a[128:131]
ds_read_b64_tr_b16 v[160:161], v34 offset:0
v_mfma_f32_16x16x32_bf16 a[132:135], v[240:243], v[196:199], a[132:135]
s_add_u32 m0, s25, 32768
ds_read_b64_tr_b16 v[162:163], v34 offset:2048
v_mfma_f32_16x16x32_bf16 a[136:139], v[240:243], v[200:203], a[136:139]
global_load_lds_dwordx4 v2, s[4:5] sc1
ds_read_b128 v[128:131], v11 offset:0
v_mfma_f32_16x16x32_bf16 a[140:143], v[240:243], v[204:207], a[140:143]
ds_read_b128 v[132:135], v11 offset:1024
v_mfma_f32_16x16x32_bf16 a[144:147], v[240:243], v[208:211], a[144:147]
ds_read_b128 v[136:139], v11 offset:2048
v_mfma_f32_16x16x32_bf16 a[148:151], v[240:243], v[212:215], a[148:151]
ds_read_b128 v[140:143], v11 offset:3072
v_mfma_f32_16x16x32_bf16 a[152:155], v[240:243], v[216:219], a[152:155]
ds_read_b128 v[144:147], v11 offset:4096
v_mfma_f32_16x16x32_bf16 a[156:159], v[240:243], v[220:223], a[156:159]
ds_read_b128 v[148:151], v11 offset:5120
v_mfma_f32_16x16x32_bf16 a[160:163], v[244:247], v[192:195], a[160:163]
ds_read_b128 v[152:155], v11 offset:6144
v_mfma_f32_16x16x32_bf16 a[164:167], v[244:247], v[196:199], a[164:167]
s_add_u32 m0, s25, 33792
ds_read_b128 v[156:159], v11 offset:7168
v_mfma_f32_16x16x32_bf16 a[168:171], v[244:247], v[200:203], a[168:171]
global_load_lds_dwordx4 v3, s[4:5] sc1
ds_read_b64_tr_b16 v[164:165], v35 offset:0
v_mfma_f32_16x16x32_bf16 a[172:175], v[244:247], v[204:207], a[172:175]
ds_read_b64_tr_b16 v[166:167], v35 offset:2048
v_mfma_f32_16x16x32_bf16 a[176:179], v[244:247], v[208:211], a[176:179]
ds_read_b64_tr_b16 v[168:169], v36 offset:0
v_mfma_f32_16x16x32_bf16 a[180:183], v[244:247], v[212:215], a[180:183]
ds_read_b64_tr_b16 v[170:171], v36 offset:2048
v_mfma_f32_16x16x32_bf16 a[184:187], v[244:247], v[216:219], a[184:187]
ds_read_b64_tr_b16 v[172:173], v37 offset:0
v_mfma_f32_16x16x32_bf16 a[188:191], v[244:247], v[220:223], a[188:191]
ds_read_b64_tr_b16 v[174:175], v37 offset:2048
v_mfma_f32_16x16x32_bf16 a[192:195], v[248:251], v[192:195], a[192:195]
ds_read_b64_tr_b16 v[176:177], v38 offset:0
v_mfma_f32_16x16x32_bf16 a[196:199], v[248:251], v[196:199], a[196:199]
s_add_u32 m0, s25, 34816
ds_read_b64_tr_b16 v[178:179], v38 offset:2048
v_mfma_f32_16x16x32_bf16 a[200:203], v[248:251], v[200:203], a[200:203]
global_load_lds_dwordx4 v4, s[4:5] sc1
ds_read_b64_tr_b16 v[180:181], v39 offset:0
v_mfma_f32_16x16x32_bf16 a[204:207], v[248:251], v[204:207], a[204:207]
ds_read_b64_tr_b16 v[182:183], v39 offset:2048
v_mfma_f32_16x16x32_bf16 a[208:211], v[248:251], v[208:211], a[208:211]
ds_read_b64_tr_b16 v[184:185], v40 offset:0
v_mfma_f32_16x16x32_bf16 a[212:215], v[248:251], v[212:215], a[212:215]
ds_read_b64_tr_b16 v[186:187], v40 offset:2048
v_mfma_f32_16x16x32_bf16 a[216:219], v[248:251], v[216:219], a[216:219]
ds_read_b64_tr_b16 v[188:189], v41 offset:0
v_mfma_f32_16x16x32_bf16 a[220:223], v[248:251], v[220:223], a[220:223]
ds_read_b64_tr_b16 v[190:191], v41 offset:2048
v_mfma_f32_16x16x32_bf16 a[224:227], v[252:255], v[192:195], a[224:227]
v_mfma_f32_16x16x32_bf16 a[228:231], v[252:255], v[196:199], a[228:231]
s_add_u32 m0, s25, 35840
v_mfma_f32_16x16x32_bf16 a[232:235], v[252:255], v[200:203], a[232:235]
global_load_lds_dwordx4 v5, s[4:5] sc1
v_mfma_f32_16x16x32_bf16 a[236:239], v[252:255], v[204:207], a[236:239]
v_mfma_f32_16x16x32_bf16 a[240:243], v[252:255], v[208:211], a[240:243]
v_mfma_f32_16x16x32_bf16 a[244:247], v[252:255], v[212:215], a[244:247]
v_mfma_f32_16x16x32_bf16 a[248:251], v[252:255], v[216:219], a[248:251]
v_mfma_f32_16x16x32_bf16 a[252:255], v[252:255], v[220:223], a[252:255]
s_add_u32 s4, s4, s8
s_addc_u32 s5, s5, 0
s_waitcnt lgkmcnt(0)
v_mfma_f32_16x16x32_bf16 a[0:3], v[160:163], v[128:131], a[0:3]
v_mfma_f32_16x16x32_bf16 a[4:7], v[160:163], v[132:135], a[4:7]
s_add_u32 m0, s26, 32768
v_mfma_f32_16x16x32_bf16 a[8:11], v[160:163], v[136:139], a[8:11]
global_load_lds_dwordx4 v6, s[6:7]
v_mfma_f32_16x16x32_bf16 a[12:15], v[160:163], v[140:143], a[12:15]
v_mfma_f32_16x16x32_bf16 a[16:19], v[160:163], v[144:147], a[16:19]
v_mfma_f32_16x16x32_bf16 a[20:23], v[160:163], v[148:151], a[20:23]
v_mfma_f32_16x16x32_bf16 a[24:27], v[160:163], v[152:155], a[24:27]
v_mfma_f32_16x16x32_bf16 a[28:31], v[160:163], v[156:159], a[28:31]
v_mfma_f32_16x16x32_bf16 a[32:35], v[164:167], v[128:131], a[32:35]
v_mfma_f32_16x16x32_bf16 a[36:39], v[164:167], v[132:135], a[36:39]
s_add_u32 m0, s26, 33792
v_mfma_f32_16x16x32_bf16 a[40:43], v[164:167], v[136:139], a[40:43]
global_load_lds_dwordx4 v7, s[6:7]
v_mfma_f32_16x16x32_bf16 a[44:47], v[164:167], v[140:143], a[44:47]
v_mfma_f32_16x16x32_bf16 a[48:51], v[164:167], v[144:147], a[48:51]
v_mfma_f32_16x16x32_bf16 a[52:55], v[164:167], v[148:151], a[52:55]
v_mfma_f32_16x16x32_bf16 a[56:59], v[164:167], v[152:155], a[56:59]
v_mfma_f32_16x16x32_bf16 a[60:63], v[164:167], v[156:159], a[60:63]
v_mfma_f32_16x16x32_bf16 a[64:67], v[168:171], v[128:131], a[64:67]
v_mfma_f32_16x16x32_bf16 a[68:71], v[168:171], v[132:135], a[68:71]
s_add_u32 m0, s26, 34816
v_mfma_f32_16x16x32_bf16 a[72:75], v[168:171], v[136:139], a[72:75]
global_load_lds_dwordx4 v8, s[6:7]
v_mfma_f32_16x16x32_bf16 a[76:79], v[168:171], v[140:143], a[76:79]
v_mfma_f32_16x16x32_bf16 a[80:83], v[168:171], v[144:147], a[80:83]
v_mfma_f32_16x16x32_bf16 a[84:87], v[168:171], v[148:151], a[84:87]
v_mfma_f32_16x16x32_bf16 a[88:91], v[168:171], v[152:155], a[88:91]
v_mfma_f32_16x16x32_bf16 a[92:95], v[168:171], v[156:159], a[92:95]
v_mfma_f32_16x16x32_bf16 a[96:99], v[172:175], v[128:131], a[96:99]
v_mfma_f32_16x16x32_bf16 a[100:103], v[172:175], v[132:135], a[100:103]
s_add_u32 m0, s26, 35840
v_mfma_f32_16x16x32_bf16 a[104:107], v[172:175], v[136:139], a[104:107]
global_load_lds_dwordx4 v9, s[6:7]
v_mfma_f32_16x16x32_bf16 a[108:111], v[172:175], v[140:143], a[108:111]
v_mfma_f32_16x16x32_bf16 a[112:115], v[172:175], v[144:147], a[112:115]
v_mfma_f32_16x16x32_bf16 a[116:119], v[172:175], v[148:151], a[116:119]
v_mfma_f32_16x16x32_bf16 a[120:123], v[172:175], v[152:155], a[120:123]
v_mfma_f32_16x16x32_bf16 a[124:127], v[172:175], v[156:159], a[124:127]
s_add_u32 s6, s6, s9
s_addc_u32 s7, s7, 0
s_waitcnt vmcnt(16)
s_barrier
v_mfma_f32_16x16x32_bf16 a[128:131], v[176:179], v[128:131], a[128:131]
ds_read_b64_tr_b16 v[224:225], v34 offset:32768
v_mfma_f32_16x16x32_bf16 a[132:135], v[176:179], v[132:135], a[132:135]
s_add_u32 m0, s25, 65536
ds_read_b64_tr_b16 v[226:227], v34 offset:34816
v_mfma_f32_16x16x32_bf16 a[136:139], v[176:179], v[136:139], a[136:139]
global_load_lds_dwordx4 v2, s[4:5] sc1
ds_read_b128 v[192:195], v11 offset:32768
v_mfma_f32_16x16x32_bf16 a[140:143], v[176:179], v[140:143], a[140:143]
ds_read_b128 v[196:199], v11 offset:33792
v_mfma_f32_16x16x32_bf16 a[144:147], v[176:179], v[144:147], a[144:147]
ds_read_b128 v[200:203], v11 offset:34816
v_mfma_f32_16x16x32_bf16 a[148:151], v[176:179], v[148:151], a[148:151]
ds_read_b128 v[204:207], v11 offset:35840
v_mfma_f32_16x16x32_bf16 a[152:155], v[176:179], v[152:155], a[152:155]
ds_read_b128 v[208:211], v11 offset:36864
v_mfma_f32_16x16x32_bf16 a[156:159], v[176:179], v[156:159], a[156:159]
ds_read_b128 v[212:215], v11 offset:37888
v_mfma_f32_16x16x32_bf16 a[160:163], v[180:183], v[128:131], a[160:163]
ds_read_b128 v[216:219], v11 offset:38912
v_mfma_f32_16x16x32_bf16 a[164:167], v[180:183], v[132:135], a[164:167]
s_add_u32 m0, s25, 66560
ds_read_b128 v[220:223], v11 offset:39936
v_mfma_f32_16x16x32_bf16 a[168:171], v[180:183], v[136:139], a[168:171]
global_load_lds_dwordx4 v3, s[4:5] sc1
ds_read_b64_tr_b16 v[228:229], v35 offset:32768
v_mfma_f32_16x16x32_bf16 a[172:175], v[180:183], v[140:143], a[172:175]
ds_read_b64_tr_b16 v[230:231], v35 offset:34816
v_mfma_f32_16x16x32_bf16 a[176:179], v[180:183], v[144:147], a[176:179]
ds_read_b64_tr_b16 v[232:233], v36 offset:32768
v_mfma_f32_16x16x32_bf16 a[180:183], v[180:183], v[148:151], a[180:183]
ds_read_b64_tr_b16 v[234:235], v36 offset:34816
v_mfma_f32_16x16x32_bf16 a[184:187], v[180:183], v[152:155], a[184:187]
ds_read_b64_tr_b16 v[236:237], v37 offset:32768
v_mfma_f32_16x16x32_bf16 a[188:191], v[180:183], v[156:159], a[188:191]
ds_read_b64_tr_b16 v[238:239], v37 offset:34816
v_mfma_f32_16x16x32_bf16 a[192:195], v[184:187], v[128:131], a[192:195]
ds_read_b64_tr_b16 v[240:241], v38 offset:32768
v_mfma_f32_16x16x32_bf16 a[196:199], v[184:187], v[132:135], a[196:199]
s_add_u32 m0, s25, 67584
ds_read_b64_tr_b16 v[242:243], v38 offset:34816
v_mfma_f32_16x16x32_bf16 a[200:203], v[184:187], v[136:139], a[200:203]
global_load_lds_dwordx4 v4, s[4:5] sc1
ds_read_b64_tr_b16 v[244:245], v39 offset:32768
v_mfma_f32_16x16x32_bf16 a[204:207], v[184:187], v[140:143], a[204:207]
ds_read_b64_tr_b16 v[246:247], v39 offset:34816
v_mfma_f32_16x16x32_bf16 a[208:211], v[184:187], v[144:147], a[208:211]
ds_read_b64_tr_b16 v[248:249], v40 offset:32768
v_mfma_f32_16x16x32_bf16 a[212:215], v[184:187], v[148:151], a[212:215]
ds_read_b64_tr_b16 v[250:251], v40 offset:34816
v_mfma_f32_16x16x32_bf16 a[216:219], v[184:187], v[152:155], a[216:219]
ds_read_b64_tr_b16 v[252:253], v41 offset:32768
v_mfma_f32_16x16x32_bf16 a[220:223], v[184:187], v[156:159], a[220:223]
ds_read_b64_tr_b16 v[254:255], v41 offset:34816
v_mfma_f32_16x16x32_bf16 a[224:227], v[188:191], v[128:131], a[224:227]
v_mfma_f32_16x16x32_bf16 a[228:231], v[188:191], v[132:135], a[228:231]
s_add_u32 m0, s25, 68608
v_mfma_f32_16x16x32_bf16 a[232:235], v[188:191], v[136:139], a[232:235]
global_load_lds_dwordx4 v5, s[4:5] sc1
v_mfma_f32_16x16x32_bf16 a[236:239], v[188:191], v[140:143], a[236:239]
v_mfma_f32_16x16x32_bf16 a[240:243], v[188:191], v[144:147], a[240:243]
v_mfma_f32_16x16x32_bf16 a[244:247], v[188:191], v[148:151], a[244:247]
v_mfma_f32_16x16x32_bf16 a[248:251], v[188:191], v[152:155], a[248:251]
v_mfma_f32_16x16x32_bf16 a[252:255], v[188:191], v[156:159], a[252:255]
s_add_u32 s4, s4, s8
s_addc_u32 s5, s5, 0
s_waitcnt lgkmcnt(0)
v_mfma_f32_16x16x32_bf16 a[0:3], v[224:227], v[192:195], a[0:3]
v_mfma_f32_16x16x32_bf16 a[4:7], v[224:227], v[196:199], a[4:7]
s_add_u32 m0, s26, 65536
v_mfma_f32_16x16x32_bf16 a[8:11], v[224:227], v[200:203], a[8:11]
global_load_lds_dwordx4 v6, s[6:7]
v_mfma_f32_16x16x32_bf16 a[12:15], v[224:227], v[204:207], a[12:15]
v_mfma_f32_16x16x32_bf16 a[16:19], v[224:227], v[208:211], a[16:19]
v_mfma_f32_16x16x32_bf16 a[20:23], v[224:227], v[212:215], a[20:23]
v_mfma_f32_16x16x32_bf16 a[24:27], v[224:227], v[216:219], a[24:27]
v_mfma_f32_16x16x32_bf16 a[28:31], v[224:227], v[220:223], a[28:31]
v_mfma_f32_16x16x32_bf16 a[32:35], v[228:231], v[192:195], a[32:35]
v_mfma_f32_16x16x32_bf16 a[36:39], v[228:231], v[196:199], a[36:39]
s_add_u32 m0, s26, 66560
v_mfma_f32_16x16x32_bf16 a[40:43], v[228:231], v[200:203], a[40:43]
global_load_lds_dwordx4 v7, s[6:7]
v_mfma_f32_16x16x32_bf16 a[44:47], v[228:231], v[204:207], a[44:47]
v_mfma_f32_16x16x32_bf16 a[48:51], v[228:231], v[208:211], a[48:51]
v_mfma_f32_16x16x32_bf16 a[52:55], v[228:231], v[212:215], a[52:55]
v_mfma_f32_16x16x32_bf16 a[56:59], v[228:231], v[216:219], a[56:59]
v_mfma_f32_16x16x32_bf16 a[60:63], v[228:231], v[220:223], a[60:63]
v_mfma_f32_16x16x32_bf16 a[64:67], v[232:235], v[192:195], a[64:67]
v_mfma_f32_16x16x32_bf16 a[68:71], v[232:235], v[196:199], a[68:71]
s_add_u32 m0, s26, 67584
v_mfma_f32_16x16x32_bf16 a[72:75], v[232:235], v[200:203], a[72:75]
global_load_lds_dwordx4 v8, s[6:7]
v_mfma_f32_16x16x32_bf16 a[76:79], v[232:235], v[204:207], a[76:79]
v_mfma_f32_16x16x32_bf16 a[80:83], v[232:235], v[208:211], a[80:83]
v_mfma_f32_16x16x32_bf16 a[84:87], v[232:235], v[212:215], a[84:87]
v_mfma_f32_16x16x32_bf16 a[88:91], v[232:235], v[216:219], a[88:91]
v_mfma_f32_16x16x32_bf16 a[92:95], v[232:235], v[220:223], a[92:95]
v_mfma_f32_16x16x32_bf16 a[96:99], v[236:239], v[192:195], a[96:99]
v_mfma_f32_16x16x32_bf16 a[100:103], v[236:239], v[196:199], a[100:103]
s_add_u32 m0, s26, 68608
v_mfma_f32_16x16x32_bf16 a[104:107], v[236:239], v[200:203], a[104:107]
global_load_lds_dwordx4 v9, s[6:7]
v_mfma_f32_16x16x32_bf16 a[108:111], v[236:239], v[204:207], a[108:111]
v_mfma_f32_16x16x32_bf16 a[112:115], v[236:239], v[208:211], a[112:115]
v_mfma_f32_16x16x32_bf16 a[116:119], v[236:239], v[212:215], a[116:119]
v_mfma_f32_16x16x32_bf16 a[120:123], v[236:239], v[216:219], a[120:123]
v_mfma_f32_16x16x32_bf16 a[124:127], v[236:239], v[220:223], a[124:127]
s_add_u32 s6, s6, s9
s_addc_u32 s7, s7, 0
s_waitcnt vmcnt(16)
s_barrier
v_mfma_f32_16x16x32_bf16 a[128:131], v[240:243], v[192:195], a[128:131]
ds_read_b64_tr_b16 v[160:161], v26 offset:0
v_mfma_f32_16x16x32_bf16 a[132:135], v[240:243], v[196:199], a[132:135]
s_add_u32 m0, s25, 98304
ds_read_b64_tr_b16 v[162:163], v26 offset:2048
v_mfma_f32_16x16x32_bf16 a[136:139], v[240:243], v[200:203], a[136:139]
global_load_lds_dwordx4 v2, s[4:5] sc1
ds_read_b128 v[128:131], v10 offset:0
v_mfma_f32_16x16x32_bf16 a[140:143], v[240:243], v[204:207], a[140:143]
ds_read_b128 v[132:135], v10 offset:1024
v_mfma_f32_16x16x32_bf16 a[144:147], v[240:243], v[208:211], a[144:147]
ds_read_b128 v[136:139], v10 offset:2048
v_mfma_f32_16x16x32_bf16 a[148:151], v[240:243], v[212:215], a[148:151]
ds_read_b128 v[140:143], v10 offset:3072
v_mfma_f32_16x16x32_bf16 a[152:155], v[240:243], v[216:219], a[152:155]
ds_read_b128 v[144:147], v10 offset:4096
v_mfma_f32_16x16x32_bf16 a[156:159], v[240:243], v[220:223], a[156:159]
ds_read_b128 v[148:151], v10 offset:5120
v_mfma_f32_16x16x32_bf16 a[160:163], v[244:247], v[192:195], a[160:163]
ds_read_b128 v[152:155], v10 offset:6144
v_mfma_f32_16x16x32_bf16 a[164:167], v[244:247], v[196:199], a[164:167]
s_add_u32 m0, s25, 99328
ds_read_b128 v[156:159], v10 offset:7168
v_mfma_f32_16x16x32_bf16 a[168:171], v[244:247], v[200:203], a[168:171]
global_load_lds_dwordx4 v3, s[4:5] sc1
ds_read_b64_tr_b16 v[164:165], v27 offset:0
v_mfma_f32_16x16x32_bf16 a[172:175], v[244:247], v[204:207], a[172:175]
ds_read_b64_tr_b16 v[166:167], v27 offset:2048
v_mfma_f32_16x16x32_bf16 a[176:179], v[244:247], v[208:211], a[176:179]
ds_read_b64_tr_b16 v[168:169], v28 offset:0
v_mfma_f32_16x16x32_bf16 a[180:183], v[244:247], v[212:215], a[180:183]
ds_read_b64_tr_b16 v[170:171], v28 offset:2048
v_mfma_f32_16x16x32_bf16 a[184:187], v[244:247], v[216:219], a[184:187]
ds_read_b64_tr_b16 v[172:173], v29 offset:0
v_mfma_f32_16x16x32_bf16 a[188:191], v[244:247], v[220:223], a[188:191]
ds_read_b64_tr_b16 v[174:175], v29 offset:2048
v_mfma_f32_16x16x32_bf16 a[192:195], v[248:251], v[192:195], a[192:195]
ds_read_b64_tr_b16 v[176:177], v30 offset:0
v_mfma_f32_16x16x32_bf16 a[196:199], v[248:251], v[196:199], a[196:199]
s_add_u32 m0, s25, 100352
ds_read_b64_tr_b16 v[178:179], v30 offset:2048
v_mfma_f32_16x16x32_bf16 a[200:203], v[248:251], v[200:203], a[200:203]
global_load_lds_dwordx4 v4, s[4:5] sc1
ds_read_b64_tr_b16 v[180:181], v31 offset:0
v_mfma_f32_16x16x32_bf16 a[204:207], v[248:251], v[204:207], a[204:207]
ds_read_b64_tr_b16 v[182:183], v31 offset:2048
v_mfma_f32_16x16x32_bf16 a[208:211], v[248:251], v[208:211], a[208:211]
ds_read_b64_tr_b16 v[184:185], v32 offset:0
v_mfma_f32_16x16x32_bf16 a[212:215], v[248:251], v[212:215], a[212:215]
ds_read_b64_tr_b16 v[186:187], v32 offset:2048
v_mfma_f32_16x16x32_bf16 a[216:219], v[248:251], v[216:219], a[216:219]
ds_read_b64_tr_b16 v[188:189], v33 offset:0
v_mfma_f32_16x16x32_bf16 a[220:223], v[248:251], v[220:223], a[220:223]
ds_read_b64_tr_b16 v[190:191], v33 offset:2048
v_mfma_f32_16x16x32_bf16 a[224:227], v[252:255], v[192:195], a[224:227]
v_mfma_f32_16x16x32_bf16 a[228:231], v[252:255], v[196:199], a[228:231]
s_add_u32 m0, s25, 101376
v_mfma_f32_16x16x32_bf16 a[232:235], v[252:255], v[200:203], a[232:235]
global_load_lds_dwordx4 v5, s[4:5] sc1
v_mfma_f32_16x16x32_bf16 a[236:239], v[252:255], v[204:207], a[236:239]
v_mfma_f32_16x16x32_bf16 a[240:243], v[252:255], v[208:211], a[240:243]
v_mfma_f32_16x16x32_bf16 a[244:247], v[252:255], v[212:215], a[244:247]
v_mfma_f32_16x16x32_bf16 a[248:251], v[252:255], v[216:219], a[248:251]
v_mfma_f32_16x16x32_bf16 a[252:255], v[252:255], v[220:223], a[252:255]
s_add_u32 s4, s4, s8
s_addc_u32 s5, s5, 0
s_sub_u32 s11, s11, 1
s_cmp_eq_u32 s11, 0
s_cbranch_scc1 M_gle_75
s_waitcnt lgkmcnt(0)
v_mfma_f32_16x16x32_bf16 a[0:3], v[160:163], v[128:131], a[0:3]
v_mfma_f32_16x16x32_bf16 a[4:7], v[160:163], v[132:135], a[4:7]
s_add_u32 m0, s26, 98304
v_mfma_f32_16x16x32_bf16 a[8:11], v[160:163], v[136:139], a[8:11]
global_load_lds_dwordx4 v6, s[6:7]
v_mfma_f32_16x16x32_bf16 a[12:15], v[160:163], v[140:143], a[12:15]
v_mfma_f32_16x16x32_bf16 a[16:19], v[160:163], v[144:147], a[16:19]
v_mfma_f32_16x16x32_bf16 a[20:23], v[160:163], v[148:151], a[20:23]
v_mfma_f32_16x16x32_bf16 a[24:27], v[160:163], v[152:155], a[24:27]
v_mfma_f32_16x16x32_bf16 a[28:31], v[160:163], v[156:159], a[28:31]
v_mfma_f32_16x16x32_bf16 a[32:35], v[164:167], v[128:131], a[32:35]
v_mfma_f32_16x16x32_bf16 a[36:39], v[164:167], v[132:135], a[36:39]
s_add_u32 m0, s26, 99328
v_mfma_f32_16x16x32_bf16 a[40:43], v[164:167], v[136:139], a[40:43]
global_load_lds_dwordx4 v7, s[6:7]
v_mfma_f32_16x16x32_bf16 a[44:47], v[164:167], v[140:143], a[44:47]
v_mfma_f32_16x16x32_bf16 a[48:51], v[164:167], v[144:147], a[48:51]
v_mfma_f32_16x16x32_bf16 a[52:55], v[164:167], v[148:151], a[52:55]
v_mfma_f32_16x16x32_bf16 a[56:59], v[164:167], v[152:155], a[56:59]
v_mfma_f32_16x16x32_bf16 a[60:63], v[164:167], v[156:159], a[60:63]
v_mfma_f32_16x16x32_bf16 a[64:67], v[168:171], v[128:131], a[64:67]
v_mfma_f32_16x16x32_bf16 a[68:71], v[168:171], v[132:135], a[68:71]
s_add_u32 m0, s26, 100352
v_mfma_f32_16x16x32_bf16 a[72:75], v[168:171], v[136:139], a[72:75]
global_load_lds_dwordx4 v8, s[6:7]
v_mfma_f32_16x16x32_bf16 a[76:79], v[168:171], v[140:143], a[76:79]
v_mfma_f32_16x16x32_bf16 a[80:83], v[168:171], v[144:147], a[80:83]
v_mfma_f32_16x16x32_bf16 a[84:87], v[168:171], v[148:151], a[84:87]
v_mfma_f32_16x16x32_bf16 a[88:91], v[168:171], v[152:155], a[88:91]
v_mfma_f32_16x16x32_bf16 a[92:95], v[168:171], v[156:159], a[92:95]
v_mfma_f32_16x16x32_bf16 a[96:99], v[172:175], v[128:131], a[96:99]
v_mfma_f32_16x16x32_bf16 a[100:103], v[172:175], v[132:135], a[100:103]
s_add_u32 m0, s26, 101376
v_mfma_f32_16x16x32_bf16 a[104:107], v[172:175], v[136:139], a[104:107]
global_load_lds_dwordx4 v9, s[6:7]
v_mfma_f32_16x16x32_bf16 a[108:111], v[172:175], v[140:143], a[108:111]
v_mfma_f32_16x16x32_bf16 a[112:115], v[172:175], v[144:147], a[112:115]
v_mfma_f32_16x16x32_bf16 a[116:119], v[172:175], v[148:151], a[116:119]
v_mfma_f32_16x16x32_bf16 a[120:123], v[172:175], v[152:155], a[120:123]
v_mfma_f32_16x16x32_bf16 a[124:127], v[172:175], v[156:159], a[124:127]
s_add_u32 s6, s6, s9
s_addc_u32 s7, s7, 0
s_waitcnt vmcnt(16)
s_barrier
v_mfma_f32_16x16x32_bf16 a[128:131], v[176:179], v[128:131], a[128:131]
ds_read_b64_tr_b16 v[224:225], v26 offset:32768
v_mfma_f32_16x16x32_bf16 a[132:135], v[176:179], v[132:135], a[132:135]
s_add_u32 m0, s25, 0
ds_read_b64_tr_b16 v[226:227], v26 offset:34816
v_mfma_f32_16x16x32_bf16 a[136:139], v[176:179], v[136:139], a[136:139]
global_load_lds_dwordx4 v2, s[4:5] sc1
ds_read_b128 v[192:195], v10 offset:32768
v_mfma_f32_16x16x32_bf16 a[140:143], v[176:179], v[140:143], a[140:143]
ds_read_b128 v[196:199], v10 offset:33792
v_mfma_f32_16x16x32_bf16 a[144:147], v[176:179], v[144:147], a[144:147]
ds_read_b128 v[200:203], v10 offset:34816
v_mfma_f32_16x16x32_bf16 a[148:151], v[176:179], v[148:151], a[148:151]
ds_read_b128 v[204:207], v10 offset:35840
v_mfma_f32_16x16x32_bf16 a[152:155], v[176:179], v[152:155], a[152:155]
ds_read_b128 v[208:211], v10 offset:36864
v_mfma_f32_16x16x32_bf16 a[156:159], v[176:179], v[156:159], a[156:159]
ds_read_b128 v[212:215], v10 offset:37888
v_mfma_f32_16x16x32_bf16 a[160:163], v[180:183], v[128:131], a[160:163]
ds_read_b128 v[216:219], v10 offset:38912
v_mfma_f32_16x16x32_bf16 a[164:167], v[180:183], v[132:135], a[164:167]
s_add_u32 m0, s25, 1024
ds_read_b128 v[220:223], v10 offset:39936
v_mfma_f32_16x16x32_bf16 a[168:171], v[180:183], v[136:139], a[168:171]
global_load_lds_dwordx4 v3, s[4:5] sc1
ds_read_b64_tr_b16 v[228:229], v27 offset:32768
v_mfma_f32_16x16x32_bf16 a[172:175], v[180:183], v[140:143], a[172:175]
ds_read_b64_tr_b16 v[230:231], v27 offset:34816
v_mfma_f32_16x16x32_bf16 a[176:179], v[180:183], v[144:147], a[176:179]
ds_read_b64_tr_b16 v[232:233], v28 offset:32768
v_mfma_f32_16x16x32_bf16 a[180:183], v[180:183], v[148:151], a[180:183]
ds_read_b64_tr_b16 v[234:235], v28 offset:34816
v_mfma_f32_16x16x32_bf16 a[184:187], v[180:183], v[152:155], a[184:187]
ds_read_b64_tr_b16 v[236:237], v29 offset:32768
v_mfma_f32_16x16x32_bf16 a[188:191], v[180:183], v[156:159], a[188:191]
ds_read_b64_tr_b16 v[238:239], v29 offset:34816
v_mfma_f32_16x16x32_bf16 a[192:195], v[184:187], v[128:131], a[192:195]
ds_read_b64_tr_b16 v[240:241], v30 offset:32768
v_mfma_f32_16x16x32_bf16 a[196:199], v[184:187], v[132:135], a[196:199]
s_add_u32 m0, s25, 2048
ds_read_b64_tr_b16 v[242:243], v30 offset:34816
v_mfma_f32_16x16x32_bf16 a[200:203], v[184:187], v[136:139], a[200:203]
global_load_lds_dwordx4 v4, s[4:5] sc1
ds_read_b64_tr_b16 v[244:245], v31 offset:32768
v_mfma_f32_16x16x32_bf16 a[204:207], v[184:187], v[140:143], a[204:207]
ds_read_b64_tr_b16 v[246:247], v31 offset:34816
v_mfma_f32_16x16x32_bf16 a[208:211], v[184:187], v[144:147], a[208:211]
ds_read_b64_tr_b16 v[248:249], v32 offset:32768
v_mfma_f32_16x16x32_bf16 a[212:215], v[184:187], v[148:151], a[212:215]
ds_read_b64_tr_b16 v[250:251], v32 offset:34816
v_mfma_f32_16x16x32_bf16 a[216:219], v[184:187], v[152:155], a[216:219]
ds_read_b64_tr_b16 v[252:253], v33 offset:32768
v_mfma_f32_16x16x32_bf16 a[220:223], v[184:187], v[156:159], a[220:223]
ds_read_b64_tr_b16 v[254:255], v33 offset:34816
v_mfma_f32_16x16x32_bf16 a[224:227], v[188:191], v[128:131], a[224:227]
v_mfma_f32_16x16x32_bf16 a[228:231], v[188:191], v[132:135], a[228:231]
s_add_u32 m0, s25, 3072
v_mfma_f32_16x16x32_bf16 a[232:235], v[188:191], v[136:139], a[232:235]
global_load_lds_dwordx4 v5, s[4:5] sc1
v_mfma_f32_16x16x32_bf16 a[236:239], v[188:191], v[140:143], a[236:239]
v_mfma_f32_16x16x32_bf16 a[240:243], v[188:191], v[144:147], a[240:243]
v_mfma_f32_16x16x32_bf16 a[244:247], v[188:191], v[148:151], a[244:247]
v_mfma_f32_16x16x32_bf16 a[248:251], v[188:191], v[152:155], a[248:251]
v_mfma_f32_16x16x32_bf16 a[252:255], v[188:191], v[156:159], a[252:255]
s_add_u32 s4, s4, s8
s_addc_u32 s5, s5, 0
s_branch M_gl_74
M_gle_75:
s_waitcnt lgkmcnt(0)
v_mfma_f32_16x16x32_bf16 a[0:3], v[160:163], v[128:131], a[0:3]
v_mfma_f32_16x16x32_bf16 a[4:7], v[160:163], v[132:135], a[4:7]
s_add_u32 m0, s26, 98304
v_mfma_f32_16x16x32_bf16 a[8:11], v[160:163], v[136:139], a[8:11]
global_load_lds_dwordx4 v6, s[6:7]
v_mfma_f32_16x16x32_bf16 a[12:15], v[160:163], v[140:143], a[12:15]
v_mfma_f32_16x16x32_bf16 a[16:19], v[160:163], v[144:147], a[16:19]
v_mfma_f32_16x16x32_bf16 a[20:23], v[160:163], v[148:151], a[20:23]
v_mfma_f32_16x16x32_bf16 a[24:27], v[160:163], v[152:155], a[24:27]
v_mfma_f32_16x16x32_bf16 a[28:31], v[160:163], v[156:159], a[28:31]
v_mfma_f32_16x16x32_bf16 a[32:35], v[164:167], v[128:131], a[32:35]
v_mfma_f32_16x16x32_bf16 a[36:39], v[164:167], v[132:135], a[36:39]
s_add_u32 m0, s26, 99328
v_mfma_f32_16x16x32_bf16 a[40:43], v[164:167], v[136:139], a[40:43]
global_load_lds_dwordx4 v7, s[6:7]
v_mfma_f32_16x16x32_bf16 a[44:47], v[164:167], v[140:143], a[44:47]
v_mfma_f32_16x16x32_bf16 a[48:51], v[164:167], v[144:147], a[48:51]
v_mfma_f32_16x16x32_bf16 a[52:55], v[164:167], v[148:151], a[52:55]
v_mfma_f32_16x16x32_bf16 a[56:59], v[164:167], v[152:155], a[56:59]
v_mfma_f32_16x16x32_bf16 a[60:63], v[164:167], v[156:159], a[60:63]
v_mfma_f32_16x16x32_bf16 a[64:67], v[168:171], v[128:131], a[64:67]
v_mfma_f32_16x16x32_bf16 a[68:71], v[168:171], v[132:135], a[68:71]
s_add_u32 m0, s26, 100352
v_mfma_f32_16x16x32_bf16 a[72:75], v[168:171], v[136:139], a[72:75]
global_load_lds_dwordx4 v8, s[6:7]
v_mfma_f32_16x16x32_bf16 a[76:79], v[168:171], v[140:143], a[76:79]
v_mfma_f32_16x16x32_bf16 a[80:83], v[168:171], v[144:147], a[80:83]
v_mfma_f32_16x16x32_bf16 a[84:87], v[168:171], v[148:151], a[84:87]
v_mfma_f32_16x16x32_bf16 a[88:91], v[168:171], v[152:155], a[88:91]
v_mfma_f32_16x16x32_bf16 a[92:95], v[168:171], v[156:159], a[92:95]
v_mfma_f32_16x16x32_bf16 a[96:99], v[172:175], v[128:131], a[96:99]
v_mfma_f32_16x16x32_bf16 a[100:103], v[172:175], v[132:135], a[100:103]
s_add_u32 m0, s26, 101376
v_mfma_f32_16x16x32_bf16 a[104:107], v[172:175], v[136:139], a[104:107]
global_load_lds_dwordx4 v9, s[6:7]
v_mfma_f32_16x16x32_bf16 a[108:111], v[172:175], v[140:143], a[108:111]
v_mfma_f32_16x16x32_bf16 a[112:115], v[172:175], v[144:147], a[112:115]
v_mfma_f32_16x16x32_bf16 a[116:119], v[172:175], v[148:151], a[116:119]
v_mfma_f32_16x16x32_bf16 a[120:123], v[172:175], v[152:155], a[120:123]
v_mfma_f32_16x16x32_bf16 a[124:127], v[172:175], v[156:159], a[124:127]
s_add_u32 s6, s6, s9
s_addc_u32 s7, s7, 0
s_waitcnt vmcnt(16)
s_barrier
v_mfma_f32_16x16x32_bf16 a[128:131], v[176:179], v[128:131], a[128:131]
ds_read_b64_tr_b16 v[224:225], v26 offset:32768
v_mfma_f32_16x16x32_bf16 a[132:135], v[176:179], v[132:135], a[132:135]
ds_read_b64_tr_b16 v[226:227], v26 offset:34816
v_mfma_f32_16x16x32_bf16 a[136:139], v[176:179], v[136:139], a[136:139]
ds_read_b128 v[192:195], v10 offset:32768
v_mfma_f32_16x16x32_bf16 a[140:143], v[176:179], v[140:143], a[140:143]
ds_read_b128 v[196:199], v10 offset:33792
v_mfma_f32_16x16x32_bf16 a[144:147], v[176:179], v[144:147], a[144:147]
ds_read_b128 v[200:203], v10 offset:34816
v_mfma_f32_16x16x32_bf16 a[148:151], v[176:179], v[148:151], a[148:151]
ds_read_b128 v[204:207], v10 offset:35840
v_mfma_f32_16x16x32_bf16 a[152:155], v[176:179], v[152:155], a[152:155]
ds_read_b128 v[208:211], v10 offset:36864
v_mfma_f32_16x16x32_bf16 a[156:159], v[176:179], v[156:159], a[156:159]
ds_read_b128 v[212:215], v10 offset:37888
v_mfma_f32_16x16x32_bf16 a[160:163], v[180:183], v[128:131], a[160:163]
ds_read_b128 v[216:219], v10 offset:38912
v_mfma_f32_16x16x32_bf16 a[164:167], v[180:183], v[132:135], a[164:167]
ds_read_b128 v[220:223], v10 offset:39936
v_mfma_f32_16x16x32_bf16 a[168:171], v[180:183], v[136:139], a[168:171]
ds_read_b64_tr_b16 v[228:229], v27 offset:32768
v_mfma_f32_16x16x32_bf16 a[172:175], v[180:183], v[140:143], a[172:175]
ds_read_b64_tr_b16 v[230:231], v27 offset:34816
v_mfma_f32_16x16x32_bf16 a[176:179], v[180:183], v[144:147], a[176:179]
ds_read_b64_tr_b16 v[232:233], v28 offset:32768
v_mfma_f32_16x16x32_bf16 a[180:183], v[180:183], v[148:151], a[180:183]
ds_read_b64_tr_b16 v[234:235], v28 offset:34816
v_mfma_f32_16x16x32_bf16 a[184:187], v[180:183], v[152:155], a[184:187]
ds_read_b64_tr_b16 v[236:237], v29 offset:32768
v_mfma_f32_16x16x32_bf16 a[188:191], v[180:183], v[156:159], a[188:191]
ds_read_b64_tr_b16 v[238:239], v29 offset:34816
v_mfma_f32_16x16x32_bf16 a[192:195], v[184:187], v[128:131], a[192:195]
ds_read_b64_tr_b16 v[240:241], v30 offset:32768
v_mfma_f32_16x16x32_bf16 a[196:199], v[184:187], v[132:135], a[196:199]
ds_read_b64_tr_b16 v[242:243], v30 offset:34816
v_mfma_f32_16x16x32_bf16 a[200:203], v[184:187], v[136:139], a[200:203]
ds_read_b64_tr_b16 v[244:245], v31 offset:32768
v_mfma_f32_16x16x32_bf16 a[204:207], v[184:187], v[140:143], a[204:207]
ds_read_b64_tr_b16 v[246:247], v31 offset:34816
v_mfma_f32_16x16x32_bf16 a[208:211], v[184:187], v[144:147], a[208:211]
ds_read_b64_tr_b16 v[248:249], v32 offset:32768
v_mfma_f32_16x16x32_bf16 a[212:215], v[184:187], v[148:151], a[212:215]
ds_read_b64_tr_b16 v[250:251], v32 offset:34816
v_mfma_f32_16x16x32_bf16 a[216:219], v[184:187], v[152:155], a[216:219]
ds_read_b64_tr_b16 v[252:253], v33 offset:32768
v_mfma_f32_16x16x32_bf16 a[220:223], v[184:187], v[156:159], a[220:223]
ds_read_b64_tr_b16 v[254:255], v33 offset:34816
v_mfma_f32_16x16x32_bf16 a[224:227], v[188:191], v[128:131], a[224:227]
v_mfma_f32_16x16x32_bf16 a[228:231], v[188:191], v[132:135], a[228:231]
v_mfma_f32_16x16x32_bf16 a[232:235], v[188:191], v[136:139], a[232:235]
v_mfma_f32_16x16x32_bf16 a[236:239], v[188:191], v[140:143], a[236:239]
v_mfma_f32_16x16x32_bf16 a[240:243], v[188:191], v[144:147], a[240:243]
v_mfma_f32_16x16x32_bf16 a[244:247], v[188:191], v[148:151], a[244:247]
v_mfma_f32_16x16x32_bf16 a[248:251], v[188:191], v[152:155], a[248:251]
v_mfma_f32_16x16x32_bf16 a[252:255], v[188:191], v[156:159], a[252:255]
s_waitcnt lgkmcnt(0)
v_mfma_f32_16x16x32_bf16 a[0:3], v[224:227], v[192:195], a[0:3]
v_mfma_f32_16x16x32_bf16 a[4:7], v[224:227], v[196:199], a[4:7]
v_mfma_f32_16x16x32_bf16 a[8:11], v[224:227], v[200:203], a[8:11]
v_mfma_f32_16x16x32_bf16 a[12:15], v[224:227], v[204:207], a[12:15]
v_mfma_f32_16x16x32_bf16 a[16:19], v[224:227], v[208:211], a[16:19]
v_mfma_f32_16x16x32_bf16 a[20:23], v[224:227], v[212:215], a[20:23]
v_mfma_f32_16x16x32_bf16 a[24:27], v[224:227], v[216:219], a[24:27]
v_mfma_f32_16x16x32_bf16 a[28:31], v[224:227], v[220:223], a[28:31]
v_mfma_f32_16x16x32_bf16 a[32:35], v[228:231], v[192:195], a[32:35]
v_mfma_f32_16x16x32_bf16 a[36:39], v[228:231], v[196:199], a[36:39]
v_mfma_f32_16x16x32_bf16 a[40:43], v[228:231], v[200:203], a[40:43]
v_mfma_f32_16x16x32_bf16 a[44:47], v[228:231], v[204:207], a[44:47]
v_mfma_f32_16x16x32_bf16 a[48:51], v[228:231], v[208:211], a[48:51]
v_mfma_f32_16x16x32_bf16 a[52:55], v[228:231], v[212:215], a[52:55]
v_mfma_f32_16x16x32_bf16 a[56:59], v[228:231], v[216:219], a[56:59]
v_mfma_f32_16x16x32_bf16 a[60:63], v[228:231], v[220:223], a[60:63]
v_mfma_f32_16x16x32_bf16 a[64:67], v[232:235], v[192:195], a[64:67]
v_mfma_f32_16x16x32_bf16 a[68:71], v[232:235], v[196:199], a[68:71]
v_mfma_f32_16x16x32_bf16 a[72:75], v[232:235], v[200:203], a[72:75]
v_mfma_f32_16x16x32_bf16 a[76:79], v[232:235], v[204:207], a[76:79]
v_mfma_f32_16x16x32_bf16 a[80:83], v[232:235], v[208:211], a[80:83]
v_mfma_f32_16x16x32_bf16 a[84:87], v[232:235], v[212:215], a[84:87]
v_mfma_f32_16x16x32_bf16 a[88:91], v[232:235], v[216:219], a[88:91]
v_mfma_f32_16x16x32_bf16 a[92:95], v[232:235], v[220:223], a[92:95]
v_mfma_f32_16x16x32_bf16 a[96:99], v[236:239], v[192:195], a[96:99]
v_mfma_f32_16x16x32_bf16 a[100:103], v[236:239], v[196:199], a[100:103]
v_mfma_f32_16x16x32_bf16 a[104:107], v[236:239], v[200:203], a[104:107]
v_mfma_f32_16x16x32_bf16 a[108:111], v[236:239], v[204:207], a[108:111]
v_mfma_f32_16x16x32_bf16 a[112:115], v[236:239], v[208:211], a[112:115]
v_mfma_f32_16x16x32_bf16 a[116:119], v[236:239], v[212:215], a[116:119]
v_mfma_f32_16x16x32_bf16 a[120:123], v[236:239], v[216:219], a[120:123]
v_mfma_f32_16x16x32_bf16 a[124:127], v[236:239], v[220:223], a[124:127]
s_waitcnt vmcnt(8)
s_barrier
v_mfma_f32_16x16x32_bf16 a[128:131], v[240:243], v[192:195], a[128:131]
ds_read_b64_tr_b16 v[160:161], v34 offset:0
v_mfma_f32_16x16x32_bf16 a[132:135], v[240:243], v[196:199], a[132:135]
ds_read_b64_tr_b16 v[162:163], v34 offset:2048
v_mfma_f32_16x16x32_bf16 a[136:139], v[240:243], v[200:203], a[136:139]
ds_read_b128 v[128:131], v11 offset:0
v_mfma_f32_16x16x32_bf16 a[140:143], v[240:243], v[204:207], a[140:143]
ds_read_b128 v[132:135], v11 offset:1024
v_mfma_f32_16x16x32_bf16 a[144:147], v[240:243], v[208:211], a[144:147]
ds_read_b128 v[136:139], v11 offset:2048
v_mfma_f32_16x16x32_bf16 a[148:151], v[240:243], v[212:215], a[148:151]
ds_read_b128 v[140:143], v11 offset:3072
v_mfma_f32_16x16x32_bf16 a[152:155], v[240:243], v[216:219], a[152:155]
ds_read_b128 v[144:147], v11 offset:4096
v_mfma_f32_16x16x32_bf16 a[156:159], v[240:243], v[220:223], a[156:159]
ds_read_b128 v[148:151], v11 offset:5120
v_mfma_f32_16x16x32_bf16 a[160:163], v[244:247], v[192:195], a[160:163]
ds_read_b128 v[152:155], v11 offset:6144
v_mfma_f32_16x16x32_bf16 a[164:167], v[244:247], v[196:199], a[164:167]
ds_read_b128 v[156:159], v11 offset:7168
v_mfma_f32_16x16x32_bf16 a[168:171], v[244:247], v[200:203], a[168:171]
ds_read_b64_tr_b16 v[164:165], v35 offset:0
v_mfma_f32_16x16x32_bf16 a[172:175], v[244:247], v[204:207], a[172:175]
ds_read_b64_tr_b16 v[166:167], v35 offset:2048
v_mfma_f32_16x16x32_bf16 a[176:179], v[244:247], v[208:211], a[176:179]
ds_read_b64_tr_b16 v[168:169], v36 offset:0
v_mfma_f32_16x16x32_bf16 a[180:183], v[244:247], v[212:215], a[180:183]
ds_read_b64_tr_b16 v[170:171], v36 offset:2048
v_mfma_f32_16x16x32_bf16 a[184:187], v[244:247], v[216:219], a[184:187]
ds_read_b64_tr_b16 v[172:173], v37 offset:0
v_mfma_f32_16x16x32_bf16 a[188:191], v[244:247], v[220:223], a[188:191]
ds_read_b64_tr_b16 v[174:175], v37 offset:2048
v_mfma_f32_16x16x32_bf16 a[192:195], v[248:251], v[192:195], a[192:195]
ds_read_b64_tr_b16 v[176:177], v38 offset:0
v_mfma_f32_16x16x32_bf16 a[196:199], v[248:251], v[196:199], a[196:199]
ds_read_b64_tr_b16 v[178:179], v38 offset:2048
v_mfma_f32_16x16x32_bf16 a[200:203], v[248:251], v[200:203], a[200:203]
ds_read_b64_tr_b16 v[180:181], v39 offset:0
v_mfma_f32_16x16x32_bf16 a[204:207], v[248:251], v[204:207], a[204:207]
ds_read_b64_tr_b16 v[182:183], v39 offset:2048
v_mfma_f32_16x16x32_bf16 a[208:211], v[248:251], v[208:211], a[208:211]
ds_read_b64_tr_b16 v[184:185], v40 offset:0
v_mfma_f32_16x16x32_bf16 a[212:215], v[248:251], v[212:215], a[212:215]
ds_read_b64_tr_b16 v[186:187], v40 offset:2048
v_mfma_f32_16x16x32_bf16 a[216:219], v[248:251], v[216:219], a[216:219]
ds_read_b64_tr_b16 v[188:189], v41 offset:0
v_mfma_f32_16x16x32_bf16 a[220:223], v[248:251], v[220:223], a[220:223]
ds_read_b64_tr_b16 v[190:191], v41 offset:2048
v_mfma_f32_16x16x32_bf16 a[224:227], v[252:255], v[192:195], a[224:227]
v_mfma_f32_16x16x32_bf16 a[228:231], v[252:255], v[196:199], a[228:231]
v_mfma_f32_16x16x32_bf16 a[232:235], v[252:255], v[200:203], a[232:235]
v_mfma_f32_16x16x32_bf16 a[236:239], v[252:255], v[204:207], a[236:239]
v_mfma_f32_16x16x32_bf16 a[240:243], v[252:255], v[208:211], a[240:243]
v_mfma_f32_16x16x32_bf16 a[244:247], v[252:255], v[212:215], a[244:247]
v_mfma_f32_16x16x32_bf16 a[248:251], v[252:255], v[216:219], a[248:251]
v_mfma_f32_16x16x32_bf16 a[252:255], v[252:255], v[220:223], a[252:255]
s_waitcnt lgkmcnt(0)
v_mfma_f32_16x16x32_bf16 a[0:3], v[160:163], v[128:131], a[0:3]
v_mfma_f32_16x16x32_bf16 a[4:7], v[160:163], v[132:135], a[4:7]
v_mfma_f32_16x16x32_bf16 a[8:11], v[160:163], v[136:139], a[8:11]
v_mfma_f32_16x16x32_bf16 a[12:15], v[160:163], v[140:143], a[12:15]
v_mfma_f32_16x16x32_bf16 a[16:19], v[160:163], v[144:147], a[16:19]
v_mfma_f32_16x16x32_bf16 a[20:23], v[160:163], v[148:151], a[20:23]
v_mfma_f32_16x16x32_bf16 a[24:27], v[160:163], v[152:155], a[24:27]
v_mfma_f32_16x16x32_bf16 a[28:31], v[160:163], v[156:159], a[28:31]
v_mfma_f32_16x16x32_bf16 a[32:35], v[164:167], v[128:131], a[32:35]
v_mfma_f32_16x16x32_bf16 a[36:39], v[164:167], v[132:135], a[36:39]
v_mfma_f32_16x16x32_bf16 a[40:43], v[164:167], v[136:139], a[40:43]
v_mfma_f32_16x16x32_bf16 a[44:47], v[164:167], v[140:143], a[44:47]
v_mfma_f32_16x16x32_bf16 a[48:51], v[164:167], v[144:147], a[48:51]
v_mfma_f32_16x16x32_bf16 a[52:55], v[164:167], v[148:151], a[52:55]
v_mfma_f32_16x16x32_bf16 a[56:59], v[164:167], v[152:155], a[56:59]
v_mfma_f32_16x16x32_bf16 a[60:63], v[164:167], v[156:159], a[60:63]
v_mfma_f32_16x16x32_bf16 a[64:67], v[168:171], v[128:131], a[64:67]
v_mfma_f32_16x16x32_bf16 a[68:71], v[168:171], v[132:135], a[68:71]
v_mfma_f32_16x16x32_bf16 a[72:75], v[168:171], v[136:139], a[72:75]
v_mfma_f32_16x16x32_bf16 a[76:79], v[168:171], v[140:143], a[76:79]
v_mfma_f32_16x16x32_bf16 a[80:83], v[168:171], v[144:147], a[80:83]
v_mfma_f32_16x16x32_bf16 a[84:87], v[168:171], v[148:151], a[84:87]
v_mfma_f32_16x16x32_bf16 a[88:91], v[168:171], v[152:155], a[88:91]
v_mfma_f32_16x16x32_bf16 a[92:95], v[168:171], v[156:159], a[92:95]
v_mfma_f32_16x16x32_bf16 a[96:99], v[172:175], v[128:131], a[96:99]
v_mfma_f32_16x16x32_bf16 a[100:103], v[172:175], v[132:135], a[100:103]
v_mfma_f32_16x16x32_bf16 a[104:107], v[172:175], v[136:139], a[104:107]
v_mfma_f32_16x16x32_bf16 a[108:111], v[172:175], v[140:143], a[108:111]
v_mfma_f32_16x16x32_bf16 a[112:115], v[172:175], v[144:147], a[112:115]
v_mfma_f32_16x16x32_bf16 a[116:119], v[172:175], v[148:151], a[116:119]
v_mfma_f32_16x16x32_bf16 a[120:123], v[172:175], v[152:155], a[120:123]
v_mfma_f32_16x16x32_bf16 a[124:127], v[172:175], v[156:159], a[124:127]
s_waitcnt vmcnt(0)
s_barrier
v_mfma_f32_16x16x32_bf16 a[128:131], v[176:179], v[128:131], a[128:131]
ds_read_b64_tr_b16 v[224:225], v34 offset:32768
v_mfma_f32_16x16x32_bf16 a[132:135], v[176:179], v[132:135], a[132:135]
ds_read_b64_tr_b16 v[226:227], v34 offset:34816
v_mfma_f32_16x16x32_bf16 a[136:139], v[176:179], v[136:139], a[136:139]
ds_read_b128 v[192:195], v11 offset:32768
v_mfma_f32_16x16x32_bf16 a[140:143], v[176:179], v[140:143], a[140:143]
ds_read_b128 v[196:199], v11 offset:33792
v_mfma_f32_16x16x32_bf16 a[144:147], v[176:179], v[144:147], a[144:147]
ds_read_b128 v[200:203], v11 offset:34816
v_mfma_f32_16x16x32_bf16 a[148:151], v[176:179], v[148:151], a[148:151]
ds_read_b128 v[204:207], v11 offset:35840
v_mfma_f32_16x16x32_bf16 a[152:155], v[176:179], v[152:155], a[152:155]
ds_read_b128 v[208:211], v11 offset:36864
v_mfma_f32_16x16x32_bf16 a[156:159], v[176:179], v[156:159], a[156:159]
ds_read_b128 v[212:215], v11 offset:37888
v_mfma_f32_16x16x32_bf16 a[160:163], v[180:183], v[128:131], a[160:163]
ds_read_b128 v[216:219], v11 offset:38912
v_mfma_f32_16x16x32_bf16 a[164:167], v[180:183], v[132:135], a[164:167]
ds_read_b128 v[220:223], v11 offset:39936
v_mfma_f32_16x16x32_bf16 a[168:171], v[180:183], v[136:139], a[168:171]
ds_read_b64_tr_b16 v[228:229], v35 offset:32768
v_mfma_f32_16x16x32_bf16 a[172:175], v[180:183], v[140:143], a[172:175]
ds_read_b64_tr_b16 v[230:231], v35 offset:34816
v_mfma_f32_16x16x32_bf16 a[176:179], v[180:183], v[144:147], a[176:179]
ds_read_b64_tr_b16 v[232:233], v36 offset:32768
v_mfma_f32_16x16x32_bf16 a[180:183], v[180:183], v[148:151], a[180:183]
ds_read_b64_tr_b16 v[234:235], v36 offset:34816
v_mfma_f32_16x16x32_bf16 a[184:187], v[180:183], v[152:155], a[184:187]
ds_read_b64_tr_b16 v[236:237], v37 offset:32768
v_mfma_f32_16x16x32_bf16 a[188:191], v[180:183], v[156:159], a[188:191]
ds_read_b64_tr_b16 v[238:239], v37 offset:34816
v_mfma_f32_16x16x32_bf16 a[192:195], v[184:187], v[128:131], a[192:195]
ds_read_b64_tr_b16 v[240:241], v38 offset:32768
v_mfma_f32_16x16x32_bf16 a[196:199], v[184:187], v[132:135], a[196:199]
ds_read_b64_tr_b16 v[242:243], v38 offset:34816
v_mfma_f32_16x16x32_bf16 a[200:203], v[184:187], v[136:139], a[200:203]
ds_read_b64_tr_b16 v[244:245], v39 offset:32768
v_mfma_f32_16x16x32_bf16 a[204:207], v[184:187], v[140:143], a[204:207]
ds_read_b64_tr_b16 v[246:247], v39 offset:34816
v_mfma_f32_16x16x32_bf16 a[208:211], v[184:187], v[144:147], a[208:211]
ds_read_b64_tr_b16 v[248:249], v40 offset:32768
v_mfma_f32_16x16x32_bf16 a[212:215], v[184:187], v[148:151], a[212:215]
ds_read_b64_tr_b16 v[250:251], v40 offset:34816
v_mfma_f32_16x16x32_bf16 a[216:219], v[184:187], v[152:155], a[216:219]
ds_read_b64_tr_b16 v[252:253], v41 offset:32768
v_mfma_f32_16x16x32_bf16 a[220:223], v[184:187], v[156:159], a[220:223]
ds_read_b64_tr_b16 v[254:255], v41 offset:34816
v_mfma_f32_16x16x32_bf16 a[224:227], v[188:191], v[128:131], a[224:227]
v_mfma_f32_16x16x32_bf16 a[228:231], v[188:191], v[132:135], a[228:231]
v_mfma_f32_16x16x32_bf16 a[232:235], v[188:191], v[136:139], a[232:235]
v_mfma_f32_16x16x32_bf16 a[236:239], v[188:191], v[140:143], a[236:239]
v_mfma_f32_16x16x32_bf16 a[240:243], v[188:191], v[144:147], a[240:243]
v_mfma_f32_16x16x32_bf16 a[244:247], v[188:191], v[148:151], a[244:247]
v_mfma_f32_16x16x32_bf16 a[248:251], v[188:191], v[152:155], a[248:251]
v_mfma_f32_16x16x32_bf16 a[252:255], v[188:191], v[156:159], a[252:255]
s_waitcnt lgkmcnt(0)
v_mfma_f32_16x16x32_bf16 a[0:3], v[224:227], v[192:195], a[0:3]
v_mfma_f32_16x16x32_bf16 a[4:7], v[224:227], v[196:199], a[4:7]
v_mfma_f32_16x16x32_bf16 a[8:11], v[224:227], v[200:203], a[8:11]
v_mfma_f32_16x16x32_bf16 a[12:15], v[224:227], v[204:207], a[12:15]
v_mfma_f32_16x16x32_bf16 a[16:19], v[224:227], v[208:211], a[16:19]
v_mfma_f32_16x16x32_bf16 a[20:23], v[224:227], v[212:215], a[20:23]
v_mfma_f32_16x16x32_bf16 a[24:27], v[224:227], v[216:219], a[24:27]
v_mfma_f32_16x16x32_bf16 a[28:31], v[224:227], v[220:223], a[28:31]
v_mfma_f32_16x16x32_bf16 a[32:35], v[228:231], v[192:195], a[32:35]
v_mfma_f32_16x16x32_bf16 a[36:39], v[228:231], v[196:199], a[36:39]
v_mfma_f32_16x16x32_bf16 a[40:43], v[228:231], v[200:203], a[40:43]
v_mfma_f32_16x16x32_bf16 a[44:47], v[228:231], v[204:207], a[44:47]
v_mfma_f32_16x16x32_bf16 a[48:51], v[228:231], v[208:211], a[48:51]
v_mfma_f32_16x16x32_bf16 a[52:55], v[228:231], v[212:215], a[52:55]
v_mfma_f32_16x16x32_bf16 a[56:59], v[228:231], v[216:219], a[56:59]
v_mfma_f32_16x16x32_bf16 a[60:63], v[228:231], v[220:223], a[60:63]
v_mfma_f32_16x16x32_bf16 a[64:67], v[232:235], v[192:195], a[64:67]
v_mfma_f32_16x16x32_bf16 a[68:71], v[232:235], v[196:199], a[68:71]
v_mfma_f32_16x16x32_bf16 a[72:75], v[232:235], v[200:203], a[72:75]
v_mfma_f32_16x16x32_bf16 a[76:79], v[232:235], v[204:207], a[76:79]
v_mfma_f32_16x16x32_bf16 a[80:83], v[232:235], v[208:211], a[80:83]
v_mfma_f32_16x16x32_bf16 a[84:87], v[232:235], v[212:215], a[84:87]
v_mfma_f32_16x16x32_bf16 a[88:91], v[232:235], v[216:219], a[88:91]
v_mfma_f32_16x16x32_bf16 a[92:95], v[232:235], v[220:223], a[92:95]
v_mfma_f32_16x16x32_bf16 a[96:99], v[236:239], v[192:195], a[96:99]
v_mfma_f32_16x16x32_bf16 a[100:103], v[236:239], v[196:199], a[100:103]
v_mfma_f32_16x16x32_bf16 a[104:107], v[236:239], v[200:203], a[104:107]
v_mfma_f32_16x16x32_bf16 a[108:111], v[236:239], v[204:207], a[108:111]
v_mfma_f32_16x16x32_bf16 a[112:115], v[236:239], v[208:211], a[112:115]
v_mfma_f32_16x16x32_bf16 a[116:119], v[236:239], v[212:215], a[116:119]
v_mfma_f32_16x16x32_bf16 a[120:123], v[236:239], v[216:219], a[120:123]
v_mfma_f32_16x16x32_bf16 a[124:127], v[236:239], v[220:223], a[124:127]
v_mfma_f32_16x16x32_bf16 a[128:131], v[240:243], v[192:195], a[128:131]
v_mfma_f32_16x16x32_bf16 a[132:135], v[240:243], v[196:199], a[132:135]
v_mfma_f32_16x16x32_bf16 a[136:139], v[240:243], v[200:203], a[136:139]
v_mfma_f32_16x16x32_bf16 a[140:143], v[240:243], v[204:207], a[140:143]
v_mfma_f32_16x16x32_bf16 a[144:147], v[240:243], v[208:211], a[144:147]
v_mfma_f32_16x16x32_bf16 a[148:151], v[240:243], v[212:215], a[148:151]
v_mfma_f32_16x16x32_bf16 a[152:155], v[240:243], v[216:219], a[152:155]
v_mfma_f32_16x16x32_bf16 a[156:159], v[240:243], v[220:223], a[156:159]
v_mfma_f32_16x16x32_bf16 a[160:163], v[244:247], v[192:195], a[160:163]
v_mfma_f32_16x16x32_bf16 a[164:167], v[244:247], v[196:199], a[164:167]
v_mfma_f32_16x16x32_bf16 a[168:171], v[244:247], v[200:203], a[168:171]
v_mfma_f32_16x16x32_bf16 a[172:175], v[244:247], v[204:207], a[172:175]
v_mfma_f32_16x16x32_bf16 a[176:179], v[244:247], v[208:211], a[176:179]
v_mfma_f32_16x16x32_bf16 a[180:183], v[244:247], v[212:215], a[180:183]
v_mfma_f32_16x16x32_bf16 a[184:187], v[244:247], v[216:219], a[184:187]
v_mfma_f32_16x16x32_bf16 a[188:191], v[244:247], v[220:223], a[188:191]
v_mfma_f32_16x16x32_bf16 a[192:195], v[248:251], v[192:195], a[192:195]
v_mfma_f32_16x16x32_bf16 a[196:199], v[248:251], v[196:199], a[196:199]
v_mfma_f32_16x16x32_bf16 a[200:203], v[248:251], v[200:203], a[200:203]
v_mfma_f32_16x16x32_bf16 a[204:207], v[248:251], v[204:207], a[204:207]
v_mfma_f32_16x16x32_bf16 a[208:211], v[248:251], v[208:211], a[208:211]
v_mfma_f32_16x16x32_bf16 a[212:215], v[248:251], v[212:215], a[212:215]
v_mfma_f32_16x16x32_bf16 a[216:219], v[248:251], v[216:219], a[216:219]
v_mfma_f32_16x16x32_bf16 a[220:223], v[248:251], v[220:223], a[220:223]
v_mfma_f32_16x16x32_bf16 a[224:227], v[252:255], v[192:195], a[224:227]
v_mfma_f32_16x16x32_bf16 a[228:231], v[252:255], v[196:199], a[228:231]
v_mfma_f32_16x16x32_bf16 a[232:235], v[252:255], v[200:203], a[232:235]
v_mfma_f32_16x16x32_bf16 a[236:239], v[252:255], v[204:207], a[236:239]
v_mfma_f32_16x16x32_bf16 a[240:243], v[252:255], v[208:211], a[240:243]
v_mfma_f32_16x16x32_bf16 a[244:247], v[252:255], v[212:215], a[244:247]
v_mfma_f32_16x16x32_bf16 a[248:251], v[252:255], v[216:219], a[248:251]
v_mfma_f32_16x16x32_bf16 a[252:255], v[252:255], v[220:223], a[252:255]
v_and_b32 v42, 15, v1
v_lshrrev_b32 v43, 4, v1
v_and_b32 v44, 1, v43
v_lshlrev_b32 v44, 1, v44
v_lshrrev_b32 v45, 1, v43
v_add_u32 v44, v44, v45
v_lshl_add_u32 v45, v44, 4, v42
v_lshlrev_b32 v45, 4, v45
s_lshr_b32 s21, s20, 1
s_and_b32 s22, s20, 1
s_mul_i32 s21, s21, 1048576
s_lshl_b32 s22, s22, 13
s_add_u32 s21, s21, s22
v_add_u32 v56, s21, v45
v_add_u32 v57, 4096, v56
v_accvgpr_read_b32 v64, a0
v_accvgpr_read_b32 v65, a1
v_accvgpr_read_b32 v66, a2
v_accvgpr_read_b32 v67, a3
v_accvgpr_read_b32 v68, a32
v_accvgpr_read_b32 v69, a33
v_accvgpr_read_b32 v70, a34
v_accvgpr_read_b32 v71, a35
v_cvt_pk_bf16_f32 v80, v64, v65
v_cvt_pk_bf16_f32 v81, v66, v67
v_cvt_pk_bf16_f32 v82, v68, v69
v_cvt_pk_bf16_f32 v83, v70, v71
s_nop 0
v_permlane16_swap_b32 v80, v82
v_permlane16_swap_b32 v81, v83
global_store_dwordx4 v56, v[80:83], s[12:13] offset:0 sc1
v_accvgpr_read_b32 v72, a64
v_accvgpr_read_b32 v73, a65
v_accvgpr_read_b32 v74, a66
v_accvgpr_read_b32 v75, a67
v_accvgpr_read_b32 v76, a96
v_accvgpr_read_b32 v77, a97
v_accvgpr_read_b32 v78, a98
v_accvgpr_read_b32 v79, a99
v_cvt_pk_bf16_f32 v84, v72, v73
v_cvt_pk_bf16_f32 v85, v74, v75
v_cvt_pk_bf16_f32 v86, v76, v77
v_cvt_pk_bf16_f32 v87, v78, v79
s_nop 0
v_permlane16_swap_b32 v84, v86
v_permlane16_swap_b32 v85, v87
global_store_dwordx4 v56, v[84:87], s[12:13] offset:1024 sc1
v_accvgpr_read_b32 v64, a128
v_accvgpr_read_b32 v65, a129
v_accvgpr_read_b32 v66, a130
v_accvgpr_read_b32 v67, a131
v_accvgpr_read_b32 v68, a160
v_accvgpr_read_b32 v69, a161
v_accvgpr_read_b32 v70, a162
v_accvgpr_read_b32 v71, a163
v_cvt_pk_bf16_f32 v80, v64, v65
v_cvt_pk_bf16_f32 v81, v66, v67
v_cvt_pk_bf16_f32 v82, v68, v69
v_cvt_pk_bf16_f32 v83, v70, v71
s_nop 0
v_permlane16_swap_b32 v80, v82
v_permlane16_swap_b32 v81, v83
global_store_dwordx4 v56, v[80:83], s[12:13] offset:2048 sc1
v_accvgpr_read_b32 v72, a192
v_accvgpr_read_b32 v73, a193
v_accvgpr_read_b32 v74, a194
v_accvgpr_read_b32 v75, a195
v_accvgpr_read_b32 v76, a224
v_accvgpr_read_b32 v77, a225
v_accvgpr_read_b32 v78, a226
v_accvgpr_read_b32 v79, a227
v_cvt_pk_bf16_f32 v84, v72, v73
v_cvt_pk_bf16_f32 v85, v74, v75
v_cvt_pk_bf16_f32 v86, v76, v77
v_cvt_pk_bf16_f32 v87, v78, v79
s_nop 0
v_permlane16_swap_b32 v84, v86
v_permlane16_swap_b32 v85, v87
global_store_dwordx4 v56, v[84:87], s[12:13] offset:3072 sc1
v_accvgpr_read_b32 v64, a4
v_accvgpr_read_b32 v65, a5
v_accvgpr_read_b32 v66, a6
v_accvgpr_read_b32 v67, a7
v_accvgpr_read_b32 v68, a36
v_accvgpr_read_b32 v69, a37
v_accvgpr_read_b32 v70, a38
v_accvgpr_read_b32 v71, a39
v_cvt_pk_bf16_f32 v80, v64, v65
v_cvt_pk_bf16_f32 v81, v66, v67
v_cvt_pk_bf16_f32 v82, v68, v69
v_cvt_pk_bf16_f32 v83, v70, v71
s_nop 0
v_permlane16_swap_b32 v80, v82
v_permlane16_swap_b32 v81, v83
global_store_dwordx4 v57, v[80:83], s[12:13] offset:0 sc1
v_accvgpr_read_b32 v72, a68
v_accvgpr_read_b32 v73, a69
v_accvgpr_read_b32 v74, a70
v_accvgpr_read_b32 v75, a71
v_accvgpr_read_b32 v76, a100
v_accvgpr_read_b32 v77, a101
v_accvgpr_read_b32 v78, a102
v_accvgpr_read_b32 v79, a103
v_cvt_pk_bf16_f32 v84, v72, v73
v_cvt_pk_bf16_f32 v85, v74, v75
v_cvt_pk_bf16_f32 v86, v76, v77
v_cvt_pk_bf16_f32 v87, v78, v79
s_nop 0
v_permlane16_swap_b32 v84, v86
v_permlane16_swap_b32 v85, v87
global_store_dwordx4 v57, v[84:87], s[12:13] offset:1024 sc1
v_accvgpr_read_b32 v64, a132
v_accvgpr_read_b32 v65, a133
v_accvgpr_read_b32 v66, a134
v_accvgpr_read_b32 v67, a135
v_accvgpr_read_b32 v68, a164
v_accvgpr_read_b32 v69, a165
v_accvgpr_read_b32 v70, a166
v_accvgpr_read_b32 v71, a167
v_cvt_pk_bf16_f32 v80, v64, v65
v_cvt_pk_bf16_f32 v81, v66, v67
v_cvt_pk_bf16_f32 v82, v68, v69
v_cvt_pk_bf16_f32 v83, v70, v71
s_nop 0
v_permlane16_swap_b32 v80, v82
v_permlane16_swap_b32 v81, v83
global_store_dwordx4 v57, v[80:83], s[12:13] offset:2048 sc1
v_accvgpr_read_b32 v72, a196
v_accvgpr_read_b32 v73, a197
v_accvgpr_read_b32 v74, a198
v_accvgpr_read_b32 v75, a199
v_accvgpr_read_b32 v76, a228
v_accvgpr_read_b32 v77, a229
v_accvgpr_read_b32 v78, a230
v_accvgpr_read_b32 v79, a231
v_cvt_pk_bf16_f32 v84, v72, v73
v_cvt_pk_bf16_f32 v85, v74, v75
v_cvt_pk_bf16_f32 v86, v76, v77
v_cvt_pk_bf16_f32 v87, v78, v79
s_nop 0
v_permlane16_swap_b32 v84, v86
v_permlane16_swap_b32 v85, v87
global_store_dwordx4 v57, v[84:87], s[12:13] offset:3072 sc1
s_add_u32 s12, s12, 262144
s_addc_u32 s13, s13, 0
v_accvgpr_read_b32 v64, a8
v_accvgpr_read_b32 v65, a9
v_accvgpr_read_b32 v66, a10
v_accvgpr_read_b32 v67, a11
v_accvgpr_read_b32 v68, a40
v_accvgpr_read_b32 v69, a41
v_accvgpr_read_b32 v70, a42
v_accvgpr_read_b32 v71, a43
v_cvt_pk_bf16_f32 v80, v64, v65
v_cvt_pk_bf16_f32 v81, v66, v67
v_cvt_pk_bf16_f32 v82, v68, v69
v_cvt_pk_bf16_f32 v83, v70, v71
s_nop 0
v_permlane16_swap_b32 v80, v82
v_permlane16_swap_b32 v81, v83
global_store_dwordx4 v56, v[80:83], s[12:13] offset:0 sc1
v_accvgpr_read_b32 v72, a72
v_accvgpr_read_b32 v73, a73
v_accvgpr_read_b32 v74, a74
v_accvgpr_read_b32 v75, a75
v_accvgpr_read_b32 v76, a104
v_accvgpr_read_b32 v77, a105
v_accvgpr_read_b32 v78, a106
v_accvgpr_read_b32 v79, a107
v_cvt_pk_bf16_f32 v84, v72, v73
v_cvt_pk_bf16_f32 v85, v74, v75
v_cvt_pk_bf16_f32 v86, v76, v77
v_cvt_pk_bf16_f32 v87, v78, v79
s_nop 0
v_permlane16_swap_b32 v84, v86
v_permlane16_swap_b32 v85, v87
global_store_dwordx4 v56, v[84:87], s[12:13] offset:1024 sc1
v_accvgpr_read_b32 v64, a136
v_accvgpr_read_b32 v65, a137
v_accvgpr_read_b32 v66, a138
v_accvgpr_read_b32 v67, a139
v_accvgpr_read_b32 v68, a168
v_accvgpr_read_b32 v69, a169
v_accvgpr_read_b32 v70, a170
v_accvgpr_read_b32 v71, a171
v_cvt_pk_bf16_f32 v80, v64, v65
v_cvt_pk_bf16_f32 v81, v66, v67
v_cvt_pk_bf16_f32 v82, v68, v69
v_cvt_pk_bf16_f32 v83, v70, v71
s_nop 0
v_permlane16_swap_b32 v80, v82
v_permlane16_swap_b32 v81, v83
global_store_dwordx4 v56, v[80:83], s[12:13] offset:2048 sc1
v_accvgpr_read_b32 v72, a200
v_accvgpr_read_b32 v73, a201
v_accvgpr_read_b32 v74, a202
v_accvgpr_read_b32 v75, a203
v_accvgpr_read_b32 v76, a232
v_accvgpr_read_b32 v77, a233
v_accvgpr_read_b32 v78, a234
v_accvgpr_read_b32 v79, a235
v_cvt_pk_bf16_f32 v84, v72, v73
v_cvt_pk_bf16_f32 v85, v74, v75
v_cvt_pk_bf16_f32 v86, v76, v77
v_cvt_pk_bf16_f32 v87, v78, v79
s_nop 0
v_permlane16_swap_b32 v84, v86
v_permlane16_swap_b32 v85, v87
global_store_dwordx4 v56, v[84:87], s[12:13] offset:3072 sc1
v_accvgpr_read_b32 v64, a12
v_accvgpr_read_b32 v65, a13
v_accvgpr_read_b32 v66, a14
v_accvgpr_read_b32 v67, a15
v_accvgpr_read_b32 v68, a44
v_accvgpr_read_b32 v69, a45
v_accvgpr_read_b32 v70, a46
v_accvgpr_read_b32 v71, a47
v_cvt_pk_bf16_f32 v80, v64, v65
v_cvt_pk_bf16_f32 v81, v66, v67
v_cvt_pk_bf16_f32 v82, v68, v69
v_cvt_pk_bf16_f32 v83, v70, v71
s_nop 0
v_permlane16_swap_b32 v80, v82
v_permlane16_swap_b32 v81, v83
global_store_dwordx4 v57, v[80:83], s[12:13] offset:0 sc1
v_accvgpr_read_b32 v72, a76
v_accvgpr_read_b32 v73, a77
v_accvgpr_read_b32 v74, a78
v_accvgpr_read_b32 v75, a79
v_accvgpr_read_b32 v76, a108
v_accvgpr_read_b32 v77, a109
v_accvgpr_read_b32 v78, a110
v_accvgpr_read_b32 v79, a111
v_cvt_pk_bf16_f32 v84, v72, v73
v_cvt_pk_bf16_f32 v85, v74, v75
v_cvt_pk_bf16_f32 v86, v76, v77
v_cvt_pk_bf16_f32 v87, v78, v79
s_nop 0
v_permlane16_swap_b32 v84, v86
v_permlane16_swap_b32 v85, v87
global_store_dwordx4 v57, v[84:87], s[12:13] offset:1024 sc1
v_accvgpr_read_b32 v64, a140
v_accvgpr_read_b32 v65, a141
v_accvgpr_read_b32 v66, a142
v_accvgpr_read_b32 v67, a143
v_accvgpr_read_b32 v68, a172
v_accvgpr_read_b32 v69, a173
v_accvgpr_read_b32 v70, a174
v_accvgpr_read_b32 v71, a175
v_cvt_pk_bf16_f32 v80, v64, v65
v_cvt_pk_bf16_f32 v81, v66, v67
v_cvt_pk_bf16_f32 v82, v68, v69
v_cvt_pk_bf16_f32 v83, v70, v71
s_nop 0
v_permlane16_swap_b32 v80, v82
v_permlane16_swap_b32 v81, v83
global_store_dwordx4 v57, v[80:83], s[12:13] offset:2048 sc1
v_accvgpr_read_b32 v72, a204
v_accvgpr_read_b32 v73, a205
v_accvgpr_read_b32 v74, a206
v_accvgpr_read_b32 v75, a207
v_accvgpr_read_b32 v76, a236
v_accvgpr_read_b32 v77, a237
v_accvgpr_read_b32 v78, a238
v_accvgpr_read_b32 v79, a239
v_cvt_pk_bf16_f32 v84, v72, v73
v_cvt_pk_bf16_f32 v85, v74, v75
v_cvt_pk_bf16_f32 v86, v76, v77
v_cvt_pk_bf16_f32 v87, v78, v79
s_nop 0
v_permlane16_swap_b32 v84, v86
v_permlane16_swap_b32 v85, v87
global_store_dwordx4 v57, v[84:87], s[12:13] offset:3072 sc1
s_add_u32 s12, s12, 262144
s_addc_u32 s13, s13, 0
v_accvgpr_read_b32 v64, a16
v_accvgpr_read_b32 v65, a17
v_accvgpr_read_b32 v66, a18
v_accvgpr_read_b32 v67, a19
v_accvgpr_read_b32 v68, a48
v_accvgpr_read_b32 v69, a49
v_accvgpr_read_b32 v70, a50
v_accvgpr_read_b32 v71, a51
v_cvt_pk_bf16_f32 v80, v64, v65
v_cvt_pk_bf16_f32 v81, v66, v67
v_cvt_pk_bf16_f32 v82, v68, v69
v_cvt_pk_bf16_f32 v83, v70, v71
s_nop 0
v_permlane16_swap_b32 v80, v82
v_permlane16_swap_b32 v81, v83
global_store_dwordx4 v56, v[80:83], s[12:13] offset:0 sc1
v_accvgpr_read_b32 v72, a80
v_accvgpr_read_b32 v73, a81
v_accvgpr_read_b32 v74, a82
v_accvgpr_read_b32 v75, a83
v_accvgpr_read_b32 v76, a112
v_accvgpr_read_b32 v77, a113
v_accvgpr_read_b32 v78, a114
v_accvgpr_read_b32 v79, a115
v_cvt_pk_bf16_f32 v84, v72, v73
v_cvt_pk_bf16_f32 v85, v74, v75
v_cvt_pk_bf16_f32 v86, v76, v77
v_cvt_pk_bf16_f32 v87, v78, v79
s_nop 0
v_permlane16_swap_b32 v84, v86
v_permlane16_swap_b32 v85, v87
global_store_dwordx4 v56, v[84:87], s[12:13] offset:1024 sc1
v_accvgpr_read_b32 v64, a144
v_accvgpr_read_b32 v65, a145
v_accvgpr_read_b32 v66, a146
v_accvgpr_read_b32 v67, a147
v_accvgpr_read_b32 v68, a176
v_accvgpr_read_b32 v69, a177
v_accvgpr_read_b32 v70, a178
v_accvgpr_read_b32 v71, a179
v_cvt_pk_bf16_f32 v80, v64, v65
v_cvt_pk_bf16_f32 v81, v66, v67
v_cvt_pk_bf16_f32 v82, v68, v69
v_cvt_pk_bf16_f32 v83, v70, v71
s_nop 0
v_permlane16_swap_b32 v80, v82
v_permlane16_swap_b32 v81, v83
global_store_dwordx4 v56, v[80:83], s[12:13] offset:2048 sc1
v_accvgpr_read_b32 v72, a208
v_accvgpr_read_b32 v73, a209
v_accvgpr_read_b32 v74, a210
v_accvgpr_read_b32 v75, a211
v_accvgpr_read_b32 v76, a240
v_accvgpr_read_b32 v77, a241
v_accvgpr_read_b32 v78, a242
v_accvgpr_read_b32 v79, a243
v_cvt_pk_bf16_f32 v84, v72, v73
v_cvt_pk_bf16_f32 v85, v74, v75
v_cvt_pk_bf16_f32 v86, v76, v77
v_cvt_pk_bf16_f32 v87, v78, v79
s_nop 0
v_permlane16_swap_b32 v84, v86
v_permlane16_swap_b32 v85, v87
global_store_dwordx4 v56, v[84:87], s[12:13] offset:3072 sc1
v_accvgpr_read_b32 v64, a20
v_accvgpr_read_b32 v65, a21
v_accvgpr_read_b32 v66, a22
v_accvgpr_read_b32 v67, a23
v_accvgpr_read_b32 v68, a52
v_accvgpr_read_b32 v69, a53
v_accvgpr_read_b32 v70, a54
v_accvgpr_read_b32 v71, a55
v_cvt_pk_bf16_f32 v80, v64, v65
v_cvt_pk_bf16_f32 v81, v66, v67
v_cvt_pk_bf16_f32 v82, v68, v69
v_cvt_pk_bf16_f32 v83, v70, v71
s_nop 0
v_permlane16_swap_b32 v80, v82
v_permlane16_swap_b32 v81, v83
global_store_dwordx4 v57, v[80:83], s[12:13] offset:0 sc1
v_accvgpr_read_b32 v72, a84
v_accvgpr_read_b32 v73, a85
v_accvgpr_read_b32 v74, a86
v_accvgpr_read_b32 v75, a87
v_accvgpr_read_b32 v76, a116
v_accvgpr_read_b32 v77, a117
v_accvgpr_read_b32 v78, a118
v_accvgpr_read_b32 v79, a119
v_cvt_pk_bf16_f32 v84, v72, v73
v_cvt_pk_bf16_f32 v85, v74, v75
v_cvt_pk_bf16_f32 v86, v76, v77
v_cvt_pk_bf16_f32 v87, v78, v79
s_nop 0
v_permlane16_swap_b32 v84, v86
v_permlane16_swap_b32 v85, v87
global_store_dwordx4 v57, v[84:87], s[12:13] offset:1024 sc1
v_accvgpr_read_b32 v64, a148
v_accvgpr_read_b32 v65, a149
v_accvgpr_read_b32 v66, a150
v_accvgpr_read_b32 v67, a151
v_accvgpr_read_b32 v68, a180
v_accvgpr_read_b32 v69, a181
v_accvgpr_read_b32 v70, a182
v_accvgpr_read_b32 v71, a183
v_cvt_pk_bf16_f32 v80, v64, v65
v_cvt_pk_bf16_f32 v81, v66, v67
v_cvt_pk_bf16_f32 v82, v68, v69
v_cvt_pk_bf16_f32 v83, v70, v71
s_nop 0
v_permlane16_swap_b32 v80, v82
v_permlane16_swap_b32 v81, v83
global_store_dwordx4 v57, v[80:83], s[12:13] offset:2048 sc1
v_accvgpr_read_b32 v72, a212
v_accvgpr_read_b32 v73, a213
v_accvgpr_read_b32 v74, a214
v_accvgpr_read_b32 v75, a215
v_accvgpr_read_b32 v76, a244
v_accvgpr_read_b32 v77, a245
v_accvgpr_read_b32 v78, a246
v_accvgpr_read_b32 v79, a247
v_cvt_pk_bf16_f32 v84, v72, v73
v_cvt_pk_bf16_f32 v85, v74, v75
v_cvt_pk_bf16_f32 v86, v76, v77
v_cvt_pk_bf16_f32 v87, v78, v79
s_nop 0
v_permlane16_swap_b32 v84, v86
v_permlane16_swap_b32 v85, v87
global_store_dwordx4 v57, v[84:87], s[12:13] offset:3072 sc1
s_add_u32 s12, s12, 262144
s_addc_u32 s13, s13, 0
v_accvgpr_read_b32 v64, a24
v_accvgpr_read_b32 v65, a25
v_accvgpr_read_b32 v66, a26
v_accvgpr_read_b32 v67, a27
v_accvgpr_read_b32 v68, a56
v_accvgpr_read_b32 v69, a57
v_accvgpr_read_b32 v70, a58
v_accvgpr_read_b32 v71, a59
v_cvt_pk_bf16_f32 v80, v64, v65
v_cvt_pk_bf16_f32 v81, v66, v67
v_cvt_pk_bf16_f32 v82, v68, v69
v_cvt_pk_bf16_f32 v83, v70, v71
s_nop 0
v_permlane16_swap_b32 v80, v82
v_permlane16_swap_b32 v81, v83
global_store_dwordx4 v56, v[80:83], s[12:13] offset:0 sc1
v_accvgpr_read_b32 v72, a88
v_accvgpr_read_b32 v73, a89
v_accvgpr_read_b32 v74, a90
v_accvgpr_read_b32 v75, a91
v_accvgpr_read_b32 v76, a120
v_accvgpr_read_b32 v77, a121
v_accvgpr_read_b32 v78, a122
v_accvgpr_read_b32 v79, a123
v_cvt_pk_bf16_f32 v84, v72, v73
v_cvt_pk_bf16_f32 v85, v74, v75
v_cvt_pk_bf16_f32 v86, v76, v77
v_cvt_pk_bf16_f32 v87, v78, v79
s_nop 0
v_permlane16_swap_b32 v84, v86
v_permlane16_swap_b32 v85, v87
global_store_dwordx4 v56, v[84:87], s[12:13] offset:1024 sc1
v_accvgpr_read_b32 v64, a152
v_accvgpr_read_b32 v65, a153
v_accvgpr_read_b32 v66, a154
v_accvgpr_read_b32 v67, a155
v_accvgpr_read_b32 v68, a184
v_accvgpr_read_b32 v69, a185
v_accvgpr_read_b32 v70, a186
v_accvgpr_read_b32 v71, a187
v_cvt_pk_bf16_f32 v80, v64, v65
v_cvt_pk_bf16_f32 v81, v66, v67
v_cvt_pk_bf16_f32 v82, v68, v69
v_cvt_pk_bf16_f32 v83, v70, v71
s_nop 0
v_permlane16_swap_b32 v80, v82
v_permlane16_swap_b32 v81, v83
global_store_dwordx4 v56, v[80:83], s[12:13] offset:2048 sc1
v_accvgpr_read_b32 v72, a216
v_accvgpr_read_b32 v73, a217
v_accvgpr_read_b32 v74, a218
v_accvgpr_read_b32 v75, a219
v_accvgpr_read_b32 v76, a248
v_accvgpr_read_b32 v77, a249
v_accvgpr_read_b32 v78, a250
v_accvgpr_read_b32 v79, a251
v_cvt_pk_bf16_f32 v84, v72, v73
v_cvt_pk_bf16_f32 v85, v74, v75
v_cvt_pk_bf16_f32 v86, v76, v77
v_cvt_pk_bf16_f32 v87, v78, v79
s_nop 0
v_permlane16_swap_b32 v84, v86
v_permlane16_swap_b32 v85, v87
global_store_dwordx4 v56, v[84:87], s[12:13] offset:3072 sc1
v_accvgpr_read_b32 v64, a28
v_accvgpr_read_b32 v65, a29
v_accvgpr_read_b32 v66, a30
v_accvgpr_read_b32 v67, a31
v_accvgpr_read_b32 v68, a60
v_accvgpr_read_b32 v69, a61
v_accvgpr_read_b32 v70, a62
v_accvgpr_read_b32 v71, a63
v_cvt_pk_bf16_f32 v80, v64, v65
v_cvt_pk_bf16_f32 v81, v66, v67
v_cvt_pk_bf16_f32 v82, v68, v69
v_cvt_pk_bf16_f32 v83, v70, v71
s_nop 0
v_permlane16_swap_b32 v80, v82
v_permlane16_swap_b32 v81, v83
global_store_dwordx4 v57, v[80:83], s[12:13] offset:0 sc1
v_accvgpr_read_b32 v72, a92
v_accvgpr_read_b32 v73, a93
v_accvgpr_read_b32 v74, a94
v_accvgpr_read_b32 v75, a95
v_accvgpr_read_b32 v76, a124
v_accvgpr_read_b32 v77, a125
v_accvgpr_read_b32 v78, a126
v_accvgpr_read_b32 v79, a127
v_cvt_pk_bf16_f32 v84, v72, v73
v_cvt_pk_bf16_f32 v85, v74, v75
v_cvt_pk_bf16_f32 v86, v76, v77
v_cvt_pk_bf16_f32 v87, v78, v79
s_nop 0
v_permlane16_swap_b32 v84, v86
v_permlane16_swap_b32 v85, v87
global_store_dwordx4 v57, v[84:87], s[12:13] offset:1024 sc1
v_accvgpr_read_b32 v64, a156
v_accvgpr_read_b32 v65, a157
v_accvgpr_read_b32 v66, a158
v_accvgpr_read_b32 v67, a159
v_accvgpr_read_b32 v68, a188
v_accvgpr_read_b32 v69, a189
v_accvgpr_read_b32 v70, a190
v_accvgpr_read_b32 v71, a191
v_cvt_pk_bf16_f32 v80, v64, v65
v_cvt_pk_bf16_f32 v81, v66, v67
v_cvt_pk_bf16_f32 v82, v68, v69
v_cvt_pk_bf16_f32 v83, v70, v71
s_nop 0
v_permlane16_swap_b32 v80, v82
v_permlane16_swap_b32 v81, v83
global_store_dwordx4 v57, v[80:83], s[12:13] offset:2048 sc1
v_accvgpr_read_b32 v72, a220
v_accvgpr_read_b32 v73, a221
v_accvgpr_read_b32 v74, a222
v_accvgpr_read_b32 v75, a223
v_accvgpr_read_b32 v76, a252
v_accvgpr_read_b32 v77, a253
v_accvgpr_read_b32 v78, a254
v_accvgpr_read_b32 v79, a255
v_cvt_pk_bf16_f32 v84, v72, v73
v_cvt_pk_bf16_f32 v85, v74, v75
v_cvt_pk_bf16_f32 v86, v76, v77
v_cvt_pk_bf16_f32 v87, v78, v79
s_nop 0
v_permlane16_swap_b32 v84, v86
v_permlane16_swap_b32 v85, v87
global_store_dwordx4 v57, v[84:87], s[12:13] offset:3072 sc1
s_cmp_eq_u32 s60, 2
s_cbranch_scc1 M_isq_76
s_waitcnt vmcnt(0)
s_barrier
s_cmp_lg_u32 s20, 0
s_cbranch_scc1 M_sg_77
s_lshl_b32 s64, s63, 2
s_add_u32 s64, s64, 96
v_mov_b32 v42, s64
v_mov_b32 v43, 4
s_mov_b64 exec, 1
global_atomic_add v42, v43, s[56:57]
s_mov_b64 exec, -1
M_sg_77:
s_branch W_loop
M_isq_76:
s_waitcnt vmcnt(0)
s_barrier
s_cmp_lg_u32 s20, 0
s_cbranch_scc1 M_sg_78
s_lshl_b32 s64, s63, 2
s_add_u32 s64, s64, 160
v_mov_b32 v42, s64
v_mov_b32 v43, 1
s_mov_b64 exec, 1
global_atomic_add v42, v43, s[56:57]
s_mov_b64 exec, -1
M_sg_78:
s_branch W_loop
W_v:
s_lshr_b32 s63, s61, 0
s_cmp_ge_u32 s63, 2
s_cbranch_scc1 M_lb_79
s_cmp_lg_u32 s20, 0
s_cbranch_scc1 M_wcd_82
s_lshl_b32 s64, s63, 2
s_add_u32 s64, s64, 144
v_mov_b32 v42, s64
s_mov_b32 s65, 0
s_mov_b64 exec, 1
M_wc_81:
global_load_dword v43, v42, s[56:57] sc1
s_waitcnt vmcnt(0)
v_readfirstlane_b32 s64, v43
s_cmp_ge_u32 s64, 64
s_cbranch_scc1 M_wcd_82_x
s_sleep 20
s_add_u32 s65, s65, 1
s_cmp_lt_u32 s65, 400000
s_cbranch_scc1 M_wc_81
s_mov_b64 exec, -1
s_branch M_exit0
M_wcd_82_x:
s_mov_b64 exec, -1
M_wcd_82:
s_barrier
s_branch M_lbd_80
M_lb_79:
s_cmp_eq_u32 s97, 1
s_cbranch_scc1 M_wo_83
s_cmp_lg_u32 s20, 0
s_cbranch_scc1 M_wcd_85
v_mov_b32 v42, 132
s_mov_b32 s65, 0
s_mov_b64 exec, 1
M_wc_84:
global_load_dword v43, v42, s[56:57] sc1
s_waitcnt vmcnt(0)
v_readfirstlane_b32 s64, v43
s_cmp_ge_u32 s64, 128
s_cbranch_scc1 M_wcd_85_x
s_sleep 32
s_add_u32 s65, s65, 1
s_cmp_lt_u32 s65, 400000
s_cbranch_scc1 M_wc_84
s_mov_b64 exec, -1
s_branch M_exit0
M_wcd_85_x:
s_mov_b64 exec, -1
M_wcd_85:
s_barrier
s_mov_b32 s97, 1
M_wo_83:
M_lbd_80:
s_mov_b32 s66, s46
s_mov_b32 s67, s47
s_lshl_b32 s64, s62, 9
s_add_u32 s6, s66, s64
s_addc_u32 s7, s67, 0
s_mul_i32 s64, s61, 16384
s_add_u32 s64, s64, 0
s_add_u32 s4, s40, s64
s_addc_u32 s5, s41, 0
s_mov_b32 s8, 131072
s_mov_b32 s31, 8192
s_mov_b32 s9, 262144
s_mov_b32 s10, 32
s_mul_i32 s64, s61, 2097152
s_lshl_b32 s65, s62, 14
s_add_u32 s64, s64, s65
s_add_u32 s64, s64, 50331648
s_add_u32 s12, s40, s64
s_addc_u32 s13, s41, 0
s_mul_i32 s21, s20, 4096
v_lshlrev_b32 v42, 4, v1
v_add_u32 v2, s21, v42
v_add_u32 v3, 1024, v2
v_add_u32 v4, 1024, v3
v_add_u32 v5, 1024, v4
v_lshrrev_b32 v42, 5, v1
s_lshl_b32 s21, s20, 3
v_add_u32 v43, s21, v42
v_mul_lo_u32 v43, v43, s31
v_and_b32 v44, 31, v1
s_and_b32 s21, s20, 1
s_lshl_b32 s21, s21, 3
v_lshl_add_u32 v42, v42, 1, s21
v_xor_b32 v45, v44, v42
v_xor_b32 v46, 4, v45
v_lshl_add_u32 v45, v45, 4, v43
v_lshl_add_u32 v46, v46, 4, v43
s_lshl_b32 s22, s31, 1
s_mov_b32 s21, 0
v_add_u32 v6, s21, v45
s_add_u32 s21, s21, s22
v_add_u32 v7, s21, v46
s_add_u32 s21, s21, s22
v_add_u32 v8, s21, v45
s_add_u32 s21, s21, s22
v_add_u32 v9, s21, v46
s_mul_i32 s29, s20, 4096
s_add_u32 m0, s25, 0
s_nop 0
global_load_lds_dwordx4 v2, s[4:5] sc1
s_add_u32 m0, s25, 1024
s_nop 0
global_load_lds_dwordx4 v3, s[4:5] sc1
s_add_u32 m0, s25, 2048
s_nop 0
global_load_lds_dwordx4 v4, s[4:5] sc1
s_add_u32 m0, s25, 3072
s_nop 0
global_load_lds_dwordx4 v5, s[4:5] sc1
s_add_u32 m0, s26, 0
s_nop 0
global_load_lds_dwordx4 v6, s[6:7]
s_add_u32 m0, s26, 1024
s_nop 0
global_load_lds_dwordx4 v7, s[6:7]
s_add_u32 m0, s26, 2048
s_nop 0
global_load_lds_dwordx4 v8, s[6:7]
s_add_u32 m0, s26, 3072
s_nop 0
global_load_lds_dwordx4 v9, s[6:7]
s_add_u32 s4, s4, s8
s_addc_u32 s5, s5, 0
s_add_u32 s6, s6, s9
s_addc_u32 s7, s7, 0
s_add_u32 m0, s25, 32768
s_nop 0
global_load_lds_dwordx4 v2, s[4:5] sc1
s_add_u32 m0, s25, 33792
s_nop 0
global_load_lds_dwordx4 v3, s[4:5] sc1
s_add_u32 m0, s25, 34816
s_nop 0
global_load_lds_dwordx4 v4, s[4:5] sc1
s_add_u32 m0, s25, 35840
s_nop 0
global_load_lds_dwordx4 v5, s[4:5] sc1
s_add_u32 m0, s26, 32768
s_nop 0
global_load_lds_dwordx4 v6, s[6:7]
s_add_u32 m0, s26, 33792
s_nop 0
global_load_lds_dwordx4 v7, s[6:7]
s_add_u32 m0, s26, 34816
s_nop 0
global_load_lds_dwordx4 v8, s[6:7]
s_add_u32 m0, s26, 35840
s_nop 0
global_load_lds_dwordx4 v9, s[6:7]
s_add_u32 s4, s4, s8
s_addc_u32 s5, s5, 0
s_add_u32 s6, s6, s9
s_addc_u32 s7, s7, 0
s_add_u32 m0, s25, 65536
s_nop 0
global_load_lds_dwordx4 v2, s[4:5] sc1
s_add_u32 m0, s25, 66560
s_nop 0
global_load_lds_dwordx4 v3, s[4:5] sc1
s_add_u32 m0, s25, 67584
s_nop 0
global_load_lds_dwordx4 v4, s[4:5] sc1
s_add_u32 m0, s25, 68608
s_nop 0
global_load_lds_dwordx4 v5, s[4:5] sc1
s_add_u32 m0, s26, 65536
s_nop 0
global_load_lds_dwordx4 v6, s[6:7]
s_add_u32 m0, s26, 66560
s_nop 0
global_load_lds_dwordx4 v7, s[6:7]
s_add_u32 m0, s26, 67584
s_nop 0
global_load_lds_dwordx4 v8, s[6:7]
s_add_u32 m0, s26, 68608
s_nop 0
global_load_lds_dwordx4 v9, s[6:7]
s_add_u32 s4, s4, s8
s_addc_u32 s5, s5, 0
s_add_u32 s6, s6, s9
s_addc_u32 s7, s7, 0
s_add_u32 m0, s25, 98304
s_nop 0
global_load_lds_dwordx4 v2, s[4:5] sc1
s_add_u32 m0, s25, 99328
s_nop 0
global_load_lds_dwordx4 v3, s[4:5] sc1
s_add_u32 m0, s25, 100352
s_nop 0
global_load_lds_dwordx4 v4, s[4:5] sc1
s_add_u32 m0, s25, 101376
s_nop 0
global_load_lds_dwordx4 v5, s[4:5] sc1
s_add_u32 m0, s26, 98304
s_nop 0
global_load_lds_dwordx4 v6, s[6:7]
s_add_u32 m0, s26, 99328
s_nop 0
global_load_lds_dwordx4 v7, s[6:7]
s_add_u32 m0, s26, 100352
s_nop 0
global_load_lds_dwordx4 v8, s[6:7]
s_add_u32 m0, s26, 101376
s_nop 0
global_load_lds_dwordx4 v9, s[6:7]
s_add_u32 s4, s4, s8
s_addc_u32 s5, s5, 0
s_add_u32 s6, s6, s9
s_addc_u32 s7, s7, 0
s_lshr_b32 s21, s20, 1
s_mul_i32 s21, s21, 8192
v_and_b32 v42, 15, v1
v_lshlrev_b32 v43, 6, v42
v_add_u32 v43, s21, v43
v_lshrrev_b32 v42, 2, v42
v_lshrrev_b32 v44, 1, v42
v_xor_b32 v45, v42, v44
v_and_b32 v45, 1, v45
v_lshl_add_u32 v44, v45, 1, v44
v_lshrrev_b32 v45, 4, v1
v_xor_b32 v44, v44, v45
v_lshl_add_u32 v10, v44, 4, v43
v_add_u32 v11, 0x10000, v10
s_and_b32 s21, s20, 1
v_and_b32 v42, 15, v1
v_lshrrev_b32 v43, 2, v42
v_lshrrev_b32 v44, 4, v1
v_lshl_add_u32 v45, v44, 3, v43
v_lshlrev_b32 v45, 9, v45
v_and_b32 v46, 1, v42
v_lshl_add_u32 v45, v46, 3, v45
v_bfe_u32 v46, v42, 1, 1
v_lshl_add_u32 v45, v46, 4, v45
v_add_u32 v45, 16384, v45
v_and_b32 v44, 1, v44
v_lshl_add_u32 v43, v44, 2, v43
s_mul_i32 s22, s21, 8
s_add_u32 s23, s22, 0
s_and_b32 s24, s23, 7
s_and_b32 s23, s23, 8
v_xor_b32 v46, s24, v43
v_add_u32 v46, s23, v46
v_lshl_add_u32 v26, v46, 5, v45
v_add_u32 v34, 0x10000, v26
s_add_u32 s23, s22, 1
s_and_b32 s24, s23, 7
s_and_b32 s23, s23, 8
v_xor_b32 v46, s24, v43
v_add_u32 v46, s23, v46
v_lshl_add_u32 v27, v46, 5, v45
v_add_u32 v35, 0x10000, v27
s_add_u32 s23, s22, 2
s_and_b32 s24, s23, 7
s_and_b32 s23, s23, 8
v_xor_b32 v46, s24, v43
v_add_u32 v46, s23, v46
v_lshl_add_u32 v28, v46, 5, v45
v_add_u32 v36, 0x10000, v28
s_add_u32 s23, s22, 3
s_and_b32 s24, s23, 7
s_and_b32 s23, s23, 8
v_xor_b32 v46, s24, v43
v_add_u32 v46, s23, v46
v_lshl_add_u32 v29, v46, 5, v45
v_add_u32 v37, 0x10000, v29
s_add_u32 s23, s22, 4
s_and_b32 s24, s23, 7
s_and_b32 s23, s23, 8
v_xor_b32 v46, s24, v43
v_add_u32 v46, s23, v46
v_lshl_add_u32 v30, v46, 5, v45
v_add_u32 v38, 0x10000, v30
s_add_u32 s23, s22, 5
s_and_b32 s24, s23, 7
s_and_b32 s23, s23, 8
v_xor_b32 v46, s24, v43
v_add_u32 v46, s23, v46
v_lshl_add_u32 v31, v46, 5, v45
v_add_u32 v39, 0x10000, v31
s_add_u32 s23, s22, 6
s_and_b32 s24, s23, 7
s_and_b32 s23, s23, 8
v_xor_b32 v46, s24, v43
v_add_u32 v46, s23, v46
v_lshl_add_u32 v32, v46, 5, v45
v_add_u32 v40, 0x10000, v32
s_add_u32 s23, s22, 7
s_and_b32 s24, s23, 7
s_and_b32 s23, s23, 8
v_xor_b32 v46, s24, v43
v_add_u32 v46, s23, v46
v_lshl_add_u32 v33, v46, 5, v45
v_add_u32 v41, 0x10000, v33
s_waitcnt vmcnt(0)
s_barrier
ds_read_b64_tr_b16 v[160:161], v26 offset:0
ds_read_b64_tr_b16 v[162:163], v26 offset:2048
ds_read_b128 v[128:131], v10 offset:0
ds_read_b128 v[132:135], v10 offset:1024
ds_read_b128 v[136:139], v10 offset:2048
ds_read_b128 v[140:143], v10 offset:3072
ds_read_b128 v[144:147], v10 offset:4096
ds_read_b128 v[148:151], v10 offset:5120
ds_read_b128 v[152:155], v10 offset:6144
ds_read_b128 v[156:159], v10 offset:7168
ds_read_b64_tr_b16 v[164:165], v27 offset:0
ds_read_b64_tr_b16 v[166:167], v27 offset:2048
ds_read_b64_tr_b16 v[168:169], v28 offset:0
ds_read_b64_tr_b16 v[170:171], v28 offset:2048
ds_read_b64_tr_b16 v[172:173], v29 offset:0
ds_read_b64_tr_b16 v[174:175], v29 offset:2048
ds_read_b64_tr_b16 v[176:177], v30 offset:0
ds_read_b64_tr_b16 v[178:179], v30 offset:2048
ds_read_b64_tr_b16 v[180:181], v31 offset:0
ds_read_b64_tr_b16 v[182:183], v31 offset:2048
ds_read_b64_tr_b16 v[184:185], v32 offset:0
ds_read_b64_tr_b16 v[186:187], v32 offset:2048
ds_read_b64_tr_b16 v[188:189], v33 offset:0
ds_read_b64_tr_b16 v[190:191], v33 offset:2048
s_lshr_b32 s11, s10, 2
s_sub_u32 s11, s11, 1
s_waitcnt lgkmcnt(0)
v_mfma_f32_16x16x32_bf16 a[0:3], v[128:131], v[160:163], 0
v_mfma_f32_16x16x32_bf16 a[4:7], v[132:135], v[160:163], 0
v_mfma_f32_16x16x32_bf16 a[8:11], v[136:139], v[160:163], 0
v_mfma_f32_16x16x32_bf16 a[12:15], v[140:143], v[160:163], 0
v_mfma_f32_16x16x32_bf16 a[16:19], v[144:147], v[160:163], 0
v_mfma_f32_16x16x32_bf16 a[20:23], v[148:151], v[160:163], 0
v_mfma_f32_16x16x32_bf16 a[24:27], v[152:155], v[160:163], 0
v_mfma_f32_16x16x32_bf16 a[28:31], v[156:159], v[160:163], 0
v_mfma_f32_16x16x32_bf16 a[32:35], v[128:131], v[164:167], 0
v_mfma_f32_16x16x32_bf16 a[36:39], v[132:135], v[164:167], 0
v_mfma_f32_16x16x32_bf16 a[40:43], v[136:139], v[164:167], 0
v_mfma_f32_16x16x32_bf16 a[44:47], v[140:143], v[164:167], 0
v_mfma_f32_16x16x32_bf16 a[48:51], v[144:147], v[164:167], 0
v_mfma_f32_16x16x32_bf16 a[52:55], v[148:151], v[164:167], 0
v_mfma_f32_16x16x32_bf16 a[56:59], v[152:155], v[164:167], 0
v_mfma_f32_16x16x32_bf16 a[60:63], v[156:159], v[164:167], 0
v_mfma_f32_16x16x32_bf16 a[64:67], v[128:131], v[168:171], 0
v_mfma_f32_16x16x32_bf16 a[68:71], v[132:135], v[168:171], 0
v_mfma_f32_16x16x32_bf16 a[72:75], v[136:139], v[168:171], 0
v_mfma_f32_16x16x32_bf16 a[76:79], v[140:143], v[168:171], 0
v_mfma_f32_16x16x32_bf16 a[80:83], v[144:147], v[168:171], 0
v_mfma_f32_16x16x32_bf16 a[84:87], v[148:151], v[168:171], 0
v_mfma_f32_16x16x32_bf16 a[88:91], v[152:155], v[168:171], 0
v_mfma_f32_16x16x32_bf16 a[92:95], v[156:159], v[168:171], 0
v_mfma_f32_16x16x32_bf16 a[96:99], v[128:131], v[172:175], 0
v_mfma_f32_16x16x32_bf16 a[100:103], v[132:135], v[172:175], 0
v_mfma_f32_16x16x32_bf16 a[104:107], v[136:139], v[172:175], 0
v_mfma_f32_16x16x32_bf16 a[108:111], v[140:143], v[172:175], 0
v_mfma_f32_16x16x32_bf16 a[112:115], v[144:147], v[172:175], 0
v_mfma_f32_16x16x32_bf16 a[116:119], v[148:151], v[172:175], 0
v_mfma_f32_16x16x32_bf16 a[120:123], v[152:155], v[172:175], 0
v_mfma_f32_16x16x32_bf16 a[124:127], v[156:159], v[172:175], 0
s_barrier
v_mfma_f32_16x16x32_bf16 a[128:131], v[128:131], v[176:179], 0
ds_read_b64_tr_b16 v[224:225], v26 offset:32768
v_mfma_f32_16x16x32_bf16 a[132:135], v[132:135], v[176:179], 0
s_add_u32 m0, s25, 0
ds_read_b64_tr_b16 v[226:227], v26 offset:34816
v_mfma_f32_16x16x32_bf16 a[136:139], v[136:139], v[176:179], 0
global_load_lds_dwordx4 v2, s[4:5] sc1
ds_read_b128 v[192:195], v10 offset:32768
v_mfma_f32_16x16x32_bf16 a[140:143], v[140:143], v[176:179], 0
ds_read_b128 v[196:199], v10 offset:33792
v_mfma_f32_16x16x32_bf16 a[144:147], v[144:147], v[176:179], 0
ds_read_b128 v[200:203], v10 offset:34816
v_mfma_f32_16x16x32_bf16 a[148:151], v[148:151], v[176:179], 0
ds_read_b128 v[204:207], v10 offset:35840
v_mfma_f32_16x16x32_bf16 a[152:155], v[152:155], v[176:179], 0
ds_read_b128 v[208:211], v10 offset:36864
v_mfma_f32_16x16x32_bf16 a[156:159], v[156:159], v[176:179], 0
ds_read_b128 v[212:215], v10 offset:37888
v_mfma_f32_16x16x32_bf16 a[160:163], v[128:131], v[180:183], 0
ds_read_b128 v[216:219], v10 offset:38912
v_mfma_f32_16x16x32_bf16 a[164:167], v[132:135], v[180:183], 0
s_add_u32 m0, s25, 1024
ds_read_b128 v[220:223], v10 offset:39936
v_mfma_f32_16x16x32_bf16 a[168:171], v[136:139], v[180:183], 0
global_load_lds_dwordx4 v3, s[4:5] sc1
ds_read_b64_tr_b16 v[228:229], v27 offset:32768
v_mfma_f32_16x16x32_bf16 a[172:175], v[140:143], v[180:183], 0
ds_read_b64_tr_b16 v[230:231], v27 offset:34816
v_mfma_f32_16x16x32_bf16 a[176:179], v[144:147], v[180:183], 0
ds_read_b64_tr_b16 v[232:233], v28 offset:32768
v_mfma_f32_16x16x32_bf16 a[180:183], v[148:151], v[180:183], 0
ds_read_b64_tr_b16 v[234:235], v28 offset:34816
v_mfma_f32_16x16x32_bf16 a[184:187], v[152:155], v[180:183], 0
ds_read_b64_tr_b16 v[236:237], v29 offset:32768
v_mfma_f32_16x16x32_bf16 a[188:191], v[156:159], v[180:183], 0
ds_read_b64_tr_b16 v[238:239], v29 offset:34816
v_mfma_f32_16x16x32_bf16 a[192:195], v[128:131], v[184:187], 0
ds_read_b64_tr_b16 v[240:241], v30 offset:32768
v_mfma_f32_16x16x32_bf16 a[196:199], v[132:135], v[184:187], 0
s_add_u32 m0, s25, 2048
ds_read_b64_tr_b16 v[242:243], v30 offset:34816
v_mfma_f32_16x16x32_bf16 a[200:203], v[136:139], v[184:187], 0
global_load_lds_dwordx4 v4, s[4:5] sc1
ds_read_b64_tr_b16 v[244:245], v31 offset:32768
v_mfma_f32_16x16x32_bf16 a[204:207], v[140:143], v[184:187], 0
ds_read_b64_tr_b16 v[246:247], v31 offset:34816
v_mfma_f32_16x16x32_bf16 a[208:211], v[144:147], v[184:187], 0
ds_read_b64_tr_b16 v[248:249], v32 offset:32768
v_mfma_f32_16x16x32_bf16 a[212:215], v[148:151], v[184:187], 0
ds_read_b64_tr_b16 v[250:251], v32 offset:34816
v_mfma_f32_16x16x32_bf16 a[216:219], v[152:155], v[184:187], 0
ds_read_b64_tr_b16 v[252:253], v33 offset:32768
v_mfma_f32_16x16x32_bf16 a[220:223], v[156:159], v[184:187], 0
ds_read_b64_tr_b16 v[254:255], v33 offset:34816
v_mfma_f32_16x16x32_bf16 a[224:227], v[128:131], v[188:191], 0
v_mfma_f32_16x16x32_bf16 a[228:231], v[132:135], v[188:191], 0
s_add_u32 m0, s25, 3072
v_mfma_f32_16x16x32_bf16 a[232:235], v[136:139], v[188:191], 0
global_load_lds_dwordx4 v5, s[4:5] sc1
v_mfma_f32_16x16x32_bf16 a[236:239], v[140:143], v[188:191], 0
v_mfma_f32_16x16x32_bf16 a[240:243], v[144:147], v[188:191], 0
v_mfma_f32_16x16x32_bf16 a[244:247], v[148:151], v[188:191], 0
v_mfma_f32_16x16x32_bf16 a[248:251], v[152:155], v[188:191], 0
v_mfma_f32_16x16x32_bf16 a[252:255], v[156:159], v[188:191], 0
s_add_u32 s4, s4, s8
s_addc_u32 s5, s5, 0
M_gl_86:
s_waitcnt lgkmcnt(0)
v_mfma_f32_16x16x32_bf16 a[0:3], v[192:195], v[224:227], a[0:3]
v_mfma_f32_16x16x32_bf16 a[4:7], v[196:199], v[224:227], a[4:7]
s_add_u32 m0, s26, 0
v_mfma_f32_16x16x32_bf16 a[8:11], v[200:203], v[224:227], a[8:11]
global_load_lds_dwordx4 v6, s[6:7]
v_mfma_f32_16x16x32_bf16 a[12:15], v[204:207], v[224:227], a[12:15]
v_mfma_f32_16x16x32_bf16 a[16:19], v[208:211], v[224:227], a[16:19]
v_mfma_f32_16x16x32_bf16 a[20:23], v[212:215], v[224:227], a[20:23]
v_mfma_f32_16x16x32_bf16 a[24:27], v[216:219], v[224:227], a[24:27]
v_mfma_f32_16x16x32_bf16 a[28:31], v[220:223], v[224:227], a[28:31]
v_mfma_f32_16x16x32_bf16 a[32:35], v[192:195], v[228:231], a[32:35]
v_mfma_f32_16x16x32_bf16 a[36:39], v[196:199], v[228:231], a[36:39]
s_add_u32 m0, s26, 1024
v_mfma_f32_16x16x32_bf16 a[40:43], v[200:203], v[228:231], a[40:43]
global_load_lds_dwordx4 v7, s[6:7]
v_mfma_f32_16x16x32_bf16 a[44:47], v[204:207], v[228:231], a[44:47]
v_mfma_f32_16x16x32_bf16 a[48:51], v[208:211], v[228:231], a[48:51]
v_mfma_f32_16x16x32_bf16 a[52:55], v[212:215], v[228:231], a[52:55]
v_mfma_f32_16x16x32_bf16 a[56:59], v[216:219], v[228:231], a[56:59]
v_mfma_f32_16x16x32_bf16 a[60:63], v[220:223], v[228:231], a[60:63]
v_mfma_f32_16x16x32_bf16 a[64:67], v[192:195], v[232:235], a[64:67]
v_mfma_f32_16x16x32_bf16 a[68:71], v[196:199], v[232:235], a[68:71]
s_add_u32 m0, s26, 2048
v_mfma_f32_16x16x32_bf16 a[72:75], v[200:203], v[232:235], a[72:75]
global_load_lds_dwordx4 v8, s[6:7]
v_mfma_f32_16x16x32_bf16 a[76:79], v[204:207], v[232:235], a[76:79]
v_mfma_f32_16x16x32_bf16 a[80:83], v[208:211], v[232:235], a[80:83]
v_mfma_f32_16x16x32_bf16 a[84:87], v[212:215], v[232:235], a[84:87]
v_mfma_f32_16x16x32_bf16 a[88:91], v[216:219], v[232:235], a[88:91]
v_mfma_f32_16x16x32_bf16 a[92:95], v[220:223], v[232:235], a[92:95]
v_mfma_f32_16x16x32_bf16 a[96:99], v[192:195], v[236:239], a[96:99]
v_mfma_f32_16x16x32_bf16 a[100:103], v[196:199], v[236:239], a[100:103]
s_add_u32 m0, s26, 3072
v_mfma_f32_16x16x32_bf16 a[104:107], v[200:203], v[236:239], a[104:107]
global_load_lds_dwordx4 v9, s[6:7]
v_mfma_f32_16x16x32_bf16 a[108:111], v[204:207], v[236:239], a[108:111]
v_mfma_f32_16x16x32_bf16 a[112:115], v[208:211], v[236:239], a[112:115]
v_mfma_f32_16x16x32_bf16 a[116:119], v[212:215], v[236:239], a[116:119]
v_mfma_f32_16x16x32_bf16 a[120:123], v[216:219], v[236:239], a[120:123]
v_mfma_f32_16x16x32_bf16 a[124:127], v[220:223], v[236:239], a[124:127]
s_add_u32 s6, s6, s9
s_addc_u32 s7, s7, 0
s_waitcnt vmcnt(16)
s_barrier
v_mfma_f32_16x16x32_bf16 a[128:131], v[192:195], v[240:243], a[128:131]
ds_read_b64_tr_b16 v[160:161], v34 offset:0
v_mfma_f32_16x16x32_bf16 a[132:135], v[196:199], v[240:243], a[132:135]
s_add_u32 m0, s25, 32768
ds_read_b64_tr_b16 v[162:163], v34 offset:2048
v_mfma_f32_16x16x32_bf16 a[136:139], v[200:203], v[240:243], a[136:139]
global_load_lds_dwordx4 v2, s[4:5] sc1
ds_read_b128 v[128:131], v11 offset:0
v_mfma_f32_16x16x32_bf16 a[140:143], v[204:207], v[240:243], a[140:143]
ds_read_b128 v[132:135], v11 offset:1024
v_mfma_f32_16x16x32_bf16 a[144:147], v[208:211], v[240:243], a[144:147]
ds_read_b128 v[136:139], v11 offset:2048
v_mfma_f32_16x16x32_bf16 a[148:151], v[212:215], v[240:243], a[148:151]
ds_read_b128 v[140:143], v11 offset:3072
v_mfma_f32_16x16x32_bf16 a[152:155], v[216:219], v[240:243], a[152:155]
ds_read_b128 v[144:147], v11 offset:4096
v_mfma_f32_16x16x32_bf16 a[156:159], v[220:223], v[240:243], a[156:159]
ds_read_b128 v[148:151], v11 offset:5120
v_mfma_f32_16x16x32_bf16 a[160:163], v[192:195], v[244:247], a[160:163]
ds_read_b128 v[152:155], v11 offset:6144
v_mfma_f32_16x16x32_bf16 a[164:167], v[196:199], v[244:247], a[164:167]
s_add_u32 m0, s25, 33792
ds_read_b128 v[156:159], v11 offset:7168
v_mfma_f32_16x16x32_bf16 a[168:171], v[200:203], v[244:247], a[168:171]
global_load_lds_dwordx4 v3, s[4:5] sc1
ds_read_b64_tr_b16 v[164:165], v35 offset:0
v_mfma_f32_16x16x32_bf16 a[172:175], v[204:207], v[244:247], a[172:175]
ds_read_b64_tr_b16 v[166:167], v35 offset:2048
v_mfma_f32_16x16x32_bf16 a[176:179], v[208:211], v[244:247], a[176:179]
ds_read_b64_tr_b16 v[168:169], v36 offset:0
v_mfma_f32_16x16x32_bf16 a[180:183], v[212:215], v[244:247], a[180:183]
ds_read_b64_tr_b16 v[170:171], v36 offset:2048
v_mfma_f32_16x16x32_bf16 a[184:187], v[216:219], v[244:247], a[184:187]
ds_read_b64_tr_b16 v[172:173], v37 offset:0
v_mfma_f32_16x16x32_bf16 a[188:191], v[220:223], v[244:247], a[188:191]
ds_read_b64_tr_b16 v[174:175], v37 offset:2048
v_mfma_f32_16x16x32_bf16 a[192:195], v[192:195], v[248:251], a[192:195]
ds_read_b64_tr_b16 v[176:177], v38 offset:0
v_mfma_f32_16x16x32_bf16 a[196:199], v[196:199], v[248:251], a[196:199]
s_add_u32 m0, s25, 34816
ds_read_b64_tr_b16 v[178:179], v38 offset:2048
v_mfma_f32_16x16x32_bf16 a[200:203], v[200:203], v[248:251], a[200:203]
global_load_lds_dwordx4 v4, s[4:5] sc1
ds_read_b64_tr_b16 v[180:181], v39 offset:0
v_mfma_f32_16x16x32_bf16 a[204:207], v[204:207], v[248:251], a[204:207]
ds_read_b64_tr_b16 v[182:183], v39 offset:2048
v_mfma_f32_16x16x32_bf16 a[208:211], v[208:211], v[248:251], a[208:211]
ds_read_b64_tr_b16 v[184:185], v40 offset:0
v_mfma_f32_16x16x32_bf16 a[212:215], v[212:215], v[248:251], a[212:215]
ds_read_b64_tr_b16 v[186:187], v40 offset:2048
v_mfma_f32_16x16x32_bf16 a[216:219], v[216:219], v[248:251], a[216:219]
ds_read_b64_tr_b16 v[188:189], v41 offset:0
v_mfma_f32_16x16x32_bf16 a[220:223], v[220:223], v[248:251], a[220:223]
ds_read_b64_tr_b16 v[190:191], v41 offset:2048
v_mfma_f32_16x16x32_bf16 a[224:227], v[192:195], v[252:255], a[224:227]
v_mfma_f32_16x16x32_bf16 a[228:231], v[196:199], v[252:255], a[228:231]
s_add_u32 m0, s25, 35840
v_mfma_f32_16x16x32_bf16 a[232:235], v[200:203], v[252:255], a[232:235]
global_load_lds_dwordx4 v5, s[4:5] sc1
v_mfma_f32_16x16x32_bf16 a[236:239], v[204:207], v[252:255], a[236:239]
v_mfma_f32_16x16x32_bf16 a[240:243], v[208:211], v[252:255], a[240:243]
v_mfma_f32_16x16x32_bf16 a[244:247], v[212:215], v[252:255], a[244:247]
v_mfma_f32_16x16x32_bf16 a[248:251], v[216:219], v[252:255], a[248:251]
v_mfma_f32_16x16x32_bf16 a[252:255], v[220:223], v[252:255], a[252:255]
s_add_u32 s4, s4, s8
s_addc_u32 s5, s5, 0
s_waitcnt lgkmcnt(0)
v_mfma_f32_16x16x32_bf16 a[0:3], v[128:131], v[160:163], a[0:3]
v_mfma_f32_16x16x32_bf16 a[4:7], v[132:135], v[160:163], a[4:7]
s_add_u32 m0, s26, 32768
v_mfma_f32_16x16x32_bf16 a[8:11], v[136:139], v[160:163], a[8:11]
global_load_lds_dwordx4 v6, s[6:7]
v_mfma_f32_16x16x32_bf16 a[12:15], v[140:143], v[160:163], a[12:15]
v_mfma_f32_16x16x32_bf16 a[16:19], v[144:147], v[160:163], a[16:19]
v_mfma_f32_16x16x32_bf16 a[20:23], v[148:151], v[160:163], a[20:23]
v_mfma_f32_16x16x32_bf16 a[24:27], v[152:155], v[160:163], a[24:27]
v_mfma_f32_16x16x32_bf16 a[28:31], v[156:159], v[160:163], a[28:31]
v_mfma_f32_16x16x32_bf16 a[32:35], v[128:131], v[164:167], a[32:35]
v_mfma_f32_16x16x32_bf16 a[36:39], v[132:135], v[164:167], a[36:39]
s_add_u32 m0, s26, 33792
v_mfma_f32_16x16x32_bf16 a[40:43], v[136:139], v[164:167], a[40:43]
global_load_lds_dwordx4 v7, s[6:7]
v_mfma_f32_16x16x32_bf16 a[44:47], v[140:143], v[164:167], a[44:47]
v_mfma_f32_16x16x32_bf16 a[48:51], v[144:147], v[164:167], a[48:51]
v_mfma_f32_16x16x32_bf16 a[52:55], v[148:151], v[164:167], a[52:55]
v_mfma_f32_16x16x32_bf16 a[56:59], v[152:155], v[164:167], a[56:59]
v_mfma_f32_16x16x32_bf16 a[60:63], v[156:159], v[164:167], a[60:63]
v_mfma_f32_16x16x32_bf16 a[64:67], v[128:131], v[168:171], a[64:67]
v_mfma_f32_16x16x32_bf16 a[68:71], v[132:135], v[168:171], a[68:71]
s_add_u32 m0, s26, 34816
v_mfma_f32_16x16x32_bf16 a[72:75], v[136:139], v[168:171], a[72:75]
global_load_lds_dwordx4 v8, s[6:7]
v_mfma_f32_16x16x32_bf16 a[76:79], v[140:143], v[168:171], a[76:79]
v_mfma_f32_16x16x32_bf16 a[80:83], v[144:147], v[168:171], a[80:83]
v_mfma_f32_16x16x32_bf16 a[84:87], v[148:151], v[168:171], a[84:87]
v_mfma_f32_16x16x32_bf16 a[88:91], v[152:155], v[168:171], a[88:91]
v_mfma_f32_16x16x32_bf16 a[92:95], v[156:159], v[168:171], a[92:95]
v_mfma_f32_16x16x32_bf16 a[96:99], v[128:131], v[172:175], a[96:99]
v_mfma_f32_16x16x32_bf16 a[100:103], v[132:135], v[172:175], a[100:103]
s_add_u32 m0, s26, 35840
v_mfma_f32_16x16x32_bf16 a[104:107], v[136:139], v[172:175], a[104:107]
global_load_lds_dwordx4 v9, s[6:7]
v_mfma_f32_16x16x32_bf16 a[108:111], v[140:143], v[172:175], a[108:111]
v_mfma_f32_16x16x32_bf16 a[112:115], v[144:147], v[172:175], a[112:115]
v_mfma_f32_16x16x32_bf16 a[116:119], v[148:151], v[172:175], a[116:119]
v_mfma_f32_16x16x32_bf16 a[120:123], v[152:155], v[172:175], a[120:123]
v_mfma_f32_16x16x32_bf16 a[124:127], v[156:159], v[172:175], a[124:127]
s_add_u32 s6, s6, s9
s_addc_u32 s7, s7, 0
s_waitcnt vmcnt(16)
s_barrier
v_mfma_f32_16x16x32_bf16 a[128:131], v[128:131], v[176:179], a[128:131]
ds_read_b64_tr_b16 v[224:225], v34 offset:32768
v_mfma_f32_16x16x32_bf16 a[132:135], v[132:135], v[176:179], a[132:135]
s_add_u32 m0, s25, 65536
ds_read_b64_tr_b16 v[226:227], v34 offset:34816
v_mfma_f32_16x16x32_bf16 a[136:139], v[136:139], v[176:179], a[136:139]
global_load_lds_dwordx4 v2, s[4:5] sc1
ds_read_b128 v[192:195], v11 offset:32768
v_mfma_f32_16x16x32_bf16 a[140:143], v[140:143], v[176:179], a[140:143]
ds_read_b128 v[196:199], v11 offset:33792
v_mfma_f32_16x16x32_bf16 a[144:147], v[144:147], v[176:179], a[144:147]
ds_read_b128 v[200:203], v11 offset:34816
v_mfma_f32_16x16x32_bf16 a[148:151], v[148:151], v[176:179], a[148:151]
ds_read_b128 v[204:207], v11 offset:35840
v_mfma_f32_16x16x32_bf16 a[152:155], v[152:155], v[176:179], a[152:155]
ds_read_b128 v[208:211], v11 offset:36864
v_mfma_f32_16x16x32_bf16 a[156:159], v[156:159], v[176:179], a[156:159]
ds_read_b128 v[212:215], v11 offset:37888
v_mfma_f32_16x16x32_bf16 a[160:163], v[128:131], v[180:183], a[160:163]
ds_read_b128 v[216:219], v11 offset:38912
v_mfma_f32_16x16x32_bf16 a[164:167], v[132:135], v[180:183], a[164:167]
s_add_u32 m0, s25, 66560
ds_read_b128 v[220:223], v11 offset:39936
v_mfma_f32_16x16x32_bf16 a[168:171], v[136:139], v[180:183], a[168:171]
global_load_lds_dwordx4 v3, s[4:5] sc1
ds_read_b64_tr_b16 v[228:229], v35 offset:32768
v_mfma_f32_16x16x32_bf16 a[172:175], v[140:143], v[180:183], a[172:175]
ds_read_b64_tr_b16 v[230:231], v35 offset:34816
v_mfma_f32_16x16x32_bf16 a[176:179], v[144:147], v[180:183], a[176:179]
ds_read_b64_tr_b16 v[232:233], v36 offset:32768
v_mfma_f32_16x16x32_bf16 a[180:183], v[148:151], v[180:183], a[180:183]
ds_read_b64_tr_b16 v[234:235], v36 offset:34816
v_mfma_f32_16x16x32_bf16 a[184:187], v[152:155], v[180:183], a[184:187]
ds_read_b64_tr_b16 v[236:237], v37 offset:32768
v_mfma_f32_16x16x32_bf16 a[188:191], v[156:159], v[180:183], a[188:191]
ds_read_b64_tr_b16 v[238:239], v37 offset:34816
v_mfma_f32_16x16x32_bf16 a[192:195], v[128:131], v[184:187], a[192:195]
ds_read_b64_tr_b16 v[240:241], v38 offset:32768
v_mfma_f32_16x16x32_bf16 a[196:199], v[132:135], v[184:187], a[196:199]
s_add_u32 m0, s25, 67584
ds_read_b64_tr_b16 v[242:243], v38 offset:34816
v_mfma_f32_16x16x32_bf16 a[200:203], v[136:139], v[184:187], a[200:203]
global_load_lds_dwordx4 v4, s[4:5] sc1
ds_read_b64_tr_b16 v[244:245], v39 offset:32768
v_mfma_f32_16x16x32_bf16 a[204:207], v[140:143], v[184:187], a[204:207]
ds_read_b64_tr_b16 v[246:247], v39 offset:34816
v_mfma_f32_16x16x32_bf16 a[208:211], v[144:147], v[184:187], a[208:211]
ds_read_b64_tr_b16 v[248:249], v40 offset:32768
v_mfma_f32_16x16x32_bf16 a[212:215], v[148:151], v[184:187], a[212:215]
ds_read_b64_tr_b16 v[250:251], v40 offset:34816
v_mfma_f32_16x16x32_bf16 a[216:219], v[152:155], v[184:187], a[216:219]
ds_read_b64_tr_b16 v[252:253], v41 offset:32768
v_mfma_f32_16x16x32_bf16 a[220:223], v[156:159], v[184:187], a[220:223]
ds_read_b64_tr_b16 v[254:255], v41 offset:34816
v_mfma_f32_16x16x32_bf16 a[224:227], v[128:131], v[188:191], a[224:227]
v_mfma_f32_16x16x32_bf16 a[228:231], v[132:135], v[188:191], a[228:231]
s_add_u32 m0, s25, 68608
v_mfma_f32_16x16x32_bf16 a[232:235], v[136:139], v[188:191], a[232:235]
global_load_lds_dwordx4 v5, s[4:5] sc1
v_mfma_f32_16x16x32_bf16 a[236:239], v[140:143], v[188:191], a[236:239]
v_mfma_f32_16x16x32_bf16 a[240:243], v[144:147], v[188:191], a[240:243]
v_mfma_f32_16x16x32_bf16 a[244:247], v[148:151], v[188:191], a[244:247]
v_mfma_f32_16x16x32_bf16 a[248:251], v[152:155], v[188:191], a[248:251]
v_mfma_f32_16x16x32_bf16 a[252:255], v[156:159], v[188:191], a[252:255]
s_add_u32 s4, s4, s8
s_addc_u32 s5, s5, 0
s_waitcnt lgkmcnt(0)
v_mfma_f32_16x16x32_bf16 a[0:3], v[192:195], v[224:227], a[0:3]
v_mfma_f32_16x16x32_bf16 a[4:7], v[196:199], v[224:227], a[4:7]
s_add_u32 m0, s26, 65536
v_mfma_f32_16x16x32_bf16 a[8:11], v[200:203], v[224:227], a[8:11]
global_load_lds_dwordx4 v6, s[6:7]
v_mfma_f32_16x16x32_bf16 a[12:15], v[204:207], v[224:227], a[12:15]
v_mfma_f32_16x16x32_bf16 a[16:19], v[208:211], v[224:227], a[16:19]
v_mfma_f32_16x16x32_bf16 a[20:23], v[212:215], v[224:227], a[20:23]
v_mfma_f32_16x16x32_bf16 a[24:27], v[216:219], v[224:227], a[24:27]
v_mfma_f32_16x16x32_bf16 a[28:31], v[220:223], v[224:227], a[28:31]
v_mfma_f32_16x16x32_bf16 a[32:35], v[192:195], v[228:231], a[32:35]
v_mfma_f32_16x16x32_bf16 a[36:39], v[196:199], v[228:231], a[36:39]
s_add_u32 m0, s26, 66560
v_mfma_f32_16x16x32_bf16 a[40:43], v[200:203], v[228:231], a[40:43]
global_load_lds_dwordx4 v7, s[6:7]
v_mfma_f32_16x16x32_bf16 a[44:47], v[204:207], v[228:231], a[44:47]
v_mfma_f32_16x16x32_bf16 a[48:51], v[208:211], v[228:231], a[48:51]
v_mfma_f32_16x16x32_bf16 a[52:55], v[212:215], v[228:231], a[52:55]
v_mfma_f32_16x16x32_bf16 a[56:59], v[216:219], v[228:231], a[56:59]
v_mfma_f32_16x16x32_bf16 a[60:63], v[220:223], v[228:231], a[60:63]
v_mfma_f32_16x16x32_bf16 a[64:67], v[192:195], v[232:235], a[64:67]
v_mfma_f32_16x16x32_bf16 a[68:71], v[196:199], v[232:235], a[68:71]
s_add_u32 m0, s26, 67584
v_mfma_f32_16x16x32_bf16 a[72:75], v[200:203], v[232:235], a[72:75]
global_load_lds_dwordx4 v8, s[6:7]
v_mfma_f32_16x16x32_bf16 a[76:79], v[204:207], v[232:235], a[76:79]
v_mfma_f32_16x16x32_bf16 a[80:83], v[208:211], v[232:235], a[80:83]
v_mfma_f32_16x16x32_bf16 a[84:87], v[212:215], v[232:235], a[84:87]
v_mfma_f32_16x16x32_bf16 a[88:91], v[216:219], v[232:235], a[88:91]
v_mfma_f32_16x16x32_bf16 a[92:95], v[220:223], v[232:235], a[92:95]
v_mfma_f32_16x16x32_bf16 a[96:99], v[192:195], v[236:239], a[96:99]
v_mfma_f32_16x16x32_bf16 a[100:103], v[196:199], v[236:239], a[100:103]
s_add_u32 m0, s26, 68608
v_mfma_f32_16x16x32_bf16 a[104:107], v[200:203], v[236:239], a[104:107]
global_load_lds_dwordx4 v9, s[6:7]
v_mfma_f32_16x16x32_bf16 a[108:111], v[204:207], v[236:239], a[108:111]
v_mfma_f32_16x16x32_bf16 a[112:115], v[208:211], v[236:239], a[112:115]
v_mfma_f32_16x16x32_bf16 a[116:119], v[212:215], v[236:239], a[116:119]
v_mfma_f32_16x16x32_bf16 a[120:123], v[216:219], v[236:239], a[120:123]
v_mfma_f32_16x16x32_bf16 a[124:127], v[220:223], v[236:239], a[124:127]
s_add_u32 s6, s6, s9
s_addc_u32 s7, s7, 0
s_waitcnt vmcnt(16)
s_barrier
v_mfma_f32_16x16x32_bf16 a[128:131], v[192:195], v[240:243], a[128:131]
ds_read_b64_tr_b16 v[160:161], v26 offset:0
v_mfma_f32_16x16x32_bf16 a[132:135], v[196:199], v[240:243], a[132:135]
s_add_u32 m0, s25, 98304
ds_read_b64_tr_b16 v[162:163], v26 offset:2048
v_mfma_f32_16x16x32_bf16 a[136:139], v[200:203], v[240:243], a[136:139]
global_load_lds_dwordx4 v2, s[4:5] sc1
ds_read_b128 v[128:131], v10 offset:0
v_mfma_f32_16x16x32_bf16 a[140:143], v[204:207], v[240:243], a[140:143]
ds_read_b128 v[132:135], v10 offset:1024
v_mfma_f32_16x16x32_bf16 a[144:147], v[208:211], v[240:243], a[144:147]
ds_read_b128 v[136:139], v10 offset:2048
v_mfma_f32_16x16x32_bf16 a[148:151], v[212:215], v[240:243], a[148:151]
ds_read_b128 v[140:143], v10 offset:3072
v_mfma_f32_16x16x32_bf16 a[152:155], v[216:219], v[240:243], a[152:155]
ds_read_b128 v[144:147], v10 offset:4096
v_mfma_f32_16x16x32_bf16 a[156:159], v[220:223], v[240:243], a[156:159]
ds_read_b128 v[148:151], v10 offset:5120
v_mfma_f32_16x16x32_bf16 a[160:163], v[192:195], v[244:247], a[160:163]
ds_read_b128 v[152:155], v10 offset:6144
v_mfma_f32_16x16x32_bf16 a[164:167], v[196:199], v[244:247], a[164:167]
s_add_u32 m0, s25, 99328
ds_read_b128 v[156:159], v10 offset:7168
v_mfma_f32_16x16x32_bf16 a[168:171], v[200:203], v[244:247], a[168:171]
global_load_lds_dwordx4 v3, s[4:5] sc1
ds_read_b64_tr_b16 v[164:165], v27 offset:0
v_mfma_f32_16x16x32_bf16 a[172:175], v[204:207], v[244:247], a[172:175]
ds_read_b64_tr_b16 v[166:167], v27 offset:2048
v_mfma_f32_16x16x32_bf16 a[176:179], v[208:211], v[244:247], a[176:179]
ds_read_b64_tr_b16 v[168:169], v28 offset:0
v_mfma_f32_16x16x32_bf16 a[180:183], v[212:215], v[244:247], a[180:183]
ds_read_b64_tr_b16 v[170:171], v28 offset:2048
v_mfma_f32_16x16x32_bf16 a[184:187], v[216:219], v[244:247], a[184:187]
ds_read_b64_tr_b16 v[172:173], v29 offset:0
v_mfma_f32_16x16x32_bf16 a[188:191], v[220:223], v[244:247], a[188:191]
ds_read_b64_tr_b16 v[174:175], v29 offset:2048
v_mfma_f32_16x16x32_bf16 a[192:195], v[192:195], v[248:251], a[192:195]
ds_read_b64_tr_b16 v[176:177], v30 offset:0
v_mfma_f32_16x16x32_bf16 a[196:199], v[196:199], v[248:251], a[196:199]
s_add_u32 m0, s25, 100352
ds_read_b64_tr_b16 v[178:179], v30 offset:2048
v_mfma_f32_16x16x32_bf16 a[200:203], v[200:203], v[248:251], a[200:203]
global_load_lds_dwordx4 v4, s[4:5] sc1
ds_read_b64_tr_b16 v[180:181], v31 offset:0
v_mfma_f32_16x16x32_bf16 a[204:207], v[204:207], v[248:251], a[204:207]
ds_read_b64_tr_b16 v[182:183], v31 offset:2048
v_mfma_f32_16x16x32_bf16 a[208:211], v[208:211], v[248:251], a[208:211]
ds_read_b64_tr_b16 v[184:185], v32 offset:0
v_mfma_f32_16x16x32_bf16 a[212:215], v[212:215], v[248:251], a[212:215]
ds_read_b64_tr_b16 v[186:187], v32 offset:2048
v_mfma_f32_16x16x32_bf16 a[216:219], v[216:219], v[248:251], a[216:219]
ds_read_b64_tr_b16 v[188:189], v33 offset:0
v_mfma_f32_16x16x32_bf16 a[220:223], v[220:223], v[248:251], a[220:223]
ds_read_b64_tr_b16 v[190:191], v33 offset:2048
v_mfma_f32_16x16x32_bf16 a[224:227], v[192:195], v[252:255], a[224:227]
v_mfma_f32_16x16x32_bf16 a[228:231], v[196:199], v[252:255], a[228:231]
s_add_u32 m0, s25, 101376
v_mfma_f32_16x16x32_bf16 a[232:235], v[200:203], v[252:255], a[232:235]
global_load_lds_dwordx4 v5, s[4:5] sc1
v_mfma_f32_16x16x32_bf16 a[236:239], v[204:207], v[252:255], a[236:239]
v_mfma_f32_16x16x32_bf16 a[240:243], v[208:211], v[252:255], a[240:243]
v_mfma_f32_16x16x32_bf16 a[244:247], v[212:215], v[252:255], a[244:247]
v_mfma_f32_16x16x32_bf16 a[248:251], v[216:219], v[252:255], a[248:251]
v_mfma_f32_16x16x32_bf16 a[252:255], v[220:223], v[252:255], a[252:255]
s_add_u32 s4, s4, s8
s_addc_u32 s5, s5, 0
s_sub_u32 s11, s11, 1
s_cmp_eq_u32 s11, 0
s_cbranch_scc1 M_gle_87
s_waitcnt lgkmcnt(0)
v_mfma_f32_16x16x32_bf16 a[0:3], v[128:131], v[160:163], a[0:3]
v_mfma_f32_16x16x32_bf16 a[4:7], v[132:135], v[160:163], a[4:7]
s_add_u32 m0, s26, 98304
v_mfma_f32_16x16x32_bf16 a[8:11], v[136:139], v[160:163], a[8:11]
global_load_lds_dwordx4 v6, s[6:7]
v_mfma_f32_16x16x32_bf16 a[12:15], v[140:143], v[160:163], a[12:15]
v_mfma_f32_16x16x32_bf16 a[16:19], v[144:147], v[160:163], a[16:19]
v_mfma_f32_16x16x32_bf16 a[20:23], v[148:151], v[160:163], a[20:23]
v_mfma_f32_16x16x32_bf16 a[24:27], v[152:155], v[160:163], a[24:27]
v_mfma_f32_16x16x32_bf16 a[28:31], v[156:159], v[160:163], a[28:31]
v_mfma_f32_16x16x32_bf16 a[32:35], v[128:131], v[164:167], a[32:35]
v_mfma_f32_16x16x32_bf16 a[36:39], v[132:135], v[164:167], a[36:39]
s_add_u32 m0, s26, 99328
v_mfma_f32_16x16x32_bf16 a[40:43], v[136:139], v[164:167], a[40:43]
global_load_lds_dwordx4 v7, s[6:7]
v_mfma_f32_16x16x32_bf16 a[44:47], v[140:143], v[164:167], a[44:47]
v_mfma_f32_16x16x32_bf16 a[48:51], v[144:147], v[164:167], a[48:51]
v_mfma_f32_16x16x32_bf16 a[52:55], v[148:151], v[164:167], a[52:55]
v_mfma_f32_16x16x32_bf16 a[56:59], v[152:155], v[164:167], a[56:59]
v_mfma_f32_16x16x32_bf16 a[60:63], v[156:159], v[164:167], a[60:63]
v_mfma_f32_16x16x32_bf16 a[64:67], v[128:131], v[168:171], a[64:67]
v_mfma_f32_16x16x32_bf16 a[68:71], v[132:135], v[168:171], a[68:71]
s_add_u32 m0, s26, 100352
v_mfma_f32_16x16x32_bf16 a[72:75], v[136:139], v[168:171], a[72:75]
global_load_lds_dwordx4 v8, s[6:7]
v_mfma_f32_16x16x32_bf16 a[76:79], v[140:143], v[168:171], a[76:79]
v_mfma_f32_16x16x32_bf16 a[80:83], v[144:147], v[168:171], a[80:83]
v_mfma_f32_16x16x32_bf16 a[84:87], v[148:151], v[168:171], a[84:87]
v_mfma_f32_16x16x32_bf16 a[88:91], v[152:155], v[168:171], a[88:91]
v_mfma_f32_16x16x32_bf16 a[92:95], v[156:159], v[168:171], a[92:95]
v_mfma_f32_16x16x32_bf16 a[96:99], v[128:131], v[172:175], a[96:99]
v_mfma_f32_16x16x32_bf16 a[100:103], v[132:135], v[172:175], a[100:103]
s_add_u32 m0, s26, 101376
v_mfma_f32_16x16x32_bf16 a[104:107], v[136:139], v[172:175], a[104:107]
global_load_lds_dwordx4 v9, s[6:7]
v_mfma_f32_16x16x32_bf16 a[108:111], v[140:143], v[172:175], a[108:111]
v_mfma_f32_16x16x32_bf16 a[112:115], v[144:147], v[172:175], a[112:115]
v_mfma_f32_16x16x32_bf16 a[116:119], v[148:151], v[172:175], a[116:119]
v_mfma_f32_16x16x32_bf16 a[120:123], v[152:155], v[172:175], a[120:123]
v_mfma_f32_16x16x32_bf16 a[124:127], v[156:159], v[172:175], a[124:127]
s_add_u32 s6, s6, s9
s_addc_u32 s7, s7, 0
s_waitcnt vmcnt(16)
s_barrier
v_mfma_f32_16x16x32_bf16 a[128:131], v[128:131], v[176:179], a[128:131]
ds_read_b64_tr_b16 v[224:225], v26 offset:32768
v_mfma_f32_16x16x32_bf16 a[132:135], v[132:135], v[176:179], a[132:135]
s_add_u32 m0, s25, 0
ds_read_b64_tr_b16 v[226:227], v26 offset:34816
v_mfma_f32_16x16x32_bf16 a[136:139], v[136:139], v[176:179], a[136:139]
global_load_lds_dwordx4 v2, s[4:5] sc1
ds_read_b128 v[192:195], v10 offset:32768
v_mfma_f32_16x16x32_bf16 a[140:143], v[140:143], v[176:179], a[140:143]
ds_read_b128 v[196:199], v10 offset:33792
v_mfma_f32_16x16x32_bf16 a[144:147], v[144:147], v[176:179], a[144:147]
ds_read_b128 v[200:203], v10 offset:34816
v_mfma_f32_16x16x32_bf16 a[148:151], v[148:151], v[176:179], a[148:151]
ds_read_b128 v[204:207], v10 offset:35840
v_mfma_f32_16x16x32_bf16 a[152:155], v[152:155], v[176:179], a[152:155]
ds_read_b128 v[208:211], v10 offset:36864
v_mfma_f32_16x16x32_bf16 a[156:159], v[156:159], v[176:179], a[156:159]
ds_read_b128 v[212:215], v10 offset:37888
v_mfma_f32_16x16x32_bf16 a[160:163], v[128:131], v[180:183], a[160:163]
ds_read_b128 v[216:219], v10 offset:38912
v_mfma_f32_16x16x32_bf16 a[164:167], v[132:135], v[180:183], a[164:167]
s_add_u32 m0, s25, 1024
ds_read_b128 v[220:223], v10 offset:39936
v_mfma_f32_16x16x32_bf16 a[168:171], v[136:139], v[180:183], a[168:171]
global_load_lds_dwordx4 v3, s[4:5] sc1
ds_read_b64_tr_b16 v[228:229], v27 offset:32768
v_mfma_f32_16x16x32_bf16 a[172:175], v[140:143], v[180:183], a[172:175]
ds_read_b64_tr_b16 v[230:231], v27 offset:34816
v_mfma_f32_16x16x32_bf16 a[176:179], v[144:147], v[180:183], a[176:179]
ds_read_b64_tr_b16 v[232:233], v28 offset:32768
v_mfma_f32_16x16x32_bf16 a[180:183], v[148:151], v[180:183], a[180:183]
ds_read_b64_tr_b16 v[234:235], v28 offset:34816
v_mfma_f32_16x16x32_bf16 a[184:187], v[152:155], v[180:183], a[184:187]
ds_read_b64_tr_b16 v[236:237], v29 offset:32768
v_mfma_f32_16x16x32_bf16 a[188:191], v[156:159], v[180:183], a[188:191]
ds_read_b64_tr_b16 v[238:239], v29 offset:34816
v_mfma_f32_16x16x32_bf16 a[192:195], v[128:131], v[184:187], a[192:195]
ds_read_b64_tr_b16 v[240:241], v30 offset:32768
v_mfma_f32_16x16x32_bf16 a[196:199], v[132:135], v[184:187], a[196:199]
s_add_u32 m0, s25, 2048
ds_read_b64_tr_b16 v[242:243], v30 offset:34816
v_mfma_f32_16x16x32_bf16 a[200:203], v[136:139], v[184:187], a[200:203]
global_load_lds_dwordx4 v4, s[4:5] sc1
ds_read_b64_tr_b16 v[244:245], v31 offset:32768
v_mfma_f32_16x16x32_bf16 a[204:207], v[140:143], v[184:187], a[204:207]
ds_read_b64_tr_b16 v[246:247], v31 offset:34816
v_mfma_f32_16x16x32_bf16 a[208:211], v[144:147], v[184:187], a[208:211]
ds_read_b64_tr_b16 v[248:249], v32 offset:32768
v_mfma_f32_16x16x32_bf16 a[212:215], v[148:151], v[184:187], a[212:215]
ds_read_b64_tr_b16 v[250:251], v32 offset:34816
v_mfma_f32_16x16x32_bf16 a[216:219], v[152:155], v[184:187], a[216:219]
ds_read_b64_tr_b16 v[252:253], v33 offset:32768
v_mfma_f32_16x16x32_bf16 a[220:223], v[156:159], v[184:187], a[220:223]
ds_read_b64_tr_b16 v[254:255], v33 offset:34816
v_mfma_f32_16x16x32_bf16 a[224:227], v[128:131], v[188:191], a[224:227]
v_mfma_f32_16x16x32_bf16 a[228:231], v[132:135], v[188:191], a[228:231]
s_add_u32 m0, s25, 3072
v_mfma_f32_16x16x32_bf16 a[232:235], v[136:139], v[188:191], a[232:235]
global_load_lds_dwordx4 v5, s[4:5] sc1
v_mfma_f32_16x16x32_bf16 a[236:239], v[140:143], v[188:191], a[236:239]
v_mfma_f32_16x16x32_bf16 a[240:243], v[144:147], v[188:191], a[240:243]
v_mfma_f32_16x16x32_bf16 a[244:247], v[148:151], v[188:191], a[244:247]
v_mfma_f32_16x16x32_bf16 a[248:251], v[152:155], v[188:191], a[248:251]
v_mfma_f32_16x16x32_bf16 a[252:255], v[156:159], v[188:191], a[252:255]
s_add_u32 s4, s4, s8
s_addc_u32 s5, s5, 0
s_branch M_gl_86
M_gle_87:
s_waitcnt lgkmcnt(0)
v_mfma_f32_16x16x32_bf16 a[0:3], v[128:131], v[160:163], a[0:3]
v_mfma_f32_16x16x32_bf16 a[4:7], v[132:135], v[160:163], a[4:7]
s_add_u32 m0, s26, 98304
v_mfma_f32_16x16x32_bf16 a[8:11], v[136:139], v[160:163], a[8:11]
global_load_lds_dwordx4 v6, s[6:7]
v_mfma_f32_16x16x32_bf16 a[12:15], v[140:143], v[160:163], a[12:15]
v_mfma_f32_16x16x32_bf16 a[16:19], v[144:147], v[160:163], a[16:19]
v_mfma_f32_16x16x32_bf16 a[20:23], v[148:151], v[160:163], a[20:23]
v_mfma_f32_16x16x32_bf16 a[24:27], v[152:155], v[160:163], a[24:27]
v_mfma_f32_16x16x32_bf16 a[28:31], v[156:159], v[160:163], a[28:31]
v_mfma_f32_16x16x32_bf16 a[32:35], v[128:131], v[164:167], a[32:35]
v_mfma_f32_16x16x32_bf16 a[36:39], v[132:135], v[164:167], a[36:39]
s_add_u32 m0, s26, 99328
v_mfma_f32_16x16x32_bf16 a[40:43], v[136:139], v[164:167], a[40:43]
global_load_lds_dwordx4 v7, s[6:7]
v_mfma_f32_16x16x32_bf16 a[44:47], v[140:143], v[164:167], a[44:47]
v_mfma_f32_16x16x32_bf16 a[48:51], v[144:147], v[164:167], a[48:51]
v_mfma_f32_16x16x32_bf16 a[52:55], v[148:151], v[164:167], a[52:55]
v_mfma_f32_16x16x32_bf16 a[56:59], v[152:155], v[164:167], a[56:59]
v_mfma_f32_16x16x32_bf16 a[60:63], v[156:159], v[164:167], a[60:63]
v_mfma_f32_16x16x32_bf16 a[64:67], v[128:131], v[168:171], a[64:67]
v_mfma_f32_16x16x32_bf16 a[68:71], v[132:135], v[168:171], a[68:71]
s_add_u32 m0, s26, 100352
v_mfma_f32_16x16x32_bf16 a[72:75], v[136:139], v[168:171], a[72:75]
global_load_lds_dwordx4 v8, s[6:7]
v_mfma_f32_16x16x32_bf16 a[76:79], v[140:143], v[168:171], a[76:79]
v_mfma_f32_16x16x32_bf16 a[80:83], v[144:147], v[168:171], a[80:83]
v_mfma_f32_16x16x32_bf16 a[84:87], v[148:151], v[168:171], a[84:87]
v_mfma_f32_16x16x32_bf16 a[88:91], v[152:155], v[168:171], a[88:91]
v_mfma_f32_16x16x32_bf16 a[92:95], v[156:159], v[168:171], a[92:95]
v_mfma_f32_16x16x32_bf16 a[96:99], v[128:131], v[172:175], a[96:99]
v_mfma_f32_16x16x32_bf16 a[100:103], v[132:135], v[172:175], a[100:103]
s_add_u32 m0, s26, 101376
v_mfma_f32_16x16x32_bf16 a[104:107], v[136:139], v[172:175], a[104:107]
global_load_lds_dwordx4 v9, s[6:7]
v_mfma_f32_16x16x32_bf16 a[108:111], v[140:143], v[172:175], a[108:111]
v_mfma_f32_16x16x32_bf16 a[112:115], v[144:147], v[172:175], a[112:115]
v_mfma_f32_16x16x32_bf16 a[116:119], v[148:151], v[172:175], a[116:119]
v_mfma_f32_16x16x32_bf16 a[120:123], v[152:155], v[172:175], a[120:123]
v_mfma_f32_16x16x32_bf16 a[124:127], v[156:159], v[172:175], a[124:127]
s_add_u32 s6, s6, s9
s_addc_u32 s7, s7, 0
s_waitcnt vmcnt(16)
s_barrier
v_mfma_f32_16x16x32_bf16 a[128:131], v[128:131], v[176:179], a[128:131]
ds_read_b64_tr_b16 v[224:225], v26 offset:32768
v_mfma_f32_16x16x32_bf16 a[132:135], v[132:135], v[176:179], a[132:135]
ds_read_b64_tr_b16 v[226:227], v26 offset:34816
v_mfma_f32_16x16x32_bf16 a[136:139], v[136:139], v[176:179], a[136:139]
ds_read_b128 v[192:195], v10 offset:32768
v_mfma_f32_16x16x32_bf16 a[140:143], v[140:143], v[176:179], a[140:143]
ds_read_b128 v[196:199], v10 offset:33792
v_mfma_f32_16x16x32_bf16 a[144:147], v[144:147], v[176:179], a[144:147]
ds_read_b128 v[200:203], v10 offset:34816
v_mfma_f32_16x16x32_bf16 a[148:151], v[148:151], v[176:179], a[148:151]
ds_read_b128 v[204:207], v10 offset:35840
v_mfma_f32_16x16x32_bf16 a[152:155], v[152:155], v[176:179], a[152:155]
ds_read_b128 v[208:211], v10 offset:36864
v_mfma_f32_16x16x32_bf16 a[156:159], v[156:159], v[176:179], a[156:159]
ds_read_b128 v[212:215], v10 offset:37888
v_mfma_f32_16x16x32_bf16 a[160:163], v[128:131], v[180:183], a[160:163]
ds_read_b128 v[216:219], v10 offset:38912
v_mfma_f32_16x16x32_bf16 a[164:167], v[132:135], v[180:183], a[164:167]
ds_read_b128 v[220:223], v10 offset:39936
v_mfma_f32_16x16x32_bf16 a[168:171], v[136:139], v[180:183], a[168:171]
ds_read_b64_tr_b16 v[228:229], v27 offset:32768
v_mfma_f32_16x16x32_bf16 a[172:175], v[140:143], v[180:183], a[172:175]
ds_read_b64_tr_b16 v[230:231], v27 offset:34816
v_mfma_f32_16x16x32_bf16 a[176:179], v[144:147], v[180:183], a[176:179]
ds_read_b64_tr_b16 v[232:233], v28 offset:32768
v_mfma_f32_16x16x32_bf16 a[180:183], v[148:151], v[180:183], a[180:183]
ds_read_b64_tr_b16 v[234:235], v28 offset:34816
v_mfma_f32_16x16x32_bf16 a[184:187], v[152:155], v[180:183], a[184:187]
ds_read_b64_tr_b16 v[236:237], v29 offset:32768
v_mfma_f32_16x16x32_bf16 a[188:191], v[156:159], v[180:183], a[188:191]
ds_read_b64_tr_b16 v[238:239], v29 offset:34816
v_mfma_f32_16x16x32_bf16 a[192:195], v[128:131], v[184:187], a[192:195]
ds_read_b64_tr_b16 v[240:241], v30 offset:32768
v_mfma_f32_16x16x32_bf16 a[196:199], v[132:135], v[184:187], a[196:199]
ds_read_b64_tr_b16 v[242:243], v30 offset:34816
v_mfma_f32_16x16x32_bf16 a[200:203], v[136:139], v[184:187], a[200:203]
ds_read_b64_tr_b16 v[244:245], v31 offset:32768
v_mfma_f32_16x16x32_bf16 a[204:207], v[140:143], v[184:187], a[204:207]
ds_read_b64_tr_b16 v[246:247], v31 offset:34816
v_mfma_f32_16x16x32_bf16 a[208:211], v[144:147], v[184:187], a[208:211]
ds_read_b64_tr_b16 v[248:249], v32 offset:32768
v_mfma_f32_16x16x32_bf16 a[212:215], v[148:151], v[184:187], a[212:215]
ds_read_b64_tr_b16 v[250:251], v32 offset:34816
v_mfma_f32_16x16x32_bf16 a[216:219], v[152:155], v[184:187], a[216:219]
ds_read_b64_tr_b16 v[252:253], v33 offset:32768
v_mfma_f32_16x16x32_bf16 a[220:223], v[156:159], v[184:187], a[220:223]
ds_read_b64_tr_b16 v[254:255], v33 offset:34816
v_mfma_f32_16x16x32_bf16 a[224:227], v[128:131], v[188:191], a[224:227]
v_mfma_f32_16x16x32_bf16 a[228:231], v[132:135], v[188:191], a[228:231]
v_mfma_f32_16x16x32_bf16 a[232:235], v[136:139], v[188:191], a[232:235]
v_mfma_f32_16x16x32_bf16 a[236:239], v[140:143], v[188:191], a[236:239]
v_mfma_f32_16x16x32_bf16 a[240:243], v[144:147], v[188:191], a[240:243]
v_mfma_f32_16x16x32_bf16 a[244:247], v[148:151], v[188:191], a[244:247]
v_mfma_f32_16x16x32_bf16 a[248:251], v[152:155], v[188:191], a[248:251]
v_mfma_f32_16x16x32_bf16 a[252:255], v[156:159], v[188:191], a[252:255]
s_waitcnt lgkmcnt(0)
v_mfma_f32_16x16x32_bf16 a[0:3], v[192:195], v[224:227], a[0:3]
v_mfma_f32_16x16x32_bf16 a[4:7], v[196:199], v[224:227], a[4:7]
v_mfma_f32_16x16x32_bf16 a[8:11], v[200:203], v[224:227], a[8:11]
v_mfma_f32_16x16x32_bf16 a[12:15], v[204:207], v[224:227], a[12:15]
v_mfma_f32_16x16x32_bf16 a[16:19], v[208:211], v[224:227], a[16:19]
v_mfma_f32_16x16x32_bf16 a[20:23], v[212:215], v[224:227], a[20:23]
v_mfma_f32_16x16x32_bf16 a[24:27], v[216:219], v[224:227], a[24:27]
v_mfma_f32_16x16x32_bf16 a[28:31], v[220:223], v[224:227], a[28:31]
v_mfma_f32_16x16x32_bf16 a[32:35], v[192:195], v[228:231], a[32:35]
v_mfma_f32_16x16x32_bf16 a[36:39], v[196:199], v[228:231], a[36:39]
v_mfma_f32_16x16x32_bf16 a[40:43], v[200:203], v[228:231], a[40:43]
v_mfma_f32_16x16x32_bf16 a[44:47], v[204:207], v[228:231], a[44:47]
v_mfma_f32_16x16x32_bf16 a[48:51], v[208:211], v[228:231], a[48:51]
v_mfma_f32_16x16x32_bf16 a[52:55], v[212:215], v[228:231], a[52:55]
v_mfma_f32_16x16x32_bf16 a[56:59], v[216:219], v[228:231], a[56:59]
v_mfma_f32_16x16x32_bf16 a[60:63], v[220:223], v[228:231], a[60:63]
v_mfma_f32_16x16x32_bf16 a[64:67], v[192:195], v[232:235], a[64:67]
v_mfma_f32_16x16x32_bf16 a[68:71], v[196:199], v[232:235], a[68:71]
v_mfma_f32_16x16x32_bf16 a[72:75], v[200:203], v[232:235], a[72:75]
v_mfma_f32_16x16x32_bf16 a[76:79], v[204:207], v[232:235], a[76:79]
v_mfma_f32_16x16x32_bf16 a[80:83], v[208:211], v[232:235], a[80:83]
v_mfma_f32_16x16x32_bf16 a[84:87], v[212:215], v[232:235], a[84:87]
v_mfma_f32_16x16x32_bf16 a[88:91], v[216:219], v[232:235], a[88:91]
v_mfma_f32_16x16x32_bf16 a[92:95], v[220:223], v[232:235], a[92:95]
v_mfma_f32_16x16x32_bf16 a[96:99], v[192:195], v[236:239], a[96:99]
v_mfma_f32_16x16x32_bf16 a[100:103], v[196:199], v[236:239], a[100:103]
v_mfma_f32_16x16x32_bf16 a[104:107], v[200:203], v[236:239], a[104:107]
v_mfma_f32_16x16x32_bf16 a[108:111], v[204:207], v[236:239], a[108:111]
v_mfma_f32_16x16x32_bf16 a[112:115], v[208:211], v[236:239], a[112:115]
v_mfma_f32_16x16x32_bf16 a[116:119], v[212:215], v[236:239], a[116:119]
v_mfma_f32_16x16x32_bf16 a[120:123], v[216:219], v[236:239], a[120:123]
v_mfma_f32_16x16x32_bf16 a[124:127], v[220:223], v[236:239], a[124:127]
s_waitcnt vmcnt(8)
s_barrier
v_mfma_f32_16x16x32_bf16 a[128:131], v[192:195], v[240:243], a[128:131]
ds_read_b64_tr_b16 v[160:161], v34 offset:0
v_mfma_f32_16x16x32_bf16 a[132:135], v[196:199], v[240:243], a[132:135]
ds_read_b64_tr_b16 v[162:163], v34 offset:2048
v_mfma_f32_16x16x32_bf16 a[136:139], v[200:203], v[240:243], a[136:139]
ds_read_b128 v[128:131], v11 offset:0
v_mfma_f32_16x16x32_bf16 a[140:143], v[204:207], v[240:243], a[140:143]
ds_read_b128 v[132:135], v11 offset:1024
v_mfma_f32_16x16x32_bf16 a[144:147], v[208:211], v[240:243], a[144:147]
ds_read_b128 v[136:139], v11 offset:2048
v_mfma_f32_16x16x32_bf16 a[148:151], v[212:215], v[240:243], a[148:151]
ds_read_b128 v[140:143], v11 offset:3072
v_mfma_f32_16x16x32_bf16 a[152:155], v[216:219], v[240:243], a[152:155]
ds_read_b128 v[144:147], v11 offset:4096
v_mfma_f32_16x16x32_bf16 a[156:159], v[220:223], v[240:243], a[156:159]
ds_read_b128 v[148:151], v11 offset:5120
v_mfma_f32_16x16x32_bf16 a[160:163], v[192:195], v[244:247], a[160:163]
ds_read_b128 v[152:155], v11 offset:6144
v_mfma_f32_16x16x32_bf16 a[164:167], v[196:199], v[244:247], a[164:167]
ds_read_b128 v[156:159], v11 offset:7168
v_mfma_f32_16x16x32_bf16 a[168:171], v[200:203], v[244:247], a[168:171]
ds_read_b64_tr_b16 v[164:165], v35 offset:0
v_mfma_f32_16x16x32_bf16 a[172:175], v[204:207], v[244:247], a[172:175]
ds_read_b64_tr_b16 v[166:167], v35 offset:2048
v_mfma_f32_16x16x32_bf16 a[176:179], v[208:211], v[244:247], a[176:179]
ds_read_b64_tr_b16 v[168:169], v36 offset:0
v_mfma_f32_16x16x32_bf16 a[180:183], v[212:215], v[244:247], a[180:183]
ds_read_b64_tr_b16 v[170:171], v36 offset:2048
v_mfma_f32_16x16x32_bf16 a[184:187], v[216:219], v[244:247], a[184:187]
ds_read_b64_tr_b16 v[172:173], v37 offset:0
v_mfma_f32_16x16x32_bf16 a[188:191], v[220:223], v[244:247], a[188:191]
ds_read_b64_tr_b16 v[174:175], v37 offset:2048
v_mfma_f32_16x16x32_bf16 a[192:195], v[192:195], v[248:251], a[192:195]
ds_read_b64_tr_b16 v[176:177], v38 offset:0
v_mfma_f32_16x16x32_bf16 a[196:199], v[196:199], v[248:251], a[196:199]
ds_read_b64_tr_b16 v[178:179], v38 offset:2048
v_mfma_f32_16x16x32_bf16 a[200:203], v[200:203], v[248:251], a[200:203]
ds_read_b64_tr_b16 v[180:181], v39 offset:0
v_mfma_f32_16x16x32_bf16 a[204:207], v[204:207], v[248:251], a[204:207]
ds_read_b64_tr_b16 v[182:183], v39 offset:2048
v_mfma_f32_16x16x32_bf16 a[208:211], v[208:211], v[248:251], a[208:211]
ds_read_b64_tr_b16 v[184:185], v40 offset:0
v_mfma_f32_16x16x32_bf16 a[212:215], v[212:215], v[248:251], a[212:215]
ds_read_b64_tr_b16 v[186:187], v40 offset:2048
v_mfma_f32_16x16x32_bf16 a[216:219], v[216:219], v[248:251], a[216:219]
ds_read_b64_tr_b16 v[188:189], v41 offset:0
v_mfma_f32_16x16x32_bf16 a[220:223], v[220:223], v[248:251], a[220:223]
ds_read_b64_tr_b16 v[190:191], v41 offset:2048
v_mfma_f32_16x16x32_bf16 a[224:227], v[192:195], v[252:255], a[224:227]
v_mfma_f32_16x16x32_bf16 a[228:231], v[196:199], v[252:255], a[228:231]
v_mfma_f32_16x16x32_bf16 a[232:235], v[200:203], v[252:255], a[232:235]
v_mfma_f32_16x16x32_bf16 a[236:239], v[204:207], v[252:255], a[236:239]
v_mfma_f32_16x16x32_bf16 a[240:243], v[208:211], v[252:255], a[240:243]
v_mfma_f32_16x16x32_bf16 a[244:247], v[212:215], v[252:255], a[244:247]
v_mfma_f32_16x16x32_bf16 a[248:251], v[216:219], v[252:255], a[248:251]
v_mfma_f32_16x16x32_bf16 a[252:255], v[220:223], v[252:255], a[252:255]
s_waitcnt lgkmcnt(0)
v_mfma_f32_16x16x32_bf16 a[0:3], v[128:131], v[160:163], a[0:3]
v_mfma_f32_16x16x32_bf16 a[4:7], v[132:135], v[160:163], a[4:7]
v_mfma_f32_16x16x32_bf16 a[8:11], v[136:139], v[160:163], a[8:11]
v_mfma_f32_16x16x32_bf16 a[12:15], v[140:143], v[160:163], a[12:15]
v_mfma_f32_16x16x32_bf16 a[16:19], v[144:147], v[160:163], a[16:19]
v_mfma_f32_16x16x32_bf16 a[20:23], v[148:151], v[160:163], a[20:23]
v_mfma_f32_16x16x32_bf16 a[24:27], v[152:155], v[160:163], a[24:27]
v_mfma_f32_16x16x32_bf16 a[28:31], v[156:159], v[160:163], a[28:31]
v_mfma_f32_16x16x32_bf16 a[32:35], v[128:131], v[164:167], a[32:35]
v_mfma_f32_16x16x32_bf16 a[36:39], v[132:135], v[164:167], a[36:39]
v_mfma_f32_16x16x32_bf16 a[40:43], v[136:139], v[164:167], a[40:43]
v_mfma_f32_16x16x32_bf16 a[44:47], v[140:143], v[164:167], a[44:47]
v_mfma_f32_16x16x32_bf16 a[48:51], v[144:147], v[164:167], a[48:51]
v_mfma_f32_16x16x32_bf16 a[52:55], v[148:151], v[164:167], a[52:55]
v_mfma_f32_16x16x32_bf16 a[56:59], v[152:155], v[164:167], a[56:59]
v_mfma_f32_16x16x32_bf16 a[60:63], v[156:159], v[164:167], a[60:63]
v_mfma_f32_16x16x32_bf16 a[64:67], v[128:131], v[168:171], a[64:67]
v_mfma_f32_16x16x32_bf16 a[68:71], v[132:135], v[168:171], a[68:71]
v_mfma_f32_16x16x32_bf16 a[72:75], v[136:139], v[168:171], a[72:75]
v_mfma_f32_16x16x32_bf16 a[76:79], v[140:143], v[168:171], a[76:79]
v_mfma_f32_16x16x32_bf16 a[80:83], v[144:147], v[168:171], a[80:83]
v_mfma_f32_16x16x32_bf16 a[84:87], v[148:151], v[168:171], a[84:87]
v_mfma_f32_16x16x32_bf16 a[88:91], v[152:155], v[168:171], a[88:91]
v_mfma_f32_16x16x32_bf16 a[92:95], v[156:159], v[168:171], a[92:95]
v_mfma_f32_16x16x32_bf16 a[96:99], v[128:131], v[172:175], a[96:99]
v_mfma_f32_16x16x32_bf16 a[100:103], v[132:135], v[172:175], a[100:103]
v_mfma_f32_16x16x32_bf16 a[104:107], v[136:139], v[172:175], a[104:107]
v_mfma_f32_16x16x32_bf16 a[108:111], v[140:143], v[172:175], a[108:111]
v_mfma_f32_16x16x32_bf16 a[112:115], v[144:147], v[172:175], a[112:115]
v_mfma_f32_16x16x32_bf16 a[116:119], v[148:151], v[172:175], a[116:119]
v_mfma_f32_16x16x32_bf16 a[120:123], v[152:155], v[172:175], a[120:123]
v_mfma_f32_16x16x32_bf16 a[124:127], v[156:159], v[172:175], a[124:127]
s_waitcnt vmcnt(0)
s_barrier
v_mfma_f32_16x16x32_bf16 a[128:131], v[128:131], v[176:179], a[128:131]
ds_read_b64_tr_b16 v[224:225], v34 offset:32768
v_mfma_f32_16x16x32_bf16 a[132:135], v[132:135], v[176:179], a[132:135]
ds_read_b64_tr_b16 v[226:227], v34 offset:34816
v_mfma_f32_16x16x32_bf16 a[136:139], v[136:139], v[176:179], a[136:139]
ds_read_b128 v[192:195], v11 offset:32768
v_mfma_f32_16x16x32_bf16 a[140:143], v[140:143], v[176:179], a[140:143]
ds_read_b128 v[196:199], v11 offset:33792
v_mfma_f32_16x16x32_bf16 a[144:147], v[144:147], v[176:179], a[144:147]
ds_read_b128 v[200:203], v11 offset:34816
v_mfma_f32_16x16x32_bf16 a[148:151], v[148:151], v[176:179], a[148:151]
ds_read_b128 v[204:207], v11 offset:35840
v_mfma_f32_16x16x32_bf16 a[152:155], v[152:155], v[176:179], a[152:155]
ds_read_b128 v[208:211], v11 offset:36864
v_mfma_f32_16x16x32_bf16 a[156:159], v[156:159], v[176:179], a[156:159]
ds_read_b128 v[212:215], v11 offset:37888
v_mfma_f32_16x16x32_bf16 a[160:163], v[128:131], v[180:183], a[160:163]
ds_read_b128 v[216:219], v11 offset:38912
v_mfma_f32_16x16x32_bf16 a[164:167], v[132:135], v[180:183], a[164:167]
ds_read_b128 v[220:223], v11 offset:39936
v_mfma_f32_16x16x32_bf16 a[168:171], v[136:139], v[180:183], a[168:171]
ds_read_b64_tr_b16 v[228:229], v35 offset:32768
v_mfma_f32_16x16x32_bf16 a[172:175], v[140:143], v[180:183], a[172:175]
ds_read_b64_tr_b16 v[230:231], v35 offset:34816
v_mfma_f32_16x16x32_bf16 a[176:179], v[144:147], v[180:183], a[176:179]
ds_read_b64_tr_b16 v[232:233], v36 offset:32768
v_mfma_f32_16x16x32_bf16 a[180:183], v[148:151], v[180:183], a[180:183]
ds_read_b64_tr_b16 v[234:235], v36 offset:34816
v_mfma_f32_16x16x32_bf16 a[184:187], v[152:155], v[180:183], a[184:187]
ds_read_b64_tr_b16 v[236:237], v37 offset:32768
v_mfma_f32_16x16x32_bf16 a[188:191], v[156:159], v[180:183], a[188:191]
ds_read_b64_tr_b16 v[238:239], v37 offset:34816
v_mfma_f32_16x16x32_bf16 a[192:195], v[128:131], v[184:187], a[192:195]
ds_read_b64_tr_b16 v[240:241], v38 offset:32768
v_mfma_f32_16x16x32_bf16 a[196:199], v[132:135], v[184:187], a[196:199]
ds_read_b64_tr_b16 v[242:243], v38 offset:34816
v_mfma_f32_16x16x32_bf16 a[200:203], v[136:139], v[184:187], a[200:203]
ds_read_b64_tr_b16 v[244:245], v39 offset:32768
v_mfma_f32_16x16x32_bf16 a[204:207], v[140:143], v[184:187], a[204:207]
ds_read_b64_tr_b16 v[246:247], v39 offset:34816
v_mfma_f32_16x16x32_bf16 a[208:211], v[144:147], v[184:187], a[208:211]
ds_read_b64_tr_b16 v[248:249], v40 offset:32768
v_mfma_f32_16x16x32_bf16 a[212:215], v[148:151], v[184:187], a[212:215]
ds_read_b64_tr_b16 v[250:251], v40 offset:34816
v_mfma_f32_16x16x32_bf16 a[216:219], v[152:155], v[184:187], a[216:219]
ds_read_b64_tr_b16 v[252:253], v41 offset:32768
v_mfma_f32_16x16x32_bf16 a[220:223], v[156:159], v[184:187], a[220:223]
ds_read_b64_tr_b16 v[254:255], v41 offset:34816
v_mfma_f32_16x16x32_bf16 a[224:227], v[128:131], v[188:191], a[224:227]
v_mfma_f32_16x16x32_bf16 a[228:231], v[132:135], v[188:191], a[228:231]
v_mfma_f32_16x16x32_bf16 a[232:235], v[136:139], v[188:191], a[232:235]
v_mfma_f32_16x16x32_bf16 a[236:239], v[140:143], v[188:191], a[236:239]
v_mfma_f32_16x16x32_bf16 a[240:243], v[144:147], v[188:191], a[240:243]
v_mfma_f32_16x16x32_bf16 a[244:247], v[148:151], v[188:191], a[244:247]
v_mfma_f32_16x16x32_bf16 a[248:251], v[152:155], v[188:191], a[248:251]
v_mfma_f32_16x16x32_bf16 a[252:255], v[156:159], v[188:191], a[252:255]
s_waitcnt lgkmcnt(0)
v_mfma_f32_16x16x32_bf16 a[0:3], v[192:195], v[224:227], a[0:3]
v_mfma_f32_16x16x32_bf16 a[4:7], v[196:199], v[224:227], a[4:7]
v_mfma_f32_16x16x32_bf16 a[8:11], v[200:203], v[224:227], a[8:11]
v_mfma_f32_16x16x32_bf16 a[12:15], v[204:207], v[224:227], a[12:15]
v_mfma_f32_16x16x32_bf16 a[16:19], v[208:211], v[224:227], a[16:19]
v_mfma_f32_16x16x32_bf16 a[20:23], v[212:215], v[224:227], a[20:23]
v_mfma_f32_16x16x32_bf16 a[24:27], v[216:219], v[224:227], a[24:27]
v_mfma_f32_16x16x32_bf16 a[28:31], v[220:223], v[224:227], a[28:31]
v_mfma_f32_16x16x32_bf16 a[32:35], v[192:195], v[228:231], a[32:35]
v_mfma_f32_16x16x32_bf16 a[36:39], v[196:199], v[228:231], a[36:39]
v_mfma_f32_16x16x32_bf16 a[40:43], v[200:203], v[228:231], a[40:43]
v_mfma_f32_16x16x32_bf16 a[44:47], v[204:207], v[228:231], a[44:47]
v_mfma_f32_16x16x32_bf16 a[48:51], v[208:211], v[228:231], a[48:51]
v_mfma_f32_16x16x32_bf16 a[52:55], v[212:215], v[228:231], a[52:55]
v_mfma_f32_16x16x32_bf16 a[56:59], v[216:219], v[228:231], a[56:59]
v_mfma_f32_16x16x32_bf16 a[60:63], v[220:223], v[228:231], a[60:63]
v_mfma_f32_16x16x32_bf16 a[64:67], v[192:195], v[232:235], a[64:67]
v_mfma_f32_16x16x32_bf16 a[68:71], v[196:199], v[232:235], a[68:71]
v_mfma_f32_16x16x32_bf16 a[72:75], v[200:203], v[232:235], a[72:75]
v_mfma_f32_16x16x32_bf16 a[76:79], v[204:207], v[232:235], a[76:79]
v_mfma_f32_16x16x32_bf16 a[80:83], v[208:211], v[232:235], a[80:83]
v_mfma_f32_16x16x32_bf16 a[84:87], v[212:215], v[232:235], a[84:87]
v_mfma_f32_16x16x32_bf16 a[88:91], v[216:219], v[232:235], a[88:91]
v_mfma_f32_16x16x32_bf16 a[92:95], v[220:223], v[232:235], a[92:95]
v_mfma_f32_16x16x32_bf16 a[96:99], v[192:195], v[236:239], a[96:99]
v_mfma_f32_16x16x32_bf16 a[100:103], v[196:199], v[236:239], a[100:103]
v_mfma_f32_16x16x32_bf16 a[104:107], v[200:203], v[236:239], a[104:107]
v_mfma_f32_16x16x32_bf16 a[108:111], v[204:207], v[236:239], a[108:111]
v_mfma_f32_16x16x32_bf16 a[112:115], v[208:211], v[236:239], a[112:115]
v_mfma_f32_16x16x32_bf16 a[116:119], v[212:215], v[236:239], a[116:119]
v_mfma_f32_16x16x32_bf16 a[120:123], v[216:219], v[236:239], a[120:123]
v_mfma_f32_16x16x32_bf16 a[124:127], v[220:223], v[236:239], a[124:127]
v_mfma_f32_16x16x32_bf16 a[128:131], v[192:195], v[240:243], a[128:131]
v_mfma_f32_16x16x32_bf16 a[132:135], v[196:199], v[240:243], a[132:135]
v_mfma_f32_16x16x32_bf16 a[136:139], v[200:203], v[240:243], a[136:139]
v_mfma_f32_16x16x32_bf16 a[140:143], v[204:207], v[240:243], a[140:143]
v_mfma_f32_16x16x32_bf16 a[144:147], v[208:211], v[240:243], a[144:147]
v_mfma_f32_16x16x32_bf16 a[148:151], v[212:215], v[240:243], a[148:151]
v_mfma_f32_16x16x32_bf16 a[152:155], v[216:219], v[240:243], a[152:155]
v_mfma_f32_16x16x32_bf16 a[156:159], v[220:223], v[240:243], a[156:159]
v_mfma_f32_16x16x32_bf16 a[160:163], v[192:195], v[244:247], a[160:163]
v_mfma_f32_16x16x32_bf16 a[164:167], v[196:199], v[244:247], a[164:167]
v_mfma_f32_16x16x32_bf16 a[168:171], v[200:203], v[244:247], a[168:171]
v_mfma_f32_16x16x32_bf16 a[172:175], v[204:207], v[244:247], a[172:175]
v_mfma_f32_16x16x32_bf16 a[176:179], v[208:211], v[244:247], a[176:179]
v_mfma_f32_16x16x32_bf16 a[180:183], v[212:215], v[244:247], a[180:183]
v_mfma_f32_16x16x32_bf16 a[184:187], v[216:219], v[244:247], a[184:187]
v_mfma_f32_16x16x32_bf16 a[188:191], v[220:223], v[244:247], a[188:191]
v_mfma_f32_16x16x32_bf16 a[192:195], v[192:195], v[248:251], a[192:195]
v_mfma_f32_16x16x32_bf16 a[196:199], v[196:199], v[248:251], a[196:199]
v_mfma_f32_16x16x32_bf16 a[200:203], v[200:203], v[248:251], a[200:203]
v_mfma_f32_16x16x32_bf16 a[204:207], v[204:207], v[248:251], a[204:207]
v_mfma_f32_16x16x32_bf16 a[208:211], v[208:211], v[248:251], a[208:211]
v_mfma_f32_16x16x32_bf16 a[212:215], v[212:215], v[248:251], a[212:215]
v_mfma_f32_16x16x32_bf16 a[216:219], v[216:219], v[248:251], a[216:219]
v_mfma_f32_16x16x32_bf16 a[220:223], v[220:223], v[248:251], a[220:223]
v_mfma_f32_16x16x32_bf16 a[224:227], v[192:195], v[252:255], a[224:227]
v_mfma_f32_16x16x32_bf16 a[228:231], v[196:199], v[252:255], a[228:231]
v_mfma_f32_16x16x32_bf16 a[232:235], v[200:203], v[252:255], a[232:235]
v_mfma_f32_16x16x32_bf16 a[236:239], v[204:207], v[252:255], a[236:239]
v_mfma_f32_16x16x32_bf16 a[240:243], v[208:211], v[252:255], a[240:243]
v_mfma_f32_16x16x32_bf16 a[244:247], v[212:215], v[252:255], a[244:247]
v_mfma_f32_16x16x32_bf16 a[248:251], v[216:219], v[252:255], a[248:251]
v_mfma_f32_16x16x32_bf16 a[252:255], v[220:223], v[252:255], a[252:255]
s_lshr_b32 s21, s20, 1
s_and_b32 s22, s20, 1
s_mul_i32 s21, s21, 1048576
s_lshl_b32 s22, s22, 13
s_add_u32 s21, s21, s22
v_lshlrev_b32 v42, 4, v1
v_add_u32 v56, s21, v42
v_add_u32 v57, 4096, v56
v_accvgpr_read_b32 v64, a0
v_accvgpr_read_b32 v65, a1
v_accvgpr_read_b32 v66, a2
v_accvgpr_read_b32 v67, a3
v_accvgpr_read_b32 v68, a4
v_accvgpr_read_b32 v69, a5
v_accvgpr_read_b32 v70, a6
v_accvgpr_read_b32 v71, a7
v_cvt_pk_bf16_f32 v80, v64, v65
v_cvt_pk_bf16_f32 v81, v66, v67
v_cvt_pk_bf16_f32 v82, v68, v69
v_cvt_pk_bf16_f32 v83, v70, v71
global_store_dwordx4 v56, v[80:83], s[12:13] offset:0 sc1
v_accvgpr_read_b32 v72, a32
v_accvgpr_read_b32 v73, a33
v_accvgpr_read_b32 v74, a34
v_accvgpr_read_b32 v75, a35
v_accvgpr_read_b32 v76, a36
v_accvgpr_read_b32 v77, a37
v_accvgpr_read_b32 v78, a38
v_accvgpr_read_b32 v79, a39
v_cvt_pk_bf16_f32 v84, v72, v73
v_cvt_pk_bf16_f32 v85, v74, v75
v_cvt_pk_bf16_f32 v86, v76, v77
v_cvt_pk_bf16_f32 v87, v78, v79
global_store_dwordx4 v56, v[84:87], s[12:13] offset:1024 sc1
v_accvgpr_read_b32 v64, a64
v_accvgpr_read_b32 v65, a65
v_accvgpr_read_b32 v66, a66
v_accvgpr_read_b32 v67, a67
v_accvgpr_read_b32 v68, a68
v_accvgpr_read_b32 v69, a69
v_accvgpr_read_b32 v70, a70
v_accvgpr_read_b32 v71, a71
v_cvt_pk_bf16_f32 v80, v64, v65
v_cvt_pk_bf16_f32 v81, v66, v67
v_cvt_pk_bf16_f32 v82, v68, v69
v_cvt_pk_bf16_f32 v83, v70, v71
global_store_dwordx4 v56, v[80:83], s[12:13] offset:2048 sc1
v_accvgpr_read_b32 v72, a96
v_accvgpr_read_b32 v73, a97
v_accvgpr_read_b32 v74, a98
v_accvgpr_read_b32 v75, a99
v_accvgpr_read_b32 v76, a100
v_accvgpr_read_b32 v77, a101
v_accvgpr_read_b32 v78, a102
v_accvgpr_read_b32 v79, a103
v_cvt_pk_bf16_f32 v84, v72, v73
v_cvt_pk_bf16_f32 v85, v74, v75
v_cvt_pk_bf16_f32 v86, v76, v77
v_cvt_pk_bf16_f32 v87, v78, v79
global_store_dwordx4 v56, v[84:87], s[12:13] offset:3072 sc1
v_accvgpr_read_b32 v64, a128
v_accvgpr_read_b32 v65, a129
v_accvgpr_read_b32 v66, a130
v_accvgpr_read_b32 v67, a131
v_accvgpr_read_b32 v68, a132
v_accvgpr_read_b32 v69, a133
v_accvgpr_read_b32 v70, a134
v_accvgpr_read_b32 v71, a135
v_cvt_pk_bf16_f32 v80, v64, v65
v_cvt_pk_bf16_f32 v81, v66, v67
v_cvt_pk_bf16_f32 v82, v68, v69
v_cvt_pk_bf16_f32 v83, v70, v71
global_store_dwordx4 v57, v[80:83], s[12:13] offset:0 sc1
v_accvgpr_read_b32 v72, a160
v_accvgpr_read_b32 v73, a161
v_accvgpr_read_b32 v74, a162
v_accvgpr_read_b32 v75, a163
v_accvgpr_read_b32 v76, a164
v_accvgpr_read_b32 v77, a165
v_accvgpr_read_b32 v78, a166
v_accvgpr_read_b32 v79, a167
v_cvt_pk_bf16_f32 v84, v72, v73
v_cvt_pk_bf16_f32 v85, v74, v75
v_cvt_pk_bf16_f32 v86, v76, v77
v_cvt_pk_bf16_f32 v87, v78, v79
global_store_dwordx4 v57, v[84:87], s[12:13] offset:1024 sc1
v_accvgpr_read_b32 v64, a192
v_accvgpr_read_b32 v65, a193
v_accvgpr_read_b32 v66, a194
v_accvgpr_read_b32 v67, a195
v_accvgpr_read_b32 v68, a196
v_accvgpr_read_b32 v69, a197
v_accvgpr_read_b32 v70, a198
v_accvgpr_read_b32 v71, a199
v_cvt_pk_bf16_f32 v80, v64, v65
v_cvt_pk_bf16_f32 v81, v66, v67
v_cvt_pk_bf16_f32 v82, v68, v69
v_cvt_pk_bf16_f32 v83, v70, v71
global_store_dwordx4 v57, v[80:83], s[12:13] offset:2048 sc1
v_accvgpr_read_b32 v72, a224
v_accvgpr_read_b32 v73, a225
v_accvgpr_read_b32 v74, a226
v_accvgpr_read_b32 v75, a227
v_accvgpr_read_b32 v76, a228
v_accvgpr_read_b32 v77, a229
v_accvgpr_read_b32 v78, a230
v_accvgpr_read_b32 v79, a231
v_cvt_pk_bf16_f32 v84, v72, v73
v_cvt_pk_bf16_f32 v85, v74, v75
v_cvt_pk_bf16_f32 v86, v76, v77
v_cvt_pk_bf16_f32 v87, v78, v79
global_store_dwordx4 v57, v[84:87], s[12:13] offset:3072 sc1
s_add_u32 s12, s12, 262144
s_addc_u32 s13, s13, 0
v_accvgpr_read_b32 v64, a8
v_accvgpr_read_b32 v65, a9
v_accvgpr_read_b32 v66, a10
v_accvgpr_read_b32 v67, a11
v_accvgpr_read_b32 v68, a12
v_accvgpr_read_b32 v69, a13
v_accvgpr_read_b32 v70, a14
v_accvgpr_read_b32 v71, a15
v_cvt_pk_bf16_f32 v80, v64, v65
v_cvt_pk_bf16_f32 v81, v66, v67
v_cvt_pk_bf16_f32 v82, v68, v69
v_cvt_pk_bf16_f32 v83, v70, v71
global_store_dwordx4 v56, v[80:83], s[12:13] offset:0 sc1
v_accvgpr_read_b32 v72, a40
v_accvgpr_read_b32 v73, a41
v_accvgpr_read_b32 v74, a42
v_accvgpr_read_b32 v75, a43
v_accvgpr_read_b32 v76, a44
v_accvgpr_read_b32 v77, a45
v_accvgpr_read_b32 v78, a46
v_accvgpr_read_b32 v79, a47
v_cvt_pk_bf16_f32 v84, v72, v73
v_cvt_pk_bf16_f32 v85, v74, v75
v_cvt_pk_bf16_f32 v86, v76, v77
v_cvt_pk_bf16_f32 v87, v78, v79
global_store_dwordx4 v56, v[84:87], s[12:13] offset:1024 sc1
v_accvgpr_read_b32 v64, a72
v_accvgpr_read_b32 v65, a73
v_accvgpr_read_b32 v66, a74
v_accvgpr_read_b32 v67, a75
v_accvgpr_read_b32 v68, a76
v_accvgpr_read_b32 v69, a77
v_accvgpr_read_b32 v70, a78
v_accvgpr_read_b32 v71, a79
v_cvt_pk_bf16_f32 v80, v64, v65
v_cvt_pk_bf16_f32 v81, v66, v67
v_cvt_pk_bf16_f32 v82, v68, v69
v_cvt_pk_bf16_f32 v83, v70, v71
global_store_dwordx4 v56, v[80:83], s[12:13] offset:2048 sc1
v_accvgpr_read_b32 v72, a104
v_accvgpr_read_b32 v73, a105
v_accvgpr_read_b32 v74, a106
v_accvgpr_read_b32 v75, a107
v_accvgpr_read_b32 v76, a108
v_accvgpr_read_b32 v77, a109
v_accvgpr_read_b32 v78, a110
v_accvgpr_read_b32 v79, a111
v_cvt_pk_bf16_f32 v84, v72, v73
v_cvt_pk_bf16_f32 v85, v74, v75
v_cvt_pk_bf16_f32 v86, v76, v77
v_cvt_pk_bf16_f32 v87, v78, v79
global_store_dwordx4 v56, v[84:87], s[12:13] offset:3072 sc1
v_accvgpr_read_b32 v64, a136
v_accvgpr_read_b32 v65, a137
v_accvgpr_read_b32 v66, a138
v_accvgpr_read_b32 v67, a139
v_accvgpr_read_b32 v68, a140
v_accvgpr_read_b32 v69, a141
v_accvgpr_read_b32 v70, a142
v_accvgpr_read_b32 v71, a143
v_cvt_pk_bf16_f32 v80, v64, v65
v_cvt_pk_bf16_f32 v81, v66, v67
v_cvt_pk_bf16_f32 v82, v68, v69
v_cvt_pk_bf16_f32 v83, v70, v71
global_store_dwordx4 v57, v[80:83], s[12:13] offset:0 sc1
v_accvgpr_read_b32 v72, a168
v_accvgpr_read_b32 v73, a169
v_accvgpr_read_b32 v74, a170
v_accvgpr_read_b32 v75, a171
v_accvgpr_read_b32 v76, a172
v_accvgpr_read_b32 v77, a173
v_accvgpr_read_b32 v78, a174
v_accvgpr_read_b32 v79, a175
v_cvt_pk_bf16_f32 v84, v72, v73
v_cvt_pk_bf16_f32 v85, v74, v75
v_cvt_pk_bf16_f32 v86, v76, v77
v_cvt_pk_bf16_f32 v87, v78, v79
global_store_dwordx4 v57, v[84:87], s[12:13] offset:1024 sc1
v_accvgpr_read_b32 v64, a200
v_accvgpr_read_b32 v65, a201
v_accvgpr_read_b32 v66, a202
v_accvgpr_read_b32 v67, a203
v_accvgpr_read_b32 v68, a204
v_accvgpr_read_b32 v69, a205
v_accvgpr_read_b32 v70, a206
v_accvgpr_read_b32 v71, a207
v_cvt_pk_bf16_f32 v80, v64, v65
v_cvt_pk_bf16_f32 v81, v66, v67
v_cvt_pk_bf16_f32 v82, v68, v69
v_cvt_pk_bf16_f32 v83, v70, v71
global_store_dwordx4 v57, v[80:83], s[12:13] offset:2048 sc1
v_accvgpr_read_b32 v72, a232
v_accvgpr_read_b32 v73, a233
v_accvgpr_read_b32 v74, a234
v_accvgpr_read_b32 v75, a235
v_accvgpr_read_b32 v76, a236
v_accvgpr_read_b32 v77, a237
v_accvgpr_read_b32 v78, a238
v_accvgpr_read_b32 v79, a239
v_cvt_pk_bf16_f32 v84, v72, v73
v_cvt_pk_bf16_f32 v85, v74, v75
v_cvt_pk_bf16_f32 v86, v76, v77
v_cvt_pk_bf16_f32 v87, v78, v79
global_store_dwordx4 v57, v[84:87], s[12:13] offset:3072 sc1
s_add_u32 s12, s12, 262144
s_addc_u32 s13, s13, 0
v_accvgpr_read_b32 v64, a16
v_accvgpr_read_b32 v65, a17
v_accvgpr_read_b32 v66, a18
v_accvgpr_read_b32 v67, a19
v_accvgpr_read_b32 v68, a20
v_accvgpr_read_b32 v69, a21
v_accvgpr_read_b32 v70, a22
v_accvgpr_read_b32 v71, a23
v_cvt_pk_bf16_f32 v80, v64, v65
v_cvt_pk_bf16_f32 v81, v66, v67
v_cvt_pk_bf16_f32 v82, v68, v69
v_cvt_pk_bf16_f32 v83, v70, v71
global_store_dwordx4 v56, v[80:83], s[12:13] offset:0 sc1
v_accvgpr_read_b32 v72, a48
v_accvgpr_read_b32 v73, a49
v_accvgpr_read_b32 v74, a50
v_accvgpr_read_b32 v75, a51
v_accvgpr_read_b32 v76, a52
v_accvgpr_read_b32 v77, a53
v_accvgpr_read_b32 v78, a54
v_accvgpr_read_b32 v79, a55
v_cvt_pk_bf16_f32 v84, v72, v73
v_cvt_pk_bf16_f32 v85, v74, v75
v_cvt_pk_bf16_f32 v86, v76, v77
v_cvt_pk_bf16_f32 v87, v78, v79
global_store_dwordx4 v56, v[84:87], s[12:13] offset:1024 sc1
v_accvgpr_read_b32 v64, a80
v_accvgpr_read_b32 v65, a81
v_accvgpr_read_b32 v66, a82
v_accvgpr_read_b32 v67, a83
v_accvgpr_read_b32 v68, a84
v_accvgpr_read_b32 v69, a85
v_accvgpr_read_b32 v70, a86
v_accvgpr_read_b32 v71, a87
v_cvt_pk_bf16_f32 v80, v64, v65
v_cvt_pk_bf16_f32 v81, v66, v67
v_cvt_pk_bf16_f32 v82, v68, v69
v_cvt_pk_bf16_f32 v83, v70, v71
global_store_dwordx4 v56, v[80:83], s[12:13] offset:2048 sc1
v_accvgpr_read_b32 v72, a112
v_accvgpr_read_b32 v73, a113
v_accvgpr_read_b32 v74, a114
v_accvgpr_read_b32 v75, a115
v_accvgpr_read_b32 v76, a116
v_accvgpr_read_b32 v77, a117
v_accvgpr_read_b32 v78, a118
v_accvgpr_read_b32 v79, a119
v_cvt_pk_bf16_f32 v84, v72, v73
v_cvt_pk_bf16_f32 v85, v74, v75
v_cvt_pk_bf16_f32 v86, v76, v77
v_cvt_pk_bf16_f32 v87, v78, v79
global_store_dwordx4 v56, v[84:87], s[12:13] offset:3072 sc1
v_accvgpr_read_b32 v64, a144
v_accvgpr_read_b32 v65, a145
v_accvgpr_read_b32 v66, a146
v_accvgpr_read_b32 v67, a147
v_accvgpr_read_b32 v68, a148
v_accvgpr_read_b32 v69, a149
v_accvgpr_read_b32 v70, a150
v_accvgpr_read_b32 v71, a151
v_cvt_pk_bf16_f32 v80, v64, v65
v_cvt_pk_bf16_f32 v81, v66, v67
v_cvt_pk_bf16_f32 v82, v68, v69
v_cvt_pk_bf16_f32 v83, v70, v71
global_store_dwordx4 v57, v[80:83], s[12:13] offset:0 sc1
v_accvgpr_read_b32 v72, a176
v_accvgpr_read_b32 v73, a177
v_accvgpr_read_b32 v74, a178
v_accvgpr_read_b32 v75, a179
v_accvgpr_read_b32 v76, a180
v_accvgpr_read_b32 v77, a181
v_accvgpr_read_b32 v78, a182
v_accvgpr_read_b32 v79, a183
v_cvt_pk_bf16_f32 v84, v72, v73
v_cvt_pk_bf16_f32 v85, v74, v75
v_cvt_pk_bf16_f32 v86, v76, v77
v_cvt_pk_bf16_f32 v87, v78, v79
global_store_dwordx4 v57, v[84:87], s[12:13] offset:1024 sc1
v_accvgpr_read_b32 v64, a208
v_accvgpr_read_b32 v65, a209
v_accvgpr_read_b32 v66, a210
v_accvgpr_read_b32 v67, a211
v_accvgpr_read_b32 v68, a212
v_accvgpr_read_b32 v69, a213
v_accvgpr_read_b32 v70, a214
v_accvgpr_read_b32 v71, a215
v_cvt_pk_bf16_f32 v80, v64, v65
v_cvt_pk_bf16_f32 v81, v66, v67
v_cvt_pk_bf16_f32 v82, v68, v69
v_cvt_pk_bf16_f32 v83, v70, v71
global_store_dwordx4 v57, v[80:83], s[12:13] offset:2048 sc1
v_accvgpr_read_b32 v72, a240
v_accvgpr_read_b32 v73, a241
v_accvgpr_read_b32 v74, a242
v_accvgpr_read_b32 v75, a243
v_accvgpr_read_b32 v76, a244
v_accvgpr_read_b32 v77, a245
v_accvgpr_read_b32 v78, a246
v_accvgpr_read_b32 v79, a247
v_cvt_pk_bf16_f32 v84, v72, v73
v_cvt_pk_bf16_f32 v85, v74, v75
v_cvt_pk_bf16_f32 v86, v76, v77
v_cvt_pk_bf16_f32 v87, v78, v79
global_store_dwordx4 v57, v[84:87], s[12:13] offset:3072 sc1
s_add_u32 s12, s12, 262144
s_addc_u32 s13, s13, 0
v_accvgpr_read_b32 v64, a24
v_accvgpr_read_b32 v65, a25
v_accvgpr_read_b32 v66, a26
v_accvgpr_read_b32 v67, a27
v_accvgpr_read_b32 v68, a28
v_accvgpr_read_b32 v69, a29
v_accvgpr_read_b32 v70, a30
v_accvgpr_read_b32 v71, a31
v_cvt_pk_bf16_f32 v80, v64, v65
v_cvt_pk_bf16_f32 v81, v66, v67
v_cvt_pk_bf16_f32 v82, v68, v69
v_cvt_pk_bf16_f32 v83, v70, v71
global_store_dwordx4 v56, v[80:83], s[12:13] offset:0 sc1
v_accvgpr_read_b32 v72, a56
v_accvgpr_read_b32 v73, a57
v_accvgpr_read_b32 v74, a58
v_accvgpr_read_b32 v75, a59
v_accvgpr_read_b32 v76, a60
v_accvgpr_read_b32 v77, a61
v_accvgpr_read_b32 v78, a62
v_accvgpr_read_b32 v79, a63
v_cvt_pk_bf16_f32 v84, v72, v73
v_cvt_pk_bf16_f32 v85, v74, v75
v_cvt_pk_bf16_f32 v86, v76, v77
v_cvt_pk_bf16_f32 v87, v78, v79
global_store_dwordx4 v56, v[84:87], s[12:13] offset:1024 sc1
v_accvgpr_read_b32 v64, a88
v_accvgpr_read_b32 v65, a89
v_accvgpr_read_b32 v66, a90
v_accvgpr_read_b32 v67, a91
v_accvgpr_read_b32 v68, a92
v_accvgpr_read_b32 v69, a93
v_accvgpr_read_b32 v70, a94
v_accvgpr_read_b32 v71, a95
v_cvt_pk_bf16_f32 v80, v64, v65
v_cvt_pk_bf16_f32 v81, v66, v67
v_cvt_pk_bf16_f32 v82, v68, v69
v_cvt_pk_bf16_f32 v83, v70, v71
global_store_dwordx4 v56, v[80:83], s[12:13] offset:2048 sc1
v_accvgpr_read_b32 v72, a120
v_accvgpr_read_b32 v73, a121
v_accvgpr_read_b32 v74, a122
v_accvgpr_read_b32 v75, a123
v_accvgpr_read_b32 v76, a124
v_accvgpr_read_b32 v77, a125
v_accvgpr_read_b32 v78, a126
v_accvgpr_read_b32 v79, a127
v_cvt_pk_bf16_f32 v84, v72, v73
v_cvt_pk_bf16_f32 v85, v74, v75
v_cvt_pk_bf16_f32 v86, v76, v77
v_cvt_pk_bf16_f32 v87, v78, v79
global_store_dwordx4 v56, v[84:87], s[12:13] offset:3072 sc1
v_accvgpr_read_b32 v64, a152
v_accvgpr_read_b32 v65, a153
v_accvgpr_read_b32 v66, a154
v_accvgpr_read_b32 v67, a155
v_accvgpr_read_b32 v68, a156
v_accvgpr_read_b32 v69, a157
v_accvgpr_read_b32 v70, a158
v_accvgpr_read_b32 v71, a159
v_cvt_pk_bf16_f32 v80, v64, v65
v_cvt_pk_bf16_f32 v81, v66, v67
v_cvt_pk_bf16_f32 v82, v68, v69
v_cvt_pk_bf16_f32 v83, v70, v71
global_store_dwordx4 v57, v[80:83], s[12:13] offset:0 sc1
v_accvgpr_read_b32 v72, a184
v_accvgpr_read_b32 v73, a185
v_accvgpr_read_b32 v74, a186
v_accvgpr_read_b32 v75, a187
v_accvgpr_read_b32 v76, a188
v_accvgpr_read_b32 v77, a189
v_accvgpr_read_b32 v78, a190
v_accvgpr_read_b32 v79, a191
v_cvt_pk_bf16_f32 v84, v72, v73
v_cvt_pk_bf16_f32 v85, v74, v75
v_cvt_pk_bf16_f32 v86, v76, v77
v_cvt_pk_bf16_f32 v87, v78, v79
global_store_dwordx4 v57, v[84:87], s[12:13] offset:1024 sc1
v_accvgpr_read_b32 v64, a216
v_accvgpr_read_b32 v65, a217
v_accvgpr_read_b32 v66, a218
v_accvgpr_read_b32 v67, a219
v_accvgpr_read_b32 v68, a220
v_accvgpr_read_b32 v69, a221
v_accvgpr_read_b32 v70, a222
v_accvgpr_read_b32 v71, a223
v_cvt_pk_bf16_f32 v80, v64, v65
v_cvt_pk_bf16_f32 v81, v66, v67
v_cvt_pk_bf16_f32 v82, v68, v69
v_cvt_pk_bf16_f32 v83, v70, v71
global_store_dwordx4 v57, v[80:83], s[12:13] offset:2048 sc1
v_accvgpr_read_b32 v72, a248
v_accvgpr_read_b32 v73, a249
v_accvgpr_read_b32 v74, a250
v_accvgpr_read_b32 v75, a251
v_accvgpr_read_b32 v76, a252
v_accvgpr_read_b32 v77, a253
v_accvgpr_read_b32 v78, a254
v_accvgpr_read_b32 v79, a255
v_cvt_pk_bf16_f32 v84, v72, v73
v_cvt_pk_bf16_f32 v85, v74, v75
v_cvt_pk_bf16_f32 v86, v76, v77
v_cvt_pk_bf16_f32 v87, v78, v79
global_store_dwordx4 v57, v[84:87], s[12:13] offset:3072 sc1
s_waitcnt vmcnt(0)
s_barrier
s_cmp_lg_u32 s20, 0
s_cbranch_scc1 M_sg_88
s_lshl_b32 s64, s63, 2
s_add_u32 s64, s64, 96
v_mov_b32 v42, s64
v_mov_b32 v43, 4
s_mov_b64 exec, 1
global_atomic_add v42, v43, s[56:57]
s_mov_b64 exec, -1
M_sg_88:
s_branch W_loop
W_ks:
s_lshr_b32 s63, s61, 2
s_cmp_ge_u32 s63, 2
s_cbranch_scc1 M_lb_89
s_cmp_lg_u32 s20, 0
s_cbranch_scc1 M_wcd_92
s_lshl_b32 s64, s63, 2
s_add_u32 s64, s64, 144
v_mov_b32 v42, s64
s_mov_b32 s65, 0
s_mov_b64 exec, 1
M_wc_91:
global_load_dword v43, v42, s[56:57] sc1
s_waitcnt vmcnt(0)
v_readfirstlane_b32 s64, v43
s_cmp_ge_u32 s64, 64
s_cbranch_scc1 M_wcd_92_x
s_sleep 20
s_add_u32 s65, s65, 1
s_cmp_lt_u32 s65, 400000
s_cbranch_scc1 M_wc_91
s_mov_b64 exec, -1
s_branch M_exit0
M_wcd_92_x:
s_mov_b64 exec, -1
M_wcd_92:
s_barrier
s_branch M_lbd_90
M_lb_89:
s_cmp_eq_u32 s97, 1
s_cbranch_scc1 M_wo_93
s_cmp_lg_u32 s20, 0
s_cbranch_scc1 M_wcd_95
v_mov_b32 v42, 132
s_mov_b32 s65, 0
s_mov_b64 exec, 1
M_wc_94:
global_load_dword v43, v42, s[56:57] sc1
s_waitcnt vmcnt(0)
v_readfirstlane_b32 s64, v43
s_cmp_ge_u32 s64, 128
s_cbranch_scc1 M_wcd_95_x
s_sleep 32
s_add_u32 s65, s65, 1
s_cmp_lt_u32 s65, 400000
s_cbranch_scc1 M_wc_94
s_mov_b64 exec, -1
s_branch M_exit0
M_wcd_95_x:
s_mov_b64 exec, -1
M_wcd_95:
s_barrier
s_mov_b32 s97, 1
M_wo_93:
M_lbd_90:
s_cmp_eq_u32 s60, 5
s_cselect_b32 s66, s44, s42
s_cselect_b32 s67, s45, s43
s_lshl_b32 s64, s62, 9
s_add_u32 s6, s66, s64
s_addc_u32 s7, s67, 0
s_mul_i32 s64, s61, 4096
s_add_u32 s64, s64, 0
s_add_u32 s4, s40, s64
s_addc_u32 s5, s41, 0
s_mov_b32 s8, 131072
s_mov_b32 s31, 8192
s_mov_b32 s9, 262144
s_mov_b32 s10, 32
s_mul_i32 s64, s61, 524288
s_lshl_b32 s65, s62, 14
s_add_u32 s64, s64, s65
s_mov_b32 s65, 16777216
s_cmp_eq_u32 s60, 5
s_cselect_b32 s65, 33554432, s65
s_add_u32 s64, s64, s65
s_add_u32 s12, s40, s64
s_addc_u32 s13, s41, 0
s_call_b64 s[94:95], W_sub_smalln
v_and_b32 v42, 15, v1
v_lshrrev_b32 v43, 4, v1
v_and_b32 v44, 1, v43
v_lshlrev_b32 v44, 1, v44
v_lshrrev_b32 v45, 1, v43
v_add_u32 v44, v44, v45
v_lshl_add_u32 v45, v44, 4, v42
v_lshlrev_b32 v45, 4, v45
s_mov_b32 s21, 0
s_mov_b32 s22, s20
s_mul_i32 s21, s21, 524288
s_lshr_b32 s23, s22, 1
s_lshl_b32 s23, s23, 13
s_and_b32 s22, s22, 1
s_lshl_b32 s22, s22, 11
s_add_u32 s22, s22, s23
s_add_u32 s21, s21, s22
v_add_u32 v56, s21, v45
v_add_u32 v57, 4096, v56
v_accvgpr_read_b32 v64, a0
v_accvgpr_read_b32 v65, a1
v_accvgpr_read_b32 v66, a2
v_accvgpr_read_b32 v67, a3
v_accvgpr_read_b32 v68, a16
v_accvgpr_read_b32 v69, a17
v_accvgpr_read_b32 v70, a18
v_accvgpr_read_b32 v71, a19
v_cvt_pk_bf16_f32 v80, v64, v65
v_cvt_pk_bf16_f32 v81, v66, v67
v_cvt_pk_bf16_f32 v82, v68, v69
v_cvt_pk_bf16_f32 v83, v70, v71
s_nop 0
v_permlane16_swap_b32 v80, v82
v_permlane16_swap_b32 v81, v83
global_store_dwordx4 v56, v[80:83], s[12:13] offset:0 sc1
v_accvgpr_read_b32 v72, a32
v_accvgpr_read_b32 v73, a33
v_accvgpr_read_b32 v74, a34
v_accvgpr_read_b32 v75, a35
v_accvgpr_read_b32 v76, a48
v_accvgpr_read_b32 v77, a49
v_accvgpr_read_b32 v78, a50
v_accvgpr_read_b32 v79, a51
v_cvt_pk_bf16_f32 v84, v72, v73
v_cvt_pk_bf16_f32 v85, v74, v75
v_cvt_pk_bf16_f32 v86, v76, v77
v_cvt_pk_bf16_f32 v87, v78, v79
s_nop 0
v_permlane16_swap_b32 v84, v86
v_permlane16_swap_b32 v85, v87
global_store_dwordx4 v56, v[84:87], s[12:13] offset:1024 sc1
v_accvgpr_read_b32 v64, a4
v_accvgpr_read_b32 v65, a5
v_accvgpr_read_b32 v66, a6
v_accvgpr_read_b32 v67, a7
v_accvgpr_read_b32 v68, a20
v_accvgpr_read_b32 v69, a21
v_accvgpr_read_b32 v70, a22
v_accvgpr_read_b32 v71, a23
v_cvt_pk_bf16_f32 v80, v64, v65
v_cvt_pk_bf16_f32 v81, v66, v67
v_cvt_pk_bf16_f32 v82, v68, v69
v_cvt_pk_bf16_f32 v83, v70, v71
s_nop 0
v_permlane16_swap_b32 v80, v82
v_permlane16_swap_b32 v81, v83
global_store_dwordx4 v57, v[80:83], s[12:13] offset:0 sc1
v_accvgpr_read_b32 v72, a36
v_accvgpr_read_b32 v73, a37
v_accvgpr_read_b32 v74, a38
v_accvgpr_read_b32 v75, a39
v_accvgpr_read_b32 v76, a52
v_accvgpr_read_b32 v77, a53
v_accvgpr_read_b32 v78, a54
v_accvgpr_read_b32 v79, a55
v_cvt_pk_bf16_f32 v84, v72, v73
v_cvt_pk_bf16_f32 v85, v74, v75
v_cvt_pk_bf16_f32 v86, v76, v77
v_cvt_pk_bf16_f32 v87, v78, v79
s_nop 0
v_permlane16_swap_b32 v84, v86
v_permlane16_swap_b32 v85, v87
global_store_dwordx4 v57, v[84:87], s[12:13] offset:1024 sc1
s_add_u32 s12, s12, 262144
s_addc_u32 s13, s13, 0
v_accvgpr_read_b32 v64, a8
v_accvgpr_read_b32 v65, a9
v_accvgpr_read_b32 v66, a10
v_accvgpr_read_b32 v67, a11
v_accvgpr_read_b32 v68, a24
v_accvgpr_read_b32 v69, a25
v_accvgpr_read_b32 v70, a26
v_accvgpr_read_b32 v71, a27
v_cvt_pk_bf16_f32 v80, v64, v65
v_cvt_pk_bf16_f32 v81, v66, v67
v_cvt_pk_bf16_f32 v82, v68, v69
v_cvt_pk_bf16_f32 v83, v70, v71
s_nop 0
v_permlane16_swap_b32 v80, v82
v_permlane16_swap_b32 v81, v83
global_store_dwordx4 v56, v[80:83], s[12:13] offset:0 sc1
v_accvgpr_read_b32 v72, a40
v_accvgpr_read_b32 v73, a41
v_accvgpr_read_b32 v74, a42
v_accvgpr_read_b32 v75, a43
v_accvgpr_read_b32 v76, a56
v_accvgpr_read_b32 v77, a57
v_accvgpr_read_b32 v78, a58
v_accvgpr_read_b32 v79, a59
v_cvt_pk_bf16_f32 v84, v72, v73
v_cvt_pk_bf16_f32 v85, v74, v75
v_cvt_pk_bf16_f32 v86, v76, v77
v_cvt_pk_bf16_f32 v87, v78, v79
s_nop 0
v_permlane16_swap_b32 v84, v86
v_permlane16_swap_b32 v85, v87
global_store_dwordx4 v56, v[84:87], s[12:13] offset:1024 sc1
v_accvgpr_read_b32 v64, a12
v_accvgpr_read_b32 v65, a13
v_accvgpr_read_b32 v66, a14
v_accvgpr_read_b32 v67, a15
v_accvgpr_read_b32 v68, a28
v_accvgpr_read_b32 v69, a29
v_accvgpr_read_b32 v70, a30
v_accvgpr_read_b32 v71, a31
v_cvt_pk_bf16_f32 v80, v64, v65
v_cvt_pk_bf16_f32 v81, v66, v67
v_cvt_pk_bf16_f32 v82, v68, v69
v_cvt_pk_bf16_f32 v83, v70, v71
s_nop 0
v_permlane16_swap_b32 v80, v82
v_permlane16_swap_b32 v81, v83
global_store_dwordx4 v57, v[80:83], s[12:13] offset:0 sc1
v_accvgpr_read_b32 v72, a44
v_accvgpr_read_b32 v73, a45
v_accvgpr_read_b32 v74, a46
v_accvgpr_read_b32 v75, a47
v_accvgpr_read_b32 v76, a60
v_accvgpr_read_b32 v77, a61
v_accvgpr_read_b32 v78, a62
v_accvgpr_read_b32 v79, a63
v_cvt_pk_bf16_f32 v84, v72, v73
v_cvt_pk_bf16_f32 v85, v74, v75
v_cvt_pk_bf16_f32 v86, v76, v77
v_cvt_pk_bf16_f32 v87, v78, v79
s_nop 0
v_permlane16_swap_b32 v84, v86
v_permlane16_swap_b32 v85, v87
global_store_dwordx4 v57, v[84:87], s[12:13] offset:1024 sc1
s_waitcnt vmcnt(0)
s_barrier
s_cmp_lg_u32 s20, 0
s_cbranch_scc1 M_sg_96
s_lshl_b32 s64, s63, 2
s_add_u32 s64, s64, 96
v_mov_b32 v42, s64
v_mov_b32 v43, 1
s_mov_b64 exec, 1
global_atomic_add v42, v43, s[56:57]
s_mov_b64 exec, -1
M_sg_96:
s_branch W_loop
W_vs:
s_lshr_b32 s63, s61, 2
s_cmp_ge_u32 s63, 2
s_cbranch_scc1 M_lb_97
s_cmp_lg_u32 s20, 0
s_cbranch_scc1 M_wcd_100
s_lshl_b32 s64, s63, 2
s_add_u32 s64, s64, 144
v_mov_b32 v42, s64
s_mov_b32 s65, 0
s_mov_b64 exec, 1
M_wc_99:
global_load_dword v43, v42, s[56:57] sc1
s_waitcnt vmcnt(0)
v_readfirstlane_b32 s64, v43
s_cmp_ge_u32 s64, 64
s_cbranch_scc1 M_wcd_100_x
s_sleep 20
s_add_u32 s65, s65, 1
s_cmp_lt_u32 s65, 400000
s_cbranch_scc1 M_wc_99
s_mov_b64 exec, -1
s_branch M_exit0
M_wcd_100_x:
s_mov_b64 exec, -1
M_wcd_100:
s_barrier
s_branch M_lbd_98
M_lb_97:
s_cmp_eq_u32 s97, 1
s_cbranch_scc1 M_wo_101
s_cmp_lg_u32 s20, 0
s_cbranch_scc1 M_wcd_103
v_mov_b32 v42, 132
s_mov_b32 s65, 0
s_mov_b64 exec, 1
M_wc_102:
global_load_dword v43, v42, s[56:57] sc1
s_waitcnt vmcnt(0)
v_readfirstlane_b32 s64, v43
s_cmp_ge_u32 s64, 128
s_cbranch_scc1 M_wcd_103_x
s_sleep 32
s_add_u32 s65, s65, 1
s_cmp_lt_u32 s65, 400000
s_cbranch_scc1 M_wc_102
s_mov_b64 exec, -1
s_branch M_exit0
M_wcd_103_x:
s_mov_b64 exec, -1
M_wcd_103:
s_barrier
s_mov_b32 s97, 1
M_wo_101:
M_lbd_98:
s_mov_b32 s66, s46
s_mov_b32 s67, s47
s_lshl_b32 s64, s62, 9
s_add_u32 s6, s66, s64
s_addc_u32 s7, s67, 0
s_mul_i32 s64, s61, 4096
s_add_u32 s64, s64, 0
s_add_u32 s4, s40, s64
s_addc_u32 s5, s41, 0
s_mov_b32 s8, 131072
s_mov_b32 s31, 8192
s_mov_b32 s9, 262144
s_mov_b32 s10, 32
s_mul_i32 s64, s61, 524288
s_lshl_b32 s65, s62, 14
s_add_u32 s64, s64, s65
s_add_u32 s64, s64, 50331648
s_add_u32 s12, s40, s64
s_addc_u32 s13, s41, 0
s_mul_i32 s21, s20, 1024
v_lshlrev_b32 v42, 4, v1
v_add_u32 v2, s21, v42
v_lshrrev_b32 v42, 5, v1
s_lshl_b32 s21, s20, 3
v_add_u32 v43, s21, v42
v_mul_lo_u32 v43, v43, s31
v_and_b32 v44, 31, v1
s_and_b32 s21, s20, 1
s_lshl_b32 s21, s21, 3
v_lshl_add_u32 v42, v42, 1, s21
v_xor_b32 v45, v44, v42
v_xor_b32 v46, 4, v45
v_lshl_add_u32 v45, v45, 4, v43
v_lshl_add_u32 v46, v46, 4, v43
s_lshl_b32 s22, s31, 1
s_mov_b32 s21, 0
v_add_u32 v6, s21, v45
s_add_u32 s21, s21, s22
v_add_u32 v7, s21, v46
s_add_u32 s21, s21, s22
v_add_u32 v8, s21, v45
s_add_u32 s21, s21, s22
v_add_u32 v9, s21, v46
s_mul_i32 s29, s20, 1024
s_add_u32 m0, s29, 0
s_nop 0
global_load_lds_dwordx4 v2, s[4:5] sc1
s_add_u32 m0, s26, 0
s_nop 0
global_load_lds_dwordx4 v6, s[6:7]
s_add_u32 m0, s26, 1024
s_nop 0
global_load_lds_dwordx4 v7, s[6:7]
s_add_u32 m0, s26, 2048
s_nop 0
global_load_lds_dwordx4 v8, s[6:7]
s_add_u32 m0, s26, 3072
s_nop 0
global_load_lds_dwordx4 v9, s[6:7]
s_add_u32 s4, s4, s8
s_addc_u32 s5, s5, 0
s_add_u32 s6, s6, s9
s_addc_u32 s7, s7, 0
s_add_u32 m0, s29, 32768
s_nop 0
global_load_lds_dwordx4 v2, s[4:5] sc1
s_add_u32 m0, s26, 32768
s_nop 0
global_load_lds_dwordx4 v6, s[6:7]
s_add_u32 m0, s26, 33792
s_nop 0
global_load_lds_dwordx4 v7, s[6:7]
s_add_u32 m0, s26, 34816
s_nop 0
global_load_lds_dwordx4 v8, s[6:7]
s_add_u32 m0, s26, 35840
s_nop 0
global_load_lds_dwordx4 v9, s[6:7]
s_add_u32 s4, s4, s8
s_addc_u32 s5, s5, 0
s_add_u32 s6, s6, s9
s_addc_u32 s7, s7, 0
s_add_u32 m0, s29, 65536
s_nop 0
global_load_lds_dwordx4 v2, s[4:5] sc1
s_add_u32 m0, s26, 65536
s_nop 0
global_load_lds_dwordx4 v6, s[6:7]
s_add_u32 m0, s26, 66560
s_nop 0
global_load_lds_dwordx4 v7, s[6:7]
s_add_u32 m0, s26, 67584
s_nop 0
global_load_lds_dwordx4 v8, s[6:7]
s_add_u32 m0, s26, 68608
s_nop 0
global_load_lds_dwordx4 v9, s[6:7]
s_add_u32 s4, s4, s8
s_addc_u32 s5, s5, 0
s_add_u32 s6, s6, s9
s_addc_u32 s7, s7, 0
s_add_u32 m0, s29, 98304
s_nop 0
global_load_lds_dwordx4 v2, s[4:5] sc1
s_add_u32 m0, s26, 98304
s_nop 0
global_load_lds_dwordx4 v6, s[6:7]
s_add_u32 m0, s26, 99328
s_nop 0
global_load_lds_dwordx4 v7, s[6:7]
s_add_u32 m0, s26, 100352
s_nop 0
global_load_lds_dwordx4 v8, s[6:7]
s_add_u32 m0, s26, 101376
s_nop 0
global_load_lds_dwordx4 v9, s[6:7]
s_add_u32 s4, s4, s8
s_addc_u32 s5, s5, 0
s_add_u32 s6, s6, s9
s_addc_u32 s7, s7, 0
s_mov_b32 s21, 0
s_mul_i32 s21, s21, 4096
v_and_b32 v42, 15, v1
v_lshlrev_b32 v43, 6, v42
v_add_u32 v43, s21, v43
v_lshrrev_b32 v42, 2, v42
v_lshrrev_b32 v44, 1, v42
v_xor_b32 v45, v42, v44
v_and_b32 v45, 1, v45
v_lshl_add_u32 v44, v45, 1, v44
v_lshrrev_b32 v45, 4, v1
v_xor_b32 v44, v44, v45
v_lshl_add_u32 v10, v44, 4, v43
v_add_u32 v11, 0x10000, v10
s_mov_b32 s21, s20
v_and_b32 v42, 15, v1
v_lshrrev_b32 v43, 2, v42
v_lshrrev_b32 v44, 4, v1
v_lshl_add_u32 v45, v44, 3, v43
v_lshlrev_b32 v45, 9, v45
v_and_b32 v46, 1, v42
v_lshl_add_u32 v45, v46, 3, v45
v_bfe_u32 v46, v42, 1, 1
v_lshl_add_u32 v45, v46, 4, v45
v_add_u32 v45, 16384, v45
v_and_b32 v44, 1, v44
v_lshl_add_u32 v43, v44, 2, v43
s_mul_i32 s22, s21, 4
s_add_u32 s23, s22, 0
s_and_b32 s24, s23, 7
s_and_b32 s23, s23, 8
v_xor_b32 v46, s24, v43
v_add_u32 v46, s23, v46
v_lshl_add_u32 v26, v46, 5, v45
v_add_u32 v34, 0x10000, v26
s_add_u32 s23, s22, 1
s_and_b32 s24, s23, 7
s_and_b32 s23, s23, 8
v_xor_b32 v46, s24, v43
v_add_u32 v46, s23, v46
v_lshl_add_u32 v27, v46, 5, v45
v_add_u32 v35, 0x10000, v27
s_add_u32 s23, s22, 2
s_and_b32 s24, s23, 7
s_and_b32 s23, s23, 8
v_xor_b32 v46, s24, v43
v_add_u32 v46, s23, v46
v_lshl_add_u32 v28, v46, 5, v45
v_add_u32 v36, 0x10000, v28
s_add_u32 s23, s22, 3
s_and_b32 s24, s23, 7
s_and_b32 s23, s23, 8
v_xor_b32 v46, s24, v43
v_add_u32 v46, s23, v46
v_lshl_add_u32 v29, v46, 5, v45
v_add_u32 v37, 0x10000, v29
s_waitcnt vmcnt(0)
s_barrier
ds_read_b64_tr_b16 v[160:161], v26 offset:0
ds_read_b64_tr_b16 v[162:163], v26 offset:2048
ds_read_b128 v[128:131], v10 offset:0
ds_read_b128 v[132:135], v10 offset:1024
ds_read_b128 v[136:139], v10 offset:2048
ds_read_b128 v[140:143], v10 offset:3072
ds_read_b64_tr_b16 v[164:165], v27 offset:0
ds_read_b64_tr_b16 v[166:167], v27 offset:2048
ds_read_b64_tr_b16 v[168:169], v28 offset:0
ds_read_b64_tr_b16 v[170:171], v28 offset:2048
ds_read_b64_tr_b16 v[172:173], v29 offset:0
ds_read_b64_tr_b16 v[174:175], v29 offset:2048
s_lshr_b32 s11, s10, 2
s_sub_u32 s11, s11, 1
s_waitcnt lgkmcnt(0)
v_mfma_f32_16x16x32_bf16 a[0:3], v[128:131], v[160:163], 0
v_mfma_f32_16x16x32_bf16 a[4:7], v[132:135], v[160:163], 0
v_mfma_f32_16x16x32_bf16 a[8:11], v[136:139], v[160:163], 0
v_mfma_f32_16x16x32_bf16 a[12:15], v[140:143], v[160:163], 0
v_mfma_f32_16x16x32_bf16 a[16:19], v[128:131], v[164:167], 0
v_mfma_f32_16x16x32_bf16 a[20:23], v[132:135], v[164:167], 0
v_mfma_f32_16x16x32_bf16 a[24:27], v[136:139], v[164:167], 0
v_mfma_f32_16x16x32_bf16 a[28:31], v[140:143], v[164:167], 0
s_barrier
v_mfma_f32_16x16x32_bf16 a[32:35], v[128:131], v[168:171], 0
ds_read_b64_tr_b16 v[224:225], v26 offset:32768
ds_read_b64_tr_b16 v[226:227], v26 offset:34816
v_mfma_f32_16x16x32_bf16 a[36:39], v[132:135], v[168:171], 0
s_add_u32 m0, s29, 0
ds_read_b128 v[192:195], v10 offset:32768
ds_read_b128 v[196:199], v10 offset:33792
v_mfma_f32_16x16x32_bf16 a[40:43], v[136:139], v[168:171], 0
global_load_lds_dwordx4 v2, s[4:5] sc1
ds_read_b128 v[200:203], v10 offset:34816
ds_read_b128 v[204:207], v10 offset:35840
v_mfma_f32_16x16x32_bf16 a[44:47], v[140:143], v[168:171], 0
ds_read_b64_tr_b16 v[228:229], v27 offset:32768
ds_read_b64_tr_b16 v[230:231], v27 offset:34816
v_mfma_f32_16x16x32_bf16 a[48:51], v[128:131], v[172:175], 0
ds_read_b64_tr_b16 v[232:233], v28 offset:32768
ds_read_b64_tr_b16 v[234:235], v28 offset:34816
v_mfma_f32_16x16x32_bf16 a[52:55], v[132:135], v[172:175], 0
ds_read_b64_tr_b16 v[236:237], v29 offset:32768
ds_read_b64_tr_b16 v[238:239], v29 offset:34816
v_mfma_f32_16x16x32_bf16 a[56:59], v[136:139], v[172:175], 0
v_mfma_f32_16x16x32_bf16 a[60:63], v[140:143], v[172:175], 0
s_add_u32 s4, s4, s8
s_addc_u32 s5, s5, 0
M_gl_104:
s_waitcnt lgkmcnt(0)
v_mfma_f32_16x16x32_bf16 a[0:3], v[192:195], v[224:227], a[0:3]
s_add_u32 m0, s26, 0
v_mfma_f32_16x16x32_bf16 a[4:7], v[196:199], v[224:227], a[4:7]
global_load_lds_dwordx4 v6, s[6:7]
v_mfma_f32_16x16x32_bf16 a[8:11], v[200:203], v[224:227], a[8:11]
s_add_u32 m0, s26, 1024
v_mfma_f32_16x16x32_bf16 a[12:15], v[204:207], v[224:227], a[12:15]
global_load_lds_dwordx4 v7, s[6:7]
v_mfma_f32_16x16x32_bf16 a[16:19], v[192:195], v[228:231], a[16:19]
s_add_u32 m0, s26, 2048
v_mfma_f32_16x16x32_bf16 a[20:23], v[196:199], v[228:231], a[20:23]
global_load_lds_dwordx4 v8, s[6:7]
v_mfma_f32_16x16x32_bf16 a[24:27], v[200:203], v[228:231], a[24:27]
s_add_u32 m0, s26, 3072
v_mfma_f32_16x16x32_bf16 a[28:31], v[204:207], v[228:231], a[28:31]
global_load_lds_dwordx4 v9, s[6:7]
s_add_u32 s6, s6, s9
s_addc_u32 s7, s7, 0
s_waitcnt vmcnt(10)
s_barrier
v_mfma_f32_16x16x32_bf16 a[32:35], v[192:195], v[232:235], a[32:35]
ds_read_b64_tr_b16 v[160:161], v34 offset:0
ds_read_b64_tr_b16 v[162:163], v34 offset:2048
v_mfma_f32_16x16x32_bf16 a[36:39], v[196:199], v[232:235], a[36:39]
s_add_u32 m0, s29, 32768
ds_read_b128 v[128:131], v11 offset:0
ds_read_b128 v[132:135], v11 offset:1024
v_mfma_f32_16x16x32_bf16 a[40:43], v[200:203], v[232:235], a[40:43]
global_load_lds_dwordx4 v2, s[4:5] sc1
ds_read_b128 v[136:139], v11 offset:2048
ds_read_b128 v[140:143], v11 offset:3072
v_mfma_f32_16x16x32_bf16 a[44:47], v[204:207], v[232:235], a[44:47]
ds_read_b64_tr_b16 v[164:165], v35 offset:0
ds_read_b64_tr_b16 v[166:167], v35 offset:2048
v_mfma_f32_16x16x32_bf16 a[48:51], v[192:195], v[236:239], a[48:51]
ds_read_b64_tr_b16 v[168:169], v36 offset:0
ds_read_b64_tr_b16 v[170:171], v36 offset:2048
v_mfma_f32_16x16x32_bf16 a[52:55], v[196:199], v[236:239], a[52:55]
ds_read_b64_tr_b16 v[172:173], v37 offset:0
ds_read_b64_tr_b16 v[174:175], v37 offset:2048
v_mfma_f32_16x16x32_bf16 a[56:59], v[200:203], v[236:239], a[56:59]
v_mfma_f32_16x16x32_bf16 a[60:63], v[204:207], v[236:239], a[60:63]
s_add_u32 s4, s4, s8
s_addc_u32 s5, s5, 0
s_waitcnt lgkmcnt(0)
v_mfma_f32_16x16x32_bf16 a[0:3], v[128:131], v[160:163], a[0:3]
s_add_u32 m0, s26, 32768
v_mfma_f32_16x16x32_bf16 a[4:7], v[132:135], v[160:163], a[4:7]
global_load_lds_dwordx4 v6, s[6:7]
v_mfma_f32_16x16x32_bf16 a[8:11], v[136:139], v[160:163], a[8:11]
s_add_u32 m0, s26, 33792
v_mfma_f32_16x16x32_bf16 a[12:15], v[140:143], v[160:163], a[12:15]
global_load_lds_dwordx4 v7, s[6:7]
v_mfma_f32_16x16x32_bf16 a[16:19], v[128:131], v[164:167], a[16:19]
s_add_u32 m0, s26, 34816
v_mfma_f32_16x16x32_bf16 a[20:23], v[132:135], v[164:167], a[20:23]
global_load_lds_dwordx4 v8, s[6:7]
v_mfma_f32_16x16x32_bf16 a[24:27], v[136:139], v[164:167], a[24:27]
s_add_u32 m0, s26, 35840
v_mfma_f32_16x16x32_bf16 a[28:31], v[140:143], v[164:167], a[28:31]
global_load_lds_dwordx4 v9, s[6:7]
s_add_u32 s6, s6, s9
s_addc_u32 s7, s7, 0
s_waitcnt vmcnt(10)
s_barrier
v_mfma_f32_16x16x32_bf16 a[32:35], v[128:131], v[168:171], a[32:35]
ds_read_b64_tr_b16 v[224:225], v34 offset:32768
ds_read_b64_tr_b16 v[226:227], v34 offset:34816
v_mfma_f32_16x16x32_bf16 a[36:39], v[132:135], v[168:171], a[36:39]
s_add_u32 m0, s29, 65536
ds_read_b128 v[192:195], v11 offset:32768
ds_read_b128 v[196:199], v11 offset:33792
v_mfma_f32_16x16x32_bf16 a[40:43], v[136:139], v[168:171], a[40:43]
global_load_lds_dwordx4 v2, s[4:5] sc1
ds_read_b128 v[200:203], v11 offset:34816
ds_read_b128 v[204:207], v11 offset:35840
v_mfma_f32_16x16x32_bf16 a[44:47], v[140:143], v[168:171], a[44:47]
ds_read_b64_tr_b16 v[228:229], v35 offset:32768
ds_read_b64_tr_b16 v[230:231], v35 offset:34816
v_mfma_f32_16x16x32_bf16 a[48:51], v[128:131], v[172:175], a[48:51]
ds_read_b64_tr_b16 v[232:233], v36 offset:32768
ds_read_b64_tr_b16 v[234:235], v36 offset:34816
v_mfma_f32_16x16x32_bf16 a[52:55], v[132:135], v[172:175], a[52:55]
ds_read_b64_tr_b16 v[236:237], v37 offset:32768
ds_read_b64_tr_b16 v[238:239], v37 offset:34816
v_mfma_f32_16x16x32_bf16 a[56:59], v[136:139], v[172:175], a[56:59]
v_mfma_f32_16x16x32_bf16 a[60:63], v[140:143], v[172:175], a[60:63]
s_add_u32 s4, s4, s8
s_addc_u32 s5, s5, 0
s_waitcnt lgkmcnt(0)
v_mfma_f32_16x16x32_bf16 a[0:3], v[192:195], v[224:227], a[0:3]
s_add_u32 m0, s26, 65536
v_mfma_f32_16x16x32_bf16 a[4:7], v[196:199], v[224:227], a[4:7]
global_load_lds_dwordx4 v6, s[6:7]
v_mfma_f32_16x16x32_bf16 a[8:11], v[200:203], v[224:227], a[8:11]
s_add_u32 m0, s26, 66560
v_mfma_f32_16x16x32_bf16 a[12:15], v[204:207], v[224:227], a[12:15]
global_load_lds_dwordx4 v7, s[6:7]
v_mfma_f32_16x16x32_bf16 a[16:19], v[192:195], v[228:231], a[16:19]
s_add_u32 m0, s26, 67584
v_mfma_f32_16x16x32_bf16 a[20:23], v[196:199], v[228:231], a[20:23]
global_load_lds_dwordx4 v8, s[6:7]
v_mfma_f32_16x16x32_bf16 a[24:27], v[200:203], v[228:231], a[24:27]
s_add_u32 m0, s26, 68608
v_mfma_f32_16x16x32_bf16 a[28:31], v[204:207], v[228:231], a[28:31]
global_load_lds_dwordx4 v9, s[6:7]
s_add_u32 s6, s6, s9
s_addc_u32 s7, s7, 0
s_waitcnt vmcnt(10)
s_barrier
v_mfma_f32_16x16x32_bf16 a[32:35], v[192:195], v[232:235], a[32:35]
ds_read_b64_tr_b16 v[160:161], v26 offset:0
ds_read_b64_tr_b16 v[162:163], v26 offset:2048
v_mfma_f32_16x16x32_bf16 a[36:39], v[196:199], v[232:235], a[36:39]
s_add_u32 m0, s29, 98304
ds_read_b128 v[128:131], v10 offset:0
ds_read_b128 v[132:135], v10 offset:1024
v_mfma_f32_16x16x32_bf16 a[40:43], v[200:203], v[232:235], a[40:43]
global_load_lds_dwordx4 v2, s[4:5] sc1
ds_read_b128 v[136:139], v10 offset:2048
ds_read_b128 v[140:143], v10 offset:3072
v_mfma_f32_16x16x32_bf16 a[44:47], v[204:207], v[232:235], a[44:47]
ds_read_b64_tr_b16 v[164:165], v27 offset:0
ds_read_b64_tr_b16 v[166:167], v27 offset:2048
v_mfma_f32_16x16x32_bf16 a[48:51], v[192:195], v[236:239], a[48:51]
ds_read_b64_tr_b16 v[168:169], v28 offset:0
ds_read_b64_tr_b16 v[170:171], v28 offset:2048
v_mfma_f32_16x16x32_bf16 a[52:55], v[196:199], v[236:239], a[52:55]
ds_read_b64_tr_b16 v[172:173], v29 offset:0
ds_read_b64_tr_b16 v[174:175], v29 offset:2048
v_mfma_f32_16x16x32_bf16 a[56:59], v[200:203], v[236:239], a[56:59]
v_mfma_f32_16x16x32_bf16 a[60:63], v[204:207], v[236:239], a[60:63]
s_add_u32 s4, s4, s8
s_addc_u32 s5, s5, 0
s_sub_u32 s11, s11, 1
s_cmp_eq_u32 s11, 0
s_cbranch_scc1 M_gle_105
s_waitcnt lgkmcnt(0)
v_mfma_f32_16x16x32_bf16 a[0:3], v[128:131], v[160:163], a[0:3]
s_add_u32 m0, s26, 98304
v_mfma_f32_16x16x32_bf16 a[4:7], v[132:135], v[160:163], a[4:7]
global_load_lds_dwordx4 v6, s[6:7]
v_mfma_f32_16x16x32_bf16 a[8:11], v[136:139], v[160:163], a[8:11]
s_add_u32 m0, s26, 99328
v_mfma_f32_16x16x32_bf16 a[12:15], v[140:143], v[160:163], a[12:15]
global_load_lds_dwordx4 v7, s[6:7]
v_mfma_f32_16x16x32_bf16 a[16:19], v[128:131], v[164:167], a[16:19]
s_add_u32 m0, s26, 100352
v_mfma_f32_16x16x32_bf16 a[20:23], v[132:135], v[164:167], a[20:23]
global_load_lds_dwordx4 v8, s[6:7]
v_mfma_f32_16x16x32_bf16 a[24:27], v[136:139], v[164:167], a[24:27]
s_add_u32 m0, s26, 101376
v_mfma_f32_16x16x32_bf16 a[28:31], v[140:143], v[164:167], a[28:31]
global_load_lds_dwordx4 v9, s[6:7]
s_add_u32 s6, s6, s9
s_addc_u32 s7, s7, 0
s_waitcnt vmcnt(10)
s_barrier
v_mfma_f32_16x16x32_bf16 a[32:35], v[128:131], v[168:171], a[32:35]
ds_read_b64_tr_b16 v[224:225], v26 offset:32768
ds_read_b64_tr_b16 v[226:227], v26 offset:34816
v_mfma_f32_16x16x32_bf16 a[36:39], v[132:135], v[168:171], a[36:39]
s_add_u32 m0, s29, 0
ds_read_b128 v[192:195], v10 offset:32768
ds_read_b128 v[196:199], v10 offset:33792
v_mfma_f32_16x16x32_bf16 a[40:43], v[136:139], v[168:171], a[40:43]
global_load_lds_dwordx4 v2, s[4:5] sc1
ds_read_b128 v[200:203], v10 offset:34816
ds_read_b128 v[204:207], v10 offset:35840
v_mfma_f32_16x16x32_bf16 a[44:47], v[140:143], v[168:171], a[44:47]
ds_read_b64_tr_b16 v[228:229], v27 offset:32768
ds_read_b64_tr_b16 v[230:231], v27 offset:34816
v_mfma_f32_16x16x32_bf16 a[48:51], v[128:131], v[172:175], a[48:51]
ds_read_b64_tr_b16 v[232:233], v28 offset:32768
ds_read_b64_tr_b16 v[234:235], v28 offset:34816
v_mfma_f32_16x16x32_bf16 a[52:55], v[132:135], v[172:175], a[52:55]
ds_read_b64_tr_b16 v[236:237], v29 offset:32768
ds_read_b64_tr_b16 v[238:239], v29 offset:34816
v_mfma_f32_16x16x32_bf16 a[56:59], v[136:139], v[172:175], a[56:59]
v_mfma_f32_16x16x32_bf16 a[60:63], v[140:143], v[172:175], a[60:63]
s_add_u32 s4, s4, s8
s_addc_u32 s5, s5, 0
s_branch M_gl_104
M_gle_105:
s_waitcnt lgkmcnt(0)
v_mfma_f32_16x16x32_bf16 a[0:3], v[128:131], v[160:163], a[0:3]
s_add_u32 m0, s26, 98304
v_mfma_f32_16x16x32_bf16 a[4:7], v[132:135], v[160:163], a[4:7]
global_load_lds_dwordx4 v6, s[6:7]
v_mfma_f32_16x16x32_bf16 a[8:11], v[136:139], v[160:163], a[8:11]
s_add_u32 m0, s26, 99328
v_mfma_f32_16x16x32_bf16 a[12:15], v[140:143], v[160:163], a[12:15]
global_load_lds_dwordx4 v7, s[6:7]
v_mfma_f32_16x16x32_bf16 a[16:19], v[128:131], v[164:167], a[16:19]
s_add_u32 m0, s26, 100352
v_mfma_f32_16x16x32_bf16 a[20:23], v[132:135], v[164:167], a[20:23]
global_load_lds_dwordx4 v8, s[6:7]
v_mfma_f32_16x16x32_bf16 a[24:27], v[136:139], v[164:167], a[24:27]
s_add_u32 m0, s26, 101376
v_mfma_f32_16x16x32_bf16 a[28:31], v[140:143], v[164:167], a[28:31]
global_load_lds_dwordx4 v9, s[6:7]
s_add_u32 s6, s6, s9
s_addc_u32 s7, s7, 0
s_waitcnt vmcnt(10)
s_barrier
v_mfma_f32_16x16x32_bf16 a[32:35], v[128:131], v[168:171], a[32:35]
ds_read_b64_tr_b16 v[224:225], v26 offset:32768
ds_read_b64_tr_b16 v[226:227], v26 offset:34816
v_mfma_f32_16x16x32_bf16 a[36:39], v[132:135], v[168:171], a[36:39]
ds_read_b128 v[192:195], v10 offset:32768
ds_read_b128 v[196:199], v10 offset:33792
v_mfma_f32_16x16x32_bf16 a[40:43], v[136:139], v[168:171], a[40:43]
ds_read_b128 v[200:203], v10 offset:34816
ds_read_b128 v[204:207], v10 offset:35840
v_mfma_f32_16x16x32_bf16 a[44:47], v[140:143], v[168:171], a[44:47]
ds_read_b64_tr_b16 v[228:229], v27 offset:32768
ds_read_b64_tr_b16 v[230:231], v27 offset:34816
v_mfma_f32_16x16x32_bf16 a[48:51], v[128:131], v[172:175], a[48:51]
ds_read_b64_tr_b16 v[232:233], v28 offset:32768
ds_read_b64_tr_b16 v[234:235], v28 offset:34816
v_mfma_f32_16x16x32_bf16 a[52:55], v[132:135], v[172:175], a[52:55]
ds_read_b64_tr_b16 v[236:237], v29 offset:32768
ds_read_b64_tr_b16 v[238:239], v29 offset:34816
v_mfma_f32_16x16x32_bf16 a[56:59], v[136:139], v[172:175], a[56:59]
v_mfma_f32_16x16x32_bf16 a[60:63], v[140:143], v[172:175], a[60:63]
s_waitcnt lgkmcnt(0)
v_mfma_f32_16x16x32_bf16 a[0:3], v[192:195], v[224:227], a[0:3]
v_mfma_f32_16x16x32_bf16 a[4:7], v[196:199], v[224:227], a[4:7]
v_mfma_f32_16x16x32_bf16 a[8:11], v[200:203], v[224:227], a[8:11]
v_mfma_f32_16x16x32_bf16 a[12:15], v[204:207], v[224:227], a[12:15]
v_mfma_f32_16x16x32_bf16 a[16:19], v[192:195], v[228:231], a[16:19]
v_mfma_f32_16x16x32_bf16 a[20:23], v[196:199], v[228:231], a[20:23]
v_mfma_f32_16x16x32_bf16 a[24:27], v[200:203], v[228:231], a[24:27]
v_mfma_f32_16x16x32_bf16 a[28:31], v[204:207], v[228:231], a[28:31]
s_waitcnt vmcnt(5)
s_barrier
v_mfma_f32_16x16x32_bf16 a[32:35], v[192:195], v[232:235], a[32:35]
ds_read_b64_tr_b16 v[160:161], v34 offset:0
ds_read_b64_tr_b16 v[162:163], v34 offset:2048
v_mfma_f32_16x16x32_bf16 a[36:39], v[196:199], v[232:235], a[36:39]
ds_read_b128 v[128:131], v11 offset:0
ds_read_b128 v[132:135], v11 offset:1024
v_mfma_f32_16x16x32_bf16 a[40:43], v[200:203], v[232:235], a[40:43]
ds_read_b128 v[136:139], v11 offset:2048
ds_read_b128 v[140:143], v11 offset:3072
v_mfma_f32_16x16x32_bf16 a[44:47], v[204:207], v[232:235], a[44:47]
ds_read_b64_tr_b16 v[164:165], v35 offset:0
ds_read_b64_tr_b16 v[166:167], v35 offset:2048
v_mfma_f32_16x16x32_bf16 a[48:51], v[192:195], v[236:239], a[48:51]
ds_read_b64_tr_b16 v[168:169], v36 offset:0
ds_read_b64_tr_b16 v[170:171], v36 offset:2048
v_mfma_f32_16x16x32_bf16 a[52:55], v[196:199], v[236:239], a[52:55]
ds_read_b64_tr_b16 v[172:173], v37 offset:0
ds_read_b64_tr_b16 v[174:175], v37 offset:2048
v_mfma_f32_16x16x32_bf16 a[56:59], v[200:203], v[236:239], a[56:59]
v_mfma_f32_16x16x32_bf16 a[60:63], v[204:207], v[236:239], a[60:63]
s_waitcnt lgkmcnt(0)
v_mfma_f32_16x16x32_bf16 a[0:3], v[128:131], v[160:163], a[0:3]
v_mfma_f32_16x16x32_bf16 a[4:7], v[132:135], v[160:163], a[4:7]
v_mfma_f32_16x16x32_bf16 a[8:11], v[136:139], v[160:163], a[8:11]
v_mfma_f32_16x16x32_bf16 a[12:15], v[140:143], v[160:163], a[12:15]
v_mfma_f32_16x16x32_bf16 a[16:19], v[128:131], v[164:167], a[16:19]
v_mfma_f32_16x16x32_bf16 a[20:23], v[132:135], v[164:167], a[20:23]
v_mfma_f32_16x16x32_bf16 a[24:27], v[136:139], v[164:167], a[24:27]
v_mfma_f32_16x16x32_bf16 a[28:31], v[140:143], v[164:167], a[28:31]
s_waitcnt vmcnt(0)
s_barrier
v_mfma_f32_16x16x32_bf16 a[32:35], v[128:131], v[168:171], a[32:35]
ds_read_b64_tr_b16 v[224:225], v34 offset:32768
ds_read_b64_tr_b16 v[226:227], v34 offset:34816
v_mfma_f32_16x16x32_bf16 a[36:39], v[132:135], v[168:171], a[36:39]
ds_read_b128 v[192:195], v11 offset:32768
ds_read_b128 v[196:199], v11 offset:33792
v_mfma_f32_16x16x32_bf16 a[40:43], v[136:139], v[168:171], a[40:43]
ds_read_b128 v[200:203], v11 offset:34816
ds_read_b128 v[204:207], v11 offset:35840
v_mfma_f32_16x16x32_bf16 a[44:47], v[140:143], v[168:171], a[44:47]
ds_read_b64_tr_b16 v[228:229], v35 offset:32768
ds_read_b64_tr_b16 v[230:231], v35 offset:34816
v_mfma_f32_16x16x32_bf16 a[48:51], v[128:131], v[172:175], a[48:51]
ds_read_b64_tr_b16 v[232:233], v36 offset:32768
ds_read_b64_tr_b16 v[234:235], v36 offset:34816
v_mfma_f32_16x16x32_bf16 a[52:55], v[132:135], v[172:175], a[52:55]
ds_read_b64_tr_b16 v[236:237], v37 offset:32768
ds_read_b64_tr_b16 v[238:239], v37 offset:34816
v_mfma_f32_16x16x32_bf16 a[56:59], v[136:139], v[172:175], a[56:59]
v_mfma_f32_16x16x32_bf16 a[60:63], v[140:143], v[172:175], a[60:63]
s_waitcnt lgkmcnt(0)
v_mfma_f32_16x16x32_bf16 a[0:3], v[192:195], v[224:227], a[0:3]
v_mfma_f32_16x16x32_bf16 a[4:7], v[196:199], v[224:227], a[4:7]
v_mfma_f32_16x16x32_bf16 a[8:11], v[200:203], v[224:227], a[8:11]
v_mfma_f32_16x16x32_bf16 a[12:15], v[204:207], v[224:227], a[12:15]
v_mfma_f32_16x16x32_bf16 a[16:19], v[192:195], v[228:231], a[16:19]
v_mfma_f32_16x16x32_bf16 a[20:23], v[196:199], v[228:231], a[20:23]
v_mfma_f32_16x16x32_bf16 a[24:27], v[200:203], v[228:231], a[24:27]
v_mfma_f32_16x16x32_bf16 a[28:31], v[204:207], v[228:231], a[28:31]
v_mfma_f32_16x16x32_bf16 a[32:35], v[192:195], v[232:235], a[32:35]
v_mfma_f32_16x16x32_bf16 a[36:39], v[196:199], v[232:235], a[36:39]
v_mfma_f32_16x16x32_bf16 a[40:43], v[200:203], v[232:235], a[40:43]
v_mfma_f32_16x16x32_bf16 a[44:47], v[204:207], v[232:235], a[44:47]
v_mfma_f32_16x16x32_bf16 a[48:51], v[192:195], v[236:239], a[48:51]
v_mfma_f32_16x16x32_bf16 a[52:55], v[196:199], v[236:239], a[52:55]
v_mfma_f32_16x16x32_bf16 a[56:59], v[200:203], v[236:239], a[56:59]
v_mfma_f32_16x16x32_bf16 a[60:63], v[204:207], v[236:239], a[60:63]
s_mov_b32 s21, 0
s_mov_b32 s22, s20
s_mul_i32 s21, s21, 524288
s_lshr_b32 s23, s22, 1
s_lshl_b32 s23, s23, 13
s_and_b32 s22, s22, 1
s_lshl_b32 s22, s22, 12
s_add_u32 s22, s22, s23
s_add_u32 s21, s21, s22
v_lshlrev_b32 v42, 4, v1
v_add_u32 v56, s21, v42
v_add_u32 v57, 4096, v56
v_accvgpr_read_b32 v64, a0
v_accvgpr_read_b32 v65, a1
v_accvgpr_read_b32 v66, a2
v_accvgpr_read_b32 v67, a3
v_accvgpr_read_b32 v68, a4
v_accvgpr_read_b32 v69, a5
v_accvgpr_read_b32 v70, a6
v_accvgpr_read_b32 v71, a7
v_cvt_pk_bf16_f32 v80, v64, v65
v_cvt_pk_bf16_f32 v81, v66, v67
v_cvt_pk_bf16_f32 v82, v68, v69
v_cvt_pk_bf16_f32 v83, v70, v71
global_store_dwordx4 v56, v[80:83], s[12:13] offset:0 sc1
v_accvgpr_read_b32 v72, a16
v_accvgpr_read_b32 v73, a17
v_accvgpr_read_b32 v74, a18
v_accvgpr_read_b32 v75, a19
v_accvgpr_read_b32 v76, a20
v_accvgpr_read_b32 v77, a21
v_accvgpr_read_b32 v78, a22
v_accvgpr_read_b32 v79, a23
v_cvt_pk_bf16_f32 v84, v72, v73
v_cvt_pk_bf16_f32 v85, v74, v75
v_cvt_pk_bf16_f32 v86, v76, v77
v_cvt_pk_bf16_f32 v87, v78, v79
global_store_dwordx4 v56, v[84:87], s[12:13] offset:1024 sc1
v_accvgpr_read_b32 v64, a32
v_accvgpr_read_b32 v65, a33
v_accvgpr_read_b32 v66, a34
v_accvgpr_read_b32 v67, a35
v_accvgpr_read_b32 v68, a36
v_accvgpr_read_b32 v69, a37
v_accvgpr_read_b32 v70, a38
v_accvgpr_read_b32 v71, a39
v_cvt_pk_bf16_f32 v80, v64, v65
v_cvt_pk_bf16_f32 v81, v66, v67
v_cvt_pk_bf16_f32 v82, v68, v69
v_cvt_pk_bf16_f32 v83, v70, v71
global_store_dwordx4 v56, v[80:83], s[12:13] offset:2048 sc1
v_accvgpr_read_b32 v72, a48
v_accvgpr_read_b32 v73, a49
v_accvgpr_read_b32 v74, a50
v_accvgpr_read_b32 v75, a51
v_accvgpr_read_b32 v76, a52
v_accvgpr_read_b32 v77, a53
v_accvgpr_read_b32 v78, a54
v_accvgpr_read_b32 v79, a55
v_cvt_pk_bf16_f32 v84, v72, v73
v_cvt_pk_bf16_f32 v85, v74, v75
v_cvt_pk_bf16_f32 v86, v76, v77
v_cvt_pk_bf16_f32 v87, v78, v79
global_store_dwordx4 v56, v[84:87], s[12:13] offset:3072 sc1
s_add_u32 s12, s12, 262144
s_addc_u32 s13, s13, 0
v_accvgpr_read_b32 v64, a8
v_accvgpr_read_b32 v65, a9
v_accvgpr_read_b32 v66, a10
v_accvgpr_read_b32 v67, a11
v_accvgpr_read_b32 v68, a12
v_accvgpr_read_b32 v69, a13
v_accvgpr_read_b32 v70, a14
v_accvgpr_read_b32 v71, a15
v_cvt_pk_bf16_f32 v80, v64, v65
v_cvt_pk_bf16_f32 v81, v66, v67
v_cvt_pk_bf16_f32 v82, v68, v69
v_cvt_pk_bf16_f32 v83, v70, v71
global_store_dwordx4 v56, v[80:83], s[12:13] offset:0 sc1
v_accvgpr_read_b32 v72, a24
v_accvgpr_read_b32 v73, a25
v_accvgpr_read_b32 v74, a26
v_accvgpr_read_b32 v75, a27
v_accvgpr_read_b32 v76, a28
v_accvgpr_read_b32 v77, a29
v_accvgpr_read_b32 v78, a30
v_accvgpr_read_b32 v79, a31
v_cvt_pk_bf16_f32 v84, v72, v73
v_cvt_pk_bf16_f32 v85, v74, v75
v_cvt_pk_bf16_f32 v86, v76, v77
v_cvt_pk_bf16_f32 v87, v78, v79
global_store_dwordx4 v56, v[84:87], s[12:13] offset:1024 sc1
v_accvgpr_read_b32 v64, a40
v_accvgpr_read_b32 v65, a41
v_accvgpr_read_b32 v66, a42
v_accvgpr_read_b32 v67, a43
v_accvgpr_read_b32 v68, a44
v_accvgpr_read_b32 v69, a45
v_accvgpr_read_b32 v70, a46
v_accvgpr_read_b32 v71, a47
v_cvt_pk_bf16_f32 v80, v64, v65
v_cvt_pk_bf16_f32 v81, v66, v67
v_cvt_pk_bf16_f32 v82, v68, v69
v_cvt_pk_bf16_f32 v83, v70, v71
global_store_dwordx4 v56, v[80:83], s[12:13] offset:2048 sc1
v_accvgpr_read_b32 v72, a56
v_accvgpr_read_b32 v73, a57
v_accvgpr_read_b32 v74, a58
v_accvgpr_read_b32 v75, a59
v_accvgpr_read_b32 v76, a60
v_accvgpr_read_b32 v77, a61
v_accvgpr_read_b32 v78, a62
v_accvgpr_read_b32 v79, a63
v_cvt_pk_bf16_f32 v84, v72, v73
v_cvt_pk_bf16_f32 v85, v74, v75
v_cvt_pk_bf16_f32 v86, v76, v77
v_cvt_pk_bf16_f32 v87, v78, v79
global_store_dwordx4 v56, v[84:87], s[12:13] offset:3072 sc1
s_waitcnt vmcnt(0)
s_barrier
s_cmp_lg_u32 s20, 0
s_cbranch_scc1 M_sg_106
s_lshl_b32 s64, s63, 2
s_add_u32 s64, s64, 96
v_mov_b32 v42, s64
v_mov_b32 v43, 1
s_mov_b64 exec, 1
global_atomic_add v42, v43, s[56:57]
s_mov_b64 exec, -1
M_sg_106:
s_branch W_loop
W_m1:
s_mul_i32 s64, s58, 14
s_add_u32 s64, s64, s62
s_and_b32 s61, s64, 3
s_lshr_b32 s62, s64, 2
s_cmp_eq_u32 s97, 1
s_cbranch_scc1 M_wo_107
s_cmp_lg_u32 s20, 0
s_cbranch_scc1 M_wcd_109
v_mov_b32 v42, 132
s_mov_b32 s65, 0
s_mov_b64 exec, 1
M_wc_108:
global_load_dword v43, v42, s[56:57] sc1
s_waitcnt vmcnt(0)
v_readfirstlane_b32 s64, v43
s_cmp_ge_u32 s64, 128
s_cbranch_scc1 M_wcd_109_x
s_sleep 32
s_add_u32 s65, s65, 1
s_cmp_lt_u32 s65, 400000
s_cbranch_scc1 M_wc_108
s_mov_b64 exec, -1
s_branch M_exit0
M_wcd_109_x:
s_mov_b64 exec, -1
M_wcd_109:
s_barrier
s_mov_b32 s97, 1
M_wo_107:
s_lshl_b32 s64, s61, 9
s_add_u32 s64, s64, 4194304
s_add_u32 s4, s40, s64
s_addc_u32 s5, s41, 0
s_lshl_b32 s64, s62, 9
s_add_u32 s6, s48, s64
s_addc_u32 s7, s49, 0
s_add_u32 s14, s50, s64
s_addc_u32 s15, s51, 0
s_mov_b32 s30, 2048
s_mov_b32 s8, 65536
s_mov_b32 s31, 7168
s_mov_b32 s9, 229376
s_mov_b32 s10, 64
s_lshl_b32 s64, s62, 19
s_lshl_b32 s65, s61, 14
s_add_u32 s64, s64, s65
s_add_u32 s64, s64, 67108864
s_add_u32 s12, s40, s64
s_addc_u32 s13, s41, 0
s_lshl_b32 s64, s62, 2
s_add_u32 s64, s64, s61
s_lshl_b32 s64, s64, 18
s_lshl_b32 s65, s20, 10
s_add_u32 s64, s64, s65
s_add_u32 s36, s52, s64
s_addc_u32 s37, s53, 0
s_add_u32 s38, s65, 131072
v_lshlrev_b32 v55, 4, v1
v_lshrrev_b32 v42, 5, v1
s_lshl_b32 s21, s20, 3
v_add_u32 v43, s21, v42
v_mul_lo_u32 v43, v43, s30
v_and_b32 v44, 31, v1
s_and_b32 s21, s20, 1
s_lshl_b32 s21, s21, 3
v_lshl_add_u32 v42, v42, 1, s21
v_xor_b32 v45, v44, v42
v_xor_b32 v46, 4, v45
v_lshl_add_u32 v45, v45, 4, v43
v_lshl_add_u32 v46, v46, 4, v43
s_lshl_b32 s22, s30, 1
s_mov_b32 s21, 0
v_add_u32 v2, s21, v45
s_add_u32 s21, s21, s22
v_add_u32 v3, s21, v46
s_add_u32 s21, s21, s22
v_add_u32 v4, s21, v45
s_add_u32 s21, s21, s22
v_add_u32 v5, s21, v46
v_lshrrev_b32 v42, 5, v1
s_lshl_b32 s21, s20, 3
v_add_u32 v43, s21, v42
v_mul_lo_u32 v43, v43, s31
v_and_b32 v44, 31, v1
s_and_b32 s21, s20, 1
s_lshl_b32 s21, s21, 3
v_lshl_add_u32 v42, v42, 1, s21
v_xor_b32 v45, v44, v42
v_xor_b32 v46, 4, v45
v_lshl_add_u32 v45, v45, 4, v43
v_lshl_add_u32 v46, v46, 4, v43
s_lshl_b32 s22, s31, 1
s_mov_b32 s21, 0
v_add_u32 v6, s21, v45
s_add_u32 s21, s21, s22
v_add_u32 v7, s21, v46
s_add_u32 s21, s21, s22
v_add_u32 v8, s21, v45
s_add_u32 s21, s21, s22
v_add_u32 v9, s21, v46
s_mul_i32 s29, s20, 4096
s_add_u32 m0, s25, 0
s_nop 0
global_load_lds_dwordx4 v2, s[4:5] sc1
s_add_u32 m0, s25, 1024
s_nop 0
global_load_lds_dwordx4 v3, s[4:5] sc1
s_add_u32 m0, s25, 2048
s_nop 0
global_load_lds_dwordx4 v4, s[4:5] sc1
s_add_u32 m0, s25, 3072
s_nop 0
global_load_lds_dwordx4 v5, s[4:5] sc1
s_add_u32 m0, s26, 0
s_nop 0
global_load_lds_dwordx4 v6, s[6:7]
s_add_u32 m0, s26, 1024
s_nop 0
global_load_lds_dwordx4 v7, s[6:7]
s_add_u32 m0, s26, 2048
s_nop 0
global_load_lds_dwordx4 v8, s[6:7]
s_add_u32 m0, s26, 3072
s_nop 0
global_load_lds_dwordx4 v9, s[6:7]
s_add_u32 s4, s4, s8
s_addc_u32 s5, s5, 0
s_add_u32 s6, s6, s9
s_addc_u32 s7, s7, 0
s_add_u32 m0, s25, 32768
s_nop 0
global_load_lds_dwordx4 v2, s[4:5] sc1
s_add_u32 m0, s25, 33792
s_nop 0
global_load_lds_dwordx4 v3, s[4:5] sc1
s_add_u32 m0, s25, 34816
s_nop 0
global_load_lds_dwordx4 v4, s[4:5] sc1
s_add_u32 m0, s25, 35840
s_nop 0
global_load_lds_dwordx4 v5, s[4:5] sc1
s_add_u32 m0, s26, 32768
s_nop 0
global_load_lds_dwordx4 v6, s[6:7]
s_add_u32 m0, s26, 33792
s_nop 0
global_load_lds_dwordx4 v7, s[6:7]
s_add_u32 m0, s26, 34816
s_nop 0
global_load_lds_dwordx4 v8, s[6:7]
s_add_u32 m0, s26, 35840
s_nop 0
global_load_lds_dwordx4 v9, s[6:7]
s_add_u32 s4, s4, s8
s_addc_u32 s5, s5, 0
s_add_u32 s6, s6, s9
s_addc_u32 s7, s7, 0
s_add_u32 m0, s25, 65536
s_nop 0
global_load_lds_dwordx4 v2, s[4:5] sc1
s_add_u32 m0, s25, 66560
s_nop 0
global_load_lds_dwordx4 v3, s[4:5] sc1
s_add_u32 m0, s25, 67584
s_nop 0
global_load_lds_dwordx4 v4, s[4:5] sc1
s_add_u32 m0, s25, 68608
s_nop 0
global_load_lds_dwordx4 v5, s[4:5] sc1
s_add_u32 m0, s26, 65536
s_nop 0
global_load_lds_dwordx4 v6, s[6:7]
s_add_u32 m0, s26, 66560
s_nop 0
global_load_lds_dwordx4 v7, s[6:7]
s_add_u32 m0, s26, 67584
s_nop 0
global_load_lds_dwordx4 v8, s[6:7]
s_add_u32 m0, s26, 68608
s_nop 0
global_load_lds_dwordx4 v9, s[6:7]
s_add_u32 s4, s4, s8
s_addc_u32 s5, s5, 0
s_add_u32 s6, s6, s9
s_addc_u32 s7, s7, 0
s_add_u32 m0, s25, 98304
s_nop 0
global_load_lds_dwordx4 v2, s[4:5] sc1
s_add_u32 m0, s25, 99328
s_nop 0
global_load_lds_dwordx4 v3, s[4:5] sc1
s_add_u32 m0, s25, 100352
s_nop 0
global_load_lds_dwordx4 v4, s[4:5] sc1
s_add_u32 m0, s25, 101376
s_nop 0
global_load_lds_dwordx4 v5, s[4:5] sc1
s_add_u32 m0, s26, 98304
s_nop 0
global_load_lds_dwordx4 v6, s[6:7]
s_add_u32 m0, s26, 99328
s_nop 0
global_load_lds_dwordx4 v7, s[6:7]
s_add_u32 m0, s26, 100352
s_nop 0
global_load_lds_dwordx4 v8, s[6:7]
s_add_u32 m0, s26, 101376
s_nop 0
global_load_lds_dwordx4 v9, s[6:7]
s_add_u32 s4, s4, s8
s_addc_u32 s5, s5, 0
s_add_u32 s6, s6, s9
s_addc_u32 s7, s7, 0
s_lshr_b32 s21, s20, 1
v_and_b32 v42, 15, v1
v_lshrrev_b32 v43, 2, v42
v_lshrrev_b32 v44, 4, v1
v_lshl_add_u32 v45, v44, 3, v43
v_lshlrev_b32 v45, 9, v45
v_and_b32 v46, 1, v42
v_lshl_add_u32 v45, v46, 3, v45
v_bfe_u32 v46, v42, 1, 1
v_lshl_add_u32 v45, v46, 4, v45
v_and_b32 v44, 1, v44
v_lshl_add_u32 v43, v44, 2, v43
s_mul_i32 s22, s21, 8
s_add_u32 s23, s22, 0
s_and_b32 s24, s23, 7
s_and_b32 s23, s23, 8
v_xor_b32 v46, s24, v43
v_add_u32 v46, s23, v46
v_lshl_add_u32 v10, v46, 5, v45
v_add_u32 v18, 0x10000, v10
s_add_u32 s23, s22, 1
s_and_b32 s24, s23, 7
s_and_b32 s23, s23, 8
v_xor_b32 v46, s24, v43
v_add_u32 v46, s23, v46
v_lshl_add_u32 v11, v46, 5, v45
v_add_u32 v19, 0x10000, v11
s_add_u32 s23, s22, 2
s_and_b32 s24, s23, 7
s_and_b32 s23, s23, 8
v_xor_b32 v46, s24, v43
v_add_u32 v46, s23, v46
v_lshl_add_u32 v12, v46, 5, v45
v_add_u32 v20, 0x10000, v12
s_add_u32 s23, s22, 3
s_and_b32 s24, s23, 7
s_and_b32 s23, s23, 8
v_xor_b32 v46, s24, v43
v_add_u32 v46, s23, v46
v_lshl_add_u32 v13, v46, 5, v45
v_add_u32 v21, 0x10000, v13
s_add_u32 s23, s22, 4
s_and_b32 s24, s23, 7
s_and_b32 s23, s23, 8
v_xor_b32 v46, s24, v43
v_add_u32 v46, s23, v46
v_lshl_add_u32 v14, v46, 5, v45
v_add_u32 v22, 0x10000, v14
s_add_u32 s23, s22, 5
s_and_b32 s24, s23, 7
s_and_b32 s23, s23, 8
v_xor_b32 v46, s24, v43
v_add_u32 v46, s23, v46
v_lshl_add_u32 v15, v46, 5, v45
v_add_u32 v23, 0x10000, v15
s_add_u32 s23, s22, 6
s_and_b32 s24, s23, 7
s_and_b32 s23, s23, 8
v_xor_b32 v46, s24, v43
v_add_u32 v46, s23, v46
v_lshl_add_u32 v16, v46, 5, v45
v_add_u32 v24, 0x10000, v16
s_add_u32 s23, s22, 7
s_and_b32 s24, s23, 7
s_and_b32 s23, s23, 8
v_xor_b32 v46, s24, v43
v_add_u32 v46, s23, v46
v_lshl_add_u32 v17, v46, 5, v45
v_add_u32 v25, 0x10000, v17
s_and_b32 s21, s20, 1
v_and_b32 v42, 15, v1
v_lshrrev_b32 v43, 2, v42
v_lshrrev_b32 v44, 4, v1
v_lshl_add_u32 v45, v44, 3, v43
v_lshlrev_b32 v45, 9, v45
v_and_b32 v46, 1, v42
v_lshl_add_u32 v45, v46, 3, v45
v_bfe_u32 v46, v42, 1, 1
v_lshl_add_u32 v45, v46, 4, v45
v_add_u32 v45, 16384, v45
v_and_b32 v44, 1, v44
v_lshl_add_u32 v43, v44, 2, v43
s_mul_i32 s22, s21, 8
s_add_u32 s23, s22, 0
s_and_b32 s24, s23, 7
s_and_b32 s23, s23, 8
v_xor_b32 v46, s24, v43
v_add_u32 v46, s23, v46
v_lshl_add_u32 v26, v46, 5, v45
v_add_u32 v34, 0x10000, v26
s_add_u32 s23, s22, 1
s_and_b32 s24, s23, 7
s_and_b32 s23, s23, 8
v_xor_b32 v46, s24, v43
v_add_u32 v46, s23, v46
v_lshl_add_u32 v27, v46, 5, v45
v_add_u32 v35, 0x10000, v27
s_add_u32 s23, s22, 2
s_and_b32 s24, s23, 7
s_and_b32 s23, s23, 8
v_xor_b32 v46, s24, v43
v_add_u32 v46, s23, v46
v_lshl_add_u32 v28, v46, 5, v45
v_add_u32 v36, 0x10000, v28
s_add_u32 s23, s22, 3
s_and_b32 s24, s23, 7
s_and_b32 s23, s23, 8
v_xor_b32 v46, s24, v43
v_add_u32 v46, s23, v46
v_lshl_add_u32 v29, v46, 5, v45
v_add_u32 v37, 0x10000, v29
s_add_u32 s23, s22, 4
s_and_b32 s24, s23, 7
s_and_b32 s23, s23, 8
v_xor_b32 v46, s24, v43
v_add_u32 v46, s23, v46
v_lshl_add_u32 v30, v46, 5, v45
v_add_u32 v38, 0x10000, v30
s_add_u32 s23, s22, 5
s_and_b32 s24, s23, 7
s_and_b32 s23, s23, 8
v_xor_b32 v46, s24, v43
v_add_u32 v46, s23, v46
v_lshl_add_u32 v31, v46, 5, v45
v_add_u32 v39, 0x10000, v31
s_add_u32 s23, s22, 6
s_and_b32 s24, s23, 7
s_and_b32 s23, s23, 8
v_xor_b32 v46, s24, v43
v_add_u32 v46, s23, v46
v_lshl_add_u32 v32, v46, 5, v45
v_add_u32 v40, 0x10000, v32
s_add_u32 s23, s22, 7
s_and_b32 s24, s23, 7
s_and_b32 s23, s23, 8
v_xor_b32 v46, s24, v43
v_add_u32 v46, s23, v46
v_lshl_add_u32 v33, v46, 5, v45
v_add_u32 v41, 0x10000, v33
s_waitcnt vmcnt(0)
s_barrier
ds_read_b64_tr_b16 v[160:161], v26 offset:0
ds_read_b64_tr_b16 v[162:163], v26 offset:2048
ds_read_b64_tr_b16 v[128:129], v10 offset:0
ds_read_b64_tr_b16 v[130:131], v10 offset:2048
ds_read_b64_tr_b16 v[132:133], v11 offset:0
ds_read_b64_tr_b16 v[134:135], v11 offset:2048
ds_read_b64_tr_b16 v[136:137], v12 offset:0
ds_read_b64_tr_b16 v[138:139], v12 offset:2048
ds_read_b64_tr_b16 v[140:141], v13 offset:0
ds_read_b64_tr_b16 v[142:143], v13 offset:2048
ds_read_b64_tr_b16 v[144:145], v14 offset:0
ds_read_b64_tr_b16 v[146:147], v14 offset:2048
ds_read_b64_tr_b16 v[148:149], v15 offset:0
ds_read_b64_tr_b16 v[150:151], v15 offset:2048
ds_read_b64_tr_b16 v[152:153], v16 offset:0
ds_read_b64_tr_b16 v[154:155], v16 offset:2048
ds_read_b64_tr_b16 v[156:157], v17 offset:0
ds_read_b64_tr_b16 v[158:159], v17 offset:2048
ds_read_b64_tr_b16 v[164:165], v27 offset:0
ds_read_b64_tr_b16 v[166:167], v27 offset:2048
ds_read_b64_tr_b16 v[168:169], v28 offset:0
ds_read_b64_tr_b16 v[170:171], v28 offset:2048
ds_read_b64_tr_b16 v[172:173], v29 offset:0
ds_read_b64_tr_b16 v[174:175], v29 offset:2048
ds_read_b64_tr_b16 v[176:177], v30 offset:0
ds_read_b64_tr_b16 v[178:179], v30 offset:2048
ds_read_b64_tr_b16 v[180:181], v31 offset:0
ds_read_b64_tr_b16 v[182:183], v31 offset:2048
ds_read_b64_tr_b16 v[184:185], v32 offset:0
ds_read_b64_tr_b16 v[186:187], v32 offset:2048
ds_read_b64_tr_b16 v[188:189], v33 offset:0
ds_read_b64_tr_b16 v[190:191], v33 offset:2048
s_lshr_b32 s11, s10, 2
s_sub_u32 s11, s11, 1
s_waitcnt lgkmcnt(0)
v_mfma_f32_16x16x32_bf16 a[0:3], v[160:163], v[128:131], 0
v_mfma_f32_16x16x32_bf16 a[4:7], v[160:163], v[132:135], 0
v_mfma_f32_16x16x32_bf16 a[8:11], v[160:163], v[136:139], 0
v_mfma_f32_16x16x32_bf16 a[12:15], v[160:163], v[140:143], 0
v_mfma_f32_16x16x32_bf16 a[16:19], v[160:163], v[144:147], 0
v_mfma_f32_16x16x32_bf16 a[20:23], v[160:163], v[148:151], 0
v_mfma_f32_16x16x32_bf16 a[24:27], v[160:163], v[152:155], 0
v_mfma_f32_16x16x32_bf16 a[28:31], v[160:163], v[156:159], 0
v_mfma_f32_16x16x32_bf16 a[32:35], v[164:167], v[128:131], 0
v_mfma_f32_16x16x32_bf16 a[36:39], v[164:167], v[132:135], 0
v_mfma_f32_16x16x32_bf16 a[40:43], v[164:167], v[136:139], 0
v_mfma_f32_16x16x32_bf16 a[44:47], v[164:167], v[140:143], 0
v_mfma_f32_16x16x32_bf16 a[48:51], v[164:167], v[144:147], 0
v_mfma_f32_16x16x32_bf16 a[52:55], v[164:167], v[148:151], 0
v_mfma_f32_16x16x32_bf16 a[56:59], v[164:167], v[152:155], 0
v_mfma_f32_16x16x32_bf16 a[60:63], v[164:167], v[156:159], 0
v_mfma_f32_16x16x32_bf16 a[64:67], v[168:171], v[128:131], 0
v_mfma_f32_16x16x32_bf16 a[68:71], v[168:171], v[132:135], 0
v_mfma_f32_16x16x32_bf16 a[72:75], v[168:171], v[136:139], 0
v_mfma_f32_16x16x32_bf16 a[76:79], v[168:171], v[140:143], 0
v_mfma_f32_16x16x32_bf16 a[80:83], v[168:171], v[144:147], 0
v_mfma_f32_16x16x32_bf16 a[84:87], v[168:171], v[148:151], 0
v_mfma_f32_16x16x32_bf16 a[88:91], v[168:171], v[152:155], 0
v_mfma_f32_16x16x32_bf16 a[92:95], v[168:171], v[156:159], 0
v_mfma_f32_16x16x32_bf16 a[96:99], v[172:175], v[128:131], 0
v_mfma_f32_16x16x32_bf16 a[100:103], v[172:175], v[132:135], 0
v_mfma_f32_16x16x32_bf16 a[104:107], v[172:175], v[136:139], 0
v_mfma_f32_16x16x32_bf16 a[108:111], v[172:175], v[140:143], 0
v_mfma_f32_16x16x32_bf16 a[112:115], v[172:175], v[144:147], 0
v_mfma_f32_16x16x32_bf16 a[116:119], v[172:175], v[148:151], 0
v_mfma_f32_16x16x32_bf16 a[120:123], v[172:175], v[152:155], 0
v_mfma_f32_16x16x32_bf16 a[124:127], v[172:175], v[156:159], 0
s_barrier
v_mfma_f32_16x16x32_bf16 a[128:131], v[176:179], v[128:131], 0
ds_read_b64_tr_b16 v[224:225], v26 offset:32768
ds_read_b64_tr_b16 v[226:227], v26 offset:34816
v_mfma_f32_16x16x32_bf16 a[132:135], v[176:179], v[132:135], 0
s_add_u32 m0, s25, 0
ds_read_b64_tr_b16 v[192:193], v10 offset:32768
ds_read_b64_tr_b16 v[194:195], v10 offset:34816
v_mfma_f32_16x16x32_bf16 a[136:139], v[176:179], v[136:139], 0
global_load_lds_dwordx4 v2, s[4:5] sc1
ds_read_b64_tr_b16 v[196:197], v11 offset:32768
ds_read_b64_tr_b16 v[198:199], v11 offset:34816
v_mfma_f32_16x16x32_bf16 a[140:143], v[176:179], v[140:143], 0
ds_read_b64_tr_b16 v[200:201], v12 offset:32768
ds_read_b64_tr_b16 v[202:203], v12 offset:34816
v_mfma_f32_16x16x32_bf16 a[144:147], v[176:179], v[144:147], 0
ds_read_b64_tr_b16 v[204:205], v13 offset:32768
ds_read_b64_tr_b16 v[206:207], v13 offset:34816
v_mfma_f32_16x16x32_bf16 a[148:151], v[176:179], v[148:151], 0
ds_read_b64_tr_b16 v[208:209], v14 offset:32768
ds_read_b64_tr_b16 v[210:211], v14 offset:34816
v_mfma_f32_16x16x32_bf16 a[152:155], v[176:179], v[152:155], 0
ds_read_b64_tr_b16 v[212:213], v15 offset:32768
ds_read_b64_tr_b16 v[214:215], v15 offset:34816
v_mfma_f32_16x16x32_bf16 a[156:159], v[176:179], v[156:159], 0
ds_read_b64_tr_b16 v[216:217], v16 offset:32768
ds_read_b64_tr_b16 v[218:219], v16 offset:34816
v_mfma_f32_16x16x32_bf16 a[160:163], v[180:183], v[128:131], 0
ds_read_b64_tr_b16 v[220:221], v17 offset:32768
ds_read_b64_tr_b16 v[222:223], v17 offset:34816
v_mfma_f32_16x16x32_bf16 a[164:167], v[180:183], v[132:135], 0
s_add_u32 m0, s25, 1024
ds_read_b64_tr_b16 v[228:229], v27 offset:32768
ds_read_b64_tr_b16 v[230:231], v27 offset:34816
v_mfma_f32_16x16x32_bf16 a[168:171], v[180:183], v[136:139], 0
global_load_lds_dwordx4 v3, s[4:5] sc1
ds_read_b64_tr_b16 v[232:233], v28 offset:32768
ds_read_b64_tr_b16 v[234:235], v28 offset:34816
v_mfma_f32_16x16x32_bf16 a[172:175], v[180:183], v[140:143], 0
ds_read_b64_tr_b16 v[236:237], v29 offset:32768
ds_read_b64_tr_b16 v[238:239], v29 offset:34816
v_mfma_f32_16x16x32_bf16 a[176:179], v[180:183], v[144:147], 0
ds_read_b64_tr_b16 v[240:241], v30 offset:32768
ds_read_b64_tr_b16 v[242:243], v30 offset:34816
v_mfma_f32_16x16x32_bf16 a[180:183], v[180:183], v[148:151], 0
ds_read_b64_tr_b16 v[244:245], v31 offset:32768
ds_read_b64_tr_b16 v[246:247], v31 offset:34816
v_mfma_f32_16x16x32_bf16 a[184:187], v[180:183], v[152:155], 0
ds_read_b64_tr_b16 v[248:249], v32 offset:32768
ds_read_b64_tr_b16 v[250:251], v32 offset:34816
v_mfma_f32_16x16x32_bf16 a[188:191], v[180:183], v[156:159], 0
ds_read_b64_tr_b16 v[252:253], v33 offset:32768
ds_read_b64_tr_b16 v[254:255], v33 offset:34816
v_mfma_f32_16x16x32_bf16 a[192:195], v[184:187], v[128:131], 0
v_mfma_f32_16x16x32_bf16 a[196:199], v[184:187], v[132:135], 0
s_add_u32 m0, s25, 2048
v_mfma_f32_16x16x32_bf16 a[200:203], v[184:187], v[136:139], 0
global_load_lds_dwordx4 v4, s[4:5] sc1
v_mfma_f32_16x16x32_bf16 a[204:207], v[184:187], v[140:143], 0
v_mfma_f32_16x16x32_bf16 a[208:211], v[184:187], v[144:147], 0
v_mfma_f32_16x16x32_bf16 a[212:215], v[184:187], v[148:151], 0
v_mfma_f32_16x16x32_bf16 a[216:219], v[184:187], v[152:155], 0
v_mfma_f32_16x16x32_bf16 a[220:223], v[184:187], v[156:159], 0
v_mfma_f32_16x16x32_bf16 a[224:227], v[188:191], v[128:131], 0
v_mfma_f32_16x16x32_bf16 a[228:231], v[188:191], v[132:135], 0
s_add_u32 m0, s25, 3072
v_mfma_f32_16x16x32_bf16 a[232:235], v[188:191], v[136:139], 0
global_load_lds_dwordx4 v5, s[4:5] sc1
v_mfma_f32_16x16x32_bf16 a[236:239], v[188:191], v[140:143], 0
v_mfma_f32_16x16x32_bf16 a[240:243], v[188:191], v[144:147], 0
v_mfma_f32_16x16x32_bf16 a[244:247], v[188:191], v[148:151], 0
v_mfma_f32_16x16x32_bf16 a[248:251], v[188:191], v[152:155], 0
v_mfma_f32_16x16x32_bf16 a[252:255], v[188:191], v[156:159], 0
s_add_u32 s4, s4, s8
s_addc_u32 s5, s5, 0
M_gl_110:
s_waitcnt lgkmcnt(0)
v_mfma_f32_16x16x32_bf16 a[0:3], v[224:227], v[192:195], a[0:3]
v_mfma_f32_16x16x32_bf16 a[4:7], v[224:227], v[196:199], a[4:7]
s_add_u32 m0, s26, 0
v_mfma_f32_16x16x32_bf16 a[8:11], v[224:227], v[200:203], a[8:11]
global_load_lds_dwordx4 v6, s[6:7]
v_mfma_f32_16x16x32_bf16 a[12:15], v[224:227], v[204:207], a[12:15]
v_mfma_f32_16x16x32_bf16 a[16:19], v[224:227], v[208:211], a[16:19]
v_mfma_f32_16x16x32_bf16 a[20:23], v[224:227], v[212:215], a[20:23]
v_mfma_f32_16x16x32_bf16 a[24:27], v[224:227], v[216:219], a[24:27]
v_mfma_f32_16x16x32_bf16 a[28:31], v[224:227], v[220:223], a[28:31]
s_add_u32 m0, s26, 1024
v_mfma_f32_16x16x32_bf16 a[32:35], v[228:231], v[192:195], a[32:35]
global_load_lds_dwordx4 v7, s[6:7]
v_mfma_f32_16x16x32_bf16 a[36:39], v[228:231], v[196:199], a[36:39]
v_mfma_f32_16x16x32_bf16 a[40:43], v[228:231], v[200:203], a[40:43]
v_mfma_f32_16x16x32_bf16 a[44:47], v[228:231], v[204:207], a[44:47]
v_mfma_f32_16x16x32_bf16 a[48:51], v[228:231], v[208:211], a[48:51]
v_mfma_f32_16x16x32_bf16 a[52:55], v[228:231], v[212:215], a[52:55]
s_add_u32 m0, s26, 2048
v_mfma_f32_16x16x32_bf16 a[56:59], v[228:231], v[216:219], a[56:59]
global_load_lds_dwordx4 v8, s[6:7]
v_mfma_f32_16x16x32_bf16 a[60:63], v[228:231], v[220:223], a[60:63]
v_mfma_f32_16x16x32_bf16 a[64:67], v[232:235], v[192:195], a[64:67]
v_mfma_f32_16x16x32_bf16 a[68:71], v[232:235], v[196:199], a[68:71]
v_mfma_f32_16x16x32_bf16 a[72:75], v[232:235], v[200:203], a[72:75]
v_mfma_f32_16x16x32_bf16 a[76:79], v[232:235], v[204:207], a[76:79]
s_add_u32 m0, s26, 3072
v_mfma_f32_16x16x32_bf16 a[80:83], v[232:235], v[208:211], a[80:83]
global_load_lds_dwordx4 v9, s[6:7]
v_mfma_f32_16x16x32_bf16 a[84:87], v[232:235], v[212:215], a[84:87]
v_mfma_f32_16x16x32_bf16 a[88:91], v[232:235], v[216:219], a[88:91]
v_mfma_f32_16x16x32_bf16 a[92:95], v[232:235], v[220:223], a[92:95]
v_mfma_f32_16x16x32_bf16 a[96:99], v[236:239], v[192:195], a[96:99]
v_mfma_f32_16x16x32_bf16 a[100:103], v[236:239], v[196:199], a[100:103]
s_mov_b32 m0, s38
v_mfma_f32_16x16x32_bf16 a[104:107], v[236:239], v[200:203], a[104:107]
global_load_lds_dwordx4 v55, s[36:37]
v_mfma_f32_16x16x32_bf16 a[108:111], v[236:239], v[204:207], a[108:111]
v_mfma_f32_16x16x32_bf16 a[112:115], v[236:239], v[208:211], a[112:115]
v_mfma_f32_16x16x32_bf16 a[116:119], v[236:239], v[212:215], a[116:119]
v_mfma_f32_16x16x32_bf16 a[120:123], v[236:239], v[216:219], a[120:123]
v_mfma_f32_16x16x32_bf16 a[124:127], v[236:239], v[220:223], a[124:127]
s_add_u32 s6, s6, s9
s_addc_u32 s7, s7, 0
s_add_u32 s36, s36, 4096
s_addc_u32 s37, s37, 0
s_waitcnt vmcnt(18)
s_barrier
v_mfma_f32_16x16x32_bf16 a[128:131], v[240:243], v[192:195], a[128:131]
ds_read_b64_tr_b16 v[160:161], v34 offset:0
ds_read_b64_tr_b16 v[162:163], v34 offset:2048
v_mfma_f32_16x16x32_bf16 a[132:135], v[240:243], v[196:199], a[132:135]
s_add_u32 m0, s25, 32768
ds_read_b64_tr_b16 v[128:129], v18 offset:0
ds_read_b64_tr_b16 v[130:131], v18 offset:2048
v_mfma_f32_16x16x32_bf16 a[136:139], v[240:243], v[200:203], a[136:139]
global_load_lds_dwordx4 v2, s[4:5] sc1
ds_read_b64_tr_b16 v[132:133], v19 offset:0
ds_read_b64_tr_b16 v[134:135], v19 offset:2048
v_mfma_f32_16x16x32_bf16 a[140:143], v[240:243], v[204:207], a[140:143]
ds_read_b64_tr_b16 v[136:137], v20 offset:0
ds_read_b64_tr_b16 v[138:139], v20 offset:2048
v_mfma_f32_16x16x32_bf16 a[144:147], v[240:243], v[208:211], a[144:147]
ds_read_b64_tr_b16 v[140:141], v21 offset:0
ds_read_b64_tr_b16 v[142:143], v21 offset:2048
v_mfma_f32_16x16x32_bf16 a[148:151], v[240:243], v[212:215], a[148:151]
ds_read_b64_tr_b16 v[144:145], v22 offset:0
ds_read_b64_tr_b16 v[146:147], v22 offset:2048
v_mfma_f32_16x16x32_bf16 a[152:155], v[240:243], v[216:219], a[152:155]
ds_read_b64_tr_b16 v[148:149], v23 offset:0
ds_read_b64_tr_b16 v[150:151], v23 offset:2048
v_mfma_f32_16x16x32_bf16 a[156:159], v[240:243], v[220:223], a[156:159]
ds_read_b64_tr_b16 v[152:153], v24 offset:0
ds_read_b64_tr_b16 v[154:155], v24 offset:2048
v_mfma_f32_16x16x32_bf16 a[160:163], v[244:247], v[192:195], a[160:163]
ds_read_b64_tr_b16 v[156:157], v25 offset:0
ds_read_b64_tr_b16 v[158:159], v25 offset:2048
v_mfma_f32_16x16x32_bf16 a[164:167], v[244:247], v[196:199], a[164:167]
s_add_u32 m0, s25, 33792
ds_read_b64_tr_b16 v[164:165], v35 offset:0
ds_read_b64_tr_b16 v[166:167], v35 offset:2048
v_mfma_f32_16x16x32_bf16 a[168:171], v[244:247], v[200:203], a[168:171]
global_load_lds_dwordx4 v3, s[4:5] sc1
ds_read_b64_tr_b16 v[168:169], v36 offset:0
ds_read_b64_tr_b16 v[170:171], v36 offset:2048
v_mfma_f32_16x16x32_bf16 a[172:175], v[244:247], v[204:207], a[172:175]
ds_read_b64_tr_b16 v[172:173], v37 offset:0
ds_read_b64_tr_b16 v[174:175], v37 offset:2048
v_mfma_f32_16x16x32_bf16 a[176:179], v[244:247], v[208:211], a[176:179]
ds_read_b64_tr_b16 v[176:177], v38 offset:0
ds_read_b64_tr_b16 v[178:179], v38 offset:2048
v_mfma_f32_16x16x32_bf16 a[180:183], v[244:247], v[212:215], a[180:183]
ds_read_b64_tr_b16 v[180:181], v39 offset:0
ds_read_b64_tr_b16 v[182:183], v39 offset:2048
v_mfma_f32_16x16x32_bf16 a[184:187], v[244:247], v[216:219], a[184:187]
ds_read_b64_tr_b16 v[184:185], v40 offset:0
ds_read_b64_tr_b16 v[186:187], v40 offset:2048
v_mfma_f32_16x16x32_bf16 a[188:191], v[244:247], v[220:223], a[188:191]
ds_read_b64_tr_b16 v[188:189], v41 offset:0
ds_read_b64_tr_b16 v[190:191], v41 offset:2048
v_mfma_f32_16x16x32_bf16 a[192:195], v[248:251], v[192:195], a[192:195]
v_mfma_f32_16x16x32_bf16 a[196:199], v[248:251], v[196:199], a[196:199]
s_add_u32 m0, s25, 34816
v_mfma_f32_16x16x32_bf16 a[200:203], v[248:251], v[200:203], a[200:203]
global_load_lds_dwordx4 v4, s[4:5] sc1
v_mfma_f32_16x16x32_bf16 a[204:207], v[248:251], v[204:207], a[204:207]
v_mfma_f32_16x16x32_bf16 a[208:211], v[248:251], v[208:211], a[208:211]
v_mfma_f32_16x16x32_bf16 a[212:215], v[248:251], v[212:215], a[212:215]
v_mfma_f32_16x16x32_bf16 a[216:219], v[248:251], v[216:219], a[216:219]
v_mfma_f32_16x16x32_bf16 a[220:223], v[248:251], v[220:223], a[220:223]
v_mfma_f32_16x16x32_bf16 a[224:227], v[252:255], v[192:195], a[224:227]
v_mfma_f32_16x16x32_bf16 a[228:231], v[252:255], v[196:199], a[228:231]
s_add_u32 m0, s25, 35840
v_mfma_f32_16x16x32_bf16 a[232:235], v[252:255], v[200:203], a[232:235]
global_load_lds_dwordx4 v5, s[4:5] sc1
v_mfma_f32_16x16x32_bf16 a[236:239], v[252:255], v[204:207], a[236:239]
v_mfma_f32_16x16x32_bf16 a[240:243], v[252:255], v[208:211], a[240:243]
v_mfma_f32_16x16x32_bf16 a[244:247], v[252:255], v[212:215], a[244:247]
v_mfma_f32_16x16x32_bf16 a[248:251], v[252:255], v[216:219], a[248:251]
v_mfma_f32_16x16x32_bf16 a[252:255], v[252:255], v[220:223], a[252:255]
s_add_u32 s4, s4, s8
s_addc_u32 s5, s5, 0
s_waitcnt lgkmcnt(0)
v_mfma_f32_16x16x32_bf16 a[0:3], v[160:163], v[128:131], a[0:3]
v_mfma_f32_16x16x32_bf16 a[4:7], v[160:163], v[132:135], a[4:7]
s_add_u32 m0, s26, 32768
v_mfma_f32_16x16x32_bf16 a[8:11], v[160:163], v[136:139], a[8:11]
global_load_lds_dwordx4 v6, s[6:7]
v_mfma_f32_16x16x32_bf16 a[12:15], v[160:163], v[140:143], a[12:15]
v_mfma_f32_16x16x32_bf16 a[16:19], v[160:163], v[144:147], a[16:19]
v_mfma_f32_16x16x32_bf16 a[20:23], v[160:163], v[148:151], a[20:23]
v_mfma_f32_16x16x32_bf16 a[24:27], v[160:163], v[152:155], a[24:27]
v_mfma_f32_16x16x32_bf16 a[28:31], v[160:163], v[156:159], a[28:31]
s_add_u32 m0, s26, 33792
v_mfma_f32_16x16x32_bf16 a[32:35], v[164:167], v[128:131], a[32:35]
global_load_lds_dwordx4 v7, s[6:7]
v_mfma_f32_16x16x32_bf16 a[36:39], v[164:167], v[132:135], a[36:39]
v_mfma_f32_16x16x32_bf16 a[40:43], v[164:167], v[136:139], a[40:43]
v_mfma_f32_16x16x32_bf16 a[44:47], v[164:167], v[140:143], a[44:47]
v_mfma_f32_16x16x32_bf16 a[48:51], v[164:167], v[144:147], a[48:51]
v_mfma_f32_16x16x32_bf16 a[52:55], v[164:167], v[148:151], a[52:55]
s_add_u32 m0, s26, 34816
v_mfma_f32_16x16x32_bf16 a[56:59], v[164:167], v[152:155], a[56:59]
global_load_lds_dwordx4 v8, s[6:7]
v_mfma_f32_16x16x32_bf16 a[60:63], v[164:167], v[156:159], a[60:63]
v_mfma_f32_16x16x32_bf16 a[64:67], v[168:171], v[128:131], a[64:67]
v_mfma_f32_16x16x32_bf16 a[68:71], v[168:171], v[132:135], a[68:71]
v_mfma_f32_16x16x32_bf16 a[72:75], v[168:171], v[136:139], a[72:75]
v_mfma_f32_16x16x32_bf16 a[76:79], v[168:171], v[140:143], a[76:79]
s_add_u32 m0, s26, 35840
v_mfma_f32_16x16x32_bf16 a[80:83], v[168:171], v[144:147], a[80:83]
global_load_lds_dwordx4 v9, s[6:7]
v_mfma_f32_16x16x32_bf16 a[84:87], v[168:171], v[148:151], a[84:87]
v_mfma_f32_16x16x32_bf16 a[88:91], v[168:171], v[152:155], a[88:91]
v_mfma_f32_16x16x32_bf16 a[92:95], v[168:171], v[156:159], a[92:95]
v_mfma_f32_16x16x32_bf16 a[96:99], v[172:175], v[128:131], a[96:99]
v_mfma_f32_16x16x32_bf16 a[100:103], v[172:175], v[132:135], a[100:103]
s_mov_b32 m0, s38
v_mfma_f32_16x16x32_bf16 a[104:107], v[172:175], v[136:139], a[104:107]
global_load_lds_dwordx4 v55, s[36:37]
v_mfma_f32_16x16x32_bf16 a[108:111], v[172:175], v[140:143], a[108:111]
v_mfma_f32_16x16x32_bf16 a[112:115], v[172:175], v[144:147], a[112:115]
v_mfma_f32_16x16x32_bf16 a[116:119], v[172:175], v[148:151], a[116:119]
v_mfma_f32_16x16x32_bf16 a[120:123], v[172:175], v[152:155], a[120:123]
v_mfma_f32_16x16x32_bf16 a[124:127], v[172:175], v[156:159], a[124:127]
s_add_u32 s6, s6, s9
s_addc_u32 s7, s7, 0
s_add_u32 s36, s36, 4096
s_addc_u32 s37, s37, 0
s_waitcnt vmcnt(18)
s_barrier
v_mfma_f32_16x16x32_bf16 a[128:131], v[176:179], v[128:131], a[128:131]
ds_read_b64_tr_b16 v[224:225], v34 offset:32768
ds_read_b64_tr_b16 v[226:227], v34 offset:34816
v_mfma_f32_16x16x32_bf16 a[132:135], v[176:179], v[132:135], a[132:135]
s_add_u32 m0, s25, 65536
ds_read_b64_tr_b16 v[192:193], v18 offset:32768
ds_read_b64_tr_b16 v[194:195], v18 offset:34816
v_mfma_f32_16x16x32_bf16 a[136:139], v[176:179], v[136:139], a[136:139]
global_load_lds_dwordx4 v2, s[4:5] sc1
ds_read_b64_tr_b16 v[196:197], v19 offset:32768
ds_read_b64_tr_b16 v[198:199], v19 offset:34816
v_mfma_f32_16x16x32_bf16 a[140:143], v[176:179], v[140:143], a[140:143]
ds_read_b64_tr_b16 v[200:201], v20 offset:32768
ds_read_b64_tr_b16 v[202:203], v20 offset:34816
v_mfma_f32_16x16x32_bf16 a[144:147], v[176:179], v[144:147], a[144:147]
ds_read_b64_tr_b16 v[204:205], v21 offset:32768
ds_read_b64_tr_b16 v[206:207], v21 offset:34816
v_mfma_f32_16x16x32_bf16 a[148:151], v[176:179], v[148:151], a[148:151]
ds_read_b64_tr_b16 v[208:209], v22 offset:32768
ds_read_b64_tr_b16 v[210:211], v22 offset:34816
v_mfma_f32_16x16x32_bf16 a[152:155], v[176:179], v[152:155], a[152:155]
ds_read_b64_tr_b16 v[212:213], v23 offset:32768
ds_read_b64_tr_b16 v[214:215], v23 offset:34816
v_mfma_f32_16x16x32_bf16 a[156:159], v[176:179], v[156:159], a[156:159]
ds_read_b64_tr_b16 v[216:217], v24 offset:32768
ds_read_b64_tr_b16 v[218:219], v24 offset:34816
v_mfma_f32_16x16x32_bf16 a[160:163], v[180:183], v[128:131], a[160:163]
ds_read_b64_tr_b16 v[220:221], v25 offset:32768
ds_read_b64_tr_b16 v[222:223], v25 offset:34816
v_mfma_f32_16x16x32_bf16 a[164:167], v[180:183], v[132:135], a[164:167]
s_add_u32 m0, s25, 66560
ds_read_b64_tr_b16 v[228:229], v35 offset:32768
ds_read_b64_tr_b16 v[230:231], v35 offset:34816
v_mfma_f32_16x16x32_bf16 a[168:171], v[180:183], v[136:139], a[168:171]
global_load_lds_dwordx4 v3, s[4:5] sc1
ds_read_b64_tr_b16 v[232:233], v36 offset:32768
ds_read_b64_tr_b16 v[234:235], v36 offset:34816
v_mfma_f32_16x16x32_bf16 a[172:175], v[180:183], v[140:143], a[172:175]
ds_read_b64_tr_b16 v[236:237], v37 offset:32768
ds_read_b64_tr_b16 v[238:239], v37 offset:34816
v_mfma_f32_16x16x32_bf16 a[176:179], v[180:183], v[144:147], a[176:179]
ds_read_b64_tr_b16 v[240:241], v38 offset:32768
ds_read_b64_tr_b16 v[242:243], v38 offset:34816
v_mfma_f32_16x16x32_bf16 a[180:183], v[180:183], v[148:151], a[180:183]
ds_read_b64_tr_b16 v[244:245], v39 offset:32768
ds_read_b64_tr_b16 v[246:247], v39 offset:34816
v_mfma_f32_16x16x32_bf16 a[184:187], v[180:183], v[152:155], a[184:187]
ds_read_b64_tr_b16 v[248:249], v40 offset:32768
ds_read_b64_tr_b16 v[250:251], v40 offset:34816
v_mfma_f32_16x16x32_bf16 a[188:191], v[180:183], v[156:159], a[188:191]
ds_read_b64_tr_b16 v[252:253], v41 offset:32768
ds_read_b64_tr_b16 v[254:255], v41 offset:34816
v_mfma_f32_16x16x32_bf16 a[192:195], v[184:187], v[128:131], a[192:195]
v_mfma_f32_16x16x32_bf16 a[196:199], v[184:187], v[132:135], a[196:199]
s_add_u32 m0, s25, 67584
v_mfma_f32_16x16x32_bf16 a[200:203], v[184:187], v[136:139], a[200:203]
global_load_lds_dwordx4 v4, s[4:5] sc1
v_mfma_f32_16x16x32_bf16 a[204:207], v[184:187], v[140:143], a[204:207]
v_mfma_f32_16x16x32_bf16 a[208:211], v[184:187], v[144:147], a[208:211]
v_mfma_f32_16x16x32_bf16 a[212:215], v[184:187], v[148:151], a[212:215]
v_mfma_f32_16x16x32_bf16 a[216:219], v[184:187], v[152:155], a[216:219]
v_mfma_f32_16x16x32_bf16 a[220:223], v[184:187], v[156:159], a[220:223]
v_mfma_f32_16x16x32_bf16 a[224:227], v[188:191], v[128:131], a[224:227]
v_mfma_f32_16x16x32_bf16 a[228:231], v[188:191], v[132:135], a[228:231]
s_add_u32 m0, s25, 68608
v_mfma_f32_16x16x32_bf16 a[232:235], v[188:191], v[136:139], a[232:235]
global_load_lds_dwordx4 v5, s[4:5] sc1
v_mfma_f32_16x16x32_bf16 a[236:239], v[188:191], v[140:143], a[236:239]
v_mfma_f32_16x16x32_bf16 a[240:243], v[188:191], v[144:147], a[240:243]
v_mfma_f32_16x16x32_bf16 a[244:247], v[188:191], v[148:151], a[244:247]
v_mfma_f32_16x16x32_bf16 a[248:251], v[188:191], v[152:155], a[248:251]
v_mfma_f32_16x16x32_bf16 a[252:255], v[188:191], v[156:159], a[252:255]
s_add_u32 s4, s4, s8
s_addc_u32 s5, s5, 0
s_waitcnt lgkmcnt(0)
v_mfma_f32_16x16x32_bf16 a[0:3], v[224:227], v[192:195], a[0:3]
v_mfma_f32_16x16x32_bf16 a[4:7], v[224:227], v[196:199], a[4:7]
s_add_u32 m0, s26, 65536
v_mfma_f32_16x16x32_bf16 a[8:11], v[224:227], v[200:203], a[8:11]
global_load_lds_dwordx4 v6, s[6:7]
v_mfma_f32_16x16x32_bf16 a[12:15], v[224:227], v[204:207], a[12:15]
v_mfma_f32_16x16x32_bf16 a[16:19], v[224:227], v[208:211], a[16:19]
v_mfma_f32_16x16x32_bf16 a[20:23], v[224:227], v[212:215], a[20:23]
v_mfma_f32_16x16x32_bf16 a[24:27], v[224:227], v[216:219], a[24:27]
v_mfma_f32_16x16x32_bf16 a[28:31], v[224:227], v[220:223], a[28:31]
s_add_u32 m0, s26, 66560
v_mfma_f32_16x16x32_bf16 a[32:35], v[228:231], v[192:195], a[32:35]
global_load_lds_dwordx4 v7, s[6:7]
v_mfma_f32_16x16x32_bf16 a[36:39], v[228:231], v[196:199], a[36:39]
v_mfma_f32_16x16x32_bf16 a[40:43], v[228:231], v[200:203], a[40:43]
v_mfma_f32_16x16x32_bf16 a[44:47], v[228:231], v[204:207], a[44:47]
v_mfma_f32_16x16x32_bf16 a[48:51], v[228:231], v[208:211], a[48:51]
v_mfma_f32_16x16x32_bf16 a[52:55], v[228:231], v[212:215], a[52:55]
s_add_u32 m0, s26, 67584
v_mfma_f32_16x16x32_bf16 a[56:59], v[228:231], v[216:219], a[56:59]
global_load_lds_dwordx4 v8, s[6:7]
v_mfma_f32_16x16x32_bf16 a[60:63], v[228:231], v[220:223], a[60:63]
v_mfma_f32_16x16x32_bf16 a[64:67], v[232:235], v[192:195], a[64:67]
v_mfma_f32_16x16x32_bf16 a[68:71], v[232:235], v[196:199], a[68:71]
v_mfma_f32_16x16x32_bf16 a[72:75], v[232:235], v[200:203], a[72:75]
v_mfma_f32_16x16x32_bf16 a[76:79], v[232:235], v[204:207], a[76:79]
s_add_u32 m0, s26, 68608
v_mfma_f32_16x16x32_bf16 a[80:83], v[232:235], v[208:211], a[80:83]
global_load_lds_dwordx4 v9, s[6:7]
v_mfma_f32_16x16x32_bf16 a[84:87], v[232:235], v[212:215], a[84:87]
v_mfma_f32_16x16x32_bf16 a[88:91], v[232:235], v[216:219], a[88:91]
v_mfma_f32_16x16x32_bf16 a[92:95], v[232:235], v[220:223], a[92:95]
v_mfma_f32_16x16x32_bf16 a[96:99], v[236:239], v[192:195], a[96:99]
v_mfma_f32_16x16x32_bf16 a[100:103], v[236:239], v[196:199], a[100:103]
s_mov_b32 m0, s38
v_mfma_f32_16x16x32_bf16 a[104:107], v[236:239], v[200:203], a[104:107]
global_load_lds_dwordx4 v55, s[36:37]
v_mfma_f32_16x16x32_bf16 a[108:111], v[236:239], v[204:207], a[108:111]
v_mfma_f32_16x16x32_bf16 a[112:115], v[236:239], v[208:211], a[112:115]
v_mfma_f32_16x16x32_bf16 a[116:119], v[236:239], v[212:215], a[116:119]
v_mfma_f32_16x16x32_bf16 a[120:123], v[236:239], v[216:219], a[120:123]
v_mfma_f32_16x16x32_bf16 a[124:127], v[236:239], v[220:223], a[124:127]
s_add_u32 s6, s6, s9
s_addc_u32 s7, s7, 0
s_add_u32 s36, s36, 4096
s_addc_u32 s37, s37, 0
s_waitcnt vmcnt(18)
s_barrier
v_mfma_f32_16x16x32_bf16 a[128:131], v[240:243], v[192:195], a[128:131]
ds_read_b64_tr_b16 v[160:161], v26 offset:0
ds_read_b64_tr_b16 v[162:163], v26 offset:2048
v_mfma_f32_16x16x32_bf16 a[132:135], v[240:243], v[196:199], a[132:135]
s_add_u32 m0, s25, 98304
ds_read_b64_tr_b16 v[128:129], v10 offset:0
ds_read_b64_tr_b16 v[130:131], v10 offset:2048
v_mfma_f32_16x16x32_bf16 a[136:139], v[240:243], v[200:203], a[136:139]
global_load_lds_dwordx4 v2, s[4:5] sc1
ds_read_b64_tr_b16 v[132:133], v11 offset:0
ds_read_b64_tr_b16 v[134:135], v11 offset:2048
v_mfma_f32_16x16x32_bf16 a[140:143], v[240:243], v[204:207], a[140:143]
ds_read_b64_tr_b16 v[136:137], v12 offset:0
ds_read_b64_tr_b16 v[138:139], v12 offset:2048
v_mfma_f32_16x16x32_bf16 a[144:147], v[240:243], v[208:211], a[144:147]
ds_read_b64_tr_b16 v[140:141], v13 offset:0
ds_read_b64_tr_b16 v[142:143], v13 offset:2048
v_mfma_f32_16x16x32_bf16 a[148:151], v[240:243], v[212:215], a[148:151]
ds_read_b64_tr_b16 v[144:145], v14 offset:0
ds_read_b64_tr_b16 v[146:147], v14 offset:2048
v_mfma_f32_16x16x32_bf16 a[152:155], v[240:243], v[216:219], a[152:155]
ds_read_b64_tr_b16 v[148:149], v15 offset:0
ds_read_b64_tr_b16 v[150:151], v15 offset:2048
v_mfma_f32_16x16x32_bf16 a[156:159], v[240:243], v[220:223], a[156:159]
ds_read_b64_tr_b16 v[152:153], v16 offset:0
ds_read_b64_tr_b16 v[154:155], v16 offset:2048
v_mfma_f32_16x16x32_bf16 a[160:163], v[244:247], v[192:195], a[160:163]
ds_read_b64_tr_b16 v[156:157], v17 offset:0
ds_read_b64_tr_b16 v[158:159], v17 offset:2048
v_mfma_f32_16x16x32_bf16 a[164:167], v[244:247], v[196:199], a[164:167]
s_add_u32 m0, s25, 99328
ds_read_b64_tr_b16 v[164:165], v27 offset:0
ds_read_b64_tr_b16 v[166:167], v27 offset:2048
v_mfma_f32_16x16x32_bf16 a[168:171], v[244:247], v[200:203], a[168:171]
global_load_lds_dwordx4 v3, s[4:5] sc1
ds_read_b64_tr_b16 v[168:169], v28 offset:0
ds_read_b64_tr_b16 v[170:171], v28 offset:2048
v_mfma_f32_16x16x32_bf16 a[172:175], v[244:247], v[204:207], a[172:175]
ds_read_b64_tr_b16 v[172:173], v29 offset:0
ds_read_b64_tr_b16 v[174:175], v29 offset:2048
v_mfma_f32_16x16x32_bf16 a[176:179], v[244:247], v[208:211], a[176:179]
ds_read_b64_tr_b16 v[176:177], v30 offset:0
ds_read_b64_tr_b16 v[178:179], v30 offset:2048
v_mfma_f32_16x16x32_bf16 a[180:183], v[244:247], v[212:215], a[180:183]
ds_read_b64_tr_b16 v[180:181], v31 offset:0
ds_read_b64_tr_b16 v[182:183], v31 offset:2048
v_mfma_f32_16x16x32_bf16 a[184:187], v[244:247], v[216:219], a[184:187]
ds_read_b64_tr_b16 v[184:185], v32 offset:0
ds_read_b64_tr_b16 v[186:187], v32 offset:2048
v_mfma_f32_16x16x32_bf16 a[188:191], v[244:247], v[220:223], a[188:191]
ds_read_b64_tr_b16 v[188:189], v33 offset:0
ds_read_b64_tr_b16 v[190:191], v33 offset:2048
v_mfma_f32_16x16x32_bf16 a[192:195], v[248:251], v[192:195], a[192:195]
v_mfma_f32_16x16x32_bf16 a[196:199], v[248:251], v[196:199], a[196:199]
s_add_u32 m0, s25, 100352
v_mfma_f32_16x16x32_bf16 a[200:203], v[248:251], v[200:203], a[200:203]
global_load_lds_dwordx4 v4, s[4:5] sc1
v_mfma_f32_16x16x32_bf16 a[204:207], v[248:251], v[204:207], a[204:207]
v_mfma_f32_16x16x32_bf16 a[208:211], v[248:251], v[208:211], a[208:211]
v_mfma_f32_16x16x32_bf16 a[212:215], v[248:251], v[212:215], a[212:215]
v_mfma_f32_16x16x32_bf16 a[216:219], v[248:251], v[216:219], a[216:219]
v_mfma_f32_16x16x32_bf16 a[220:223], v[248:251], v[220:223], a[220:223]
v_mfma_f32_16x16x32_bf16 a[224:227], v[252:255], v[192:195], a[224:227]
v_mfma_f32_16x16x32_bf16 a[228:231], v[252:255], v[196:199], a[228:231]
s_add_u32 m0, s25, 101376
v_mfma_f32_16x16x32_bf16 a[232:235], v[252:255], v[200:203], a[232:235]
global_load_lds_dwordx4 v5, s[4:5] sc1
v_mfma_f32_16x16x32_bf16 a[236:239], v[252:255], v[204:207], a[236:239]
v_mfma_f32_16x16x32_bf16 a[240:243], v[252:255], v[208:211], a[240:243]
v_mfma_f32_16x16x32_bf16 a[244:247], v[252:255], v[212:215], a[244:247]
v_mfma_f32_16x16x32_bf16 a[248:251], v[252:255], v[216:219], a[248:251]
v_mfma_f32_16x16x32_bf16 a[252:255], v[252:255], v[220:223], a[252:255]
s_add_u32 s4, s4, s8
s_addc_u32 s5, s5, 0
s_sub_u32 s11, s11, 1
s_cmp_eq_u32 s11, 0
s_cbranch_scc1 M_gle_111
s_waitcnt lgkmcnt(0)
v_mfma_f32_16x16x32_bf16 a[0:3], v[160:163], v[128:131], a[0:3]
v_mfma_f32_16x16x32_bf16 a[4:7], v[160:163], v[132:135], a[4:7]
s_add_u32 m0, s26, 98304
v_mfma_f32_16x16x32_bf16 a[8:11], v[160:163], v[136:139], a[8:11]
global_load_lds_dwordx4 v6, s[6:7]
v_mfma_f32_16x16x32_bf16 a[12:15], v[160:163], v[140:143], a[12:15]
v_mfma_f32_16x16x32_bf16 a[16:19], v[160:163], v[144:147], a[16:19]
v_mfma_f32_16x16x32_bf16 a[20:23], v[160:163], v[148:151], a[20:23]
v_mfma_f32_16x16x32_bf16 a[24:27], v[160:163], v[152:155], a[24:27]
v_mfma_f32_16x16x32_bf16 a[28:31], v[160:163], v[156:159], a[28:31]
s_add_u32 m0, s26, 99328
v_mfma_f32_16x16x32_bf16 a[32:35], v[164:167], v[128:131], a[32:35]
global_load_lds_dwordx4 v7, s[6:7]
v_mfma_f32_16x16x32_bf16 a[36:39], v[164:167], v[132:135], a[36:39]
v_mfma_f32_16x16x32_bf16 a[40:43], v[164:167], v[136:139], a[40:43]
v_mfma_f32_16x16x32_bf16 a[44:47], v[164:167], v[140:143], a[44:47]
v_mfma_f32_16x16x32_bf16 a[48:51], v[164:167], v[144:147], a[48:51]
v_mfma_f32_16x16x32_bf16 a[52:55], v[164:167], v[148:151], a[52:55]
s_add_u32 m0, s26, 100352
v_mfma_f32_16x16x32_bf16 a[56:59], v[164:167], v[152:155], a[56:59]
global_load_lds_dwordx4 v8, s[6:7]
v_mfma_f32_16x16x32_bf16 a[60:63], v[164:167], v[156:159], a[60:63]
v_mfma_f32_16x16x32_bf16 a[64:67], v[168:171], v[128:131], a[64:67]
v_mfma_f32_16x16x32_bf16 a[68:71], v[168:171], v[132:135], a[68:71]
v_mfma_f32_16x16x32_bf16 a[72:75], v[168:171], v[136:139], a[72:75]
v_mfma_f32_16x16x32_bf16 a[76:79], v[168:171], v[140:143], a[76:79]
s_add_u32 m0, s26, 101376
v_mfma_f32_16x16x32_bf16 a[80:83], v[168:171], v[144:147], a[80:83]
global_load_lds_dwordx4 v9, s[6:7]
v_mfma_f32_16x16x32_bf16 a[84:87], v[168:171], v[148:151], a[84:87]
v_mfma_f32_16x16x32_bf16 a[88:91], v[168:171], v[152:155], a[88:91]
v_mfma_f32_16x16x32_bf16 a[92:95], v[168:171], v[156:159], a[92:95]
v_mfma_f32_16x16x32_bf16 a[96:99], v[172:175], v[128:131], a[96:99]
v_mfma_f32_16x16x32_bf16 a[100:103], v[172:175], v[132:135], a[100:103]
s_mov_b32 m0, s38
v_mfma_f32_16x16x32_bf16 a[104:107], v[172:175], v[136:139], a[104:107]
global_load_lds_dwordx4 v55, s[36:37]
v_mfma_f32_16x16x32_bf16 a[108:111], v[172:175], v[140:143], a[108:111]
v_mfma_f32_16x16x32_bf16 a[112:115], v[172:175], v[144:147], a[112:115]
v_mfma_f32_16x16x32_bf16 a[116:119], v[172:175], v[148:151], a[116:119]
v_mfma_f32_16x16x32_bf16 a[120:123], v[172:175], v[152:155], a[120:123]
v_mfma_f32_16x16x32_bf16 a[124:127], v[172:175], v[156:159], a[124:127]
s_add_u32 s6, s6, s9
s_addc_u32 s7, s7, 0
s_add_u32 s36, s36, 4096
s_addc_u32 s37, s37, 0
s_waitcnt vmcnt(18)
s_barrier
v_mfma_f32_16x16x32_bf16 a[128:131], v[176:179], v[128:131], a[128:131]
ds_read_b64_tr_b16 v[224:225], v26 offset:32768
ds_read_b64_tr_b16 v[226:227], v26 offset:34816
v_mfma_f32_16x16x32_bf16 a[132:135], v[176:179], v[132:135], a[132:135]
s_add_u32 m0, s25, 0
ds_read_b64_tr_b16 v[192:193], v10 offset:32768
ds_read_b64_tr_b16 v[194:195], v10 offset:34816
v_mfma_f32_16x16x32_bf16 a[136:139], v[176:179], v[136:139], a[136:139]
global_load_lds_dwordx4 v2, s[4:5] sc1
ds_read_b64_tr_b16 v[196:197], v11 offset:32768
ds_read_b64_tr_b16 v[198:199], v11 offset:34816
v_mfma_f32_16x16x32_bf16 a[140:143], v[176:179], v[140:143], a[140:143]
ds_read_b64_tr_b16 v[200:201], v12 offset:32768
ds_read_b64_tr_b16 v[202:203], v12 offset:34816
v_mfma_f32_16x16x32_bf16 a[144:147], v[176:179], v[144:147], a[144:147]
ds_read_b64_tr_b16 v[204:205], v13 offset:32768
ds_read_b64_tr_b16 v[206:207], v13 offset:34816
v_mfma_f32_16x16x32_bf16 a[148:151], v[176:179], v[148:151], a[148:151]
ds_read_b64_tr_b16 v[208:209], v14 offset:32768
ds_read_b64_tr_b16 v[210:211], v14 offset:34816
v_mfma_f32_16x16x32_bf16 a[152:155], v[176:179], v[152:155], a[152:155]
ds_read_b64_tr_b16 v[212:213], v15 offset:32768
ds_read_b64_tr_b16 v[214:215], v15 offset:34816
v_mfma_f32_16x16x32_bf16 a[156:159], v[176:179], v[156:159], a[156:159]
ds_read_b64_tr_b16 v[216:217], v16 offset:32768
ds_read_b64_tr_b16 v[218:219], v16 offset:34816
v_mfma_f32_16x16x32_bf16 a[160:163], v[180:183], v[128:131], a[160:163]
ds_read_b64_tr_b16 v[220:221], v17 offset:32768
ds_read_b64_tr_b16 v[222:223], v17 offset:34816
v_mfma_f32_16x16x32_bf16 a[164:167], v[180:183], v[132:135], a[164:167]
s_add_u32 m0, s25, 1024
ds_read_b64_tr_b16 v[228:229], v27 offset:32768
ds_read_b64_tr_b16 v[230:231], v27 offset:34816
v_mfma_f32_16x16x32_bf16 a[168:171], v[180:183], v[136:139], a[168:171]
global_load_lds_dwordx4 v3, s[4:5] sc1
ds_read_b64_tr_b16 v[232:233], v28 offset:32768
ds_read_b64_tr_b16 v[234:235], v28 offset:34816
v_mfma_f32_16x16x32_bf16 a[172:175], v[180:183], v[140:143], a[172:175]
ds_read_b64_tr_b16 v[236:237], v29 offset:32768
ds_read_b64_tr_b16 v[238:239], v29 offset:34816
v_mfma_f32_16x16x32_bf16 a[176:179], v[180:183], v[144:147], a[176:179]
ds_read_b64_tr_b16 v[240:241], v30 offset:32768
ds_read_b64_tr_b16 v[242:243], v30 offset:34816
v_mfma_f32_16x16x32_bf16 a[180:183], v[180:183], v[148:151], a[180:183]
ds_read_b64_tr_b16 v[244:245], v31 offset:32768
ds_read_b64_tr_b16 v[246:247], v31 offset:34816
v_mfma_f32_16x16x32_bf16 a[184:187], v[180:183], v[152:155], a[184:187]
ds_read_b64_tr_b16 v[248:249], v32 offset:32768
ds_read_b64_tr_b16 v[250:251], v32 offset:34816
v_mfma_f32_16x16x32_bf16 a[188:191], v[180:183], v[156:159], a[188:191]
ds_read_b64_tr_b16 v[252:253], v33 offset:32768
ds_read_b64_tr_b16 v[254:255], v33 offset:34816
v_mfma_f32_16x16x32_bf16 a[192:195], v[184:187], v[128:131], a[192:195]
v_mfma_f32_16x16x32_bf16 a[196:199], v[184:187], v[132:135], a[196:199]
s_add_u32 m0, s25, 2048
v_mfma_f32_16x16x32_bf16 a[200:203], v[184:187], v[136:139], a[200:203]
global_load_lds_dwordx4 v4, s[4:5] sc1
v_mfma_f32_16x16x32_bf16 a[204:207], v[184:187], v[140:143], a[204:207]
v_mfma_f32_16x16x32_bf16 a[208:211], v[184:187], v[144:147], a[208:211]
v_mfma_f32_16x16x32_bf16 a[212:215], v[184:187], v[148:151], a[212:215]
v_mfma_f32_16x16x32_bf16 a[216:219], v[184:187], v[152:155], a[216:219]
v_mfma_f32_16x16x32_bf16 a[220:223], v[184:187], v[156:159], a[220:223]
v_mfma_f32_16x16x32_bf16 a[224:227], v[188:191], v[128:131], a[224:227]
v_mfma_f32_16x16x32_bf16 a[228:231], v[188:191], v[132:135], a[228:231]
s_add_u32 m0, s25, 3072
v_mfma_f32_16x16x32_bf16 a[232:235], v[188:191], v[136:139], a[232:235]
global_load_lds_dwordx4 v5, s[4:5] sc1
v_mfma_f32_16x16x32_bf16 a[236:239], v[188:191], v[140:143], a[236:239]
v_mfma_f32_16x16x32_bf16 a[240:243], v[188:191], v[144:147], a[240:243]
v_mfma_f32_16x16x32_bf16 a[244:247], v[188:191], v[148:151], a[244:247]
v_mfma_f32_16x16x32_bf16 a[248:251], v[188:191], v[152:155], a[248:251]
v_mfma_f32_16x16x32_bf16 a[252:255], v[188:191], v[156:159], a[252:255]
s_add_u32 s4, s4, s8
s_addc_u32 s5, s5, 0
s_branch M_gl_110
M_gle_111:
s_waitcnt lgkmcnt(0)
v_mfma_f32_16x16x32_bf16 a[0:3], v[160:163], v[128:131], a[0:3]
v_mfma_f32_16x16x32_bf16 a[4:7], v[160:163], v[132:135], a[4:7]
s_add_u32 m0, s26, 98304
v_mfma_f32_16x16x32_bf16 a[8:11], v[160:163], v[136:139], a[8:11]
global_load_lds_dwordx4 v6, s[6:7]
v_mfma_f32_16x16x32_bf16 a[12:15], v[160:163], v[140:143], a[12:15]
v_mfma_f32_16x16x32_bf16 a[16:19], v[160:163], v[144:147], a[16:19]
v_mfma_f32_16x16x32_bf16 a[20:23], v[160:163], v[148:151], a[20:23]
v_mfma_f32_16x16x32_bf16 a[24:27], v[160:163], v[152:155], a[24:27]
v_mfma_f32_16x16x32_bf16 a[28:31], v[160:163], v[156:159], a[28:31]
s_add_u32 m0, s26, 99328
v_mfma_f32_16x16x32_bf16 a[32:35], v[164:167], v[128:131], a[32:35]
global_load_lds_dwordx4 v7, s[6:7]
v_mfma_f32_16x16x32_bf16 a[36:39], v[164:167], v[132:135], a[36:39]
v_mfma_f32_16x16x32_bf16 a[40:43], v[164:167], v[136:139], a[40:43]
v_mfma_f32_16x16x32_bf16 a[44:47], v[164:167], v[140:143], a[44:47]
v_mfma_f32_16x16x32_bf16 a[48:51], v[164:167], v[144:147], a[48:51]
v_mfma_f32_16x16x32_bf16 a[52:55], v[164:167], v[148:151], a[52:55]
s_add_u32 m0, s26, 100352
v_mfma_f32_16x16x32_bf16 a[56:59], v[164:167], v[152:155], a[56:59]
global_load_lds_dwordx4 v8, s[6:7]
v_mfma_f32_16x16x32_bf16 a[60:63], v[164:167], v[156:159], a[60:63]
v_mfma_f32_16x16x32_bf16 a[64:67], v[168:171], v[128:131], a[64:67]
v_mfma_f32_16x16x32_bf16 a[68:71], v[168:171], v[132:135], a[68:71]
v_mfma_f32_16x16x32_bf16 a[72:75], v[168:171], v[136:139], a[72:75]
v_mfma_f32_16x16x32_bf16 a[76:79], v[168:171], v[140:143], a[76:79]
s_add_u32 m0, s26, 101376
v_mfma_f32_16x16x32_bf16 a[80:83], v[168:171], v[144:147], a[80:83]
global_load_lds_dwordx4 v9, s[6:7]
v_mfma_f32_16x16x32_bf16 a[84:87], v[168:171], v[148:151], a[84:87]
v_mfma_f32_16x16x32_bf16 a[88:91], v[168:171], v[152:155], a[88:91]
v_mfma_f32_16x16x32_bf16 a[92:95], v[168:171], v[156:159], a[92:95]
v_mfma_f32_16x16x32_bf16 a[96:99], v[172:175], v[128:131], a[96:99]
v_mfma_f32_16x16x32_bf16 a[100:103], v[172:175], v[132:135], a[100:103]
s_mov_b32 m0, s38
v_mfma_f32_16x16x32_bf16 a[104:107], v[172:175], v[136:139], a[104:107]
global_load_lds_dwordx4 v55, s[36:37]
v_mfma_f32_16x16x32_bf16 a[108:111], v[172:175], v[140:143], a[108:111]
v_mfma_f32_16x16x32_bf16 a[112:115], v[172:175], v[144:147], a[112:115]
v_mfma_f32_16x16x32_bf16 a[116:119], v[172:175], v[148:151], a[116:119]
v_mfma_f32_16x16x32_bf16 a[120:123], v[172:175], v[152:155], a[120:123]
v_mfma_f32_16x16x32_bf16 a[124:127], v[172:175], v[156:159], a[124:127]
s_add_u32 s6, s6, s9
s_addc_u32 s7, s7, 0
s_add_u32 s36, s36, 4096
s_addc_u32 s37, s37, 0
s_waitcnt vmcnt(18)
s_barrier
v_mfma_f32_16x16x32_bf16 a[128:131], v[176:179], v[128:131], a[128:131]
ds_read_b64_tr_b16 v[224:225], v26 offset:32768
ds_read_b64_tr_b16 v[226:227], v26 offset:34816
v_mfma_f32_16x16x32_bf16 a[132:135], v[176:179], v[132:135], a[132:135]
ds_read_b64_tr_b16 v[192:193], v10 offset:32768
ds_read_b64_tr_b16 v[194:195], v10 offset:34816
v_mfma_f32_16x16x32_bf16 a[136:139], v[176:179], v[136:139], a[136:139]
ds_read_b64_tr_b16 v[196:197], v11 offset:32768
ds_read_b64_tr_b16 v[198:199], v11 offset:34816
v_mfma_f32_16x16x32_bf16 a[140:143], v[176:179], v[140:143], a[140:143]
ds_read_b64_tr_b16 v[200:201], v12 offset:32768
ds_read_b64_tr_b16 v[202:203], v12 offset:34816
v_mfma_f32_16x16x32_bf16 a[144:147], v[176:179], v[144:147], a[144:147]
ds_read_b64_tr_b16 v[204:205], v13 offset:32768
ds_read_b64_tr_b16 v[206:207], v13 offset:34816
v_mfma_f32_16x16x32_bf16 a[148:151], v[176:179], v[148:151], a[148:151]
ds_read_b64_tr_b16 v[208:209], v14 offset:32768
ds_read_b64_tr_b16 v[210:211], v14 offset:34816
v_mfma_f32_16x16x32_bf16 a[152:155], v[176:179], v[152:155], a[152:155]
ds_read_b64_tr_b16 v[212:213], v15 offset:32768
ds_read_b64_tr_b16 v[214:215], v15 offset:34816
v_mfma_f32_16x16x32_bf16 a[156:159], v[176:179], v[156:159], a[156:159]
ds_read_b64_tr_b16 v[216:217], v16 offset:32768
ds_read_b64_tr_b16 v[218:219], v16 offset:34816
v_mfma_f32_16x16x32_bf16 a[160:163], v[180:183], v[128:131], a[160:163]
ds_read_b64_tr_b16 v[220:221], v17 offset:32768
ds_read_b64_tr_b16 v[222:223], v17 offset:34816
v_mfma_f32_16x16x32_bf16 a[164:167], v[180:183], v[132:135], a[164:167]
ds_read_b64_tr_b16 v[228:229], v27 offset:32768
ds_read_b64_tr_b16 v[230:231], v27 offset:34816
v_mfma_f32_16x16x32_bf16 a[168:171], v[180:183], v[136:139], a[168:171]
ds_read_b64_tr_b16 v[232:233], v28 offset:32768
ds_read_b64_tr_b16 v[234:235], v28 offset:34816
v_mfma_f32_16x16x32_bf16 a[172:175], v[180:183], v[140:143], a[172:175]
ds_read_b64_tr_b16 v[236:237], v29 offset:32768
ds_read_b64_tr_b16 v[238:239], v29 offset:34816
v_mfma_f32_16x16x32_bf16 a[176:179], v[180:183], v[144:147], a[176:179]
ds_read_b64_tr_b16 v[240:241], v30 offset:32768
ds_read_b64_tr_b16 v[242:243], v30 offset:34816
v_mfma_f32_16x16x32_bf16 a[180:183], v[180:183], v[148:151], a[180:183]
ds_read_b64_tr_b16 v[244:245], v31 offset:32768
ds_read_b64_tr_b16 v[246:247], v31 offset:34816
v_mfma_f32_16x16x32_bf16 a[184:187], v[180:183], v[152:155], a[184:187]
ds_read_b64_tr_b16 v[248:249], v32 offset:32768
ds_read_b64_tr_b16 v[250:251], v32 offset:34816
v_mfma_f32_16x16x32_bf16 a[188:191], v[180:183], v[156:159], a[188:191]
ds_read_b64_tr_b16 v[252:253], v33 offset:32768
ds_read_b64_tr_b16 v[254:255], v33 offset:34816
v_mfma_f32_16x16x32_bf16 a[192:195], v[184:187], v[128:131], a[192:195]
v_mfma_f32_16x16x32_bf16 a[196:199], v[184:187], v[132:135], a[196:199]
v_mfma_f32_16x16x32_bf16 a[200:203], v[184:187], v[136:139], a[200:203]
v_mfma_f32_16x16x32_bf16 a[204:207], v[184:187], v[140:143], a[204:207]
v_mfma_f32_16x16x32_bf16 a[208:211], v[184:187], v[144:147], a[208:211]
v_mfma_f32_16x16x32_bf16 a[212:215], v[184:187], v[148:151], a[212:215]
v_mfma_f32_16x16x32_bf16 a[216:219], v[184:187], v[152:155], a[216:219]
v_mfma_f32_16x16x32_bf16 a[220:223], v[184:187], v[156:159], a[220:223]
v_mfma_f32_16x16x32_bf16 a[224:227], v[188:191], v[128:131], a[224:227]
v_mfma_f32_16x16x32_bf16 a[228:231], v[188:191], v[132:135], a[228:231]
v_mfma_f32_16x16x32_bf16 a[232:235], v[188:191], v[136:139], a[232:235]
v_mfma_f32_16x16x32_bf16 a[236:239], v[188:191], v[140:143], a[236:239]
v_mfma_f32_16x16x32_bf16 a[240:243], v[188:191], v[144:147], a[240:243]
v_mfma_f32_16x16x32_bf16 a[244:247], v[188:191], v[148:151], a[244:247]
v_mfma_f32_16x16x32_bf16 a[248:251], v[188:191], v[152:155], a[248:251]
v_mfma_f32_16x16x32_bf16 a[252:255], v[188:191], v[156:159], a[252:255]
s_waitcnt lgkmcnt(0)
v_mfma_f32_16x16x32_bf16 a[0:3], v[224:227], v[192:195], a[0:3]
v_mfma_f32_16x16x32_bf16 a[4:7], v[224:227], v[196:199], a[4:7]
v_mfma_f32_16x16x32_bf16 a[8:11], v[224:227], v[200:203], a[8:11]
v_mfma_f32_16x16x32_bf16 a[12:15], v[224:227], v[204:207], a[12:15]
v_mfma_f32_16x16x32_bf16 a[16:19], v[224:227], v[208:211], a[16:19]
v_mfma_f32_16x16x32_bf16 a[20:23], v[224:227], v[212:215], a[20:23]
v_mfma_f32_16x16x32_bf16 a[24:27], v[224:227], v[216:219], a[24:27]
v_mfma_f32_16x16x32_bf16 a[28:31], v[224:227], v[220:223], a[28:31]
v_mfma_f32_16x16x32_bf16 a[32:35], v[228:231], v[192:195], a[32:35]
v_mfma_f32_16x16x32_bf16 a[36:39], v[228:231], v[196:199], a[36:39]
v_mfma_f32_16x16x32_bf16 a[40:43], v[228:231], v[200:203], a[40:43]
v_mfma_f32_16x16x32_bf16 a[44:47], v[228:231], v[204:207], a[44:47]
v_mfma_f32_16x16x32_bf16 a[48:51], v[228:231], v[208:211], a[48:51]
v_mfma_f32_16x16x32_bf16 a[52:55], v[228:231], v[212:215], a[52:55]
v_mfma_f32_16x16x32_bf16 a[56:59], v[228:231], v[216:219], a[56:59]
v_mfma_f32_16x16x32_bf16 a[60:63], v[228:231], v[220:223], a[60:63]
v_mfma_f32_16x16x32_bf16 a[64:67], v[232:235], v[192:195], a[64:67]
v_mfma_f32_16x16x32_bf16 a[68:71], v[232:235], v[196:199], a[68:71]
v_mfma_f32_16x16x32_bf16 a[72:75], v[232:235], v[200:203], a[72:75]
v_mfma_f32_16x16x32_bf16 a[76:79], v[232:235], v[204:207], a[76:79]
v_mfma_f32_16x16x32_bf16 a[80:83], v[232:235], v[208:211], a[80:83]
v_mfma_f32_16x16x32_bf16 a[84:87], v[232:235], v[212:215], a[84:87]
v_mfma_f32_16x16x32_bf16 a[88:91], v[232:235], v[216:219], a[88:91]
v_mfma_f32_16x16x32_bf16 a[92:95], v[232:235], v[220:223], a[92:95]
v_mfma_f32_16x16x32_bf16 a[96:99], v[236:239], v[192:195], a[96:99]
v_mfma_f32_16x16x32_bf16 a[100:103], v[236:239], v[196:199], a[100:103]
v_mfma_f32_16x16x32_bf16 a[104:107], v[236:239], v[200:203], a[104:107]
v_mfma_f32_16x16x32_bf16 a[108:111], v[236:239], v[204:207], a[108:111]
v_mfma_f32_16x16x32_bf16 a[112:115], v[236:239], v[208:211], a[112:115]
v_mfma_f32_16x16x32_bf16 a[116:119], v[236:239], v[212:215], a[116:119]
v_mfma_f32_16x16x32_bf16 a[120:123], v[236:239], v[216:219], a[120:123]
v_mfma_f32_16x16x32_bf16 a[124:127], v[236:239], v[220:223], a[124:127]
s_waitcnt vmcnt(9)
s_barrier
v_mfma_f32_16x16x32_bf16 a[128:131], v[240:243], v[192:195], a[128:131]
ds_read_b64_tr_b16 v[160:161], v34 offset:0
ds_read_b64_tr_b16 v[162:163], v34 offset:2048
v_mfma_f32_16x16x32_bf16 a[132:135], v[240:243], v[196:199], a[132:135]
ds_read_b64_tr_b16 v[128:129], v18 offset:0
ds_read_b64_tr_b16 v[130:131], v18 offset:2048
v_mfma_f32_16x16x32_bf16 a[136:139], v[240:243], v[200:203], a[136:139]
ds_read_b64_tr_b16 v[132:133], v19 offset:0
ds_read_b64_tr_b16 v[134:135], v19 offset:2048
v_mfma_f32_16x16x32_bf16 a[140:143], v[240:243], v[204:207], a[140:143]
ds_read_b64_tr_b16 v[136:137], v20 offset:0
ds_read_b64_tr_b16 v[138:139], v20 offset:2048
v_mfma_f32_16x16x32_bf16 a[144:147], v[240:243], v[208:211], a[144:147]
ds_read_b64_tr_b16 v[140:141], v21 offset:0
ds_read_b64_tr_b16 v[142:143], v21 offset:2048
v_mfma_f32_16x16x32_bf16 a[148:151], v[240:243], v[212:215], a[148:151]
ds_read_b64_tr_b16 v[144:145], v22 offset:0
ds_read_b64_tr_b16 v[146:147], v22 offset:2048
v_mfma_f32_16x16x32_bf16 a[152:155], v[240:243], v[216:219], a[152:155]
ds_read_b64_tr_b16 v[148:149], v23 offset:0
ds_read_b64_tr_b16 v[150:151], v23 offset:2048
v_mfma_f32_16x16x32_bf16 a[156:159], v[240:243], v[220:223], a[156:159]
ds_read_b64_tr_b16 v[152:153], v24 offset:0
ds_read_b64_tr_b16 v[154:155], v24 offset:2048
v_mfma_f32_16x16x32_bf16 a[160:163], v[244:247], v[192:195], a[160:163]
ds_read_b64_tr_b16 v[156:157], v25 offset:0
ds_read_b64_tr_b16 v[158:159], v25 offset:2048
v_mfma_f32_16x16x32_bf16 a[164:167], v[244:247], v[196:199], a[164:167]
ds_read_b64_tr_b16 v[164:165], v35 offset:0
ds_read_b64_tr_b16 v[166:167], v35 offset:2048
v_mfma_f32_16x16x32_bf16 a[168:171], v[244:247], v[200:203], a[168:171]
ds_read_b64_tr_b16 v[168:169], v36 offset:0
ds_read_b64_tr_b16 v[170:171], v36 offset:2048
v_mfma_f32_16x16x32_bf16 a[172:175], v[244:247], v[204:207], a[172:175]
ds_read_b64_tr_b16 v[172:173], v37 offset:0
ds_read_b64_tr_b16 v[174:175], v37 offset:2048
v_mfma_f32_16x16x32_bf16 a[176:179], v[244:247], v[208:211], a[176:179]
ds_read_b64_tr_b16 v[176:177], v38 offset:0
ds_read_b64_tr_b16 v[178:179], v38 offset:2048
v_mfma_f32_16x16x32_bf16 a[180:183], v[244:247], v[212:215], a[180:183]
ds_read_b64_tr_b16 v[180:181], v39 offset:0
ds_read_b64_tr_b16 v[182:183], v39 offset:2048
v_mfma_f32_16x16x32_bf16 a[184:187], v[244:247], v[216:219], a[184:187]
ds_read_b64_tr_b16 v[184:185], v40 offset:0
ds_read_b64_tr_b16 v[186:187], v40 offset:2048
v_mfma_f32_16x16x32_bf16 a[188:191], v[244:247], v[220:223], a[188:191]
ds_read_b64_tr_b16 v[188:189], v41 offset:0
ds_read_b64_tr_b16 v[190:191], v41 offset:2048
v_mfma_f32_16x16x32_bf16 a[192:195], v[248:251], v[192:195], a[192:195]
v_mfma_f32_16x16x32_bf16 a[196:199], v[248:251], v[196:199], a[196:199]
v_mfma_f32_16x16x32_bf16 a[200:203], v[248:251], v[200:203], a[200:203]
v_mfma_f32_16x16x32_bf16 a[204:207], v[248:251], v[204:207], a[204:207]
v_mfma_f32_16x16x32_bf16 a[208:211], v[248:251], v[208:211], a[208:211]
v_mfma_f32_16x16x32_bf16 a[212:215], v[248:251], v[212:215], a[212:215]
v_mfma_f32_16x16x32_bf16 a[216:219], v[248:251], v[216:219], a[216:219]
v_mfma_f32_16x16x32_bf16 a[220:223], v[248:251], v[220:223], a[220:223]
v_mfma_f32_16x16x32_bf16 a[224:227], v[252:255], v[192:195], a[224:227]
v_mfma_f32_16x16x32_bf16 a[228:231], v[252:255], v[196:199], a[228:231]
v_mfma_f32_16x16x32_bf16 a[232:235], v[252:255], v[200:203], a[232:235]
v_mfma_f32_16x16x32_bf16 a[236:239], v[252:255], v[204:207], a[236:239]
v_mfma_f32_16x16x32_bf16 a[240:243], v[252:255], v[208:211], a[240:243]
v_mfma_f32_16x16x32_bf16 a[244:247], v[252:255], v[212:215], a[244:247]
v_mfma_f32_16x16x32_bf16 a[248:251], v[252:255], v[216:219], a[248:251]
v_mfma_f32_16x16x32_bf16 a[252:255], v[252:255], v[220:223], a[252:255]
s_waitcnt lgkmcnt(0)
v_mfma_f32_16x16x32_bf16 a[0:3], v[160:163], v[128:131], a[0:3]
v_mfma_f32_16x16x32_bf16 a[4:7], v[160:163], v[132:135], a[4:7]
v_mfma_f32_16x16x32_bf16 a[8:11], v[160:163], v[136:139], a[8:11]
v_mfma_f32_16x16x32_bf16 a[12:15], v[160:163], v[140:143], a[12:15]
v_mfma_f32_16x16x32_bf16 a[16:19], v[160:163], v[144:147], a[16:19]
v_mfma_f32_16x16x32_bf16 a[20:23], v[160:163], v[148:151], a[20:23]
v_mfma_f32_16x16x32_bf16 a[24:27], v[160:163], v[152:155], a[24:27]
v_mfma_f32_16x16x32_bf16 a[28:31], v[160:163], v[156:159], a[28:31]
v_mfma_f32_16x16x32_bf16 a[32:35], v[164:167], v[128:131], a[32:35]
v_mfma_f32_16x16x32_bf16 a[36:39], v[164:167], v[132:135], a[36:39]
v_mfma_f32_16x16x32_bf16 a[40:43], v[164:167], v[136:139], a[40:43]
v_mfma_f32_16x16x32_bf16 a[44:47], v[164:167], v[140:143], a[44:47]
v_mfma_f32_16x16x32_bf16 a[48:51], v[164:167], v[144:147], a[48:51]
v_mfma_f32_16x16x32_bf16 a[52:55], v[164:167], v[148:151], a[52:55]
v_mfma_f32_16x16x32_bf16 a[56:59], v[164:167], v[152:155], a[56:59]
v_mfma_f32_16x16x32_bf16 a[60:63], v[164:167], v[156:159], a[60:63]
v_mfma_f32_16x16x32_bf16 a[64:67], v[168:171], v[128:131], a[64:67]
v_mfma_f32_16x16x32_bf16 a[68:71], v[168:171], v[132:135], a[68:71]
v_mfma_f32_16x16x32_bf16 a[72:75], v[168:171], v[136:139], a[72:75]
v_mfma_f32_16x16x32_bf16 a[76:79], v[168:171], v[140:143], a[76:79]
v_mfma_f32_16x16x32_bf16 a[80:83], v[168:171], v[144:147], a[80:83]
v_mfma_f32_16x16x32_bf16 a[84:87], v[168:171], v[148:151], a[84:87]
v_mfma_f32_16x16x32_bf16 a[88:91], v[168:171], v[152:155], a[88:91]
v_mfma_f32_16x16x32_bf16 a[92:95], v[168:171], v[156:159], a[92:95]
v_mfma_f32_16x16x32_bf16 a[96:99], v[172:175], v[128:131], a[96:99]
v_mfma_f32_16x16x32_bf16 a[100:103], v[172:175], v[132:135], a[100:103]
v_mfma_f32_16x16x32_bf16 a[104:107], v[172:175], v[136:139], a[104:107]
v_mfma_f32_16x16x32_bf16 a[108:111], v[172:175], v[140:143], a[108:111]
v_mfma_f32_16x16x32_bf16 a[112:115], v[172:175], v[144:147], a[112:115]
v_mfma_f32_16x16x32_bf16 a[116:119], v[172:175], v[148:151], a[116:119]
v_mfma_f32_16x16x32_bf16 a[120:123], v[172:175], v[152:155], a[120:123]
v_mfma_f32_16x16x32_bf16 a[124:127], v[172:175], v[156:159], a[124:127]
s_waitcnt vmcnt(0)
s_barrier
v_mfma_f32_16x16x32_bf16 a[128:131], v[176:179], v[128:131], a[128:131]
ds_read_b64_tr_b16 v[224:225], v34 offset:32768
ds_read_b64_tr_b16 v[226:227], v34 offset:34816
v_mfma_f32_16x16x32_bf16 a[132:135], v[176:179], v[132:135], a[132:135]
ds_read_b64_tr_b16 v[192:193], v18 offset:32768
ds_read_b64_tr_b16 v[194:195], v18 offset:34816
v_mfma_f32_16x16x32_bf16 a[136:139], v[176:179], v[136:139], a[136:139]
ds_read_b64_tr_b16 v[196:197], v19 offset:32768
ds_read_b64_tr_b16 v[198:199], v19 offset:34816
v_mfma_f32_16x16x32_bf16 a[140:143], v[176:179], v[140:143], a[140:143]
ds_read_b64_tr_b16 v[200:201], v20 offset:32768
ds_read_b64_tr_b16 v[202:203], v20 offset:34816
v_mfma_f32_16x16x32_bf16 a[144:147], v[176:179], v[144:147], a[144:147]
ds_read_b64_tr_b16 v[204:205], v21 offset:32768
ds_read_b64_tr_b16 v[206:207], v21 offset:34816
v_mfma_f32_16x16x32_bf16 a[148:151], v[176:179], v[148:151], a[148:151]
ds_read_b64_tr_b16 v[208:209], v22 offset:32768
ds_read_b64_tr_b16 v[210:211], v22 offset:34816
v_mfma_f32_16x16x32_bf16 a[152:155], v[176:179], v[152:155], a[152:155]
ds_read_b64_tr_b16 v[212:213], v23 offset:32768
ds_read_b64_tr_b16 v[214:215], v23 offset:34816
v_mfma_f32_16x16x32_bf16 a[156:159], v[176:179], v[156:159], a[156:159]
ds_read_b64_tr_b16 v[216:217], v24 offset:32768
ds_read_b64_tr_b16 v[218:219], v24 offset:34816
v_mfma_f32_16x16x32_bf16 a[160:163], v[180:183], v[128:131], a[160:163]
ds_read_b64_tr_b16 v[220:221], v25 offset:32768
ds_read_b64_tr_b16 v[222:223], v25 offset:34816
v_mfma_f32_16x16x32_bf16 a[164:167], v[180:183], v[132:135], a[164:167]
ds_read_b64_tr_b16 v[228:229], v35 offset:32768
ds_read_b64_tr_b16 v[230:231], v35 offset:34816
v_mfma_f32_16x16x32_bf16 a[168:171], v[180:183], v[136:139], a[168:171]
ds_read_b64_tr_b16 v[232:233], v36 offset:32768
ds_read_b64_tr_b16 v[234:235], v36 offset:34816
v_mfma_f32_16x16x32_bf16 a[172:175], v[180:183], v[140:143], a[172:175]
ds_read_b64_tr_b16 v[236:237], v37 offset:32768
ds_read_b64_tr_b16 v[238:239], v37 offset:34816
v_mfma_f32_16x16x32_bf16 a[176:179], v[180:183], v[144:147], a[176:179]
ds_read_b64_tr_b16 v[240:241], v38 offset:32768
ds_read_b64_tr_b16 v[242:243], v38 offset:34816
v_mfma_f32_16x16x32_bf16 a[180:183], v[180:183], v[148:151], a[180:183]
ds_read_b64_tr_b16 v[244:245], v39 offset:32768
ds_read_b64_tr_b16 v[246:247], v39 offset:34816
v_mfma_f32_16x16x32_bf16 a[184:187], v[180:183], v[152:155], a[184:187]
ds_read_b64_tr_b16 v[248:249], v40 offset:32768
ds_read_b64_tr_b16 v[250:251], v40 offset:34816
v_mfma_f32_16x16x32_bf16 a[188:191], v[180:183], v[156:159], a[188:191]
ds_read_b64_tr_b16 v[252:253], v41 offset:32768
ds_read_b64_tr_b16 v[254:255], v41 offset:34816
v_mfma_f32_16x16x32_bf16 a[192:195], v[184:187], v[128:131], a[192:195]
v_mfma_f32_16x16x32_bf16 a[196:199], v[184:187], v[132:135], a[196:199]
v_mfma_f32_16x16x32_bf16 a[200:203], v[184:187], v[136:139], a[200:203]
v_mfma_f32_16x16x32_bf16 a[204:207], v[184:187], v[140:143], a[204:207]
v_mfma_f32_16x16x32_bf16 a[208:211], v[184:187], v[144:147], a[208:211]
v_mfma_f32_16x16x32_bf16 a[212:215], v[184:187], v[148:151], a[212:215]
v_mfma_f32_16x16x32_bf16 a[216:219], v[184:187], v[152:155], a[216:219]
v_mfma_f32_16x16x32_bf16 a[220:223], v[184:187], v[156:159], a[220:223]
v_mfma_f32_16x16x32_bf16 a[224:227], v[188:191], v[128:131], a[224:227]
v_mfma_f32_16x16x32_bf16 a[228:231], v[188:191], v[132:135], a[228:231]
v_mfma_f32_16x16x32_bf16 a[232:235], v[188:191], v[136:139], a[232:235]
v_mfma_f32_16x16x32_bf16 a[236:239], v[188:191], v[140:143], a[236:239]
v_mfma_f32_16x16x32_bf16 a[240:243], v[188:191], v[144:147], a[240:243]
v_mfma_f32_16x16x32_bf16 a[244:247], v[188:191], v[148:151], a[244:247]
v_mfma_f32_16x16x32_bf16 a[248:251], v[188:191], v[152:155], a[248:251]
v_mfma_f32_16x16x32_bf16 a[252:255], v[188:191], v[156:159], a[252:255]
s_waitcnt lgkmcnt(0)
v_mfma_f32_16x16x32_bf16 a[0:3], v[224:227], v[192:195], a[0:3]
v_mfma_f32_16x16x32_bf16 a[4:7], v[224:227], v[196:199], a[4:7]
v_mfma_f32_16x16x32_bf16 a[8:11], v[224:227], v[200:203], a[8:11]
v_mfma_f32_16x16x32_bf16 a[12:15], v[224:227], v[204:207], a[12:15]
v_mfma_f32_16x16x32_bf16 a[16:19], v[224:227], v[208:211], a[16:19]
v_mfma_f32_16x16x32_bf16 a[20:23], v[224:227], v[212:215], a[20:23]
v_mfma_f32_16x16x32_bf16 a[24:27], v[224:227], v[216:219], a[24:27]
v_mfma_f32_16x16x32_bf16 a[28:31], v[224:227], v[220:223], a[28:31]
v_mfma_f32_16x16x32_bf16 a[32:35], v[228:231], v[192:195], a[32:35]
v_mfma_f32_16x16x32_bf16 a[36:39], v[228:231], v[196:199], a[36:39]
v_mfma_f32_16x16x32_bf16 a[40:43], v[228:231], v[200:203], a[40:43]
v_mfma_f32_16x16x32_bf16 a[44:47], v[228:231], v[204:207], a[44:47]
v_mfma_f32_16x16x32_bf16 a[48:51], v[228:231], v[208:211], a[48:51]
v_mfma_f32_16x16x32_bf16 a[52:55], v[228:231], v[212:215], a[52:55]
v_mfma_f32_16x16x32_bf16 a[56:59], v[228:231], v[216:219], a[56:59]
v_mfma_f32_16x16x32_bf16 a[60:63], v[228:231], v[220:223], a[60:63]
v_mfma_f32_16x16x32_bf16 a[64:67], v[232:235], v[192:195], a[64:67]
v_mfma_f32_16x16x32_bf16 a[68:71], v[232:235], v[196:199], a[68:71]
v_mfma_f32_16x16x32_bf16 a[72:75], v[232:235], v[200:203], a[72:75]
v_mfma_f32_16x16x32_bf16 a[76:79], v[232:235], v[204:207], a[76:79]
v_mfma_f32_16x16x32_bf16 a[80:83], v[232:235], v[208:211], a[80:83]
v_mfma_f32_16x16x32_bf16 a[84:87], v[232:235], v[212:215], a[84:87]
v_mfma_f32_16x16x32_bf16 a[88:91], v[232:235], v[216:219], a[88:91]
v_mfma_f32_16x16x32_bf16 a[92:95], v[232:235], v[220:223], a[92:95]
v_mfma_f32_16x16x32_bf16 a[96:99], v[236:239], v[192:195], a[96:99]
v_mfma_f32_16x16x32_bf16 a[100:103], v[236:239], v[196:199], a[100:103]
v_mfma_f32_16x16x32_bf16 a[104:107], v[236:239], v[200:203], a[104:107]
v_mfma_f32_16x16x32_bf16 a[108:111], v[236:239], v[204:207], a[108:111]
v_mfma_f32_16x16x32_bf16 a[112:115], v[236:239], v[208:211], a[112:115]
v_mfma_f32_16x16x32_bf16 a[116:119], v[236:239], v[212:215], a[116:119]
v_mfma_f32_16x16x32_bf16 a[120:123], v[236:239], v[216:219], a[120:123]
v_mfma_f32_16x16x32_bf16 a[124:127], v[236:239], v[220:223], a[124:127]
v_mfma_f32_16x16x32_bf16 a[128:131], v[240:243], v[192:195], a[128:131]
v_mfma_f32_16x16x32_bf16 a[132:135], v[240:243], v[196:199], a[132:135]
v_mfma_f32_16x16x32_bf16 a[136:139], v[240:243], v[200:203], a[136:139]
v_mfma_f32_16x16x32_bf16 a[140:143], v[240:243], v[204:207], a[140:143]
v_mfma_f32_16x16x32_bf16 a[144:147], v[240:243], v[208:211], a[144:147]
v_mfma_f32_16x16x32_bf16 a[148:151], v[240:243], v[212:215], a[148:151]
v_mfma_f32_16x16x32_bf16 a[152:155], v[240:243], v[216:219], a[152:155]
v_mfma_f32_16x16x32_bf16 a[156:159], v[240:243], v[220:223], a[156:159]
v_mfma_f32_16x16x32_bf16 a[160:163], v[244:247], v[192:195], a[160:163]
v_mfma_f32_16x16x32_bf16 a[164:167], v[244:247], v[196:199], a[164:167]
v_mfma_f32_16x16x32_bf16 a[168:171], v[244:247], v[200:203], a[168:171]
v_mfma_f32_16x16x32_bf16 a[172:175], v[244:247], v[204:207], a[172:175]
v_mfma_f32_16x16x32_bf16 a[176:179], v[244:247], v[208:211], a[176:179]
v_mfma_f32_16x16x32_bf16 a[180:183], v[244:247], v[212:215], a[180:183]
v_mfma_f32_16x16x32_bf16 a[184:187], v[244:247], v[216:219], a[184:187]
v_mfma_f32_16x16x32_bf16 a[188:191], v[244:247], v[220:223], a[188:191]
v_mfma_f32_16x16x32_bf16 a[192:195], v[248:251], v[192:195], a[192:195]
v_mfma_f32_16x16x32_bf16 a[196:199], v[248:251], v[196:199], a[196:199]
v_mfma_f32_16x16x32_bf16 a[200:203], v[248:251], v[200:203], a[200:203]
v_mfma_f32_16x16x32_bf16 a[204:207], v[248:251], v[204:207], a[204:207]
v_mfma_f32_16x16x32_bf16 a[208:211], v[248:251], v[208:211], a[208:211]
v_mfma_f32_16x16x32_bf16 a[212:215], v[248:251], v[212:215], a[212:215]
v_mfma_f32_16x16x32_bf16 a[216:219], v[248:251], v[216:219], a[216:219]
v_mfma_f32_16x16x32_bf16 a[220:223], v[248:251], v[220:223], a[220:223]
v_mfma_f32_16x16x32_bf16 a[224:227], v[252:255], v[192:195], a[224:227]
v_mfma_f32_16x16x32_bf16 a[228:231], v[252:255], v[196:199], a[228:231]
v_mfma_f32_16x16x32_bf16 a[232:235], v[252:255], v[200:203], a[232:235]
v_mfma_f32_16x16x32_bf16 a[236:239], v[252:255], v[204:207], a[236:239]
v_mfma_f32_16x16x32_bf16 a[240:243], v[252:255], v[208:211], a[240:243]
v_mfma_f32_16x16x32_bf16 a[244:247], v[252:255], v[212:215], a[244:247]
v_mfma_f32_16x16x32_bf16 a[248:251], v[252:255], v[216:219], a[248:251]
v_mfma_f32_16x16x32_bf16 a[252:255], v[252:255], v[220:223], a[252:255]
v_and_b32 v42, 15, v1
v_lshrrev_b32 v43, 4, v1
v_and_b32 v44, 1, v43
v_lshlrev_b32 v44, 1, v44
v_lshrrev_b32 v45, 1, v43
v_add_u32 v44, v44, v45
v_lshrrev_b32 v46, 2, v42
v_lshrrev_b32 v45, 1, v46
v_xor_b32 v46, v46, v45
v_and_b32 v46, 1, v46
v_lshl_add_u32 v45, v46, 1, v45
v_xor_b32 v45, v45, v44
v_lshlrev_b32 v45, 4, v45
v_lshl_add_u32 v45, v42, 6, v45
s_lshr_b32 s21, s20, 1
s_and_b32 s22, s20, 1
s_lshl_b32 s21, s21, 13
s_lshl_b32 s23, s22, 18
s_add_u32 s21, s21, s23
v_add_u32 v56, s21, v45
v_add_u32 v57, 4096, v56
s_lshl_b32 s22, s22, 8
v_lshlrev_b32 v58, 3, v43
v_add_u32 v58, s22, v58
global_load_dwordx2 v[88:89], v58, s[14:15] offset:0
global_load_dwordx2 v[90:91], v58, s[14:15] offset:32
global_load_dwordx2 v[92:93], v58, s[14:15] offset:64
global_load_dwordx2 v[94:95], v58, s[14:15] offset:96
global_load_dwordx2 v[96:97], v58, s[14:15] offset:128
global_load_dwordx2 v[98:99], v58, s[14:15] offset:160
global_load_dwordx2 v[100:101], v58, s[14:15] offset:192
global_load_dwordx2 v[102:103], v58, s[14:15] offset:224
s_waitcnt vmcnt(0)
v_lshlrev_b32 v104, 16, v88
v_and_b32 v105, 0xffff0000, v88
v_lshlrev_b32 v106, 16, v89
v_and_b32 v107, 0xffff0000, v89
v_lshlrev_b32 v108, 16, v90
v_and_b32 v109, 0xffff0000, v90
v_lshlrev_b32 v110, 16, v91
v_and_b32 v111, 0xffff0000, v91
v_lshlrev_b32 v112, 16, v92
v_and_b32 v113, 0xffff0000, v92
v_lshlrev_b32 v114, 16, v93
v_and_b32 v115, 0xffff0000, v93
v_lshlrev_b32 v116, 16, v94
v_and_b32 v117, 0xffff0000, v94
v_lshlrev_b32 v118, 16, v95
v_and_b32 v119, 0xffff0000, v95
v_lshlrev_b32 v120, 16, v96
v_and_b32 v121, 0xffff0000, v96
v_lshlrev_b32 v122, 16, v97
v_and_b32 v123, 0xffff0000, v97
v_lshlrev_b32 v124, 16, v98
v_and_b32 v125, 0xffff0000, v98
v_lshlrev_b32 v126, 16, v99
v_and_b32 v127, 0xffff0000, v99
v_lshlrev_b32 v128, 16, v100
v_and_b32 v129, 0xffff0000, v100
v_lshlrev_b32 v130, 16, v101
v_and_b32 v131, 0xffff0000, v101
v_lshlrev_b32 v132, 16, v102
v_and_b32 v133, 0xffff0000, v102
v_lshlrev_b32 v134, 16, v103
v_and_b32 v135, 0xffff0000, v103
s_mov_b32 s34, 0xbdd2d3e8
s_mov_b32 s35, 0xbdd2d3e8
v_mov_b32 v60, 0xc0135761
v_mov_b32 v61, 0xc0135761
v_mov_b32 v62, 1.0
v_mov_b32 v63, 1.0
v_accvgpr_read_b32 v64, a0
v_accvgpr_read_b32 v65, a1
v_accvgpr_read_b32 v66, a2
v_accvgpr_read_b32 v67, a3
v_accvgpr_read_b32 v68, a32
v_accvgpr_read_b32 v69, a33
v_accvgpr_read_b32 v70, a34
v_accvgpr_read_b32 v71, a35
v_cvt_pk_bf16_f32 v88, v64, v65
v_cvt_pk_bf16_f32 v90, v66, v67
v_cvt_pk_bf16_f32 v92, v68, v69
v_cvt_pk_bf16_f32 v94, v70, v71
v_lshlrev_b32 v64, 16, v88
v_and_b32 v65, 0xffff0000, v88
v_lshlrev_b32 v66, 16, v90
v_and_b32 v67, 0xffff0000, v90
v_lshlrev_b32 v68, 16, v92
v_and_b32 v69, 0xffff0000, v92
v_lshlrev_b32 v70, 16, v94
v_and_b32 v71, 0xffff0000, v94
v_pk_add_f32 v[64:65], v[64:65], v[104:105]
v_pk_add_f32 v[66:67], v[66:67], v[106:107]
v_pk_add_f32 v[68:69], v[68:69], v[108:109]
v_pk_add_f32 v[70:71], v[70:71], v[110:111]
v_cvt_pk_bf16_f32 v88, v64, v65
v_cvt_pk_bf16_f32 v90, v66, v67
v_cvt_pk_bf16_f32 v92, v68, v69
v_cvt_pk_bf16_f32 v94, v70, v71
v_lshlrev_b32 v64, 16, v88
v_and_b32 v65, 0xffff0000, v88
v_lshlrev_b32 v66, 16, v90
v_and_b32 v67, 0xffff0000, v90
v_lshlrev_b32 v68, 16, v92
v_and_b32 v69, 0xffff0000, v92
v_lshlrev_b32 v70, 16, v94
v_and_b32 v71, 0xffff0000, v94
v_pk_mul_f32 v[88:89], v[64:65], v[64:65]
v_pk_mul_f32 v[90:91], v[66:67], v[66:67]
v_pk_mul_f32 v[92:93], v[68:69], v[68:69]
v_pk_mul_f32 v[94:95], v[70:71], v[70:71]
v_pk_fma_f32 v[88:89], v[88:89], s[34:35], v[60:61]
v_pk_fma_f32 v[90:91], v[90:91], s[34:35], v[60:61]
v_pk_fma_f32 v[92:93], v[92:93], s[34:35], v[60:61]
v_pk_fma_f32 v[94:95], v[94:95], s[34:35], v[60:61]
v_pk_mul_f32 v[88:89], v[88:89], v[64:65]
v_pk_mul_f32 v[90:91], v[90:91], v[66:67]
v_pk_mul_f32 v[92:93], v[92:93], v[68:69]
v_pk_mul_f32 v[94:95], v[94:95], v[70:71]
v_exp_f32 v88, v88
v_exp_f32 v89, v89
v_exp_f32 v90, v90
v_exp_f32 v91, v91
v_exp_f32 v92, v92
v_exp_f32 v93, v93
v_exp_f32 v94, v94
v_exp_f32 v95, v95
v_pk_add_f32 v[88:89], v[88:89], v[62:63]
v_pk_add_f32 v[90:91], v[90:91], v[62:63]
v_pk_add_f32 v[92:93], v[92:93], v[62:63]
v_pk_add_f32 v[94:95], v[94:95], v[62:63]
v_rcp_f32 v88, v88
v_rcp_f32 v89, v89
v_rcp_f32 v90, v90
v_rcp_f32 v91, v91
v_rcp_f32 v92, v92
v_rcp_f32 v93, v93
v_rcp_f32 v94, v94
v_rcp_f32 v95, v95
v_pk_mul_f32 v[64:65], v[64:65], v[88:89]
v_pk_mul_f32 v[66:67], v[66:67], v[90:91]
v_pk_mul_f32 v[68:69], v[68:69], v[92:93]
v_pk_mul_f32 v[70:71], v[70:71], v[94:95]
v_cvt_pk_bf16_f32 v80, v64, v65
v_cvt_pk_bf16_f32 v81, v66, v67
v_cvt_pk_bf16_f32 v82, v68, v69
v_cvt_pk_bf16_f32 v83, v70, v71
s_nop 0
v_permlane16_swap_b32 v80, v82
v_permlane16_swap_b32 v81, v83
global_store_dwordx4 v56, v[80:83], s[12:13] offset:0 sc1
v_accvgpr_read_b32 v72, a4
v_accvgpr_read_b32 v73, a5
v_accvgpr_read_b32 v74, a6
v_accvgpr_read_b32 v75, a7
v_accvgpr_read_b32 v76, a36
v_accvgpr_read_b32 v77, a37
v_accvgpr_read_b32 v78, a38
v_accvgpr_read_b32 v79, a39
v_cvt_pk_bf16_f32 v88, v72, v73
v_cvt_pk_bf16_f32 v90, v74, v75
v_cvt_pk_bf16_f32 v92, v76, v77
v_cvt_pk_bf16_f32 v94, v78, v79
v_lshlrev_b32 v72, 16, v88
v_and_b32 v73, 0xffff0000, v88
v_lshlrev_b32 v74, 16, v90
v_and_b32 v75, 0xffff0000, v90
v_lshlrev_b32 v76, 16, v92
v_and_b32 v77, 0xffff0000, v92
v_lshlrev_b32 v78, 16, v94
v_and_b32 v79, 0xffff0000, v94
v_pk_add_f32 v[72:73], v[72:73], v[104:105]
v_pk_add_f32 v[74:75], v[74:75], v[106:107]
v_pk_add_f32 v[76:77], v[76:77], v[108:109]
v_pk_add_f32 v[78:79], v[78:79], v[110:111]
v_cvt_pk_bf16_f32 v88, v72, v73
v_cvt_pk_bf16_f32 v90, v74, v75
v_cvt_pk_bf16_f32 v92, v76, v77
v_cvt_pk_bf16_f32 v94, v78, v79
v_lshlrev_b32 v72, 16, v88
v_and_b32 v73, 0xffff0000, v88
v_lshlrev_b32 v74, 16, v90
v_and_b32 v75, 0xffff0000, v90
v_lshlrev_b32 v76, 16, v92
v_and_b32 v77, 0xffff0000, v92
v_lshlrev_b32 v78, 16, v94
v_and_b32 v79, 0xffff0000, v94
v_pk_mul_f32 v[88:89], v[72:73], v[72:73]
v_pk_mul_f32 v[90:91], v[74:75], v[74:75]
v_pk_mul_f32 v[92:93], v[76:77], v[76:77]
v_pk_mul_f32 v[94:95], v[78:79], v[78:79]
v_pk_fma_f32 v[88:89], v[88:89], s[34:35], v[60:61]
v_pk_fma_f32 v[90:91], v[90:91], s[34:35], v[60:61]
v_pk_fma_f32 v[92:93], v[92:93], s[34:35], v[60:61]
v_pk_fma_f32 v[94:95], v[94:95], s[34:35], v[60:61]
v_pk_mul_f32 v[88:89], v[88:89], v[72:73]
v_pk_mul_f32 v[90:91], v[90:91], v[74:75]
v_pk_mul_f32 v[92:93], v[92:93], v[76:77]
v_pk_mul_f32 v[94:95], v[94:95], v[78:79]
v_exp_f32 v88, v88
v_exp_f32 v89, v89
v_exp_f32 v90, v90
v_exp_f32 v91, v91
v_exp_f32 v92, v92
v_exp_f32 v93, v93
v_exp_f32 v94, v94
v_exp_f32 v95, v95
v_pk_add_f32 v[88:89], v[88:89], v[62:63]
v_pk_add_f32 v[90:91], v[90:91], v[62:63]
v_pk_add_f32 v[92:93], v[92:93], v[62:63]
v_pk_add_f32 v[94:95], v[94:95], v[62:63]
v_rcp_f32 v88, v88
v_rcp_f32 v89, v89
v_rcp_f32 v90, v90
v_rcp_f32 v91, v91
v_rcp_f32 v92, v92
v_rcp_f32 v93, v93
v_rcp_f32 v94, v94
v_rcp_f32 v95, v95
v_pk_mul_f32 v[72:73], v[72:73], v[88:89]
v_pk_mul_f32 v[74:75], v[74:75], v[90:91]
v_pk_mul_f32 v[76:77], v[76:77], v[92:93]
v_pk_mul_f32 v[78:79], v[78:79], v[94:95]
v_cvt_pk_bf16_f32 v84, v72, v73
v_cvt_pk_bf16_f32 v85, v74, v75
v_cvt_pk_bf16_f32 v86, v76, v77
v_cvt_pk_bf16_f32 v87, v78, v79
s_nop 0
v_permlane16_swap_b32 v84, v86
v_permlane16_swap_b32 v85, v87
global_store_dwordx4 v56, v[84:87], s[12:13] offset:1024 sc1
v_accvgpr_read_b32 v64, a8
v_accvgpr_read_b32 v65, a9
v_accvgpr_read_b32 v66, a10
v_accvgpr_read_b32 v67, a11
v_accvgpr_read_b32 v68, a40
v_accvgpr_read_b32 v69, a41
v_accvgpr_read_b32 v70, a42
v_accvgpr_read_b32 v71, a43
v_cvt_pk_bf16_f32 v88, v64, v65
v_cvt_pk_bf16_f32 v90, v66, v67
v_cvt_pk_bf16_f32 v92, v68, v69
v_cvt_pk_bf16_f32 v94, v70, v71
v_lshlrev_b32 v64, 16, v88
v_and_b32 v65, 0xffff0000, v88
v_lshlrev_b32 v66, 16, v90
v_and_b32 v67, 0xffff0000, v90
v_lshlrev_b32 v68, 16, v92
v_and_b32 v69, 0xffff0000, v92
v_lshlrev_b32 v70, 16, v94
v_and_b32 v71, 0xffff0000, v94
v_pk_add_f32 v[64:65], v[64:65], v[104:105]
v_pk_add_f32 v[66:67], v[66:67], v[106:107]
v_pk_add_f32 v[68:69], v[68:69], v[108:109]
v_pk_add_f32 v[70:71], v[70:71], v[110:111]
v_cvt_pk_bf16_f32 v88, v64, v65
v_cvt_pk_bf16_f32 v90, v66, v67
v_cvt_pk_bf16_f32 v92, v68, v69
v_cvt_pk_bf16_f32 v94, v70, v71
v_lshlrev_b32 v64, 16, v88
v_and_b32 v65, 0xffff0000, v88
v_lshlrev_b32 v66, 16, v90
v_and_b32 v67, 0xffff0000, v90
v_lshlrev_b32 v68, 16, v92
v_and_b32 v69, 0xffff0000, v92
v_lshlrev_b32 v70, 16, v94
v_and_b32 v71, 0xffff0000, v94
v_pk_mul_f32 v[88:89], v[64:65], v[64:65]
v_pk_mul_f32 v[90:91], v[66:67], v[66:67]
v_pk_mul_f32 v[92:93], v[68:69], v[68:69]
v_pk_mul_f32 v[94:95], v[70:71], v[70:71]
v_pk_fma_f32 v[88:89], v[88:89], s[34:35], v[60:61]
v_pk_fma_f32 v[90:91], v[90:91], s[34:35], v[60:61]
v_pk_fma_f32 v[92:93], v[92:93], s[34:35], v[60:61]
v_pk_fma_f32 v[94:95], v[94:95], s[34:35], v[60:61]
v_pk_mul_f32 v[88:89], v[88:89], v[64:65]
v_pk_mul_f32 v[90:91], v[90:91], v[66:67]
v_pk_mul_f32 v[92:93], v[92:93], v[68:69]
v_pk_mul_f32 v[94:95], v[94:95], v[70:71]
v_exp_f32 v88, v88
v_exp_f32 v89, v89
v_exp_f32 v90, v90
v_exp_f32 v91, v91
v_exp_f32 v92, v92
v_exp_f32 v93, v93
v_exp_f32 v94, v94
v_exp_f32 v95, v95
v_pk_add_f32 v[88:89], v[88:89], v[62:63]
v_pk_add_f32 v[90:91], v[90:91], v[62:63]
v_pk_add_f32 v[92:93], v[92:93], v[62:63]
v_pk_add_f32 v[94:95], v[94:95], v[62:63]
v_rcp_f32 v88, v88
v_rcp_f32 v89, v89
v_rcp_f32 v90, v90
v_rcp_f32 v91, v91
v_rcp_f32 v92, v92
v_rcp_f32 v93, v93
v_rcp_f32 v94, v94
v_rcp_f32 v95, v95
v_pk_mul_f32 v[64:65], v[64:65], v[88:89]
v_pk_mul_f32 v[66:67], v[66:67], v[90:91]
v_pk_mul_f32 v[68:69], v[68:69], v[92:93]
v_pk_mul_f32 v[70:71], v[70:71], v[94:95]
v_cvt_pk_bf16_f32 v80, v64, v65
v_cvt_pk_bf16_f32 v81, v66, v67
v_cvt_pk_bf16_f32 v82, v68, v69
v_cvt_pk_bf16_f32 v83, v70, v71
s_nop 0
v_permlane16_swap_b32 v80, v82
v_permlane16_swap_b32 v81, v83
global_store_dwordx4 v56, v[80:83], s[12:13] offset:2048 sc1
v_accvgpr_read_b32 v72, a12
v_accvgpr_read_b32 v73, a13
v_accvgpr_read_b32 v74, a14
v_accvgpr_read_b32 v75, a15
v_accvgpr_read_b32 v76, a44
v_accvgpr_read_b32 v77, a45
v_accvgpr_read_b32 v78, a46
v_accvgpr_read_b32 v79, a47
v_cvt_pk_bf16_f32 v88, v72, v73
v_cvt_pk_bf16_f32 v90, v74, v75
v_cvt_pk_bf16_f32 v92, v76, v77
v_cvt_pk_bf16_f32 v94, v78, v79
v_lshlrev_b32 v72, 16, v88
v_and_b32 v73, 0xffff0000, v88
v_lshlrev_b32 v74, 16, v90
v_and_b32 v75, 0xffff0000, v90
v_lshlrev_b32 v76, 16, v92
v_and_b32 v77, 0xffff0000, v92
v_lshlrev_b32 v78, 16, v94
v_and_b32 v79, 0xffff0000, v94
v_pk_add_f32 v[72:73], v[72:73], v[104:105]
v_pk_add_f32 v[74:75], v[74:75], v[106:107]
v_pk_add_f32 v[76:77], v[76:77], v[108:109]
v_pk_add_f32 v[78:79], v[78:79], v[110:111]
v_cvt_pk_bf16_f32 v88, v72, v73
v_cvt_pk_bf16_f32 v90, v74, v75
v_cvt_pk_bf16_f32 v92, v76, v77
v_cvt_pk_bf16_f32 v94, v78, v79
v_lshlrev_b32 v72, 16, v88
v_and_b32 v73, 0xffff0000, v88
v_lshlrev_b32 v74, 16, v90
v_and_b32 v75, 0xffff0000, v90
v_lshlrev_b32 v76, 16, v92
v_and_b32 v77, 0xffff0000, v92
v_lshlrev_b32 v78, 16, v94
v_and_b32 v79, 0xffff0000, v94
v_pk_mul_f32 v[88:89], v[72:73], v[72:73]
v_pk_mul_f32 v[90:91], v[74:75], v[74:75]
v_pk_mul_f32 v[92:93], v[76:77], v[76:77]
v_pk_mul_f32 v[94:95], v[78:79], v[78:79]
v_pk_fma_f32 v[88:89], v[88:89], s[34:35], v[60:61]
v_pk_fma_f32 v[90:91], v[90:91], s[34:35], v[60:61]
v_pk_fma_f32 v[92:93], v[92:93], s[34:35], v[60:61]
v_pk_fma_f32 v[94:95], v[94:95], s[34:35], v[60:61]
v_pk_mul_f32 v[88:89], v[88:89], v[72:73]
v_pk_mul_f32 v[90:91], v[90:91], v[74:75]
v_pk_mul_f32 v[92:93], v[92:93], v[76:77]
v_pk_mul_f32 v[94:95], v[94:95], v[78:79]
v_exp_f32 v88, v88
v_exp_f32 v89, v89
v_exp_f32 v90, v90
v_exp_f32 v91, v91
v_exp_f32 v92, v92
v_exp_f32 v93, v93
v_exp_f32 v94, v94
v_exp_f32 v95, v95
v_pk_add_f32 v[88:89], v[88:89], v[62:63]
v_pk_add_f32 v[90:91], v[90:91], v[62:63]
v_pk_add_f32 v[92:93], v[92:93], v[62:63]
v_pk_add_f32 v[94:95], v[94:95], v[62:63]
v_rcp_f32 v88, v88
v_rcp_f32 v89, v89
v_rcp_f32 v90, v90
v_rcp_f32 v91, v91
v_rcp_f32 v92, v92
v_rcp_f32 v93, v93
v_rcp_f32 v94, v94
v_rcp_f32 v95, v95
v_pk_mul_f32 v[72:73], v[72:73], v[88:89]
v_pk_mul_f32 v[74:75], v[74:75], v[90:91]
v_pk_mul_f32 v[76:77], v[76:77], v[92:93]
v_pk_mul_f32 v[78:79], v[78:79], v[94:95]
v_cvt_pk_bf16_f32 v84, v72, v73
v_cvt_pk_bf16_f32 v85, v74, v75
v_cvt_pk_bf16_f32 v86, v76, v77
v_cvt_pk_bf16_f32 v87, v78, v79
s_nop 0
v_permlane16_swap_b32 v84, v86
v_permlane16_swap_b32 v85, v87
global_store_dwordx4 v56, v[84:87], s[12:13] offset:3072 sc1
v_accvgpr_read_b32 v64, a16
v_accvgpr_read_b32 v65, a17
v_accvgpr_read_b32 v66, a18
v_accvgpr_read_b32 v67, a19
v_accvgpr_read_b32 v68, a48
v_accvgpr_read_b32 v69, a49
v_accvgpr_read_b32 v70, a50
v_accvgpr_read_b32 v71, a51
v_cvt_pk_bf16_f32 v88, v64, v65
v_cvt_pk_bf16_f32 v90, v66, v67
v_cvt_pk_bf16_f32 v92, v68, v69
v_cvt_pk_bf16_f32 v94, v70, v71
v_lshlrev_b32 v64, 16, v88
v_and_b32 v65, 0xffff0000, v88
v_lshlrev_b32 v66, 16, v90
v_and_b32 v67, 0xffff0000, v90
v_lshlrev_b32 v68, 16, v92
v_and_b32 v69, 0xffff0000, v92
v_lshlrev_b32 v70, 16, v94
v_and_b32 v71, 0xffff0000, v94
v_pk_add_f32 v[64:65], v[64:65], v[104:105]
v_pk_add_f32 v[66:67], v[66:67], v[106:107]
v_pk_add_f32 v[68:69], v[68:69], v[108:109]
v_pk_add_f32 v[70:71], v[70:71], v[110:111]
v_cvt_pk_bf16_f32 v88, v64, v65
v_cvt_pk_bf16_f32 v90, v66, v67
v_cvt_pk_bf16_f32 v92, v68, v69
v_cvt_pk_bf16_f32 v94, v70, v71
v_lshlrev_b32 v64, 16, v88
v_and_b32 v65, 0xffff0000, v88
v_lshlrev_b32 v66, 16, v90
v_and_b32 v67, 0xffff0000, v90
v_lshlrev_b32 v68, 16, v92
v_and_b32 v69, 0xffff0000, v92
v_lshlrev_b32 v70, 16, v94
v_and_b32 v71, 0xffff0000, v94
v_pk_mul_f32 v[88:89], v[64:65], v[64:65]
v_pk_mul_f32 v[90:91], v[66:67], v[66:67]
v_pk_mul_f32 v[92:93], v[68:69], v[68:69]
v_pk_mul_f32 v[94:95], v[70:71], v[70:71]
v_pk_fma_f32 v[88:89], v[88:89], s[34:35], v[60:61]
v_pk_fma_f32 v[90:91], v[90:91], s[34:35], v[60:61]
v_pk_fma_f32 v[92:93], v[92:93], s[34:35], v[60:61]
v_pk_fma_f32 v[94:95], v[94:95], s[34:35], v[60:61]
v_pk_mul_f32 v[88:89], v[88:89], v[64:65]
v_pk_mul_f32 v[90:91], v[90:91], v[66:67]
v_pk_mul_f32 v[92:93], v[92:93], v[68:69]
v_pk_mul_f32 v[94:95], v[94:95], v[70:71]
v_exp_f32 v88, v88
v_exp_f32 v89, v89
v_exp_f32 v90, v90
v_exp_f32 v91, v91
v_exp_f32 v92, v92
v_exp_f32 v93, v93
v_exp_f32 v94, v94
v_exp_f32 v95, v95
v_pk_add_f32 v[88:89], v[88:89], v[62:63]
v_pk_add_f32 v[90:91], v[90:91], v[62:63]
v_pk_add_f32 v[92:93], v[92:93], v[62:63]
v_pk_add_f32 v[94:95], v[94:95], v[62:63]
v_rcp_f32 v88, v88
v_rcp_f32 v89, v89
v_rcp_f32 v90, v90
v_rcp_f32 v91, v91
v_rcp_f32 v92, v92
v_rcp_f32 v93, v93
v_rcp_f32 v94, v94
v_rcp_f32 v95, v95
v_pk_mul_f32 v[64:65], v[64:65], v[88:89]
v_pk_mul_f32 v[66:67], v[66:67], v[90:91]
v_pk_mul_f32 v[68:69], v[68:69], v[92:93]
v_pk_mul_f32 v[70:71], v[70:71], v[94:95]
v_cvt_pk_bf16_f32 v80, v64, v65
v_cvt_pk_bf16_f32 v81, v66, v67
v_cvt_pk_bf16_f32 v82, v68, v69
v_cvt_pk_bf16_f32 v83, v70, v71
s_nop 0
v_permlane16_swap_b32 v80, v82
v_permlane16_swap_b32 v81, v83
global_store_dwordx4 v57, v[80:83], s[12:13] offset:0 sc1
v_accvgpr_read_b32 v72, a20
v_accvgpr_read_b32 v73, a21
v_accvgpr_read_b32 v74, a22
v_accvgpr_read_b32 v75, a23
v_accvgpr_read_b32 v76, a52
v_accvgpr_read_b32 v77, a53
v_accvgpr_read_b32 v78, a54
v_accvgpr_read_b32 v79, a55
v_cvt_pk_bf16_f32 v88, v72, v73
v_cvt_pk_bf16_f32 v90, v74, v75
v_cvt_pk_bf16_f32 v92, v76, v77
v_cvt_pk_bf16_f32 v94, v78, v79
v_lshlrev_b32 v72, 16, v88
v_and_b32 v73, 0xffff0000, v88
v_lshlrev_b32 v74, 16, v90
v_and_b32 v75, 0xffff0000, v90
v_lshlrev_b32 v76, 16, v92
v_and_b32 v77, 0xffff0000, v92
v_lshlrev_b32 v78, 16, v94
v_and_b32 v79, 0xffff0000, v94
v_pk_add_f32 v[72:73], v[72:73], v[104:105]
v_pk_add_f32 v[74:75], v[74:75], v[106:107]
v_pk_add_f32 v[76:77], v[76:77], v[108:109]
v_pk_add_f32 v[78:79], v[78:79], v[110:111]
v_cvt_pk_bf16_f32 v88, v72, v73
v_cvt_pk_bf16_f32 v90, v74, v75
v_cvt_pk_bf16_f32 v92, v76, v77
v_cvt_pk_bf16_f32 v94, v78, v79
v_lshlrev_b32 v72, 16, v88
v_and_b32 v73, 0xffff0000, v88
v_lshlrev_b32 v74, 16, v90
v_and_b32 v75, 0xffff0000, v90
v_lshlrev_b32 v76, 16, v92
v_and_b32 v77, 0xffff0000, v92
v_lshlrev_b32 v78, 16, v94
v_and_b32 v79, 0xffff0000, v94
v_pk_mul_f32 v[88:89], v[72:73], v[72:73]
v_pk_mul_f32 v[90:91], v[74:75], v[74:75]
v_pk_mul_f32 v[92:93], v[76:77], v[76:77]
v_pk_mul_f32 v[94:95], v[78:79], v[78:79]
v_pk_fma_f32 v[88:89], v[88:89], s[34:35], v[60:61]
v_pk_fma_f32 v[90:91], v[90:91], s[34:35], v[60:61]
v_pk_fma_f32 v[92:93], v[92:93], s[34:35], v[60:61]
v_pk_fma_f32 v[94:95], v[94:95], s[34:35], v[60:61]
v_pk_mul_f32 v[88:89], v[88:89], v[72:73]
v_pk_mul_f32 v[90:91], v[90:91], v[74:75]
v_pk_mul_f32 v[92:93], v[92:93], v[76:77]
v_pk_mul_f32 v[94:95], v[94:95], v[78:79]
v_exp_f32 v88, v88
v_exp_f32 v89, v89
v_exp_f32 v90, v90
v_exp_f32 v91, v91
v_exp_f32 v92, v92
v_exp_f32 v93, v93
v_exp_f32 v94, v94
v_exp_f32 v95, v95
v_pk_add_f32 v[88:89], v[88:89], v[62:63]
v_pk_add_f32 v[90:91], v[90:91], v[62:63]
v_pk_add_f32 v[92:93], v[92:93], v[62:63]
v_pk_add_f32 v[94:95], v[94:95], v[62:63]
v_rcp_f32 v88, v88
v_rcp_f32 v89, v89
v_rcp_f32 v90, v90
v_rcp_f32 v91, v91
v_rcp_f32 v92, v92
v_rcp_f32 v93, v93
v_rcp_f32 v94, v94
v_rcp_f32 v95, v95
v_pk_mul_f32 v[72:73], v[72:73], v[88:89]
v_pk_mul_f32 v[74:75], v[74:75], v[90:91]
v_pk_mul_f32 v[76:77], v[76:77], v[92:93]
v_pk_mul_f32 v[78:79], v[78:79], v[94:95]
v_cvt_pk_bf16_f32 v84, v72, v73
v_cvt_pk_bf16_f32 v85, v74, v75
v_cvt_pk_bf16_f32 v86, v76, v77
v_cvt_pk_bf16_f32 v87, v78, v79
s_nop 0
v_permlane16_swap_b32 v84, v86
v_permlane16_swap_b32 v85, v87
global_store_dwordx4 v57, v[84:87], s[12:13] offset:1024 sc1
v_accvgpr_read_b32 v64, a24
v_accvgpr_read_b32 v65, a25
v_accvgpr_read_b32 v66, a26
v_accvgpr_read_b32 v67, a27
v_accvgpr_read_b32 v68, a56
v_accvgpr_read_b32 v69, a57
v_accvgpr_read_b32 v70, a58
v_accvgpr_read_b32 v71, a59
v_cvt_pk_bf16_f32 v88, v64, v65
v_cvt_pk_bf16_f32 v90, v66, v67
v_cvt_pk_bf16_f32 v92, v68, v69
v_cvt_pk_bf16_f32 v94, v70, v71
v_lshlrev_b32 v64, 16, v88
v_and_b32 v65, 0xffff0000, v88
v_lshlrev_b32 v66, 16, v90
v_and_b32 v67, 0xffff0000, v90
v_lshlrev_b32 v68, 16, v92
v_and_b32 v69, 0xffff0000, v92
v_lshlrev_b32 v70, 16, v94
v_and_b32 v71, 0xffff0000, v94
v_pk_add_f32 v[64:65], v[64:65], v[104:105]
v_pk_add_f32 v[66:67], v[66:67], v[106:107]
v_pk_add_f32 v[68:69], v[68:69], v[108:109]
v_pk_add_f32 v[70:71], v[70:71], v[110:111]
v_cvt_pk_bf16_f32 v88, v64, v65
v_cvt_pk_bf16_f32 v90, v66, v67
v_cvt_pk_bf16_f32 v92, v68, v69
v_cvt_pk_bf16_f32 v94, v70, v71
v_lshlrev_b32 v64, 16, v88
v_and_b32 v65, 0xffff0000, v88
v_lshlrev_b32 v66, 16, v90
v_and_b32 v67, 0xffff0000, v90
v_lshlrev_b32 v68, 16, v92
v_and_b32 v69, 0xffff0000, v92
v_lshlrev_b32 v70, 16, v94
v_and_b32 v71, 0xffff0000, v94
v_pk_mul_f32 v[88:89], v[64:65], v[64:65]
v_pk_mul_f32 v[90:91], v[66:67], v[66:67]
v_pk_mul_f32 v[92:93], v[68:69], v[68:69]
v_pk_mul_f32 v[94:95], v[70:71], v[70:71]
v_pk_fma_f32 v[88:89], v[88:89], s[34:35], v[60:61]
v_pk_fma_f32 v[90:91], v[90:91], s[34:35], v[60:61]
v_pk_fma_f32 v[92:93], v[92:93], s[34:35], v[60:61]
v_pk_fma_f32 v[94:95], v[94:95], s[34:35], v[60:61]
v_pk_mul_f32 v[88:89], v[88:89], v[64:65]
v_pk_mul_f32 v[90:91], v[90:91], v[66:67]
v_pk_mul_f32 v[92:93], v[92:93], v[68:69]
v_pk_mul_f32 v[94:95], v[94:95], v[70:71]
v_exp_f32 v88, v88
v_exp_f32 v89, v89
v_exp_f32 v90, v90
v_exp_f32 v91, v91
v_exp_f32 v92, v92
v_exp_f32 v93, v93
v_exp_f32 v94, v94
v_exp_f32 v95, v95
v_pk_add_f32 v[88:89], v[88:89], v[62:63]
v_pk_add_f32 v[90:91], v[90:91], v[62:63]
v_pk_add_f32 v[92:93], v[92:93], v[62:63]
v_pk_add_f32 v[94:95], v[94:95], v[62:63]
v_rcp_f32 v88, v88
v_rcp_f32 v89, v89
v_rcp_f32 v90, v90
v_rcp_f32 v91, v91
v_rcp_f32 v92, v92
v_rcp_f32 v93, v93
v_rcp_f32 v94, v94
v_rcp_f32 v95, v95
v_pk_mul_f32 v[64:65], v[64:65], v[88:89]
v_pk_mul_f32 v[66:67], v[66:67], v[90:91]
v_pk_mul_f32 v[68:69], v[68:69], v[92:93]
v_pk_mul_f32 v[70:71], v[70:71], v[94:95]
v_cvt_pk_bf16_f32 v80, v64, v65
v_cvt_pk_bf16_f32 v81, v66, v67
v_cvt_pk_bf16_f32 v82, v68, v69
v_cvt_pk_bf16_f32 v83, v70, v71
s_nop 0
v_permlane16_swap_b32 v80, v82
v_permlane16_swap_b32 v81, v83
global_store_dwordx4 v57, v[80:83], s[12:13] offset:2048 sc1
v_accvgpr_read_b32 v72, a28
v_accvgpr_read_b32 v73, a29
v_accvgpr_read_b32 v74, a30
v_accvgpr_read_b32 v75, a31
v_accvgpr_read_b32 v76, a60
v_accvgpr_read_b32 v77, a61
v_accvgpr_read_b32 v78, a62
v_accvgpr_read_b32 v79, a63
v_cvt_pk_bf16_f32 v88, v72, v73
v_cvt_pk_bf16_f32 v90, v74, v75
v_cvt_pk_bf16_f32 v92, v76, v77
v_cvt_pk_bf16_f32 v94, v78, v79
v_lshlrev_b32 v72, 16, v88
v_and_b32 v73, 0xffff0000, v88
v_lshlrev_b32 v74, 16, v90
v_and_b32 v75, 0xffff0000, v90
v_lshlrev_b32 v76, 16, v92
v_and_b32 v77, 0xffff0000, v92
v_lshlrev_b32 v78, 16, v94
v_and_b32 v79, 0xffff0000, v94
v_pk_add_f32 v[72:73], v[72:73], v[104:105]
v_pk_add_f32 v[74:75], v[74:75], v[106:107]
v_pk_add_f32 v[76:77], v[76:77], v[108:109]
v_pk_add_f32 v[78:79], v[78:79], v[110:111]
v_cvt_pk_bf16_f32 v88, v72, v73
v_cvt_pk_bf16_f32 v90, v74, v75
v_cvt_pk_bf16_f32 v92, v76, v77
v_cvt_pk_bf16_f32 v94, v78, v79
v_lshlrev_b32 v72, 16, v88
v_and_b32 v73, 0xffff0000, v88
v_lshlrev_b32 v74, 16, v90
v_and_b32 v75, 0xffff0000, v90
v_lshlrev_b32 v76, 16, v92
v_and_b32 v77, 0xffff0000, v92
v_lshlrev_b32 v78, 16, v94
v_and_b32 v79, 0xffff0000, v94
v_pk_mul_f32 v[88:89], v[72:73], v[72:73]
v_pk_mul_f32 v[90:91], v[74:75], v[74:75]
v_pk_mul_f32 v[92:93], v[76:77], v[76:77]
v_pk_mul_f32 v[94:95], v[78:79], v[78:79]
v_pk_fma_f32 v[88:89], v[88:89], s[34:35], v[60:61]
v_pk_fma_f32 v[90:91], v[90:91], s[34:35], v[60:61]
v_pk_fma_f32 v[92:93], v[92:93], s[34:35], v[60:61]
v_pk_fma_f32 v[94:95], v[94:95], s[34:35], v[60:61]
v_pk_mul_f32 v[88:89], v[88:89], v[72:73]
v_pk_mul_f32 v[90:91], v[90:91], v[74:75]
v_pk_mul_f32 v[92:93], v[92:93], v[76:77]
v_pk_mul_f32 v[94:95], v[94:95], v[78:79]
v_exp_f32 v88, v88
v_exp_f32 v89, v89
v_exp_f32 v90, v90
v_exp_f32 v91, v91
v_exp_f32 v92, v92
v_exp_f32 v93, v93
v_exp_f32 v94, v94
v_exp_f32 v95, v95
v_pk_add_f32 v[88:89], v[88:89], v[62:63]
v_pk_add_f32 v[90:91], v[90:91], v[62:63]
v_pk_add_f32 v[92:93], v[92:93], v[62:63]
v_pk_add_f32 v[94:95], v[94:95], v[62:63]
v_rcp_f32 v88, v88
v_rcp_f32 v89, v89
v_rcp_f32 v90, v90
v_rcp_f32 v91, v91
v_rcp_f32 v92, v92
v_rcp_f32 v93, v93
v_rcp_f32 v94, v94
v_rcp_f32 v95, v95
v_pk_mul_f32 v[72:73], v[72:73], v[88:89]
v_pk_mul_f32 v[74:75], v[74:75], v[90:91]
v_pk_mul_f32 v[76:77], v[76:77], v[92:93]
v_pk_mul_f32 v[78:79], v[78:79], v[94:95]
v_cvt_pk_bf16_f32 v84, v72, v73
v_cvt_pk_bf16_f32 v85, v74, v75
v_cvt_pk_bf16_f32 v86, v76, v77
v_cvt_pk_bf16_f32 v87, v78, v79
s_nop 0
v_permlane16_swap_b32 v84, v86
v_permlane16_swap_b32 v85, v87
global_store_dwordx4 v57, v[84:87], s[12:13] offset:3072 sc1
s_add_u32 s12, s12, 65536
s_addc_u32 s13, s13, 0
v_accvgpr_read_b32 v64, a64
v_accvgpr_read_b32 v65, a65
v_accvgpr_read_b32 v66, a66
v_accvgpr_read_b32 v67, a67
v_accvgpr_read_b32 v68, a96
v_accvgpr_read_b32 v69, a97
v_accvgpr_read_b32 v70, a98
v_accvgpr_read_b32 v71, a99
v_cvt_pk_bf16_f32 v88, v64, v65
v_cvt_pk_bf16_f32 v90, v66, v67
v_cvt_pk_bf16_f32 v92, v68, v69
v_cvt_pk_bf16_f32 v94, v70, v71
v_lshlrev_b32 v64, 16, v88
v_and_b32 v65, 0xffff0000, v88
v_lshlrev_b32 v66, 16, v90
v_and_b32 v67, 0xffff0000, v90
v_lshlrev_b32 v68, 16, v92
v_and_b32 v69, 0xffff0000, v92
v_lshlrev_b32 v70, 16, v94
v_and_b32 v71, 0xffff0000, v94
v_pk_add_f32 v[64:65], v[64:65], v[112:113]
v_pk_add_f32 v[66:67], v[66:67], v[114:115]
v_pk_add_f32 v[68:69], v[68:69], v[116:117]
v_pk_add_f32 v[70:71], v[70:71], v[118:119]
v_cvt_pk_bf16_f32 v88, v64, v65
v_cvt_pk_bf16_f32 v90, v66, v67
v_cvt_pk_bf16_f32 v92, v68, v69
v_cvt_pk_bf16_f32 v94, v70, v71
v_lshlrev_b32 v64, 16, v88
v_and_b32 v65, 0xffff0000, v88
v_lshlrev_b32 v66, 16, v90
v_and_b32 v67, 0xffff0000, v90
v_lshlrev_b32 v68, 16, v92
v_and_b32 v69, 0xffff0000, v92
v_lshlrev_b32 v70, 16, v94
v_and_b32 v71, 0xffff0000, v94
v_pk_mul_f32 v[88:89], v[64:65], v[64:65]
v_pk_mul_f32 v[90:91], v[66:67], v[66:67]
v_pk_mul_f32 v[92:93], v[68:69], v[68:69]
v_pk_mul_f32 v[94:95], v[70:71], v[70:71]
v_pk_fma_f32 v[88:89], v[88:89], s[34:35], v[60:61]
v_pk_fma_f32 v[90:91], v[90:91], s[34:35], v[60:61]
v_pk_fma_f32 v[92:93], v[92:93], s[34:35], v[60:61]
v_pk_fma_f32 v[94:95], v[94:95], s[34:35], v[60:61]
v_pk_mul_f32 v[88:89], v[88:89], v[64:65]
v_pk_mul_f32 v[90:91], v[90:91], v[66:67]
v_pk_mul_f32 v[92:93], v[92:93], v[68:69]
v_pk_mul_f32 v[94:95], v[94:95], v[70:71]
v_exp_f32 v88, v88
v_exp_f32 v89, v89
v_exp_f32 v90, v90
v_exp_f32 v91, v91
v_exp_f32 v92, v92
v_exp_f32 v93, v93
v_exp_f32 v94, v94
v_exp_f32 v95, v95
v_pk_add_f32 v[88:89], v[88:89], v[62:63]
v_pk_add_f32 v[90:91], v[90:91], v[62:63]
v_pk_add_f32 v[92:93], v[92:93], v[62:63]
v_pk_add_f32 v[94:95], v[94:95], v[62:63]
v_rcp_f32 v88, v88
v_rcp_f32 v89, v89
v_rcp_f32 v90, v90
v_rcp_f32 v91, v91
v_rcp_f32 v92, v92
v_rcp_f32 v93, v93
v_rcp_f32 v94, v94
v_rcp_f32 v95, v95
v_pk_mul_f32 v[64:65], v[64:65], v[88:89]
v_pk_mul_f32 v[66:67], v[66:67], v[90:91]
v_pk_mul_f32 v[68:69], v[68:69], v[92:93]
v_pk_mul_f32 v[70:71], v[70:71], v[94:95]
v_cvt_pk_bf16_f32 v80, v64, v65
v_cvt_pk_bf16_f32 v81, v66, v67
v_cvt_pk_bf16_f32 v82, v68, v69
v_cvt_pk_bf16_f32 v83, v70, v71
s_nop 0
v_permlane16_swap_b32 v80, v82
v_permlane16_swap_b32 v81, v83
global_store_dwordx4 v56, v[80:83], s[12:13] offset:0 sc1
v_accvgpr_read_b32 v72, a68
v_accvgpr_read_b32 v73, a69
v_accvgpr_read_b32 v74, a70
v_accvgpr_read_b32 v75, a71
v_accvgpr_read_b32 v76, a100
v_accvgpr_read_b32 v77, a101
v_accvgpr_read_b32 v78, a102
v_accvgpr_read_b32 v79, a103
v_cvt_pk_bf16_f32 v88, v72, v73
v_cvt_pk_bf16_f32 v90, v74, v75
v_cvt_pk_bf16_f32 v92, v76, v77
v_cvt_pk_bf16_f32 v94, v78, v79
v_lshlrev_b32 v72, 16, v88
v_and_b32 v73, 0xffff0000, v88
v_lshlrev_b32 v74, 16, v90
v_and_b32 v75, 0xffff0000, v90
v_lshlrev_b32 v76, 16, v92
v_and_b32 v77, 0xffff0000, v92
v_lshlrev_b32 v78, 16, v94
v_and_b32 v79, 0xffff0000, v94
v_pk_add_f32 v[72:73], v[72:73], v[112:113]
v_pk_add_f32 v[74:75], v[74:75], v[114:115]
v_pk_add_f32 v[76:77], v[76:77], v[116:117]
v_pk_add_f32 v[78:79], v[78:79], v[118:119]
v_cvt_pk_bf16_f32 v88, v72, v73
v_cvt_pk_bf16_f32 v90, v74, v75
v_cvt_pk_bf16_f32 v92, v76, v77
v_cvt_pk_bf16_f32 v94, v78, v79
v_lshlrev_b32 v72, 16, v88
v_and_b32 v73, 0xffff0000, v88
v_lshlrev_b32 v74, 16, v90
v_and_b32 v75, 0xffff0000, v90
v_lshlrev_b32 v76, 16, v92
v_and_b32 v77, 0xffff0000, v92
v_lshlrev_b32 v78, 16, v94
v_and_b32 v79, 0xffff0000, v94
v_pk_mul_f32 v[88:89], v[72:73], v[72:73]
v_pk_mul_f32 v[90:91], v[74:75], v[74:75]
v_pk_mul_f32 v[92:93], v[76:77], v[76:77]
v_pk_mul_f32 v[94:95], v[78:79], v[78:79]
v_pk_fma_f32 v[88:89], v[88:89], s[34:35], v[60:61]
v_pk_fma_f32 v[90:91], v[90:91], s[34:35], v[60:61]
v_pk_fma_f32 v[92:93], v[92:93], s[34:35], v[60:61]
v_pk_fma_f32 v[94:95], v[94:95], s[34:35], v[60:61]
v_pk_mul_f32 v[88:89], v[88:89], v[72:73]
v_pk_mul_f32 v[90:91], v[90:91], v[74:75]
v_pk_mul_f32 v[92:93], v[92:93], v[76:77]
v_pk_mul_f32 v[94:95], v[94:95], v[78:79]
v_exp_f32 v88, v88
v_exp_f32 v89, v89
v_exp_f32 v90, v90
v_exp_f32 v91, v91
v_exp_f32 v92, v92
v_exp_f32 v93, v93
v_exp_f32 v94, v94
v_exp_f32 v95, v95
v_pk_add_f32 v[88:89], v[88:89], v[62:63]
v_pk_add_f32 v[90:91], v[90:91], v[62:63]
v_pk_add_f32 v[92:93], v[92:93], v[62:63]
v_pk_add_f32 v[94:95], v[94:95], v[62:63]
v_rcp_f32 v88, v88
v_rcp_f32 v89, v89
v_rcp_f32 v90, v90
v_rcp_f32 v91, v91
v_rcp_f32 v92, v92
v_rcp_f32 v93, v93
v_rcp_f32 v94, v94
v_rcp_f32 v95, v95
v_pk_mul_f32 v[72:73], v[72:73], v[88:89]
v_pk_mul_f32 v[74:75], v[74:75], v[90:91]
v_pk_mul_f32 v[76:77], v[76:77], v[92:93]
v_pk_mul_f32 v[78:79], v[78:79], v[94:95]
v_cvt_pk_bf16_f32 v84, v72, v73
v_cvt_pk_bf16_f32 v85, v74, v75
v_cvt_pk_bf16_f32 v86, v76, v77
v_cvt_pk_bf16_f32 v87, v78, v79
s_nop 0
v_permlane16_swap_b32 v84, v86
v_permlane16_swap_b32 v85, v87
global_store_dwordx4 v56, v[84:87], s[12:13] offset:1024 sc1
v_accvgpr_read_b32 v64, a72
v_accvgpr_read_b32 v65, a73
v_accvgpr_read_b32 v66, a74
v_accvgpr_read_b32 v67, a75
v_accvgpr_read_b32 v68, a104
v_accvgpr_read_b32 v69, a105
v_accvgpr_read_b32 v70, a106
v_accvgpr_read_b32 v71, a107
v_cvt_pk_bf16_f32 v88, v64, v65
v_cvt_pk_bf16_f32 v90, v66, v67
v_cvt_pk_bf16_f32 v92, v68, v69
v_cvt_pk_bf16_f32 v94, v70, v71
v_lshlrev_b32 v64, 16, v88
v_and_b32 v65, 0xffff0000, v88
v_lshlrev_b32 v66, 16, v90
v_and_b32 v67, 0xffff0000, v90
v_lshlrev_b32 v68, 16, v92
v_and_b32 v69, 0xffff0000, v92
v_lshlrev_b32 v70, 16, v94
v_and_b32 v71, 0xffff0000, v94
v_pk_add_f32 v[64:65], v[64:65], v[112:113]
v_pk_add_f32 v[66:67], v[66:67], v[114:115]
v_pk_add_f32 v[68:69], v[68:69], v[116:117]
v_pk_add_f32 v[70:71], v[70:71], v[118:119]
v_cvt_pk_bf16_f32 v88, v64, v65
v_cvt_pk_bf16_f32 v90, v66, v67
v_cvt_pk_bf16_f32 v92, v68, v69
v_cvt_pk_bf16_f32 v94, v70, v71
v_lshlrev_b32 v64, 16, v88
v_and_b32 v65, 0xffff0000, v88
v_lshlrev_b32 v66, 16, v90
v_and_b32 v67, 0xffff0000, v90
v_lshlrev_b32 v68, 16, v92
v_and_b32 v69, 0xffff0000, v92
v_lshlrev_b32 v70, 16, v94
v_and_b32 v71, 0xffff0000, v94
v_pk_mul_f32 v[88:89], v[64:65], v[64:65]
v_pk_mul_f32 v[90:91], v[66:67], v[66:67]
v_pk_mul_f32 v[92:93], v[68:69], v[68:69]
v_pk_mul_f32 v[94:95], v[70:71], v[70:71]
v_pk_fma_f32 v[88:89], v[88:89], s[34:35], v[60:61]
v_pk_fma_f32 v[90:91], v[90:91], s[34:35], v[60:61]
v_pk_fma_f32 v[92:93], v[92:93], s[34:35], v[60:61]
v_pk_fma_f32 v[94:95], v[94:95], s[34:35], v[60:61]
v_pk_mul_f32 v[88:89], v[88:89], v[64:65]
v_pk_mul_f32 v[90:91], v[90:91], v[66:67]
v_pk_mul_f32 v[92:93], v[92:93], v[68:69]
v_pk_mul_f32 v[94:95], v[94:95], v[70:71]
v_exp_f32 v88, v88
v_exp_f32 v89, v89
v_exp_f32 v90, v90
v_exp_f32 v91, v91
v_exp_f32 v92, v92
v_exp_f32 v93, v93
v_exp_f32 v94, v94
v_exp_f32 v95, v95
v_pk_add_f32 v[88:89], v[88:89], v[62:63]
v_pk_add_f32 v[90:91], v[90:91], v[62:63]
v_pk_add_f32 v[92:93], v[92:93], v[62:63]
v_pk_add_f32 v[94:95], v[94:95], v[62:63]
v_rcp_f32 v88, v88
v_rcp_f32 v89, v89
v_rcp_f32 v90, v90
v_rcp_f32 v91, v91
v_rcp_f32 v92, v92
v_rcp_f32 v93, v93
v_rcp_f32 v94, v94
v_rcp_f32 v95, v95
v_pk_mul_f32 v[64:65], v[64:65], v[88:89]
v_pk_mul_f32 v[66:67], v[66:67], v[90:91]
v_pk_mul_f32 v[68:69], v[68:69], v[92:93]
v_pk_mul_f32 v[70:71], v[70:71], v[94:95]
v_cvt_pk_bf16_f32 v80, v64, v65
v_cvt_pk_bf16_f32 v81, v66, v67
v_cvt_pk_bf16_f32 v82, v68, v69
v_cvt_pk_bf16_f32 v83, v70, v71
s_nop 0
v_permlane16_swap_b32 v80, v82
v_permlane16_swap_b32 v81, v83
global_store_dwordx4 v56, v[80:83], s[12:13] offset:2048 sc1
v_accvgpr_read_b32 v72, a76
v_accvgpr_read_b32 v73, a77
v_accvgpr_read_b32 v74, a78
v_accvgpr_read_b32 v75, a79
v_accvgpr_read_b32 v76, a108
v_accvgpr_read_b32 v77, a109
v_accvgpr_read_b32 v78, a110
v_accvgpr_read_b32 v79, a111
v_cvt_pk_bf16_f32 v88, v72, v73
v_cvt_pk_bf16_f32 v90, v74, v75
v_cvt_pk_bf16_f32 v92, v76, v77
v_cvt_pk_bf16_f32 v94, v78, v79
v_lshlrev_b32 v72, 16, v88
v_and_b32 v73, 0xffff0000, v88
v_lshlrev_b32 v74, 16, v90
v_and_b32 v75, 0xffff0000, v90
v_lshlrev_b32 v76, 16, v92
v_and_b32 v77, 0xffff0000, v92
v_lshlrev_b32 v78, 16, v94
v_and_b32 v79, 0xffff0000, v94
v_pk_add_f32 v[72:73], v[72:73], v[112:113]
v_pk_add_f32 v[74:75], v[74:75], v[114:115]
v_pk_add_f32 v[76:77], v[76:77], v[116:117]
v_pk_add_f32 v[78:79], v[78:79], v[118:119]
v_cvt_pk_bf16_f32 v88, v72, v73
v_cvt_pk_bf16_f32 v90, v74, v75
v_cvt_pk_bf16_f32 v92, v76, v77
v_cvt_pk_bf16_f32 v94, v78, v79
v_lshlrev_b32 v72, 16, v88
v_and_b32 v73, 0xffff0000, v88
v_lshlrev_b32 v74, 16, v90
v_and_b32 v75, 0xffff0000, v90
v_lshlrev_b32 v76, 16, v92
v_and_b32 v77, 0xffff0000, v92
v_lshlrev_b32 v78, 16, v94
v_and_b32 v79, 0xffff0000, v94
v_pk_mul_f32 v[88:89], v[72:73], v[72:73]
v_pk_mul_f32 v[90:91], v[74:75], v[74:75]
v_pk_mul_f32 v[92:93], v[76:77], v[76:77]
v_pk_mul_f32 v[94:95], v[78:79], v[78:79]
v_pk_fma_f32 v[88:89], v[88:89], s[34:35], v[60:61]
v_pk_fma_f32 v[90:91], v[90:91], s[34:35], v[60:61]
v_pk_fma_f32 v[92:93], v[92:93], s[34:35], v[60:61]
v_pk_fma_f32 v[94:95], v[94:95], s[34:35], v[60:61]
v_pk_mul_f32 v[88:89], v[88:89], v[72:73]
v_pk_mul_f32 v[90:91], v[90:91], v[74:75]
v_pk_mul_f32 v[92:93], v[92:93], v[76:77]
v_pk_mul_f32 v[94:95], v[94:95], v[78:79]
v_exp_f32 v88, v88
v_exp_f32 v89, v89
v_exp_f32 v90, v90
v_exp_f32 v91, v91
v_exp_f32 v92, v92
v_exp_f32 v93, v93
v_exp_f32 v94, v94
v_exp_f32 v95, v95
v_pk_add_f32 v[88:89], v[88:89], v[62:63]
v_pk_add_f32 v[90:91], v[90:91], v[62:63]
v_pk_add_f32 v[92:93], v[92:93], v[62:63]
v_pk_add_f32 v[94:95], v[94:95], v[62:63]
v_rcp_f32 v88, v88
v_rcp_f32 v89, v89
v_rcp_f32 v90, v90
v_rcp_f32 v91, v91
v_rcp_f32 v92, v92
v_rcp_f32 v93, v93
v_rcp_f32 v94, v94
v_rcp_f32 v95, v95
v_pk_mul_f32 v[72:73], v[72:73], v[88:89]
v_pk_mul_f32 v[74:75], v[74:75], v[90:91]
v_pk_mul_f32 v[76:77], v[76:77], v[92:93]
v_pk_mul_f32 v[78:79], v[78:79], v[94:95]
v_cvt_pk_bf16_f32 v84, v72, v73
v_cvt_pk_bf16_f32 v85, v74, v75
v_cvt_pk_bf16_f32 v86, v76, v77
v_cvt_pk_bf16_f32 v87, v78, v79
s_nop 0
v_permlane16_swap_b32 v84, v86
v_permlane16_swap_b32 v85, v87
global_store_dwordx4 v56, v[84:87], s[12:13] offset:3072 sc1
v_accvgpr_read_b32 v64, a80
v_accvgpr_read_b32 v65, a81
v_accvgpr_read_b32 v66, a82
v_accvgpr_read_b32 v67, a83
v_accvgpr_read_b32 v68, a112
v_accvgpr_read_b32 v69, a113
v_accvgpr_read_b32 v70, a114
v_accvgpr_read_b32 v71, a115
v_cvt_pk_bf16_f32 v88, v64, v65
v_cvt_pk_bf16_f32 v90, v66, v67
v_cvt_pk_bf16_f32 v92, v68, v69
v_cvt_pk_bf16_f32 v94, v70, v71
v_lshlrev_b32 v64, 16, v88
v_and_b32 v65, 0xffff0000, v88
v_lshlrev_b32 v66, 16, v90
v_and_b32 v67, 0xffff0000, v90
v_lshlrev_b32 v68, 16, v92
v_and_b32 v69, 0xffff0000, v92
v_lshlrev_b32 v70, 16, v94
v_and_b32 v71, 0xffff0000, v94
v_pk_add_f32 v[64:65], v[64:65], v[112:113]
v_pk_add_f32 v[66:67], v[66:67], v[114:115]
v_pk_add_f32 v[68:69], v[68:69], v[116:117]
v_pk_add_f32 v[70:71], v[70:71], v[118:119]
v_cvt_pk_bf16_f32 v88, v64, v65
v_cvt_pk_bf16_f32 v90, v66, v67
v_cvt_pk_bf16_f32 v92, v68, v69
v_cvt_pk_bf16_f32 v94, v70, v71
v_lshlrev_b32 v64, 16, v88
v_and_b32 v65, 0xffff0000, v88
v_lshlrev_b32 v66, 16, v90
v_and_b32 v67, 0xffff0000, v90
v_lshlrev_b32 v68, 16, v92
v_and_b32 v69, 0xffff0000, v92
v_lshlrev_b32 v70, 16, v94
v_and_b32 v71, 0xffff0000, v94
v_pk_mul_f32 v[88:89], v[64:65], v[64:65]
v_pk_mul_f32 v[90:91], v[66:67], v[66:67]
v_pk_mul_f32 v[92:93], v[68:69], v[68:69]
v_pk_mul_f32 v[94:95], v[70:71], v[70:71]
v_pk_fma_f32 v[88:89], v[88:89], s[34:35], v[60:61]
v_pk_fma_f32 v[90:91], v[90:91], s[34:35], v[60:61]
v_pk_fma_f32 v[92:93], v[92:93], s[34:35], v[60:61]
v_pk_fma_f32 v[94:95], v[94:95], s[34:35], v[60:61]
v_pk_mul_f32 v[88:89], v[88:89], v[64:65]
v_pk_mul_f32 v[90:91], v[90:91], v[66:67]
v_pk_mul_f32 v[92:93], v[92:93], v[68:69]
v_pk_mul_f32 v[94:95], v[94:95], v[70:71]
v_exp_f32 v88, v88
v_exp_f32 v89, v89
v_exp_f32 v90, v90
v_exp_f32 v91, v91
v_exp_f32 v92, v92
v_exp_f32 v93, v93
v_exp_f32 v94, v94
v_exp_f32 v95, v95
v_pk_add_f32 v[88:89], v[88:89], v[62:63]
v_pk_add_f32 v[90:91], v[90:91], v[62:63]
v_pk_add_f32 v[92:93], v[92:93], v[62:63]
v_pk_add_f32 v[94:95], v[94:95], v[62:63]
v_rcp_f32 v88, v88
v_rcp_f32 v89, v89
v_rcp_f32 v90, v90
v_rcp_f32 v91, v91
v_rcp_f32 v92, v92
v_rcp_f32 v93, v93
v_rcp_f32 v94, v94
v_rcp_f32 v95, v95
v_pk_mul_f32 v[64:65], v[64:65], v[88:89]
v_pk_mul_f32 v[66:67], v[66:67], v[90:91]
v_pk_mul_f32 v[68:69], v[68:69], v[92:93]
v_pk_mul_f32 v[70:71], v[70:71], v[94:95]
v_cvt_pk_bf16_f32 v80, v64, v65
v_cvt_pk_bf16_f32 v81, v66, v67
v_cvt_pk_bf16_f32 v82, v68, v69
v_cvt_pk_bf16_f32 v83, v70, v71
s_nop 0
v_permlane16_swap_b32 v80, v82
v_permlane16_swap_b32 v81, v83
global_store_dwordx4 v57, v[80:83], s[12:13] offset:0 sc1
v_accvgpr_read_b32 v72, a84
v_accvgpr_read_b32 v73, a85
v_accvgpr_read_b32 v74, a86
v_accvgpr_read_b32 v75, a87
v_accvgpr_read_b32 v76, a116
v_accvgpr_read_b32 v77, a117
v_accvgpr_read_b32 v78, a118
v_accvgpr_read_b32 v79, a119
v_cvt_pk_bf16_f32 v88, v72, v73
v_cvt_pk_bf16_f32 v90, v74, v75
v_cvt_pk_bf16_f32 v92, v76, v77
v_cvt_pk_bf16_f32 v94, v78, v79
v_lshlrev_b32 v72, 16, v88
v_and_b32 v73, 0xffff0000, v88
v_lshlrev_b32 v74, 16, v90
v_and_b32 v75, 0xffff0000, v90
v_lshlrev_b32 v76, 16, v92
v_and_b32 v77, 0xffff0000, v92
v_lshlrev_b32 v78, 16, v94
v_and_b32 v79, 0xffff0000, v94
v_pk_add_f32 v[72:73], v[72:73], v[112:113]
v_pk_add_f32 v[74:75], v[74:75], v[114:115]
v_pk_add_f32 v[76:77], v[76:77], v[116:117]
v_pk_add_f32 v[78:79], v[78:79], v[118:119]
v_cvt_pk_bf16_f32 v88, v72, v73
v_cvt_pk_bf16_f32 v90, v74, v75
v_cvt_pk_bf16_f32 v92, v76, v77
v_cvt_pk_bf16_f32 v94, v78, v79
v_lshlrev_b32 v72, 16, v88
v_and_b32 v73, 0xffff0000, v88
v_lshlrev_b32 v74, 16, v90
v_and_b32 v75, 0xffff0000, v90
v_lshlrev_b32 v76, 16, v92
v_and_b32 v77, 0xffff0000, v92
v_lshlrev_b32 v78, 16, v94
v_and_b32 v79, 0xffff0000, v94
v_pk_mul_f32 v[88:89], v[72:73], v[72:73]
v_pk_mul_f32 v[90:91], v[74:75], v[74:75]
v_pk_mul_f32 v[92:93], v[76:77], v[76:77]
v_pk_mul_f32 v[94:95], v[78:79], v[78:79]
v_pk_fma_f32 v[88:89], v[88:89], s[34:35], v[60:61]
v_pk_fma_f32 v[90:91], v[90:91], s[34:35], v[60:61]
v_pk_fma_f32 v[92:93], v[92:93], s[34:35], v[60:61]
v_pk_fma_f32 v[94:95], v[94:95], s[34:35], v[60:61]
v_pk_mul_f32 v[88:89], v[88:89], v[72:73]
v_pk_mul_f32 v[90:91], v[90:91], v[74:75]
v_pk_mul_f32 v[92:93], v[92:93], v[76:77]
v_pk_mul_f32 v[94:95], v[94:95], v[78:79]
v_exp_f32 v88, v88
v_exp_f32 v89, v89
v_exp_f32 v90, v90
v_exp_f32 v91, v91
v_exp_f32 v92, v92
v_exp_f32 v93, v93
v_exp_f32 v94, v94
v_exp_f32 v95, v95
v_pk_add_f32 v[88:89], v[88:89], v[62:63]
v_pk_add_f32 v[90:91], v[90:91], v[62:63]
v_pk_add_f32 v[92:93], v[92:93], v[62:63]
v_pk_add_f32 v[94:95], v[94:95], v[62:63]
v_rcp_f32 v88, v88
v_rcp_f32 v89, v89
v_rcp_f32 v90, v90
v_rcp_f32 v91, v91
v_rcp_f32 v92, v92
v_rcp_f32 v93, v93
v_rcp_f32 v94, v94
v_rcp_f32 v95, v95
v_pk_mul_f32 v[72:73], v[72:73], v[88:89]
v_pk_mul_f32 v[74:75], v[74:75], v[90:91]
v_pk_mul_f32 v[76:77], v[76:77], v[92:93]
v_pk_mul_f32 v[78:79], v[78:79], v[94:95]
v_cvt_pk_bf16_f32 v84, v72, v73
v_cvt_pk_bf16_f32 v85, v74, v75
v_cvt_pk_bf16_f32 v86, v76, v77
v_cvt_pk_bf16_f32 v87, v78, v79
s_nop 0
v_permlane16_swap_b32 v84, v86
v_permlane16_swap_b32 v85, v87
global_store_dwordx4 v57, v[84:87], s[12:13] offset:1024 sc1
v_accvgpr_read_b32 v64, a88
v_accvgpr_read_b32 v65, a89
v_accvgpr_read_b32 v66, a90
v_accvgpr_read_b32 v67, a91
v_accvgpr_read_b32 v68, a120
v_accvgpr_read_b32 v69, a121
v_accvgpr_read_b32 v70, a122
v_accvgpr_read_b32 v71, a123
v_cvt_pk_bf16_f32 v88, v64, v65
v_cvt_pk_bf16_f32 v90, v66, v67
v_cvt_pk_bf16_f32 v92, v68, v69
v_cvt_pk_bf16_f32 v94, v70, v71
v_lshlrev_b32 v64, 16, v88
v_and_b32 v65, 0xffff0000, v88
v_lshlrev_b32 v66, 16, v90
v_and_b32 v67, 0xffff0000, v90
v_lshlrev_b32 v68, 16, v92
v_and_b32 v69, 0xffff0000, v92
v_lshlrev_b32 v70, 16, v94
v_and_b32 v71, 0xffff0000, v94
v_pk_add_f32 v[64:65], v[64:65], v[112:113]
v_pk_add_f32 v[66:67], v[66:67], v[114:115]
v_pk_add_f32 v[68:69], v[68:69], v[116:117]
v_pk_add_f32 v[70:71], v[70:71], v[118:119]
v_cvt_pk_bf16_f32 v88, v64, v65
v_cvt_pk_bf16_f32 v90, v66, v67
v_cvt_pk_bf16_f32 v92, v68, v69
v_cvt_pk_bf16_f32 v94, v70, v71
v_lshlrev_b32 v64, 16, v88
v_and_b32 v65, 0xffff0000, v88
v_lshlrev_b32 v66, 16, v90
v_and_b32 v67, 0xffff0000, v90
v_lshlrev_b32 v68, 16, v92
v_and_b32 v69, 0xffff0000, v92
v_lshlrev_b32 v70, 16, v94
v_and_b32 v71, 0xffff0000, v94
v_pk_mul_f32 v[88:89], v[64:65], v[64:65]
v_pk_mul_f32 v[90:91], v[66:67], v[66:67]
v_pk_mul_f32 v[92:93], v[68:69], v[68:69]
v_pk_mul_f32 v[94:95], v[70:71], v[70:71]
v_pk_fma_f32 v[88:89], v[88:89], s[34:35], v[60:61]
v_pk_fma_f32 v[90:91], v[90:91], s[34:35], v[60:61]
v_pk_fma_f32 v[92:93], v[92:93], s[34:35], v[60:61]
v_pk_fma_f32 v[94:95], v[94:95], s[34:35], v[60:61]
v_pk_mul_f32 v[88:89], v[88:89], v[64:65]
v_pk_mul_f32 v[90:91], v[90:91], v[66:67]
v_pk_mul_f32 v[92:93], v[92:93], v[68:69]
v_pk_mul_f32 v[94:95], v[94:95], v[70:71]
v_exp_f32 v88, v88
v_exp_f32 v89, v89
v_exp_f32 v90, v90
v_exp_f32 v91, v91
v_exp_f32 v92, v92
v_exp_f32 v93, v93
v_exp_f32 v94, v94
v_exp_f32 v95, v95
v_pk_add_f32 v[88:89], v[88:89], v[62:63]
v_pk_add_f32 v[90:91], v[90:91], v[62:63]
v_pk_add_f32 v[92:93], v[92:93], v[62:63]
v_pk_add_f32 v[94:95], v[94:95], v[62:63]
v_rcp_f32 v88, v88
v_rcp_f32 v89, v89
v_rcp_f32 v90, v90
v_rcp_f32 v91, v91
v_rcp_f32 v92, v92
v_rcp_f32 v93, v93
v_rcp_f32 v94, v94
v_rcp_f32 v95, v95
v_pk_mul_f32 v[64:65], v[64:65], v[88:89]
v_pk_mul_f32 v[66:67], v[66:67], v[90:91]
v_pk_mul_f32 v[68:69], v[68:69], v[92:93]
v_pk_mul_f32 v[70:71], v[70:71], v[94:95]
v_cvt_pk_bf16_f32 v80, v64, v65
v_cvt_pk_bf16_f32 v81, v66, v67
v_cvt_pk_bf16_f32 v82, v68, v69
v_cvt_pk_bf16_f32 v83, v70, v71
s_nop 0
v_permlane16_swap_b32 v80, v82
v_permlane16_swap_b32 v81, v83
global_store_dwordx4 v57, v[80:83], s[12:13] offset:2048 sc1
v_accvgpr_read_b32 v72, a92
v_accvgpr_read_b32 v73, a93
v_accvgpr_read_b32 v74, a94
v_accvgpr_read_b32 v75, a95
v_accvgpr_read_b32 v76, a124
v_accvgpr_read_b32 v77, a125
v_accvgpr_read_b32 v78, a126
v_accvgpr_read_b32 v79, a127
v_cvt_pk_bf16_f32 v88, v72, v73
v_cvt_pk_bf16_f32 v90, v74, v75
v_cvt_pk_bf16_f32 v92, v76, v77
v_cvt_pk_bf16_f32 v94, v78, v79
v_lshlrev_b32 v72, 16, v88
v_and_b32 v73, 0xffff0000, v88
v_lshlrev_b32 v74, 16, v90
v_and_b32 v75, 0xffff0000, v90
v_lshlrev_b32 v76, 16, v92
v_and_b32 v77, 0xffff0000, v92
v_lshlrev_b32 v78, 16, v94
v_and_b32 v79, 0xffff0000, v94
v_pk_add_f32 v[72:73], v[72:73], v[112:113]
v_pk_add_f32 v[74:75], v[74:75], v[114:115]
v_pk_add_f32 v[76:77], v[76:77], v[116:117]
v_pk_add_f32 v[78:79], v[78:79], v[118:119]
v_cvt_pk_bf16_f32 v88, v72, v73
v_cvt_pk_bf16_f32 v90, v74, v75
v_cvt_pk_bf16_f32 v92, v76, v77
v_cvt_pk_bf16_f32 v94, v78, v79
v_lshlrev_b32 v72, 16, v88
v_and_b32 v73, 0xffff0000, v88
v_lshlrev_b32 v74, 16, v90
v_and_b32 v75, 0xffff0000, v90
v_lshlrev_b32 v76, 16, v92
v_and_b32 v77, 0xffff0000, v92
v_lshlrev_b32 v78, 16, v94
v_and_b32 v79, 0xffff0000, v94
v_pk_mul_f32 v[88:89], v[72:73], v[72:73]
v_pk_mul_f32 v[90:91], v[74:75], v[74:75]
v_pk_mul_f32 v[92:93], v[76:77], v[76:77]
v_pk_mul_f32 v[94:95], v[78:79], v[78:79]
v_pk_fma_f32 v[88:89], v[88:89], s[34:35], v[60:61]
v_pk_fma_f32 v[90:91], v[90:91], s[34:35], v[60:61]
v_pk_fma_f32 v[92:93], v[92:93], s[34:35], v[60:61]
v_pk_fma_f32 v[94:95], v[94:95], s[34:35], v[60:61]
v_pk_mul_f32 v[88:89], v[88:89], v[72:73]
v_pk_mul_f32 v[90:91], v[90:91], v[74:75]
v_pk_mul_f32 v[92:93], v[92:93], v[76:77]
v_pk_mul_f32 v[94:95], v[94:95], v[78:79]
v_exp_f32 v88, v88
v_exp_f32 v89, v89
v_exp_f32 v90, v90
v_exp_f32 v91, v91
v_exp_f32 v92, v92
v_exp_f32 v93, v93
v_exp_f32 v94, v94
v_exp_f32 v95, v95
v_pk_add_f32 v[88:89], v[88:89], v[62:63]
v_pk_add_f32 v[90:91], v[90:91], v[62:63]
v_pk_add_f32 v[92:93], v[92:93], v[62:63]
v_pk_add_f32 v[94:95], v[94:95], v[62:63]
v_rcp_f32 v88, v88
v_rcp_f32 v89, v89
v_rcp_f32 v90, v90
v_rcp_f32 v91, v91
v_rcp_f32 v92, v92
v_rcp_f32 v93, v93
v_rcp_f32 v94, v94
v_rcp_f32 v95, v95
v_pk_mul_f32 v[72:73], v[72:73], v[88:89]
v_pk_mul_f32 v[74:75], v[74:75], v[90:91]
v_pk_mul_f32 v[76:77], v[76:77], v[92:93]
v_pk_mul_f32 v[78:79], v[78:79], v[94:95]
v_cvt_pk_bf16_f32 v84, v72, v73
v_cvt_pk_bf16_f32 v85, v74, v75
v_cvt_pk_bf16_f32 v86, v76, v77
v_cvt_pk_bf16_f32 v87, v78, v79
s_nop 0
v_permlane16_swap_b32 v84, v86
v_permlane16_swap_b32 v85, v87
global_store_dwordx4 v57, v[84:87], s[12:13] offset:3072 sc1
s_add_u32 s12, s12, 65536
s_addc_u32 s13, s13, 0
v_accvgpr_read_b32 v64, a128
v_accvgpr_read_b32 v65, a129
v_accvgpr_read_b32 v66, a130
v_accvgpr_read_b32 v67, a131
v_accvgpr_read_b32 v68, a160
v_accvgpr_read_b32 v69, a161
v_accvgpr_read_b32 v70, a162
v_accvgpr_read_b32 v71, a163
v_cvt_pk_bf16_f32 v88, v64, v65
v_cvt_pk_bf16_f32 v90, v66, v67
v_cvt_pk_bf16_f32 v92, v68, v69
v_cvt_pk_bf16_f32 v94, v70, v71
v_lshlrev_b32 v64, 16, v88
v_and_b32 v65, 0xffff0000, v88
v_lshlrev_b32 v66, 16, v90
v_and_b32 v67, 0xffff0000, v90
v_lshlrev_b32 v68, 16, v92
v_and_b32 v69, 0xffff0000, v92
v_lshlrev_b32 v70, 16, v94
v_and_b32 v71, 0xffff0000, v94
v_pk_add_f32 v[64:65], v[64:65], v[120:121]
v_pk_add_f32 v[66:67], v[66:67], v[122:123]
v_pk_add_f32 v[68:69], v[68:69], v[124:125]
v_pk_add_f32 v[70:71], v[70:71], v[126:127]
v_cvt_pk_bf16_f32 v88, v64, v65
v_cvt_pk_bf16_f32 v90, v66, v67
v_cvt_pk_bf16_f32 v92, v68, v69
v_cvt_pk_bf16_f32 v94, v70, v71
v_lshlrev_b32 v64, 16, v88
v_and_b32 v65, 0xffff0000, v88
v_lshlrev_b32 v66, 16, v90
v_and_b32 v67, 0xffff0000, v90
v_lshlrev_b32 v68, 16, v92
v_and_b32 v69, 0xffff0000, v92
v_lshlrev_b32 v70, 16, v94
v_and_b32 v71, 0xffff0000, v94
v_pk_mul_f32 v[88:89], v[64:65], v[64:65]
v_pk_mul_f32 v[90:91], v[66:67], v[66:67]
v_pk_mul_f32 v[92:93], v[68:69], v[68:69]
v_pk_mul_f32 v[94:95], v[70:71], v[70:71]
v_pk_fma_f32 v[88:89], v[88:89], s[34:35], v[60:61]
v_pk_fma_f32 v[90:91], v[90:91], s[34:35], v[60:61]
v_pk_fma_f32 v[92:93], v[92:93], s[34:35], v[60:61]
v_pk_fma_f32 v[94:95], v[94:95], s[34:35], v[60:61]
v_pk_mul_f32 v[88:89], v[88:89], v[64:65]
v_pk_mul_f32 v[90:91], v[90:91], v[66:67]
v_pk_mul_f32 v[92:93], v[92:93], v[68:69]
v_pk_mul_f32 v[94:95], v[94:95], v[70:71]
v_exp_f32 v88, v88
v_exp_f32 v89, v89
v_exp_f32 v90, v90
v_exp_f32 v91, v91
v_exp_f32 v92, v92
v_exp_f32 v93, v93
v_exp_f32 v94, v94
v_exp_f32 v95, v95
v_pk_add_f32 v[88:89], v[88:89], v[62:63]
v_pk_add_f32 v[90:91], v[90:91], v[62:63]
v_pk_add_f32 v[92:93], v[92:93], v[62:63]
v_pk_add_f32 v[94:95], v[94:95], v[62:63]
v_rcp_f32 v88, v88
v_rcp_f32 v89, v89
v_rcp_f32 v90, v90
v_rcp_f32 v91, v91
v_rcp_f32 v92, v92
v_rcp_f32 v93, v93
v_rcp_f32 v94, v94
v_rcp_f32 v95, v95
v_pk_mul_f32 v[64:65], v[64:65], v[88:89]
v_pk_mul_f32 v[66:67], v[66:67], v[90:91]
v_pk_mul_f32 v[68:69], v[68:69], v[92:93]
v_pk_mul_f32 v[70:71], v[70:71], v[94:95]
v_cvt_pk_bf16_f32 v80, v64, v65
v_cvt_pk_bf16_f32 v81, v66, v67
v_cvt_pk_bf16_f32 v82, v68, v69
v_cvt_pk_bf16_f32 v83, v70, v71
s_nop 0
v_permlane16_swap_b32 v80, v82
v_permlane16_swap_b32 v81, v83
global_store_dwordx4 v56, v[80:83], s[12:13] offset:0 sc1
v_accvgpr_read_b32 v72, a132
v_accvgpr_read_b32 v73, a133
v_accvgpr_read_b32 v74, a134
v_accvgpr_read_b32 v75, a135
v_accvgpr_read_b32 v76, a164
v_accvgpr_read_b32 v77, a165
v_accvgpr_read_b32 v78, a166
v_accvgpr_read_b32 v79, a167
v_cvt_pk_bf16_f32 v88, v72, v73
v_cvt_pk_bf16_f32 v90, v74, v75
v_cvt_pk_bf16_f32 v92, v76, v77
v_cvt_pk_bf16_f32 v94, v78, v79
v_lshlrev_b32 v72, 16, v88
v_and_b32 v73, 0xffff0000, v88
v_lshlrev_b32 v74, 16, v90
v_and_b32 v75, 0xffff0000, v90
v_lshlrev_b32 v76, 16, v92
v_and_b32 v77, 0xffff0000, v92
v_lshlrev_b32 v78, 16, v94
v_and_b32 v79, 0xffff0000, v94
v_pk_add_f32 v[72:73], v[72:73], v[120:121]
v_pk_add_f32 v[74:75], v[74:75], v[122:123]
v_pk_add_f32 v[76:77], v[76:77], v[124:125]
v_pk_add_f32 v[78:79], v[78:79], v[126:127]
v_cvt_pk_bf16_f32 v88, v72, v73
v_cvt_pk_bf16_f32 v90, v74, v75
v_cvt_pk_bf16_f32 v92, v76, v77
v_cvt_pk_bf16_f32 v94, v78, v79
v_lshlrev_b32 v72, 16, v88
v_and_b32 v73, 0xffff0000, v88
v_lshlrev_b32 v74, 16, v90
v_and_b32 v75, 0xffff0000, v90
v_lshlrev_b32 v76, 16, v92
v_and_b32 v77, 0xffff0000, v92
v_lshlrev_b32 v78, 16, v94
v_and_b32 v79, 0xffff0000, v94
v_pk_mul_f32 v[88:89], v[72:73], v[72:73]
v_pk_mul_f32 v[90:91], v[74:75], v[74:75]
v_pk_mul_f32 v[92:93], v[76:77], v[76:77]
v_pk_mul_f32 v[94:95], v[78:79], v[78:79]
v_pk_fma_f32 v[88:89], v[88:89], s[34:35], v[60:61]
v_pk_fma_f32 v[90:91], v[90:91], s[34:35], v[60:61]
v_pk_fma_f32 v[92:93], v[92:93], s[34:35], v[60:61]
v_pk_fma_f32 v[94:95], v[94:95], s[34:35], v[60:61]
v_pk_mul_f32 v[88:89], v[88:89], v[72:73]
v_pk_mul_f32 v[90:91], v[90:91], v[74:75]
v_pk_mul_f32 v[92:93], v[92:93], v[76:77]
v_pk_mul_f32 v[94:95], v[94:95], v[78:79]
v_exp_f32 v88, v88
v_exp_f32 v89, v89
v_exp_f32 v90, v90
v_exp_f32 v91, v91
v_exp_f32 v92, v92
v_exp_f32 v93, v93
v_exp_f32 v94, v94
v_exp_f32 v95, v95
v_pk_add_f32 v[88:89], v[88:89], v[62:63]
v_pk_add_f32 v[90:91], v[90:91], v[62:63]
v_pk_add_f32 v[92:93], v[92:93], v[62:63]
v_pk_add_f32 v[94:95], v[94:95], v[62:63]
v_rcp_f32 v88, v88
v_rcp_f32 v89, v89
v_rcp_f32 v90, v90
v_rcp_f32 v91, v91
v_rcp_f32 v92, v92
v_rcp_f32 v93, v93
v_rcp_f32 v94, v94
v_rcp_f32 v95, v95
v_pk_mul_f32 v[72:73], v[72:73], v[88:89]
v_pk_mul_f32 v[74:75], v[74:75], v[90:91]
v_pk_mul_f32 v[76:77], v[76:77], v[92:93]
v_pk_mul_f32 v[78:79], v[78:79], v[94:95]
v_cvt_pk_bf16_f32 v84, v72, v73
v_cvt_pk_bf16_f32 v85, v74, v75
v_cvt_pk_bf16_f32 v86, v76, v77
v_cvt_pk_bf16_f32 v87, v78, v79
s_nop 0
v_permlane16_swap_b32 v84, v86
v_permlane16_swap_b32 v85, v87
global_store_dwordx4 v56, v[84:87], s[12:13] offset:1024 sc1
v_accvgpr_read_b32 v64, a136
v_accvgpr_read_b32 v65, a137
v_accvgpr_read_b32 v66, a138
v_accvgpr_read_b32 v67, a139
v_accvgpr_read_b32 v68, a168
v_accvgpr_read_b32 v69, a169
v_accvgpr_read_b32 v70, a170
v_accvgpr_read_b32 v71, a171
v_cvt_pk_bf16_f32 v88, v64, v65
v_cvt_pk_bf16_f32 v90, v66, v67
v_cvt_pk_bf16_f32 v92, v68, v69
v_cvt_pk_bf16_f32 v94, v70, v71
v_lshlrev_b32 v64, 16, v88
v_and_b32 v65, 0xffff0000, v88
v_lshlrev_b32 v66, 16, v90
v_and_b32 v67, 0xffff0000, v90
v_lshlrev_b32 v68, 16, v92
v_and_b32 v69, 0xffff0000, v92
v_lshlrev_b32 v70, 16, v94
v_and_b32 v71, 0xffff0000, v94
v_pk_add_f32 v[64:65], v[64:65], v[120:121]
v_pk_add_f32 v[66:67], v[66:67], v[122:123]
v_pk_add_f32 v[68:69], v[68:69], v[124:125]
v_pk_add_f32 v[70:71], v[70:71], v[126:127]
v_cvt_pk_bf16_f32 v88, v64, v65
v_cvt_pk_bf16_f32 v90, v66, v67
v_cvt_pk_bf16_f32 v92, v68, v69
v_cvt_pk_bf16_f32 v94, v70, v71
v_lshlrev_b32 v64, 16, v88
v_and_b32 v65, 0xffff0000, v88
v_lshlrev_b32 v66, 16, v90
v_and_b32 v67, 0xffff0000, v90
v_lshlrev_b32 v68, 16, v92
v_and_b32 v69, 0xffff0000, v92
v_lshlrev_b32 v70, 16, v94
v_and_b32 v71, 0xffff0000, v94
v_pk_mul_f32 v[88:89], v[64:65], v[64:65]
v_pk_mul_f32 v[90:91], v[66:67], v[66:67]
v_pk_mul_f32 v[92:93], v[68:69], v[68:69]
v_pk_mul_f32 v[94:95], v[70:71], v[70:71]
v_pk_fma_f32 v[88:89], v[88:89], s[34:35], v[60:61]
v_pk_fma_f32 v[90:91], v[90:91], s[34:35], v[60:61]
v_pk_fma_f32 v[92:93], v[92:93], s[34:35], v[60:61]
v_pk_fma_f32 v[94:95], v[94:95], s[34:35], v[60:61]
v_pk_mul_f32 v[88:89], v[88:89], v[64:65]
v_pk_mul_f32 v[90:91], v[90:91], v[66:67]
v_pk_mul_f32 v[92:93], v[92:93], v[68:69]
v_pk_mul_f32 v[94:95], v[94:95], v[70:71]
v_exp_f32 v88, v88
v_exp_f32 v89, v89
v_exp_f32 v90, v90
v_exp_f32 v91, v91
v_exp_f32 v92, v92
v_exp_f32 v93, v93
v_exp_f32 v94, v94
v_exp_f32 v95, v95
v_pk_add_f32 v[88:89], v[88:89], v[62:63]
v_pk_add_f32 v[90:91], v[90:91], v[62:63]
v_pk_add_f32 v[92:93], v[92:93], v[62:63]
v_pk_add_f32 v[94:95], v[94:95], v[62:63]
v_rcp_f32 v88, v88
v_rcp_f32 v89, v89
v_rcp_f32 v90, v90
v_rcp_f32 v91, v91
v_rcp_f32 v92, v92
v_rcp_f32 v93, v93
v_rcp_f32 v94, v94
v_rcp_f32 v95, v95
v_pk_mul_f32 v[64:65], v[64:65], v[88:89]
v_pk_mul_f32 v[66:67], v[66:67], v[90:91]
v_pk_mul_f32 v[68:69], v[68:69], v[92:93]
v_pk_mul_f32 v[70:71], v[70:71], v[94:95]
v_cvt_pk_bf16_f32 v80, v64, v65
v_cvt_pk_bf16_f32 v81, v66, v67
v_cvt_pk_bf16_f32 v82, v68, v69
v_cvt_pk_bf16_f32 v83, v70, v71
s_nop 0
v_permlane16_swap_b32 v80, v82
v_permlane16_swap_b32 v81, v83
global_store_dwordx4 v56, v[80:83], s[12:13] offset:2048 sc1
v_accvgpr_read_b32 v72, a140
v_accvgpr_read_b32 v73, a141
v_accvgpr_read_b32 v74, a142
v_accvgpr_read_b32 v75, a143
v_accvgpr_read_b32 v76, a172
v_accvgpr_read_b32 v77, a173
v_accvgpr_read_b32 v78, a174
v_accvgpr_read_b32 v79, a175
v_cvt_pk_bf16_f32 v88, v72, v73
v_cvt_pk_bf16_f32 v90, v74, v75
v_cvt_pk_bf16_f32 v92, v76, v77
v_cvt_pk_bf16_f32 v94, v78, v79
v_lshlrev_b32 v72, 16, v88
v_and_b32 v73, 0xffff0000, v88
v_lshlrev_b32 v74, 16, v90
v_and_b32 v75, 0xffff0000, v90
v_lshlrev_b32 v76, 16, v92
v_and_b32 v77, 0xffff0000, v92
v_lshlrev_b32 v78, 16, v94
v_and_b32 v79, 0xffff0000, v94
v_pk_add_f32 v[72:73], v[72:73], v[120:121]
v_pk_add_f32 v[74:75], v[74:75], v[122:123]
v_pk_add_f32 v[76:77], v[76:77], v[124:125]
v_pk_add_f32 v[78:79], v[78:79], v[126:127]
v_cvt_pk_bf16_f32 v88, v72, v73
v_cvt_pk_bf16_f32 v90, v74, v75
v_cvt_pk_bf16_f32 v92, v76, v77
v_cvt_pk_bf16_f32 v94, v78, v79
v_lshlrev_b32 v72, 16, v88
v_and_b32 v73, 0xffff0000, v88
v_lshlrev_b32 v74, 16, v90
v_and_b32 v75, 0xffff0000, v90
v_lshlrev_b32 v76, 16, v92
v_and_b32 v77, 0xffff0000, v92
v_lshlrev_b32 v78, 16, v94
v_and_b32 v79, 0xffff0000, v94
v_pk_mul_f32 v[88:89], v[72:73], v[72:73]
v_pk_mul_f32 v[90:91], v[74:75], v[74:75]
v_pk_mul_f32 v[92:93], v[76:77], v[76:77]
v_pk_mul_f32 v[94:95], v[78:79], v[78:79]
v_pk_fma_f32 v[88:89], v[88:89], s[34:35], v[60:61]
v_pk_fma_f32 v[90:91], v[90:91], s[34:35], v[60:61]
v_pk_fma_f32 v[92:93], v[92:93], s[34:35], v[60:61]
v_pk_fma_f32 v[94:95], v[94:95], s[34:35], v[60:61]
v_pk_mul_f32 v[88:89], v[88:89], v[72:73]
v_pk_mul_f32 v[90:91], v[90:91], v[74:75]
v_pk_mul_f32 v[92:93], v[92:93], v[76:77]
v_pk_mul_f32 v[94:95], v[94:95], v[78:79]
v_exp_f32 v88, v88
v_exp_f32 v89, v89
v_exp_f32 v90, v90
v_exp_f32 v91, v91
v_exp_f32 v92, v92
v_exp_f32 v93, v93
v_exp_f32 v94, v94
v_exp_f32 v95, v95
v_pk_add_f32 v[88:89], v[88:89], v[62:63]
v_pk_add_f32 v[90:91], v[90:91], v[62:63]
v_pk_add_f32 v[92:93], v[92:93], v[62:63]
v_pk_add_f32 v[94:95], v[94:95], v[62:63]
v_rcp_f32 v88, v88
v_rcp_f32 v89, v89
v_rcp_f32 v90, v90
v_rcp_f32 v91, v91
v_rcp_f32 v92, v92
v_rcp_f32 v93, v93
v_rcp_f32 v94, v94
v_rcp_f32 v95, v95
v_pk_mul_f32 v[72:73], v[72:73], v[88:89]
v_pk_mul_f32 v[74:75], v[74:75], v[90:91]
v_pk_mul_f32 v[76:77], v[76:77], v[92:93]
v_pk_mul_f32 v[78:79], v[78:79], v[94:95]
v_cvt_pk_bf16_f32 v84, v72, v73
v_cvt_pk_bf16_f32 v85, v74, v75
v_cvt_pk_bf16_f32 v86, v76, v77
v_cvt_pk_bf16_f32 v87, v78, v79
s_nop 0
v_permlane16_swap_b32 v84, v86
v_permlane16_swap_b32 v85, v87
global_store_dwordx4 v56, v[84:87], s[12:13] offset:3072 sc1
v_accvgpr_read_b32 v64, a144
v_accvgpr_read_b32 v65, a145
v_accvgpr_read_b32 v66, a146
v_accvgpr_read_b32 v67, a147
v_accvgpr_read_b32 v68, a176
v_accvgpr_read_b32 v69, a177
v_accvgpr_read_b32 v70, a178
v_accvgpr_read_b32 v71, a179
v_cvt_pk_bf16_f32 v88, v64, v65
v_cvt_pk_bf16_f32 v90, v66, v67
v_cvt_pk_bf16_f32 v92, v68, v69
v_cvt_pk_bf16_f32 v94, v70, v71
v_lshlrev_b32 v64, 16, v88
v_and_b32 v65, 0xffff0000, v88
v_lshlrev_b32 v66, 16, v90
v_and_b32 v67, 0xffff0000, v90
v_lshlrev_b32 v68, 16, v92
v_and_b32 v69, 0xffff0000, v92
v_lshlrev_b32 v70, 16, v94
v_and_b32 v71, 0xffff0000, v94
v_pk_add_f32 v[64:65], v[64:65], v[120:121]
v_pk_add_f32 v[66:67], v[66:67], v[122:123]
v_pk_add_f32 v[68:69], v[68:69], v[124:125]
v_pk_add_f32 v[70:71], v[70:71], v[126:127]
v_cvt_pk_bf16_f32 v88, v64, v65
v_cvt_pk_bf16_f32 v90, v66, v67
v_cvt_pk_bf16_f32 v92, v68, v69
v_cvt_pk_bf16_f32 v94, v70, v71
v_lshlrev_b32 v64, 16, v88
v_and_b32 v65, 0xffff0000, v88
v_lshlrev_b32 v66, 16, v90
v_and_b32 v67, 0xffff0000, v90
v_lshlrev_b32 v68, 16, v92
v_and_b32 v69, 0xffff0000, v92
v_lshlrev_b32 v70, 16, v94
v_and_b32 v71, 0xffff0000, v94
v_pk_mul_f32 v[88:89], v[64:65], v[64:65]
v_pk_mul_f32 v[90:91], v[66:67], v[66:67]
v_pk_mul_f32 v[92:93], v[68:69], v[68:69]
v_pk_mul_f32 v[94:95], v[70:71], v[70:71]
v_pk_fma_f32 v[88:89], v[88:89], s[34:35], v[60:61]
v_pk_fma_f32 v[90:91], v[90:91], s[34:35], v[60:61]
v_pk_fma_f32 v[92:93], v[92:93], s[34:35], v[60:61]
v_pk_fma_f32 v[94:95], v[94:95], s[34:35], v[60:61]
v_pk_mul_f32 v[88:89], v[88:89], v[64:65]
v_pk_mul_f32 v[90:91], v[90:91], v[66:67]
v_pk_mul_f32 v[92:93], v[92:93], v[68:69]
v_pk_mul_f32 v[94:95], v[94:95], v[70:71]
v_exp_f32 v88, v88
v_exp_f32 v89, v89
v_exp_f32 v90, v90
v_exp_f32 v91, v91
v_exp_f32 v92, v92
v_exp_f32 v93, v93
v_exp_f32 v94, v94
v_exp_f32 v95, v95
v_pk_add_f32 v[88:89], v[88:89], v[62:63]
v_pk_add_f32 v[90:91], v[90:91], v[62:63]
v_pk_add_f32 v[92:93], v[92:93], v[62:63]
v_pk_add_f32 v[94:95], v[94:95], v[62:63]
v_rcp_f32 v88, v88
v_rcp_f32 v89, v89
v_rcp_f32 v90, v90
v_rcp_f32 v91, v91
v_rcp_f32 v92, v92
v_rcp_f32 v93, v93
v_rcp_f32 v94, v94
v_rcp_f32 v95, v95
v_pk_mul_f32 v[64:65], v[64:65], v[88:89]
v_pk_mul_f32 v[66:67], v[66:67], v[90:91]
v_pk_mul_f32 v[68:69], v[68:69], v[92:93]
v_pk_mul_f32 v[70:71], v[70:71], v[94:95]
v_cvt_pk_bf16_f32 v80, v64, v65
v_cvt_pk_bf16_f32 v81, v66, v67
v_cvt_pk_bf16_f32 v82, v68, v69
v_cvt_pk_bf16_f32 v83, v70, v71
s_nop 0
v_permlane16_swap_b32 v80, v82
v_permlane16_swap_b32 v81, v83
global_store_dwordx4 v57, v[80:83], s[12:13] offset:0 sc1
v_accvgpr_read_b32 v72, a148
v_accvgpr_read_b32 v73, a149
v_accvgpr_read_b32 v74, a150
v_accvgpr_read_b32 v75, a151
v_accvgpr_read_b32 v76, a180
v_accvgpr_read_b32 v77, a181
v_accvgpr_read_b32 v78, a182
v_accvgpr_read_b32 v79, a183
v_cvt_pk_bf16_f32 v88, v72, v73
v_cvt_pk_bf16_f32 v90, v74, v75
v_cvt_pk_bf16_f32 v92, v76, v77
v_cvt_pk_bf16_f32 v94, v78, v79
v_lshlrev_b32 v72, 16, v88
v_and_b32 v73, 0xffff0000, v88
v_lshlrev_b32 v74, 16, v90
v_and_b32 v75, 0xffff0000, v90
v_lshlrev_b32 v76, 16, v92
v_and_b32 v77, 0xffff0000, v92
v_lshlrev_b32 v78, 16, v94
v_and_b32 v79, 0xffff0000, v94
v_pk_add_f32 v[72:73], v[72:73], v[120:121]
v_pk_add_f32 v[74:75], v[74:75], v[122:123]
v_pk_add_f32 v[76:77], v[76:77], v[124:125]
v_pk_add_f32 v[78:79], v[78:79], v[126:127]
v_cvt_pk_bf16_f32 v88, v72, v73
v_cvt_pk_bf16_f32 v90, v74, v75
v_cvt_pk_bf16_f32 v92, v76, v77
v_cvt_pk_bf16_f32 v94, v78, v79
v_lshlrev_b32 v72, 16, v88
v_and_b32 v73, 0xffff0000, v88
v_lshlrev_b32 v74, 16, v90
v_and_b32 v75, 0xffff0000, v90
v_lshlrev_b32 v76, 16, v92
v_and_b32 v77, 0xffff0000, v92
v_lshlrev_b32 v78, 16, v94
v_and_b32 v79, 0xffff0000, v94
v_pk_mul_f32 v[88:89], v[72:73], v[72:73]
v_pk_mul_f32 v[90:91], v[74:75], v[74:75]
v_pk_mul_f32 v[92:93], v[76:77], v[76:77]
v_pk_mul_f32 v[94:95], v[78:79], v[78:79]
v_pk_fma_f32 v[88:89], v[88:89], s[34:35], v[60:61]
v_pk_fma_f32 v[90:91], v[90:91], s[34:35], v[60:61]
v_pk_fma_f32 v[92:93], v[92:93], s[34:35], v[60:61]
v_pk_fma_f32 v[94:95], v[94:95], s[34:35], v[60:61]
v_pk_mul_f32 v[88:89], v[88:89], v[72:73]
v_pk_mul_f32 v[90:91], v[90:91], v[74:75]
v_pk_mul_f32 v[92:93], v[92:93], v[76:77]
v_pk_mul_f32 v[94:95], v[94:95], v[78:79]
v_exp_f32 v88, v88
v_exp_f32 v89, v89
v_exp_f32 v90, v90
v_exp_f32 v91, v91
v_exp_f32 v92, v92
v_exp_f32 v93, v93
v_exp_f32 v94, v94
v_exp_f32 v95, v95
v_pk_add_f32 v[88:89], v[88:89], v[62:63]
v_pk_add_f32 v[90:91], v[90:91], v[62:63]
v_pk_add_f32 v[92:93], v[92:93], v[62:63]
v_pk_add_f32 v[94:95], v[94:95], v[62:63]
v_rcp_f32 v88, v88
v_rcp_f32 v89, v89
v_rcp_f32 v90, v90
v_rcp_f32 v91, v91
v_rcp_f32 v92, v92
v_rcp_f32 v93, v93
v_rcp_f32 v94, v94
v_rcp_f32 v95, v95
v_pk_mul_f32 v[72:73], v[72:73], v[88:89]
v_pk_mul_f32 v[74:75], v[74:75], v[90:91]
v_pk_mul_f32 v[76:77], v[76:77], v[92:93]
v_pk_mul_f32 v[78:79], v[78:79], v[94:95]
v_cvt_pk_bf16_f32 v84, v72, v73
v_cvt_pk_bf16_f32 v85, v74, v75
v_cvt_pk_bf16_f32 v86, v76, v77
v_cvt_pk_bf16_f32 v87, v78, v79
s_nop 0
v_permlane16_swap_b32 v84, v86
v_permlane16_swap_b32 v85, v87
global_store_dwordx4 v57, v[84:87], s[12:13] offset:1024 sc1
v_accvgpr_read_b32 v64, a152
v_accvgpr_read_b32 v65, a153
v_accvgpr_read_b32 v66, a154
v_accvgpr_read_b32 v67, a155
v_accvgpr_read_b32 v68, a184
v_accvgpr_read_b32 v69, a185
v_accvgpr_read_b32 v70, a186
v_accvgpr_read_b32 v71, a187
v_cvt_pk_bf16_f32 v88, v64, v65
v_cvt_pk_bf16_f32 v90, v66, v67
v_cvt_pk_bf16_f32 v92, v68, v69
v_cvt_pk_bf16_f32 v94, v70, v71
v_lshlrev_b32 v64, 16, v88
v_and_b32 v65, 0xffff0000, v88
v_lshlrev_b32 v66, 16, v90
v_and_b32 v67, 0xffff0000, v90
v_lshlrev_b32 v68, 16, v92
v_and_b32 v69, 0xffff0000, v92
v_lshlrev_b32 v70, 16, v94
v_and_b32 v71, 0xffff0000, v94
v_pk_add_f32 v[64:65], v[64:65], v[120:121]
v_pk_add_f32 v[66:67], v[66:67], v[122:123]
v_pk_add_f32 v[68:69], v[68:69], v[124:125]
v_pk_add_f32 v[70:71], v[70:71], v[126:127]
v_cvt_pk_bf16_f32 v88, v64, v65
v_cvt_pk_bf16_f32 v90, v66, v67
v_cvt_pk_bf16_f32 v92, v68, v69
v_cvt_pk_bf16_f32 v94, v70, v71
v_lshlrev_b32 v64, 16, v88
v_and_b32 v65, 0xffff0000, v88
v_lshlrev_b32 v66, 16, v90
v_and_b32 v67, 0xffff0000, v90
v_lshlrev_b32 v68, 16, v92
v_and_b32 v69, 0xffff0000, v92
v_lshlrev_b32 v70, 16, v94
v_and_b32 v71, 0xffff0000, v94
v_pk_mul_f32 v[88:89], v[64:65], v[64:65]
v_pk_mul_f32 v[90:91], v[66:67], v[66:67]
v_pk_mul_f32 v[92:93], v[68:69], v[68:69]
v_pk_mul_f32 v[94:95], v[70:71], v[70:71]
v_pk_fma_f32 v[88:89], v[88:89], s[34:35], v[60:61]
v_pk_fma_f32 v[90:91], v[90:91], s[34:35], v[60:61]
v_pk_fma_f32 v[92:93], v[92:93], s[34:35], v[60:61]
v_pk_fma_f32 v[94:95], v[94:95], s[34:35], v[60:61]
v_pk_mul_f32 v[88:89], v[88:89], v[64:65]
v_pk_mul_f32 v[90:91], v[90:91], v[66:67]
v_pk_mul_f32 v[92:93], v[92:93], v[68:69]
v_pk_mul_f32 v[94:95], v[94:95], v[70:71]
v_exp_f32 v88, v88
v_exp_f32 v89, v89
v_exp_f32 v90, v90
v_exp_f32 v91, v91
v_exp_f32 v92, v92
v_exp_f32 v93, v93
v_exp_f32 v94, v94
v_exp_f32 v95, v95
v_pk_add_f32 v[88:89], v[88:89], v[62:63]
v_pk_add_f32 v[90:91], v[90:91], v[62:63]
v_pk_add_f32 v[92:93], v[92:93], v[62:63]
v_pk_add_f32 v[94:95], v[94:95], v[62:63]
v_rcp_f32 v88, v88
v_rcp_f32 v89, v89
v_rcp_f32 v90, v90
v_rcp_f32 v91, v91
v_rcp_f32 v92, v92
v_rcp_f32 v93, v93
v_rcp_f32 v94, v94
v_rcp_f32 v95, v95
v_pk_mul_f32 v[64:65], v[64:65], v[88:89]
v_pk_mul_f32 v[66:67], v[66:67], v[90:91]
v_pk_mul_f32 v[68:69], v[68:69], v[92:93]
v_pk_mul_f32 v[70:71], v[70:71], v[94:95]
v_cvt_pk_bf16_f32 v80, v64, v65
v_cvt_pk_bf16_f32 v81, v66, v67
v_cvt_pk_bf16_f32 v82, v68, v69
v_cvt_pk_bf16_f32 v83, v70, v71
s_nop 0
v_permlane16_swap_b32 v80, v82
v_permlane16_swap_b32 v81, v83
global_store_dwordx4 v57, v[80:83], s[12:13] offset:2048 sc1
v_accvgpr_read_b32 v72, a156
v_accvgpr_read_b32 v73, a157
v_accvgpr_read_b32 v74, a158
v_accvgpr_read_b32 v75, a159
v_accvgpr_read_b32 v76, a188
v_accvgpr_read_b32 v77, a189
v_accvgpr_read_b32 v78, a190
v_accvgpr_read_b32 v79, a191
v_cvt_pk_bf16_f32 v88, v72, v73
v_cvt_pk_bf16_f32 v90, v74, v75
v_cvt_pk_bf16_f32 v92, v76, v77
v_cvt_pk_bf16_f32 v94, v78, v79
v_lshlrev_b32 v72, 16, v88
v_and_b32 v73, 0xffff0000, v88
v_lshlrev_b32 v74, 16, v90
v_and_b32 v75, 0xffff0000, v90
v_lshlrev_b32 v76, 16, v92
v_and_b32 v77, 0xffff0000, v92
v_lshlrev_b32 v78, 16, v94
v_and_b32 v79, 0xffff0000, v94
v_pk_add_f32 v[72:73], v[72:73], v[120:121]
v_pk_add_f32 v[74:75], v[74:75], v[122:123]
v_pk_add_f32 v[76:77], v[76:77], v[124:125]
v_pk_add_f32 v[78:79], v[78:79], v[126:127]
v_cvt_pk_bf16_f32 v88, v72, v73
v_cvt_pk_bf16_f32 v90, v74, v75
v_cvt_pk_bf16_f32 v92, v76, v77
v_cvt_pk_bf16_f32 v94, v78, v79
v_lshlrev_b32 v72, 16, v88
v_and_b32 v73, 0xffff0000, v88
v_lshlrev_b32 v74, 16, v90
v_and_b32 v75, 0xffff0000, v90
v_lshlrev_b32 v76, 16, v92
v_and_b32 v77, 0xffff0000, v92
v_lshlrev_b32 v78, 16, v94
v_and_b32 v79, 0xffff0000, v94
v_pk_mul_f32 v[88:89], v[72:73], v[72:73]
v_pk_mul_f32 v[90:91], v[74:75], v[74:75]
v_pk_mul_f32 v[92:93], v[76:77], v[76:77]
v_pk_mul_f32 v[94:95], v[78:79], v[78:79]
v_pk_fma_f32 v[88:89], v[88:89], s[34:35], v[60:61]
v_pk_fma_f32 v[90:91], v[90:91], s[34:35], v[60:61]
v_pk_fma_f32 v[92:93], v[92:93], s[34:35], v[60:61]
v_pk_fma_f32 v[94:95], v[94:95], s[34:35], v[60:61]
v_pk_mul_f32 v[88:89], v[88:89], v[72:73]
v_pk_mul_f32 v[90:91], v[90:91], v[74:75]
v_pk_mul_f32 v[92:93], v[92:93], v[76:77]
v_pk_mul_f32 v[94:95], v[94:95], v[78:79]
v_exp_f32 v88, v88
v_exp_f32 v89, v89
v_exp_f32 v90, v90
v_exp_f32 v91, v91
v_exp_f32 v92, v92
v_exp_f32 v93, v93
v_exp_f32 v94, v94
v_exp_f32 v95, v95
v_pk_add_f32 v[88:89], v[88:89], v[62:63]
v_pk_add_f32 v[90:91], v[90:91], v[62:63]
v_pk_add_f32 v[92:93], v[92:93], v[62:63]
v_pk_add_f32 v[94:95], v[94:95], v[62:63]
v_rcp_f32 v88, v88
v_rcp_f32 v89, v89
v_rcp_f32 v90, v90
v_rcp_f32 v91, v91
v_rcp_f32 v92, v92
v_rcp_f32 v93, v93
v_rcp_f32 v94, v94
v_rcp_f32 v95, v95
v_pk_mul_f32 v[72:73], v[72:73], v[88:89]
v_pk_mul_f32 v[74:75], v[74:75], v[90:91]
v_pk_mul_f32 v[76:77], v[76:77], v[92:93]
v_pk_mul_f32 v[78:79], v[78:79], v[94:95]
v_cvt_pk_bf16_f32 v84, v72, v73
v_cvt_pk_bf16_f32 v85, v74, v75
v_cvt_pk_bf16_f32 v86, v76, v77
v_cvt_pk_bf16_f32 v87, v78, v79
s_nop 0
v_permlane16_swap_b32 v84, v86
v_permlane16_swap_b32 v85, v87
global_store_dwordx4 v57, v[84:87], s[12:13] offset:3072 sc1
s_add_u32 s12, s12, 65536
s_addc_u32 s13, s13, 0
v_accvgpr_read_b32 v64, a192
v_accvgpr_read_b32 v65, a193
v_accvgpr_read_b32 v66, a194
v_accvgpr_read_b32 v67, a195
v_accvgpr_read_b32 v68, a224
v_accvgpr_read_b32 v69, a225
v_accvgpr_read_b32 v70, a226
v_accvgpr_read_b32 v71, a227
v_cvt_pk_bf16_f32 v88, v64, v65
v_cvt_pk_bf16_f32 v90, v66, v67
v_cvt_pk_bf16_f32 v92, v68, v69
v_cvt_pk_bf16_f32 v94, v70, v71
v_lshlrev_b32 v64, 16, v88
v_and_b32 v65, 0xffff0000, v88
v_lshlrev_b32 v66, 16, v90
v_and_b32 v67, 0xffff0000, v90
v_lshlrev_b32 v68, 16, v92
v_and_b32 v69, 0xffff0000, v92
v_lshlrev_b32 v70, 16, v94
v_and_b32 v71, 0xffff0000, v94
v_pk_add_f32 v[64:65], v[64:65], v[128:129]
v_pk_add_f32 v[66:67], v[66:67], v[130:131]
v_pk_add_f32 v[68:69], v[68:69], v[132:133]
v_pk_add_f32 v[70:71], v[70:71], v[134:135]
v_cvt_pk_bf16_f32 v88, v64, v65
v_cvt_pk_bf16_f32 v90, v66, v67
v_cvt_pk_bf16_f32 v92, v68, v69
v_cvt_pk_bf16_f32 v94, v70, v71
v_lshlrev_b32 v64, 16, v88
v_and_b32 v65, 0xffff0000, v88
v_lshlrev_b32 v66, 16, v90
v_and_b32 v67, 0xffff0000, v90
v_lshlrev_b32 v68, 16, v92
v_and_b32 v69, 0xffff0000, v92
v_lshlrev_b32 v70, 16, v94
v_and_b32 v71, 0xffff0000, v94
v_pk_mul_f32 v[88:89], v[64:65], v[64:65]
v_pk_mul_f32 v[90:91], v[66:67], v[66:67]
v_pk_mul_f32 v[92:93], v[68:69], v[68:69]
v_pk_mul_f32 v[94:95], v[70:71], v[70:71]
v_pk_fma_f32 v[88:89], v[88:89], s[34:35], v[60:61]
v_pk_fma_f32 v[90:91], v[90:91], s[34:35], v[60:61]
v_pk_fma_f32 v[92:93], v[92:93], s[34:35], v[60:61]
v_pk_fma_f32 v[94:95], v[94:95], s[34:35], v[60:61]
v_pk_mul_f32 v[88:89], v[88:89], v[64:65]
v_pk_mul_f32 v[90:91], v[90:91], v[66:67]
v_pk_mul_f32 v[92:93], v[92:93], v[68:69]
v_pk_mul_f32 v[94:95], v[94:95], v[70:71]
v_exp_f32 v88, v88
v_exp_f32 v89, v89
v_exp_f32 v90, v90
v_exp_f32 v91, v91
v_exp_f32 v92, v92
v_exp_f32 v93, v93
v_exp_f32 v94, v94
v_exp_f32 v95, v95
v_pk_add_f32 v[88:89], v[88:89], v[62:63]
v_pk_add_f32 v[90:91], v[90:91], v[62:63]
v_pk_add_f32 v[92:93], v[92:93], v[62:63]
v_pk_add_f32 v[94:95], v[94:95], v[62:63]
v_rcp_f32 v88, v88
v_rcp_f32 v89, v89
v_rcp_f32 v90, v90
v_rcp_f32 v91, v91
v_rcp_f32 v92, v92
v_rcp_f32 v93, v93
v_rcp_f32 v94, v94
v_rcp_f32 v95, v95
v_pk_mul_f32 v[64:65], v[64:65], v[88:89]
v_pk_mul_f32 v[66:67], v[66:67], v[90:91]
v_pk_mul_f32 v[68:69], v[68:69], v[92:93]
v_pk_mul_f32 v[70:71], v[70:71], v[94:95]
v_cvt_pk_bf16_f32 v80, v64, v65
v_cvt_pk_bf16_f32 v81, v66, v67
v_cvt_pk_bf16_f32 v82, v68, v69
v_cvt_pk_bf16_f32 v83, v70, v71
s_nop 0
v_permlane16_swap_b32 v80, v82
v_permlane16_swap_b32 v81, v83
global_store_dwordx4 v56, v[80:83], s[12:13] offset:0 sc1
v_accvgpr_read_b32 v72, a196
v_accvgpr_read_b32 v73, a197
v_accvgpr_read_b32 v74, a198
v_accvgpr_read_b32 v75, a199
v_accvgpr_read_b32 v76, a228
v_accvgpr_read_b32 v77, a229
v_accvgpr_read_b32 v78, a230
v_accvgpr_read_b32 v79, a231
v_cvt_pk_bf16_f32 v88, v72, v73
v_cvt_pk_bf16_f32 v90, v74, v75
v_cvt_pk_bf16_f32 v92, v76, v77
v_cvt_pk_bf16_f32 v94, v78, v79
v_lshlrev_b32 v72, 16, v88
v_and_b32 v73, 0xffff0000, v88
v_lshlrev_b32 v74, 16, v90
v_and_b32 v75, 0xffff0000, v90
v_lshlrev_b32 v76, 16, v92
v_and_b32 v77, 0xffff0000, v92
v_lshlrev_b32 v78, 16, v94
v_and_b32 v79, 0xffff0000, v94
v_pk_add_f32 v[72:73], v[72:73], v[128:129]
v_pk_add_f32 v[74:75], v[74:75], v[130:131]
v_pk_add_f32 v[76:77], v[76:77], v[132:133]
v_pk_add_f32 v[78:79], v[78:79], v[134:135]
v_cvt_pk_bf16_f32 v88, v72, v73
v_cvt_pk_bf16_f32 v90, v74, v75
v_cvt_pk_bf16_f32 v92, v76, v77
v_cvt_pk_bf16_f32 v94, v78, v79
v_lshlrev_b32 v72, 16, v88
v_and_b32 v73, 0xffff0000, v88
v_lshlrev_b32 v74, 16, v90
v_and_b32 v75, 0xffff0000, v90
v_lshlrev_b32 v76, 16, v92
v_and_b32 v77, 0xffff0000, v92
v_lshlrev_b32 v78, 16, v94
v_and_b32 v79, 0xffff0000, v94
v_pk_mul_f32 v[88:89], v[72:73], v[72:73]
v_pk_mul_f32 v[90:91], v[74:75], v[74:75]
v_pk_mul_f32 v[92:93], v[76:77], v[76:77]
v_pk_mul_f32 v[94:95], v[78:79], v[78:79]
v_pk_fma_f32 v[88:89], v[88:89], s[34:35], v[60:61]
v_pk_fma_f32 v[90:91], v[90:91], s[34:35], v[60:61]
v_pk_fma_f32 v[92:93], v[92:93], s[34:35], v[60:61]
v_pk_fma_f32 v[94:95], v[94:95], s[34:35], v[60:61]
v_pk_mul_f32 v[88:89], v[88:89], v[72:73]
v_pk_mul_f32 v[90:91], v[90:91], v[74:75]
v_pk_mul_f32 v[92:93], v[92:93], v[76:77]
v_pk_mul_f32 v[94:95], v[94:95], v[78:79]
v_exp_f32 v88, v88
v_exp_f32 v89, v89
v_exp_f32 v90, v90
v_exp_f32 v91, v91
v_exp_f32 v92, v92
v_exp_f32 v93, v93
v_exp_f32 v94, v94
v_exp_f32 v95, v95
v_pk_add_f32 v[88:89], v[88:89], v[62:63]
v_pk_add_f32 v[90:91], v[90:91], v[62:63]
v_pk_add_f32 v[92:93], v[92:93], v[62:63]
v_pk_add_f32 v[94:95], v[94:95], v[62:63]
v_rcp_f32 v88, v88
v_rcp_f32 v89, v89
v_rcp_f32 v90, v90
v_rcp_f32 v91, v91
v_rcp_f32 v92, v92
v_rcp_f32 v93, v93
v_rcp_f32 v94, v94
v_rcp_f32 v95, v95
v_pk_mul_f32 v[72:73], v[72:73], v[88:89]
v_pk_mul_f32 v[74:75], v[74:75], v[90:91]
v_pk_mul_f32 v[76:77], v[76:77], v[92:93]
v_pk_mul_f32 v[78:79], v[78:79], v[94:95]
v_cvt_pk_bf16_f32 v84, v72, v73
v_cvt_pk_bf16_f32 v85, v74, v75
v_cvt_pk_bf16_f32 v86, v76, v77
v_cvt_pk_bf16_f32 v87, v78, v79
s_nop 0
v_permlane16_swap_b32 v84, v86
v_permlane16_swap_b32 v85, v87
global_store_dwordx4 v56, v[84:87], s[12:13] offset:1024 sc1
v_accvgpr_read_b32 v64, a200
v_accvgpr_read_b32 v65, a201
v_accvgpr_read_b32 v66, a202
v_accvgpr_read_b32 v67, a203
v_accvgpr_read_b32 v68, a232
v_accvgpr_read_b32 v69, a233
v_accvgpr_read_b32 v70, a234
v_accvgpr_read_b32 v71, a235
v_cvt_pk_bf16_f32 v88, v64, v65
v_cvt_pk_bf16_f32 v90, v66, v67
v_cvt_pk_bf16_f32 v92, v68, v69
v_cvt_pk_bf16_f32 v94, v70, v71
v_lshlrev_b32 v64, 16, v88
v_and_b32 v65, 0xffff0000, v88
v_lshlrev_b32 v66, 16, v90
v_and_b32 v67, 0xffff0000, v90
v_lshlrev_b32 v68, 16, v92
v_and_b32 v69, 0xffff0000, v92
v_lshlrev_b32 v70, 16, v94
v_and_b32 v71, 0xffff0000, v94
v_pk_add_f32 v[64:65], v[64:65], v[128:129]
v_pk_add_f32 v[66:67], v[66:67], v[130:131]
v_pk_add_f32 v[68:69], v[68:69], v[132:133]
v_pk_add_f32 v[70:71], v[70:71], v[134:135]
v_cvt_pk_bf16_f32 v88, v64, v65
v_cvt_pk_bf16_f32 v90, v66, v67
v_cvt_pk_bf16_f32 v92, v68, v69
v_cvt_pk_bf16_f32 v94, v70, v71
v_lshlrev_b32 v64, 16, v88
v_and_b32 v65, 0xffff0000, v88
v_lshlrev_b32 v66, 16, v90
v_and_b32 v67, 0xffff0000, v90
v_lshlrev_b32 v68, 16, v92
v_and_b32 v69, 0xffff0000, v92
v_lshlrev_b32 v70, 16, v94
v_and_b32 v71, 0xffff0000, v94
v_pk_mul_f32 v[88:89], v[64:65], v[64:65]
v_pk_mul_f32 v[90:91], v[66:67], v[66:67]
v_pk_mul_f32 v[92:93], v[68:69], v[68:69]
v_pk_mul_f32 v[94:95], v[70:71], v[70:71]
v_pk_fma_f32 v[88:89], v[88:89], s[34:35], v[60:61]
v_pk_fma_f32 v[90:91], v[90:91], s[34:35], v[60:61]
v_pk_fma_f32 v[92:93], v[92:93], s[34:35], v[60:61]
v_pk_fma_f32 v[94:95], v[94:95], s[34:35], v[60:61]
v_pk_mul_f32 v[88:89], v[88:89], v[64:65]
v_pk_mul_f32 v[90:91], v[90:91], v[66:67]
v_pk_mul_f32 v[92:93], v[92:93], v[68:69]
v_pk_mul_f32 v[94:95], v[94:95], v[70:71]
v_exp_f32 v88, v88
v_exp_f32 v89, v89
v_exp_f32 v90, v90
v_exp_f32 v91, v91
v_exp_f32 v92, v92
v_exp_f32 v93, v93
v_exp_f32 v94, v94
v_exp_f32 v95, v95
v_pk_add_f32 v[88:89], v[88:89], v[62:63]
v_pk_add_f32 v[90:91], v[90:91], v[62:63]
v_pk_add_f32 v[92:93], v[92:93], v[62:63]
v_pk_add_f32 v[94:95], v[94:95], v[62:63]
v_rcp_f32 v88, v88
v_rcp_f32 v89, v89
v_rcp_f32 v90, v90
v_rcp_f32 v91, v91
v_rcp_f32 v92, v92
v_rcp_f32 v93, v93
v_rcp_f32 v94, v94
v_rcp_f32 v95, v95
v_pk_mul_f32 v[64:65], v[64:65], v[88:89]
v_pk_mul_f32 v[66:67], v[66:67], v[90:91]
v_pk_mul_f32 v[68:69], v[68:69], v[92:93]
v_pk_mul_f32 v[70:71], v[70:71], v[94:95]
v_cvt_pk_bf16_f32 v80, v64, v65
v_cvt_pk_bf16_f32 v81, v66, v67
v_cvt_pk_bf16_f32 v82, v68, v69
v_cvt_pk_bf16_f32 v83, v70, v71
s_nop 0
v_permlane16_swap_b32 v80, v82
v_permlane16_swap_b32 v81, v83
global_store_dwordx4 v56, v[80:83], s[12:13] offset:2048 sc1
v_accvgpr_read_b32 v72, a204
v_accvgpr_read_b32 v73, a205
v_accvgpr_read_b32 v74, a206
v_accvgpr_read_b32 v75, a207
v_accvgpr_read_b32 v76, a236
v_accvgpr_read_b32 v77, a237
v_accvgpr_read_b32 v78, a238
v_accvgpr_read_b32 v79, a239
v_cvt_pk_bf16_f32 v88, v72, v73
v_cvt_pk_bf16_f32 v90, v74, v75
v_cvt_pk_bf16_f32 v92, v76, v77
v_cvt_pk_bf16_f32 v94, v78, v79
v_lshlrev_b32 v72, 16, v88
v_and_b32 v73, 0xffff0000, v88
v_lshlrev_b32 v74, 16, v90
v_and_b32 v75, 0xffff0000, v90
v_lshlrev_b32 v76, 16, v92
v_and_b32 v77, 0xffff0000, v92
v_lshlrev_b32 v78, 16, v94
v_and_b32 v79, 0xffff0000, v94
v_pk_add_f32 v[72:73], v[72:73], v[128:129]
v_pk_add_f32 v[74:75], v[74:75], v[130:131]
v_pk_add_f32 v[76:77], v[76:77], v[132:133]
v_pk_add_f32 v[78:79], v[78:79], v[134:135]
v_cvt_pk_bf16_f32 v88, v72, v73
v_cvt_pk_bf16_f32 v90, v74, v75
v_cvt_pk_bf16_f32 v92, v76, v77
v_cvt_pk_bf16_f32 v94, v78, v79
v_lshlrev_b32 v72, 16, v88
v_and_b32 v73, 0xffff0000, v88
v_lshlrev_b32 v74, 16, v90
v_and_b32 v75, 0xffff0000, v90
v_lshlrev_b32 v76, 16, v92
v_and_b32 v77, 0xffff0000, v92
v_lshlrev_b32 v78, 16, v94
v_and_b32 v79, 0xffff0000, v94
v_pk_mul_f32 v[88:89], v[72:73], v[72:73]
v_pk_mul_f32 v[90:91], v[74:75], v[74:75]
v_pk_mul_f32 v[92:93], v[76:77], v[76:77]
v_pk_mul_f32 v[94:95], v[78:79], v[78:79]
v_pk_fma_f32 v[88:89], v[88:89], s[34:35], v[60:61]
v_pk_fma_f32 v[90:91], v[90:91], s[34:35], v[60:61]
v_pk_fma_f32 v[92:93], v[92:93], s[34:35], v[60:61]
v_pk_fma_f32 v[94:95], v[94:95], s[34:35], v[60:61]
v_pk_mul_f32 v[88:89], v[88:89], v[72:73]
v_pk_mul_f32 v[90:91], v[90:91], v[74:75]
v_pk_mul_f32 v[92:93], v[92:93], v[76:77]
v_pk_mul_f32 v[94:95], v[94:95], v[78:79]
v_exp_f32 v88, v88
v_exp_f32 v89, v89
v_exp_f32 v90, v90
v_exp_f32 v91, v91
v_exp_f32 v92, v92
v_exp_f32 v93, v93
v_exp_f32 v94, v94
v_exp_f32 v95, v95
v_pk_add_f32 v[88:89], v[88:89], v[62:63]
v_pk_add_f32 v[90:91], v[90:91], v[62:63]
v_pk_add_f32 v[92:93], v[92:93], v[62:63]
v_pk_add_f32 v[94:95], v[94:95], v[62:63]
v_rcp_f32 v88, v88
v_rcp_f32 v89, v89
v_rcp_f32 v90, v90
v_rcp_f32 v91, v91
v_rcp_f32 v92, v92
v_rcp_f32 v93, v93
v_rcp_f32 v94, v94
v_rcp_f32 v95, v95
v_pk_mul_f32 v[72:73], v[72:73], v[88:89]
v_pk_mul_f32 v[74:75], v[74:75], v[90:91]
v_pk_mul_f32 v[76:77], v[76:77], v[92:93]
v_pk_mul_f32 v[78:79], v[78:79], v[94:95]
v_cvt_pk_bf16_f32 v84, v72, v73
v_cvt_pk_bf16_f32 v85, v74, v75
v_cvt_pk_bf16_f32 v86, v76, v77
v_cvt_pk_bf16_f32 v87, v78, v79
s_nop 0
v_permlane16_swap_b32 v84, v86
v_permlane16_swap_b32 v85, v87
global_store_dwordx4 v56, v[84:87], s[12:13] offset:3072 sc1
v_accvgpr_read_b32 v64, a208
v_accvgpr_read_b32 v65, a209
v_accvgpr_read_b32 v66, a210
v_accvgpr_read_b32 v67, a211
v_accvgpr_read_b32 v68, a240
v_accvgpr_read_b32 v69, a241
v_accvgpr_read_b32 v70, a242
v_accvgpr_read_b32 v71, a243
v_cvt_pk_bf16_f32 v88, v64, v65
v_cvt_pk_bf16_f32 v90, v66, v67
v_cvt_pk_bf16_f32 v92, v68, v69
v_cvt_pk_bf16_f32 v94, v70, v71
v_lshlrev_b32 v64, 16, v88
v_and_b32 v65, 0xffff0000, v88
v_lshlrev_b32 v66, 16, v90
v_and_b32 v67, 0xffff0000, v90
v_lshlrev_b32 v68, 16, v92
v_and_b32 v69, 0xffff0000, v92
v_lshlrev_b32 v70, 16, v94
v_and_b32 v71, 0xffff0000, v94
v_pk_add_f32 v[64:65], v[64:65], v[128:129]
v_pk_add_f32 v[66:67], v[66:67], v[130:131]
v_pk_add_f32 v[68:69], v[68:69], v[132:133]
v_pk_add_f32 v[70:71], v[70:71], v[134:135]
v_cvt_pk_bf16_f32 v88, v64, v65
v_cvt_pk_bf16_f32 v90, v66, v67
v_cvt_pk_bf16_f32 v92, v68, v69
v_cvt_pk_bf16_f32 v94, v70, v71
v_lshlrev_b32 v64, 16, v88
v_and_b32 v65, 0xffff0000, v88
v_lshlrev_b32 v66, 16, v90
v_and_b32 v67, 0xffff0000, v90
v_lshlrev_b32 v68, 16, v92
v_and_b32 v69, 0xffff0000, v92
v_lshlrev_b32 v70, 16, v94
v_and_b32 v71, 0xffff0000, v94
v_pk_mul_f32 v[88:89], v[64:65], v[64:65]
v_pk_mul_f32 v[90:91], v[66:67], v[66:67]
v_pk_mul_f32 v[92:93], v[68:69], v[68:69]
v_pk_mul_f32 v[94:95], v[70:71], v[70:71]
v_pk_fma_f32 v[88:89], v[88:89], s[34:35], v[60:61]
v_pk_fma_f32 v[90:91], v[90:91], s[34:35], v[60:61]
v_pk_fma_f32 v[92:93], v[92:93], s[34:35], v[60:61]
v_pk_fma_f32 v[94:95], v[94:95], s[34:35], v[60:61]
v_pk_mul_f32 v[88:89], v[88:89], v[64:65]
v_pk_mul_f32 v[90:91], v[90:91], v[66:67]
v_pk_mul_f32 v[92:93], v[92:93], v[68:69]
v_pk_mul_f32 v[94:95], v[94:95], v[70:71]
v_exp_f32 v88, v88
v_exp_f32 v89, v89
v_exp_f32 v90, v90
v_exp_f32 v91, v91
v_exp_f32 v92, v92
v_exp_f32 v93, v93
v_exp_f32 v94, v94
v_exp_f32 v95, v95
v_pk_add_f32 v[88:89], v[88:89], v[62:63]
v_pk_add_f32 v[90:91], v[90:91], v[62:63]
v_pk_add_f32 v[92:93], v[92:93], v[62:63]
v_pk_add_f32 v[94:95], v[94:95], v[62:63]
v_rcp_f32 v88, v88
v_rcp_f32 v89, v89
v_rcp_f32 v90, v90
v_rcp_f32 v91, v91
v_rcp_f32 v92, v92
v_rcp_f32 v93, v93
v_rcp_f32 v94, v94
v_rcp_f32 v95, v95
v_pk_mul_f32 v[64:65], v[64:65], v[88:89]
v_pk_mul_f32 v[66:67], v[66:67], v[90:91]
v_pk_mul_f32 v[68:69], v[68:69], v[92:93]
v_pk_mul_f32 v[70:71], v[70:71], v[94:95]
v_cvt_pk_bf16_f32 v80, v64, v65
v_cvt_pk_bf16_f32 v81, v66, v67
v_cvt_pk_bf16_f32 v82, v68, v69
v_cvt_pk_bf16_f32 v83, v70, v71
s_nop 0
v_permlane16_swap_b32 v80, v82
v_permlane16_swap_b32 v81, v83
global_store_dwordx4 v57, v[80:83], s[12:13] offset:0 sc1
v_accvgpr_read_b32 v72, a212
v_accvgpr_read_b32 v73, a213
v_accvgpr_read_b32 v74, a214
v_accvgpr_read_b32 v75, a215
v_accvgpr_read_b32 v76, a244
v_accvgpr_read_b32 v77, a245
v_accvgpr_read_b32 v78, a246
v_accvgpr_read_b32 v79, a247
v_cvt_pk_bf16_f32 v88, v72, v73
v_cvt_pk_bf16_f32 v90, v74, v75
v_cvt_pk_bf16_f32 v92, v76, v77
v_cvt_pk_bf16_f32 v94, v78, v79
v_lshlrev_b32 v72, 16, v88
v_and_b32 v73, 0xffff0000, v88
v_lshlrev_b32 v74, 16, v90
v_and_b32 v75, 0xffff0000, v90
v_lshlrev_b32 v76, 16, v92
v_and_b32 v77, 0xffff0000, v92
v_lshlrev_b32 v78, 16, v94
v_and_b32 v79, 0xffff0000, v94
v_pk_add_f32 v[72:73], v[72:73], v[128:129]
v_pk_add_f32 v[74:75], v[74:75], v[130:131]
v_pk_add_f32 v[76:77], v[76:77], v[132:133]
v_pk_add_f32 v[78:79], v[78:79], v[134:135]
v_cvt_pk_bf16_f32 v88, v72, v73
v_cvt_pk_bf16_f32 v90, v74, v75
v_cvt_pk_bf16_f32 v92, v76, v77
v_cvt_pk_bf16_f32 v94, v78, v79
v_lshlrev_b32 v72, 16, v88
v_and_b32 v73, 0xffff0000, v88
v_lshlrev_b32 v74, 16, v90
v_and_b32 v75, 0xffff0000, v90
v_lshlrev_b32 v76, 16, v92
v_and_b32 v77, 0xffff0000, v92
v_lshlrev_b32 v78, 16, v94
v_and_b32 v79, 0xffff0000, v94
v_pk_mul_f32 v[88:89], v[72:73], v[72:73]
v_pk_mul_f32 v[90:91], v[74:75], v[74:75]
v_pk_mul_f32 v[92:93], v[76:77], v[76:77]
v_pk_mul_f32 v[94:95], v[78:79], v[78:79]
v_pk_fma_f32 v[88:89], v[88:89], s[34:35], v[60:61]
v_pk_fma_f32 v[90:91], v[90:91], s[34:35], v[60:61]
v_pk_fma_f32 v[92:93], v[92:93], s[34:35], v[60:61]
v_pk_fma_f32 v[94:95], v[94:95], s[34:35], v[60:61]
v_pk_mul_f32 v[88:89], v[88:89], v[72:73]
v_pk_mul_f32 v[90:91], v[90:91], v[74:75]
v_pk_mul_f32 v[92:93], v[92:93], v[76:77]
v_pk_mul_f32 v[94:95], v[94:95], v[78:79]
v_exp_f32 v88, v88
v_exp_f32 v89, v89
v_exp_f32 v90, v90
v_exp_f32 v91, v91
v_exp_f32 v92, v92
v_exp_f32 v93, v93
v_exp_f32 v94, v94
v_exp_f32 v95, v95
v_pk_add_f32 v[88:89], v[88:89], v[62:63]
v_pk_add_f32 v[90:91], v[90:91], v[62:63]
v_pk_add_f32 v[92:93], v[92:93], v[62:63]
v_pk_add_f32 v[94:95], v[94:95], v[62:63]
v_rcp_f32 v88, v88
v_rcp_f32 v89, v89
v_rcp_f32 v90, v90
v_rcp_f32 v91, v91
v_rcp_f32 v92, v92
v_rcp_f32 v93, v93
v_rcp_f32 v94, v94
v_rcp_f32 v95, v95
v_pk_mul_f32 v[72:73], v[72:73], v[88:89]
v_pk_mul_f32 v[74:75], v[74:75], v[90:91]
v_pk_mul_f32 v[76:77], v[76:77], v[92:93]
v_pk_mul_f32 v[78:79], v[78:79], v[94:95]
v_cvt_pk_bf16_f32 v84, v72, v73
v_cvt_pk_bf16_f32 v85, v74, v75
v_cvt_pk_bf16_f32 v86, v76, v77
v_cvt_pk_bf16_f32 v87, v78, v79
s_nop 0
v_permlane16_swap_b32 v84, v86
v_permlane16_swap_b32 v85, v87
global_store_dwordx4 v57, v[84:87], s[12:13] offset:1024 sc1
v_accvgpr_read_b32 v64, a216
v_accvgpr_read_b32 v65, a217
v_accvgpr_read_b32 v66, a218
v_accvgpr_read_b32 v67, a219
v_accvgpr_read_b32 v68, a248
v_accvgpr_read_b32 v69, a249
v_accvgpr_read_b32 v70, a250
v_accvgpr_read_b32 v71, a251
v_cvt_pk_bf16_f32 v88, v64, v65
v_cvt_pk_bf16_f32 v90, v66, v67
v_cvt_pk_bf16_f32 v92, v68, v69
v_cvt_pk_bf16_f32 v94, v70, v71
v_lshlrev_b32 v64, 16, v88
v_and_b32 v65, 0xffff0000, v88
v_lshlrev_b32 v66, 16, v90
v_and_b32 v67, 0xffff0000, v90
v_lshlrev_b32 v68, 16, v92
v_and_b32 v69, 0xffff0000, v92
v_lshlrev_b32 v70, 16, v94
v_and_b32 v71, 0xffff0000, v94
v_pk_add_f32 v[64:65], v[64:65], v[128:129]
v_pk_add_f32 v[66:67], v[66:67], v[130:131]
v_pk_add_f32 v[68:69], v[68:69], v[132:133]
v_pk_add_f32 v[70:71], v[70:71], v[134:135]
v_cvt_pk_bf16_f32 v88, v64, v65
v_cvt_pk_bf16_f32 v90, v66, v67
v_cvt_pk_bf16_f32 v92, v68, v69
v_cvt_pk_bf16_f32 v94, v70, v71
v_lshlrev_b32 v64, 16, v88
v_and_b32 v65, 0xffff0000, v88
v_lshlrev_b32 v66, 16, v90
v_and_b32 v67, 0xffff0000, v90
v_lshlrev_b32 v68, 16, v92
v_and_b32 v69, 0xffff0000, v92
v_lshlrev_b32 v70, 16, v94
v_and_b32 v71, 0xffff0000, v94
v_pk_mul_f32 v[88:89], v[64:65], v[64:65]
v_pk_mul_f32 v[90:91], v[66:67], v[66:67]
v_pk_mul_f32 v[92:93], v[68:69], v[68:69]
v_pk_mul_f32 v[94:95], v[70:71], v[70:71]
v_pk_fma_f32 v[88:89], v[88:89], s[34:35], v[60:61]
v_pk_fma_f32 v[90:91], v[90:91], s[34:35], v[60:61]
v_pk_fma_f32 v[92:93], v[92:93], s[34:35], v[60:61]
v_pk_fma_f32 v[94:95], v[94:95], s[34:35], v[60:61]
v_pk_mul_f32 v[88:89], v[88:89], v[64:65]
v_pk_mul_f32 v[90:91], v[90:91], v[66:67]
v_pk_mul_f32 v[92:93], v[92:93], v[68:69]
v_pk_mul_f32 v[94:95], v[94:95], v[70:71]
v_exp_f32 v88, v88
v_exp_f32 v89, v89
v_exp_f32 v90, v90
v_exp_f32 v91, v91
v_exp_f32 v92, v92
v_exp_f32 v93, v93
v_exp_f32 v94, v94
v_exp_f32 v95, v95
v_pk_add_f32 v[88:89], v[88:89], v[62:63]
v_pk_add_f32 v[90:91], v[90:91], v[62:63]
v_pk_add_f32 v[92:93], v[92:93], v[62:63]
v_pk_add_f32 v[94:95], v[94:95], v[62:63]
v_rcp_f32 v88, v88
v_rcp_f32 v89, v89
v_rcp_f32 v90, v90
v_rcp_f32 v91, v91
v_rcp_f32 v92, v92
v_rcp_f32 v93, v93
v_rcp_f32 v94, v94
v_rcp_f32 v95, v95
v_pk_mul_f32 v[64:65], v[64:65], v[88:89]
v_pk_mul_f32 v[66:67], v[66:67], v[90:91]
v_pk_mul_f32 v[68:69], v[68:69], v[92:93]
v_pk_mul_f32 v[70:71], v[70:71], v[94:95]
v_cvt_pk_bf16_f32 v80, v64, v65
v_cvt_pk_bf16_f32 v81, v66, v67
v_cvt_pk_bf16_f32 v82, v68, v69
v_cvt_pk_bf16_f32 v83, v70, v71
s_nop 0
v_permlane16_swap_b32 v80, v82
v_permlane16_swap_b32 v81, v83
global_store_dwordx4 v57, v[80:83], s[12:13] offset:2048 sc1
v_accvgpr_read_b32 v72, a220
v_accvgpr_read_b32 v73, a221
v_accvgpr_read_b32 v74, a222
v_accvgpr_read_b32 v75, a223
v_accvgpr_read_b32 v76, a252
v_accvgpr_read_b32 v77, a253
v_accvgpr_read_b32 v78, a254
v_accvgpr_read_b32 v79, a255
v_cvt_pk_bf16_f32 v88, v72, v73
v_cvt_pk_bf16_f32 v90, v74, v75
v_cvt_pk_bf16_f32 v92, v76, v77
v_cvt_pk_bf16_f32 v94, v78, v79
v_lshlrev_b32 v72, 16, v88
v_and_b32 v73, 0xffff0000, v88
v_lshlrev_b32 v74, 16, v90
v_and_b32 v75, 0xffff0000, v90
v_lshlrev_b32 v76, 16, v92
v_and_b32 v77, 0xffff0000, v92
v_lshlrev_b32 v78, 16, v94
v_and_b32 v79, 0xffff0000, v94
v_pk_add_f32 v[72:73], v[72:73], v[128:129]
v_pk_add_f32 v[74:75], v[74:75], v[130:131]
v_pk_add_f32 v[76:77], v[76:77], v[132:133]
v_pk_add_f32 v[78:79], v[78:79], v[134:135]
v_cvt_pk_bf16_f32 v88, v72, v73
v_cvt_pk_bf16_f32 v90, v74, v75
v_cvt_pk_bf16_f32 v92, v76, v77
v_cvt_pk_bf16_f32 v94, v78, v79
v_lshlrev_b32 v72, 16, v88
v_and_b32 v73, 0xffff0000, v88
v_lshlrev_b32 v74, 16, v90
v_and_b32 v75, 0xffff0000, v90
v_lshlrev_b32 v76, 16, v92
v_and_b32 v77, 0xffff0000, v92
v_lshlrev_b32 v78, 16, v94
v_and_b32 v79, 0xffff0000, v94
v_pk_mul_f32 v[88:89], v[72:73], v[72:73]
v_pk_mul_f32 v[90:91], v[74:75], v[74:75]
v_pk_mul_f32 v[92:93], v[76:77], v[76:77]
v_pk_mul_f32 v[94:95], v[78:79], v[78:79]
v_pk_fma_f32 v[88:89], v[88:89], s[34:35], v[60:61]
v_pk_fma_f32 v[90:91], v[90:91], s[34:35], v[60:61]
v_pk_fma_f32 v[92:93], v[92:93], s[34:35], v[60:61]
v_pk_fma_f32 v[94:95], v[94:95], s[34:35], v[60:61]
v_pk_mul_f32 v[88:89], v[88:89], v[72:73]
v_pk_mul_f32 v[90:91], v[90:91], v[74:75]
v_pk_mul_f32 v[92:93], v[92:93], v[76:77]
v_pk_mul_f32 v[94:95], v[94:95], v[78:79]
v_exp_f32 v88, v88
v_exp_f32 v89, v89
v_exp_f32 v90, v90
v_exp_f32 v91, v91
v_exp_f32 v92, v92
v_exp_f32 v93, v93
v_exp_f32 v94, v94
v_exp_f32 v95, v95
v_pk_add_f32 v[88:89], v[88:89], v[62:63]
v_pk_add_f32 v[90:91], v[90:91], v[62:63]
v_pk_add_f32 v[92:93], v[92:93], v[62:63]
v_pk_add_f32 v[94:95], v[94:95], v[62:63]
v_rcp_f32 v88, v88
v_rcp_f32 v89, v89
v_rcp_f32 v90, v90
v_rcp_f32 v91, v91
v_rcp_f32 v92, v92
v_rcp_f32 v93, v93
v_rcp_f32 v94, v94
v_rcp_f32 v95, v95
v_pk_mul_f32 v[72:73], v[72:73], v[88:89]
v_pk_mul_f32 v[74:75], v[74:75], v[90:91]
v_pk_mul_f32 v[76:77], v[76:77], v[92:93]
v_pk_mul_f32 v[78:79], v[78:79], v[94:95]
v_cvt_pk_bf16_f32 v84, v72, v73
v_cvt_pk_bf16_f32 v85, v74, v75
v_cvt_pk_bf16_f32 v86, v76, v77
v_cvt_pk_bf16_f32 v87, v78, v79
s_nop 0
v_permlane16_swap_b32 v84, v86
v_permlane16_swap_b32 v85, v87
global_store_dwordx4 v57, v[84:87], s[12:13] offset:3072 sc1
s_waitcnt vmcnt(0)
s_barrier
s_cmp_lg_u32 s20, 0
s_cbranch_scc1 M_sg_112
v_mov_b32 v42, 136
v_mov_b32 v43, 1
s_mov_b64 exec, 1
global_atomic_add v42, v43, s[56:57]
s_mov_b64 exec, -1
M_sg_112:
s_branch W_loop
W_m2:
s_lshl_b32 s64, s58, 1
s_add_u32 s62, s62, s64
s_cmp_eq_u32 s93, 1
s_cbranch_scc1 M_wo_113
s_cmp_lg_u32 s20, 0
s_cbranch_scc1 M_wcd_115
v_mov_b32 v42, 136
s_mov_b32 s65, 0
s_mov_b64 exec, 1
M_wc_114:
global_load_dword v43, v42, s[56:57] sc1
s_waitcnt vmcnt(0)
v_readfirstlane_b32 s64, v43
s_cmp_ge_u32 s64, 56
s_cbranch_scc1 M_wcd_115_x
s_sleep 32
s_add_u32 s65, s65, 1
s_cmp_lt_u32 s65, 400000
s_cbranch_scc1 M_wc_114
s_mov_b64 exec, -1
s_branch M_exit0
M_wcd_115_x:
s_mov_b64 exec, -1
M_wcd_115:
s_barrier
s_mov_b32 s93, 1
M_wo_113:
s_lshl_b32 s64, s61, 13
s_add_u32 s64, s64, 67108864
s_add_u32 s4, s40, s64
s_addc_u32 s5, s41, 0
s_lshl_b32 s64, s62, 9
s_add_u32 s6, s52, s64
s_addc_u32 s7, s53, 0
s_add_u32 s14, s54, s64
s_addc_u32 s15, s55, 0
s_mov_b32 s8, 65536
s_mov_b32 s31, 4096
s_mov_b32 s9, 131072
s_mov_b32 s10, 112
s_lshl_b32 s64, s62, 19
s_lshl_b32 s65, s61, 8
s_add_u32 s64, s64, s65
s_add_u32 s64, s64, 75497472
s_add_u32 s12, s40, s64
s_addc_u32 s13, s41, 0
s_mul_i32 s21, s20, 2048
v_lshlrev_b32 v42, 4, v1
v_add_u32 v2, s21, v42
v_add_u32 v3, 1024, v2
v_lshrrev_b32 v42, 5, v1
s_lshl_b32 s21, s20, 3
v_add_u32 v43, s21, v42
v_mul_lo_u32 v43, v43, s31
v_and_b32 v44, 31, v1
s_and_b32 s21, s20, 1
s_lshl_b32 s21, s21, 3
v_lshl_add_u32 v42, v42, 1, s21
v_xor_b32 v45, v44, v42
v_xor_b32 v46, 4, v45
v_lshl_add_u32 v45, v45, 4, v43
v_lshl_add_u32 v46, v46, 4, v43
s_lshl_b32 s22, s31, 1
s_mov_b32 s21, 0
v_add_u32 v6, s21, v45
s_add_u32 s21, s21, s22
v_add_u32 v7, s21, v46
s_add_u32 s21, s21, s22
v_add_u32 v8, s21, v45
s_add_u32 s21, s21, s22
v_add_u32 v9, s21, v46
s_mul_i32 s29, s20, 2048
s_add_u32 m0, s29, 0
s_nop 0
global_load_lds_dwordx4 v2, s[4:5] sc1
s_add_u32 m0, s29, 1024
s_nop 0
global_load_lds_dwordx4 v3, s[4:5] sc1
s_add_u32 m0, s26, 0
s_nop 0
global_load_lds_dwordx4 v6, s[6:7]
s_add_u32 m0, s26, 1024
s_nop 0
global_load_lds_dwordx4 v7, s[6:7]
s_add_u32 m0, s26, 2048
s_nop 0
global_load_lds_dwordx4 v8, s[6:7]
s_add_u32 m0, s26, 3072
s_nop 0
global_load_lds_dwordx4 v9, s[6:7]
s_add_u32 s4, s4, s8
s_addc_u32 s5, s5, 0
s_add_u32 s6, s6, s9
s_addc_u32 s7, s7, 0
s_add_u32 m0, s29, 32768
s_nop 0
global_load_lds_dwordx4 v2, s[4:5] sc1
s_add_u32 m0, s29, 33792
s_nop 0
global_load_lds_dwordx4 v3, s[4:5] sc1
s_add_u32 m0, s26, 32768
s_nop 0
global_load_lds_dwordx4 v6, s[6:7]
s_add_u32 m0, s26, 33792
s_nop 0
global_load_lds_dwordx4 v7, s[6:7]
s_add_u32 m0, s26, 34816
s_nop 0
global_load_lds_dwordx4 v8, s[6:7]
s_add_u32 m0, s26, 35840
s_nop 0
global_load_lds_dwordx4 v9, s[6:7]
s_add_u32 s4, s4, s8
s_addc_u32 s5, s5, 0
s_add_u32 s6, s6, s9
s_addc_u32 s7, s7, 0
s_add_u32 m0, s29, 65536
s_nop 0
global_load_lds_dwordx4 v2, s[4:5] sc1
s_add_u32 m0, s29, 66560
s_nop 0
global_load_lds_dwordx4 v3, s[4:5] sc1
s_add_u32 m0, s26, 65536
s_nop 0
global_load_lds_dwordx4 v6, s[6:7]
s_add_u32 m0, s26, 66560
s_nop 0
global_load_lds_dwordx4 v7, s[6:7]
s_add_u32 m0, s26, 67584
s_nop 0
global_load_lds_dwordx4 v8, s[6:7]
s_add_u32 m0, s26, 68608
s_nop 0
global_load_lds_dwordx4 v9, s[6:7]
s_add_u32 s4, s4, s8
s_addc_u32 s5, s5, 0
s_add_u32 s6, s6, s9
s_addc_u32 s7, s7, 0
s_add_u32 m0, s29, 98304
s_nop 0
global_load_lds_dwordx4 v2, s[4:5] sc1
s_add_u32 m0, s29, 99328
s_nop 0
global_load_lds_dwordx4 v3, s[4:5] sc1
s_add_u32 m0, s26, 98304
s_nop 0
global_load_lds_dwordx4 v6, s[6:7]
s_add_u32 m0, s26, 99328
s_nop 0
global_load_lds_dwordx4 v7, s[6:7]
s_add_u32 m0, s26, 100352
s_nop 0
global_load_lds_dwordx4 v8, s[6:7]
s_add_u32 m0, s26, 101376
s_nop 0
global_load_lds_dwordx4 v9, s[6:7]
s_add_u32 s4, s4, s8
s_addc_u32 s5, s5, 0
s_add_u32 s6, s6, s9
s_addc_u32 s7, s7, 0
s_lshr_b32 s21, s20, 1
s_mul_i32 s21, s21, 4096
v_and_b32 v42, 15, v1
v_lshlrev_b32 v43, 6, v42
v_add_u32 v43, s21, v43
v_lshrrev_b32 v42, 2, v42
v_lshrrev_b32 v44, 1, v42
v_xor_b32 v45, v42, v44
v_and_b32 v45, 1, v45
v_lshl_add_u32 v44, v45, 1, v44
v_lshrrev_b32 v45, 4, v1
v_xor_b32 v44, v44, v45
v_lshl_add_u32 v10, v44, 4, v43
v_add_u32 v11, 0x10000, v10
s_and_b32 s21, s20, 1
v_and_b32 v42, 15, v1
v_lshrrev_b32 v43, 2, v42
v_lshrrev_b32 v44, 4, v1
v_lshl_add_u32 v45, v44, 3, v43
v_lshlrev_b32 v45, 9, v45
v_and_b32 v46, 1, v42
v_lshl_add_u32 v45, v46, 3, v45
v_bfe_u32 v46, v42, 1, 1
v_lshl_add_u32 v45, v46, 4, v45
v_add_u32 v45, 16384, v45
v_and_b32 v44, 1, v44
v_lshl_add_u32 v43, v44, 2, v43
s_mul_i32 s22, s21, 8
s_add_u32 s23, s22, 0
s_and_b32 s24, s23, 7
s_and_b32 s23, s23, 8
v_xor_b32 v46, s24, v43
v_add_u32 v46, s23, v46
v_lshl_add_u32 v26, v46, 5, v45
v_add_u32 v34, 0x10000, v26
s_add_u32 s23, s22, 1
s_and_b32 s24, s23, 7
s_and_b32 s23, s23, 8
v_xor_b32 v46, s24, v43
v_add_u32 v46, s23, v46
v_lshl_add_u32 v27, v46, 5, v45
v_add_u32 v35, 0x10000, v27
s_add_u32 s23, s22, 2
s_and_b32 s24, s23, 7
s_and_b32 s23, s23, 8
v_xor_b32 v46, s24, v43
v_add_u32 v46, s23, v46
v_lshl_add_u32 v28, v46, 5, v45
v_add_u32 v36, 0x10000, v28
s_add_u32 s23, s22, 3
s_and_b32 s24, s23, 7
s_and_b32 s23, s23, 8
v_xor_b32 v46, s24, v43
v_add_u32 v46, s23, v46
v_lshl_add_u32 v29, v46, 5, v45
v_add_u32 v37, 0x10000, v29
s_add_u32 s23, s22, 4
s_and_b32 s24, s23, 7
s_and_b32 s23, s23, 8
v_xor_b32 v46, s24, v43
v_add_u32 v46, s23, v46
v_lshl_add_u32 v30, v46, 5, v45
v_add_u32 v38, 0x10000, v30
s_add_u32 s23, s22, 5
s_and_b32 s24, s23, 7
s_and_b32 s23, s23, 8
v_xor_b32 v46, s24, v43
v_add_u32 v46, s23, v46
v_lshl_add_u32 v31, v46, 5, v45
v_add_u32 v39, 0x10000, v31
s_add_u32 s23, s22, 6
s_and_b32 s24, s23, 7
s_and_b32 s23, s23, 8
v_xor_b32 v46, s24, v43
v_add_u32 v46, s23, v46
v_lshl_add_u32 v32, v46, 5, v45
v_add_u32 v40, 0x10000, v32
s_add_u32 s23, s22, 7
s_and_b32 s24, s23, 7
s_and_b32 s23, s23, 8
v_xor_b32 v46, s24, v43
v_add_u32 v46, s23, v46
v_lshl_add_u32 v33, v46, 5, v45
v_add_u32 v41, 0x10000, v33
s_waitcnt vmcnt(0)
s_barrier
ds_read_b64_tr_b16 v[160:161], v26 offset:0
ds_read_b64_tr_b16 v[162:163], v26 offset:2048
ds_read_b128 v[128:131], v10 offset:0
ds_read_b128 v[132:135], v10 offset:1024
ds_read_b128 v[136:139], v10 offset:2048
ds_read_b128 v[140:143], v10 offset:3072
ds_read_b64_tr_b16 v[164:165], v27 offset:0
ds_read_b64_tr_b16 v[166:167], v27 offset:2048
ds_read_b64_tr_b16 v[168:169], v28 offset:0
ds_read_b64_tr_b16 v[170:171], v28 offset:2048
ds_read_b64_tr_b16 v[172:173], v29 offset:0
ds_read_b64_tr_b16 v[174:175], v29 offset:2048
ds_read_b64_tr_b16 v[176:177], v30 offset:0
ds_read_b64_tr_b16 v[178:179], v30 offset:2048
ds_read_b64_tr_b16 v[180:181], v31 offset:0
ds_read_b64_tr_b16 v[182:183], v31 offset:2048
ds_read_b64_tr_b16 v[184:185], v32 offset:0
ds_read_b64_tr_b16 v[186:187], v32 offset:2048
ds_read_b64_tr_b16 v[188:189], v33 offset:0
ds_read_b64_tr_b16 v[190:191], v33 offset:2048
s_lshr_b32 s11, s10, 2
s_sub_u32 s11, s11, 1
s_waitcnt lgkmcnt(0)
v_mfma_f32_16x16x32_bf16 a[0:3], v[128:131], v[160:163], 0
v_mfma_f32_16x16x32_bf16 a[4:7], v[132:135], v[160:163], 0
v_mfma_f32_16x16x32_bf16 a[8:11], v[136:139], v[160:163], 0
v_mfma_f32_16x16x32_bf16 a[12:15], v[140:143], v[160:163], 0
v_mfma_f32_16x16x32_bf16 a[16:19], v[128:131], v[164:167], 0
v_mfma_f32_16x16x32_bf16 a[20:23], v[132:135], v[164:167], 0
v_mfma_f32_16x16x32_bf16 a[24:27], v[136:139], v[164:167], 0
v_mfma_f32_16x16x32_bf16 a[28:31], v[140:143], v[164:167], 0
v_mfma_f32_16x16x32_bf16 a[32:35], v[128:131], v[168:171], 0
v_mfma_f32_16x16x32_bf16 a[36:39], v[132:135], v[168:171], 0
v_mfma_f32_16x16x32_bf16 a[40:43], v[136:139], v[168:171], 0
v_mfma_f32_16x16x32_bf16 a[44:47], v[140:143], v[168:171], 0
v_mfma_f32_16x16x32_bf16 a[48:51], v[128:131], v[172:175], 0
v_mfma_f32_16x16x32_bf16 a[52:55], v[132:135], v[172:175], 0
v_mfma_f32_16x16x32_bf16 a[56:59], v[136:139], v[172:175], 0
v_mfma_f32_16x16x32_bf16 a[60:63], v[140:143], v[172:175], 0
s_barrier
v_mfma_f32_16x16x32_bf16 a[64:67], v[128:131], v[176:179], 0
ds_read_b64_tr_b16 v[224:225], v26 offset:32768
ds_read_b64_tr_b16 v[226:227], v26 offset:34816
v_mfma_f32_16x16x32_bf16 a[68:71], v[132:135], v[176:179], 0
s_add_u32 m0, s29, 0
ds_read_b128 v[192:195], v10 offset:32768
ds_read_b128 v[196:199], v10 offset:33792
v_mfma_f32_16x16x32_bf16 a[72:75], v[136:139], v[176:179], 0
global_load_lds_dwordx4 v2, s[4:5] sc1
ds_read_b128 v[200:203], v10 offset:34816
ds_read_b128 v[204:207], v10 offset:35840
v_mfma_f32_16x16x32_bf16 a[76:79], v[140:143], v[176:179], 0
ds_read_b64_tr_b16 v[228:229], v27 offset:32768
ds_read_b64_tr_b16 v[230:231], v27 offset:34816
v_mfma_f32_16x16x32_bf16 a[80:83], v[128:131], v[180:183], 0
ds_read_b64_tr_b16 v[232:233], v28 offset:32768
ds_read_b64_tr_b16 v[234:235], v28 offset:34816
v_mfma_f32_16x16x32_bf16 a[84:87], v[132:135], v[180:183], 0
ds_read_b64_tr_b16 v[236:237], v29 offset:32768
ds_read_b64_tr_b16 v[238:239], v29 offset:34816
v_mfma_f32_16x16x32_bf16 a[88:91], v[136:139], v[180:183], 0
ds_read_b64_tr_b16 v[240:241], v30 offset:32768
ds_read_b64_tr_b16 v[242:243], v30 offset:34816
v_mfma_f32_16x16x32_bf16 a[92:95], v[140:143], v[180:183], 0
ds_read_b64_tr_b16 v[244:245], v31 offset:32768
ds_read_b64_tr_b16 v[246:247], v31 offset:34816
v_mfma_f32_16x16x32_bf16 a[96:99], v[128:131], v[184:187], 0
ds_read_b64_tr_b16 v[248:249], v32 offset:32768
ds_read_b64_tr_b16 v[250:251], v32 offset:34816
v_mfma_f32_16x16x32_bf16 a[100:103], v[132:135], v[184:187], 0
s_add_u32 m0, s29, 1024
ds_read_b64_tr_b16 v[252:253], v33 offset:32768
ds_read_b64_tr_b16 v[254:255], v33 offset:34816
v_mfma_f32_16x16x32_bf16 a[104:107], v[136:139], v[184:187], 0
global_load_lds_dwordx4 v3, s[4:5] sc1
v_mfma_f32_16x16x32_bf16 a[108:111], v[140:143], v[184:187], 0
v_mfma_f32_16x16x32_bf16 a[112:115], v[128:131], v[188:191], 0
v_mfma_f32_16x16x32_bf16 a[116:119], v[132:135], v[188:191], 0
v_mfma_f32_16x16x32_bf16 a[120:123], v[136:139], v[188:191], 0
v_mfma_f32_16x16x32_bf16 a[124:127], v[140:143], v[188:191], 0
s_add_u32 s4, s4, s8
s_addc_u32 s5, s5, 0
M_gl_116:
s_waitcnt lgkmcnt(0)
v_mfma_f32_16x16x32_bf16 a[0:3], v[192:195], v[224:227], a[0:3]
v_mfma_f32_16x16x32_bf16 a[4:7], v[196:199], v[224:227], a[4:7]
s_add_u32 m0, s26, 0
v_mfma_f32_16x16x32_bf16 a[8:11], v[200:203], v[224:227], a[8:11]
global_load_lds_dwordx4 v6, s[6:7]
v_mfma_f32_16x16x32_bf16 a[12:15], v[204:207], v[224:227], a[12:15]
v_mfma_f32_16x16x32_bf16 a[16:19], v[192:195], v[228:231], a[16:19]
v_mfma_f32_16x16x32_bf16 a[20:23], v[196:199], v[228:231], a[20:23]
s_add_u32 m0, s26, 1024
v_mfma_f32_16x16x32_bf16 a[24:27], v[200:203], v[228:231], a[24:27]
global_load_lds_dwordx4 v7, s[6:7]
v_mfma_f32_16x16x32_bf16 a[28:31], v[204:207], v[228:231], a[28:31]
v_mfma_f32_16x16x32_bf16 a[32:35], v[192:195], v[232:235], a[32:35]
v_mfma_f32_16x16x32_bf16 a[36:39], v[196:199], v[232:235], a[36:39]
s_add_u32 m0, s26, 2048
v_mfma_f32_16x16x32_bf16 a[40:43], v[200:203], v[232:235], a[40:43]
global_load_lds_dwordx4 v8, s[6:7]
v_mfma_f32_16x16x32_bf16 a[44:47], v[204:207], v[232:235], a[44:47]
v_mfma_f32_16x16x32_bf16 a[48:51], v[192:195], v[236:239], a[48:51]
v_mfma_f32_16x16x32_bf16 a[52:55], v[196:199], v[236:239], a[52:55]
s_add_u32 m0, s26, 3072
v_mfma_f32_16x16x32_bf16 a[56:59], v[200:203], v[236:239], a[56:59]
global_load_lds_dwordx4 v9, s[6:7]
v_mfma_f32_16x16x32_bf16 a[60:63], v[204:207], v[236:239], a[60:63]
s_add_u32 s6, s6, s9
s_addc_u32 s7, s7, 0
s_waitcnt vmcnt(12)
s_barrier
v_mfma_f32_16x16x32_bf16 a[64:67], v[192:195], v[240:243], a[64:67]
ds_read_b64_tr_b16 v[160:161], v34 offset:0
ds_read_b64_tr_b16 v[162:163], v34 offset:2048
v_mfma_f32_16x16x32_bf16 a[68:71], v[196:199], v[240:243], a[68:71]
s_add_u32 m0, s29, 32768
ds_read_b128 v[128:131], v11 offset:0
ds_read_b128 v[132:135], v11 offset:1024
v_mfma_f32_16x16x32_bf16 a[72:75], v[200:203], v[240:243], a[72:75]
global_load_lds_dwordx4 v2, s[4:5] sc1
ds_read_b128 v[136:139], v11 offset:2048
ds_read_b128 v[140:143], v11 offset:3072
v_mfma_f32_16x16x32_bf16 a[76:79], v[204:207], v[240:243], a[76:79]
ds_read_b64_tr_b16 v[164:165], v35 offset:0
ds_read_b64_tr_b16 v[166:167], v35 offset:2048
v_mfma_f32_16x16x32_bf16 a[80:83], v[192:195], v[244:247], a[80:83]
ds_read_b64_tr_b16 v[168:169], v36 offset:0
ds_read_b64_tr_b16 v[170:171], v36 offset:2048
v_mfma_f32_16x16x32_bf16 a[84:87], v[196:199], v[244:247], a[84:87]
ds_read_b64_tr_b16 v[172:173], v37 offset:0
ds_read_b64_tr_b16 v[174:175], v37 offset:2048
v_mfma_f32_16x16x32_bf16 a[88:91], v[200:203], v[244:247], a[88:91]
ds_read_b64_tr_b16 v[176:177], v38 offset:0
ds_read_b64_tr_b16 v[178:179], v38 offset:2048
v_mfma_f32_16x16x32_bf16 a[92:95], v[204:207], v[244:247], a[92:95]
ds_read_b64_tr_b16 v[180:181], v39 offset:0
ds_read_b64_tr_b16 v[182:183], v39 offset:2048
v_mfma_f32_16x16x32_bf16 a[96:99], v[192:195], v[248:251], a[96:99]
ds_read_b64_tr_b16 v[184:185], v40 offset:0
ds_read_b64_tr_b16 v[186:187], v40 offset:2048
v_mfma_f32_16x16x32_bf16 a[100:103], v[196:199], v[248:251], a[100:103]
s_add_u32 m0, s29, 33792
ds_read_b64_tr_b16 v[188:189], v41 offset:0
ds_read_b64_tr_b16 v[190:191], v41 offset:2048
v_mfma_f32_16x16x32_bf16 a[104:107], v[200:203], v[248:251], a[104:107]
global_load_lds_dwordx4 v3, s[4:5] sc1
v_mfma_f32_16x16x32_bf16 a[108:111], v[204:207], v[248:251], a[108:111]
v_mfma_f32_16x16x32_bf16 a[112:115], v[192:195], v[252:255], a[112:115]
v_mfma_f32_16x16x32_bf16 a[116:119], v[196:199], v[252:255], a[116:119]
v_mfma_f32_16x16x32_bf16 a[120:123], v[200:203], v[252:255], a[120:123]
v_mfma_f32_16x16x32_bf16 a[124:127], v[204:207], v[252:255], a[124:127]
s_add_u32 s4, s4, s8
s_addc_u32 s5, s5, 0
s_waitcnt lgkmcnt(0)
v_mfma_f32_16x16x32_bf16 a[0:3], v[128:131], v[160:163], a[0:3]
v_mfma_f32_16x16x32_bf16 a[4:7], v[132:135], v[160:163], a[4:7]
s_add_u32 m0, s26, 32768
v_mfma_f32_16x16x32_bf16 a[8:11], v[136:139], v[160:163], a[8:11]
global_load_lds_dwordx4 v6, s[6:7]
v_mfma_f32_16x16x32_bf16 a[12:15], v[140:143], v[160:163], a[12:15]
v_mfma_f32_16x16x32_bf16 a[16:19], v[128:131], v[164:167], a[16:19]
v_mfma_f32_16x16x32_bf16 a[20:23], v[132:135], v[164:167], a[20:23]
s_add_u32 m0, s26, 33792
v_mfma_f32_16x16x32_bf16 a[24:27], v[136:139], v[164:167], a[24:27]
global_load_lds_dwordx4 v7, s[6:7]
v_mfma_f32_16x16x32_bf16 a[28:31], v[140:143], v[164:167], a[28:31]
v_mfma_f32_16x16x32_bf16 a[32:35], v[128:131], v[168:171], a[32:35]
v_mfma_f32_16x16x32_bf16 a[36:39], v[132:135], v[168:171], a[36:39]
s_add_u32 m0, s26, 34816
v_mfma_f32_16x16x32_bf16 a[40:43], v[136:139], v[168:171], a[40:43]
global_load_lds_dwordx4 v8, s[6:7]
v_mfma_f32_16x16x32_bf16 a[44:47], v[140:143], v[168:171], a[44:47]
v_mfma_f32_16x16x32_bf16 a[48:51], v[128:131], v[172:175], a[48:51]
v_mfma_f32_16x16x32_bf16 a[52:55], v[132:135], v[172:175], a[52:55]
s_add_u32 m0, s26, 35840
v_mfma_f32_16x16x32_bf16 a[56:59], v[136:139], v[172:175], a[56:59]
global_load_lds_dwordx4 v9, s[6:7]
v_mfma_f32_16x16x32_bf16 a[60:63], v[140:143], v[172:175], a[60:63]
s_add_u32 s6, s6, s9
s_addc_u32 s7, s7, 0
s_waitcnt vmcnt(12)
s_barrier
v_mfma_f32_16x16x32_bf16 a[64:67], v[128:131], v[176:179], a[64:67]
ds_read_b64_tr_b16 v[224:225], v34 offset:32768
ds_read_b64_tr_b16 v[226:227], v34 offset:34816
v_mfma_f32_16x16x32_bf16 a[68:71], v[132:135], v[176:179], a[68:71]
s_add_u32 m0, s29, 65536
ds_read_b128 v[192:195], v11 offset:32768
ds_read_b128 v[196:199], v11 offset:33792
v_mfma_f32_16x16x32_bf16 a[72:75], v[136:139], v[176:179], a[72:75]
global_load_lds_dwordx4 v2, s[4:5] sc1
ds_read_b128 v[200:203], v11 offset:34816
ds_read_b128 v[204:207], v11 offset:35840
v_mfma_f32_16x16x32_bf16 a[76:79], v[140:143], v[176:179], a[76:79]
ds_read_b64_tr_b16 v[228:229], v35 offset:32768
ds_read_b64_tr_b16 v[230:231], v35 offset:34816
v_mfma_f32_16x16x32_bf16 a[80:83], v[128:131], v[180:183], a[80:83]
ds_read_b64_tr_b16 v[232:233], v36 offset:32768
ds_read_b64_tr_b16 v[234:235], v36 offset:34816
v_mfma_f32_16x16x32_bf16 a[84:87], v[132:135], v[180:183], a[84:87]
ds_read_b64_tr_b16 v[236:237], v37 offset:32768
ds_read_b64_tr_b16 v[238:239], v37 offset:34816
v_mfma_f32_16x16x32_bf16 a[88:91], v[136:139], v[180:183], a[88:91]
ds_read_b64_tr_b16 v[240:241], v38 offset:32768
ds_read_b64_tr_b16 v[242:243], v38 offset:34816
v_mfma_f32_16x16x32_bf16 a[92:95], v[140:143], v[180:183], a[92:95]
ds_read_b64_tr_b16 v[244:245], v39 offset:32768
ds_read_b64_tr_b16 v[246:247], v39 offset:34816
v_mfma_f32_16x16x32_bf16 a[96:99], v[128:131], v[184:187], a[96:99]
ds_read_b64_tr_b16 v[248:249], v40 offset:32768
ds_read_b64_tr_b16 v[250:251], v40 offset:34816
v_mfma_f32_16x16x32_bf16 a[100:103], v[132:135], v[184:187], a[100:103]
s_add_u32 m0, s29, 66560
ds_read_b64_tr_b16 v[252:253], v41 offset:32768
ds_read_b64_tr_b16 v[254:255], v41 offset:34816
v_mfma_f32_16x16x32_bf16 a[104:107], v[136:139], v[184:187], a[104:107]
global_load_lds_dwordx4 v3, s[4:5] sc1
v_mfma_f32_16x16x32_bf16 a[108:111], v[140:143], v[184:187], a[108:111]
v_mfma_f32_16x16x32_bf16 a[112:115], v[128:131], v[188:191], a[112:115]
v_mfma_f32_16x16x32_bf16 a[116:119], v[132:135], v[188:191], a[116:119]
v_mfma_f32_16x16x32_bf16 a[120:123], v[136:139], v[188:191], a[120:123]
v_mfma_f32_16x16x32_bf16 a[124:127], v[140:143], v[188:191], a[124:127]
s_add_u32 s4, s4, s8
s_addc_u32 s5, s5, 0
s_waitcnt lgkmcnt(0)
v_mfma_f32_16x16x32_bf16 a[0:3], v[192:195], v[224:227], a[0:3]
v_mfma_f32_16x16x32_bf16 a[4:7], v[196:199], v[224:227], a[4:7]
s_add_u32 m0, s26, 65536
v_mfma_f32_16x16x32_bf16 a[8:11], v[200:203], v[224:227], a[8:11]
global_load_lds_dwordx4 v6, s[6:7]
v_mfma_f32_16x16x32_bf16 a[12:15], v[204:207], v[224:227], a[12:15]
v_mfma_f32_16x16x32_bf16 a[16:19], v[192:195], v[228:231], a[16:19]
v_mfma_f32_16x16x32_bf16 a[20:23], v[196:199], v[228:231], a[20:23]
s_add_u32 m0, s26, 66560
v_mfma_f32_16x16x32_bf16 a[24:27], v[200:203], v[228:231], a[24:27]
global_load_lds_dwordx4 v7, s[6:7]
v_mfma_f32_16x16x32_bf16 a[28:31], v[204:207], v[228:231], a[28:31]
v_mfma_f32_16x16x32_bf16 a[32:35], v[192:195], v[232:235], a[32:35]
v_mfma_f32_16x16x32_bf16 a[36:39], v[196:199], v[232:235], a[36:39]
s_add_u32 m0, s26, 67584
v_mfma_f32_16x16x32_bf16 a[40:43], v[200:203], v[232:235], a[40:43]
global_load_lds_dwordx4 v8, s[6:7]
v_mfma_f32_16x16x32_bf16 a[44:47], v[204:207], v[232:235], a[44:47]
v_mfma_f32_16x16x32_bf16 a[48:51], v[192:195], v[236:239], a[48:51]
v_mfma_f32_16x16x32_bf16 a[52:55], v[196:199], v[236:239], a[52:55]
s_add_u32 m0, s26, 68608
v_mfma_f32_16x16x32_bf16 a[56:59], v[200:203], v[236:239], a[56:59]
global_load_lds_dwordx4 v9, s[6:7]
v_mfma_f32_16x16x32_bf16 a[60:63], v[204:207], v[236:239], a[60:63]
s_add_u32 s6, s6, s9
s_addc_u32 s7, s7, 0
s_waitcnt vmcnt(12)
s_barrier
v_mfma_f32_16x16x32_bf16 a[64:67], v[192:195], v[240:243], a[64:67]
ds_read_b64_tr_b16 v[160:161], v26 offset:0
ds_read_b64_tr_b16 v[162:163], v26 offset:2048
v_mfma_f32_16x16x32_bf16 a[68:71], v[196:199], v[240:243], a[68:71]
s_add_u32 m0, s29, 98304
ds_read_b128 v[128:131], v10 offset:0
ds_read_b128 v[132:135], v10 offset:1024
v_mfma_f32_16x16x32_bf16 a[72:75], v[200:203], v[240:243], a[72:75]
global_load_lds_dwordx4 v2, s[4:5] sc1
ds_read_b128 v[136:139], v10 offset:2048
ds_read_b128 v[140:143], v10 offset:3072
v_mfma_f32_16x16x32_bf16 a[76:79], v[204:207], v[240:243], a[76:79]
ds_read_b64_tr_b16 v[164:165], v27 offset:0
ds_read_b64_tr_b16 v[166:167], v27 offset:2048
v_mfma_f32_16x16x32_bf16 a[80:83], v[192:195], v[244:247], a[80:83]
ds_read_b64_tr_b16 v[168:169], v28 offset:0
ds_read_b64_tr_b16 v[170:171], v28 offset:2048
v_mfma_f32_16x16x32_bf16 a[84:87], v[196:199], v[244:247], a[84:87]
ds_read_b64_tr_b16 v[172:173], v29 offset:0
ds_read_b64_tr_b16 v[174:175], v29 offset:2048
v_mfma_f32_16x16x32_bf16 a[88:91], v[200:203], v[244:247], a[88:91]
ds_read_b64_tr_b16 v[176:177], v30 offset:0
ds_read_b64_tr_b16 v[178:179], v30 offset:2048
v_mfma_f32_16x16x32_bf16 a[92:95], v[204:207], v[244:247], a[92:95]
ds_read_b64_tr_b16 v[180:181], v31 offset:0
ds_read_b64_tr_b16 v[182:183], v31 offset:2048
v_mfma_f32_16x16x32_bf16 a[96:99], v[192:195], v[248:251], a[96:99]
ds_read_b64_tr_b16 v[184:185], v32 offset:0
ds_read_b64_tr_b16 v[186:187], v32 offset:2048
v_mfma_f32_16x16x32_bf16 a[100:103], v[196:199], v[248:251], a[100:103]
s_add_u32 m0, s29, 99328
ds_read_b64_tr_b16 v[188:189], v33 offset:0
ds_read_b64_tr_b16 v[190:191], v33 offset:2048
v_mfma_f32_16x16x32_bf16 a[104:107], v[200:203], v[248:251], a[104:107]
global_load_lds_dwordx4 v3, s[4:5] sc1
v_mfma_f32_16x16x32_bf16 a[108:111], v[204:207], v[248:251], a[108:111]
v_mfma_f32_16x16x32_bf16 a[112:115], v[192:195], v[252:255], a[112:115]
v_mfma_f32_16x16x32_bf16 a[116:119], v[196:199], v[252:255], a[116:119]
v_mfma_f32_16x16x32_bf16 a[120:123], v[200:203], v[252:255], a[120:123]
v_mfma_f32_16x16x32_bf16 a[124:127], v[204:207], v[252:255], a[124:127]
s_add_u32 s4, s4, s8
s_addc_u32 s5, s5, 0
s_sub_u32 s11, s11, 1
s_cmp_eq_u32 s11, 0
s_cbranch_scc1 M_gle_117
s_waitcnt lgkmcnt(0)
v_mfma_f32_16x16x32_bf16 a[0:3], v[128:131], v[160:163], a[0:3]
v_mfma_f32_16x16x32_bf16 a[4:7], v[132:135], v[160:163], a[4:7]
s_add_u32 m0, s26, 98304
v_mfma_f32_16x16x32_bf16 a[8:11], v[136:139], v[160:163], a[8:11]
global_load_lds_dwordx4 v6, s[6:7]
v_mfma_f32_16x16x32_bf16 a[12:15], v[140:143], v[160:163], a[12:15]
v_mfma_f32_16x16x32_bf16 a[16:19], v[128:131], v[164:167], a[16:19]
v_mfma_f32_16x16x32_bf16 a[20:23], v[132:135], v[164:167], a[20:23]
s_add_u32 m0, s26, 99328
v_mfma_f32_16x16x32_bf16 a[24:27], v[136:139], v[164:167], a[24:27]
global_load_lds_dwordx4 v7, s[6:7]
v_mfma_f32_16x16x32_bf16 a[28:31], v[140:143], v[164:167], a[28:31]
v_mfma_f32_16x16x32_bf16 a[32:35], v[128:131], v[168:171], a[32:35]
v_mfma_f32_16x16x32_bf16 a[36:39], v[132:135], v[168:171], a[36:39]
s_add_u32 m0, s26, 100352
v_mfma_f32_16x16x32_bf16 a[40:43], v[136:139], v[168:171], a[40:43]
global_load_lds_dwordx4 v8, s[6:7]
v_mfma_f32_16x16x32_bf16 a[44:47], v[140:143], v[168:171], a[44:47]
v_mfma_f32_16x16x32_bf16 a[48:51], v[128:131], v[172:175], a[48:51]
v_mfma_f32_16x16x32_bf16 a[52:55], v[132:135], v[172:175], a[52:55]
s_add_u32 m0, s26, 101376
v_mfma_f32_16x16x32_bf16 a[56:59], v[136:139], v[172:175], a[56:59]
global_load_lds_dwordx4 v9, s[6:7]
v_mfma_f32_16x16x32_bf16 a[60:63], v[140:143], v[172:175], a[60:63]
s_add_u32 s6, s6, s9
s_addc_u32 s7, s7, 0
s_waitcnt vmcnt(12)
s_barrier
v_mfma_f32_16x16x32_bf16 a[64:67], v[128:131], v[176:179], a[64:67]
ds_read_b64_tr_b16 v[224:225], v26 offset:32768
ds_read_b64_tr_b16 v[226:227], v26 offset:34816
v_mfma_f32_16x16x32_bf16 a[68:71], v[132:135], v[176:179], a[68:71]
s_add_u32 m0, s29, 0
ds_read_b128 v[192:195], v10 offset:32768
ds_read_b128 v[196:199], v10 offset:33792
v_mfma_f32_16x16x32_bf16 a[72:75], v[136:139], v[176:179], a[72:75]
global_load_lds_dwordx4 v2, s[4:5] sc1
ds_read_b128 v[200:203], v10 offset:34816
ds_read_b128 v[204:207], v10 offset:35840
v_mfma_f32_16x16x32_bf16 a[76:79], v[140:143], v[176:179], a[76:79]
ds_read_b64_tr_b16 v[228:229], v27 offset:32768
ds_read_b64_tr_b16 v[230:231], v27 offset:34816
v_mfma_f32_16x16x32_bf16 a[80:83], v[128:131], v[180:183], a[80:83]
ds_read_b64_tr_b16 v[232:233], v28 offset:32768
ds_read_b64_tr_b16 v[234:235], v28 offset:34816
v_mfma_f32_16x16x32_bf16 a[84:87], v[132:135], v[180:183], a[84:87]
ds_read_b64_tr_b16 v[236:237], v29 offset:32768
ds_read_b64_tr_b16 v[238:239], v29 offset:34816
v_mfma_f32_16x16x32_bf16 a[88:91], v[136:139], v[180:183], a[88:91]
ds_read_b64_tr_b16 v[240:241], v30 offset:32768
ds_read_b64_tr_b16 v[242:243], v30 offset:34816
v_mfma_f32_16x16x32_bf16 a[92:95], v[140:143], v[180:183], a[92:95]
ds_read_b64_tr_b16 v[244:245], v31 offset:32768
ds_read_b64_tr_b16 v[246:247], v31 offset:34816
v_mfma_f32_16x16x32_bf16 a[96:99], v[128:131], v[184:187], a[96:99]
ds_read_b64_tr_b16 v[248:249], v32 offset:32768
ds_read_b64_tr_b16 v[250:251], v32 offset:34816
v_mfma_f32_16x16x32_bf16 a[100:103], v[132:135], v[184:187], a[100:103]
s_add_u32 m0, s29, 1024
ds_read_b64_tr_b16 v[252:253], v33 offset:32768
ds_read_b64_tr_b16 v[254:255], v33 offset:34816
v_mfma_f32_16x16x32_bf16 a[104:107], v[136:139], v[184:187], a[104:107]
global_load_lds_dwordx4 v3, s[4:5] sc1
v_mfma_f32_16x16x32_bf16 a[108:111], v[140:143], v[184:187], a[108:111]
v_mfma_f32_16x16x32_bf16 a[112:115], v[128:131], v[188:191], a[112:115]
v_mfma_f32_16x16x32_bf16 a[116:119], v[132:135], v[188:191], a[116:119]
v_mfma_f32_16x16x32_bf16 a[120:123], v[136:139], v[188:191], a[120:123]
v_mfma_f32_16x16x32_bf16 a[124:127], v[140:143], v[188:191], a[124:127]
s_add_u32 s4, s4, s8
s_addc_u32 s5, s5, 0
s_branch M_gl_116
M_gle_117:
s_waitcnt lgkmcnt(0)
v_mfma_f32_16x16x32_bf16 a[0:3], v[128:131], v[160:163], a[0:3]
v_mfma_f32_16x16x32_bf16 a[4:7], v[132:135], v[160:163], a[4:7]
s_add_u32 m0, s26, 98304
v_mfma_f32_16x16x32_bf16 a[8:11], v[136:139], v[160:163], a[8:11]
global_load_lds_dwordx4 v6, s[6:7]
v_mfma_f32_16x16x32_bf16 a[12:15], v[140:143], v[160:163], a[12:15]
v_mfma_f32_16x16x32_bf16 a[16:19], v[128:131], v[164:167], a[16:19]
v_mfma_f32_16x16x32_bf16 a[20:23], v[132:135], v[164:167], a[20:23]
s_add_u32 m0, s26, 99328
v_mfma_f32_16x16x32_bf16 a[24:27], v[136:139], v[164:167], a[24:27]
global_load_lds_dwordx4 v7, s[6:7]
v_mfma_f32_16x16x32_bf16 a[28:31], v[140:143], v[164:167], a[28:31]
v_mfma_f32_16x16x32_bf16 a[32:35], v[128:131], v[168:171], a[32:35]
v_mfma_f32_16x16x32_bf16 a[36:39], v[132:135], v[168:171], a[36:39]
s_add_u32 m0, s26, 100352
v_mfma_f32_16x16x32_bf16 a[40:43], v[136:139], v[168:171], a[40:43]
global_load_lds_dwordx4 v8, s[6:7]
v_mfma_f32_16x16x32_bf16 a[44:47], v[140:143], v[168:171], a[44:47]
v_mfma_f32_16x16x32_bf16 a[48:51], v[128:131], v[172:175], a[48:51]
v_mfma_f32_16x16x32_bf16 a[52:55], v[132:135], v[172:175], a[52:55]
s_add_u32 m0, s26, 101376
v_mfma_f32_16x16x32_bf16 a[56:59], v[136:139], v[172:175], a[56:59]
global_load_lds_dwordx4 v9, s[6:7]
v_mfma_f32_16x16x32_bf16 a[60:63], v[140:143], v[172:175], a[60:63]
s_add_u32 s6, s6, s9
s_addc_u32 s7, s7, 0
s_waitcnt vmcnt(12)
s_barrier
v_mfma_f32_16x16x32_bf16 a[64:67], v[128:131], v[176:179], a[64:67]
ds_read_b64_tr_b16 v[224:225], v26 offset:32768
ds_read_b64_tr_b16 v[226:227], v26 offset:34816
v_mfma_f32_16x16x32_bf16 a[68:71], v[132:135], v[176:179], a[68:71]
ds_read_b128 v[192:195], v10 offset:32768
ds_read_b128 v[196:199], v10 offset:33792
v_mfma_f32_16x16x32_bf16 a[72:75], v[136:139], v[176:179], a[72:75]
ds_read_b128 v[200:203], v10 offset:34816
ds_read_b128 v[204:207], v10 offset:35840
v_mfma_f32_16x16x32_bf16 a[76:79], v[140:143], v[176:179], a[76:79]
ds_read_b64_tr_b16 v[228:229], v27 offset:32768
ds_read_b64_tr_b16 v[230:231], v27 offset:34816
v_mfma_f32_16x16x32_bf16 a[80:83], v[128:131], v[180:183], a[80:83]
ds_read_b64_tr_b16 v[232:233], v28 offset:32768
ds_read_b64_tr_b16 v[234:235], v28 offset:34816
v_mfma_f32_16x16x32_bf16 a[84:87], v[132:135], v[180:183], a[84:87]
ds_read_b64_tr_b16 v[236:237], v29 offset:32768
ds_read_b64_tr_b16 v[238:239], v29 offset:34816
v_mfma_f32_16x16x32_bf16 a[88:91], v[136:139], v[180:183], a[88:91]
ds_read_b64_tr_b16 v[240:241], v30 offset:32768
ds_read_b64_tr_b16 v[242:243], v30 offset:34816
v_mfma_f32_16x16x32_bf16 a[92:95], v[140:143], v[180:183], a[92:95]
ds_read_b64_tr_b16 v[244:245], v31 offset:32768
ds_read_b64_tr_b16 v[246:247], v31 offset:34816
v_mfma_f32_16x16x32_bf16 a[96:99], v[128:131], v[184:187], a[96:99]
ds_read_b64_tr_b16 v[248:249], v32 offset:32768
ds_read_b64_tr_b16 v[250:251], v32 offset:34816
v_mfma_f32_16x16x32_bf16 a[100:103], v[132:135], v[184:187], a[100:103]
ds_read_b64_tr_b16 v[252:253], v33 offset:32768
ds_read_b64_tr_b16 v[254:255], v33 offset:34816
v_mfma_f32_16x16x32_bf16 a[104:107], v[136:139], v[184:187], a[104:107]
v_mfma_f32_16x16x32_bf16 a[108:111], v[140:143], v[184:187], a[108:111]
v_mfma_f32_16x16x32_bf16 a[112:115], v[128:131], v[188:191], a[112:115]
v_mfma_f32_16x16x32_bf16 a[116:119], v[132:135], v[188:191], a[116:119]
v_mfma_f32_16x16x32_bf16 a[120:123], v[136:139], v[188:191], a[120:123]
v_mfma_f32_16x16x32_bf16 a[124:127], v[140:143], v[188:191], a[124:127]
s_waitcnt lgkmcnt(0)
v_mfma_f32_16x16x32_bf16 a[0:3], v[192:195], v[224:227], a[0:3]
v_mfma_f32_16x16x32_bf16 a[4:7], v[196:199], v[224:227], a[4:7]
v_mfma_f32_16x16x32_bf16 a[8:11], v[200:203], v[224:227], a[8:11]
v_mfma_f32_16x16x32_bf16 a[12:15], v[204:207], v[224:227], a[12:15]
v_mfma_f32_16x16x32_bf16 a[16:19], v[192:195], v[228:231], a[16:19]
v_mfma_f32_16x16x32_bf16 a[20:23], v[196:199], v[228:231], a[20:23]
v_mfma_f32_16x16x32_bf16 a[24:27], v[200:203], v[228:231], a[24:27]
v_mfma_f32_16x16x32_bf16 a[28:31], v[204:207], v[228:231], a[28:31]
v_mfma_f32_16x16x32_bf16 a[32:35], v[192:195], v[232:235], a[32:35]
v_mfma_f32_16x16x32_bf16 a[36:39], v[196:199], v[232:235], a[36:39]
v_mfma_f32_16x16x32_bf16 a[40:43], v[200:203], v[232:235], a[40:43]
v_mfma_f32_16x16x32_bf16 a[44:47], v[204:207], v[232:235], a[44:47]
v_mfma_f32_16x16x32_bf16 a[48:51], v[192:195], v[236:239], a[48:51]
v_mfma_f32_16x16x32_bf16 a[52:55], v[196:199], v[236:239], a[52:55]
v_mfma_f32_16x16x32_bf16 a[56:59], v[200:203], v[236:239], a[56:59]
v_mfma_f32_16x16x32_bf16 a[60:63], v[204:207], v[236:239], a[60:63]
s_waitcnt vmcnt(6)
s_barrier
v_mfma_f32_16x16x32_bf16 a[64:67], v[192:195], v[240:243], a[64:67]
ds_read_b64_tr_b16 v[160:161], v34 offset:0
ds_read_b64_tr_b16 v[162:163], v34 offset:2048
v_mfma_f32_16x16x32_bf16 a[68:71], v[196:199], v[240:243], a[68:71]
ds_read_b128 v[128:131], v11 offset:0
ds_read_b128 v[132:135], v11 offset:1024
v_mfma_f32_16x16x32_bf16 a[72:75], v[200:203], v[240:243], a[72:75]
ds_read_b128 v[136:139], v11 offset:2048
ds_read_b128 v[140:143], v11 offset:3072
v_mfma_f32_16x16x32_bf16 a[76:79], v[204:207], v[240:243], a[76:79]
ds_read_b64_tr_b16 v[164:165], v35 offset:0
ds_read_b64_tr_b16 v[166:167], v35 offset:2048
v_mfma_f32_16x16x32_bf16 a[80:83], v[192:195], v[244:247], a[80:83]
ds_read_b64_tr_b16 v[168:169], v36 offset:0
ds_read_b64_tr_b16 v[170:171], v36 offset:2048
v_mfma_f32_16x16x32_bf16 a[84:87], v[196:199], v[244:247], a[84:87]
ds_read_b64_tr_b16 v[172:173], v37 offset:0
ds_read_b64_tr_b16 v[174:175], v37 offset:2048
v_mfma_f32_16x16x32_bf16 a[88:91], v[200:203], v[244:247], a[88:91]
ds_read_b64_tr_b16 v[176:177], v38 offset:0
ds_read_b64_tr_b16 v[178:179], v38 offset:2048
v_mfma_f32_16x16x32_bf16 a[92:95], v[204:207], v[244:247], a[92:95]
ds_read_b64_tr_b16 v[180:181], v39 offset:0
ds_read_b64_tr_b16 v[182:183], v39 offset:2048
v_mfma_f32_16x16x32_bf16 a[96:99], v[192:195], v[248:251], a[96:99]
ds_read_b64_tr_b16 v[184:185], v40 offset:0
ds_read_b64_tr_b16 v[186:187], v40 offset:2048
v_mfma_f32_16x16x32_bf16 a[100:103], v[196:199], v[248:251], a[100:103]
ds_read_b64_tr_b16 v[188:189], v41 offset:0
ds_read_b64_tr_b16 v[190:191], v41 offset:2048
v_mfma_f32_16x16x32_bf16 a[104:107], v[200:203], v[248:251], a[104:107]
v_mfma_f32_16x16x32_bf16 a[108:111], v[204:207], v[248:251], a[108:111]
v_mfma_f32_16x16x32_bf16 a[112:115], v[192:195], v[252:255], a[112:115]
v_mfma_f32_16x16x32_bf16 a[116:119], v[196:199], v[252:255], a[116:119]
v_mfma_f32_16x16x32_bf16 a[120:123], v[200:203], v[252:255], a[120:123]
v_mfma_f32_16x16x32_bf16 a[124:127], v[204:207], v[252:255], a[124:127]
s_waitcnt lgkmcnt(0)
v_mfma_f32_16x16x32_bf16 a[0:3], v[128:131], v[160:163], a[0:3]
v_mfma_f32_16x16x32_bf16 a[4:7], v[132:135], v[160:163], a[4:7]
v_mfma_f32_16x16x32_bf16 a[8:11], v[136:139], v[160:163], a[8:11]
v_mfma_f32_16x16x32_bf16 a[12:15], v[140:143], v[160:163], a[12:15]
v_mfma_f32_16x16x32_bf16 a[16:19], v[128:131], v[164:167], a[16:19]
v_mfma_f32_16x16x32_bf16 a[20:23], v[132:135], v[164:167], a[20:23]
v_mfma_f32_16x16x32_bf16 a[24:27], v[136:139], v[164:167], a[24:27]
v_mfma_f32_16x16x32_bf16 a[28:31], v[140:143], v[164:167], a[28:31]
v_mfma_f32_16x16x32_bf16 a[32:35], v[128:131], v[168:171], a[32:35]
v_mfma_f32_16x16x32_bf16 a[36:39], v[132:135], v[168:171], a[36:39]
v_mfma_f32_16x16x32_bf16 a[40:43], v[136:139], v[168:171], a[40:43]
v_mfma_f32_16x16x32_bf16 a[44:47], v[140:143], v[168:171], a[44:47]
v_mfma_f32_16x16x32_bf16 a[48:51], v[128:131], v[172:175], a[48:51]
v_mfma_f32_16x16x32_bf16 a[52:55], v[132:135], v[172:175], a[52:55]
v_mfma_f32_16x16x32_bf16 a[56:59], v[136:139], v[172:175], a[56:59]
v_mfma_f32_16x16x32_bf16 a[60:63], v[140:143], v[172:175], a[60:63]
s_waitcnt vmcnt(0)
s_barrier
v_mfma_f32_16x16x32_bf16 a[64:67], v[128:131], v[176:179], a[64:67]
ds_read_b64_tr_b16 v[224:225], v34 offset:32768
ds_read_b64_tr_b16 v[226:227], v34 offset:34816
v_mfma_f32_16x16x32_bf16 a[68:71], v[132:135], v[176:179], a[68:71]
ds_read_b128 v[192:195], v11 offset:32768
ds_read_b128 v[196:199], v11 offset:33792
v_mfma_f32_16x16x32_bf16 a[72:75], v[136:139], v[176:179], a[72:75]
ds_read_b128 v[200:203], v11 offset:34816
ds_read_b128 v[204:207], v11 offset:35840
v_mfma_f32_16x16x32_bf16 a[76:79], v[140:143], v[176:179], a[76:79]
ds_read_b64_tr_b16 v[228:229], v35 offset:32768
ds_read_b64_tr_b16 v[230:231], v35 offset:34816
v_mfma_f32_16x16x32_bf16 a[80:83], v[128:131], v[180:183], a[80:83]
ds_read_b64_tr_b16 v[232:233], v36 offset:32768
ds_read_b64_tr_b16 v[234:235], v36 offset:34816
v_mfma_f32_16x16x32_bf16 a[84:87], v[132:135], v[180:183], a[84:87]
ds_read_b64_tr_b16 v[236:237], v37 offset:32768
ds_read_b64_tr_b16 v[238:239], v37 offset:34816
v_mfma_f32_16x16x32_bf16 a[88:91], v[136:139], v[180:183], a[88:91]
ds_read_b64_tr_b16 v[240:241], v38 offset:32768
ds_read_b64_tr_b16 v[242:243], v38 offset:34816
v_mfma_f32_16x16x32_bf16 a[92:95], v[140:143], v[180:183], a[92:95]
ds_read_b64_tr_b16 v[244:245], v39 offset:32768
ds_read_b64_tr_b16 v[246:247], v39 offset:34816
v_mfma_f32_16x16x32_bf16 a[96:99], v[128:131], v[184:187], a[96:99]
ds_read_b64_tr_b16 v[248:249], v40 offset:32768
ds_read_b64_tr_b16 v[250:251], v40 offset:34816
v_mfma_f32_16x16x32_bf16 a[100:103], v[132:135], v[184:187], a[100:103]
ds_read_b64_tr_b16 v[252:253], v41 offset:32768
ds_read_b64_tr_b16 v[254:255], v41 offset:34816
v_mfma_f32_16x16x32_bf16 a[104:107], v[136:139], v[184:187], a[104:107]
v_mfma_f32_16x16x32_bf16 a[108:111], v[140:143], v[184:187], a[108:111]
v_mfma_f32_16x16x32_bf16 a[112:115], v[128:131], v[188:191], a[112:115]
v_mfma_f32_16x16x32_bf16 a[116:119], v[132:135], v[188:191], a[116:119]
v_mfma_f32_16x16x32_bf16 a[120:123], v[136:139], v[188:191], a[120:123]
v_mfma_f32_16x16x32_bf16 a[124:127], v[140:143], v[188:191], a[124:127]
s_waitcnt lgkmcnt(0)
v_mfma_f32_16x16x32_bf16 a[0:3], v[192:195], v[224:227], a[0:3]
v_mfma_f32_16x16x32_bf16 a[4:7], v[196:199], v[224:227], a[4:7]
v_mfma_f32_16x16x32_bf16 a[8:11], v[200:203], v[224:227], a[8:11]
v_mfma_f32_16x16x32_bf16 a[12:15], v[204:207], v[224:227], a[12:15]
v_mfma_f32_16x16x32_bf16 a[16:19], v[192:195], v[228:231], a[16:19]
v_mfma_f32_16x16x32_bf16 a[20:23], v[196:199], v[228:231], a[20:23]
v_mfma_f32_16x16x32_bf16 a[24:27], v[200:203], v[228:231], a[24:27]
v_mfma_f32_16x16x32_bf16 a[28:31], v[204:207], v[228:231], a[28:31]
v_mfma_f32_16x16x32_bf16 a[32:35], v[192:195], v[232:235], a[32:35]
v_mfma_f32_16x16x32_bf16 a[36:39], v[196:199], v[232:235], a[36:39]
v_mfma_f32_16x16x32_bf16 a[40:43], v[200:203], v[232:235], a[40:43]
v_mfma_f32_16x16x32_bf16 a[44:47], v[204:207], v[232:235], a[44:47]
v_mfma_f32_16x16x32_bf16 a[48:51], v[192:195], v[236:239], a[48:51]
v_mfma_f32_16x16x32_bf16 a[52:55], v[196:199], v[236:239], a[52:55]
v_mfma_f32_16x16x32_bf16 a[56:59], v[200:203], v[236:239], a[56:59]
v_mfma_f32_16x16x32_bf16 a[60:63], v[204:207], v[236:239], a[60:63]
v_mfma_f32_16x16x32_bf16 a[64:67], v[192:195], v[240:243], a[64:67]
v_mfma_f32_16x16x32_bf16 a[68:71], v[196:199], v[240:243], a[68:71]
v_mfma_f32_16x16x32_bf16 a[72:75], v[200:203], v[240:243], a[72:75]
v_mfma_f32_16x16x32_bf16 a[76:79], v[204:207], v[240:243], a[76:79]
v_mfma_f32_16x16x32_bf16 a[80:83], v[192:195], v[244:247], a[80:83]
v_mfma_f32_16x16x32_bf16 a[84:87], v[196:199], v[244:247], a[84:87]
v_mfma_f32_16x16x32_bf16 a[88:91], v[200:203], v[244:247], a[88:91]
v_mfma_f32_16x16x32_bf16 a[92:95], v[204:207], v[244:247], a[92:95]
v_mfma_f32_16x16x32_bf16 a[96:99], v[192:195], v[248:251], a[96:99]
v_mfma_f32_16x16x32_bf16 a[100:103], v[196:199], v[248:251], a[100:103]
v_mfma_f32_16x16x32_bf16 a[104:107], v[200:203], v[248:251], a[104:107]
v_mfma_f32_16x16x32_bf16 a[108:111], v[204:207], v[248:251], a[108:111]
v_mfma_f32_16x16x32_bf16 a[112:115], v[192:195], v[252:255], a[112:115]
v_mfma_f32_16x16x32_bf16 a[116:119], v[196:199], v[252:255], a[116:119]
v_mfma_f32_16x16x32_bf16 a[120:123], v[200:203], v[252:255], a[120:123]
v_mfma_f32_16x16x32_bf16 a[124:127], v[204:207], v[252:255], a[124:127]
v_and_b32 v42, 15, v1
v_lshrrev_b32 v43, 4, v1
v_and_b32 v44, 1, v43
v_lshlrev_b32 v44, 1, v44
v_lshrrev_b32 v45, 1, v43
v_add_u32 v44, v44, v45
s_and_b32 s21, s20, 1
s_lshr_b32 s22, s20, 1
s_mul_i32 s21, s21, 262144
s_mul_i32 s22, s22, 128
s_add_u32 s21, s21, s22
v_mul_u32_u24 v45, 2048, v42
v_lshl_add_u32 v45, v44, 4, v45
v_add_u32 v56, s21, v45
s_and_b32 s22, s20, 1
s_lshl_b32 s22, s22, 8
v_lshlrev_b32 v58, 1, v42
v_add_u32 v58, s22, v58
global_load_ushort v104, v58, s[14:15] offset:0
global_load_ushort v105, v58, s[14:15] offset:32
global_load_ushort v106, v58, s[14:15] offset:64
global_load_ushort v107, v58, s[14:15] offset:96
global_load_ushort v108, v58, s[14:15] offset:128
global_load_ushort v109, v58, s[14:15] offset:160
global_load_ushort v110, v58, s[14:15] offset:192
global_load_ushort v111, v58, s[14:15] offset:224
s_waitcnt vmcnt(0)
v_lshlrev_b32 v104, 16, v104
v_lshlrev_b32 v105, 16, v105
v_lshlrev_b32 v106, 16, v106
v_lshlrev_b32 v107, 16, v107
v_lshlrev_b32 v108, 16, v108
v_lshlrev_b32 v109, 16, v109
v_lshlrev_b32 v110, 16, v110
v_lshlrev_b32 v111, 16, v111
s_mov_b32 s34, 0xbfb8aa3b
s_mov_b32 s35, 0xbfb8aa3b
v_mov_b32 v62, 1.0
v_mov_b32 v63, 1.0
v_accvgpr_read_b32 v64, a0
v_accvgpr_read_b32 v65, a1
v_accvgpr_read_b32 v66, a2
v_accvgpr_read_b32 v67, a3
v_accvgpr_read_b32 v68, a4
v_accvgpr_read_b32 v69, a5
v_accvgpr_read_b32 v70, a6
v_accvgpr_read_b32 v71, a7
v_cvt_pk_bf16_f32 v88, v64, v65
v_cvt_pk_bf16_f32 v90, v66, v67
v_cvt_pk_bf16_f32 v92, v68, v69
v_cvt_pk_bf16_f32 v94, v70, v71
v_lshlrev_b32 v64, 16, v88
v_and_b32 v65, 0xffff0000, v88
v_lshlrev_b32 v66, 16, v90
v_and_b32 v67, 0xffff0000, v90
v_lshlrev_b32 v68, 16, v92
v_and_b32 v69, 0xffff0000, v92
v_lshlrev_b32 v70, 16, v94
v_and_b32 v71, 0xffff0000, v94
v_add_f32 v64, v64, v104
v_add_f32 v65, v65, v104
v_add_f32 v66, v66, v104
v_add_f32 v67, v67, v104
v_add_f32 v68, v68, v104
v_add_f32 v69, v69, v104
v_add_f32 v70, v70, v104
v_add_f32 v71, v71, v104
v_cvt_pk_bf16_f32 v88, v64, v65
v_cvt_pk_bf16_f32 v90, v66, v67
v_cvt_pk_bf16_f32 v92, v68, v69
v_cvt_pk_bf16_f32 v94, v70, v71
v_lshlrev_b32 v64, 16, v88
v_and_b32 v65, 0xffff0000, v88
v_lshlrev_b32 v66, 16, v90
v_and_b32 v67, 0xffff0000, v90
v_lshlrev_b32 v68, 16, v92
v_and_b32 v69, 0xffff0000, v92
v_lshlrev_b32 v70, 16, v94
v_and_b32 v71, 0xffff0000, v94
v_pk_mul_f32 v[88:89], v[64:65], s[34:35]
v_pk_mul_f32 v[90:91], v[66:67], s[34:35]
v_pk_mul_f32 v[92:93], v[68:69], s[34:35]
v_pk_mul_f32 v[94:95], v[70:71], s[34:35]
v_exp_f32 v88, v88
v_exp_f32 v89, v89
v_exp_f32 v90, v90
v_exp_f32 v91, v91
v_exp_f32 v92, v92
v_exp_f32 v93, v93
v_exp_f32 v94, v94
v_exp_f32 v95, v95
v_pk_add_f32 v[88:89], v[88:89], v[62:63]
v_pk_add_f32 v[90:91], v[90:91], v[62:63]
v_pk_add_f32 v[92:93], v[92:93], v[62:63]
v_pk_add_f32 v[94:95], v[94:95], v[62:63]
v_rcp_f32 v88, v88
v_rcp_f32 v89, v89
v_rcp_f32 v90, v90
v_rcp_f32 v91, v91
v_rcp_f32 v92, v92
v_rcp_f32 v93, v93
v_rcp_f32 v94, v94
v_rcp_f32 v95, v95
v_pk_mul_f32 v[64:65], v[64:65], v[88:89]
v_pk_mul_f32 v[66:67], v[66:67], v[90:91]
v_pk_mul_f32 v[68:69], v[68:69], v[92:93]
v_pk_mul_f32 v[70:71], v[70:71], v[94:95]
v_cvt_pk_bf16_f32 v80, v64, v65
v_cvt_pk_bf16_f32 v81, v66, v67
v_cvt_pk_bf16_f32 v82, v68, v69
v_cvt_pk_bf16_f32 v83, v70, v71
s_nop 0
v_permlane16_swap_b32 v80, v82
v_permlane16_swap_b32 v81, v83
global_store_dwordx4 v56, v[80:83], s[12:13] offset:0 sc1
v_accvgpr_read_b32 v72, a8
v_accvgpr_read_b32 v73, a9
v_accvgpr_read_b32 v74, a10
v_accvgpr_read_b32 v75, a11
v_accvgpr_read_b32 v76, a12
v_accvgpr_read_b32 v77, a13
v_accvgpr_read_b32 v78, a14
v_accvgpr_read_b32 v79, a15
v_cvt_pk_bf16_f32 v88, v72, v73
v_cvt_pk_bf16_f32 v90, v74, v75
v_cvt_pk_bf16_f32 v92, v76, v77
v_cvt_pk_bf16_f32 v94, v78, v79
v_lshlrev_b32 v72, 16, v88
v_and_b32 v73, 0xffff0000, v88
v_lshlrev_b32 v74, 16, v90
v_and_b32 v75, 0xffff0000, v90
v_lshlrev_b32 v76, 16, v92
v_and_b32 v77, 0xffff0000, v92
v_lshlrev_b32 v78, 16, v94
v_and_b32 v79, 0xffff0000, v94
v_add_f32 v72, v72, v104
v_add_f32 v73, v73, v104
v_add_f32 v74, v74, v104
v_add_f32 v75, v75, v104
v_add_f32 v76, v76, v104
v_add_f32 v77, v77, v104
v_add_f32 v78, v78, v104
v_add_f32 v79, v79, v104
v_cvt_pk_bf16_f32 v88, v72, v73
v_cvt_pk_bf16_f32 v90, v74, v75
v_cvt_pk_bf16_f32 v92, v76, v77
v_cvt_pk_bf16_f32 v94, v78, v79
v_lshlrev_b32 v72, 16, v88
v_and_b32 v73, 0xffff0000, v88
v_lshlrev_b32 v74, 16, v90
v_and_b32 v75, 0xffff0000, v90
v_lshlrev_b32 v76, 16, v92
v_and_b32 v77, 0xffff0000, v92
v_lshlrev_b32 v78, 16, v94
v_and_b32 v79, 0xffff0000, v94
v_pk_mul_f32 v[88:89], v[72:73], s[34:35]
v_pk_mul_f32 v[90:91], v[74:75], s[34:35]
v_pk_mul_f32 v[92:93], v[76:77], s[34:35]
v_pk_mul_f32 v[94:95], v[78:79], s[34:35]
v_exp_f32 v88, v88
v_exp_f32 v89, v89
v_exp_f32 v90, v90
v_exp_f32 v91, v91
v_exp_f32 v92, v92
v_exp_f32 v93, v93
v_exp_f32 v94, v94
v_exp_f32 v95, v95
v_pk_add_f32 v[88:89], v[88:89], v[62:63]
v_pk_add_f32 v[90:91], v[90:91], v[62:63]
v_pk_add_f32 v[92:93], v[92:93], v[62:63]
v_pk_add_f32 v[94:95], v[94:95], v[62:63]
v_rcp_f32 v88, v88
v_rcp_f32 v89, v89
v_rcp_f32 v90, v90
v_rcp_f32 v91, v91
v_rcp_f32 v92, v92
v_rcp_f32 v93, v93
v_rcp_f32 v94, v94
v_rcp_f32 v95, v95
v_pk_mul_f32 v[72:73], v[72:73], v[88:89]
v_pk_mul_f32 v[74:75], v[74:75], v[90:91]
v_pk_mul_f32 v[76:77], v[76:77], v[92:93]
v_pk_mul_f32 v[78:79], v[78:79], v[94:95]
v_cvt_pk_bf16_f32 v84, v72, v73
v_cvt_pk_bf16_f32 v85, v74, v75
v_cvt_pk_bf16_f32 v86, v76, v77
v_cvt_pk_bf16_f32 v87, v78, v79
s_nop 0
v_permlane16_swap_b32 v84, v86
v_permlane16_swap_b32 v85, v87
global_store_dwordx4 v56, v[84:87], s[12:13] offset:64 sc1
s_add_u32 s12, s12, 32768
s_addc_u32 s13, s13, 0
v_accvgpr_read_b32 v64, a16
v_accvgpr_read_b32 v65, a17
v_accvgpr_read_b32 v66, a18
v_accvgpr_read_b32 v67, a19
v_accvgpr_read_b32 v68, a20
v_accvgpr_read_b32 v69, a21
v_accvgpr_read_b32 v70, a22
v_accvgpr_read_b32 v71, a23
v_cvt_pk_bf16_f32 v88, v64, v65
v_cvt_pk_bf16_f32 v90, v66, v67
v_cvt_pk_bf16_f32 v92, v68, v69
v_cvt_pk_bf16_f32 v94, v70, v71
v_lshlrev_b32 v64, 16, v88
v_and_b32 v65, 0xffff0000, v88
v_lshlrev_b32 v66, 16, v90
v_and_b32 v67, 0xffff0000, v90
v_lshlrev_b32 v68, 16, v92
v_and_b32 v69, 0xffff0000, v92
v_lshlrev_b32 v70, 16, v94
v_and_b32 v71, 0xffff0000, v94
v_add_f32 v64, v64, v105
v_add_f32 v65, v65, v105
v_add_f32 v66, v66, v105
v_add_f32 v67, v67, v105
v_add_f32 v68, v68, v105
v_add_f32 v69, v69, v105
v_add_f32 v70, v70, v105
v_add_f32 v71, v71, v105
v_cvt_pk_bf16_f32 v88, v64, v65
v_cvt_pk_bf16_f32 v90, v66, v67
v_cvt_pk_bf16_f32 v92, v68, v69
v_cvt_pk_bf16_f32 v94, v70, v71
v_lshlrev_b32 v64, 16, v88
v_and_b32 v65, 0xffff0000, v88
v_lshlrev_b32 v66, 16, v90
v_and_b32 v67, 0xffff0000, v90
v_lshlrev_b32 v68, 16, v92
v_and_b32 v69, 0xffff0000, v92
v_lshlrev_b32 v70, 16, v94
v_and_b32 v71, 0xffff0000, v94
v_pk_mul_f32 v[88:89], v[64:65], s[34:35]
v_pk_mul_f32 v[90:91], v[66:67], s[34:35]
v_pk_mul_f32 v[92:93], v[68:69], s[34:35]
v_pk_mul_f32 v[94:95], v[70:71], s[34:35]
v_exp_f32 v88, v88
v_exp_f32 v89, v89
v_exp_f32 v90, v90
v_exp_f32 v91, v91
v_exp_f32 v92, v92
v_exp_f32 v93, v93
v_exp_f32 v94, v94
v_exp_f32 v95, v95
v_pk_add_f32 v[88:89], v[88:89], v[62:63]
v_pk_add_f32 v[90:91], v[90:91], v[62:63]
v_pk_add_f32 v[92:93], v[92:93], v[62:63]
v_pk_add_f32 v[94:95], v[94:95], v[62:63]
v_rcp_f32 v88, v88
v_rcp_f32 v89, v89
v_rcp_f32 v90, v90
v_rcp_f32 v91, v91
v_rcp_f32 v92, v92
v_rcp_f32 v93, v93
v_rcp_f32 v94, v94
v_rcp_f32 v95, v95
v_pk_mul_f32 v[64:65], v[64:65], v[88:89]
v_pk_mul_f32 v[66:67], v[66:67], v[90:91]
v_pk_mul_f32 v[68:69], v[68:69], v[92:93]
v_pk_mul_f32 v[70:71], v[70:71], v[94:95]
v_cvt_pk_bf16_f32 v80, v64, v65
v_cvt_pk_bf16_f32 v81, v66, v67
v_cvt_pk_bf16_f32 v82, v68, v69
v_cvt_pk_bf16_f32 v83, v70, v71
s_nop 0
v_permlane16_swap_b32 v80, v82
v_permlane16_swap_b32 v81, v83
global_store_dwordx4 v56, v[80:83], s[12:13] offset:0 sc1
v_accvgpr_read_b32 v72, a24
v_accvgpr_read_b32 v73, a25
v_accvgpr_read_b32 v74, a26
v_accvgpr_read_b32 v75, a27
v_accvgpr_read_b32 v76, a28
v_accvgpr_read_b32 v77, a29
v_accvgpr_read_b32 v78, a30
v_accvgpr_read_b32 v79, a31
v_cvt_pk_bf16_f32 v88, v72, v73
v_cvt_pk_bf16_f32 v90, v74, v75
v_cvt_pk_bf16_f32 v92, v76, v77
v_cvt_pk_bf16_f32 v94, v78, v79
v_lshlrev_b32 v72, 16, v88
v_and_b32 v73, 0xffff0000, v88
v_lshlrev_b32 v74, 16, v90
v_and_b32 v75, 0xffff0000, v90
v_lshlrev_b32 v76, 16, v92
v_and_b32 v77, 0xffff0000, v92
v_lshlrev_b32 v78, 16, v94
v_and_b32 v79, 0xffff0000, v94
v_add_f32 v72, v72, v105
v_add_f32 v73, v73, v105
v_add_f32 v74, v74, v105
v_add_f32 v75, v75, v105
v_add_f32 v76, v76, v105
v_add_f32 v77, v77, v105
v_add_f32 v78, v78, v105
v_add_f32 v79, v79, v105
v_cvt_pk_bf16_f32 v88, v72, v73
v_cvt_pk_bf16_f32 v90, v74, v75
v_cvt_pk_bf16_f32 v92, v76, v77
v_cvt_pk_bf16_f32 v94, v78, v79
v_lshlrev_b32 v72, 16, v88
v_and_b32 v73, 0xffff0000, v88
v_lshlrev_b32 v74, 16, v90
v_and_b32 v75, 0xffff0000, v90
v_lshlrev_b32 v76, 16, v92
v_and_b32 v77, 0xffff0000, v92
v_lshlrev_b32 v78, 16, v94
v_and_b32 v79, 0xffff0000, v94
v_pk_mul_f32 v[88:89], v[72:73], s[34:35]
v_pk_mul_f32 v[90:91], v[74:75], s[34:35]
v_pk_mul_f32 v[92:93], v[76:77], s[34:35]
v_pk_mul_f32 v[94:95], v[78:79], s[34:35]
v_exp_f32 v88, v88
v_exp_f32 v89, v89
v_exp_f32 v90, v90
v_exp_f32 v91, v91
v_exp_f32 v92, v92
v_exp_f32 v93, v93
v_exp_f32 v94, v94
v_exp_f32 v95, v95
v_pk_add_f32 v[88:89], v[88:89], v[62:63]
v_pk_add_f32 v[90:91], v[90:91], v[62:63]
v_pk_add_f32 v[92:93], v[92:93], v[62:63]
v_pk_add_f32 v[94:95], v[94:95], v[62:63]
v_rcp_f32 v88, v88
v_rcp_f32 v89, v89
v_rcp_f32 v90, v90
v_rcp_f32 v91, v91
v_rcp_f32 v92, v92
v_rcp_f32 v93, v93
v_rcp_f32 v94, v94
v_rcp_f32 v95, v95
v_pk_mul_f32 v[72:73], v[72:73], v[88:89]
v_pk_mul_f32 v[74:75], v[74:75], v[90:91]
v_pk_mul_f32 v[76:77], v[76:77], v[92:93]
v_pk_mul_f32 v[78:79], v[78:79], v[94:95]
v_cvt_pk_bf16_f32 v84, v72, v73
v_cvt_pk_bf16_f32 v85, v74, v75
v_cvt_pk_bf16_f32 v86, v76, v77
v_cvt_pk_bf16_f32 v87, v78, v79
s_nop 0
v_permlane16_swap_b32 v84, v86
v_permlane16_swap_b32 v85, v87
global_store_dwordx4 v56, v[84:87], s[12:13] offset:64 sc1
s_add_u32 s12, s12, 32768
s_addc_u32 s13, s13, 0
v_accvgpr_read_b32 v64, a32
v_accvgpr_read_b32 v65, a33
v_accvgpr_read_b32 v66, a34
v_accvgpr_read_b32 v67, a35
v_accvgpr_read_b32 v68, a36
v_accvgpr_read_b32 v69, a37
v_accvgpr_read_b32 v70, a38
v_accvgpr_read_b32 v71, a39
v_cvt_pk_bf16_f32 v88, v64, v65
v_cvt_pk_bf16_f32 v90, v66, v67
v_cvt_pk_bf16_f32 v92, v68, v69
v_cvt_pk_bf16_f32 v94, v70, v71
v_lshlrev_b32 v64, 16, v88
v_and_b32 v65, 0xffff0000, v88
v_lshlrev_b32 v66, 16, v90
v_and_b32 v67, 0xffff0000, v90
v_lshlrev_b32 v68, 16, v92
v_and_b32 v69, 0xffff0000, v92
v_lshlrev_b32 v70, 16, v94
v_and_b32 v71, 0xffff0000, v94
v_add_f32 v64, v64, v106
v_add_f32 v65, v65, v106
v_add_f32 v66, v66, v106
v_add_f32 v67, v67, v106
v_add_f32 v68, v68, v106
v_add_f32 v69, v69, v106
v_add_f32 v70, v70, v106
v_add_f32 v71, v71, v106
v_cvt_pk_bf16_f32 v88, v64, v65
v_cvt_pk_bf16_f32 v90, v66, v67
v_cvt_pk_bf16_f32 v92, v68, v69
v_cvt_pk_bf16_f32 v94, v70, v71
v_lshlrev_b32 v64, 16, v88
v_and_b32 v65, 0xffff0000, v88
v_lshlrev_b32 v66, 16, v90
v_and_b32 v67, 0xffff0000, v90
v_lshlrev_b32 v68, 16, v92
v_and_b32 v69, 0xffff0000, v92
v_lshlrev_b32 v70, 16, v94
v_and_b32 v71, 0xffff0000, v94
v_pk_mul_f32 v[88:89], v[64:65], s[34:35]
v_pk_mul_f32 v[90:91], v[66:67], s[34:35]
v_pk_mul_f32 v[92:93], v[68:69], s[34:35]
v_pk_mul_f32 v[94:95], v[70:71], s[34:35]
v_exp_f32 v88, v88
v_exp_f32 v89, v89
v_exp_f32 v90, v90
v_exp_f32 v91, v91
v_exp_f32 v92, v92
v_exp_f32 v93, v93
v_exp_f32 v94, v94
v_exp_f32 v95, v95
v_pk_add_f32 v[88:89], v[88:89], v[62:63]
v_pk_add_f32 v[90:91], v[90:91], v[62:63]
v_pk_add_f32 v[92:93], v[92:93], v[62:63]
v_pk_add_f32 v[94:95], v[94:95], v[62:63]
v_rcp_f32 v88, v88
v_rcp_f32 v89, v89
v_rcp_f32 v90, v90
v_rcp_f32 v91, v91
v_rcp_f32 v92, v92
v_rcp_f32 v93, v93
v_rcp_f32 v94, v94
v_rcp_f32 v95, v95
v_pk_mul_f32 v[64:65], v[64:65], v[88:89]
v_pk_mul_f32 v[66:67], v[66:67], v[90:91]
v_pk_mul_f32 v[68:69], v[68:69], v[92:93]
v_pk_mul_f32 v[70:71], v[70:71], v[94:95]
v_cvt_pk_bf16_f32 v80, v64, v65
v_cvt_pk_bf16_f32 v81, v66, v67
v_cvt_pk_bf16_f32 v82, v68, v69
v_cvt_pk_bf16_f32 v83, v70, v71
s_nop 0
v_permlane16_swap_b32 v80, v82
v_permlane16_swap_b32 v81, v83
global_store_dwordx4 v56, v[80:83], s[12:13] offset:0 sc1
v_accvgpr_read_b32 v72, a40
v_accvgpr_read_b32 v73, a41
v_accvgpr_read_b32 v74, a42
v_accvgpr_read_b32 v75, a43
v_accvgpr_read_b32 v76, a44
v_accvgpr_read_b32 v77, a45
v_accvgpr_read_b32 v78, a46
v_accvgpr_read_b32 v79, a47
v_cvt_pk_bf16_f32 v88, v72, v73
v_cvt_pk_bf16_f32 v90, v74, v75
v_cvt_pk_bf16_f32 v92, v76, v77
v_cvt_pk_bf16_f32 v94, v78, v79
v_lshlrev_b32 v72, 16, v88
v_and_b32 v73, 0xffff0000, v88
v_lshlrev_b32 v74, 16, v90
v_and_b32 v75, 0xffff0000, v90
v_lshlrev_b32 v76, 16, v92
v_and_b32 v77, 0xffff0000, v92
v_lshlrev_b32 v78, 16, v94
v_and_b32 v79, 0xffff0000, v94
v_add_f32 v72, v72, v106
v_add_f32 v73, v73, v106
v_add_f32 v74, v74, v106
v_add_f32 v75, v75, v106
v_add_f32 v76, v76, v106
v_add_f32 v77, v77, v106
v_add_f32 v78, v78, v106
v_add_f32 v79, v79, v106
v_cvt_pk_bf16_f32 v88, v72, v73
v_cvt_pk_bf16_f32 v90, v74, v75
v_cvt_pk_bf16_f32 v92, v76, v77
v_cvt_pk_bf16_f32 v94, v78, v79
v_lshlrev_b32 v72, 16, v88
v_and_b32 v73, 0xffff0000, v88
v_lshlrev_b32 v74, 16, v90
v_and_b32 v75, 0xffff0000, v90
v_lshlrev_b32 v76, 16, v92
v_and_b32 v77, 0xffff0000, v92
v_lshlrev_b32 v78, 16, v94
v_and_b32 v79, 0xffff0000, v94
v_pk_mul_f32 v[88:89], v[72:73], s[34:35]
v_pk_mul_f32 v[90:91], v[74:75], s[34:35]
v_pk_mul_f32 v[92:93], v[76:77], s[34:35]
v_pk_mul_f32 v[94:95], v[78:79], s[34:35]
v_exp_f32 v88, v88
v_exp_f32 v89, v89
v_exp_f32 v90, v90
v_exp_f32 v91, v91
v_exp_f32 v92, v92
v_exp_f32 v93, v93
v_exp_f32 v94, v94
v_exp_f32 v95, v95
v_pk_add_f32 v[88:89], v[88:89], v[62:63]
v_pk_add_f32 v[90:91], v[90:91], v[62:63]
v_pk_add_f32 v[92:93], v[92:93], v[62:63]
v_pk_add_f32 v[94:95], v[94:95], v[62:63]
v_rcp_f32 v88, v88
v_rcp_f32 v89, v89
v_rcp_f32 v90, v90
v_rcp_f32 v91, v91
v_rcp_f32 v92, v92
v_rcp_f32 v93, v93
v_rcp_f32 v94, v94
v_rcp_f32 v95, v95
v_pk_mul_f32 v[72:73], v[72:73], v[88:89]
v_pk_mul_f32 v[74:75], v[74:75], v[90:91]
v_pk_mul_f32 v[76:77], v[76:77], v[92:93]
v_pk_mul_f32 v[78:79], v[78:79], v[94:95]
v_cvt_pk_bf16_f32 v84, v72, v73
v_cvt_pk_bf16_f32 v85, v74, v75
v_cvt_pk_bf16_f32 v86, v76, v77
v_cvt_pk_bf16_f32 v87, v78, v79
s_nop 0
v_permlane16_swap_b32 v84, v86
v_permlane16_swap_b32 v85, v87
global_store_dwordx4 v56, v[84:87], s[12:13] offset:64 sc1
s_add_u32 s12, s12, 32768
s_addc_u32 s13, s13, 0
v_accvgpr_read_b32 v64, a48
v_accvgpr_read_b32 v65, a49
v_accvgpr_read_b32 v66, a50
v_accvgpr_read_b32 v67, a51
v_accvgpr_read_b32 v68, a52
v_accvgpr_read_b32 v69, a53
v_accvgpr_read_b32 v70, a54
v_accvgpr_read_b32 v71, a55
v_cvt_pk_bf16_f32 v88, v64, v65
v_cvt_pk_bf16_f32 v90, v66, v67
v_cvt_pk_bf16_f32 v92, v68, v69
v_cvt_pk_bf16_f32 v94, v70, v71
v_lshlrev_b32 v64, 16, v88
v_and_b32 v65, 0xffff0000, v88
v_lshlrev_b32 v66, 16, v90
v_and_b32 v67, 0xffff0000, v90
v_lshlrev_b32 v68, 16, v92
v_and_b32 v69, 0xffff0000, v92
v_lshlrev_b32 v70, 16, v94
v_and_b32 v71, 0xffff0000, v94
v_add_f32 v64, v64, v107
v_add_f32 v65, v65, v107
v_add_f32 v66, v66, v107
v_add_f32 v67, v67, v107
v_add_f32 v68, v68, v107
v_add_f32 v69, v69, v107
v_add_f32 v70, v70, v107
v_add_f32 v71, v71, v107
v_cvt_pk_bf16_f32 v88, v64, v65
v_cvt_pk_bf16_f32 v90, v66, v67
v_cvt_pk_bf16_f32 v92, v68, v69
v_cvt_pk_bf16_f32 v94, v70, v71
v_lshlrev_b32 v64, 16, v88
v_and_b32 v65, 0xffff0000, v88
v_lshlrev_b32 v66, 16, v90
v_and_b32 v67, 0xffff0000, v90
v_lshlrev_b32 v68, 16, v92
v_and_b32 v69, 0xffff0000, v92
v_lshlrev_b32 v70, 16, v94
v_and_b32 v71, 0xffff0000, v94
v_pk_mul_f32 v[88:89], v[64:65], s[34:35]
v_pk_mul_f32 v[90:91], v[66:67], s[34:35]
v_pk_mul_f32 v[92:93], v[68:69], s[34:35]
v_pk_mul_f32 v[94:95], v[70:71], s[34:35]
v_exp_f32 v88, v88
v_exp_f32 v89, v89
v_exp_f32 v90, v90
v_exp_f32 v91, v91
v_exp_f32 v92, v92
v_exp_f32 v93, v93
v_exp_f32 v94, v94
v_exp_f32 v95, v95
v_pk_add_f32 v[88:89], v[88:89], v[62:63]
v_pk_add_f32 v[90:91], v[90:91], v[62:63]
v_pk_add_f32 v[92:93], v[92:93], v[62:63]
v_pk_add_f32 v[94:95], v[94:95], v[62:63]
v_rcp_f32 v88, v88
v_rcp_f32 v89, v89
v_rcp_f32 v90, v90
v_rcp_f32 v91, v91
v_rcp_f32 v92, v92
v_rcp_f32 v93, v93
v_rcp_f32 v94, v94
v_rcp_f32 v95, v95
v_pk_mul_f32 v[64:65], v[64:65], v[88:89]
v_pk_mul_f32 v[66:67], v[66:67], v[90:91]
v_pk_mul_f32 v[68:69], v[68:69], v[92:93]
v_pk_mul_f32 v[70:71], v[70:71], v[94:95]
v_cvt_pk_bf16_f32 v80, v64, v65
v_cvt_pk_bf16_f32 v81, v66, v67
v_cvt_pk_bf16_f32 v82, v68, v69
v_cvt_pk_bf16_f32 v83, v70, v71
s_nop 0
v_permlane16_swap_b32 v80, v82
v_permlane16_swap_b32 v81, v83
global_store_dwordx4 v56, v[80:83], s[12:13] offset:0 sc1
v_accvgpr_read_b32 v72, a56
v_accvgpr_read_b32 v73, a57
v_accvgpr_read_b32 v74, a58
v_accvgpr_read_b32 v75, a59
v_accvgpr_read_b32 v76, a60
v_accvgpr_read_b32 v77, a61
v_accvgpr_read_b32 v78, a62
v_accvgpr_read_b32 v79, a63
v_cvt_pk_bf16_f32 v88, v72, v73
v_cvt_pk_bf16_f32 v90, v74, v75
v_cvt_pk_bf16_f32 v92, v76, v77
v_cvt_pk_bf16_f32 v94, v78, v79
v_lshlrev_b32 v72, 16, v88
v_and_b32 v73, 0xffff0000, v88
v_lshlrev_b32 v74, 16, v90
v_and_b32 v75, 0xffff0000, v90
v_lshlrev_b32 v76, 16, v92
v_and_b32 v77, 0xffff0000, v92
v_lshlrev_b32 v78, 16, v94
v_and_b32 v79, 0xffff0000, v94
v_add_f32 v72, v72, v107
v_add_f32 v73, v73, v107
v_add_f32 v74, v74, v107
v_add_f32 v75, v75, v107
v_add_f32 v76, v76, v107
v_add_f32 v77, v77, v107
v_add_f32 v78, v78, v107
v_add_f32 v79, v79, v107
v_cvt_pk_bf16_f32 v88, v72, v73
v_cvt_pk_bf16_f32 v90, v74, v75
v_cvt_pk_bf16_f32 v92, v76, v77
v_cvt_pk_bf16_f32 v94, v78, v79
v_lshlrev_b32 v72, 16, v88
v_and_b32 v73, 0xffff0000, v88
v_lshlrev_b32 v74, 16, v90
v_and_b32 v75, 0xffff0000, v90
v_lshlrev_b32 v76, 16, v92
v_and_b32 v77, 0xffff0000, v92
v_lshlrev_b32 v78, 16, v94
v_and_b32 v79, 0xffff0000, v94
v_pk_mul_f32 v[88:89], v[72:73], s[34:35]
v_pk_mul_f32 v[90:91], v[74:75], s[34:35]
v_pk_mul_f32 v[92:93], v[76:77], s[34:35]
v_pk_mul_f32 v[94:95], v[78:79], s[34:35]
v_exp_f32 v88, v88
v_exp_f32 v89, v89
v_exp_f32 v90, v90
v_exp_f32 v91, v91
v_exp_f32 v92, v92
v_exp_f32 v93, v93
v_exp_f32 v94, v94
v_exp_f32 v95, v95
v_pk_add_f32 v[88:89], v[88:89], v[62:63]
v_pk_add_f32 v[90:91], v[90:91], v[62:63]
v_pk_add_f32 v[92:93], v[92:93], v[62:63]
v_pk_add_f32 v[94:95], v[94:95], v[62:63]
v_rcp_f32 v88, v88
v_rcp_f32 v89, v89
v_rcp_f32 v90, v90
v_rcp_f32 v91, v91
v_rcp_f32 v92, v92
v_rcp_f32 v93, v93
v_rcp_f32 v94, v94
v_rcp_f32 v95, v95
v_pk_mul_f32 v[72:73], v[72:73], v[88:89]
v_pk_mul_f32 v[74:75], v[74:75], v[90:91]
v_pk_mul_f32 v[76:77], v[76:77], v[92:93]
v_pk_mul_f32 v[78:79], v[78:79], v[94:95]
v_cvt_pk_bf16_f32 v84, v72, v73
v_cvt_pk_bf16_f32 v85, v74, v75
v_cvt_pk_bf16_f32 v86, v76, v77
v_cvt_pk_bf16_f32 v87, v78, v79
s_nop 0
v_permlane16_swap_b32 v84, v86
v_permlane16_swap_b32 v85, v87
global_store_dwordx4 v56, v[84:87], s[12:13] offset:64 sc1
s_add_u32 s12, s12, 32768
s_addc_u32 s13, s13, 0
v_accvgpr_read_b32 v64, a64
v_accvgpr_read_b32 v65, a65
v_accvgpr_read_b32 v66, a66
v_accvgpr_read_b32 v67, a67
v_accvgpr_read_b32 v68, a68
v_accvgpr_read_b32 v69, a69
v_accvgpr_read_b32 v70, a70
v_accvgpr_read_b32 v71, a71
v_cvt_pk_bf16_f32 v88, v64, v65
v_cvt_pk_bf16_f32 v90, v66, v67
v_cvt_pk_bf16_f32 v92, v68, v69
v_cvt_pk_bf16_f32 v94, v70, v71
v_lshlrev_b32 v64, 16, v88
v_and_b32 v65, 0xffff0000, v88
v_lshlrev_b32 v66, 16, v90
v_and_b32 v67, 0xffff0000, v90
v_lshlrev_b32 v68, 16, v92
v_and_b32 v69, 0xffff0000, v92
v_lshlrev_b32 v70, 16, v94
v_and_b32 v71, 0xffff0000, v94
v_add_f32 v64, v64, v108
v_add_f32 v65, v65, v108
v_add_f32 v66, v66, v108
v_add_f32 v67, v67, v108
v_add_f32 v68, v68, v108
v_add_f32 v69, v69, v108
v_add_f32 v70, v70, v108
v_add_f32 v71, v71, v108
v_cvt_pk_bf16_f32 v88, v64, v65
v_cvt_pk_bf16_f32 v90, v66, v67
v_cvt_pk_bf16_f32 v92, v68, v69
v_cvt_pk_bf16_f32 v94, v70, v71
v_lshlrev_b32 v64, 16, v88
v_and_b32 v65, 0xffff0000, v88
v_lshlrev_b32 v66, 16, v90
v_and_b32 v67, 0xffff0000, v90
v_lshlrev_b32 v68, 16, v92
v_and_b32 v69, 0xffff0000, v92
v_lshlrev_b32 v70, 16, v94
v_and_b32 v71, 0xffff0000, v94
v_pk_mul_f32 v[88:89], v[64:65], s[34:35]
v_pk_mul_f32 v[90:91], v[66:67], s[34:35]
v_pk_mul_f32 v[92:93], v[68:69], s[34:35]
v_pk_mul_f32 v[94:95], v[70:71], s[34:35]
v_exp_f32 v88, v88
v_exp_f32 v89, v89
v_exp_f32 v90, v90
v_exp_f32 v91, v91
v_exp_f32 v92, v92
v_exp_f32 v93, v93
v_exp_f32 v94, v94
v_exp_f32 v95, v95
v_pk_add_f32 v[88:89], v[88:89], v[62:63]
v_pk_add_f32 v[90:91], v[90:91], v[62:63]
v_pk_add_f32 v[92:93], v[92:93], v[62:63]
v_pk_add_f32 v[94:95], v[94:95], v[62:63]
v_rcp_f32 v88, v88
v_rcp_f32 v89, v89
v_rcp_f32 v90, v90
v_rcp_f32 v91, v91
v_rcp_f32 v92, v92
v_rcp_f32 v93, v93
v_rcp_f32 v94, v94
v_rcp_f32 v95, v95
v_pk_mul_f32 v[64:65], v[64:65], v[88:89]
v_pk_mul_f32 v[66:67], v[66:67], v[90:91]
v_pk_mul_f32 v[68:69], v[68:69], v[92:93]
v_pk_mul_f32 v[70:71], v[70:71], v[94:95]
v_cvt_pk_bf16_f32 v80, v64, v65
v_cvt_pk_bf16_f32 v81, v66, v67
v_cvt_pk_bf16_f32 v82, v68, v69
v_cvt_pk_bf16_f32 v83, v70, v71
s_nop 0
v_permlane16_swap_b32 v80, v82
v_permlane16_swap_b32 v81, v83
global_store_dwordx4 v56, v[80:83], s[12:13] offset:0 sc1
v_accvgpr_read_b32 v72, a72
v_accvgpr_read_b32 v73, a73
v_accvgpr_read_b32 v74, a74
v_accvgpr_read_b32 v75, a75
v_accvgpr_read_b32 v76, a76
v_accvgpr_read_b32 v77, a77
v_accvgpr_read_b32 v78, a78
v_accvgpr_read_b32 v79, a79
v_cvt_pk_bf16_f32 v88, v72, v73
v_cvt_pk_bf16_f32 v90, v74, v75
v_cvt_pk_bf16_f32 v92, v76, v77
v_cvt_pk_bf16_f32 v94, v78, v79
v_lshlrev_b32 v72, 16, v88
v_and_b32 v73, 0xffff0000, v88
v_lshlrev_b32 v74, 16, v90
v_and_b32 v75, 0xffff0000, v90
v_lshlrev_b32 v76, 16, v92
v_and_b32 v77, 0xffff0000, v92
v_lshlrev_b32 v78, 16, v94
v_and_b32 v79, 0xffff0000, v94
v_add_f32 v72, v72, v108
v_add_f32 v73, v73, v108
v_add_f32 v74, v74, v108
v_add_f32 v75, v75, v108
v_add_f32 v76, v76, v108
v_add_f32 v77, v77, v108
v_add_f32 v78, v78, v108
v_add_f32 v79, v79, v108
v_cvt_pk_bf16_f32 v88, v72, v73
v_cvt_pk_bf16_f32 v90, v74, v75
v_cvt_pk_bf16_f32 v92, v76, v77
v_cvt_pk_bf16_f32 v94, v78, v79
v_lshlrev_b32 v72, 16, v88
v_and_b32 v73, 0xffff0000, v88
v_lshlrev_b32 v74, 16, v90
v_and_b32 v75, 0xffff0000, v90
v_lshlrev_b32 v76, 16, v92
v_and_b32 v77, 0xffff0000, v92
v_lshlrev_b32 v78, 16, v94
v_and_b32 v79, 0xffff0000, v94
v_pk_mul_f32 v[88:89], v[72:73], s[34:35]
v_pk_mul_f32 v[90:91], v[74:75], s[34:35]
v_pk_mul_f32 v[92:93], v[76:77], s[34:35]
v_pk_mul_f32 v[94:95], v[78:79], s[34:35]
v_exp_f32 v88, v88
v_exp_f32 v89, v89
v_exp_f32 v90, v90
v_exp_f32 v91, v91
v_exp_f32 v92, v92
v_exp_f32 v93, v93
v_exp_f32 v94, v94
v_exp_f32 v95, v95
v_pk_add_f32 v[88:89], v[88:89], v[62:63]
v_pk_add_f32 v[90:91], v[90:91], v[62:63]
v_pk_add_f32 v[92:93], v[92:93], v[62:63]
v_pk_add_f32 v[94:95], v[94:95], v[62:63]
v_rcp_f32 v88, v88
v_rcp_f32 v89, v89
v_rcp_f32 v90, v90
v_rcp_f32 v91, v91
v_rcp_f32 v92, v92
v_rcp_f32 v93, v93
v_rcp_f32 v94, v94
v_rcp_f32 v95, v95
v_pk_mul_f32 v[72:73], v[72:73], v[88:89]
v_pk_mul_f32 v[74:75], v[74:75], v[90:91]
v_pk_mul_f32 v[76:77], v[76:77], v[92:93]
v_pk_mul_f32 v[78:79], v[78:79], v[94:95]
v_cvt_pk_bf16_f32 v84, v72, v73
v_cvt_pk_bf16_f32 v85, v74, v75
v_cvt_pk_bf16_f32 v86, v76, v77
v_cvt_pk_bf16_f32 v87, v78, v79
s_nop 0
v_permlane16_swap_b32 v84, v86
v_permlane16_swap_b32 v85, v87
global_store_dwordx4 v56, v[84:87], s[12:13] offset:64 sc1
s_add_u32 s12, s12, 32768
s_addc_u32 s13, s13, 0
v_accvgpr_read_b32 v64, a80
v_accvgpr_read_b32 v65, a81
v_accvgpr_read_b32 v66, a82
v_accvgpr_read_b32 v67, a83
v_accvgpr_read_b32 v68, a84
v_accvgpr_read_b32 v69, a85
v_accvgpr_read_b32 v70, a86
v_accvgpr_read_b32 v71, a87
v_cvt_pk_bf16_f32 v88, v64, v65
v_cvt_pk_bf16_f32 v90, v66, v67
v_cvt_pk_bf16_f32 v92, v68, v69
v_cvt_pk_bf16_f32 v94, v70, v71
v_lshlrev_b32 v64, 16, v88
v_and_b32 v65, 0xffff0000, v88
v_lshlrev_b32 v66, 16, v90
v_and_b32 v67, 0xffff0000, v90
v_lshlrev_b32 v68, 16, v92
v_and_b32 v69, 0xffff0000, v92
v_lshlrev_b32 v70, 16, v94
v_and_b32 v71, 0xffff0000, v94
v_add_f32 v64, v64, v109
v_add_f32 v65, v65, v109
v_add_f32 v66, v66, v109
v_add_f32 v67, v67, v109
v_add_f32 v68, v68, v109
v_add_f32 v69, v69, v109
v_add_f32 v70, v70, v109
v_add_f32 v71, v71, v109
v_cvt_pk_bf16_f32 v88, v64, v65
v_cvt_pk_bf16_f32 v90, v66, v67
v_cvt_pk_bf16_f32 v92, v68, v69
v_cvt_pk_bf16_f32 v94, v70, v71
v_lshlrev_b32 v64, 16, v88
v_and_b32 v65, 0xffff0000, v88
v_lshlrev_b32 v66, 16, v90
v_and_b32 v67, 0xffff0000, v90
v_lshlrev_b32 v68, 16, v92
v_and_b32 v69, 0xffff0000, v92
v_lshlrev_b32 v70, 16, v94
v_and_b32 v71, 0xffff0000, v94
v_pk_mul_f32 v[88:89], v[64:65], s[34:35]
v_pk_mul_f32 v[90:91], v[66:67], s[34:35]
v_pk_mul_f32 v[92:93], v[68:69], s[34:35]
v_pk_mul_f32 v[94:95], v[70:71], s[34:35]
v_exp_f32 v88, v88
v_exp_f32 v89, v89
v_exp_f32 v90, v90
v_exp_f32 v91, v91
v_exp_f32 v92, v92
v_exp_f32 v93, v93
v_exp_f32 v94, v94
v_exp_f32 v95, v95
v_pk_add_f32 v[88:89], v[88:89], v[62:63]
v_pk_add_f32 v[90:91], v[90:91], v[62:63]
v_pk_add_f32 v[92:93], v[92:93], v[62:63]
v_pk_add_f32 v[94:95], v[94:95], v[62:63]
v_rcp_f32 v88, v88
v_rcp_f32 v89, v89
v_rcp_f32 v90, v90
v_rcp_f32 v91, v91
v_rcp_f32 v92, v92
v_rcp_f32 v93, v93
v_rcp_f32 v94, v94
v_rcp_f32 v95, v95
v_pk_mul_f32 v[64:65], v[64:65], v[88:89]
v_pk_mul_f32 v[66:67], v[66:67], v[90:91]
v_pk_mul_f32 v[68:69], v[68:69], v[92:93]
v_pk_mul_f32 v[70:71], v[70:71], v[94:95]
v_cvt_pk_bf16_f32 v80, v64, v65
v_cvt_pk_bf16_f32 v81, v66, v67
v_cvt_pk_bf16_f32 v82, v68, v69
v_cvt_pk_bf16_f32 v83, v70, v71
s_nop 0
v_permlane16_swap_b32 v80, v82
v_permlane16_swap_b32 v81, v83
global_store_dwordx4 v56, v[80:83], s[12:13] offset:0 sc1
v_accvgpr_read_b32 v72, a88
v_accvgpr_read_b32 v73, a89
v_accvgpr_read_b32 v74, a90
v_accvgpr_read_b32 v75, a91
v_accvgpr_read_b32 v76, a92
v_accvgpr_read_b32 v77, a93
v_accvgpr_read_b32 v78, a94
v_accvgpr_read_b32 v79, a95
v_cvt_pk_bf16_f32 v88, v72, v73
v_cvt_pk_bf16_f32 v90, v74, v75
v_cvt_pk_bf16_f32 v92, v76, v77
v_cvt_pk_bf16_f32 v94, v78, v79
v_lshlrev_b32 v72, 16, v88
v_and_b32 v73, 0xffff0000, v88
v_lshlrev_b32 v74, 16, v90
v_and_b32 v75, 0xffff0000, v90
v_lshlrev_b32 v76, 16, v92
v_and_b32 v77, 0xffff0000, v92
v_lshlrev_b32 v78, 16, v94
v_and_b32 v79, 0xffff0000, v94
v_add_f32 v72, v72, v109
v_add_f32 v73, v73, v109
v_add_f32 v74, v74, v109
v_add_f32 v75, v75, v109
v_add_f32 v76, v76, v109
v_add_f32 v77, v77, v109
v_add_f32 v78, v78, v109
v_add_f32 v79, v79, v109
v_cvt_pk_bf16_f32 v88, v72, v73
v_cvt_pk_bf16_f32 v90, v74, v75
v_cvt_pk_bf16_f32 v92, v76, v77
v_cvt_pk_bf16_f32 v94, v78, v79
v_lshlrev_b32 v72, 16, v88
v_and_b32 v73, 0xffff0000, v88
v_lshlrev_b32 v74, 16, v90
v_and_b32 v75, 0xffff0000, v90
v_lshlrev_b32 v76, 16, v92
v_and_b32 v77, 0xffff0000, v92
v_lshlrev_b32 v78, 16, v94
v_and_b32 v79, 0xffff0000, v94
v_pk_mul_f32 v[88:89], v[72:73], s[34:35]
v_pk_mul_f32 v[90:91], v[74:75], s[34:35]
v_pk_mul_f32 v[92:93], v[76:77], s[34:35]
v_pk_mul_f32 v[94:95], v[78:79], s[34:35]
v_exp_f32 v88, v88
v_exp_f32 v89, v89
v_exp_f32 v90, v90
v_exp_f32 v91, v91
v_exp_f32 v92, v92
v_exp_f32 v93, v93
v_exp_f32 v94, v94
v_exp_f32 v95, v95
v_pk_add_f32 v[88:89], v[88:89], v[62:63]
v_pk_add_f32 v[90:91], v[90:91], v[62:63]
v_pk_add_f32 v[92:93], v[92:93], v[62:63]
v_pk_add_f32 v[94:95], v[94:95], v[62:63]
v_rcp_f32 v88, v88
v_rcp_f32 v89, v89
v_rcp_f32 v90, v90
v_rcp_f32 v91, v91
v_rcp_f32 v92, v92
v_rcp_f32 v93, v93
v_rcp_f32 v94, v94
v_rcp_f32 v95, v95
v_pk_mul_f32 v[72:73], v[72:73], v[88:89]
v_pk_mul_f32 v[74:75], v[74:75], v[90:91]
v_pk_mul_f32 v[76:77], v[76:77], v[92:93]
v_pk_mul_f32 v[78:79], v[78:79], v[94:95]
v_cvt_pk_bf16_f32 v84, v72, v73
v_cvt_pk_bf16_f32 v85, v74, v75
v_cvt_pk_bf16_f32 v86, v76, v77
v_cvt_pk_bf16_f32 v87, v78, v79
s_nop 0
v_permlane16_swap_b32 v84, v86
v_permlane16_swap_b32 v85, v87
global_store_dwordx4 v56, v[84:87], s[12:13] offset:64 sc1
s_add_u32 s12, s12, 32768
s_addc_u32 s13, s13, 0
v_accvgpr_read_b32 v64, a96
v_accvgpr_read_b32 v65, a97
v_accvgpr_read_b32 v66, a98
v_accvgpr_read_b32 v67, a99
v_accvgpr_read_b32 v68, a100
v_accvgpr_read_b32 v69, a101
v_accvgpr_read_b32 v70, a102
v_accvgpr_read_b32 v71, a103
v_cvt_pk_bf16_f32 v88, v64, v65
v_cvt_pk_bf16_f32 v90, v66, v67
v_cvt_pk_bf16_f32 v92, v68, v69
v_cvt_pk_bf16_f32 v94, v70, v71
v_lshlrev_b32 v64, 16, v88
v_and_b32 v65, 0xffff0000, v88
v_lshlrev_b32 v66, 16, v90
v_and_b32 v67, 0xffff0000, v90
v_lshlrev_b32 v68, 16, v92
v_and_b32 v69, 0xffff0000, v92
v_lshlrev_b32 v70, 16, v94
v_and_b32 v71, 0xffff0000, v94
v_add_f32 v64, v64, v110
v_add_f32 v65, v65, v110
v_add_f32 v66, v66, v110
v_add_f32 v67, v67, v110
v_add_f32 v68, v68, v110
v_add_f32 v69, v69, v110
v_add_f32 v70, v70, v110
v_add_f32 v71, v71, v110
v_cvt_pk_bf16_f32 v88, v64, v65
v_cvt_pk_bf16_f32 v90, v66, v67
v_cvt_pk_bf16_f32 v92, v68, v69
v_cvt_pk_bf16_f32 v94, v70, v71
v_lshlrev_b32 v64, 16, v88
v_and_b32 v65, 0xffff0000, v88
v_lshlrev_b32 v66, 16, v90
v_and_b32 v67, 0xffff0000, v90
v_lshlrev_b32 v68, 16, v92
v_and_b32 v69, 0xffff0000, v92
v_lshlrev_b32 v70, 16, v94
v_and_b32 v71, 0xffff0000, v94
v_pk_mul_f32 v[88:89], v[64:65], s[34:35]
v_pk_mul_f32 v[90:91], v[66:67], s[34:35]
v_pk_mul_f32 v[92:93], v[68:69], s[34:35]
v_pk_mul_f32 v[94:95], v[70:71], s[34:35]
v_exp_f32 v88, v88
v_exp_f32 v89, v89
v_exp_f32 v90, v90
v_exp_f32 v91, v91
v_exp_f32 v92, v92
v_exp_f32 v93, v93
v_exp_f32 v94, v94
v_exp_f32 v95, v95
v_pk_add_f32 v[88:89], v[88:89], v[62:63]
v_pk_add_f32 v[90:91], v[90:91], v[62:63]
v_pk_add_f32 v[92:93], v[92:93], v[62:63]
v_pk_add_f32 v[94:95], v[94:95], v[62:63]
v_rcp_f32 v88, v88
v_rcp_f32 v89, v89
v_rcp_f32 v90, v90
v_rcp_f32 v91, v91
v_rcp_f32 v92, v92
v_rcp_f32 v93, v93
v_rcp_f32 v94, v94
v_rcp_f32 v95, v95
v_pk_mul_f32 v[64:65], v[64:65], v[88:89]
v_pk_mul_f32 v[66:67], v[66:67], v[90:91]
v_pk_mul_f32 v[68:69], v[68:69], v[92:93]
v_pk_mul_f32 v[70:71], v[70:71], v[94:95]
v_cvt_pk_bf16_f32 v80, v64, v65
v_cvt_pk_bf16_f32 v81, v66, v67
v_cvt_pk_bf16_f32 v82, v68, v69
v_cvt_pk_bf16_f32 v83, v70, v71
s_nop 0
v_permlane16_swap_b32 v80, v82
v_permlane16_swap_b32 v81, v83
global_store_dwordx4 v56, v[80:83], s[12:13] offset:0 sc1
v_accvgpr_read_b32 v72, a104
v_accvgpr_read_b32 v73, a105
v_accvgpr_read_b32 v74, a106
v_accvgpr_read_b32 v75, a107
v_accvgpr_read_b32 v76, a108
v_accvgpr_read_b32 v77, a109
v_accvgpr_read_b32 v78, a110
v_accvgpr_read_b32 v79, a111
v_cvt_pk_bf16_f32 v88, v72, v73
v_cvt_pk_bf16_f32 v90, v74, v75
v_cvt_pk_bf16_f32 v92, v76, v77
v_cvt_pk_bf16_f32 v94, v78, v79
v_lshlrev_b32 v72, 16, v88
v_and_b32 v73, 0xffff0000, v88
v_lshlrev_b32 v74, 16, v90
v_and_b32 v75, 0xffff0000, v90
v_lshlrev_b32 v76, 16, v92
v_and_b32 v77, 0xffff0000, v92
v_lshlrev_b32 v78, 16, v94
v_and_b32 v79, 0xffff0000, v94
v_add_f32 v72, v72, v110
v_add_f32 v73, v73, v110
v_add_f32 v74, v74, v110
v_add_f32 v75, v75, v110
v_add_f32 v76, v76, v110
v_add_f32 v77, v77, v110
v_add_f32 v78, v78, v110
v_add_f32 v79, v79, v110
v_cvt_pk_bf16_f32 v88, v72, v73
v_cvt_pk_bf16_f32 v90, v74, v75
v_cvt_pk_bf16_f32 v92, v76, v77
v_cvt_pk_bf16_f32 v94, v78, v79
v_lshlrev_b32 v72, 16, v88
v_and_b32 v73, 0xffff0000, v88
v_lshlrev_b32 v74, 16, v90
v_and_b32 v75, 0xffff0000, v90
v_lshlrev_b32 v76, 16, v92
v_and_b32 v77, 0xffff0000, v92
v_lshlrev_b32 v78, 16, v94
v_and_b32 v79, 0xffff0000, v94
v_pk_mul_f32 v[88:89], v[72:73], s[34:35]
v_pk_mul_f32 v[90:91], v[74:75], s[34:35]
v_pk_mul_f32 v[92:93], v[76:77], s[34:35]
v_pk_mul_f32 v[94:95], v[78:79], s[34:35]
v_exp_f32 v88, v88
v_exp_f32 v89, v89
v_exp_f32 v90, v90
v_exp_f32 v91, v91
v_exp_f32 v92, v92
v_exp_f32 v93, v93
v_exp_f32 v94, v94
v_exp_f32 v95, v95
v_pk_add_f32 v[88:89], v[88:89], v[62:63]
v_pk_add_f32 v[90:91], v[90:91], v[62:63]
v_pk_add_f32 v[92:93], v[92:93], v[62:63]
v_pk_add_f32 v[94:95], v[94:95], v[62:63]
v_rcp_f32 v88, v88
v_rcp_f32 v89, v89
v_rcp_f32 v90, v90
v_rcp_f32 v91, v91
v_rcp_f32 v92, v92
v_rcp_f32 v93, v93
v_rcp_f32 v94, v94
v_rcp_f32 v95, v95
v_pk_mul_f32 v[72:73], v[72:73], v[88:89]
v_pk_mul_f32 v[74:75], v[74:75], v[90:91]
v_pk_mul_f32 v[76:77], v[76:77], v[92:93]
v_pk_mul_f32 v[78:79], v[78:79], v[94:95]
v_cvt_pk_bf16_f32 v84, v72, v73
v_cvt_pk_bf16_f32 v85, v74, v75
v_cvt_pk_bf16_f32 v86, v76, v77
v_cvt_pk_bf16_f32 v87, v78, v79
s_nop 0
v_permlane16_swap_b32 v84, v86
v_permlane16_swap_b32 v85, v87
global_store_dwordx4 v56, v[84:87], s[12:13] offset:64 sc1
s_add_u32 s12, s12, 32768
s_addc_u32 s13, s13, 0
v_accvgpr_read_b32 v64, a112
v_accvgpr_read_b32 v65, a113
v_accvgpr_read_b32 v66, a114
v_accvgpr_read_b32 v67, a115
v_accvgpr_read_b32 v68, a116
v_accvgpr_read_b32 v69, a117
v_accvgpr_read_b32 v70, a118
v_accvgpr_read_b32 v71, a119
v_cvt_pk_bf16_f32 v88, v64, v65
v_cvt_pk_bf16_f32 v90, v66, v67
v_cvt_pk_bf16_f32 v92, v68, v69
v_cvt_pk_bf16_f32 v94, v70, v71
v_lshlrev_b32 v64, 16, v88
v_and_b32 v65, 0xffff0000, v88
v_lshlrev_b32 v66, 16, v90
v_and_b32 v67, 0xffff0000, v90
v_lshlrev_b32 v68, 16, v92
v_and_b32 v69, 0xffff0000, v92
v_lshlrev_b32 v70, 16, v94
v_and_b32 v71, 0xffff0000, v94
v_add_f32 v64, v64, v111
v_add_f32 v65, v65, v111
v_add_f32 v66, v66, v111
v_add_f32 v67, v67, v111
v_add_f32 v68, v68, v111
v_add_f32 v69, v69, v111
v_add_f32 v70, v70, v111
v_add_f32 v71, v71, v111
v_cvt_pk_bf16_f32 v88, v64, v65
v_cvt_pk_bf16_f32 v90, v66, v67
v_cvt_pk_bf16_f32 v92, v68, v69
v_cvt_pk_bf16_f32 v94, v70, v71
v_lshlrev_b32 v64, 16, v88
v_and_b32 v65, 0xffff0000, v88
v_lshlrev_b32 v66, 16, v90
v_and_b32 v67, 0xffff0000, v90
v_lshlrev_b32 v68, 16, v92
v_and_b32 v69, 0xffff0000, v92
v_lshlrev_b32 v70, 16, v94
v_and_b32 v71, 0xffff0000, v94
v_pk_mul_f32 v[88:89], v[64:65], s[34:35]
v_pk_mul_f32 v[90:91], v[66:67], s[34:35]
v_pk_mul_f32 v[92:93], v[68:69], s[34:35]
v_pk_mul_f32 v[94:95], v[70:71], s[34:35]
v_exp_f32 v88, v88
v_exp_f32 v89, v89
v_exp_f32 v90, v90
v_exp_f32 v91, v91
v_exp_f32 v92, v92
v_exp_f32 v93, v93
v_exp_f32 v94, v94
v_exp_f32 v95, v95
v_pk_add_f32 v[88:89], v[88:89], v[62:63]
v_pk_add_f32 v[90:91], v[90:91], v[62:63]
v_pk_add_f32 v[92:93], v[92:93], v[62:63]
v_pk_add_f32 v[94:95], v[94:95], v[62:63]
v_rcp_f32 v88, v88
v_rcp_f32 v89, v89
v_rcp_f32 v90, v90
v_rcp_f32 v91, v91
v_rcp_f32 v92, v92
v_rcp_f32 v93, v93
v_rcp_f32 v94, v94
v_rcp_f32 v95, v95
v_pk_mul_f32 v[64:65], v[64:65], v[88:89]
v_pk_mul_f32 v[66:67], v[66:67], v[90:91]
v_pk_mul_f32 v[68:69], v[68:69], v[92:93]
v_pk_mul_f32 v[70:71], v[70:71], v[94:95]
v_cvt_pk_bf16_f32 v80, v64, v65
v_cvt_pk_bf16_f32 v81, v66, v67
v_cvt_pk_bf16_f32 v82, v68, v69
v_cvt_pk_bf16_f32 v83, v70, v71
s_nop 0
v_permlane16_swap_b32 v80, v82
v_permlane16_swap_b32 v81, v83
global_store_dwordx4 v56, v[80:83], s[12:13] offset:0 sc1
v_accvgpr_read_b32 v72, a120
v_accvgpr_read_b32 v73, a121
v_accvgpr_read_b32 v74, a122
v_accvgpr_read_b32 v75, a123
v_accvgpr_read_b32 v76, a124
v_accvgpr_read_b32 v77, a125
v_accvgpr_read_b32 v78, a126
v_accvgpr_read_b32 v79, a127
v_cvt_pk_bf16_f32 v88, v72, v73
v_cvt_pk_bf16_f32 v90, v74, v75
v_cvt_pk_bf16_f32 v92, v76, v77
v_cvt_pk_bf16_f32 v94, v78, v79
v_lshlrev_b32 v72, 16, v88
v_and_b32 v73, 0xffff0000, v88
v_lshlrev_b32 v74, 16, v90
v_and_b32 v75, 0xffff0000, v90
v_lshlrev_b32 v76, 16, v92
v_and_b32 v77, 0xffff0000, v92
v_lshlrev_b32 v78, 16, v94
v_and_b32 v79, 0xffff0000, v94
v_add_f32 v72, v72, v111
v_add_f32 v73, v73, v111
v_add_f32 v74, v74, v111
v_add_f32 v75, v75, v111
v_add_f32 v76, v76, v111
v_add_f32 v77, v77, v111
v_add_f32 v78, v78, v111
v_add_f32 v79, v79, v111
v_cvt_pk_bf16_f32 v88, v72, v73
v_cvt_pk_bf16_f32 v90, v74, v75
v_cvt_pk_bf16_f32 v92, v76, v77
v_cvt_pk_bf16_f32 v94, v78, v79
v_lshlrev_b32 v72, 16, v88
v_and_b32 v73, 0xffff0000, v88
v_lshlrev_b32 v74, 16, v90
v_and_b32 v75, 0xffff0000, v90
v_lshlrev_b32 v76, 16, v92
v_and_b32 v77, 0xffff0000, v92
v_lshlrev_b32 v78, 16, v94
v_and_b32 v79, 0xffff0000, v94
v_pk_mul_f32 v[88:89], v[72:73], s[34:35]
v_pk_mul_f32 v[90:91], v[74:75], s[34:35]
v_pk_mul_f32 v[92:93], v[76:77], s[34:35]
v_pk_mul_f32 v[94:95], v[78:79], s[34:35]
v_exp_f32 v88, v88
v_exp_f32 v89, v89
v_exp_f32 v90, v90
v_exp_f32 v91, v91
v_exp_f32 v92, v92
v_exp_f32 v93, v93
v_exp_f32 v94, v94
v_exp_f32 v95, v95
v_pk_add_f32 v[88:89], v[88:89], v[62:63]
v_pk_add_f32 v[90:91], v[90:91], v[62:63]
v_pk_add_f32 v[92:93], v[92:93], v[62:63]
v_pk_add_f32 v[94:95], v[94:95], v[62:63]
v_rcp_f32 v88, v88
v_rcp_f32 v89, v89
v_rcp_f32 v90, v90
v_rcp_f32 v91, v91
v_rcp_f32 v92, v92
v_rcp_f32 v93, v93
v_rcp_f32 v94, v94
v_rcp_f32 v95, v95
v_pk_mul_f32 v[72:73], v[72:73], v[88:89]
v_pk_mul_f32 v[74:75], v[74:75], v[90:91]
v_pk_mul_f32 v[76:77], v[76:77], v[92:93]
v_pk_mul_f32 v[78:79], v[78:79], v[94:95]
v_cvt_pk_bf16_f32 v84, v72, v73
v_cvt_pk_bf16_f32 v85, v74, v75
v_cvt_pk_bf16_f32 v86, v76, v77
v_cvt_pk_bf16_f32 v87, v78, v79
s_nop 0
v_permlane16_swap_b32 v84, v86
v_permlane16_swap_b32 v85, v87
global_store_dwordx4 v56, v[84:87], s[12:13] offset:64 sc1
s_waitcnt vmcnt(0)
s_barrier
s_cmp_lg_u32 s20, 0
s_cbranch_scc1 M_sg_118
s_lshl_b32 s64, s62, 2
s_add_u32 s64, s64, 192
v_mov_b32 v42, s64
v_mov_b32 v43, 1
s_mov_b64 exec, 1
global_atomic_add v42, v43, s[56:57]
s_mov_b64 exec, -1
M_sg_118:
s_branch W_loop
W_at:
s_lshr_b32 s63, s61, 2
s_cmp_lg_u32 s20, 0
s_cbranch_scc1 M_wcd_120
s_lshl_b32 s64, s63, 2
s_add_u32 s64, s64, 160
v_mov_b32 v42, s64
s_mov_b32 s65, 0
s_mov_b64 exec, 1
M_wc_119:
global_load_dword v43, v42, s[56:57] sc1
s_waitcnt vmcnt(0)
v_readfirstlane_b32 s64, v43
s_cmp_ge_u32 s64, 16
s_cbranch_scc1 M_wcd_120_x
s_sleep 32
s_add_u32 s65, s65, 1
s_cmp_lt_u32 s65, 400000
s_cbranch_scc1 M_wc_119
s_mov_b64 exec, -1
s_branch M_exit0
M_wcd_120_x:
s_mov_b64 exec, -1
M_wcd_120:
s_barrier
s_lshl_b32 s66, s61, 6
s_add_u32 s66, s66, 64
s_cmp_lg_u32 s20, 0
s_cbranch_scc1 M_wcd_122
s_lshl_b32 s64, s58, 2
s_add_u32 s64, s64, 224
v_mov_b32 v42, s64
s_mov_b32 s65, 0
s_mov_b64 exec, 1
M_wc_121:
global_load_dword v43, v42, s[56:57] sc1
s_waitcnt vmcnt(0)
v_readfirstlane_b32 s64, v43
s_cmp_ge_u32 s64, s66
s_cbranch_scc1 M_wcd_122_x
s_sleep 24
s_add_u32 s65, s65, 1
s_cmp_lt_u32 s65, 400000
s_cbranch_scc1 M_wc_121
s_mov_b64 exec, -1
s_branch M_exit0
M_wcd_122_x:
s_mov_b64 exec, -1
M_wcd_122:
s_barrier
s_lshl_b32 s30, s61, 1
s_lshl_b32 s31, s58, 3
s_lshl_b32 s64, s20, 1
s_add_u32 s31, s31, s64
v_and_b32 v1, 63, v0
v_and_b32 v2, 15, v1
v_lshrrev_b32 v3, 4, v1
s_mov_b32 s16, 0x3e0293ee
s_mov_b32 s18, 0
s_mov_b32 s19, -1
v_lshlrev_b32 v4, 4, v1
v_add_u32 v8, 16777216, v4
v_add_u32 v9, 4096, v8
v_add_u32 v10, 33554432, v4
v_add_u32 v11, 4096, v10
v_add_u32 v12, 50331648, v4
v_add_u32 v13, 4096, v12
v_and_b32 v4, 7, v1
v_lshlrev_b32 v4, 4, v4
v_lshl_add_u32 v14, v3, 7, v4
v_add_u32 v14, 100663296, v14
v_and_b32 v4, 31, v1
v_lshlrev_b32 v15, 3, v4
v_add_u32 v15, 104857600, v15
v_lshrrev_b32 v4, 2, v2
v_lshrrev_b32 v5, 1, v4
v_xor_b32 v4, v4, v5
v_and_b32 v4, 1, v4
v_lshl_add_u32 v5, v4, 1, v5
v_and_b32 v4, 1, v3
v_lshlrev_b32 v4, 1, v4
v_lshrrev_b32 v6, 1, v3
v_add_u32 v4, v4, v6
v_xor_b32 v4, v4, v5
v_lshlrev_b32 v4, 4, v4
v_lshl_add_u32 v16, v2, 6, v4
v_add_u32 v16, 83886080, v16
s_add_u32 s28, s30, 0
s_add_u32 s29, s31, 0
s_lshl_b32 s21, s28, 18
s_lshl_b32 s22, s29, 13
s_add_u32 s21, s21, s22
s_add_u32 s4, s40, s21
s_addc_u32 s5, s41, 0
s_lshl_b32 s21, s28, 16
s_lshl_b32 s22, s29, 11
s_add_u32 s21, s21, s22
s_add_u32 s6, s40, s21
s_addc_u32 s7, s41, 0
s_lshl_b32 s21, s29, 19
s_lshl_b32 s22, s28, 11
s_add_u32 s21, s21, s22
s_add_u32 s8, s40, s21
s_addc_u32 s9, s41, 0
global_load_dwordx4 a[0:3], v8, s[4:5] offset:0 sc1
global_load_dwordx4 a[32:35], v10, s[4:5] offset:0 sc1
global_load_dwordx4 a[4:7], v8, s[4:5] offset:1024 sc1
global_load_dwordx4 a[36:39], v10, s[4:5] offset:1024 sc1
global_load_dwordx4 a[8:11], v8, s[4:5] offset:2048 sc1
global_load_dwordx4 a[40:43], v10, s[4:5] offset:2048 sc1
global_load_dwordx4 a[12:15], v8, s[4:5] offset:3072 sc1
global_load_dwordx4 a[44:47], v10, s[4:5] offset:3072 sc1
global_load_dwordx4 a[16:19], v9, s[4:5] offset:0 sc1
global_load_dwordx4 a[48:51], v11, s[4:5] offset:0 sc1
global_load_dwordx4 a[20:23], v9, s[4:5] offset:1024 sc1
global_load_dwordx4 a[52:55], v11, s[4:5] offset:1024 sc1
global_load_dwordx4 a[24:27], v9, s[4:5] offset:2048 sc1
global_load_dwordx4 a[56:59], v11, s[4:5] offset:2048 sc1
global_load_dwordx4 a[28:31], v9, s[4:5] offset:3072 sc1
global_load_dwordx4 a[60:63], v11, s[4:5] offset:3072 sc1
global_load_dwordx4 a[64:67], v14, s[6:7] offset:0 sc1
global_load_dwordx4 a[68:71], v14, s[6:7] offset:512 sc1
global_load_dwordx4 a[72:75], v14, s[6:7] offset:1024 sc1
global_load_dwordx4 a[76:79], v14, s[6:7] offset:1536 sc1
global_load_dwordx4 a[80:83], v12, s[4:5] offset:0 sc1
global_load_dwordx2 a[112:113], v15, s[6:7] offset:0 sc1
global_load_dwordx4 a[84:87], v12, s[4:5] offset:1024 sc1
global_load_dwordx2 a[114:115], v15, s[6:7] offset:256 sc1
global_load_dwordx4 a[88:91], v12, s[4:5] offset:2048 sc1
global_load_dwordx2 a[116:117], v15, s[6:7] offset:512 sc1
global_load_dwordx4 a[92:95], v12, s[4:5] offset:3072 sc1
global_load_dwordx2 a[118:119], v15, s[6:7] offset:768 sc1
global_load_dwordx4 a[96:99], v13, s[4:5] offset:0 sc1
global_load_dwordx2 a[120:121], v15, s[6:7] offset:1024 sc1
global_load_dwordx4 a[100:103], v13, s[4:5] offset:1024 sc1
global_load_dwordx2 a[122:123], v15, s[6:7] offset:1280 sc1
global_load_dwordx4 a[104:107], v13, s[4:5] offset:2048 sc1
global_load_dwordx2 a[124:125], v15, s[6:7] offset:1536 sc1
global_load_dwordx4 a[108:111], v13, s[4:5] offset:3072 sc1
global_load_dwordx2 a[126:127], v15, s[6:7] offset:1792 sc1
s_add_u32 s28, s30, 0
s_add_u32 s29, s31, 1
s_lshl_b32 s21, s28, 18
s_lshl_b32 s22, s29, 13
s_add_u32 s21, s21, s22
s_add_u32 s10, s40, s21
s_addc_u32 s11, s41, 0
s_lshl_b32 s21, s28, 16
s_lshl_b32 s22, s29, 11
s_add_u32 s21, s21, s22
s_add_u32 s12, s40, s21
s_addc_u32 s13, s41, 0
s_lshl_b32 s21, s29, 19
s_lshl_b32 s22, s28, 11
s_add_u32 s21, s21, s22
s_add_u32 s14, s40, s21
s_addc_u32 s15, s41, 0
global_load_dwordx4 a[128:131], v8, s[10:11] offset:0 sc1
global_load_dwordx4 a[160:163], v10, s[10:11] offset:0 sc1
global_load_dwordx4 a[132:135], v8, s[10:11] offset:1024 sc1
global_load_dwordx4 a[164:167], v10, s[10:11] offset:1024 sc1
global_load_dwordx4 a[136:139], v8, s[10:11] offset:2048 sc1
global_load_dwordx4 a[168:171], v10, s[10:11] offset:2048 sc1
global_load_dwordx4 a[140:143], v8, s[10:11] offset:3072 sc1
global_load_dwordx4 a[172:175], v10, s[10:11] offset:3072 sc1
global_load_dwordx4 a[144:147], v9, s[10:11] offset:0 sc1
global_load_dwordx4 a[176:179], v11, s[10:11] offset:0 sc1
global_load_dwordx4 a[148:151], v9, s[10:11] offset:1024 sc1
global_load_dwordx4 a[180:183], v11, s[10:11] offset:1024 sc1
global_load_dwordx4 a[152:155], v9, s[10:11] offset:2048 sc1
global_load_dwordx4 a[184:187], v11, s[10:11] offset:2048 sc1
global_load_dwordx4 a[156:159], v9, s[10:11] offset:3072 sc1
global_load_dwordx4 a[188:191], v11, s[10:11] offset:3072 sc1
global_load_dwordx4 a[192:195], v14, s[12:13] offset:0 sc1
global_load_dwordx4 a[196:199], v14, s[12:13] offset:512 sc1
global_load_dwordx4 a[200:203], v14, s[12:13] offset:1024 sc1
global_load_dwordx4 a[204:207], v14, s[12:13] offset:1536 sc1
global_load_dwordx4 a[208:211], v12, s[10:11] offset:0 sc1
global_load_dwordx2 a[240:241], v15, s[12:13] offset:0 sc1
global_load_dwordx4 a[212:215], v12, s[10:11] offset:1024 sc1
global_load_dwordx2 a[242:243], v15, s[12:13] offset:256 sc1
global_load_dwordx4 a[216:219], v12, s[10:11] offset:2048 sc1
global_load_dwordx2 a[244:245], v15, s[12:13] offset:512 sc1
global_load_dwordx4 a[220:223], v12, s[10:11] offset:3072 sc1
global_load_dwordx2 a[246:247], v15, s[12:13] offset:768 sc1
global_load_dwordx4 a[224:227], v13, s[10:11] offset:0 sc1
global_load_dwordx2 a[248:249], v15, s[12:13] offset:1024 sc1
global_load_dwordx4 a[228:231], v13, s[10:11] offset:1024 sc1
global_load_dwordx2 a[250:251], v15, s[12:13] offset:1280 sc1
global_load_dwordx4 a[232:235], v13, s[10:11] offset:2048 sc1
global_load_dwordx2 a[252:253], v15, s[12:13] offset:1536 sc1
global_load_dwordx4 a[236:239], v13, s[10:11] offset:3072 sc1
global_load_dwordx2 a[254:255], v15, s[12:13] offset:1792 sc1
s_waitcnt vmcnt(36)
v_mfma_f32_16x16x32_bf16 v[20:23], a[32:35], a[0:3], 0
v_mfma_f32_16x16x32_bf16 v[20:23], a[36:39], a[4:7], v[20:23]
v_mfma_f32_16x16x32_bf16 v[20:23], a[40:43], a[8:11], v[20:23]
v_mfma_f32_16x16x32_bf16 v[20:23], a[44:47], a[12:15], v[20:23]
v_mfma_f32_16x16x32_bf16 v[24:27], a[64:67], a[0:3], 0
v_mfma_f32_16x16x32_bf16 v[24:27], a[68:71], a[4:7], v[24:27]
v_mfma_f32_16x16x32_bf16 v[24:27], a[72:75], a[8:11], v[24:27]
v_mfma_f32_16x16x32_bf16 v[24:27], a[76:79], a[12:15], v[24:27]
v_mfma_f32_16x16x32_bf16 v[28:31], a[32:35], a[16:19], 0
v_mfma_f32_16x16x32_bf16 v[28:31], a[36:39], a[20:23], v[28:31]
v_mfma_f32_16x16x32_bf16 v[28:31], a[40:43], a[24:27], v[28:31]
v_mfma_f32_16x16x32_bf16 v[28:31], a[44:47], a[28:31], v[28:31]
v_mfma_f32_16x16x32_bf16 v[32:35], a[48:51], a[16:19], 0
v_mfma_f32_16x16x32_bf16 v[32:35], a[52:55], a[20:23], v[32:35]
v_mfma_f32_16x16x32_bf16 v[32:35], a[56:59], a[24:27], v[32:35]
v_mfma_f32_16x16x32_bf16 v[32:35], a[60:63], a[28:31], v[32:35]
v_mfma_f32_16x16x32_bf16 v[36:39], a[64:67], a[16:19], 0
v_mfma_f32_16x16x32_bf16 v[36:39], a[68:71], a[20:23], v[36:39]
v_mfma_f32_16x16x32_bf16 v[36:39], a[72:75], a[24:27], v[36:39]
v_mfma_f32_16x16x32_bf16 v[36:39], a[76:79], a[28:31], v[36:39]
v_mov_b32 v60, 0xff800000
v_lshlrev_b32 v61, 2, v3
v_add_u32 v62, 0, v61
v_cmp_gt_u32 vcc, v62, v2
s_nop 1
v_cndmask_b32 v20, v20, v60, vcc
v_cndmask_b32 v32, v32, v60, vcc
v_cndmask_b32 v24, v24, v60, s[18:19]
v_cndmask_b32 v36, v36, v60, s[18:19]
v_add_u32 v62, 1, v61
v_cmp_gt_u32 vcc, v62, v2
s_nop 1
v_cndmask_b32 v21, v21, v60, vcc
v_cndmask_b32 v33, v33, v60, vcc
v_cndmask_b32 v25, v25, v60, s[18:19]
v_cndmask_b32 v37, v37, v60, s[18:19]
v_add_u32 v62, 2, v61
v_cmp_gt_u32 vcc, v62, v2
s_nop 1
v_cndmask_b32 v22, v22, v60, vcc
v_cndmask_b32 v34, v34, v60, vcc
v_cndmask_b32 v26, v26, v60, s[18:19]
v_cndmask_b32 v38, v38, v60, s[18:19]
v_add_u32 v62, 3, v61
v_cmp_gt_u32 vcc, v62, v2
s_nop 1
v_cndmask_b32 v23, v23, v60, vcc
v_cndmask_b32 v35, v35, v60, vcc
v_cndmask_b32 v27, v27, v60, s[18:19]
v_cndmask_b32 v39, v39, v60, s[18:19]
v_max3_f32 v63, v20, v21, v22
v_max3_f32 v63, v63, v23, v24
v_max3_f32 v63, v63, v25, v26
v_max_f32 v63, v63, v27
v_mov_b32 v64, v63
s_nop 1
v_permlane16_swap_b32 v63, v64
v_max_f32 v63, v63, v64
v_mov_b32 v64, v63
s_nop 1
v_permlane32_swap_b32 v63, v64
v_max_f32 v63, v63, v64
v_mul_f32 v63, s16, v63
v_fma_f32 v20, v20, s16, -v63
v_fma_f32 v21, v21, s16, -v63
v_fma_f32 v22, v22, s16, -v63
v_fma_f32 v23, v23, s16, -v63
v_fma_f32 v24, v24, s16, -v63
v_fma_f32 v25, v25, s16, -v63
v_fma_f32 v26, v26, s16, -v63
v_fma_f32 v27, v27, s16, -v63
v_exp_f32 v20, v20
v_exp_f32 v21, v21
v_exp_f32 v22, v22
v_exp_f32 v23, v23
v_exp_f32 v24, v24
v_exp_f32 v25, v25
v_exp_f32 v26, v26
v_exp_f32 v27, v27
v_add_f32 v65, v20, v21
v_add_f32 v65, v65, v22
v_add_f32 v65, v65, v23
v_add_f32 v65, v65, v24
v_add_f32 v65, v65, v25
v_add_f32 v65, v65, v26
v_add_f32 v65, v65, v27
v_mov_b32 v64, v65
s_nop 1
v_permlane16_swap_b32 v65, v64
v_add_f32 v65, v65, v64
v_mov_b32 v64, v65
s_nop 1
v_permlane32_swap_b32 v65, v64
v_add_f32 v65, v65, v64
v_rcp_f32 v65, v65
s_nop 0
v_mul_f32 v20, v20, v65
v_mul_f32 v21, v21, v65
v_mul_f32 v22, v22, v65
v_mul_f32 v23, v23, v65
v_mul_f32 v24, v24, v65
v_mul_f32 v25, v25, v65
v_mul_f32 v26, v26, v65
v_mul_f32 v27, v27, v65
v_cvt_pk_bf16_f32 v40, v20, v21
v_cvt_pk_bf16_f32 v41, v22, v23
v_mov_b32 v42, 0
v_mov_b32 v43, 0
v_cvt_pk_bf16_f32 v44, v24, v25
v_cvt_pk_bf16_f32 v45, v26, v27
v_max3_f32 v63, v28, v29, v30
v_max3_f32 v63, v63, v31, v32
v_max3_f32 v63, v63, v33, v34
v_max3_f32 v63, v63, v35, v36
v_max3_f32 v63, v63, v37, v38
v_max_f32 v63, v63, v39
v_mov_b32 v64, v63
s_nop 1
v_permlane16_swap_b32 v63, v64
v_max_f32 v63, v63, v64
v_mov_b32 v64, v63
s_nop 1
v_permlane32_swap_b32 v63, v64
v_max_f32 v63, v63, v64
v_mul_f32 v63, s16, v63
v_fma_f32 v28, v28, s16, -v63
v_fma_f32 v29, v29, s16, -v63
v_fma_f32 v30, v30, s16, -v63
v_fma_f32 v31, v31, s16, -v63
v_fma_f32 v32, v32, s16, -v63
v_fma_f32 v33, v33, s16, -v63
v_fma_f32 v34, v34, s16, -v63
v_fma_f32 v35, v35, s16, -v63
v_fma_f32 v36, v36, s16, -v63
v_fma_f32 v37, v37, s16, -v63
v_fma_f32 v38, v38, s16, -v63
v_fma_f32 v39, v39, s16, -v63
v_exp_f32 v28, v28
v_exp_f32 v29, v29
v_exp_f32 v30, v30
v_exp_f32 v31, v31
v_exp_f32 v32, v32
v_exp_f32 v33, v33
v_exp_f32 v34, v34
v_exp_f32 v35, v35
v_exp_f32 v36, v36
v_exp_f32 v37, v37
v_exp_f32 v38, v38
v_exp_f32 v39, v39
v_add_f32 v66, v28, v29
v_add_f32 v66, v66, v30
v_add_f32 v66, v66, v31
v_add_f32 v66, v66, v32
v_add_f32 v66, v66, v33
v_add_f32 v66, v66, v34
v_add_f32 v66, v66, v35
v_add_f32 v66, v66, v36
v_add_f32 v66, v66, v37
v_add_f32 v66, v66, v38
v_add_f32 v66, v66, v39
v_mov_b32 v64, v66
s_nop 1
v_permlane16_swap_b32 v66, v64
v_add_f32 v66, v66, v64
v_mov_b32 v64, v66
s_nop 1
v_permlane32_swap_b32 v66, v64
v_add_f32 v66, v66, v64
v_rcp_f32 v66, v66
s_nop 0
v_mul_f32 v28, v28, v66
v_mul_f32 v29, v29, v66
v_mul_f32 v30, v30, v66
v_mul_f32 v31, v31, v66
v_mul_f32 v32, v32, v66
v_mul_f32 v33, v33, v66
v_mul_f32 v34, v34, v66
v_mul_f32 v35, v35, v66
v_mul_f32 v36, v36, v66
v_mul_f32 v37, v37, v66
v_mul_f32 v38, v38, v66
v_mul_f32 v39, v39, v66
v_cvt_pk_bf16_f32 v46, v28, v29
v_cvt_pk_bf16_f32 v47, v30, v31
v_cvt_pk_bf16_f32 v48, v32, v33
v_cvt_pk_bf16_f32 v49, v34, v35
v_cvt_pk_bf16_f32 v50, v36, v37
v_cvt_pk_bf16_f32 v51, v38, v39
v_mfma_f32_16x16x16_bf16 v[52:55], a[112:113], v[44:45], 0
v_mfma_f32_16x16x16_bf16 v[56:59], a[114:115], v[44:45], 0
s_nop 4
v_mfma_f32_16x16x32_bf16 v[52:55], a[80:83], v[40:43], v[52:55]
v_mfma_f32_16x16x32_bf16 v[56:59], a[84:87], v[40:43], v[56:59]
s_nop 6
v_cvt_pk_bf16_f32 v68, v52, v53
v_cvt_pk_bf16_f32 v69, v54, v55
v_cvt_pk_bf16_f32 v70, v56, v57
v_cvt_pk_bf16_f32 v71, v58, v59
s_nop 0
v_permlane16_swap_b32 v68, v70
v_permlane16_swap_b32 v69, v71
v_add_u32 v4, 0, v16
global_store_dwordx4 v4, v[68:71], s[8:9] sc1
v_mfma_f32_16x16x16_bf16 v[52:55], a[116:117], v[44:45], 0
v_mfma_f32_16x16x16_bf16 v[56:59], a[118:119], v[44:45], 0
s_nop 4
v_mfma_f32_16x16x32_bf16 v[52:55], a[88:91], v[40:43], v[52:55]
v_mfma_f32_16x16x32_bf16 v[56:59], a[92:95], v[40:43], v[56:59]
s_nop 6
v_cvt_pk_bf16_f32 v72, v52, v53
v_cvt_pk_bf16_f32 v73, v54, v55
v_cvt_pk_bf16_f32 v74, v56, v57
v_cvt_pk_bf16_f32 v75, v58, v59
s_nop 0
v_permlane16_swap_b32 v72, v74
v_permlane16_swap_b32 v73, v75
v_add_u32 v4, 131072, v16
global_store_dwordx4 v4, v[72:75], s[8:9] sc1
v_mfma_f32_16x16x16_bf16 v[52:55], a[120:121], v[44:45], 0
v_mfma_f32_16x16x16_bf16 v[56:59], a[122:123], v[44:45], 0
s_nop 4
v_mfma_f32_16x16x32_bf16 v[52:55], a[96:99], v[40:43], v[52:55]
v_mfma_f32_16x16x32_bf16 v[56:59], a[100:103], v[40:43], v[56:59]
s_nop 6
v_cvt_pk_bf16_f32 v68, v52, v53
v_cvt_pk_bf16_f32 v69, v54, v55
v_cvt_pk_bf16_f32 v70, v56, v57
v_cvt_pk_bf16_f32 v71, v58, v59
s_nop 0
v_permlane16_swap_b32 v68, v70
v_permlane16_swap_b32 v69, v71
v_add_u32 v4, 262144, v16
global_store_dwordx4 v4, v[68:71], s[8:9] sc1
v_mfma_f32_16x16x16_bf16 v[52:55], a[124:125], v[44:45], 0
v_mfma_f32_16x16x16_bf16 v[56:59], a[126:127], v[44:45], 0
s_nop 4
v_mfma_f32_16x16x32_bf16 v[52:55], a[104:107], v[40:43], v[52:55]
v_mfma_f32_16x16x32_bf16 v[56:59], a[108:111], v[40:43], v[56:59]
s_nop 6
v_cvt_pk_bf16_f32 v72, v52, v53
v_cvt_pk_bf16_f32 v73, v54, v55
v_cvt_pk_bf16_f32 v74, v56, v57
v_cvt_pk_bf16_f32 v75, v58, v59
s_nop 0
v_permlane16_swap_b32 v72, v74
v_permlane16_swap_b32 v73, v75
v_add_u32 v4, 393216, v16
global_store_dwordx4 v4, v[72:75], s[8:9] sc1
v_mfma_f32_16x16x16_bf16 v[52:55], a[112:113], v[50:51], 0
v_mfma_f32_16x16x16_bf16 v[56:59], a[114:115], v[50:51], 0
s_nop 4
v_mfma_f32_16x16x32_bf16 v[52:55], a[80:83], v[46:49], v[52:55]
v_mfma_f32_16x16x32_bf16 v[56:59], a[84:87], v[46:49], v[56:59]
s_nop 6
v_cvt_pk_bf16_f32 v68, v52, v53
v_cvt_pk_bf16_f32 v69, v54, v55
v_cvt_pk_bf16_f32 v70, v56, v57
v_cvt_pk_bf16_f32 v71, v58, v59
s_nop 0
v_permlane16_swap_b32 v68, v70
v_permlane16_swap_b32 v69, v71
v_add_u32 v4, 1024, v16
global_store_dwordx4 v4, v[68:71], s[8:9] sc1
v_mfma_f32_16x16x16_bf16 v[52:55], a[116:117], v[50:51], 0
v_mfma_f32_16x16x16_bf16 v[56:59], a[118:119], v[50:51], 0
s_nop 4
v_mfma_f32_16x16x32_bf16 v[52:55], a[88:91], v[46:49], v[52:55]
v_mfma_f32_16x16x32_bf16 v[56:59], a[92:95], v[46:49], v[56:59]
s_nop 6
v_cvt_pk_bf16_f32 v72, v52, v53
v_cvt_pk_bf16_f32 v73, v54, v55
v_cvt_pk_bf16_f32 v74, v56, v57
v_cvt_pk_bf16_f32 v75, v58, v59
s_nop 0
v_permlane16_swap_b32 v72, v74
v_permlane16_swap_b32 v73, v75
v_add_u32 v4, 132096, v16
global_store_dwordx4 v4, v[72:75], s[8:9] sc1
v_mfma_f32_16x16x16_bf16 v[52:55], a[120:121], v[50:51], 0
v_mfma_f32_16x16x16_bf16 v[56:59], a[122:123], v[50:51], 0
s_nop 4
v_mfma_f32_16x16x32_bf16 v[52:55], a[96:99], v[46:49], v[52:55]
v_mfma_f32_16x16x32_bf16 v[56:59], a[100:103], v[46:49], v[56:59]
s_nop 6
v_cvt_pk_bf16_f32 v68, v52, v53
v_cvt_pk_bf16_f32 v69, v54, v55
v_cvt_pk_bf16_f32 v70, v56, v57
v_cvt_pk_bf16_f32 v71, v58, v59
s_nop 0
v_permlane16_swap_b32 v68, v70
v_permlane16_swap_b32 v69, v71
v_add_u32 v4, 263168, v16
global_store_dwordx4 v4, v[68:71], s[8:9] sc1
v_mfma_f32_16x16x16_bf16 v[52:55], a[124:125], v[50:51], 0
v_mfma_f32_16x16x16_bf16 v[56:59], a[126:127], v[50:51], 0
s_nop 4
v_mfma_f32_16x16x32_bf16 v[52:55], a[104:107], v[46:49], v[52:55]
v_mfma_f32_16x16x32_bf16 v[56:59], a[108:111], v[46:49], v[56:59]
s_nop 6
v_cvt_pk_bf16_f32 v72, v52, v53
v_cvt_pk_bf16_f32 v73, v54, v55
v_cvt_pk_bf16_f32 v74, v56, v57
v_cvt_pk_bf16_f32 v75, v58, v59
s_nop 0
v_permlane16_swap_b32 v72, v74
v_permlane16_swap_b32 v73, v75
v_add_u32 v4, 394240, v16
global_store_dwordx4 v4, v[72:75], s[8:9] sc1
s_add_u32 s28, s30, 1
s_add_u32 s29, s31, 0
s_lshl_b32 s21, s28, 18
s_lshl_b32 s22, s29, 13
s_add_u32 s21, s21, s22
s_add_u32 s4, s40, s21
s_addc_u32 s5, s41, 0
s_lshl_b32 s21, s28, 16
s_lshl_b32 s22, s29, 11
s_add_u32 s21, s21, s22
s_add_u32 s6, s40, s21
s_addc_u32 s7, s41, 0
s_lshl_b32 s21, s29, 19
s_lshl_b32 s22, s28, 11
s_add_u32 s21, s21, s22
s_add_u32 s8, s40, s21
s_addc_u32 s9, s41, 0
global_load_dwordx4 a[0:3], v8, s[4:5] offset:0 sc1
global_load_dwordx4 a[32:35], v10, s[4:5] offset:0 sc1
global_load_dwordx4 a[4:7], v8, s[4:5] offset:1024 sc1
global_load_dwordx4 a[36:39], v10, s[4:5] offset:1024 sc1
global_load_dwordx4 a[8:11], v8, s[4:5] offset:2048 sc1
global_load_dwordx4 a[40:43], v10, s[4:5] offset:2048 sc1
global_load_dwordx4 a[12:15], v8, s[4:5] offset:3072 sc1
global_load_dwordx4 a[44:47], v10, s[4:5] offset:3072 sc1
global_load_dwordx4 a[16:19], v9, s[4:5] offset:0 sc1
global_load_dwordx4 a[48:51], v11, s[4:5] offset:0 sc1
global_load_dwordx4 a[20:23], v9, s[4:5] offset:1024 sc1
global_load_dwordx4 a[52:55], v11, s[4:5] offset:1024 sc1
global_load_dwordx4 a[24:27], v9, s[4:5] offset:2048 sc1
global_load_dwordx4 a[56:59], v11, s[4:5] offset:2048 sc1
global_load_dwordx4 a[28:31], v9, s[4:5] offset:3072 sc1
global_load_dwordx4 a[60:63], v11, s[4:5] offset:3072 sc1
global_load_dwordx4 a[64:67], v14, s[6:7] offset:0 sc1
global_load_dwordx4 a[68:71], v14, s[6:7] offset:512 sc1
global_load_dwordx4 a[72:75], v14, s[6:7] offset:1024 sc1
global_load_dwordx4 a[76:79], v14, s[6:7] offset:1536 sc1
global_load_dwordx4 a[80:83], v12, s[4:5] offset:0 sc1
global_load_dwordx2 a[112:113], v15, s[6:7] offset:0 sc1
global_load_dwordx4 a[84:87], v12, s[4:5] offset:1024 sc1
global_load_dwordx2 a[114:115], v15, s[6:7] offset:256 sc1
global_load_dwordx4 a[88:91], v12, s[4:5] offset:2048 sc1
global_load_dwordx2 a[116:117], v15, s[6:7] offset:512 sc1
global_load_dwordx4 a[92:95], v12, s[4:5] offset:3072 sc1
global_load_dwordx2 a[118:119], v15, s[6:7] offset:768 sc1
global_load_dwordx4 a[96:99], v13, s[4:5] offset:0 sc1
global_load_dwordx2 a[120:121], v15, s[6:7] offset:1024 sc1
global_load_dwordx4 a[100:103], v13, s[4:5] offset:1024 sc1
global_load_dwordx2 a[122:123], v15, s[6:7] offset:1280 sc1
global_load_dwordx4 a[104:107], v13, s[4:5] offset:2048 sc1
global_load_dwordx2 a[124:125], v15, s[6:7] offset:1536 sc1
global_load_dwordx4 a[108:111], v13, s[4:5] offset:3072 sc1
global_load_dwordx2 a[126:127], v15, s[6:7] offset:1792 sc1
s_waitcnt vmcnt(44)
v_mfma_f32_16x16x32_bf16 v[20:23], a[160:163], a[128:131], 0
v_mfma_f32_16x16x32_bf16 v[20:23], a[164:167], a[132:135], v[20:23]
v_mfma_f32_16x16x32_bf16 v[20:23], a[168:171], a[136:139], v[20:23]
v_mfma_f32_16x16x32_bf16 v[20:23], a[172:175], a[140:143], v[20:23]
v_mfma_f32_16x16x32_bf16 v[24:27], a[192:195], a[128:131], 0
v_mfma_f32_16x16x32_bf16 v[24:27], a[196:199], a[132:135], v[24:27]
v_mfma_f32_16x16x32_bf16 v[24:27], a[200:203], a[136:139], v[24:27]
v_mfma_f32_16x16x32_bf16 v[24:27], a[204:207], a[140:143], v[24:27]
v_mfma_f32_16x16x32_bf16 v[28:31], a[160:163], a[144:147], 0
v_mfma_f32_16x16x32_bf16 v[28:31], a[164:167], a[148:151], v[28:31]
v_mfma_f32_16x16x32_bf16 v[28:31], a[168:171], a[152:155], v[28:31]
v_mfma_f32_16x16x32_bf16 v[28:31], a[172:175], a[156:159], v[28:31]
v_mfma_f32_16x16x32_bf16 v[32:35], a[176:179], a[144:147], 0
v_mfma_f32_16x16x32_bf16 v[32:35], a[180:183], a[148:151], v[32:35]
v_mfma_f32_16x16x32_bf16 v[32:35], a[184:187], a[152:155], v[32:35]
v_mfma_f32_16x16x32_bf16 v[32:35], a[188:191], a[156:159], v[32:35]
v_mfma_f32_16x16x32_bf16 v[36:39], a[192:195], a[144:147], 0
v_mfma_f32_16x16x32_bf16 v[36:39], a[196:199], a[148:151], v[36:39]
v_mfma_f32_16x16x32_bf16 v[36:39], a[200:203], a[152:155], v[36:39]
v_mfma_f32_16x16x32_bf16 v[36:39], a[204:207], a[156:159], v[36:39]
v_mov_b32 v60, 0xff800000
v_lshlrev_b32 v61, 2, v3
v_add_u32 v62, 0, v61
v_cmp_gt_u32 vcc, v62, v2
s_nop 1
v_cndmask_b32 v20, v20, v60, vcc
v_cndmask_b32 v32, v32, v60, vcc
v_cndmask_b32 v24, v24, v60, s[18:19]
v_cndmask_b32 v36, v36, v60, s[18:19]
v_add_u32 v62, 1, v61
v_cmp_gt_u32 vcc, v62, v2
s_nop 1
v_cndmask_b32 v21, v21, v60, vcc
v_cndmask_b32 v33, v33, v60, vcc
v_cndmask_b32 v25, v25, v60, s[18:19]
v_cndmask_b32 v37, v37, v60, s[18:19]
v_add_u32 v62, 2, v61
v_cmp_gt_u32 vcc, v62, v2
s_nop 1
v_cndmask_b32 v22, v22, v60, vcc
v_cndmask_b32 v34, v34, v60, vcc
v_cndmask_b32 v26, v26, v60, s[18:19]
v_cndmask_b32 v38, v38, v60, s[18:19]
v_add_u32 v62, 3, v61
v_cmp_gt_u32 vcc, v62, v2
s_nop 1
v_cndmask_b32 v23, v23, v60, vcc
v_cndmask_b32 v35, v35, v60, vcc
v_cndmask_b32 v27, v27, v60, s[18:19]
v_cndmask_b32 v39, v39, v60, s[18:19]
v_max3_f32 v63, v20, v21, v22
v_max3_f32 v63, v63, v23, v24
v_max3_f32 v63, v63, v25, v26
v_max_f32 v63, v63, v27
v_mov_b32 v64, v63
s_nop 1
v_permlane16_swap_b32 v63, v64
v_max_f32 v63, v63, v64
v_mov_b32 v64, v63
s_nop 1
v_permlane32_swap_b32 v63, v64
v_max_f32 v63, v63, v64
v_mul_f32 v63, s16, v63
v_fma_f32 v20, v20, s16, -v63
v_fma_f32 v21, v21, s16, -v63
v_fma_f32 v22, v22, s16, -v63
v_fma_f32 v23, v23, s16, -v63
v_fma_f32 v24, v24, s16, -v63
v_fma_f32 v25, v25, s16, -v63
v_fma_f32 v26, v26, s16, -v63
v_fma_f32 v27, v27, s16, -v63
v_exp_f32 v20, v20
v_exp_f32 v21, v21
v_exp_f32 v22, v22
v_exp_f32 v23, v23
v_exp_f32 v24, v24
v_exp_f32 v25, v25
v_exp_f32 v26, v26
v_exp_f32 v27, v27
v_add_f32 v65, v20, v21
v_add_f32 v65, v65, v22
v_add_f32 v65, v65, v23
v_add_f32 v65, v65, v24
v_add_f32 v65, v65, v25
v_add_f32 v65, v65, v26
v_add_f32 v65, v65, v27
v_mov_b32 v64, v65
s_nop 1
v_permlane16_swap_b32 v65, v64
v_add_f32 v65, v65, v64
v_mov_b32 v64, v65
s_nop 1
v_permlane32_swap_b32 v65, v64
v_add_f32 v65, v65, v64
v_rcp_f32 v65, v65
s_nop 0
v_mul_f32 v20, v20, v65
v_mul_f32 v21, v21, v65
v_mul_f32 v22, v22, v65
v_mul_f32 v23, v23, v65
v_mul_f32 v24, v24, v65
v_mul_f32 v25, v25, v65
v_mul_f32 v26, v26, v65
v_mul_f32 v27, v27, v65
v_cvt_pk_bf16_f32 v40, v20, v21
v_cvt_pk_bf16_f32 v41, v22, v23
v_mov_b32 v42, 0
v_mov_b32 v43, 0
v_cvt_pk_bf16_f32 v44, v24, v25
v_cvt_pk_bf16_f32 v45, v26, v27
v_max3_f32 v63, v28, v29, v30
v_max3_f32 v63, v63, v31, v32
v_max3_f32 v63, v63, v33, v34
v_max3_f32 v63, v63, v35, v36
v_max3_f32 v63, v63, v37, v38
v_max_f32 v63, v63, v39
v_mov_b32 v64, v63
s_nop 1
v_permlane16_swap_b32 v63, v64
v_max_f32 v63, v63, v64
v_mov_b32 v64, v63
s_nop 1
v_permlane32_swap_b32 v63, v64
v_max_f32 v63, v63, v64
v_mul_f32 v63, s16, v63
v_fma_f32 v28, v28, s16, -v63
v_fma_f32 v29, v29, s16, -v63
v_fma_f32 v30, v30, s16, -v63
v_fma_f32 v31, v31, s16, -v63
v_fma_f32 v32, v32, s16, -v63
v_fma_f32 v33, v33, s16, -v63
v_fma_f32 v34, v34, s16, -v63
v_fma_f32 v35, v35, s16, -v63
v_fma_f32 v36, v36, s16, -v63
v_fma_f32 v37, v37, s16, -v63
v_fma_f32 v38, v38, s16, -v63
v_fma_f32 v39, v39, s16, -v63
v_exp_f32 v28, v28
v_exp_f32 v29, v29
v_exp_f32 v30, v30
v_exp_f32 v31, v31
v_exp_f32 v32, v32
v_exp_f32 v33, v33
v_exp_f32 v34, v34
v_exp_f32 v35, v35
v_exp_f32 v36, v36
v_exp_f32 v37, v37
v_exp_f32 v38, v38
v_exp_f32 v39, v39
v_add_f32 v66, v28, v29
v_add_f32 v66, v66, v30
v_add_f32 v66, v66, v31
v_add_f32 v66, v66, v32
v_add_f32 v66, v66, v33
v_add_f32 v66, v66, v34
v_add_f32 v66, v66, v35
v_add_f32 v66, v66, v36
v_add_f32 v66, v66, v37
v_add_f32 v66, v66, v38
v_add_f32 v66, v66, v39
v_mov_b32 v64, v66
s_nop 1
v_permlane16_swap_b32 v66, v64
v_add_f32 v66, v66, v64
v_mov_b32 v64, v66
s_nop 1
v_permlane32_swap_b32 v66, v64
v_add_f32 v66, v66, v64
v_rcp_f32 v66, v66
s_nop 0
v_mul_f32 v28, v28, v66
v_mul_f32 v29, v29, v66
v_mul_f32 v30, v30, v66
v_mul_f32 v31, v31, v66
v_mul_f32 v32, v32, v66
v_mul_f32 v33, v33, v66
v_mul_f32 v34, v34, v66
v_mul_f32 v35, v35, v66
v_mul_f32 v36, v36, v66
v_mul_f32 v37, v37, v66
v_mul_f32 v38, v38, v66
v_mul_f32 v39, v39, v66
v_cvt_pk_bf16_f32 v46, v28, v29
v_cvt_pk_bf16_f32 v47, v30, v31
v_cvt_pk_bf16_f32 v48, v32, v33
v_cvt_pk_bf16_f32 v49, v34, v35
v_cvt_pk_bf16_f32 v50, v36, v37
v_cvt_pk_bf16_f32 v51, v38, v39
v_mfma_f32_16x16x16_bf16 v[52:55], a[240:241], v[44:45], 0
v_mfma_f32_16x16x16_bf16 v[56:59], a[242:243], v[44:45], 0
s_nop 4
v_mfma_f32_16x16x32_bf16 v[52:55], a[208:211], v[40:43], v[52:55]
v_mfma_f32_16x16x32_bf16 v[56:59], a[212:215], v[40:43], v[56:59]
s_nop 6
v_cvt_pk_bf16_f32 v68, v52, v53
v_cvt_pk_bf16_f32 v69, v54, v55
v_cvt_pk_bf16_f32 v70, v56, v57
v_cvt_pk_bf16_f32 v71, v58, v59
s_nop 0
v_permlane16_swap_b32 v68, v70
v_permlane16_swap_b32 v69, v71
v_add_u32 v4, 0, v16
global_store_dwordx4 v4, v[68:71], s[14:15] sc1
v_mfma_f32_16x16x16_bf16 v[52:55], a[244:245], v[44:45], 0
v_mfma_f32_16x16x16_bf16 v[56:59], a[246:247], v[44:45], 0
s_nop 4
v_mfma_f32_16x16x32_bf16 v[52:55], a[216:219], v[40:43], v[52:55]
v_mfma_f32_16x16x32_bf16 v[56:59], a[220:223], v[40:43], v[56:59]
s_nop 6
v_cvt_pk_bf16_f32 v72, v52, v53
v_cvt_pk_bf16_f32 v73, v54, v55
v_cvt_pk_bf16_f32 v74, v56, v57
v_cvt_pk_bf16_f32 v75, v58, v59
s_nop 0
v_permlane16_swap_b32 v72, v74
v_permlane16_swap_b32 v73, v75
v_add_u32 v4, 131072, v16
global_store_dwordx4 v4, v[72:75], s[14:15] sc1
v_mfma_f32_16x16x16_bf16 v[52:55], a[248:249], v[44:45], 0
v_mfma_f32_16x16x16_bf16 v[56:59], a[250:251], v[44:45], 0
s_nop 4
v_mfma_f32_16x16x32_bf16 v[52:55], a[224:227], v[40:43], v[52:55]
v_mfma_f32_16x16x32_bf16 v[56:59], a[228:231], v[40:43], v[56:59]
s_nop 6
v_cvt_pk_bf16_f32 v68, v52, v53
v_cvt_pk_bf16_f32 v69, v54, v55
v_cvt_pk_bf16_f32 v70, v56, v57
v_cvt_pk_bf16_f32 v71, v58, v59
s_nop 0
v_permlane16_swap_b32 v68, v70
v_permlane16_swap_b32 v69, v71
v_add_u32 v4, 262144, v16
global_store_dwordx4 v4, v[68:71], s[14:15] sc1
v_mfma_f32_16x16x16_bf16 v[52:55], a[252:253], v[44:45], 0
v_mfma_f32_16x16x16_bf16 v[56:59], a[254:255], v[44:45], 0
s_nop 4
v_mfma_f32_16x16x32_bf16 v[52:55], a[232:235], v[40:43], v[52:55]
v_mfma_f32_16x16x32_bf16 v[56:59], a[236:239], v[40:43], v[56:59]
s_nop 6
v_cvt_pk_bf16_f32 v72, v52, v53
v_cvt_pk_bf16_f32 v73, v54, v55
v_cvt_pk_bf16_f32 v74, v56, v57
v_cvt_pk_bf16_f32 v75, v58, v59
s_nop 0
v_permlane16_swap_b32 v72, v74
v_permlane16_swap_b32 v73, v75
v_add_u32 v4, 393216, v16
global_store_dwordx4 v4, v[72:75], s[14:15] sc1
v_mfma_f32_16x16x16_bf16 v[52:55], a[240:241], v[50:51], 0
v_mfma_f32_16x16x16_bf16 v[56:59], a[242:243], v[50:51], 0
s_nop 4
v_mfma_f32_16x16x32_bf16 v[52:55], a[208:211], v[46:49], v[52:55]
v_mfma_f32_16x16x32_bf16 v[56:59], a[212:215], v[46:49], v[56:59]
s_nop 6
v_cvt_pk_bf16_f32 v68, v52, v53
v_cvt_pk_bf16_f32 v69, v54, v55
v_cvt_pk_bf16_f32 v70, v56, v57
v_cvt_pk_bf16_f32 v71, v58, v59
s_nop 0
v_permlane16_swap_b32 v68, v70
v_permlane16_swap_b32 v69, v71
v_add_u32 v4, 1024, v16
global_store_dwordx4 v4, v[68:71], s[14:15] sc1
v_mfma_f32_16x16x16_bf16 v[52:55], a[244:245], v[50:51], 0
v_mfma_f32_16x16x16_bf16 v[56:59], a[246:247], v[50:51], 0
s_nop 4
v_mfma_f32_16x16x32_bf16 v[52:55], a[216:219], v[46:49], v[52:55]
v_mfma_f32_16x16x32_bf16 v[56:59], a[220:223], v[46:49], v[56:59]
s_nop 6
v_cvt_pk_bf16_f32 v72, v52, v53
v_cvt_pk_bf16_f32 v73, v54, v55
v_cvt_pk_bf16_f32 v74, v56, v57
v_cvt_pk_bf16_f32 v75, v58, v59
s_nop 0
v_permlane16_swap_b32 v72, v74
v_permlane16_swap_b32 v73, v75
v_add_u32 v4, 132096, v16
global_store_dwordx4 v4, v[72:75], s[14:15] sc1
v_mfma_f32_16x16x16_bf16 v[52:55], a[248:249], v[50:51], 0
v_mfma_f32_16x16x16_bf16 v[56:59], a[250:251], v[50:51], 0
s_nop 4
v_mfma_f32_16x16x32_bf16 v[52:55], a[224:227], v[46:49], v[52:55]
v_mfma_f32_16x16x32_bf16 v[56:59], a[228:231], v[46:49], v[56:59]
s_nop 6
v_cvt_pk_bf16_f32 v68, v52, v53
v_cvt_pk_bf16_f32 v69, v54, v55
v_cvt_pk_bf16_f32 v70, v56, v57
v_cvt_pk_bf16_f32 v71, v58, v59
s_nop 0
v_permlane16_swap_b32 v68, v70
v_permlane16_swap_b32 v69, v71
v_add_u32 v4, 263168, v16
global_store_dwordx4 v4, v[68:71], s[14:15] sc1
v_mfma_f32_16x16x16_bf16 v[52:55], a[252:253], v[50:51], 0
v_mfma_f32_16x16x16_bf16 v[56:59], a[254:255], v[50:51], 0
s_nop 4
v_mfma_f32_16x16x32_bf16 v[52:55], a[232:235], v[46:49], v[52:55]
v_mfma_f32_16x16x32_bf16 v[56:59], a[236:239], v[46:49], v[56:59]
s_nop 6
v_cvt_pk_bf16_f32 v72, v52, v53
v_cvt_pk_bf16_f32 v73, v54, v55
v_cvt_pk_bf16_f32 v74, v56, v57
v_cvt_pk_bf16_f32 v75, v58, v59
s_nop 0
v_permlane16_swap_b32 v72, v74
v_permlane16_swap_b32 v73, v75
v_add_u32 v4, 394240, v16
global_store_dwordx4 v4, v[72:75], s[14:15] sc1
s_add_u32 s28, s30, 1
s_add_u32 s29, s31, 1
s_lshl_b32 s21, s28, 18
s_lshl_b32 s22, s29, 13
s_add_u32 s21, s21, s22
s_add_u32 s10, s40, s21
s_addc_u32 s11, s41, 0
s_lshl_b32 s21, s28, 16
s_lshl_b32 s22, s29, 11
s_add_u32 s21, s21, s22
s_add_u32 s12, s40, s21
s_addc_u32 s13, s41, 0
s_lshl_b32 s21, s29, 19
s_lshl_b32 s22, s28, 11
s_add_u32 s21, s21, s22
s_add_u32 s14, s40, s21
s_addc_u32 s15, s41, 0
global_load_dwordx4 a[128:131], v8, s[10:11] offset:0 sc1
global_load_dwordx4 a[160:163], v10, s[10:11] offset:0 sc1
global_load_dwordx4 a[132:135], v8, s[10:11] offset:1024 sc1
global_load_dwordx4 a[164:167], v10, s[10:11] offset:1024 sc1
global_load_dwordx4 a[136:139], v8, s[10:11] offset:2048 sc1
global_load_dwordx4 a[168:171], v10, s[10:11] offset:2048 sc1
global_load_dwordx4 a[140:143], v8, s[10:11] offset:3072 sc1
global_load_dwordx4 a[172:175], v10, s[10:11] offset:3072 sc1
global_load_dwordx4 a[144:147], v9, s[10:11] offset:0 sc1
global_load_dwordx4 a[176:179], v11, s[10:11] offset:0 sc1
global_load_dwordx4 a[148:151], v9, s[10:11] offset:1024 sc1
global_load_dwordx4 a[180:183], v11, s[10:11] offset:1024 sc1
global_load_dwordx4 a[152:155], v9, s[10:11] offset:2048 sc1
global_load_dwordx4 a[184:187], v11, s[10:11] offset:2048 sc1
global_load_dwordx4 a[156:159], v9, s[10:11] offset:3072 sc1
global_load_dwordx4 a[188:191], v11, s[10:11] offset:3072 sc1
global_load_dwordx4 a[192:195], v14, s[12:13] offset:0 sc1
global_load_dwordx4 a[196:199], v14, s[12:13] offset:512 sc1
global_load_dwordx4 a[200:203], v14, s[12:13] offset:1024 sc1
global_load_dwordx4 a[204:207], v14, s[12:13] offset:1536 sc1
global_load_dwordx4 a[208:211], v12, s[10:11] offset:0 sc1
global_load_dwordx2 a[240:241], v15, s[12:13] offset:0 sc1
global_load_dwordx4 a[212:215], v12, s[10:11] offset:1024 sc1
global_load_dwordx2 a[242:243], v15, s[12:13] offset:256 sc1
global_load_dwordx4 a[216:219], v12, s[10:11] offset:2048 sc1
global_load_dwordx2 a[244:245], v15, s[12:13] offset:512 sc1
global_load_dwordx4 a[220:223], v12, s[10:11] offset:3072 sc1
global_load_dwordx2 a[246:247], v15, s[12:13] offset:768 sc1
global_load_dwordx4 a[224:227], v13, s[10:11] offset:0 sc1
global_load_dwordx2 a[248:249], v15, s[12:13] offset:1024 sc1
global_load_dwordx4 a[228:231], v13, s[10:11] offset:1024 sc1
global_load_dwordx2 a[250:251], v15, s[12:13] offset:1280 sc1
global_load_dwordx4 a[232:235], v13, s[10:11] offset:2048 sc1
global_load_dwordx2 a[252:253], v15, s[12:13] offset:1536 sc1
global_load_dwordx4 a[236:239], v13, s[10:11] offset:3072 sc1
global_load_dwordx2 a[254:255], v15, s[12:13] offset:1792 sc1
s_waitcnt vmcnt(44)
v_mfma_f32_16x16x32_bf16 v[20:23], a[32:35], a[0:3], 0
v_mfma_f32_16x16x32_bf16 v[20:23], a[36:39], a[4:7], v[20:23]
v_mfma_f32_16x16x32_bf16 v[20:23], a[40:43], a[8:11], v[20:23]
v_mfma_f32_16x16x32_bf16 v[20:23], a[44:47], a[12:15], v[20:23]
v_mfma_f32_16x16x32_bf16 v[24:27], a[64:67], a[0:3], 0
v_mfma_f32_16x16x32_bf16 v[24:27], a[68:71], a[4:7], v[24:27]
v_mfma_f32_16x16x32_bf16 v[24:27], a[72:75], a[8:11], v[24:27]
v_mfma_f32_16x16x32_bf16 v[24:27], a[76:79], a[12:15], v[24:27]
v_mfma_f32_16x16x32_bf16 v[28:31], a[32:35], a[16:19], 0
v_mfma_f32_16x16x32_bf16 v[28:31], a[36:39], a[20:23], v[28:31]
v_mfma_f32_16x16x32_bf16 v[28:31], a[40:43], a[24:27], v[28:31]
v_mfma_f32_16x16x32_bf16 v[28:31], a[44:47], a[28:31], v[28:31]
v_mfma_f32_16x16x32_bf16 v[32:35], a[48:51], a[16:19], 0
v_mfma_f32_16x16x32_bf16 v[32:35], a[52:55], a[20:23], v[32:35]
v_mfma_f32_16x16x32_bf16 v[32:35], a[56:59], a[24:27], v[32:35]
v_mfma_f32_16x16x32_bf16 v[32:35], a[60:63], a[28:31], v[32:35]
v_mfma_f32_16x16x32_bf16 v[36:39], a[64:67], a[16:19], 0
v_mfma_f32_16x16x32_bf16 v[36:39], a[68:71], a[20:23], v[36:39]
v_mfma_f32_16x16x32_bf16 v[36:39], a[72:75], a[24:27], v[36:39]
v_mfma_f32_16x16x32_bf16 v[36:39], a[76:79], a[28:31], v[36:39]
v_mov_b32 v60, 0xff800000
v_lshlrev_b32 v61, 2, v3
v_add_u32 v62, 0, v61
v_cmp_gt_u32 vcc, v62, v2
s_nop 1
v_cndmask_b32 v20, v20, v60, vcc
v_cndmask_b32 v32, v32, v60, vcc
v_cndmask_b32 v24, v24, v60, s[18:19]
v_cndmask_b32 v36, v36, v60, s[18:19]
v_add_u32 v62, 1, v61
v_cmp_gt_u32 vcc, v62, v2
s_nop 1
v_cndmask_b32 v21, v21, v60, vcc
v_cndmask_b32 v33, v33, v60, vcc
v_cndmask_b32 v25, v25, v60, s[18:19]
v_cndmask_b32 v37, v37, v60, s[18:19]
v_add_u32 v62, 2, v61
v_cmp_gt_u32 vcc, v62, v2
s_nop 1
v_cndmask_b32 v22, v22, v60, vcc
v_cndmask_b32 v34, v34, v60, vcc
v_cndmask_b32 v26, v26, v60, s[18:19]
v_cndmask_b32 v38, v38, v60, s[18:19]
v_add_u32 v62, 3, v61
v_cmp_gt_u32 vcc, v62, v2
s_nop 1
v_cndmask_b32 v23, v23, v60, vcc
v_cndmask_b32 v35, v35, v60, vcc
v_cndmask_b32 v27, v27, v60, s[18:19]
v_cndmask_b32 v39, v39, v60, s[18:19]
v_max3_f32 v63, v20, v21, v22
v_max3_f32 v63, v63, v23, v24
v_max3_f32 v63, v63, v25, v26
v_max_f32 v63, v63, v27
v_mov_b32 v64, v63
s_nop 1
v_permlane16_swap_b32 v63, v64
v_max_f32 v63, v63, v64
v_mov_b32 v64, v63
s_nop 1
v_permlane32_swap_b32 v63, v64
v_max_f32 v63, v63, v64
v_mul_f32 v63, s16, v63
v_fma_f32 v20, v20, s16, -v63
v_fma_f32 v21, v21, s16, -v63
v_fma_f32 v22, v22, s16, -v63
v_fma_f32 v23, v23, s16, -v63
v_fma_f32 v24, v24, s16, -v63
v_fma_f32 v25, v25, s16, -v63
v_fma_f32 v26, v26, s16, -v63
v_fma_f32 v27, v27, s16, -v63
v_exp_f32 v20, v20
v_exp_f32 v21, v21
v_exp_f32 v22, v22
v_exp_f32 v23, v23
v_exp_f32 v24, v24
v_exp_f32 v25, v25
v_exp_f32 v26, v26
v_exp_f32 v27, v27
v_add_f32 v65, v20, v21
v_add_f32 v65, v65, v22
v_add_f32 v65, v65, v23
v_add_f32 v65, v65, v24
v_add_f32 v65, v65, v25
v_add_f32 v65, v65, v26
v_add_f32 v65, v65, v27
v_mov_b32 v64, v65
s_nop 1
v_permlane16_swap_b32 v65, v64
v_add_f32 v65, v65, v64
v_mov_b32 v64, v65
s_nop 1
v_permlane32_swap_b32 v65, v64
v_add_f32 v65, v65, v64
v_rcp_f32 v65, v65
s_nop 0
v_mul_f32 v20, v20, v65
v_mul_f32 v21, v21, v65
v_mul_f32 v22, v22, v65
v_mul_f32 v23, v23, v65
v_mul_f32 v24, v24, v65
v_mul_f32 v25, v25, v65
v_mul_f32 v26, v26, v65
v_mul_f32 v27, v27, v65
v_cvt_pk_bf16_f32 v40, v20, v21
v_cvt_pk_bf16_f32 v41, v22, v23
v_mov_b32 v42, 0
v_mov_b32 v43, 0
v_cvt_pk_bf16_f32 v44, v24, v25
v_cvt_pk_bf16_f32 v45, v26, v27
v_max3_f32 v63, v28, v29, v30
v_max3_f32 v63, v63, v31, v32
v_max3_f32 v63, v63, v33, v34
v_max3_f32 v63, v63, v35, v36
v_max3_f32 v63, v63, v37, v38
v_max_f32 v63, v63, v39
v_mov_b32 v64, v63
s_nop 1
v_permlane16_swap_b32 v63, v64
v_max_f32 v63, v63, v64
v_mov_b32 v64, v63
s_nop 1
v_permlane32_swap_b32 v63, v64
v_max_f32 v63, v63, v64
v_mul_f32 v63, s16, v63
v_fma_f32 v28, v28, s16, -v63
v_fma_f32 v29, v29, s16, -v63
v_fma_f32 v30, v30, s16, -v63
v_fma_f32 v31, v31, s16, -v63
v_fma_f32 v32, v32, s16, -v63
v_fma_f32 v33, v33, s16, -v63
v_fma_f32 v34, v34, s16, -v63
v_fma_f32 v35, v35, s16, -v63
v_fma_f32 v36, v36, s16, -v63
v_fma_f32 v37, v37, s16, -v63
v_fma_f32 v38, v38, s16, -v63
v_fma_f32 v39, v39, s16, -v63
v_exp_f32 v28, v28
v_exp_f32 v29, v29
v_exp_f32 v30, v30
v_exp_f32 v31, v31
v_exp_f32 v32, v32
v_exp_f32 v33, v33
v_exp_f32 v34, v34
v_exp_f32 v35, v35
v_exp_f32 v36, v36
v_exp_f32 v37, v37
v_exp_f32 v38, v38
v_exp_f32 v39, v39
v_add_f32 v66, v28, v29
v_add_f32 v66, v66, v30
v_add_f32 v66, v66, v31
v_add_f32 v66, v66, v32
v_add_f32 v66, v66, v33
v_add_f32 v66, v66, v34
v_add_f32 v66, v66, v35
v_add_f32 v66, v66, v36
v_add_f32 v66, v66, v37
v_add_f32 v66, v66, v38
v_add_f32 v66, v66, v39
v_mov_b32 v64, v66
s_nop 1
v_permlane16_swap_b32 v66, v64
v_add_f32 v66, v66, v64
v_mov_b32 v64, v66
s_nop 1
v_permlane32_swap_b32 v66, v64
v_add_f32 v66, v66, v64
v_rcp_f32 v66, v66
s_nop 0
v_mul_f32 v28, v28, v66
v_mul_f32 v29, v29, v66
v_mul_f32 v30, v30, v66
v_mul_f32 v31, v31, v66
v_mul_f32 v32, v32, v66
v_mul_f32 v33, v33, v66
v_mul_f32 v34, v34, v66
v_mul_f32 v35, v35, v66
v_mul_f32 v36, v36, v66
v_mul_f32 v37, v37, v66
v_mul_f32 v38, v38, v66
v_mul_f32 v39, v39, v66
v_cvt_pk_bf16_f32 v46, v28, v29
v_cvt_pk_bf16_f32 v47, v30, v31
v_cvt_pk_bf16_f32 v48, v32, v33
v_cvt_pk_bf16_f32 v49, v34, v35
v_cvt_pk_bf16_f32 v50, v36, v37
v_cvt_pk_bf16_f32 v51, v38, v39
v_mfma_f32_16x16x16_bf16 v[52:55], a[112:113], v[44:45], 0
v_mfma_f32_16x16x16_bf16 v[56:59], a[114:115], v[44:45], 0
s_nop 4
v_mfma_f32_16x16x32_bf16 v[52:55], a[80:83], v[40:43], v[52:55]
v_mfma_f32_16x16x32_bf16 v[56:59], a[84:87], v[40:43], v[56:59]
s_nop 6
v_cvt_pk_bf16_f32 v68, v52, v53
v_cvt_pk_bf16_f32 v69, v54, v55
v_cvt_pk_bf16_f32 v70, v56, v57
v_cvt_pk_bf16_f32 v71, v58, v59
s_nop 0
v_permlane16_swap_b32 v68, v70
v_permlane16_swap_b32 v69, v71
v_add_u32 v4, 0, v16
global_store_dwordx4 v4, v[68:71], s[8:9] sc1
v_mfma_f32_16x16x16_bf16 v[52:55], a[116:117], v[44:45], 0
v_mfma_f32_16x16x16_bf16 v[56:59], a[118:119], v[44:45], 0
s_nop 4
v_mfma_f32_16x16x32_bf16 v[52:55], a[88:91], v[40:43], v[52:55]
v_mfma_f32_16x16x32_bf16 v[56:59], a[92:95], v[40:43], v[56:59]
s_nop 6
v_cvt_pk_bf16_f32 v72, v52, v53
v_cvt_pk_bf16_f32 v73, v54, v55
v_cvt_pk_bf16_f32 v74, v56, v57
v_cvt_pk_bf16_f32 v75, v58, v59
s_nop 0
v_permlane16_swap_b32 v72, v74
v_permlane16_swap_b32 v73, v75
v_add_u32 v4, 131072, v16
global_store_dwordx4 v4, v[72:75], s[8:9] sc1
v_mfma_f32_16x16x16_bf16 v[52:55], a[120:121], v[44:45], 0
v_mfma_f32_16x16x16_bf16 v[56:59], a[122:123], v[44:45], 0
s_nop 4
v_mfma_f32_16x16x32_bf16 v[52:55], a[96:99], v[40:43], v[52:55]
v_mfma_f32_16x16x32_bf16 v[56:59], a[100:103], v[40:43], v[56:59]
s_nop 6
v_cvt_pk_bf16_f32 v68, v52, v53
v_cvt_pk_bf16_f32 v69, v54, v55
v_cvt_pk_bf16_f32 v70, v56, v57
v_cvt_pk_bf16_f32 v71, v58, v59
s_nop 0
v_permlane16_swap_b32 v68, v70
v_permlane16_swap_b32 v69, v71
v_add_u32 v4, 262144, v16
global_store_dwordx4 v4, v[68:71], s[8:9] sc1
v_mfma_f32_16x16x16_bf16 v[52:55], a[124:125], v[44:45], 0
v_mfma_f32_16x16x16_bf16 v[56:59], a[126:127], v[44:45], 0
s_nop 4
v_mfma_f32_16x16x32_bf16 v[52:55], a[104:107], v[40:43], v[52:55]
v_mfma_f32_16x16x32_bf16 v[56:59], a[108:111], v[40:43], v[56:59]
s_nop 6
v_cvt_pk_bf16_f32 v72, v52, v53
v_cvt_pk_bf16_f32 v73, v54, v55
v_cvt_pk_bf16_f32 v74, v56, v57
v_cvt_pk_bf16_f32 v75, v58, v59
s_nop 0
v_permlane16_swap_b32 v72, v74
v_permlane16_swap_b32 v73, v75
v_add_u32 v4, 393216, v16
global_store_dwordx4 v4, v[72:75], s[8:9] sc1
v_mfma_f32_16x16x16_bf16 v[52:55], a[112:113], v[50:51], 0
v_mfma_f32_16x16x16_bf16 v[56:59], a[114:115], v[50:51], 0
s_nop 4
v_mfma_f32_16x16x32_bf16 v[52:55], a[80:83], v[46:49], v[52:55]
v_mfma_f32_16x16x32_bf16 v[56:59], a[84:87], v[46:49], v[56:59]
s_nop 6
v_cvt_pk_bf16_f32 v68, v52, v53
v_cvt_pk_bf16_f32 v69, v54, v55
v_cvt_pk_bf16_f32 v70, v56, v57
v_cvt_pk_bf16_f32 v71, v58, v59
s_nop 0
v_permlane16_swap_b32 v68, v70
v_permlane16_swap_b32 v69, v71
v_add_u32 v4, 1024, v16
global_store_dwordx4 v4, v[68:71], s[8:9] sc1
v_mfma_f32_16x16x16_bf16 v[52:55], a[116:117], v[50:51], 0
v_mfma_f32_16x16x16_bf16 v[56:59], a[118:119], v[50:51], 0
s_nop 4
v_mfma_f32_16x16x32_bf16 v[52:55], a[88:91], v[46:49], v[52:55]
v_mfma_f32_16x16x32_bf16 v[56:59], a[92:95], v[46:49], v[56:59]
s_nop 6
v_cvt_pk_bf16_f32 v72, v52, v53
v_cvt_pk_bf16_f32 v73, v54, v55
v_cvt_pk_bf16_f32 v74, v56, v57
v_cvt_pk_bf16_f32 v75, v58, v59
s_nop 0
v_permlane16_swap_b32 v72, v74
v_permlane16_swap_b32 v73, v75
v_add_u32 v4, 132096, v16
global_store_dwordx4 v4, v[72:75], s[8:9] sc1
v_mfma_f32_16x16x16_bf16 v[52:55], a[120:121], v[50:51], 0
v_mfma_f32_16x16x16_bf16 v[56:59], a[122:123], v[50:51], 0
s_nop 4
v_mfma_f32_16x16x32_bf16 v[52:55], a[96:99], v[46:49], v[52:55]
v_mfma_f32_16x16x32_bf16 v[56:59], a[100:103], v[46:49], v[56:59]
s_nop 6
v_cvt_pk_bf16_f32 v68, v52, v53
v_cvt_pk_bf16_f32 v69, v54, v55
v_cvt_pk_bf16_f32 v70, v56, v57
v_cvt_pk_bf16_f32 v71, v58, v59
s_nop 0
v_permlane16_swap_b32 v68, v70
v_permlane16_swap_b32 v69, v71
v_add_u32 v4, 263168, v16
global_store_dwordx4 v4, v[68:71], s[8:9] sc1
v_mfma_f32_16x16x16_bf16 v[52:55], a[124:125], v[50:51], 0
v_mfma_f32_16x16x16_bf16 v[56:59], a[126:127], v[50:51], 0
s_nop 4
v_mfma_f32_16x16x32_bf16 v[52:55], a[104:107], v[46:49], v[52:55]
v_mfma_f32_16x16x32_bf16 v[56:59], a[108:111], v[46:49], v[56:59]
s_nop 6
v_cvt_pk_bf16_f32 v72, v52, v53
v_cvt_pk_bf16_f32 v73, v54, v55
v_cvt_pk_bf16_f32 v74, v56, v57
v_cvt_pk_bf16_f32 v75, v58, v59
s_nop 0
v_permlane16_swap_b32 v72, v74
v_permlane16_swap_b32 v73, v75
v_add_u32 v4, 394240, v16
global_store_dwordx4 v4, v[72:75], s[8:9] sc1
s_waitcnt vmcnt(8)
v_mfma_f32_16x16x32_bf16 v[20:23], a[160:163], a[128:131], 0
v_mfma_f32_16x16x32_bf16 v[20:23], a[164:167], a[132:135], v[20:23]
v_mfma_f32_16x16x32_bf16 v[20:23], a[168:171], a[136:139], v[20:23]
v_mfma_f32_16x16x32_bf16 v[20:23], a[172:175], a[140:143], v[20:23]
v_mfma_f32_16x16x32_bf16 v[24:27], a[192:195], a[128:131], 0
v_mfma_f32_16x16x32_bf16 v[24:27], a[196:199], a[132:135], v[24:27]
v_mfma_f32_16x16x32_bf16 v[24:27], a[200:203], a[136:139], v[24:27]
v_mfma_f32_16x16x32_bf16 v[24:27], a[204:207], a[140:143], v[24:27]
v_mfma_f32_16x16x32_bf16 v[28:31], a[160:163], a[144:147], 0
v_mfma_f32_16x16x32_bf16 v[28:31], a[164:167], a[148:151], v[28:31]
v_mfma_f32_16x16x32_bf16 v[28:31], a[168:171], a[152:155], v[28:31]
v_mfma_f32_16x16x32_bf16 v[28:31], a[172:175], a[156:159], v[28:31]
v_mfma_f32_16x16x32_bf16 v[32:35], a[176:179], a[144:147], 0
v_mfma_f32_16x16x32_bf16 v[32:35], a[180:183], a[148:151], v[32:35]
v_mfma_f32_16x16x32_bf16 v[32:35], a[184:187], a[152:155], v[32:35]
v_mfma_f32_16x16x32_bf16 v[32:35], a[188:191], a[156:159], v[32:35]
v_mfma_f32_16x16x32_bf16 v[36:39], a[192:195], a[144:147], 0
v_mfma_f32_16x16x32_bf16 v[36:39], a[196:199], a[148:151], v[36:39]
v_mfma_f32_16x16x32_bf16 v[36:39], a[200:203], a[152:155], v[36:39]
v_mfma_f32_16x16x32_bf16 v[36:39], a[204:207], a[156:159], v[36:39]
v_mov_b32 v60, 0xff800000
v_lshlrev_b32 v61, 2, v3
v_add_u32 v62, 0, v61
v_cmp_gt_u32 vcc, v62, v2
s_nop 1
v_cndmask_b32 v20, v20, v60, vcc
v_cndmask_b32 v32, v32, v60, vcc
v_cndmask_b32 v24, v24, v60, s[18:19]
v_cndmask_b32 v36, v36, v60, s[18:19]
v_add_u32 v62, 1, v61
v_cmp_gt_u32 vcc, v62, v2
s_nop 1
v_cndmask_b32 v21, v21, v60, vcc
v_cndmask_b32 v33, v33, v60, vcc
v_cndmask_b32 v25, v25, v60, s[18:19]
v_cndmask_b32 v37, v37, v60, s[18:19]
v_add_u32 v62, 2, v61
v_cmp_gt_u32 vcc, v62, v2
s_nop 1
v_cndmask_b32 v22, v22, v60, vcc
v_cndmask_b32 v34, v34, v60, vcc
v_cndmask_b32 v26, v26, v60, s[18:19]
v_cndmask_b32 v38, v38, v60, s[18:19]
v_add_u32 v62, 3, v61
v_cmp_gt_u32 vcc, v62, v2
s_nop 1
v_cndmask_b32 v23, v23, v60, vcc
v_cndmask_b32 v35, v35, v60, vcc
v_cndmask_b32 v27, v27, v60, s[18:19]
v_cndmask_b32 v39, v39, v60, s[18:19]
v_max3_f32 v63, v20, v21, v22
v_max3_f32 v63, v63, v23, v24
v_max3_f32 v63, v63, v25, v26
v_max_f32 v63, v63, v27
v_mov_b32 v64, v63
s_nop 1
v_permlane16_swap_b32 v63, v64
v_max_f32 v63, v63, v64
v_mov_b32 v64, v63
s_nop 1
v_permlane32_swap_b32 v63, v64
v_max_f32 v63, v63, v64
v_mul_f32 v63, s16, v63
v_fma_f32 v20, v20, s16, -v63
v_fma_f32 v21, v21, s16, -v63
v_fma_f32 v22, v22, s16, -v63
v_fma_f32 v23, v23, s16, -v63
v_fma_f32 v24, v24, s16, -v63
v_fma_f32 v25, v25, s16, -v63
v_fma_f32 v26, v26, s16, -v63
v_fma_f32 v27, v27, s16, -v63
v_exp_f32 v20, v20
v_exp_f32 v21, v21
v_exp_f32 v22, v22
v_exp_f32 v23, v23
v_exp_f32 v24, v24
v_exp_f32 v25, v25
v_exp_f32 v26, v26
v_exp_f32 v27, v27
v_add_f32 v65, v20, v21
v_add_f32 v65, v65, v22
v_add_f32 v65, v65, v23
v_add_f32 v65, v65, v24
v_add_f32 v65, v65, v25
v_add_f32 v65, v65, v26
v_add_f32 v65, v65, v27
v_mov_b32 v64, v65
s_nop 1
v_permlane16_swap_b32 v65, v64
v_add_f32 v65, v65, v64
v_mov_b32 v64, v65
s_nop 1
v_permlane32_swap_b32 v65, v64
v_add_f32 v65, v65, v64
v_rcp_f32 v65, v65
s_nop 0
v_mul_f32 v20, v20, v65
v_mul_f32 v21, v21, v65
v_mul_f32 v22, v22, v65
v_mul_f32 v23, v23, v65
v_mul_f32 v24, v24, v65
v_mul_f32 v25, v25, v65
v_mul_f32 v26, v26, v65
v_mul_f32 v27, v27, v65
v_cvt_pk_bf16_f32 v40, v20, v21
v_cvt_pk_bf16_f32 v41, v22, v23
v_mov_b32 v42, 0
v_mov_b32 v43, 0
v_cvt_pk_bf16_f32 v44, v24, v25
v_cvt_pk_bf16_f32 v45, v26, v27
v_max3_f32 v63, v28, v29, v30
v_max3_f32 v63, v63, v31, v32
v_max3_f32 v63, v63, v33, v34
v_max3_f32 v63, v63, v35, v36
v_max3_f32 v63, v63, v37, v38
v_max_f32 v63, v63, v39
v_mov_b32 v64, v63
s_nop 1
v_permlane16_swap_b32 v63, v64
v_max_f32 v63, v63, v64
v_mov_b32 v64, v63
s_nop 1
v_permlane32_swap_b32 v63, v64
v_max_f32 v63, v63, v64
v_mul_f32 v63, s16, v63
v_fma_f32 v28, v28, s16, -v63
v_fma_f32 v29, v29, s16, -v63
v_fma_f32 v30, v30, s16, -v63
v_fma_f32 v31, v31, s16, -v63
v_fma_f32 v32, v32, s16, -v63
v_fma_f32 v33, v33, s16, -v63
v_fma_f32 v34, v34, s16, -v63
v_fma_f32 v35, v35, s16, -v63
v_fma_f32 v36, v36, s16, -v63
v_fma_f32 v37, v37, s16, -v63
v_fma_f32 v38, v38, s16, -v63
v_fma_f32 v39, v39, s16, -v63
v_exp_f32 v28, v28
v_exp_f32 v29, v29
v_exp_f32 v30, v30
v_exp_f32 v31, v31
v_exp_f32 v32, v32
v_exp_f32 v33, v33
v_exp_f32 v34, v34
v_exp_f32 v35, v35
v_exp_f32 v36, v36
v_exp_f32 v37, v37
v_exp_f32 v38, v38
v_exp_f32 v39, v39
v_add_f32 v66, v28, v29
v_add_f32 v66, v66, v30
v_add_f32 v66, v66, v31
v_add_f32 v66, v66, v32
v_add_f32 v66, v66, v33
v_add_f32 v66, v66, v34
v_add_f32 v66, v66, v35
v_add_f32 v66, v66, v36
v_add_f32 v66, v66, v37
v_add_f32 v66, v66, v38
v_add_f32 v66, v66, v39
v_mov_b32 v64, v66
s_nop 1
v_permlane16_swap_b32 v66, v64
v_add_f32 v66, v66, v64
v_mov_b32 v64, v66
s_nop 1
v_permlane32_swap_b32 v66, v64
v_add_f32 v66, v66, v64
v_rcp_f32 v66, v66
s_nop 0
v_mul_f32 v28, v28, v66
v_mul_f32 v29, v29, v66
v_mul_f32 v30, v30, v66
v_mul_f32 v31, v31, v66
v_mul_f32 v32, v32, v66
v_mul_f32 v33, v33, v66
v_mul_f32 v34, v34, v66
v_mul_f32 v35, v35, v66
v_mul_f32 v36, v36, v66
v_mul_f32 v37, v37, v66
v_mul_f32 v38, v38, v66
v_mul_f32 v39, v39, v66
v_cvt_pk_bf16_f32 v46, v28, v29
v_cvt_pk_bf16_f32 v47, v30, v31
v_cvt_pk_bf16_f32 v48, v32, v33
v_cvt_pk_bf16_f32 v49, v34, v35
v_cvt_pk_bf16_f32 v50, v36, v37
v_cvt_pk_bf16_f32 v51, v38, v39
v_mfma_f32_16x16x16_bf16 v[52:55], a[240:241], v[44:45], 0
v_mfma_f32_16x16x16_bf16 v[56:59], a[242:243], v[44:45], 0
s_nop 4
v_mfma_f32_16x16x32_bf16 v[52:55], a[208:211], v[40:43], v[52:55]
v_mfma_f32_16x16x32_bf16 v[56:59], a[212:215], v[40:43], v[56:59]
s_nop 6
v_cvt_pk_bf16_f32 v68, v52, v53
v_cvt_pk_bf16_f32 v69, v54, v55
v_cvt_pk_bf16_f32 v70, v56, v57
v_cvt_pk_bf16_f32 v71, v58, v59
s_nop 0
v_permlane16_swap_b32 v68, v70
v_permlane16_swap_b32 v69, v71
v_add_u32 v4, 0, v16
global_store_dwordx4 v4, v[68:71], s[14:15] sc1
v_mfma_f32_16x16x16_bf16 v[52:55], a[244:245], v[44:45], 0
v_mfma_f32_16x16x16_bf16 v[56:59], a[246:247], v[44:45], 0
s_nop 4
v_mfma_f32_16x16x32_bf16 v[52:55], a[216:219], v[40:43], v[52:55]
v_mfma_f32_16x16x32_bf16 v[56:59], a[220:223], v[40:43], v[56:59]
s_nop 6
v_cvt_pk_bf16_f32 v72, v52, v53
v_cvt_pk_bf16_f32 v73, v54, v55
v_cvt_pk_bf16_f32 v74, v56, v57
v_cvt_pk_bf16_f32 v75, v58, v59
s_nop 0
v_permlane16_swap_b32 v72, v74
v_permlane16_swap_b32 v73, v75
v_add_u32 v4, 131072, v16
global_store_dwordx4 v4, v[72:75], s[14:15] sc1
v_mfma_f32_16x16x16_bf16 v[52:55], a[248:249], v[44:45], 0
v_mfma_f32_16x16x16_bf16 v[56:59], a[250:251], v[44:45], 0
s_nop 4
v_mfma_f32_16x16x32_bf16 v[52:55], a[224:227], v[40:43], v[52:55]
v_mfma_f32_16x16x32_bf16 v[56:59], a[228:231], v[40:43], v[56:59]
s_nop 6
v_cvt_pk_bf16_f32 v68, v52, v53
v_cvt_pk_bf16_f32 v69, v54, v55
v_cvt_pk_bf16_f32 v70, v56, v57
v_cvt_pk_bf16_f32 v71, v58, v59
s_nop 0
v_permlane16_swap_b32 v68, v70
v_permlane16_swap_b32 v69, v71
v_add_u32 v4, 262144, v16
global_store_dwordx4 v4, v[68:71], s[14:15] sc1
v_mfma_f32_16x16x16_bf16 v[52:55], a[252:253], v[44:45], 0
v_mfma_f32_16x16x16_bf16 v[56:59], a[254:255], v[44:45], 0
s_nop 4
v_mfma_f32_16x16x32_bf16 v[52:55], a[232:235], v[40:43], v[52:55]
v_mfma_f32_16x16x32_bf16 v[56:59], a[236:239], v[40:43], v[56:59]
s_nop 6
v_cvt_pk_bf16_f32 v72, v52, v53
v_cvt_pk_bf16_f32 v73, v54, v55
v_cvt_pk_bf16_f32 v74, v56, v57
v_cvt_pk_bf16_f32 v75, v58, v59
s_nop 0
v_permlane16_swap_b32 v72, v74
v_permlane16_swap_b32 v73, v75
v_add_u32 v4, 393216, v16
global_store_dwordx4 v4, v[72:75], s[14:15] sc1
v_mfma_f32_16x16x16_bf16 v[52:55], a[240:241], v[50:51], 0
v_mfma_f32_16x16x16_bf16 v[56:59], a[242:243], v[50:51], 0
s_nop 4
v_mfma_f32_16x16x32_bf16 v[52:55], a[208:211], v[46:49], v[52:55]
v_mfma_f32_16x16x32_bf16 v[56:59], a[212:215], v[46:49], v[56:59]
s_nop 6
v_cvt_pk_bf16_f32 v68, v52, v53
v_cvt_pk_bf16_f32 v69, v54, v55
v_cvt_pk_bf16_f32 v70, v56, v57
v_cvt_pk_bf16_f32 v71, v58, v59
s_nop 0
v_permlane16_swap_b32 v68, v70
v_permlane16_swap_b32 v69, v71
v_add_u32 v4, 1024, v16
global_store_dwordx4 v4, v[68:71], s[14:15] sc1
v_mfma_f32_16x16x16_bf16 v[52:55], a[244:245], v[50:51], 0
v_mfma_f32_16x16x16_bf16 v[56:59], a[246:247], v[50:51], 0
s_nop 4
v_mfma_f32_16x16x32_bf16 v[52:55], a[216:219], v[46:49], v[52:55]
v_mfma_f32_16x16x32_bf16 v[56:59], a[220:223], v[46:49], v[56:59]
s_nop 6
v_cvt_pk_bf16_f32 v72, v52, v53
v_cvt_pk_bf16_f32 v73, v54, v55
v_cvt_pk_bf16_f32 v74, v56, v57
v_cvt_pk_bf16_f32 v75, v58, v59
s_nop 0
v_permlane16_swap_b32 v72, v74
v_permlane16_swap_b32 v73, v75
v_add_u32 v4, 132096, v16
global_store_dwordx4 v4, v[72:75], s[14:15] sc1
v_mfma_f32_16x16x16_bf16 v[52:55], a[248:249], v[50:51], 0
v_mfma_f32_16x16x16_bf16 v[56:59], a[250:251], v[50:51], 0
s_nop 4
v_mfma_f32_16x16x32_bf16 v[52:55], a[224:227], v[46:49], v[52:55]
v_mfma_f32_16x16x32_bf16 v[56:59], a[228:231], v[46:49], v[56:59]
s_nop 6
v_cvt_pk_bf16_f32 v68, v52, v53
v_cvt_pk_bf16_f32 v69, v54, v55
v_cvt_pk_bf16_f32 v70, v56, v57
v_cvt_pk_bf16_f32 v71, v58, v59
s_nop 0
v_permlane16_swap_b32 v68, v70
v_permlane16_swap_b32 v69, v71
v_add_u32 v4, 263168, v16
global_store_dwordx4 v4, v[68:71], s[14:15] sc1
v_mfma_f32_16x16x16_bf16 v[52:55], a[252:253], v[50:51], 0
v_mfma_f32_16x16x16_bf16 v[56:59], a[254:255], v[50:51], 0
s_nop 4
v_mfma_f32_16x16x32_bf16 v[52:55], a[232:235], v[46:49], v[52:55]
v_mfma_f32_16x16x32_bf16 v[56:59], a[236:239], v[46:49], v[56:59]
s_nop 6
v_cvt_pk_bf16_f32 v72, v52, v53
v_cvt_pk_bf16_f32 v73, v54, v55
v_cvt_pk_bf16_f32 v74, v56, v57
v_cvt_pk_bf16_f32 v75, v58, v59
s_nop 0
v_permlane16_swap_b32 v72, v74
v_permlane16_swap_b32 v73, v75
v_add_u32 v4, 394240, v16
global_store_dwordx4 v4, v[72:75], s[14:15] sc1
s_lshl_b32 s66, s61, 4
s_lshl_b32 s67, s58, 2
s_add_u32 s66, s66, s67
s_waitcnt vmcnt(0)
s_barrier
v_mov_b32 v44, 163824
s_cmp_lg_u32 s20, 0
s_cbranch_scc1 M_sw_123
s_add_u32 s64, s66, 176160768
v_mov_b32 v42, s64
v_mov_b32 v43, 4
s_mov_b64 exec, 1
global_atomic_add v42, v43, s[40:41]
s_mov_b64 exec, -1
M_sw_123:
s_branch W_loop
W_at1:
s_lshr_b32 s63, s61, 2
s_cmp_lg_u32 s20, 0
s_cbranch_scc1 M_wcd_125
s_lshl_b32 s64, s63, 2
s_add_u32 s64, s64, 160
v_mov_b32 v42, s64
s_mov_b32 s65, 0
s_mov_b64 exec, 1
M_wc_124:
global_load_dword v43, v42, s[56:57] sc1
s_waitcnt vmcnt(0)
v_readfirstlane_b32 s64, v43
s_cmp_ge_u32 s64, 16
s_cbranch_scc1 M_wcd_125_x
s_sleep 32
s_add_u32 s65, s65, 1
s_cmp_lt_u32 s65, 400000
s_cbranch_scc1 M_wc_124
s_mov_b64 exec, -1
s_branch M_exit0
M_wcd_125_x:
s_mov_b64 exec, -1
M_wcd_125:
s_barrier
s_lshl_b32 s66, s61, 6
s_add_u32 s66, s66, 64
s_cmp_lg_u32 s20, 0
s_cbranch_scc1 M_wcd_127
s_lshl_b32 s64, s58, 2
s_add_u32 s64, s64, 224
v_mov_b32 v42, s64
s_mov_b32 s65, 0
s_mov_b64 exec, 1
M_wc_126:
global_load_dword v43, v42, s[56:57] sc1
s_waitcnt vmcnt(0)
v_readfirstlane_b32 s64, v43
s_cmp_ge_u32 s64, s66
s_cbranch_scc1 M_wcd_127_x
s_sleep 8
s_add_u32 s65, s65, 1
s_cmp_lt_u32 s65, 400000
s_cbranch_scc1 M_wc_126
s_mov_b64 exec, -1
s_branch M_exit0
M_wcd_127_x:
s_mov_b64 exec, -1
M_wcd_127:
s_barrier
s_lshl_b32 s30, s61, 1
s_lshr_b32 s64, s62, 1
s_add_u32 s30, s30, s64
s_lshl_b32 s31, s58, 3
s_and_b32 s64, s62, 1
s_lshl_b32 s64, s64, 2
s_add_u32 s31, s31, s64
s_add_u32 s31, s31, s20
v_and_b32 v1, 63, v0
v_and_b32 v2, 15, v1
v_lshrrev_b32 v3, 4, v1
s_mov_b32 s16, 0x3e0293ee
s_mov_b32 s18, 0
s_mov_b32 s19, -1
v_lshlrev_b32 v4, 4, v1
v_add_u32 v8, 16777216, v4
v_add_u32 v9, 4096, v8
v_add_u32 v10, 33554432, v4
v_add_u32 v11, 4096, v10
v_add_u32 v12, 50331648, v4
v_add_u32 v13, 4096, v12
v_and_b32 v4, 7, v1
v_lshlrev_b32 v4, 4, v4
v_lshl_add_u32 v14, v3, 7, v4
v_add_u32 v14, 100663296, v14
v_and_b32 v4, 31, v1
v_lshlrev_b32 v15, 3, v4
v_add_u32 v15, 104857600, v15
v_lshrrev_b32 v4, 2, v2
v_lshrrev_b32 v5, 1, v4
v_xor_b32 v4, v4, v5
v_and_b32 v4, 1, v4
v_lshl_add_u32 v5, v4, 1, v5
v_and_b32 v4, 1, v3
v_lshlrev_b32 v4, 1, v4
v_lshrrev_b32 v6, 1, v3
v_add_u32 v4, v4, v6
v_xor_b32 v4, v4, v5
v_lshlrev_b32 v4, 4, v4
v_lshl_add_u32 v16, v2, 6, v4
v_add_u32 v16, 83886080, v16
s_add_u32 s28, s30, 0
s_add_u32 s29, s31, 0
s_lshl_b32 s21, s28, 18
s_lshl_b32 s22, s29, 13
s_add_u32 s21, s21, s22
s_add_u32 s4, s40, s21
s_addc_u32 s5, s41, 0
s_lshl_b32 s21, s28, 16
s_lshl_b32 s22, s29, 11
s_add_u32 s21, s21, s22
s_add_u32 s6, s40, s21
s_addc_u32 s7, s41, 0
s_lshl_b32 s21, s29, 19
s_lshl_b32 s22, s28, 11
s_add_u32 s21, s21, s22
s_add_u32 s8, s40, s21
s_addc_u32 s9, s41, 0
global_load_dwordx4 a[0:3], v8, s[4:5] offset:0 sc1
global_load_dwordx4 a[32:35], v10, s[4:5] offset:0 sc1
global_load_dwordx4 a[4:7], v8, s[4:5] offset:1024 sc1
global_load_dwordx4 a[36:39], v10, s[4:5] offset:1024 sc1
global_load_dwordx4 a[8:11], v8, s[4:5] offset:2048 sc1
global_load_dwordx4 a[40:43], v10, s[4:5] offset:2048 sc1
global_load_dwordx4 a[12:15], v8, s[4:5] offset:3072 sc1
global_load_dwordx4 a[44:47], v10, s[4:5] offset:3072 sc1
global_load_dwordx4 a[16:19], v9, s[4:5] offset:0 sc1
global_load_dwordx4 a[48:51], v11, s[4:5] offset:0 sc1
global_load_dwordx4 a[20:23], v9, s[4:5] offset:1024 sc1
global_load_dwordx4 a[52:55], v11, s[4:5] offset:1024 sc1
global_load_dwordx4 a[24:27], v9, s[4:5] offset:2048 sc1
global_load_dwordx4 a[56:59], v11, s[4:5] offset:2048 sc1
global_load_dwordx4 a[28:31], v9, s[4:5] offset:3072 sc1
global_load_dwordx4 a[60:63], v11, s[4:5] offset:3072 sc1
global_load_dwordx4 a[64:67], v14, s[6:7] offset:0 sc1
global_load_dwordx4 a[68:71], v14, s[6:7] offset:512 sc1
global_load_dwordx4 a[72:75], v14, s[6:7] offset:1024 sc1
global_load_dwordx4 a[76:79], v14, s[6:7] offset:1536 sc1
global_load_dwordx4 a[80:83], v12, s[4:5] offset:0 sc1
global_load_dwordx2 a[112:113], v15, s[6:7] offset:0 sc1
global_load_dwordx4 a[84:87], v12, s[4:5] offset:1024 sc1
global_load_dwordx2 a[114:115], v15, s[6:7] offset:256 sc1
global_load_dwordx4 a[88:91], v12, s[4:5] offset:2048 sc1
global_load_dwordx2 a[116:117], v15, s[6:7] offset:512 sc1
global_load_dwordx4 a[92:95], v12, s[4:5] offset:3072 sc1
global_load_dwordx2 a[118:119], v15, s[6:7] offset:768 sc1
global_load_dwordx4 a[96:99], v13, s[4:5] offset:0 sc1
global_load_dwordx2 a[120:121], v15, s[6:7] offset:1024 sc1
global_load_dwordx4 a[100:103], v13, s[4:5] offset:1024 sc1
global_load_dwordx2 a[122:123], v15, s[6:7] offset:1280 sc1
global_load_dwordx4 a[104:107], v13, s[4:5] offset:2048 sc1
global_load_dwordx2 a[124:125], v15, s[6:7] offset:1536 sc1
global_load_dwordx4 a[108:111], v13, s[4:5] offset:3072 sc1
global_load_dwordx2 a[126:127], v15, s[6:7] offset:1792 sc1
s_waitcnt vmcnt(0)
v_mfma_f32_16x16x32_bf16 v[20:23], a[32:35], a[0:3], 0
v_mfma_f32_16x16x32_bf16 v[20:23], a[36:39], a[4:7], v[20:23]
v_mfma_f32_16x16x32_bf16 v[20:23], a[40:43], a[8:11], v[20:23]
v_mfma_f32_16x16x32_bf16 v[20:23], a[44:47], a[12:15], v[20:23]
v_mfma_f32_16x16x32_bf16 v[24:27], a[64:67], a[0:3], 0
v_mfma_f32_16x16x32_bf16 v[24:27], a[68:71], a[4:7], v[24:27]
v_mfma_f32_16x16x32_bf16 v[24:27], a[72:75], a[8:11], v[24:27]
v_mfma_f32_16x16x32_bf16 v[24:27], a[76:79], a[12:15], v[24:27]
v_mfma_f32_16x16x32_bf16 v[28:31], a[32:35], a[16:19], 0
v_mfma_f32_16x16x32_bf16 v[28:31], a[36:39], a[20:23], v[28:31]
v_mfma_f32_16x16x32_bf16 v[28:31], a[40:43], a[24:27], v[28:31]
v_mfma_f32_16x16x32_bf16 v[28:31], a[44:47], a[28:31], v[28:31]
v_mfma_f32_16x16x32_bf16 v[32:35], a[48:51], a[16:19], 0
v_mfma_f32_16x16x32_bf16 v[32:35], a[52:55], a[20:23], v[32:35]
v_mfma_f32_16x16x32_bf16 v[32:35], a[56:59], a[24:27], v[32:35]
v_mfma_f32_16x16x32_bf16 v[32:35], a[60:63], a[28:31], v[32:35]
v_mfma_f32_16x16x32_bf16 v[36:39], a[64:67], a[16:19], 0
v_mfma_f32_16x16x32_bf16 v[36:39], a[68:71], a[20:23], v[36:39]
v_mfma_f32_16x16x32_bf16 v[36:39], a[72:75], a[24:27], v[36:39]
v_mfma_f32_16x16x32_bf16 v[36:39], a[76:79], a[28:31], v[36:39]
v_mov_b32 v60, 0xff800000
v_lshlrev_b32 v61, 2, v3
v_add_u32 v62, 0, v61
v_cmp_gt_u32 vcc, v62, v2
s_nop 1
v_cndmask_b32 v20, v20, v60, vcc
v_cndmask_b32 v32, v32, v60, vcc
v_cndmask_b32 v24, v24, v60, s[18:19]
v_cndmask_b32 v36, v36, v60, s[18:19]
v_add_u32 v62, 1, v61
v_cmp_gt_u32 vcc, v62, v2
s_nop 1
v_cndmask_b32 v21, v21, v60, vcc
v_cndmask_b32 v33, v33, v60, vcc
v_cndmask_b32 v25, v25, v60, s[18:19]
v_cndmask_b32 v37, v37, v60, s[18:19]
v_add_u32 v62, 2, v61
v_cmp_gt_u32 vcc, v62, v2
s_nop 1
v_cndmask_b32 v22, v22, v60, vcc
v_cndmask_b32 v34, v34, v60, vcc
v_cndmask_b32 v26, v26, v60, s[18:19]
v_cndmask_b32 v38, v38, v60, s[18:19]
v_add_u32 v62, 3, v61
v_cmp_gt_u32 vcc, v62, v2
s_nop 1
v_cndmask_b32 v23, v23, v60, vcc
v_cndmask_b32 v35, v35, v60, vcc
v_cndmask_b32 v27, v27, v60, s[18:19]
v_cndmask_b32 v39, v39, v60, s[18:19]
v_max3_f32 v63, v20, v21, v22
v_max3_f32 v63, v63, v23, v24
v_max3_f32 v63, v63, v25, v26
v_max_f32 v63, v63, v27
v_mov_b32 v64, v63
s_nop 1
v_permlane16_swap_b32 v63, v64
v_max_f32 v63, v63, v64
v_mov_b32 v64, v63
s_nop 1
v_permlane32_swap_b32 v63, v64
v_max_f32 v63, v63, v64
v_mul_f32 v63, s16, v63
v_fma_f32 v20, v20, s16, -v63
v_fma_f32 v21, v21, s16, -v63
v_fma_f32 v22, v22, s16, -v63
v_fma_f32 v23, v23, s16, -v63
v_fma_f32 v24, v24, s16, -v63
v_fma_f32 v25, v25, s16, -v63
v_fma_f32 v26, v26, s16, -v63
v_fma_f32 v27, v27, s16, -v63
v_exp_f32 v20, v20
v_exp_f32 v21, v21
v_exp_f32 v22, v22
v_exp_f32 v23, v23
v_exp_f32 v24, v24
v_exp_f32 v25, v25
v_exp_f32 v26, v26
v_exp_f32 v27, v27
v_add_f32 v65, v20, v21
v_add_f32 v65, v65, v22
v_add_f32 v65, v65, v23
v_add_f32 v65, v65, v24
v_add_f32 v65, v65, v25
v_add_f32 v65, v65, v26
v_add_f32 v65, v65, v27
v_mov_b32 v64, v65
s_nop 1
v_permlane16_swap_b32 v65, v64
v_add_f32 v65, v65, v64
v_mov_b32 v64, v65
s_nop 1
v_permlane32_swap_b32 v65, v64
v_add_f32 v65, v65, v64
v_rcp_f32 v65, v65
s_nop 0
v_mul_f32 v20, v20, v65
v_mul_f32 v21, v21, v65
v_mul_f32 v22, v22, v65
v_mul_f32 v23, v23, v65
v_mul_f32 v24, v24, v65
v_mul_f32 v25, v25, v65
v_mul_f32 v26, v26, v65
v_mul_f32 v27, v27, v65
v_cvt_pk_bf16_f32 v40, v20, v21
v_cvt_pk_bf16_f32 v41, v22, v23
v_mov_b32 v42, 0
v_mov_b32 v43, 0
v_cvt_pk_bf16_f32 v44, v24, v25
v_cvt_pk_bf16_f32 v45, v26, v27
v_max3_f32 v63, v28, v29, v30
v_max3_f32 v63, v63, v31, v32
v_max3_f32 v63, v63, v33, v34
v_max3_f32 v63, v63, v35, v36
v_max3_f32 v63, v63, v37, v38
v_max_f32 v63, v63, v39
v_mov_b32 v64, v63
s_nop 1
v_permlane16_swap_b32 v63, v64
v_max_f32 v63, v63, v64
v_mov_b32 v64, v63
s_nop 1
v_permlane32_swap_b32 v63, v64
v_max_f32 v63, v63, v64
v_mul_f32 v63, s16, v63
v_fma_f32 v28, v28, s16, -v63
v_fma_f32 v29, v29, s16, -v63
v_fma_f32 v30, v30, s16, -v63
v_fma_f32 v31, v31, s16, -v63
v_fma_f32 v32, v32, s16, -v63
v_fma_f32 v33, v33, s16, -v63
v_fma_f32 v34, v34, s16, -v63
v_fma_f32 v35, v35, s16, -v63
v_fma_f32 v36, v36, s16, -v63
v_fma_f32 v37, v37, s16, -v63
v_fma_f32 v38, v38, s16, -v63
v_fma_f32 v39, v39, s16, -v63
v_exp_f32 v28, v28
v_exp_f32 v29, v29
v_exp_f32 v30, v30
v_exp_f32 v31, v31
v_exp_f32 v32, v32
v_exp_f32 v33, v33
v_exp_f32 v34, v34
v_exp_f32 v35, v35
v_exp_f32 v36, v36
v_exp_f32 v37, v37
v_exp_f32 v38, v38
v_exp_f32 v39, v39
v_add_f32 v66, v28, v29
v_add_f32 v66, v66, v30
v_add_f32 v66, v66, v31
v_add_f32 v66, v66, v32
v_add_f32 v66, v66, v33
v_add_f32 v66, v66, v34
v_add_f32 v66, v66, v35
v_add_f32 v66, v66, v36
v_add_f32 v66, v66, v37
v_add_f32 v66, v66, v38
v_add_f32 v66, v66, v39
v_mov_b32 v64, v66
s_nop 1
v_permlane16_swap_b32 v66, v64
v_add_f32 v66, v66, v64
v_mov_b32 v64, v66
s_nop 1
v_permlane32_swap_b32 v66, v64
v_add_f32 v66, v66, v64
v_rcp_f32 v66, v66
s_nop 0
v_mul_f32 v28, v28, v66
v_mul_f32 v29, v29, v66
v_mul_f32 v30, v30, v66
v_mul_f32 v31, v31, v66
v_mul_f32 v32, v32, v66
v_mul_f32 v33, v33, v66
v_mul_f32 v34, v34, v66
v_mul_f32 v35, v35, v66
v_mul_f32 v36, v36, v66
v_mul_f32 v37, v37, v66
v_mul_f32 v38, v38, v66
v_mul_f32 v39, v39, v66
v_cvt_pk_bf16_f32 v46, v28, v29
v_cvt_pk_bf16_f32 v47, v30, v31
v_cvt_pk_bf16_f32 v48, v32, v33
v_cvt_pk_bf16_f32 v49, v34, v35
v_cvt_pk_bf16_f32 v50, v36, v37
v_cvt_pk_bf16_f32 v51, v38, v39
v_mfma_f32_16x16x16_bf16 v[52:55], a[112:113], v[44:45], 0
v_mfma_f32_16x16x16_bf16 v[56:59], a[114:115], v[44:45], 0
s_nop 4
v_mfma_f32_16x16x32_bf16 v[52:55], a[80:83], v[40:43], v[52:55]
v_mfma_f32_16x16x32_bf16 v[56:59], a[84:87], v[40:43], v[56:59]
s_nop 6
v_cvt_pk_bf16_f32 v68, v52, v53
v_cvt_pk_bf16_f32 v69, v54, v55
v_cvt_pk_bf16_f32 v70, v56, v57
v_cvt_pk_bf16_f32 v71, v58, v59
s_nop 0
v_permlane16_swap_b32 v68, v70
v_permlane16_swap_b32 v69, v71
v_add_u32 v4, 0, v16
global_store_dwordx4 v4, v[68:71], s[8:9] sc1
v_mfma_f32_16x16x16_bf16 v[52:55], a[116:117], v[44:45], 0
v_mfma_f32_16x16x16_bf16 v[56:59], a[118:119], v[44:45], 0
s_nop 4
v_mfma_f32_16x16x32_bf16 v[52:55], a[88:91], v[40:43], v[52:55]
v_mfma_f32_16x16x32_bf16 v[56:59], a[92:95], v[40:43], v[56:59]
s_nop 6
v_cvt_pk_bf16_f32 v72, v52, v53
v_cvt_pk_bf16_f32 v73, v54, v55
v_cvt_pk_bf16_f32 v74, v56, v57
v_cvt_pk_bf16_f32 v75, v58, v59
s_nop 0
v_permlane16_swap_b32 v72, v74
v_permlane16_swap_b32 v73, v75
v_add_u32 v4, 131072, v16
global_store_dwordx4 v4, v[72:75], s[8:9] sc1
v_mfma_f32_16x16x16_bf16 v[52:55], a[120:121], v[44:45], 0
v_mfma_f32_16x16x16_bf16 v[56:59], a[122:123], v[44:45], 0
s_nop 4
v_mfma_f32_16x16x32_bf16 v[52:55], a[96:99], v[40:43], v[52:55]
v_mfma_f32_16x16x32_bf16 v[56:59], a[100:103], v[40:43], v[56:59]
s_nop 6
v_cvt_pk_bf16_f32 v68, v52, v53
v_cvt_pk_bf16_f32 v69, v54, v55
v_cvt_pk_bf16_f32 v70, v56, v57
v_cvt_pk_bf16_f32 v71, v58, v59
s_nop 0
v_permlane16_swap_b32 v68, v70
v_permlane16_swap_b32 v69, v71
v_add_u32 v4, 262144, v16
global_store_dwordx4 v4, v[68:71], s[8:9] sc1
v_mfma_f32_16x16x16_bf16 v[52:55], a[124:125], v[44:45], 0
v_mfma_f32_16x16x16_bf16 v[56:59], a[126:127], v[44:45], 0
s_nop 4
v_mfma_f32_16x16x32_bf16 v[52:55], a[104:107], v[40:43], v[52:55]
v_mfma_f32_16x16x32_bf16 v[56:59], a[108:111], v[40:43], v[56:59]
s_nop 6
v_cvt_pk_bf16_f32 v72, v52, v53
v_cvt_pk_bf16_f32 v73, v54, v55
v_cvt_pk_bf16_f32 v74, v56, v57
v_cvt_pk_bf16_f32 v75, v58, v59
s_nop 0
v_permlane16_swap_b32 v72, v74
v_permlane16_swap_b32 v73, v75
v_add_u32 v4, 393216, v16
global_store_dwordx4 v4, v[72:75], s[8:9] sc1
v_mfma_f32_16x16x16_bf16 v[52:55], a[112:113], v[50:51], 0
v_mfma_f32_16x16x16_bf16 v[56:59], a[114:115], v[50:51], 0
s_nop 4
v_mfma_f32_16x16x32_bf16 v[52:55], a[80:83], v[46:49], v[52:55]
v_mfma_f32_16x16x32_bf16 v[56:59], a[84:87], v[46:49], v[56:59]
s_nop 6
v_cvt_pk_bf16_f32 v68, v52, v53
v_cvt_pk_bf16_f32 v69, v54, v55
v_cvt_pk_bf16_f32 v70, v56, v57
v_cvt_pk_bf16_f32 v71, v58, v59
s_nop 0
v_permlane16_swap_b32 v68, v70
v_permlane16_swap_b32 v69, v71
v_add_u32 v4, 1024, v16
global_store_dwordx4 v4, v[68:71], s[8:9] sc1
v_mfma_f32_16x16x16_bf16 v[52:55], a[116:117], v[50:51], 0
v_mfma_f32_16x16x16_bf16 v[56:59], a[118:119], v[50:51], 0
s_nop 4
v_mfma_f32_16x16x32_bf16 v[52:55], a[88:91], v[46:49], v[52:55]
v_mfma_f32_16x16x32_bf16 v[56:59], a[92:95], v[46:49], v[56:59]
s_nop 6
v_cvt_pk_bf16_f32 v72, v52, v53
v_cvt_pk_bf16_f32 v73, v54, v55
v_cvt_pk_bf16_f32 v74, v56, v57
v_cvt_pk_bf16_f32 v75, v58, v59
s_nop 0
v_permlane16_swap_b32 v72, v74
v_permlane16_swap_b32 v73, v75
v_add_u32 v4, 132096, v16
global_store_dwordx4 v4, v[72:75], s[8:9] sc1
v_mfma_f32_16x16x16_bf16 v[52:55], a[120:121], v[50:51], 0
v_mfma_f32_16x16x16_bf16 v[56:59], a[122:123], v[50:51], 0
s_nop 4
v_mfma_f32_16x16x32_bf16 v[52:55], a[96:99], v[46:49], v[52:55]
v_mfma_f32_16x16x32_bf16 v[56:59], a[100:103], v[46:49], v[56:59]
s_nop 6
v_cvt_pk_bf16_f32 v68, v52, v53
v_cvt_pk_bf16_f32 v69, v54, v55
v_cvt_pk_bf16_f32 v70, v56, v57
v_cvt_pk_bf16_f32 v71, v58, v59
s_nop 0
v_permlane16_swap_b32 v68, v70
v_permlane16_swap_b32 v69, v71
v_add_u32 v4, 263168, v16
global_store_dwordx4 v4, v[68:71], s[8:9] sc1
v_mfma_f32_16x16x16_bf16 v[52:55], a[124:125], v[50:51], 0
v_mfma_f32_16x16x16_bf16 v[56:59], a[126:127], v[50:51], 0
s_nop 4
v_mfma_f32_16x16x32_bf16 v[52:55], a[104:107], v[46:49], v[52:55]
v_mfma_f32_16x16x32_bf16 v[56:59], a[108:111], v[46:49], v[56:59]
s_nop 6
v_cvt_pk_bf16_f32 v72, v52, v53
v_cvt_pk_bf16_f32 v73, v54, v55
v_cvt_pk_bf16_f32 v74, v56, v57
v_cvt_pk_bf16_f32 v75, v58, v59
s_nop 0
v_permlane16_swap_b32 v72, v74
v_permlane16_swap_b32 v73, v75
v_add_u32 v4, 394240, v16
global_store_dwordx4 v4, v[72:75], s[8:9] sc1
s_lshl_b32 s66, s61, 4
s_lshl_b32 s67, s58, 2
s_add_u32 s66, s66, s67
s_waitcnt vmcnt(0)
s_barrier
v_mov_b32 v44, 163824
s_cmp_lg_u32 s20, 0
s_cbranch_scc1 M_sw_128
s_add_u32 s64, s66, 176160768
v_mov_b32 v42, s64
v_mov_b32 v43, 1
s_mov_b64 exec, 1
global_atomic_add v42, v43, s[40:41]
s_mov_b64 exec, -1
M_sw_128:
s_branch W_loop
W_op:
s_lshr_b32 s63, s61, 1
s_cmp_lg_u32 s20, 0
s_cbranch_scc1 M_wcd_130
s_lshl_b32 s64, s63, 2
s_add_u32 s64, s64, 192
v_mov_b32 v42, s64
s_mov_b32 s65, 0
s_mov_b64 exec, 1
M_wc_129:
global_load_dword v43, v42, s[56:57] sc1
s_waitcnt vmcnt(0)
v_readfirstlane_b32 s64, v43
s_cmp_ge_u32 s64, 8
s_cbranch_scc1 M_wcd_130_x
s_sleep 32
s_add_u32 s65, s65, 1
s_cmp_lt_u32 s65, 400000
s_cbranch_scc1 M_wc_129
s_mov_b64 exec, -1
s_branch M_exit0
M_wcd_130_x:
s_mov_b64 exec, -1
M_wcd_130:
s_barrier
s_lshl_b32 s66, s61, 5
s_cmp_eq_u32 s92, 1
s_cbranch_scc1 M_cs_131
s_cmp_lg_u32 s20, 0
s_cbranch_scc1 M_wcd_133
s_lshl_b32 s64, s58, 2
s_add_u32 s64, s64, 224
v_mov_b32 v42, s64
s_mov_b32 s65, 0
s_mov_b64 exec, 1
M_wc_132:
global_load_dword v43, v42, s[56:57] sc1
s_waitcnt vmcnt(0)
v_readfirstlane_b32 s64, v43
s_cmp_ge_u32 s64, 32
s_cbranch_scc1 M_wcd_133_x
s_sleep 32
s_add_u32 s65, s65, 1
s_cmp_lt_u32 s65, 400000
s_cbranch_scc1 M_wc_132
s_mov_b64 exec, -1
s_branch M_exit0
M_wcd_133_x:
s_mov_b64 exec, -1
M_wcd_133:
s_barrier
s_mov_b32 s92, 1
M_cs_131:
s_cmp_lg_u32 s20, 0
s_cbranch_scc1 M_w8d_135
s_add_u32 s64, s66, 176160768
v_lshlrev_b32 v42, 2, v1
v_add_u32 v42, s64, v42
s_mov_b32 s65, 0
s_mov_b64 exec, 0xff
M_w8_134:
global_load_dword v43, v42, s[40:41] sc1
s_waitcnt vmcnt(0)
v_cmp_gt_u32 vcc, 4, v43
s_cbranch_vccz M_w8d_135_x
s_sleep 24
s_add_u32 s65, s65, 1
s_cmp_lt_u32 s65, 400000
s_cbranch_scc1 M_w8_134
s_mov_b64 exec, -1
s_branch M_exit0
M_w8d_135_x:
s_mov_b64 exec, -1
M_w8d_135:
s_barrier
s_lshl_b32 s64, s61, 13
s_add_u32 s64, s64, 83886080
s_add_u32 s4, s40, s64
s_addc_u32 s5, s41, 0
s_lshl_b32 s64, s58, 9
s_add_u32 s6, s70, s64
s_addc_u32 s7, s71, 0
s_mov_b32 s8, 131072
s_mov_b32 s31, 2048
s_mov_b32 s9, 65536
s_mov_b32 s10, 128
s_mul_i32 s21, s20, 2048
v_lshlrev_b32 v42, 4, v1
v_add_u32 v2, s21, v42
v_add_u32 v3, 1024, v2
v_lshrrev_b32 v42, 5, v1
s_lshl_b32 s21, s20, 3
v_add_u32 v43, s21, v42
v_mul_lo_u32 v43, v43, s31
v_and_b32 v44, 31, v1
s_and_b32 s21, s20, 1
s_lshl_b32 s21, s21, 3
v_lshl_add_u32 v42, v42, 1, s21
v_xor_b32 v45, v44, v42
v_xor_b32 v46, 4, v45
v_lshl_add_u32 v45, v45, 4, v43
v_lshl_add_u32 v46, v46, 4, v43
s_lshl_b32 s22, s31, 1
s_mov_b32 s21, 0
v_add_u32 v6, s21, v45
s_add_u32 s21, s21, s22
v_add_u32 v7, s21, v46
s_add_u32 s21, s21, s22
v_add_u32 v8, s21, v45
s_add_u32 s21, s21, s22
v_add_u32 v9, s21, v46
s_mul_i32 s29, s20, 2048
s_add_u32 m0, s29, 0
s_nop 0
global_load_lds_dwordx4 v2, s[4:5] sc1
s_add_u32 m0, s29, 1024
s_nop 0
global_load_lds_dwordx4 v3, s[4:5] sc1
s_add_u32 m0, s26, 0
s_nop 0
global_load_lds_dwordx4 v6, s[6:7]
s_add_u32 m0, s26, 1024
s_nop 0
global_load_lds_dwordx4 v7, s[6:7]
s_add_u32 m0, s26, 2048
s_nop 0
global_load_lds_dwordx4 v8, s[6:7]
s_add_u32 m0, s26, 3072
s_nop 0
global_load_lds_dwordx4 v9, s[6:7]
s_add_u32 s4, s4, s8
s_addc_u32 s5, s5, 0
s_add_u32 s6, s6, s9
s_addc_u32 s7, s7, 0
s_add_u32 m0, s29, 32768
s_nop 0
global_load_lds_dwordx4 v2, s[4:5] sc1
s_add_u32 m0, s29, 33792
s_nop 0
global_load_lds_dwordx4 v3, s[4:5] sc1
s_add_u32 m0, s26, 32768
s_nop 0
global_load_lds_dwordx4 v6, s[6:7]
s_add_u32 m0, s26, 33792
s_nop 0
global_load_lds_dwordx4 v7, s[6:7]
s_add_u32 m0, s26, 34816
s_nop 0
global_load_lds_dwordx4 v8, s[6:7]
s_add_u32 m0, s26, 35840
s_nop 0
global_load_lds_dwordx4 v9, s[6:7]
s_add_u32 s4, s4, s8
s_addc_u32 s5, s5, 0
s_add_u32 s6, s6, s9
s_addc_u32 s7, s7, 0
s_add_u32 m0, s29, 65536
s_nop 0
global_load_lds_dwordx4 v2, s[4:5] sc1
s_add_u32 m0, s29, 66560
s_nop 0
global_load_lds_dwordx4 v3, s[4:5] sc1
s_add_u32 m0, s26, 65536
s_nop 0
global_load_lds_dwordx4 v6, s[6:7]
s_add_u32 m0, s26, 66560
s_nop 0
global_load_lds_dwordx4 v7, s[6:7]
s_add_u32 m0, s26, 67584
s_nop 0
global_load_lds_dwordx4 v8, s[6:7]
s_add_u32 m0, s26, 68608
s_nop 0
global_load_lds_dwordx4 v9, s[6:7]
s_add_u32 s4, s4, s8
s_addc_u32 s5, s5, 0
s_add_u32 s6, s6, s9
s_addc_u32 s7, s7, 0
s_add_u32 m0, s29, 98304
s_nop 0
global_load_lds_dwordx4 v2, s[4:5] sc1
s_add_u32 m0, s29, 99328
s_nop 0
global_load_lds_dwordx4 v3, s[4:5] sc1
s_add_u32 m0, s26, 98304
s_nop 0
global_load_lds_dwordx4 v6, s[6:7]
s_add_u32 m0, s26, 99328
s_nop 0
global_load_lds_dwordx4 v7, s[6:7]
s_add_u32 m0, s26, 100352
s_nop 0
global_load_lds_dwordx4 v8, s[6:7]
s_add_u32 m0, s26, 101376
s_nop 0
global_load_lds_dwordx4 v9, s[6:7]
s_add_u32 s4, s4, s8
s_addc_u32 s5, s5, 0
s_add_u32 s6, s6, s9
s_addc_u32 s7, s7, 0
s_lshr_b32 s21, s20, 1
s_mul_i32 s21, s21, 4096
v_and_b32 v42, 15, v1
v_lshlrev_b32 v43, 6, v42
v_add_u32 v43, s21, v43
v_lshrrev_b32 v42, 2, v42
v_lshrrev_b32 v44, 1, v42
v_xor_b32 v45, v42, v44
v_and_b32 v45, 1, v45
v_lshl_add_u32 v44, v45, 1, v44
v_lshrrev_b32 v45, 4, v1
v_xor_b32 v44, v44, v45
v_lshl_add_u32 v10, v44, 4, v43
v_add_u32 v11, 0x10000, v10
s_and_b32 s21, s20, 1
v_and_b32 v42, 15, v1
v_lshrrev_b32 v43, 2, v42
v_lshrrev_b32 v44, 4, v1
v_lshl_add_u32 v45, v44, 3, v43
v_lshlrev_b32 v45, 9, v45
v_and_b32 v46, 1, v42
v_lshl_add_u32 v45, v46, 3, v45
v_bfe_u32 v46, v42, 1, 1
v_lshl_add_u32 v45, v46, 4, v45
v_add_u32 v45, 16384, v45
v_and_b32 v44, 1, v44
v_lshl_add_u32 v43, v44, 2, v43
s_mul_i32 s22, s21, 8
s_add_u32 s23, s22, 0
s_and_b32 s24, s23, 7
s_and_b32 s23, s23, 8
v_xor_b32 v46, s24, v43
v_add_u32 v46, s23, v46
v_lshl_add_u32 v26, v46, 5, v45
v_add_u32 v34, 0x10000, v26
s_add_u32 s23, s22, 1
s_and_b32 s24, s23, 7
s_and_b32 s23, s23, 8
v_xor_b32 v46, s24, v43
v_add_u32 v46, s23, v46
v_lshl_add_u32 v27, v46, 5, v45
v_add_u32 v35, 0x10000, v27
s_add_u32 s23, s22, 2
s_and_b32 s24, s23, 7
s_and_b32 s23, s23, 8
v_xor_b32 v46, s24, v43
v_add_u32 v46, s23, v46
v_lshl_add_u32 v28, v46, 5, v45
v_add_u32 v36, 0x10000, v28
s_add_u32 s23, s22, 3
s_and_b32 s24, s23, 7
s_and_b32 s23, s23, 8
v_xor_b32 v46, s24, v43
v_add_u32 v46, s23, v46
v_lshl_add_u32 v29, v46, 5, v45
v_add_u32 v37, 0x10000, v29
s_add_u32 s23, s22, 4
s_and_b32 s24, s23, 7
s_and_b32 s23, s23, 8
v_xor_b32 v46, s24, v43
v_add_u32 v46, s23, v46
v_lshl_add_u32 v30, v46, 5, v45
v_add_u32 v38, 0x10000, v30
s_add_u32 s23, s22, 5
s_and_b32 s24, s23, 7
s_and_b32 s23, s23, 8
v_xor_b32 v46, s24, v43
v_add_u32 v46, s23, v46
v_lshl_add_u32 v31, v46, 5, v45
v_add_u32 v39, 0x10000, v31
s_add_u32 s23, s22, 6
s_and_b32 s24, s23, 7
s_and_b32 s23, s23, 8
v_xor_b32 v46, s24, v43
v_add_u32 v46, s23, v46
v_lshl_add_u32 v32, v46, 5, v45
v_add_u32 v40, 0x10000, v32
s_add_u32 s23, s22, 7
s_and_b32 s24, s23, 7
s_and_b32 s23, s23, 8
v_xor_b32 v46, s24, v43
v_add_u32 v46, s23, v46
v_lshl_add_u32 v33, v46, 5, v45
v_add_u32 v41, 0x10000, v33
s_waitcnt vmcnt(0)
s_barrier
ds_read_b64_tr_b16 v[160:161], v26 offset:0
ds_read_b64_tr_b16 v[162:163], v26 offset:2048
ds_read_b128 v[128:131], v10 offset:0
ds_read_b128 v[132:135], v10 offset:1024
ds_read_b128 v[136:139], v10 offset:2048
ds_read_b128 v[140:143], v10 offset:3072
ds_read_b64_tr_b16 v[164:165], v27 offset:0
ds_read_b64_tr_b16 v[166:167], v27 offset:2048
ds_read_b64_tr_b16 v[168:169], v28 offset:0
ds_read_b64_tr_b16 v[170:171], v28 offset:2048
ds_read_b64_tr_b16 v[172:173], v29 offset:0
ds_read_b64_tr_b16 v[174:175], v29 offset:2048
ds_read_b64_tr_b16 v[176:177], v30 offset:0
ds_read_b64_tr_b16 v[178:179], v30 offset:2048
ds_read_b64_tr_b16 v[180:181], v31 offset:0
ds_read_b64_tr_b16 v[182:183], v31 offset:2048
ds_read_b64_tr_b16 v[184:185], v32 offset:0
ds_read_b64_tr_b16 v[186:187], v32 offset:2048
ds_read_b64_tr_b16 v[188:189], v33 offset:0
ds_read_b64_tr_b16 v[190:191], v33 offset:2048
s_lshr_b32 s11, s10, 2
s_sub_u32 s11, s11, 1
s_waitcnt lgkmcnt(0)
v_mfma_f32_16x16x32_bf16 a[0:3], v[160:163], v[128:131], 0
v_mfma_f32_16x16x32_bf16 a[4:7], v[160:163], v[132:135], 0
v_mfma_f32_16x16x32_bf16 a[8:11], v[160:163], v[136:139], 0
v_mfma_f32_16x16x32_bf16 a[12:15], v[160:163], v[140:143], 0
v_mfma_f32_16x16x32_bf16 a[16:19], v[164:167], v[128:131], 0
v_mfma_f32_16x16x32_bf16 a[20:23], v[164:167], v[132:135], 0
v_mfma_f32_16x16x32_bf16 a[24:27], v[164:167], v[136:139], 0
v_mfma_f32_16x16x32_bf16 a[28:31], v[164:167], v[140:143], 0
v_mfma_f32_16x16x32_bf16 a[32:35], v[168:171], v[128:131], 0
v_mfma_f32_16x16x32_bf16 a[36:39], v[168:171], v[132:135], 0
v_mfma_f32_16x16x32_bf16 a[40:43], v[168:171], v[136:139], 0
v_mfma_f32_16x16x32_bf16 a[44:47], v[168:171], v[140:143], 0
v_mfma_f32_16x16x32_bf16 a[48:51], v[172:175], v[128:131], 0
v_mfma_f32_16x16x32_bf16 a[52:55], v[172:175], v[132:135], 0
v_mfma_f32_16x16x32_bf16 a[56:59], v[172:175], v[136:139], 0
v_mfma_f32_16x16x32_bf16 a[60:63], v[172:175], v[140:143], 0
s_barrier
v_mfma_f32_16x16x32_bf16 a[64:67], v[176:179], v[128:131], 0
ds_read_b64_tr_b16 v[224:225], v26 offset:32768
ds_read_b64_tr_b16 v[226:227], v26 offset:34816
v_mfma_f32_16x16x32_bf16 a[68:71], v[176:179], v[132:135], 0
s_add_u32 m0, s29, 0
ds_read_b128 v[192:195], v10 offset:32768
ds_read_b128 v[196:199], v10 offset:33792
v_mfma_f32_16x16x32_bf16 a[72:75], v[176:179], v[136:139], 0
global_load_lds_dwordx4 v2, s[4:5] sc1
ds_read_b128 v[200:203], v10 offset:34816
ds_read_b128 v[204:207], v10 offset:35840
v_mfma_f32_16x16x32_bf16 a[76:79], v[176:179], v[140:143], 0
ds_read_b64_tr_b16 v[228:229], v27 offset:32768
ds_read_b64_tr_b16 v[230:231], v27 offset:34816
v_mfma_f32_16x16x32_bf16 a[80:83], v[180:183], v[128:131], 0
ds_read_b64_tr_b16 v[232:233], v28 offset:32768
ds_read_b64_tr_b16 v[234:235], v28 offset:34816
v_mfma_f32_16x16x32_bf16 a[84:87], v[180:183], v[132:135], 0
ds_read_b64_tr_b16 v[236:237], v29 offset:32768
ds_read_b64_tr_b16 v[238:239], v29 offset:34816
v_mfma_f32_16x16x32_bf16 a[88:91], v[180:183], v[136:139], 0
ds_read_b64_tr_b16 v[240:241], v30 offset:32768
ds_read_b64_tr_b16 v[242:243], v30 offset:34816
v_mfma_f32_16x16x32_bf16 a[92:95], v[180:183], v[140:143], 0
ds_read_b64_tr_b16 v[244:245], v31 offset:32768
ds_read_b64_tr_b16 v[246:247], v31 offset:34816
v_mfma_f32_16x16x32_bf16 a[96:99], v[184:187], v[128:131], 0
ds_read_b64_tr_b16 v[248:249], v32 offset:32768
ds_read_b64_tr_b16 v[250:251], v32 offset:34816
v_mfma_f32_16x16x32_bf16 a[100:103], v[184:187], v[132:135], 0
s_add_u32 m0, s29, 1024
ds_read_b64_tr_b16 v[252:253], v33 offset:32768
ds_read_b64_tr_b16 v[254:255], v33 offset:34816
v_mfma_f32_16x16x32_bf16 a[104:107], v[184:187], v[136:139], 0
global_load_lds_dwordx4 v3, s[4:5] sc1
v_mfma_f32_16x16x32_bf16 a[108:111], v[184:187], v[140:143], 0
v_mfma_f32_16x16x32_bf16 a[112:115], v[188:191], v[128:131], 0
v_mfma_f32_16x16x32_bf16 a[116:119], v[188:191], v[132:135], 0
v_mfma_f32_16x16x32_bf16 a[120:123], v[188:191], v[136:139], 0
v_mfma_f32_16x16x32_bf16 a[124:127], v[188:191], v[140:143], 0
s_add_u32 s4, s4, s8
s_addc_u32 s5, s5, 0
M_gl_136:
s_waitcnt lgkmcnt(0)
v_mfma_f32_16x16x32_bf16 a[0:3], v[224:227], v[192:195], a[0:3]
v_mfma_f32_16x16x32_bf16 a[4:7], v[224:227], v[196:199], a[4:7]
s_add_u32 m0, s26, 0
v_mfma_f32_16x16x32_bf16 a[8:11], v[224:227], v[200:203], a[8:11]
global_load_lds_dwordx4 v6, s[6:7]
v_mfma_f32_16x16x32_bf16 a[12:15], v[224:227], v[204:207], a[12:15]
v_mfma_f32_16x16x32_bf16 a[16:19], v[228:231], v[192:195], a[16:19]
v_mfma_f32_16x16x32_bf16 a[20:23], v[228:231], v[196:199], a[20:23]
s_add_u32 m0, s26, 1024
v_mfma_f32_16x16x32_bf16 a[24:27], v[228:231], v[200:203], a[24:27]
global_load_lds_dwordx4 v7, s[6:7]
v_mfma_f32_16x16x32_bf16 a[28:31], v[228:231], v[204:207], a[28:31]
v_mfma_f32_16x16x32_bf16 a[32:35], v[232:235], v[192:195], a[32:35]
v_mfma_f32_16x16x32_bf16 a[36:39], v[232:235], v[196:199], a[36:39]
s_add_u32 m0, s26, 2048
v_mfma_f32_16x16x32_bf16 a[40:43], v[232:235], v[200:203], a[40:43]
global_load_lds_dwordx4 v8, s[6:7]
v_mfma_f32_16x16x32_bf16 a[44:47], v[232:235], v[204:207], a[44:47]
v_mfma_f32_16x16x32_bf16 a[48:51], v[236:239], v[192:195], a[48:51]
v_mfma_f32_16x16x32_bf16 a[52:55], v[236:239], v[196:199], a[52:55]
s_add_u32 m0, s26, 3072
v_mfma_f32_16x16x32_bf16 a[56:59], v[236:239], v[200:203], a[56:59]
global_load_lds_dwordx4 v9, s[6:7]
v_mfma_f32_16x16x32_bf16 a[60:63], v[236:239], v[204:207], a[60:63]
s_add_u32 s6, s6, s9
s_addc_u32 s7, s7, 0
s_waitcnt vmcnt(12)
s_barrier
v_mfma_f32_16x16x32_bf16 a[64:67], v[240:243], v[192:195], a[64:67]
ds_read_b64_tr_b16 v[160:161], v34 offset:0
ds_read_b64_tr_b16 v[162:163], v34 offset:2048
v_mfma_f32_16x16x32_bf16 a[68:71], v[240:243], v[196:199], a[68:71]
s_add_u32 m0, s29, 32768
ds_read_b128 v[128:131], v11 offset:0
ds_read_b128 v[132:135], v11 offset:1024
v_mfma_f32_16x16x32_bf16 a[72:75], v[240:243], v[200:203], a[72:75]
global_load_lds_dwordx4 v2, s[4:5] sc1
ds_read_b128 v[136:139], v11 offset:2048
ds_read_b128 v[140:143], v11 offset:3072
v_mfma_f32_16x16x32_bf16 a[76:79], v[240:243], v[204:207], a[76:79]
ds_read_b64_tr_b16 v[164:165], v35 offset:0
ds_read_b64_tr_b16 v[166:167], v35 offset:2048
v_mfma_f32_16x16x32_bf16 a[80:83], v[244:247], v[192:195], a[80:83]
ds_read_b64_tr_b16 v[168:169], v36 offset:0
ds_read_b64_tr_b16 v[170:171], v36 offset:2048
v_mfma_f32_16x16x32_bf16 a[84:87], v[244:247], v[196:199], a[84:87]
ds_read_b64_tr_b16 v[172:173], v37 offset:0
ds_read_b64_tr_b16 v[174:175], v37 offset:2048
v_mfma_f32_16x16x32_bf16 a[88:91], v[244:247], v[200:203], a[88:91]
ds_read_b64_tr_b16 v[176:177], v38 offset:0
ds_read_b64_tr_b16 v[178:179], v38 offset:2048
v_mfma_f32_16x16x32_bf16 a[92:95], v[244:247], v[204:207], a[92:95]
ds_read_b64_tr_b16 v[180:181], v39 offset:0
ds_read_b64_tr_b16 v[182:183], v39 offset:2048
v_mfma_f32_16x16x32_bf16 a[96:99], v[248:251], v[192:195], a[96:99]
ds_read_b64_tr_b16 v[184:185], v40 offset:0
ds_read_b64_tr_b16 v[186:187], v40 offset:2048
v_mfma_f32_16x16x32_bf16 a[100:103], v[248:251], v[196:199], a[100:103]
s_add_u32 m0, s29, 33792
ds_read_b64_tr_b16 v[188:189], v41 offset:0
ds_read_b64_tr_b16 v[190:191], v41 offset:2048
v_mfma_f32_16x16x32_bf16 a[104:107], v[248:251], v[200:203], a[104:107]
global_load_lds_dwordx4 v3, s[4:5] sc1
v_mfma_f32_16x16x32_bf16 a[108:111], v[248:251], v[204:207], a[108:111]
v_mfma_f32_16x16x32_bf16 a[112:115], v[252:255], v[192:195], a[112:115]
v_mfma_f32_16x16x32_bf16 a[116:119], v[252:255], v[196:199], a[116:119]
v_mfma_f32_16x16x32_bf16 a[120:123], v[252:255], v[200:203], a[120:123]
v_mfma_f32_16x16x32_bf16 a[124:127], v[252:255], v[204:207], a[124:127]
s_add_u32 s4, s4, s8
s_addc_u32 s5, s5, 0
s_waitcnt lgkmcnt(0)
v_mfma_f32_16x16x32_bf16 a[0:3], v[160:163], v[128:131], a[0:3]
v_mfma_f32_16x16x32_bf16 a[4:7], v[160:163], v[132:135], a[4:7]
s_add_u32 m0, s26, 32768
v_mfma_f32_16x16x32_bf16 a[8:11], v[160:163], v[136:139], a[8:11]
global_load_lds_dwordx4 v6, s[6:7]
v_mfma_f32_16x16x32_bf16 a[12:15], v[160:163], v[140:143], a[12:15]
v_mfma_f32_16x16x32_bf16 a[16:19], v[164:167], v[128:131], a[16:19]
v_mfma_f32_16x16x32_bf16 a[20:23], v[164:167], v[132:135], a[20:23]
s_add_u32 m0, s26, 33792
v_mfma_f32_16x16x32_bf16 a[24:27], v[164:167], v[136:139], a[24:27]
global_load_lds_dwordx4 v7, s[6:7]
v_mfma_f32_16x16x32_bf16 a[28:31], v[164:167], v[140:143], a[28:31]
v_mfma_f32_16x16x32_bf16 a[32:35], v[168:171], v[128:131], a[32:35]
v_mfma_f32_16x16x32_bf16 a[36:39], v[168:171], v[132:135], a[36:39]
s_add_u32 m0, s26, 34816
v_mfma_f32_16x16x32_bf16 a[40:43], v[168:171], v[136:139], a[40:43]
global_load_lds_dwordx4 v8, s[6:7]
v_mfma_f32_16x16x32_bf16 a[44:47], v[168:171], v[140:143], a[44:47]
v_mfma_f32_16x16x32_bf16 a[48:51], v[172:175], v[128:131], a[48:51]
v_mfma_f32_16x16x32_bf16 a[52:55], v[172:175], v[132:135], a[52:55]
s_add_u32 m0, s26, 35840
v_mfma_f32_16x16x32_bf16 a[56:59], v[172:175], v[136:139], a[56:59]
global_load_lds_dwordx4 v9, s[6:7]
v_mfma_f32_16x16x32_bf16 a[60:63], v[172:175], v[140:143], a[60:63]
s_add_u32 s6, s6, s9
s_addc_u32 s7, s7, 0
s_waitcnt vmcnt(12)
s_barrier
v_mfma_f32_16x16x32_bf16 a[64:67], v[176:179], v[128:131], a[64:67]
ds_read_b64_tr_b16 v[224:225], v34 offset:32768
ds_read_b64_tr_b16 v[226:227], v34 offset:34816
v_mfma_f32_16x16x32_bf16 a[68:71], v[176:179], v[132:135], a[68:71]
s_add_u32 m0, s29, 65536
ds_read_b128 v[192:195], v11 offset:32768
ds_read_b128 v[196:199], v11 offset:33792
v_mfma_f32_16x16x32_bf16 a[72:75], v[176:179], v[136:139], a[72:75]
global_load_lds_dwordx4 v2, s[4:5] sc1
ds_read_b128 v[200:203], v11 offset:34816
ds_read_b128 v[204:207], v11 offset:35840
v_mfma_f32_16x16x32_bf16 a[76:79], v[176:179], v[140:143], a[76:79]
ds_read_b64_tr_b16 v[228:229], v35 offset:32768
ds_read_b64_tr_b16 v[230:231], v35 offset:34816
v_mfma_f32_16x16x32_bf16 a[80:83], v[180:183], v[128:131], a[80:83]
ds_read_b64_tr_b16 v[232:233], v36 offset:32768
ds_read_b64_tr_b16 v[234:235], v36 offset:34816
v_mfma_f32_16x16x32_bf16 a[84:87], v[180:183], v[132:135], a[84:87]
ds_read_b64_tr_b16 v[236:237], v37 offset:32768
ds_read_b64_tr_b16 v[238:239], v37 offset:34816
v_mfma_f32_16x16x32_bf16 a[88:91], v[180:183], v[136:139], a[88:91]
ds_read_b64_tr_b16 v[240:241], v38 offset:32768
ds_read_b64_tr_b16 v[242:243], v38 offset:34816
v_mfma_f32_16x16x32_bf16 a[92:95], v[180:183], v[140:143], a[92:95]
ds_read_b64_tr_b16 v[244:245], v39 offset:32768
ds_read_b64_tr_b16 v[246:247], v39 offset:34816
v_mfma_f32_16x16x32_bf16 a[96:99], v[184:187], v[128:131], a[96:99]
ds_read_b64_tr_b16 v[248:249], v40 offset:32768
ds_read_b64_tr_b16 v[250:251], v40 offset:34816
v_mfma_f32_16x16x32_bf16 a[100:103], v[184:187], v[132:135], a[100:103]
s_add_u32 m0, s29, 66560
ds_read_b64_tr_b16 v[252:253], v41 offset:32768
ds_read_b64_tr_b16 v[254:255], v41 offset:34816
v_mfma_f32_16x16x32_bf16 a[104:107], v[184:187], v[136:139], a[104:107]
global_load_lds_dwordx4 v3, s[4:5] sc1
v_mfma_f32_16x16x32_bf16 a[108:111], v[184:187], v[140:143], a[108:111]
v_mfma_f32_16x16x32_bf16 a[112:115], v[188:191], v[128:131], a[112:115]
v_mfma_f32_16x16x32_bf16 a[116:119], v[188:191], v[132:135], a[116:119]
v_mfma_f32_16x16x32_bf16 a[120:123], v[188:191], v[136:139], a[120:123]
v_mfma_f32_16x16x32_bf16 a[124:127], v[188:191], v[140:143], a[124:127]
s_add_u32 s4, s4, s8
s_addc_u32 s5, s5, 0
s_waitcnt lgkmcnt(0)
v_mfma_f32_16x16x32_bf16 a[0:3], v[224:227], v[192:195], a[0:3]
v_mfma_f32_16x16x32_bf16 a[4:7], v[224:227], v[196:199], a[4:7]
s_add_u32 m0, s26, 65536
v_mfma_f32_16x16x32_bf16 a[8:11], v[224:227], v[200:203], a[8:11]
global_load_lds_dwordx4 v6, s[6:7]
v_mfma_f32_16x16x32_bf16 a[12:15], v[224:227], v[204:207], a[12:15]
v_mfma_f32_16x16x32_bf16 a[16:19], v[228:231], v[192:195], a[16:19]
v_mfma_f32_16x16x32_bf16 a[20:23], v[228:231], v[196:199], a[20:23]
s_add_u32 m0, s26, 66560
v_mfma_f32_16x16x32_bf16 a[24:27], v[228:231], v[200:203], a[24:27]
global_load_lds_dwordx4 v7, s[6:7]
v_mfma_f32_16x16x32_bf16 a[28:31], v[228:231], v[204:207], a[28:31]
v_mfma_f32_16x16x32_bf16 a[32:35], v[232:235], v[192:195], a[32:35]
v_mfma_f32_16x16x32_bf16 a[36:39], v[232:235], v[196:199], a[36:39]
s_add_u32 m0, s26, 67584
v_mfma_f32_16x16x32_bf16 a[40:43], v[232:235], v[200:203], a[40:43]
global_load_lds_dwordx4 v8, s[6:7]
v_mfma_f32_16x16x32_bf16 a[44:47], v[232:235], v[204:207], a[44:47]
v_mfma_f32_16x16x32_bf16 a[48:51], v[236:239], v[192:195], a[48:51]
v_mfma_f32_16x16x32_bf16 a[52:55], v[236:239], v[196:199], a[52:55]
s_add_u32 m0, s26, 68608
v_mfma_f32_16x16x32_bf16 a[56:59], v[236:239], v[200:203], a[56:59]
global_load_lds_dwordx4 v9, s[6:7]
v_mfma_f32_16x16x32_bf16 a[60:63], v[236:239], v[204:207], a[60:63]
s_add_u32 s6, s6, s9
s_addc_u32 s7, s7, 0
s_waitcnt vmcnt(12)
s_barrier
v_mfma_f32_16x16x32_bf16 a[64:67], v[240:243], v[192:195], a[64:67]
ds_read_b64_tr_b16 v[160:161], v26 offset:0
ds_read_b64_tr_b16 v[162:163], v26 offset:2048
v_mfma_f32_16x16x32_bf16 a[68:71], v[240:243], v[196:199], a[68:71]
s_add_u32 m0, s29, 98304
ds_read_b128 v[128:131], v10 offset:0
ds_read_b128 v[132:135], v10 offset:1024
v_mfma_f32_16x16x32_bf16 a[72:75], v[240:243], v[200:203], a[72:75]
global_load_lds_dwordx4 v2, s[4:5] sc1
ds_read_b128 v[136:139], v10 offset:2048
ds_read_b128 v[140:143], v10 offset:3072
v_mfma_f32_16x16x32_bf16 a[76:79], v[240:243], v[204:207], a[76:79]
ds_read_b64_tr_b16 v[164:165], v27 offset:0
ds_read_b64_tr_b16 v[166:167], v27 offset:2048
v_mfma_f32_16x16x32_bf16 a[80:83], v[244:247], v[192:195], a[80:83]
ds_read_b64_tr_b16 v[168:169], v28 offset:0
ds_read_b64_tr_b16 v[170:171], v28 offset:2048
v_mfma_f32_16x16x32_bf16 a[84:87], v[244:247], v[196:199], a[84:87]
ds_read_b64_tr_b16 v[172:173], v29 offset:0
ds_read_b64_tr_b16 v[174:175], v29 offset:2048
v_mfma_f32_16x16x32_bf16 a[88:91], v[244:247], v[200:203], a[88:91]
ds_read_b64_tr_b16 v[176:177], v30 offset:0
ds_read_b64_tr_b16 v[178:179], v30 offset:2048
v_mfma_f32_16x16x32_bf16 a[92:95], v[244:247], v[204:207], a[92:95]
ds_read_b64_tr_b16 v[180:181], v31 offset:0
ds_read_b64_tr_b16 v[182:183], v31 offset:2048
v_mfma_f32_16x16x32_bf16 a[96:99], v[248:251], v[192:195], a[96:99]
ds_read_b64_tr_b16 v[184:185], v32 offset:0
ds_read_b64_tr_b16 v[186:187], v32 offset:2048
v_mfma_f32_16x16x32_bf16 a[100:103], v[248:251], v[196:199], a[100:103]
s_add_u32 m0, s29, 99328
ds_read_b64_tr_b16 v[188:189], v33 offset:0
ds_read_b64_tr_b16 v[190:191], v33 offset:2048
v_mfma_f32_16x16x32_bf16 a[104:107], v[248:251], v[200:203], a[104:107]
global_load_lds_dwordx4 v3, s[4:5] sc1
v_mfma_f32_16x16x32_bf16 a[108:111], v[248:251], v[204:207], a[108:111]
v_mfma_f32_16x16x32_bf16 a[112:115], v[252:255], v[192:195], a[112:115]
v_mfma_f32_16x16x32_bf16 a[116:119], v[252:255], v[196:199], a[116:119]
v_mfma_f32_16x16x32_bf16 a[120:123], v[252:255], v[200:203], a[120:123]
v_mfma_f32_16x16x32_bf16 a[124:127], v[252:255], v[204:207], a[124:127]
s_add_u32 s4, s4, s8
s_addc_u32 s5, s5, 0
s_sub_u32 s11, s11, 1
s_cmp_eq_u32 s11, 0
s_cbranch_scc1 M_gle_137
s_waitcnt lgkmcnt(0)
v_mfma_f32_16x16x32_bf16 a[0:3], v[160:163], v[128:131], a[0:3]
v_mfma_f32_16x16x32_bf16 a[4:7], v[160:163], v[132:135], a[4:7]
s_add_u32 m0, s26, 98304
v_mfma_f32_16x16x32_bf16 a[8:11], v[160:163], v[136:139], a[8:11]
global_load_lds_dwordx4 v6, s[6:7]
v_mfma_f32_16x16x32_bf16 a[12:15], v[160:163], v[140:143], a[12:15]
v_mfma_f32_16x16x32_bf16 a[16:19], v[164:167], v[128:131], a[16:19]
v_mfma_f32_16x16x32_bf16 a[20:23], v[164:167], v[132:135], a[20:23]
s_add_u32 m0, s26, 99328
v_mfma_f32_16x16x32_bf16 a[24:27], v[164:167], v[136:139], a[24:27]
global_load_lds_dwordx4 v7, s[6:7]
v_mfma_f32_16x16x32_bf16 a[28:31], v[164:167], v[140:143], a[28:31]
v_mfma_f32_16x16x32_bf16 a[32:35], v[168:171], v[128:131], a[32:35]
v_mfma_f32_16x16x32_bf16 a[36:39], v[168:171], v[132:135], a[36:39]
s_add_u32 m0, s26, 100352
v_mfma_f32_16x16x32_bf16 a[40:43], v[168:171], v[136:139], a[40:43]
global_load_lds_dwordx4 v8, s[6:7]
v_mfma_f32_16x16x32_bf16 a[44:47], v[168:171], v[140:143], a[44:47]
v_mfma_f32_16x16x32_bf16 a[48:51], v[172:175], v[128:131], a[48:51]
v_mfma_f32_16x16x32_bf16 a[52:55], v[172:175], v[132:135], a[52:55]
s_add_u32 m0, s26, 101376
v_mfma_f32_16x16x32_bf16 a[56:59], v[172:175], v[136:139], a[56:59]
global_load_lds_dwordx4 v9, s[6:7]
v_mfma_f32_16x16x32_bf16 a[60:63], v[172:175], v[140:143], a[60:63]
s_add_u32 s6, s6, s9
s_addc_u32 s7, s7, 0
s_waitcnt vmcnt(12)
s_barrier
v_mfma_f32_16x16x32_bf16 a[64:67], v[176:179], v[128:131], a[64:67]
ds_read_b64_tr_b16 v[224:225], v26 offset:32768
ds_read_b64_tr_b16 v[226:227], v26 offset:34816
v_mfma_f32_16x16x32_bf16 a[68:71], v[176:179], v[132:135], a[68:71]
s_add_u32 m0, s29, 0
ds_read_b128 v[192:195], v10 offset:32768
ds_read_b128 v[196:199], v10 offset:33792
v_mfma_f32_16x16x32_bf16 a[72:75], v[176:179], v[136:139], a[72:75]
global_load_lds_dwordx4 v2, s[4:5] sc1
ds_read_b128 v[200:203], v10 offset:34816
ds_read_b128 v[204:207], v10 offset:35840
v_mfma_f32_16x16x32_bf16 a[76:79], v[176:179], v[140:143], a[76:79]
ds_read_b64_tr_b16 v[228:229], v27 offset:32768
ds_read_b64_tr_b16 v[230:231], v27 offset:34816
v_mfma_f32_16x16x32_bf16 a[80:83], v[180:183], v[128:131], a[80:83]
ds_read_b64_tr_b16 v[232:233], v28 offset:32768
ds_read_b64_tr_b16 v[234:235], v28 offset:34816
v_mfma_f32_16x16x32_bf16 a[84:87], v[180:183], v[132:135], a[84:87]
ds_read_b64_tr_b16 v[236:237], v29 offset:32768
ds_read_b64_tr_b16 v[238:239], v29 offset:34816
v_mfma_f32_16x16x32_bf16 a[88:91], v[180:183], v[136:139], a[88:91]
ds_read_b64_tr_b16 v[240:241], v30 offset:32768
ds_read_b64_tr_b16 v[242:243], v30 offset:34816
v_mfma_f32_16x16x32_bf16 a[92:95], v[180:183], v[140:143], a[92:95]
ds_read_b64_tr_b16 v[244:245], v31 offset:32768
ds_read_b64_tr_b16 v[246:247], v31 offset:34816
v_mfma_f32_16x16x32_bf16 a[96:99], v[184:187], v[128:131], a[96:99]
ds_read_b64_tr_b16 v[248:249], v32 offset:32768
ds_read_b64_tr_b16 v[250:251], v32 offset:34816
v_mfma_f32_16x16x32_bf16 a[100:103], v[184:187], v[132:135], a[100:103]
s_add_u32 m0, s29, 1024
ds_read_b64_tr_b16 v[252:253], v33 offset:32768
ds_read_b64_tr_b16 v[254:255], v33 offset:34816
v_mfma_f32_16x16x32_bf16 a[104:107], v[184:187], v[136:139], a[104:107]
global_load_lds_dwordx4 v3, s[4:5] sc1
v_mfma_f32_16x16x32_bf16 a[108:111], v[184:187], v[140:143], a[108:111]
v_mfma_f32_16x16x32_bf16 a[112:115], v[188:191], v[128:131], a[112:115]
v_mfma_f32_16x16x32_bf16 a[116:119], v[188:191], v[132:135], a[116:119]
v_mfma_f32_16x16x32_bf16 a[120:123], v[188:191], v[136:139], a[120:123]
v_mfma_f32_16x16x32_bf16 a[124:127], v[188:191], v[140:143], a[124:127]
s_add_u32 s4, s4, s8
s_addc_u32 s5, s5, 0
s_branch M_gl_136
M_gle_137:
s_waitcnt lgkmcnt(0)
v_mfma_f32_16x16x32_bf16 a[0:3], v[160:163], v[128:131], a[0:3]
v_mfma_f32_16x16x32_bf16 a[4:7], v[160:163], v[132:135], a[4:7]
s_add_u32 m0, s26, 98304
v_mfma_f32_16x16x32_bf16 a[8:11], v[160:163], v[136:139], a[8:11]
global_load_lds_dwordx4 v6, s[6:7]
v_mfma_f32_16x16x32_bf16 a[12:15], v[160:163], v[140:143], a[12:15]
v_mfma_f32_16x16x32_bf16 a[16:19], v[164:167], v[128:131], a[16:19]
v_mfma_f32_16x16x32_bf16 a[20:23], v[164:167], v[132:135], a[20:23]
s_add_u32 m0, s26, 99328
v_mfma_f32_16x16x32_bf16 a[24:27], v[164:167], v[136:139], a[24:27]
global_load_lds_dwordx4 v7, s[6:7]
v_mfma_f32_16x16x32_bf16 a[28:31], v[164:167], v[140:143], a[28:31]
v_mfma_f32_16x16x32_bf16 a[32:35], v[168:171], v[128:131], a[32:35]
v_mfma_f32_16x16x32_bf16 a[36:39], v[168:171], v[132:135], a[36:39]
s_add_u32 m0, s26, 100352
v_mfma_f32_16x16x32_bf16 a[40:43], v[168:171], v[136:139], a[40:43]
global_load_lds_dwordx4 v8, s[6:7]
v_mfma_f32_16x16x32_bf16 a[44:47], v[168:171], v[140:143], a[44:47]
v_mfma_f32_16x16x32_bf16 a[48:51], v[172:175], v[128:131], a[48:51]
v_mfma_f32_16x16x32_bf16 a[52:55], v[172:175], v[132:135], a[52:55]
s_add_u32 m0, s26, 101376
v_mfma_f32_16x16x32_bf16 a[56:59], v[172:175], v[136:139], a[56:59]
global_load_lds_dwordx4 v9, s[6:7]
v_mfma_f32_16x16x32_bf16 a[60:63], v[172:175], v[140:143], a[60:63]
s_add_u32 s6, s6, s9
s_addc_u32 s7, s7, 0
s_waitcnt vmcnt(12)
s_barrier
v_mfma_f32_16x16x32_bf16 a[64:67], v[176:179], v[128:131], a[64:67]
ds_read_b64_tr_b16 v[224:225], v26 offset:32768
ds_read_b64_tr_b16 v[226:227], v26 offset:34816
v_mfma_f32_16x16x32_bf16 a[68:71], v[176:179], v[132:135], a[68:71]
ds_read_b128 v[192:195], v10 offset:32768
ds_read_b128 v[196:199], v10 offset:33792
v_mfma_f32_16x16x32_bf16 a[72:75], v[176:179], v[136:139], a[72:75]
ds_read_b128 v[200:203], v10 offset:34816
ds_read_b128 v[204:207], v10 offset:35840
v_mfma_f32_16x16x32_bf16 a[76:79], v[176:179], v[140:143], a[76:79]
ds_read_b64_tr_b16 v[228:229], v27 offset:32768
ds_read_b64_tr_b16 v[230:231], v27 offset:34816
v_mfma_f32_16x16x32_bf16 a[80:83], v[180:183], v[128:131], a[80:83]
ds_read_b64_tr_b16 v[232:233], v28 offset:32768
ds_read_b64_tr_b16 v[234:235], v28 offset:34816
v_mfma_f32_16x16x32_bf16 a[84:87], v[180:183], v[132:135], a[84:87]
ds_read_b64_tr_b16 v[236:237], v29 offset:32768
ds_read_b64_tr_b16 v[238:239], v29 offset:34816
v_mfma_f32_16x16x32_bf16 a[88:91], v[180:183], v[136:139], a[88:91]
ds_read_b64_tr_b16 v[240:241], v30 offset:32768
ds_read_b64_tr_b16 v[242:243], v30 offset:34816
v_mfma_f32_16x16x32_bf16 a[92:95], v[180:183], v[140:143], a[92:95]
ds_read_b64_tr_b16 v[244:245], v31 offset:32768
ds_read_b64_tr_b16 v[246:247], v31 offset:34816
v_mfma_f32_16x16x32_bf16 a[96:99], v[184:187], v[128:131], a[96:99]
ds_read_b64_tr_b16 v[248:249], v32 offset:32768
ds_read_b64_tr_b16 v[250:251], v32 offset:34816
v_mfma_f32_16x16x32_bf16 a[100:103], v[184:187], v[132:135], a[100:103]
ds_read_b64_tr_b16 v[252:253], v33 offset:32768
ds_read_b64_tr_b16 v[254:255], v33 offset:34816
v_mfma_f32_16x16x32_bf16 a[104:107], v[184:187], v[136:139], a[104:107]
v_mfma_f32_16x16x32_bf16 a[108:111], v[184:187], v[140:143], a[108:111]
v_mfma_f32_16x16x32_bf16 a[112:115], v[188:191], v[128:131], a[112:115]
v_mfma_f32_16x16x32_bf16 a[116:119], v[188:191], v[132:135], a[116:119]
v_mfma_f32_16x16x32_bf16 a[120:123], v[188:191], v[136:139], a[120:123]
v_mfma_f32_16x16x32_bf16 a[124:127], v[188:191], v[140:143], a[124:127]
s_waitcnt lgkmcnt(0)
v_mfma_f32_16x16x32_bf16 a[0:3], v[224:227], v[192:195], a[0:3]
v_mfma_f32_16x16x32_bf16 a[4:7], v[224:227], v[196:199], a[4:7]
v_mfma_f32_16x16x32_bf16 a[8:11], v[224:227], v[200:203], a[8:11]
v_mfma_f32_16x16x32_bf16 a[12:15], v[224:227], v[204:207], a[12:15]
v_mfma_f32_16x16x32_bf16 a[16:19], v[228:231], v[192:195], a[16:19]
v_mfma_f32_16x16x32_bf16 a[20:23], v[228:231], v[196:199], a[20:23]
v_mfma_f32_16x16x32_bf16 a[24:27], v[228:231], v[200:203], a[24:27]
v_mfma_f32_16x16x32_bf16 a[28:31], v[228:231], v[204:207], a[28:31]
v_mfma_f32_16x16x32_bf16 a[32:35], v[232:235], v[192:195], a[32:35]
v_mfma_f32_16x16x32_bf16 a[36:39], v[232:235], v[196:199], a[36:39]
v_mfma_f32_16x16x32_bf16 a[40:43], v[232:235], v[200:203], a[40:43]
v_mfma_f32_16x16x32_bf16 a[44:47], v[232:235], v[204:207], a[44:47]
v_mfma_f32_16x16x32_bf16 a[48:51], v[236:239], v[192:195], a[48:51]
v_mfma_f32_16x16x32_bf16 a[52:55], v[236:239], v[196:199], a[52:55]
v_mfma_f32_16x16x32_bf16 a[56:59], v[236:239], v[200:203], a[56:59]
v_mfma_f32_16x16x32_bf16 a[60:63], v[236:239], v[204:207], a[60:63]
s_waitcnt vmcnt(6)
s_barrier
v_mfma_f32_16x16x32_bf16 a[64:67], v[240:243], v[192:195], a[64:67]
ds_read_b64_tr_b16 v[160:161], v34 offset:0
ds_read_b64_tr_b16 v[162:163], v34 offset:2048
v_mfma_f32_16x16x32_bf16 a[68:71], v[240:243], v[196:199], a[68:71]
ds_read_b128 v[128:131], v11 offset:0
ds_read_b128 v[132:135], v11 offset:1024
v_mfma_f32_16x16x32_bf16 a[72:75], v[240:243], v[200:203], a[72:75]
ds_read_b128 v[136:139], v11 offset:2048
ds_read_b128 v[140:143], v11 offset:3072
v_mfma_f32_16x16x32_bf16 a[76:79], v[240:243], v[204:207], a[76:79]
ds_read_b64_tr_b16 v[164:165], v35 offset:0
ds_read_b64_tr_b16 v[166:167], v35 offset:2048
v_mfma_f32_16x16x32_bf16 a[80:83], v[244:247], v[192:195], a[80:83]
ds_read_b64_tr_b16 v[168:169], v36 offset:0
ds_read_b64_tr_b16 v[170:171], v36 offset:2048
v_mfma_f32_16x16x32_bf16 a[84:87], v[244:247], v[196:199], a[84:87]
ds_read_b64_tr_b16 v[172:173], v37 offset:0
ds_read_b64_tr_b16 v[174:175], v37 offset:2048
v_mfma_f32_16x16x32_bf16 a[88:91], v[244:247], v[200:203], a[88:91]
ds_read_b64_tr_b16 v[176:177], v38 offset:0
ds_read_b64_tr_b16 v[178:179], v38 offset:2048
v_mfma_f32_16x16x32_bf16 a[92:95], v[244:247], v[204:207], a[92:95]
ds_read_b64_tr_b16 v[180:181], v39 offset:0
ds_read_b64_tr_b16 v[182:183], v39 offset:2048
v_mfma_f32_16x16x32_bf16 a[96:99], v[248:251], v[192:195], a[96:99]
ds_read_b64_tr_b16 v[184:185], v40 offset:0
ds_read_b64_tr_b16 v[186:187], v40 offset:2048
v_mfma_f32_16x16x32_bf16 a[100:103], v[248:251], v[196:199], a[100:103]
ds_read_b64_tr_b16 v[188:189], v41 offset:0
ds_read_b64_tr_b16 v[190:191], v41 offset:2048
v_mfma_f32_16x16x32_bf16 a[104:107], v[248:251], v[200:203], a[104:107]
v_mfma_f32_16x16x32_bf16 a[108:111], v[248:251], v[204:207], a[108:111]
v_mfma_f32_16x16x32_bf16 a[112:115], v[252:255], v[192:195], a[112:115]
v_mfma_f32_16x16x32_bf16 a[116:119], v[252:255], v[196:199], a[116:119]
v_mfma_f32_16x16x32_bf16 a[120:123], v[252:255], v[200:203], a[120:123]
v_mfma_f32_16x16x32_bf16 a[124:127], v[252:255], v[204:207], a[124:127]
s_waitcnt lgkmcnt(0)
v_mfma_f32_16x16x32_bf16 a[0:3], v[160:163], v[128:131], a[0:3]
v_mfma_f32_16x16x32_bf16 a[4:7], v[160:163], v[132:135], a[4:7]
v_mfma_f32_16x16x32_bf16 a[8:11], v[160:163], v[136:139], a[8:11]
v_mfma_f32_16x16x32_bf16 a[12:15], v[160:163], v[140:143], a[12:15]
v_mfma_f32_16x16x32_bf16 a[16:19], v[164:167], v[128:131], a[16:19]
v_mfma_f32_16x16x32_bf16 a[20:23], v[164:167], v[132:135], a[20:23]
v_mfma_f32_16x16x32_bf16 a[24:27], v[164:167], v[136:139], a[24:27]
v_mfma_f32_16x16x32_bf16 a[28:31], v[164:167], v[140:143], a[28:31]
v_mfma_f32_16x16x32_bf16 a[32:35], v[168:171], v[128:131], a[32:35]
v_mfma_f32_16x16x32_bf16 a[36:39], v[168:171], v[132:135], a[36:39]
v_mfma_f32_16x16x32_bf16 a[40:43], v[168:171], v[136:139], a[40:43]
v_mfma_f32_16x16x32_bf16 a[44:47], v[168:171], v[140:143], a[44:47]
v_mfma_f32_16x16x32_bf16 a[48:51], v[172:175], v[128:131], a[48:51]
v_mfma_f32_16x16x32_bf16 a[52:55], v[172:175], v[132:135], a[52:55]
v_mfma_f32_16x16x32_bf16 a[56:59], v[172:175], v[136:139], a[56:59]
v_mfma_f32_16x16x32_bf16 a[60:63], v[172:175], v[140:143], a[60:63]
s_waitcnt vmcnt(0)
s_barrier
v_mfma_f32_16x16x32_bf16 a[64:67], v[176:179], v[128:131], a[64:67]
ds_read_b64_tr_b16 v[224:225], v34 offset:32768
ds_read_b64_tr_b16 v[226:227], v34 offset:34816
v_mfma_f32_16x16x32_bf16 a[68:71], v[176:179], v[132:135], a[68:71]
ds_read_b128 v[192:195], v11 offset:32768
ds_read_b128 v[196:199], v11 offset:33792
v_mfma_f32_16x16x32_bf16 a[72:75], v[176:179], v[136:139], a[72:75]
ds_read_b128 v[200:203], v11 offset:34816
ds_read_b128 v[204:207], v11 offset:35840
v_mfma_f32_16x16x32_bf16 a[76:79], v[176:179], v[140:143], a[76:79]
ds_read_b64_tr_b16 v[228:229], v35 offset:32768
ds_read_b64_tr_b16 v[230:231], v35 offset:34816
v_mfma_f32_16x16x32_bf16 a[80:83], v[180:183], v[128:131], a[80:83]
ds_read_b64_tr_b16 v[232:233], v36 offset:32768
ds_read_b64_tr_b16 v[234:235], v36 offset:34816
v_mfma_f32_16x16x32_bf16 a[84:87], v[180:183], v[132:135], a[84:87]
ds_read_b64_tr_b16 v[236:237], v37 offset:32768
ds_read_b64_tr_b16 v[238:239], v37 offset:34816
v_mfma_f32_16x16x32_bf16 a[88:91], v[180:183], v[136:139], a[88:91]
ds_read_b64_tr_b16 v[240:241], v38 offset:32768
ds_read_b64_tr_b16 v[242:243], v38 offset:34816
v_mfma_f32_16x16x32_bf16 a[92:95], v[180:183], v[140:143], a[92:95]
ds_read_b64_tr_b16 v[244:245], v39 offset:32768
ds_read_b64_tr_b16 v[246:247], v39 offset:34816
v_mfma_f32_16x16x32_bf16 a[96:99], v[184:187], v[128:131], a[96:99]
ds_read_b64_tr_b16 v[248:249], v40 offset:32768
ds_read_b64_tr_b16 v[250:251], v40 offset:34816
v_mfma_f32_16x16x32_bf16 a[100:103], v[184:187], v[132:135], a[100:103]
ds_read_b64_tr_b16 v[252:253], v41 offset:32768
ds_read_b64_tr_b16 v[254:255], v41 offset:34816
v_mfma_f32_16x16x32_bf16 a[104:107], v[184:187], v[136:139], a[104:107]
v_mfma_f32_16x16x32_bf16 a[108:111], v[184:187], v[140:143], a[108:111]
v_mfma_f32_16x16x32_bf16 a[112:115], v[188:191], v[128:131], a[112:115]
v_mfma_f32_16x16x32_bf16 a[116:119], v[188:191], v[132:135], a[116:119]
v_mfma_f32_16x16x32_bf16 a[120:123], v[188:191], v[136:139], a[120:123]
v_mfma_f32_16x16x32_bf16 a[124:127], v[188:191], v[140:143], a[124:127]
s_waitcnt lgkmcnt(0)
v_mfma_f32_16x16x32_bf16 a[0:3], v[224:227], v[192:195], a[0:3]
v_mfma_f32_16x16x32_bf16 a[4:7], v[224:227], v[196:199], a[4:7]
v_mfma_f32_16x16x32_bf16 a[8:11], v[224:227], v[200:203], a[8:11]
v_mfma_f32_16x16x32_bf16 a[12:15], v[224:227], v[204:207], a[12:15]
v_mfma_f32_16x16x32_bf16 a[16:19], v[228:231], v[192:195], a[16:19]
v_mfma_f32_16x16x32_bf16 a[20:23], v[228:231], v[196:199], a[20:23]
v_mfma_f32_16x16x32_bf16 a[24:27], v[228:231], v[200:203], a[24:27]
v_mfma_f32_16x16x32_bf16 a[28:31], v[228:231], v[204:207], a[28:31]
v_mfma_f32_16x16x32_bf16 a[32:35], v[232:235], v[192:195], a[32:35]
v_mfma_f32_16x16x32_bf16 a[36:39], v[232:235], v[196:199], a[36:39]
v_mfma_f32_16x16x32_bf16 a[40:43], v[232:235], v[200:203], a[40:43]
v_mfma_f32_16x16x32_bf16 a[44:47], v[232:235], v[204:207], a[44:47]
v_mfma_f32_16x16x32_bf16 a[48:51], v[236:239], v[192:195], a[48:51]
v_mfma_f32_16x16x32_bf16 a[52:55], v[236:239], v[196:199], a[52:55]
v_mfma_f32_16x16x32_bf16 a[56:59], v[236:239], v[200:203], a[56:59]
v_mfma_f32_16x16x32_bf16 a[60:63], v[236:239], v[204:207], a[60:63]
v_mfma_f32_16x16x32_bf16 a[64:67], v[240:243], v[192:195], a[64:67]
v_mfma_f32_16x16x32_bf16 a[68:71], v[240:243], v[196:199], a[68:71]
v_mfma_f32_16x16x32_bf16 a[72:75], v[240:243], v[200:203], a[72:75]
v_mfma_f32_16x16x32_bf16 a[76:79], v[240:243], v[204:207], a[76:79]
v_mfma_f32_16x16x32_bf16 a[80:83], v[244:247], v[192:195], a[80:83]
v_mfma_f32_16x16x32_bf16 a[84:87], v[244:247], v[196:199], a[84:87]
v_mfma_f32_16x16x32_bf16 a[88:91], v[244:247], v[200:203], a[88:91]
v_mfma_f32_16x16x32_bf16 a[92:95], v[244:247], v[204:207], a[92:95]
v_mfma_f32_16x16x32_bf16 a[96:99], v[248:251], v[192:195], a[96:99]
v_mfma_f32_16x16x32_bf16 a[100:103], v[248:251], v[196:199], a[100:103]
v_mfma_f32_16x16x32_bf16 a[104:107], v[248:251], v[200:203], a[104:107]
v_mfma_f32_16x16x32_bf16 a[108:111], v[248:251], v[204:207], a[108:111]
v_mfma_f32_16x16x32_bf16 a[112:115], v[252:255], v[192:195], a[112:115]
v_mfma_f32_16x16x32_bf16 a[116:119], v[252:255], v[196:199], a[116:119]
v_mfma_f32_16x16x32_bf16 a[120:123], v[252:255], v[200:203], a[120:123]
v_mfma_f32_16x16x32_bf16 a[124:127], v[252:255], v[204:207], a[124:127]
s_lshl_b32 s64, s61, 18
s_lshl_b32 s65, s58, 9
s_add_u32 s64, s64, s65
s_add_u32 s12, s74, s64
s_addc_u32 s13, s75, 0
s_add_u32 s16, s72, s64
s_addc_u32 s17, s73, 0
s_add_u32 s64, s64, 75497472
s_add_u32 s14, s40, s64
s_addc_u32 s15, s41, 0
v_and_b32 v42, 15, v1
v_lshrrev_b32 v43, 4, v1
v_and_b32 v44, 1, v43
v_lshlrev_b32 v44, 1, v44
v_lshrrev_b32 v45, 1, v43
v_add_u32 v44, v44, v45
s_lshr_b32 s21, s20, 1
s_and_b32 s22, s20, 1
s_mul_i32 s21, s21, 131072
s_mul_i32 s22, s22, 256
s_add_u32 s21, s21, s22
v_mul_u32_u24 v45, 2048, v42
v_lshl_add_u32 v45, v44, 4, v45
v_add_u32 v56, s21, v45
global_load_dwordx4 v[88:91], v56, s[14:15] offset:0 sc1
global_load_dwordx4 v[92:95], v56, s[16:17] offset:0
global_load_dwordx4 v[96:99], v56, s[14:15] offset:64 sc1
global_load_dwordx4 v[100:103], v56, s[16:17] offset:64
v_accvgpr_read_b32 v64, a0
v_accvgpr_read_b32 v65, a1
v_accvgpr_read_b32 v66, a2
v_accvgpr_read_b32 v67, a3
v_accvgpr_read_b32 v68, a16
v_accvgpr_read_b32 v69, a17
v_accvgpr_read_b32 v70, a18
v_accvgpr_read_b32 v71, a19
v_cvt_pk_bf16_f32 v80, v64, v65
v_cvt_pk_bf16_f32 v81, v66, v67
v_cvt_pk_bf16_f32 v82, v68, v69
v_cvt_pk_bf16_f32 v83, v70, v71
s_nop 0
v_permlane16_swap_b32 v80, v82
v_permlane16_swap_b32 v81, v83
s_waitcnt vmcnt(2)
v_lshlrev_b32 v104, 16, v80
v_and_b32 v105, 0xffff0000, v80
v_lshlrev_b32 v106, 16, v88
v_and_b32 v107, 0xffff0000, v88
v_pk_mul_f32 v[104:105], v[104:105], v[106:107]
v_cvt_pk_bf16_f32 v104, v104, v105
v_and_b32 v105, 0xffff0000, v104
v_lshlrev_b32 v104, 16, v104
v_lshlrev_b32 v106, 16, v92
v_and_b32 v107, 0xffff0000, v92
v_pk_add_f32 v[104:105], v[104:105], v[106:107]
v_cvt_pk_bf16_f32 v80, v104, v105
v_lshlrev_b32 v104, 16, v81
v_and_b32 v105, 0xffff0000, v81
v_lshlrev_b32 v106, 16, v89
v_and_b32 v107, 0xffff0000, v89
v_pk_mul_f32 v[104:105], v[104:105], v[106:107]
v_cvt_pk_bf16_f32 v104, v104, v105
v_and_b32 v105, 0xffff0000, v104
v_lshlrev_b32 v104, 16, v104
v_lshlrev_b32 v106, 16, v93
v_and_b32 v107, 0xffff0000, v93
v_pk_add_f32 v[104:105], v[104:105], v[106:107]
v_cvt_pk_bf16_f32 v81, v104, v105
v_lshlrev_b32 v104, 16, v82
v_and_b32 v105, 0xffff0000, v82
v_lshlrev_b32 v106, 16, v90
v_and_b32 v107, 0xffff0000, v90
v_pk_mul_f32 v[104:105], v[104:105], v[106:107]
v_cvt_pk_bf16_f32 v104, v104, v105
v_and_b32 v105, 0xffff0000, v104
v_lshlrev_b32 v104, 16, v104
v_lshlrev_b32 v106, 16, v94
v_and_b32 v107, 0xffff0000, v94
v_pk_add_f32 v[104:105], v[104:105], v[106:107]
v_cvt_pk_bf16_f32 v82, v104, v105
v_lshlrev_b32 v104, 16, v83
v_and_b32 v105, 0xffff0000, v83
v_lshlrev_b32 v106, 16, v91
v_and_b32 v107, 0xffff0000, v91
v_pk_mul_f32 v[104:105], v[104:105], v[106:107]
v_cvt_pk_bf16_f32 v104, v104, v105
v_and_b32 v105, 0xffff0000, v104
v_lshlrev_b32 v104, 16, v104
v_lshlrev_b32 v106, 16, v95
v_and_b32 v107, 0xffff0000, v95
v_pk_add_f32 v[104:105], v[104:105], v[106:107]
v_cvt_pk_bf16_f32 v83, v104, v105
global_store_dwordx4 v56, v[80:83], s[12:13] offset:0
global_load_dwordx4 v[88:91], v56, s[14:15] offset:128 sc1
global_load_dwordx4 v[92:95], v56, s[16:17] offset:128
v_accvgpr_read_b32 v72, a32
v_accvgpr_read_b32 v73, a33
v_accvgpr_read_b32 v74, a34
v_accvgpr_read_b32 v75, a35
v_accvgpr_read_b32 v76, a48
v_accvgpr_read_b32 v77, a49
v_accvgpr_read_b32 v78, a50
v_accvgpr_read_b32 v79, a51
v_cvt_pk_bf16_f32 v84, v72, v73
v_cvt_pk_bf16_f32 v85, v74, v75
v_cvt_pk_bf16_f32 v86, v76, v77
v_cvt_pk_bf16_f32 v87, v78, v79
s_nop 0
v_permlane16_swap_b32 v84, v86
v_permlane16_swap_b32 v85, v87
s_waitcnt vmcnt(3)
v_lshlrev_b32 v104, 16, v84
v_and_b32 v105, 0xffff0000, v84
v_lshlrev_b32 v106, 16, v96
v_and_b32 v107, 0xffff0000, v96
v_pk_mul_f32 v[104:105], v[104:105], v[106:107]
v_cvt_pk_bf16_f32 v104, v104, v105
v_and_b32 v105, 0xffff0000, v104
v_lshlrev_b32 v104, 16, v104
v_lshlrev_b32 v106, 16, v100
v_and_b32 v107, 0xffff0000, v100
v_pk_add_f32 v[104:105], v[104:105], v[106:107]
v_cvt_pk_bf16_f32 v84, v104, v105
v_lshlrev_b32 v104, 16, v85
v_and_b32 v105, 0xffff0000, v85
v_lshlrev_b32 v106, 16, v97
v_and_b32 v107, 0xffff0000, v97
v_pk_mul_f32 v[104:105], v[104:105], v[106:107]
v_cvt_pk_bf16_f32 v104, v104, v105
v_and_b32 v105, 0xffff0000, v104
v_lshlrev_b32 v104, 16, v104
v_lshlrev_b32 v106, 16, v101
v_and_b32 v107, 0xffff0000, v101
v_pk_add_f32 v[104:105], v[104:105], v[106:107]
v_cvt_pk_bf16_f32 v85, v104, v105
v_lshlrev_b32 v104, 16, v86
v_and_b32 v105, 0xffff0000, v86
v_lshlrev_b32 v106, 16, v98
v_and_b32 v107, 0xffff0000, v98
v_pk_mul_f32 v[104:105], v[104:105], v[106:107]
v_cvt_pk_bf16_f32 v104, v104, v105
v_and_b32 v105, 0xffff0000, v104
v_lshlrev_b32 v104, 16, v104
v_lshlrev_b32 v106, 16, v102
v_and_b32 v107, 0xffff0000, v102
v_pk_add_f32 v[104:105], v[104:105], v[106:107]
v_cvt_pk_bf16_f32 v86, v104, v105
v_lshlrev_b32 v104, 16, v87
v_and_b32 v105, 0xffff0000, v87
v_lshlrev_b32 v106, 16, v99
v_and_b32 v107, 0xffff0000, v99
v_pk_mul_f32 v[104:105], v[104:105], v[106:107]
v_cvt_pk_bf16_f32 v104, v104, v105
v_and_b32 v105, 0xffff0000, v104
v_lshlrev_b32 v104, 16, v104
v_lshlrev_b32 v106, 16, v103
v_and_b32 v107, 0xffff0000, v103
v_pk_add_f32 v[104:105], v[104:105], v[106:107]
v_cvt_pk_bf16_f32 v87, v104, v105
global_store_dwordx4 v56, v[84:87], s[12:13] offset:64
global_load_dwordx4 v[96:99], v56, s[14:15] offset:192 sc1
global_load_dwordx4 v[100:103], v56, s[16:17] offset:192
v_accvgpr_read_b32 v64, a64
v_accvgpr_read_b32 v65, a65
v_accvgpr_read_b32 v66, a66
v_accvgpr_read_b32 v67, a67
v_accvgpr_read_b32 v68, a80
v_accvgpr_read_b32 v69, a81
v_accvgpr_read_b32 v70, a82
v_accvgpr_read_b32 v71, a83
v_cvt_pk_bf16_f32 v80, v64, v65
v_cvt_pk_bf16_f32 v81, v66, v67
v_cvt_pk_bf16_f32 v82, v68, v69
v_cvt_pk_bf16_f32 v83, v70, v71
s_nop 0
v_permlane16_swap_b32 v80, v82
v_permlane16_swap_b32 v81, v83
s_waitcnt vmcnt(3)
v_lshlrev_b32 v104, 16, v80
v_and_b32 v105, 0xffff0000, v80
v_lshlrev_b32 v106, 16, v88
v_and_b32 v107, 0xffff0000, v88
v_pk_mul_f32 v[104:105], v[104:105], v[106:107]
v_cvt_pk_bf16_f32 v104, v104, v105
v_and_b32 v105, 0xffff0000, v104
v_lshlrev_b32 v104, 16, v104
v_lshlrev_b32 v106, 16, v92
v_and_b32 v107, 0xffff0000, v92
v_pk_add_f32 v[104:105], v[104:105], v[106:107]
v_cvt_pk_bf16_f32 v80, v104, v105
v_lshlrev_b32 v104, 16, v81
v_and_b32 v105, 0xffff0000, v81
v_lshlrev_b32 v106, 16, v89
v_and_b32 v107, 0xffff0000, v89
v_pk_mul_f32 v[104:105], v[104:105], v[106:107]
v_cvt_pk_bf16_f32 v104, v104, v105
v_and_b32 v105, 0xffff0000, v104
v_lshlrev_b32 v104, 16, v104
v_lshlrev_b32 v106, 16, v93
v_and_b32 v107, 0xffff0000, v93
v_pk_add_f32 v[104:105], v[104:105], v[106:107]
v_cvt_pk_bf16_f32 v81, v104, v105
v_lshlrev_b32 v104, 16, v82
v_and_b32 v105, 0xffff0000, v82
v_lshlrev_b32 v106, 16, v90
v_and_b32 v107, 0xffff0000, v90
v_pk_mul_f32 v[104:105], v[104:105], v[106:107]
v_cvt_pk_bf16_f32 v104, v104, v105
v_and_b32 v105, 0xffff0000, v104
v_lshlrev_b32 v104, 16, v104
v_lshlrev_b32 v106, 16, v94
v_and_b32 v107, 0xffff0000, v94
v_pk_add_f32 v[104:105], v[104:105], v[106:107]
v_cvt_pk_bf16_f32 v82, v104, v105
v_lshlrev_b32 v104, 16, v83
v_and_b32 v105, 0xffff0000, v83
v_lshlrev_b32 v106, 16, v91
v_and_b32 v107, 0xffff0000, v91
v_pk_mul_f32 v[104:105], v[104:105], v[106:107]
v_cvt_pk_bf16_f32 v104, v104, v105
v_and_b32 v105, 0xffff0000, v104
v_lshlrev_b32 v104, 16, v104
v_lshlrev_b32 v106, 16, v95
v_and_b32 v107, 0xffff0000, v95
v_pk_add_f32 v[104:105], v[104:105], v[106:107]
v_cvt_pk_bf16_f32 v83, v104, v105
global_store_dwordx4 v56, v[80:83], s[12:13] offset:128
s_add_u32 s14, s14, 32768
s_addc_u32 s15, s15, 0
s_add_u32 s16, s16, 32768
s_addc_u32 s17, s17, 0
global_load_dwordx4 v[88:91], v56, s[14:15] offset:0 sc1
global_load_dwordx4 v[92:95], v56, s[16:17] offset:0
v_accvgpr_read_b32 v72, a96
v_accvgpr_read_b32 v73, a97
v_accvgpr_read_b32 v74, a98
v_accvgpr_read_b32 v75, a99
v_accvgpr_read_b32 v76, a112
v_accvgpr_read_b32 v77, a113
v_accvgpr_read_b32 v78, a114
v_accvgpr_read_b32 v79, a115
v_cvt_pk_bf16_f32 v84, v72, v73
v_cvt_pk_bf16_f32 v85, v74, v75
v_cvt_pk_bf16_f32 v86, v76, v77
v_cvt_pk_bf16_f32 v87, v78, v79
s_nop 0
v_permlane16_swap_b32 v84, v86
v_permlane16_swap_b32 v85, v87
s_waitcnt vmcnt(3)
v_lshlrev_b32 v104, 16, v84
v_and_b32 v105, 0xffff0000, v84
v_lshlrev_b32 v106, 16, v96
v_and_b32 v107, 0xffff0000, v96
v_pk_mul_f32 v[104:105], v[104:105], v[106:107]
v_cvt_pk_bf16_f32 v104, v104, v105
v_and_b32 v105, 0xffff0000, v104
v_lshlrev_b32 v104, 16, v104
v_lshlrev_b32 v106, 16, v100
v_and_b32 v107, 0xffff0000, v100
v_pk_add_f32 v[104:105], v[104:105], v[106:107]
v_cvt_pk_bf16_f32 v84, v104, v105
v_lshlrev_b32 v104, 16, v85
v_and_b32 v105, 0xffff0000, v85
v_lshlrev_b32 v106, 16, v97
v_and_b32 v107, 0xffff0000, v97
v_pk_mul_f32 v[104:105], v[104:105], v[106:107]
v_cvt_pk_bf16_f32 v104, v104, v105
v_and_b32 v105, 0xffff0000, v104
v_lshlrev_b32 v104, 16, v104
v_lshlrev_b32 v106, 16, v101
v_and_b32 v107, 0xffff0000, v101
v_pk_add_f32 v[104:105], v[104:105], v[106:107]
v_cvt_pk_bf16_f32 v85, v104, v105
v_lshlrev_b32 v104, 16, v86
v_and_b32 v105, 0xffff0000, v86
v_lshlrev_b32 v106, 16, v98
v_and_b32 v107, 0xffff0000, v98
v_pk_mul_f32 v[104:105], v[104:105], v[106:107]
v_cvt_pk_bf16_f32 v104, v104, v105
v_and_b32 v105, 0xffff0000, v104
v_lshlrev_b32 v104, 16, v104
v_lshlrev_b32 v106, 16, v102
v_and_b32 v107, 0xffff0000, v102
v_pk_add_f32 v[104:105], v[104:105], v[106:107]
v_cvt_pk_bf16_f32 v86, v104, v105
v_lshlrev_b32 v104, 16, v87
v_and_b32 v105, 0xffff0000, v87
v_lshlrev_b32 v106, 16, v99
v_and_b32 v107, 0xffff0000, v99
v_pk_mul_f32 v[104:105], v[104:105], v[106:107]
v_cvt_pk_bf16_f32 v104, v104, v105
v_and_b32 v105, 0xffff0000, v104
v_lshlrev_b32 v104, 16, v104
v_lshlrev_b32 v106, 16, v103
v_and_b32 v107, 0xffff0000, v103
v_pk_add_f32 v[104:105], v[104:105], v[106:107]
v_cvt_pk_bf16_f32 v87, v104, v105
global_store_dwordx4 v56, v[84:87], s[12:13] offset:192
global_load_dwordx4 v[96:99], v56, s[14:15] offset:64 sc1
global_load_dwordx4 v[100:103], v56, s[16:17] offset:64
v_accvgpr_read_b32 v64, a4
v_accvgpr_read_b32 v65, a5
v_accvgpr_read_b32 v66, a6
v_accvgpr_read_b32 v67, a7
v_accvgpr_read_b32 v68, a20
v_accvgpr_read_b32 v69, a21
v_accvgpr_read_b32 v70, a22
v_accvgpr_read_b32 v71, a23
v_cvt_pk_bf16_f32 v80, v64, v65
v_cvt_pk_bf16_f32 v81, v66, v67
v_cvt_pk_bf16_f32 v82, v68, v69
v_cvt_pk_bf16_f32 v83, v70, v71
s_nop 0
v_permlane16_swap_b32 v80, v82
v_permlane16_swap_b32 v81, v83
s_waitcnt vmcnt(3)
v_lshlrev_b32 v104, 16, v80
v_and_b32 v105, 0xffff0000, v80
v_lshlrev_b32 v106, 16, v88
v_and_b32 v107, 0xffff0000, v88
v_pk_mul_f32 v[104:105], v[104:105], v[106:107]
v_cvt_pk_bf16_f32 v104, v104, v105
v_and_b32 v105, 0xffff0000, v104
v_lshlrev_b32 v104, 16, v104
v_lshlrev_b32 v106, 16, v92
v_and_b32 v107, 0xffff0000, v92
v_pk_add_f32 v[104:105], v[104:105], v[106:107]
v_cvt_pk_bf16_f32 v80, v104, v105
v_lshlrev_b32 v104, 16, v81
v_and_b32 v105, 0xffff0000, v81
v_lshlrev_b32 v106, 16, v89
v_and_b32 v107, 0xffff0000, v89
v_pk_mul_f32 v[104:105], v[104:105], v[106:107]
v_cvt_pk_bf16_f32 v104, v104, v105
v_and_b32 v105, 0xffff0000, v104
v_lshlrev_b32 v104, 16, v104
v_lshlrev_b32 v106, 16, v93
v_and_b32 v107, 0xffff0000, v93
v_pk_add_f32 v[104:105], v[104:105], v[106:107]
v_cvt_pk_bf16_f32 v81, v104, v105
v_lshlrev_b32 v104, 16, v82
v_and_b32 v105, 0xffff0000, v82
v_lshlrev_b32 v106, 16, v90
v_and_b32 v107, 0xffff0000, v90
v_pk_mul_f32 v[104:105], v[104:105], v[106:107]
v_cvt_pk_bf16_f32 v104, v104, v105
v_and_b32 v105, 0xffff0000, v104
v_lshlrev_b32 v104, 16, v104
v_lshlrev_b32 v106, 16, v94
v_and_b32 v107, 0xffff0000, v94
v_pk_add_f32 v[104:105], v[104:105], v[106:107]
v_cvt_pk_bf16_f32 v82, v104, v105
v_lshlrev_b32 v104, 16, v83
v_and_b32 v105, 0xffff0000, v83
v_lshlrev_b32 v106, 16, v91
v_and_b32 v107, 0xffff0000, v91
v_pk_mul_f32 v[104:105], v[104:105], v[106:107]
v_cvt_pk_bf16_f32 v104, v104, v105
v_and_b32 v105, 0xffff0000, v104
v_lshlrev_b32 v104, 16, v104
v_lshlrev_b32 v106, 16, v95
v_and_b32 v107, 0xffff0000, v95
v_pk_add_f32 v[104:105], v[104:105], v[106:107]
v_cvt_pk_bf16_f32 v83, v104, v105
s_add_u32 s12, s12, 32768
s_addc_u32 s13, s13, 0
global_store_dwordx4 v56, v[80:83], s[12:13] offset:0
global_load_dwordx4 v[88:91], v56, s[14:15] offset:128 sc1
global_load_dwordx4 v[92:95], v56, s[16:17] offset:128
v_accvgpr_read_b32 v72, a36
v_accvgpr_read_b32 v73, a37
v_accvgpr_read_b32 v74, a38
v_accvgpr_read_b32 v75, a39
v_accvgpr_read_b32 v76, a52
v_accvgpr_read_b32 v77, a53
v_accvgpr_read_b32 v78, a54
v_accvgpr_read_b32 v79, a55
v_cvt_pk_bf16_f32 v84, v72, v73
v_cvt_pk_bf16_f32 v85, v74, v75
v_cvt_pk_bf16_f32 v86, v76, v77
v_cvt_pk_bf16_f32 v87, v78, v79
s_nop 0
v_permlane16_swap_b32 v84, v86
v_permlane16_swap_b32 v85, v87
s_waitcnt vmcnt(3)
v_lshlrev_b32 v104, 16, v84
v_and_b32 v105, 0xffff0000, v84
v_lshlrev_b32 v106, 16, v96
v_and_b32 v107, 0xffff0000, v96
v_pk_mul_f32 v[104:105], v[104:105], v[106:107]
v_cvt_pk_bf16_f32 v104, v104, v105
v_and_b32 v105, 0xffff0000, v104
v_lshlrev_b32 v104, 16, v104
v_lshlrev_b32 v106, 16, v100
v_and_b32 v107, 0xffff0000, v100
v_pk_add_f32 v[104:105], v[104:105], v[106:107]
v_cvt_pk_bf16_f32 v84, v104, v105
v_lshlrev_b32 v104, 16, v85
v_and_b32 v105, 0xffff0000, v85
v_lshlrev_b32 v106, 16, v97
v_and_b32 v107, 0xffff0000, v97
v_pk_mul_f32 v[104:105], v[104:105], v[106:107]
v_cvt_pk_bf16_f32 v104, v104, v105
v_and_b32 v105, 0xffff0000, v104
v_lshlrev_b32 v104, 16, v104
v_lshlrev_b32 v106, 16, v101
v_and_b32 v107, 0xffff0000, v101
v_pk_add_f32 v[104:105], v[104:105], v[106:107]
v_cvt_pk_bf16_f32 v85, v104, v105
v_lshlrev_b32 v104, 16, v86
v_and_b32 v105, 0xffff0000, v86
v_lshlrev_b32 v106, 16, v98
v_and_b32 v107, 0xffff0000, v98
v_pk_mul_f32 v[104:105], v[104:105], v[106:107]
v_cvt_pk_bf16_f32 v104, v104, v105
v_and_b32 v105, 0xffff0000, v104
v_lshlrev_b32 v104, 16, v104
v_lshlrev_b32 v106, 16, v102
v_and_b32 v107, 0xffff0000, v102
v_pk_add_f32 v[104:105], v[104:105], v[106:107]
v_cvt_pk_bf16_f32 v86, v104, v105
v_lshlrev_b32 v104, 16, v87
v_and_b32 v105, 0xffff0000, v87
v_lshlrev_b32 v106, 16, v99
v_and_b32 v107, 0xffff0000, v99
v_pk_mul_f32 v[104:105], v[104:105], v[106:107]
v_cvt_pk_bf16_f32 v104, v104, v105
v_and_b32 v105, 0xffff0000, v104
v_lshlrev_b32 v104, 16, v104
v_lshlrev_b32 v106, 16, v103
v_and_b32 v107, 0xffff0000, v103
v_pk_add_f32 v[104:105], v[104:105], v[106:107]
v_cvt_pk_bf16_f32 v87, v104, v105
global_store_dwordx4 v56, v[84:87], s[12:13] offset:64
global_load_dwordx4 v[96:99], v56, s[14:15] offset:192 sc1
global_load_dwordx4 v[100:103], v56, s[16:17] offset:192
v_accvgpr_read_b32 v64, a68
v_accvgpr_read_b32 v65, a69
v_accvgpr_read_b32 v66, a70
v_accvgpr_read_b32 v67, a71
v_accvgpr_read_b32 v68, a84
v_accvgpr_read_b32 v69, a85
v_accvgpr_read_b32 v70, a86
v_accvgpr_read_b32 v71, a87
v_cvt_pk_bf16_f32 v80, v64, v65
v_cvt_pk_bf16_f32 v81, v66, v67
v_cvt_pk_bf16_f32 v82, v68, v69
v_cvt_pk_bf16_f32 v83, v70, v71
s_nop 0
v_permlane16_swap_b32 v80, v82
v_permlane16_swap_b32 v81, v83
s_waitcnt vmcnt(3)
v_lshlrev_b32 v104, 16, v80
v_and_b32 v105, 0xffff0000, v80
v_lshlrev_b32 v106, 16, v88
v_and_b32 v107, 0xffff0000, v88
v_pk_mul_f32 v[104:105], v[104:105], v[106:107]
v_cvt_pk_bf16_f32 v104, v104, v105
v_and_b32 v105, 0xffff0000, v104
v_lshlrev_b32 v104, 16, v104
v_lshlrev_b32 v106, 16, v92
v_and_b32 v107, 0xffff0000, v92
v_pk_add_f32 v[104:105], v[104:105], v[106:107]
v_cvt_pk_bf16_f32 v80, v104, v105
v_lshlrev_b32 v104, 16, v81
v_and_b32 v105, 0xffff0000, v81
v_lshlrev_b32 v106, 16, v89
v_and_b32 v107, 0xffff0000, v89
v_pk_mul_f32 v[104:105], v[104:105], v[106:107]
v_cvt_pk_bf16_f32 v104, v104, v105
v_and_b32 v105, 0xffff0000, v104
v_lshlrev_b32 v104, 16, v104
v_lshlrev_b32 v106, 16, v93
v_and_b32 v107, 0xffff0000, v93
v_pk_add_f32 v[104:105], v[104:105], v[106:107]
v_cvt_pk_bf16_f32 v81, v104, v105
v_lshlrev_b32 v104, 16, v82
v_and_b32 v105, 0xffff0000, v82
v_lshlrev_b32 v106, 16, v90
v_and_b32 v107, 0xffff0000, v90
v_pk_mul_f32 v[104:105], v[104:105], v[106:107]
v_cvt_pk_bf16_f32 v104, v104, v105
v_and_b32 v105, 0xffff0000, v104
v_lshlrev_b32 v104, 16, v104
v_lshlrev_b32 v106, 16, v94
v_and_b32 v107, 0xffff0000, v94
v_pk_add_f32 v[104:105], v[104:105], v[106:107]
v_cvt_pk_bf16_f32 v82, v104, v105
v_lshlrev_b32 v104, 16, v83
v_and_b32 v105, 0xffff0000, v83
v_lshlrev_b32 v106, 16, v91
v_and_b32 v107, 0xffff0000, v91
v_pk_mul_f32 v[104:105], v[104:105], v[106:107]
v_cvt_pk_bf16_f32 v104, v104, v105
v_and_b32 v105, 0xffff0000, v104
v_lshlrev_b32 v104, 16, v104
v_lshlrev_b32 v106, 16, v95
v_and_b32 v107, 0xffff0000, v95
v_pk_add_f32 v[104:105], v[104:105], v[106:107]
v_cvt_pk_bf16_f32 v83, v104, v105
global_store_dwordx4 v56, v[80:83], s[12:13] offset:128
s_add_u32 s14, s14, 32768
s_addc_u32 s15, s15, 0
s_add_u32 s16, s16, 32768
s_addc_u32 s17, s17, 0
global_load_dwordx4 v[88:91], v56, s[14:15] offset:0 sc1
global_load_dwordx4 v[92:95], v56, s[16:17] offset:0
v_accvgpr_read_b32 v72, a100
v_accvgpr_read_b32 v73, a101
v_accvgpr_read_b32 v74, a102
v_accvgpr_read_b32 v75, a103
v_accvgpr_read_b32 v76, a116
v_accvgpr_read_b32 v77, a117
v_accvgpr_read_b32 v78, a118
v_accvgpr_read_b32 v79, a119
v_cvt_pk_bf16_f32 v84, v72, v73
v_cvt_pk_bf16_f32 v85, v74, v75
v_cvt_pk_bf16_f32 v86, v76, v77
v_cvt_pk_bf16_f32 v87, v78, v79
s_nop 0
v_permlane16_swap_b32 v84, v86
v_permlane16_swap_b32 v85, v87
s_waitcnt vmcnt(3)
v_lshlrev_b32 v104, 16, v84
v_and_b32 v105, 0xffff0000, v84
v_lshlrev_b32 v106, 16, v96
v_and_b32 v107, 0xffff0000, v96
v_pk_mul_f32 v[104:105], v[104:105], v[106:107]
v_cvt_pk_bf16_f32 v104, v104, v105
v_and_b32 v105, 0xffff0000, v104
v_lshlrev_b32 v104, 16, v104
v_lshlrev_b32 v106, 16, v100
v_and_b32 v107, 0xffff0000, v100
v_pk_add_f32 v[104:105], v[104:105], v[106:107]
v_cvt_pk_bf16_f32 v84, v104, v105
v_lshlrev_b32 v104, 16, v85
v_and_b32 v105, 0xffff0000, v85
v_lshlrev_b32 v106, 16, v97
v_and_b32 v107, 0xffff0000, v97
v_pk_mul_f32 v[104:105], v[104:105], v[106:107]
v_cvt_pk_bf16_f32 v104, v104, v105
v_and_b32 v105, 0xffff0000, v104
v_lshlrev_b32 v104, 16, v104
v_lshlrev_b32 v106, 16, v101
v_and_b32 v107, 0xffff0000, v101
v_pk_add_f32 v[104:105], v[104:105], v[106:107]
v_cvt_pk_bf16_f32 v85, v104, v105
v_lshlrev_b32 v104, 16, v86
v_and_b32 v105, 0xffff0000, v86
v_lshlrev_b32 v106, 16, v98
v_and_b32 v107, 0xffff0000, v98
v_pk_mul_f32 v[104:105], v[104:105], v[106:107]
v_cvt_pk_bf16_f32 v104, v104, v105
v_and_b32 v105, 0xffff0000, v104
v_lshlrev_b32 v104, 16, v104
v_lshlrev_b32 v106, 16, v102
v_and_b32 v107, 0xffff0000, v102
v_pk_add_f32 v[104:105], v[104:105], v[106:107]
v_cvt_pk_bf16_f32 v86, v104, v105
v_lshlrev_b32 v104, 16, v87
v_and_b32 v105, 0xffff0000, v87
v_lshlrev_b32 v106, 16, v99
v_and_b32 v107, 0xffff0000, v99
v_pk_mul_f32 v[104:105], v[104:105], v[106:107]
v_cvt_pk_bf16_f32 v104, v104, v105
v_and_b32 v105, 0xffff0000, v104
v_lshlrev_b32 v104, 16, v104
v_lshlrev_b32 v106, 16, v103
v_and_b32 v107, 0xffff0000, v103
v_pk_add_f32 v[104:105], v[104:105], v[106:107]
v_cvt_pk_bf16_f32 v87, v104, v105
global_store_dwordx4 v56, v[84:87], s[12:13] offset:192
global_load_dwordx4 v[96:99], v56, s[14:15] offset:64 sc1
global_load_dwordx4 v[100:103], v56, s[16:17] offset:64
v_accvgpr_read_b32 v64, a8
v_accvgpr_read_b32 v65, a9
v_accvgpr_read_b32 v66, a10
v_accvgpr_read_b32 v67, a11
v_accvgpr_read_b32 v68, a24
v_accvgpr_read_b32 v69, a25
v_accvgpr_read_b32 v70, a26
v_accvgpr_read_b32 v71, a27
v_cvt_pk_bf16_f32 v80, v64, v65
v_cvt_pk_bf16_f32 v81, v66, v67
v_cvt_pk_bf16_f32 v82, v68, v69
v_cvt_pk_bf16_f32 v83, v70, v71
s_nop 0
v_permlane16_swap_b32 v80, v82
v_permlane16_swap_b32 v81, v83
s_waitcnt vmcnt(3)
v_lshlrev_b32 v104, 16, v80
v_and_b32 v105, 0xffff0000, v80
v_lshlrev_b32 v106, 16, v88
v_and_b32 v107, 0xffff0000, v88
v_pk_mul_f32 v[104:105], v[104:105], v[106:107]
v_cvt_pk_bf16_f32 v104, v104, v105
v_and_b32 v105, 0xffff0000, v104
v_lshlrev_b32 v104, 16, v104
v_lshlrev_b32 v106, 16, v92
v_and_b32 v107, 0xffff0000, v92
v_pk_add_f32 v[104:105], v[104:105], v[106:107]
v_cvt_pk_bf16_f32 v80, v104, v105
v_lshlrev_b32 v104, 16, v81
v_and_b32 v105, 0xffff0000, v81
v_lshlrev_b32 v106, 16, v89
v_and_b32 v107, 0xffff0000, v89
v_pk_mul_f32 v[104:105], v[104:105], v[106:107]
v_cvt_pk_bf16_f32 v104, v104, v105
v_and_b32 v105, 0xffff0000, v104
v_lshlrev_b32 v104, 16, v104
v_lshlrev_b32 v106, 16, v93
v_and_b32 v107, 0xffff0000, v93
v_pk_add_f32 v[104:105], v[104:105], v[106:107]
v_cvt_pk_bf16_f32 v81, v104, v105
v_lshlrev_b32 v104, 16, v82
v_and_b32 v105, 0xffff0000, v82
v_lshlrev_b32 v106, 16, v90
v_and_b32 v107, 0xffff0000, v90
v_pk_mul_f32 v[104:105], v[104:105], v[106:107]
v_cvt_pk_bf16_f32 v104, v104, v105
v_and_b32 v105, 0xffff0000, v104
v_lshlrev_b32 v104, 16, v104
v_lshlrev_b32 v106, 16, v94
v_and_b32 v107, 0xffff0000, v94
v_pk_add_f32 v[104:105], v[104:105], v[106:107]
v_cvt_pk_bf16_f32 v82, v104, v105
v_lshlrev_b32 v104, 16, v83
v_and_b32 v105, 0xffff0000, v83
v_lshlrev_b32 v106, 16, v91
v_and_b32 v107, 0xffff0000, v91
v_pk_mul_f32 v[104:105], v[104:105], v[106:107]
v_cvt_pk_bf16_f32 v104, v104, v105
v_and_b32 v105, 0xffff0000, v104
v_lshlrev_b32 v104, 16, v104
v_lshlrev_b32 v106, 16, v95
v_and_b32 v107, 0xffff0000, v95
v_pk_add_f32 v[104:105], v[104:105], v[106:107]
v_cvt_pk_bf16_f32 v83, v104, v105
s_add_u32 s12, s12, 32768
s_addc_u32 s13, s13, 0
global_store_dwordx4 v56, v[80:83], s[12:13] offset:0
global_load_dwordx4 v[88:91], v56, s[14:15] offset:128 sc1
global_load_dwordx4 v[92:95], v56, s[16:17] offset:128
v_accvgpr_read_b32 v72, a40
v_accvgpr_read_b32 v73, a41
v_accvgpr_read_b32 v74, a42
v_accvgpr_read_b32 v75, a43
v_accvgpr_read_b32 v76, a56
v_accvgpr_read_b32 v77, a57
v_accvgpr_read_b32 v78, a58
v_accvgpr_read_b32 v79, a59
v_cvt_pk_bf16_f32 v84, v72, v73
v_cvt_pk_bf16_f32 v85, v74, v75
v_cvt_pk_bf16_f32 v86, v76, v77
v_cvt_pk_bf16_f32 v87, v78, v79
s_nop 0
v_permlane16_swap_b32 v84, v86
v_permlane16_swap_b32 v85, v87
s_waitcnt vmcnt(3)
v_lshlrev_b32 v104, 16, v84
v_and_b32 v105, 0xffff0000, v84
v_lshlrev_b32 v106, 16, v96
v_and_b32 v107, 0xffff0000, v96
v_pk_mul_f32 v[104:105], v[104:105], v[106:107]
v_cvt_pk_bf16_f32 v104, v104, v105
v_and_b32 v105, 0xffff0000, v104
v_lshlrev_b32 v104, 16, v104
v_lshlrev_b32 v106, 16, v100
v_and_b32 v107, 0xffff0000, v100
v_pk_add_f32 v[104:105], v[104:105], v[106:107]
v_cvt_pk_bf16_f32 v84, v104, v105
v_lshlrev_b32 v104, 16, v85
v_and_b32 v105, 0xffff0000, v85
v_lshlrev_b32 v106, 16, v97
v_and_b32 v107, 0xffff0000, v97
v_pk_mul_f32 v[104:105], v[104:105], v[106:107]
v_cvt_pk_bf16_f32 v104, v104, v105
v_and_b32 v105, 0xffff0000, v104
v_lshlrev_b32 v104, 16, v104
v_lshlrev_b32 v106, 16, v101
v_and_b32 v107, 0xffff0000, v101
v_pk_add_f32 v[104:105], v[104:105], v[106:107]
v_cvt_pk_bf16_f32 v85, v104, v105
v_lshlrev_b32 v104, 16, v86
v_and_b32 v105, 0xffff0000, v86
v_lshlrev_b32 v106, 16, v98
v_and_b32 v107, 0xffff0000, v98
v_pk_mul_f32 v[104:105], v[104:105], v[106:107]
v_cvt_pk_bf16_f32 v104, v104, v105
v_and_b32 v105, 0xffff0000, v104
v_lshlrev_b32 v104, 16, v104
v_lshlrev_b32 v106, 16, v102
v_and_b32 v107, 0xffff0000, v102
v_pk_add_f32 v[104:105], v[104:105], v[106:107]
v_cvt_pk_bf16_f32 v86, v104, v105
v_lshlrev_b32 v104, 16, v87
v_and_b32 v105, 0xffff0000, v87
v_lshlrev_b32 v106, 16, v99
v_and_b32 v107, 0xffff0000, v99
v_pk_mul_f32 v[104:105], v[104:105], v[106:107]
v_cvt_pk_bf16_f32 v104, v104, v105
v_and_b32 v105, 0xffff0000, v104
v_lshlrev_b32 v104, 16, v104
v_lshlrev_b32 v106, 16, v103
v_and_b32 v107, 0xffff0000, v103
v_pk_add_f32 v[104:105], v[104:105], v[106:107]
v_cvt_pk_bf16_f32 v87, v104, v105
global_store_dwordx4 v56, v[84:87], s[12:13] offset:64
global_load_dwordx4 v[96:99], v56, s[14:15] offset:192 sc1
global_load_dwordx4 v[100:103], v56, s[16:17] offset:192
v_accvgpr_read_b32 v64, a72
v_accvgpr_read_b32 v65, a73
v_accvgpr_read_b32 v66, a74
v_accvgpr_read_b32 v67, a75
v_accvgpr_read_b32 v68, a88
v_accvgpr_read_b32 v69, a89
v_accvgpr_read_b32 v70, a90
v_accvgpr_read_b32 v71, a91
v_cvt_pk_bf16_f32 v80, v64, v65
v_cvt_pk_bf16_f32 v81, v66, v67
v_cvt_pk_bf16_f32 v82, v68, v69
v_cvt_pk_bf16_f32 v83, v70, v71
s_nop 0
v_permlane16_swap_b32 v80, v82
v_permlane16_swap_b32 v81, v83
s_waitcnt vmcnt(3)
v_lshlrev_b32 v104, 16, v80
v_and_b32 v105, 0xffff0000, v80
v_lshlrev_b32 v106, 16, v88
v_and_b32 v107, 0xffff0000, v88
v_pk_mul_f32 v[104:105], v[104:105], v[106:107]
v_cvt_pk_bf16_f32 v104, v104, v105
v_and_b32 v105, 0xffff0000, v104
v_lshlrev_b32 v104, 16, v104
v_lshlrev_b32 v106, 16, v92
v_and_b32 v107, 0xffff0000, v92
v_pk_add_f32 v[104:105], v[104:105], v[106:107]
v_cvt_pk_bf16_f32 v80, v104, v105
v_lshlrev_b32 v104, 16, v81
v_and_b32 v105, 0xffff0000, v81
v_lshlrev_b32 v106, 16, v89
v_and_b32 v107, 0xffff0000, v89
v_pk_mul_f32 v[104:105], v[104:105], v[106:107]
v_cvt_pk_bf16_f32 v104, v104, v105
v_and_b32 v105, 0xffff0000, v104
v_lshlrev_b32 v104, 16, v104
v_lshlrev_b32 v106, 16, v93
v_and_b32 v107, 0xffff0000, v93
v_pk_add_f32 v[104:105], v[104:105], v[106:107]
v_cvt_pk_bf16_f32 v81, v104, v105
v_lshlrev_b32 v104, 16, v82
v_and_b32 v105, 0xffff0000, v82
v_lshlrev_b32 v106, 16, v90
v_and_b32 v107, 0xffff0000, v90
v_pk_mul_f32 v[104:105], v[104:105], v[106:107]
v_cvt_pk_bf16_f32 v104, v104, v105
v_and_b32 v105, 0xffff0000, v104
v_lshlrev_b32 v104, 16, v104
v_lshlrev_b32 v106, 16, v94
v_and_b32 v107, 0xffff0000, v94
v_pk_add_f32 v[104:105], v[104:105], v[106:107]
v_cvt_pk_bf16_f32 v82, v104, v105
v_lshlrev_b32 v104, 16, v83
v_and_b32 v105, 0xffff0000, v83
v_lshlrev_b32 v106, 16, v91
v_and_b32 v107, 0xffff0000, v91
v_pk_mul_f32 v[104:105], v[104:105], v[106:107]
v_cvt_pk_bf16_f32 v104, v104, v105
v_and_b32 v105, 0xffff0000, v104
v_lshlrev_b32 v104, 16, v104
v_lshlrev_b32 v106, 16, v95
v_and_b32 v107, 0xffff0000, v95
v_pk_add_f32 v[104:105], v[104:105], v[106:107]
v_cvt_pk_bf16_f32 v83, v104, v105
global_store_dwordx4 v56, v[80:83], s[12:13] offset:128
s_add_u32 s14, s14, 32768
s_addc_u32 s15, s15, 0
s_add_u32 s16, s16, 32768
s_addc_u32 s17, s17, 0
global_load_dwordx4 v[88:91], v56, s[14:15] offset:0 sc1
global_load_dwordx4 v[92:95], v56, s[16:17] offset:0
v_accvgpr_read_b32 v72, a104
v_accvgpr_read_b32 v73, a105
v_accvgpr_read_b32 v74, a106
v_accvgpr_read_b32 v75, a107
v_accvgpr_read_b32 v76, a120
v_accvgpr_read_b32 v77, a121
v_accvgpr_read_b32 v78, a122
v_accvgpr_read_b32 v79, a123
v_cvt_pk_bf16_f32 v84, v72, v73
v_cvt_pk_bf16_f32 v85, v74, v75
v_cvt_pk_bf16_f32 v86, v76, v77
v_cvt_pk_bf16_f32 v87, v78, v79
s_nop 0
v_permlane16_swap_b32 v84, v86
v_permlane16_swap_b32 v85, v87
s_waitcnt vmcnt(3)
v_lshlrev_b32 v104, 16, v84
v_and_b32 v105, 0xffff0000, v84
v_lshlrev_b32 v106, 16, v96
v_and_b32 v107, 0xffff0000, v96
v_pk_mul_f32 v[104:105], v[104:105], v[106:107]
v_cvt_pk_bf16_f32 v104, v104, v105
v_and_b32 v105, 0xffff0000, v104
v_lshlrev_b32 v104, 16, v104
v_lshlrev_b32 v106, 16, v100
v_and_b32 v107, 0xffff0000, v100
v_pk_add_f32 v[104:105], v[104:105], v[106:107]
v_cvt_pk_bf16_f32 v84, v104, v105
v_lshlrev_b32 v104, 16, v85
v_and_b32 v105, 0xffff0000, v85
v_lshlrev_b32 v106, 16, v97
v_and_b32 v107, 0xffff0000, v97
v_pk_mul_f32 v[104:105], v[104:105], v[106:107]
v_cvt_pk_bf16_f32 v104, v104, v105
v_and_b32 v105, 0xffff0000, v104
v_lshlrev_b32 v104, 16, v104
v_lshlrev_b32 v106, 16, v101
v_and_b32 v107, 0xffff0000, v101
v_pk_add_f32 v[104:105], v[104:105], v[106:107]
v_cvt_pk_bf16_f32 v85, v104, v105
v_lshlrev_b32 v104, 16, v86
v_and_b32 v105, 0xffff0000, v86
v_lshlrev_b32 v106, 16, v98
v_and_b32 v107, 0xffff0000, v98
v_pk_mul_f32 v[104:105], v[104:105], v[106:107]
v_cvt_pk_bf16_f32 v104, v104, v105
v_and_b32 v105, 0xffff0000, v104
v_lshlrev_b32 v104, 16, v104
v_lshlrev_b32 v106, 16, v102
v_and_b32 v107, 0xffff0000, v102
v_pk_add_f32 v[104:105], v[104:105], v[106:107]
v_cvt_pk_bf16_f32 v86, v104, v105
v_lshlrev_b32 v104, 16, v87
v_and_b32 v105, 0xffff0000, v87
v_lshlrev_b32 v106, 16, v99
v_and_b32 v107, 0xffff0000, v99
v_pk_mul_f32 v[104:105], v[104:105], v[106:107]
v_cvt_pk_bf16_f32 v104, v104, v105
v_and_b32 v105, 0xffff0000, v104
v_lshlrev_b32 v104, 16, v104
v_lshlrev_b32 v106, 16, v103
v_and_b32 v107, 0xffff0000, v103
v_pk_add_f32 v[104:105], v[104:105], v[106:107]
v_cvt_pk_bf16_f32 v87, v104, v105
global_store_dwordx4 v56, v[84:87], s[12:13] offset:192
global_load_dwordx4 v[96:99], v56, s[14:15] offset:64 sc1
global_load_dwordx4 v[100:103], v56, s[16:17] offset:64
v_accvgpr_read_b32 v64, a12
v_accvgpr_read_b32 v65, a13
v_accvgpr_read_b32 v66, a14
v_accvgpr_read_b32 v67, a15
v_accvgpr_read_b32 v68, a28
v_accvgpr_read_b32 v69, a29
v_accvgpr_read_b32 v70, a30
v_accvgpr_read_b32 v71, a31
v_cvt_pk_bf16_f32 v80, v64, v65
v_cvt_pk_bf16_f32 v81, v66, v67
v_cvt_pk_bf16_f32 v82, v68, v69
v_cvt_pk_bf16_f32 v83, v70, v71
s_nop 0
v_permlane16_swap_b32 v80, v82
v_permlane16_swap_b32 v81, v83
s_waitcnt vmcnt(3)
v_lshlrev_b32 v104, 16, v80
v_and_b32 v105, 0xffff0000, v80
v_lshlrev_b32 v106, 16, v88
v_and_b32 v107, 0xffff0000, v88
v_pk_mul_f32 v[104:105], v[104:105], v[106:107]
v_cvt_pk_bf16_f32 v104, v104, v105
v_and_b32 v105, 0xffff0000, v104
v_lshlrev_b32 v104, 16, v104
v_lshlrev_b32 v106, 16, v92
v_and_b32 v107, 0xffff0000, v92
v_pk_add_f32 v[104:105], v[104:105], v[106:107]
v_cvt_pk_bf16_f32 v80, v104, v105
v_lshlrev_b32 v104, 16, v81
v_and_b32 v105, 0xffff0000, v81
v_lshlrev_b32 v106, 16, v89
v_and_b32 v107, 0xffff0000, v89
v_pk_mul_f32 v[104:105], v[104:105], v[106:107]
v_cvt_pk_bf16_f32 v104, v104, v105
v_and_b32 v105, 0xffff0000, v104
v_lshlrev_b32 v104, 16, v104
v_lshlrev_b32 v106, 16, v93
v_and_b32 v107, 0xffff0000, v93
v_pk_add_f32 v[104:105], v[104:105], v[106:107]
v_cvt_pk_bf16_f32 v81, v104, v105
v_lshlrev_b32 v104, 16, v82
v_and_b32 v105, 0xffff0000, v82
v_lshlrev_b32 v106, 16, v90
v_and_b32 v107, 0xffff0000, v90
v_pk_mul_f32 v[104:105], v[104:105], v[106:107]
v_cvt_pk_bf16_f32 v104, v104, v105
v_and_b32 v105, 0xffff0000, v104
v_lshlrev_b32 v104, 16, v104
v_lshlrev_b32 v106, 16, v94
v_and_b32 v107, 0xffff0000, v94
v_pk_add_f32 v[104:105], v[104:105], v[106:107]
v_cvt_pk_bf16_f32 v82, v104, v105
v_lshlrev_b32 v104, 16, v83
v_and_b32 v105, 0xffff0000, v83
v_lshlrev_b32 v106, 16, v91
v_and_b32 v107, 0xffff0000, v91
v_pk_mul_f32 v[104:105], v[104:105], v[106:107]
v_cvt_pk_bf16_f32 v104, v104, v105
v_and_b32 v105, 0xffff0000, v104
v_lshlrev_b32 v104, 16, v104
v_lshlrev_b32 v106, 16, v95
v_and_b32 v107, 0xffff0000, v95
v_pk_add_f32 v[104:105], v[104:105], v[106:107]
v_cvt_pk_bf16_f32 v83, v104, v105
s_add_u32 s12, s12, 32768
s_addc_u32 s13, s13, 0
global_store_dwordx4 v56, v[80:83], s[12:13] offset:0
global_load_dwordx4 v[88:91], v56, s[14:15] offset:128 sc1
global_load_dwordx4 v[92:95], v56, s[16:17] offset:128
v_accvgpr_read_b32 v72, a44
v_accvgpr_read_b32 v73, a45
v_accvgpr_read_b32 v74, a46
v_accvgpr_read_b32 v75, a47
v_accvgpr_read_b32 v76, a60
v_accvgpr_read_b32 v77, a61
v_accvgpr_read_b32 v78, a62
v_accvgpr_read_b32 v79, a63
v_cvt_pk_bf16_f32 v84, v72, v73
v_cvt_pk_bf16_f32 v85, v74, v75
v_cvt_pk_bf16_f32 v86, v76, v77
v_cvt_pk_bf16_f32 v87, v78, v79
s_nop 0
v_permlane16_swap_b32 v84, v86
v_permlane16_swap_b32 v85, v87
s_waitcnt vmcnt(3)
v_lshlrev_b32 v104, 16, v84
v_and_b32 v105, 0xffff0000, v84
v_lshlrev_b32 v106, 16, v96
v_and_b32 v107, 0xffff0000, v96
v_pk_mul_f32 v[104:105], v[104:105], v[106:107]
v_cvt_pk_bf16_f32 v104, v104, v105
v_and_b32 v105, 0xffff0000, v104
v_lshlrev_b32 v104, 16, v104
v_lshlrev_b32 v106, 16, v100
v_and_b32 v107, 0xffff0000, v100
v_pk_add_f32 v[104:105], v[104:105], v[106:107]
v_cvt_pk_bf16_f32 v84, v104, v105
v_lshlrev_b32 v104, 16, v85
v_and_b32 v105, 0xffff0000, v85
v_lshlrev_b32 v106, 16, v97
v_and_b32 v107, 0xffff0000, v97
v_pk_mul_f32 v[104:105], v[104:105], v[106:107]
v_cvt_pk_bf16_f32 v104, v104, v105
v_and_b32 v105, 0xffff0000, v104
v_lshlrev_b32 v104, 16, v104
v_lshlrev_b32 v106, 16, v101
v_and_b32 v107, 0xffff0000, v101
v_pk_add_f32 v[104:105], v[104:105], v[106:107]
v_cvt_pk_bf16_f32 v85, v104, v105
v_lshlrev_b32 v104, 16, v86
v_and_b32 v105, 0xffff0000, v86
v_lshlrev_b32 v106, 16, v98
v_and_b32 v107, 0xffff0000, v98
v_pk_mul_f32 v[104:105], v[104:105], v[106:107]
v_cvt_pk_bf16_f32 v104, v104, v105
v_and_b32 v105, 0xffff0000, v104
v_lshlrev_b32 v104, 16, v104
v_lshlrev_b32 v106, 16, v102
v_and_b32 v107, 0xffff0000, v102
v_pk_add_f32 v[104:105], v[104:105], v[106:107]
v_cvt_pk_bf16_f32 v86, v104, v105
v_lshlrev_b32 v104, 16, v87
v_and_b32 v105, 0xffff0000, v87
v_lshlrev_b32 v106, 16, v99
v_and_b32 v107, 0xffff0000, v99
v_pk_mul_f32 v[104:105], v[104:105], v[106:107]
v_cvt_pk_bf16_f32 v104, v104, v105
v_and_b32 v105, 0xffff0000, v104
v_lshlrev_b32 v104, 16, v104
v_lshlrev_b32 v106, 16, v103
v_and_b32 v107, 0xffff0000, v103
v_pk_add_f32 v[104:105], v[104:105], v[106:107]
v_cvt_pk_bf16_f32 v87, v104, v105
global_store_dwordx4 v56, v[84:87], s[12:13] offset:64
global_load_dwordx4 v[96:99], v56, s[14:15] offset:192 sc1
global_load_dwordx4 v[100:103], v56, s[16:17] offset:192
v_accvgpr_read_b32 v64, a76
v_accvgpr_read_b32 v65, a77
v_accvgpr_read_b32 v66, a78
v_accvgpr_read_b32 v67, a79
v_accvgpr_read_b32 v68, a92
v_accvgpr_read_b32 v69, a93
v_accvgpr_read_b32 v70, a94
v_accvgpr_read_b32 v71, a95
v_cvt_pk_bf16_f32 v80, v64, v65
v_cvt_pk_bf16_f32 v81, v66, v67
v_cvt_pk_bf16_f32 v82, v68, v69
v_cvt_pk_bf16_f32 v83, v70, v71
s_nop 0
v_permlane16_swap_b32 v80, v82
v_permlane16_swap_b32 v81, v83
s_waitcnt vmcnt(3)
v_lshlrev_b32 v104, 16, v80
v_and_b32 v105, 0xffff0000, v80
v_lshlrev_b32 v106, 16, v88
v_and_b32 v107, 0xffff0000, v88
v_pk_mul_f32 v[104:105], v[104:105], v[106:107]
v_cvt_pk_bf16_f32 v104, v104, v105
v_and_b32 v105, 0xffff0000, v104
v_lshlrev_b32 v104, 16, v104
v_lshlrev_b32 v106, 16, v92
v_and_b32 v107, 0xffff0000, v92
v_pk_add_f32 v[104:105], v[104:105], v[106:107]
v_cvt_pk_bf16_f32 v80, v104, v105
v_lshlrev_b32 v104, 16, v81
v_and_b32 v105, 0xffff0000, v81
v_lshlrev_b32 v106, 16, v89
v_and_b32 v107, 0xffff0000, v89
v_pk_mul_f32 v[104:105], v[104:105], v[106:107]
v_cvt_pk_bf16_f32 v104, v104, v105
v_and_b32 v105, 0xffff0000, v104
v_lshlrev_b32 v104, 16, v104
v_lshlrev_b32 v106, 16, v93
v_and_b32 v107, 0xffff0000, v93
v_pk_add_f32 v[104:105], v[104:105], v[106:107]
v_cvt_pk_bf16_f32 v81, v104, v105
v_lshlrev_b32 v104, 16, v82
v_and_b32 v105, 0xffff0000, v82
v_lshlrev_b32 v106, 16, v90
v_and_b32 v107, 0xffff0000, v90
v_pk_mul_f32 v[104:105], v[104:105], v[106:107]
v_cvt_pk_bf16_f32 v104, v104, v105
v_and_b32 v105, 0xffff0000, v104
v_lshlrev_b32 v104, 16, v104
v_lshlrev_b32 v106, 16, v94
v_and_b32 v107, 0xffff0000, v94
v_pk_add_f32 v[104:105], v[104:105], v[106:107]
v_cvt_pk_bf16_f32 v82, v104, v105
v_lshlrev_b32 v104, 16, v83
v_and_b32 v105, 0xffff0000, v83
v_lshlrev_b32 v106, 16, v91
v_and_b32 v107, 0xffff0000, v91
v_pk_mul_f32 v[104:105], v[104:105], v[106:107]
v_cvt_pk_bf16_f32 v104, v104, v105
v_and_b32 v105, 0xffff0000, v104
v_lshlrev_b32 v104, 16, v104
v_lshlrev_b32 v106, 16, v95
v_and_b32 v107, 0xffff0000, v95
v_pk_add_f32 v[104:105], v[104:105], v[106:107]
v_cvt_pk_bf16_f32 v83, v104, v105
global_store_dwordx4 v56, v[80:83], s[12:13] offset:128
v_accvgpr_read_b32 v72, a108
v_accvgpr_read_b32 v73, a109
v_accvgpr_read_b32 v74, a110
v_accvgpr_read_b32 v75, a111
v_accvgpr_read_b32 v76, a124
v_accvgpr_read_b32 v77, a125
v_accvgpr_read_b32 v78, a126
v_accvgpr_read_b32 v79, a127
v_cvt_pk_bf16_f32 v84, v72, v73
v_cvt_pk_bf16_f32 v85, v74, v75
v_cvt_pk_bf16_f32 v86, v76, v77
v_cvt_pk_bf16_f32 v87, v78, v79
s_nop 0
v_permlane16_swap_b32 v84, v86
v_permlane16_swap_b32 v85, v87
s_waitcnt vmcnt(1)
v_lshlrev_b32 v104, 16, v84
v_and_b32 v105, 0xffff0000, v84
v_lshlrev_b32 v106, 16, v96
v_and_b32 v107, 0xffff0000, v96
v_pk_mul_f32 v[104:105], v[104:105], v[106:107]
v_cvt_pk_bf16_f32 v104, v104, v105
v_and_b32 v105, 0xffff0000, v104
v_lshlrev_b32 v104, 16, v104
v_lshlrev_b32 v106, 16, v100
v_and_b32 v107, 0xffff0000, v100
v_pk_add_f32 v[104:105], v[104:105], v[106:107]
v_cvt_pk_bf16_f32 v84, v104, v105
v_lshlrev_b32 v104, 16, v85
v_and_b32 v105, 0xffff0000, v85
v_lshlrev_b32 v106, 16, v97
v_and_b32 v107, 0xffff0000, v97
v_pk_mul_f32 v[104:105], v[104:105], v[106:107]
v_cvt_pk_bf16_f32 v104, v104, v105
v_and_b32 v105, 0xffff0000, v104
v_lshlrev_b32 v104, 16, v104
v_lshlrev_b32 v106, 16, v101
v_and_b32 v107, 0xffff0000, v101
v_pk_add_f32 v[104:105], v[104:105], v[106:107]
v_cvt_pk_bf16_f32 v85, v104, v105
v_lshlrev_b32 v104, 16, v86
v_and_b32 v105, 0xffff0000, v86
v_lshlrev_b32 v106, 16, v98
v_and_b32 v107, 0xffff0000, v98
v_pk_mul_f32 v[104:105], v[104:105], v[106:107]
v_cvt_pk_bf16_f32 v104, v104, v105
v_and_b32 v105, 0xffff0000, v104
v_lshlrev_b32 v104, 16, v104
v_lshlrev_b32 v106, 16, v102
v_and_b32 v107, 0xffff0000, v102
v_pk_add_f32 v[104:105], v[104:105], v[106:107]
v_cvt_pk_bf16_f32 v86, v104, v105
v_lshlrev_b32 v104, 16, v87
v_and_b32 v105, 0xffff0000, v87
v_lshlrev_b32 v106, 16, v99
v_and_b32 v107, 0xffff0000, v99
v_pk_mul_f32 v[104:105], v[104:105], v[106:107]
v_cvt_pk_bf16_f32 v104, v104, v105
v_and_b32 v105, 0xffff0000, v104
v_lshlrev_b32 v104, 16, v104
v_lshlrev_b32 v106, 16, v103
v_and_b32 v107, 0xffff0000, v103
v_pk_add_f32 v[104:105], v[104:105], v[106:107]
v_cvt_pk_bf16_f32 v87, v104, v105
global_store_dwordx4 v56, v[84:87], s[12:13] offset:192
s_waitcnt vmcnt(0)
s_barrier
s_branch W_loop
W_fin:
s_branch W_loop
W_opp:
s_cmp_ge_u32 s61, 30
s_cbranch_scc1 W_opp8
s_lshl_b32 s66, s61, 4
s_lshr_b32 s67, s62, 0
s_lshl_b32 s67, s67, 2
s_add_u32 s66, s66, s67
s_lshl_b32 s64, s61, 12
s_lshl_b32 s65, s62, 22
s_add_u32 s64, s64, s65
s_add_u32 s64, s64, 83886080
s_add_u32 s4, s40, s64
s_addc_u32 s5, s41, 0
s_lshl_b32 s64, s58, 9
s_lshl_b32 s65, s62, 21
s_add_u32 s64, s64, s65
s_add_u32 s6, s70, s64
s_addc_u32 s7, s71, 0
s_mov_b32 s8, 131072
s_mov_b32 s31, 2048
s_mov_b32 s9, 65536
s_mov_b32 s10, 32
s_lshr_b32 s63, s61, 2
s_cmp_lg_u32 s20, 0
s_cbranch_scc1 M_wcd_139
s_lshl_b32 s64, s63, 2
s_add_u32 s64, s64, 192
v_mov_b32 v42, s64
s_mov_b32 s65, 0
s_mov_b64 exec, 1
M_wc_138:
global_load_dword v43, v42, s[56:57] sc1
s_waitcnt vmcnt(0)
v_readfirstlane_b32 s64, v43
s_cmp_ge_u32 s64, 8
s_cbranch_scc1 M_wcd_139_x
s_sleep 32
s_add_u32 s65, s65, 1
s_cmp_lt_u32 s65, 400000
s_cbranch_scc1 M_wc_138
s_mov_b64 exec, -1
s_branch M_exit0
M_wcd_139_x:
s_mov_b64 exec, -1
M_wcd_139:
s_barrier
s_cmp_eq_u32 s92, 1
s_cbranch_scc1 M_cs_140
s_cmp_lg_u32 s20, 0
s_cbranch_scc1 M_wcd_142
s_lshl_b32 s64, s58, 2
s_add_u32 s64, s64, 224
v_mov_b32 v42, s64
s_mov_b32 s65, 0
s_mov_b64 exec, 1
M_wc_141:
global_load_dword v43, v42, s[56:57] sc1
s_waitcnt vmcnt(0)
v_readfirstlane_b32 s64, v43
s_cmp_ge_u32 s64, 32
s_cbranch_scc1 M_wcd_142_x
s_sleep 32
s_add_u32 s65, s65, 1
s_cmp_lt_u32 s65, 400000
s_cbranch_scc1 M_wc_141
s_mov_b64 exec, -1
s_branch M_exit0
M_wcd_142_x:
s_mov_b64 exec, -1
M_wcd_142:
s_barrier
s_mov_b32 s92, 1
M_cs_140:
s_cmp_lg_u32 s20, 0
s_cbranch_scc1 M_wwd_144
s_add_u32 s64, s66, 176160768
v_mov_b32 v42, s64
s_mov_b32 s65, 0
s_mov_b64 exec, 1
M_ww_143:
global_load_dword v43, v42, s[40:41] sc1
s_waitcnt vmcnt(0)
v_readfirstlane_b32 s64, v43
s_cmp_ge_u32 s64, 4
s_cbranch_scc1 M_wwd_144_x
s_sleep 8
s_add_u32 s65, s65, 1
s_cmp_lt_u32 s65, 400000
s_cbranch_scc1 M_ww_143
s_mov_b64 exec, -1
s_branch M_exit0
M_wwd_144_x:
s_mov_b64 exec, -1
M_wwd_144:
s_barrier
s_call_b64 s[94:95], W_sub_smalln
s_sub_u32 s64, s61, 20
s_lshl_b32 s64, s64, 2
s_add_u32 s64, s64, s58
s_lshl_b32 s64, s64, 19
s_add_u32 s64, s64, 184549376
s_add_u32 s14, s40, s64
s_addc_u32 s15, s41, 0
s_lshl_b32 s64, s20, 14
v_lshlrev_b32 v56, 4, v1
v_add_u32 v56, s64, v56
s_lshl_b32 s64, s62, 16
v_add_u32 v57, s64, v56
global_store_dwordx4 v57, a[0:3], s[14:15] offset:0 sc1
global_store_dwordx4 v57, a[4:7], s[14:15] offset:1024 sc1
global_store_dwordx4 v57, a[8:11], s[14:15] offset:2048 sc1
global_store_dwordx4 v57, a[12:15], s[14:15] offset:3072 sc1
v_add_u32 v57, 4096, v57
global_store_dwordx4 v57, a[16:19], s[14:15] offset:0 sc1
global_store_dwordx4 v57, a[20:23], s[14:15] offset:1024 sc1
global_store_dwordx4 v57, a[24:27], s[14:15] offset:2048 sc1
global_store_dwordx4 v57, a[28:31], s[14:15] offset:3072 sc1
v_add_u32 v57, 4096, v57
global_store_dwordx4 v57, a[32:35], s[14:15] offset:0 sc1
global_store_dwordx4 v57, a[36:39], s[14:15] offset:1024 sc1
global_store_dwordx4 v57, a[40:43], s[14:15] offset:2048 sc1
global_store_dwordx4 v57, a[44:47], s[14:15] offset:3072 sc1
v_add_u32 v57, 4096, v57
global_store_dwordx4 v57, a[48:51], s[14:15] offset:0 sc1
global_store_dwordx4 v57, a[52:55], s[14:15] offset:1024 sc1
global_store_dwordx4 v57, a[56:59], s[14:15] offset:2048 sc1
global_store_dwordx4 v57, a[60:63], s[14:15] offset:3072 sc1
s_lshl_b32 s67, s61, 4
s_lshl_b32 s66, s58, 2
s_add_u32 s67, s67, s66
s_add_u32 s67, s67, 512
s_cmp_ge_u32 s61, 28
s_cbranch_scc1 M_dist_145
s_waitcnt vmcnt(0)
s_barrier
v_mov_b32 v44, 163824
s_cmp_lg_u32 s20, 0
s_cbranch_scc1 M_sw_146
s_add_u32 s64, s67, 176160768
v_mov_b32 v42, s64
v_mov_b32 v43, 1
s_mov_b64 exec, 1
global_atomic_add v45, v42, v43, s[40:41] sc0
s_waitcnt vmcnt(0)
ds_write_b32 v44, v45
s_waitcnt lgkmcnt(0)
s_mov_b64 exec, -1
M_sw_146:
s_barrier
ds_read_b32 v45, v44
s_waitcnt lgkmcnt(0)
v_readfirstlane_b32 s66, v45
s_barrier
s_cmp_lg_u32 s66, 3
s_cbranch_scc1 W_loop
v_add_u32 v57, 0, v56
global_load_dwordx4 v[128:131], v57, s[14:15] offset:0 sc1
v_add_u32 v57, 65536, v56
global_load_dwordx4 v[132:135], v57, s[14:15] offset:0 sc1
v_add_u32 v57, 131072, v56
global_load_dwordx4 v[136:139], v57, s[14:15] offset:0 sc1
v_add_u32 v57, 196608, v56
global_load_dwordx4 v[140:143], v57, s[14:15] offset:0 sc1
v_add_u32 v57, 0, v56
global_load_dwordx4 v[144:147], v57, s[14:15] offset:1024 sc1
v_add_u32 v57, 65536, v56
global_load_dwordx4 v[148:151], v57, s[14:15] offset:1024 sc1
v_add_u32 v57, 131072, v56
global_load_dwordx4 v[152:155], v57, s[14:15] offset:1024 sc1
v_add_u32 v57, 196608, v56
global_load_dwordx4 v[156:159], v57, s[14:15] offset:1024 sc1
v_add_u32 v57, 0, v56
global_load_dwordx4 v[160:163], v57, s[14:15] offset:2048 sc1
v_add_u32 v57, 65536, v56
global_load_dwordx4 v[164:167], v57, s[14:15] offset:2048 sc1
v_add_u32 v57, 131072, v56
global_load_dwordx4 v[168:171], v57, s[14:15] offset:2048 sc1
v_add_u32 v57, 196608, v56
global_load_dwordx4 v[172:175], v57, s[14:15] offset:2048 sc1
v_add_u32 v57, 0, v56
global_load_dwordx4 v[176:179], v57, s[14:15] offset:3072 sc1
v_add_u32 v57, 65536, v56
global_load_dwordx4 v[180:183], v57, s[14:15] offset:3072 sc1
v_add_u32 v57, 131072, v56
global_load_dwordx4 v[184:187], v57, s[14:15] offset:3072 sc1
v_add_u32 v57, 196608, v56
global_load_dwordx4 v[188:191], v57, s[14:15] offset:3072 sc1
v_add_u32 v57, 4096, v56
global_load_dwordx4 v[192:195], v57, s[14:15] offset:0 sc1
v_add_u32 v57, 69632, v56
global_load_dwordx4 v[196:199], v57, s[14:15] offset:0 sc1
v_add_u32 v57, 135168, v56
global_load_dwordx4 v[200:203], v57, s[14:15] offset:0 sc1
v_add_u32 v57, 200704, v56
global_load_dwordx4 v[204:207], v57, s[14:15] offset:0 sc1
v_add_u32 v57, 4096, v56
global_load_dwordx4 v[208:211], v57, s[14:15] offset:1024 sc1
v_add_u32 v57, 69632, v56
global_load_dwordx4 v[212:215], v57, s[14:15] offset:1024 sc1
v_add_u32 v57, 135168, v56
global_load_dwordx4 v[216:219], v57, s[14:15] offset:1024 sc1
v_add_u32 v57, 200704, v56
global_load_dwordx4 v[220:223], v57, s[14:15] offset:1024 sc1
v_add_u32 v57, 4096, v56
global_load_dwordx4 v[224:227], v57, s[14:15] offset:2048 sc1
v_add_u32 v57, 69632, v56
global_load_dwordx4 v[228:231], v57, s[14:15] offset:2048 sc1
v_add_u32 v57, 135168, v56
global_load_dwordx4 v[232:235], v57, s[14:15] offset:2048 sc1
v_add_u32 v57, 200704, v56
global_load_dwordx4 v[236:239], v57, s[14:15] offset:2048 sc1
v_add_u32 v57, 4096, v56
global_load_dwordx4 v[240:243], v57, s[14:15] offset:3072 sc1
v_add_u32 v57, 69632, v56
global_load_dwordx4 v[244:247], v57, s[14:15] offset:3072 sc1
v_add_u32 v57, 135168, v56
global_load_dwordx4 v[248:251], v57, s[14:15] offset:3072 sc1
v_add_u32 v57, 200704, v56
global_load_dwordx4 v[252:255], v57, s[14:15] offset:3072 sc1
s_waitcnt vmcnt(0)
v_pk_add_f32 v[128:129], v[128:129], v[132:133]
v_pk_add_f32 v[136:137], v[136:137], v[140:141]
v_pk_add_f32 v[130:131], v[130:131], v[134:135]
v_pk_add_f32 v[138:139], v[138:139], v[142:143]
v_pk_add_f32 v[128:129], v[128:129], v[136:137]
v_pk_add_f32 v[130:131], v[130:131], v[138:139]
v_accvgpr_write_b32 a0, v128
v_accvgpr_write_b32 a1, v129
v_accvgpr_write_b32 a2, v130
v_accvgpr_write_b32 a3, v131
v_pk_add_f32 v[144:145], v[144:145], v[148:149]
v_pk_add_f32 v[152:153], v[152:153], v[156:157]
v_pk_add_f32 v[146:147], v[146:147], v[150:151]
v_pk_add_f32 v[154:155], v[154:155], v[158:159]
v_pk_add_f32 v[144:145], v[144:145], v[152:153]
v_pk_add_f32 v[146:147], v[146:147], v[154:155]
v_accvgpr_write_b32 a4, v144
v_accvgpr_write_b32 a5, v145
v_accvgpr_write_b32 a6, v146
v_accvgpr_write_b32 a7, v147
v_pk_add_f32 v[160:161], v[160:161], v[164:165]
v_pk_add_f32 v[168:169], v[168:169], v[172:173]
v_pk_add_f32 v[162:163], v[162:163], v[166:167]
v_pk_add_f32 v[170:171], v[170:171], v[174:175]
v_pk_add_f32 v[160:161], v[160:161], v[168:169]
v_pk_add_f32 v[162:163], v[162:163], v[170:171]
v_accvgpr_write_b32 a8, v160
v_accvgpr_write_b32 a9, v161
v_accvgpr_write_b32 a10, v162
v_accvgpr_write_b32 a11, v163
v_pk_add_f32 v[176:177], v[176:177], v[180:181]
v_pk_add_f32 v[184:185], v[184:185], v[188:189]
v_pk_add_f32 v[178:179], v[178:179], v[182:183]
v_pk_add_f32 v[186:187], v[186:187], v[190:191]
v_pk_add_f32 v[176:177], v[176:177], v[184:185]
v_pk_add_f32 v[178:179], v[178:179], v[186:187]
v_accvgpr_write_b32 a12, v176
v_accvgpr_write_b32 a13, v177
v_accvgpr_write_b32 a14, v178
v_accvgpr_write_b32 a15, v179
v_pk_add_f32 v[192:193], v[192:193], v[196:197]
v_pk_add_f32 v[200:201], v[200:201], v[204:205]
v_pk_add_f32 v[194:195], v[194:195], v[198:199]
v_pk_add_f32 v[202:203], v[202:203], v[206:207]
v_pk_add_f32 v[192:193], v[192:193], v[200:201]
v_pk_add_f32 v[194:195], v[194:195], v[202:203]
v_accvgpr_write_b32 a16, v192
v_accvgpr_write_b32 a17, v193
v_accvgpr_write_b32 a18, v194
v_accvgpr_write_b32 a19, v195
v_pk_add_f32 v[208:209], v[208:209], v[212:213]
v_pk_add_f32 v[216:217], v[216:217], v[220:221]
v_pk_add_f32 v[210:211], v[210:211], v[214:215]
v_pk_add_f32 v[218:219], v[218:219], v[222:223]
v_pk_add_f32 v[208:209], v[208:209], v[216:217]
v_pk_add_f32 v[210:211], v[210:211], v[218:219]
v_accvgpr_write_b32 a20, v208
v_accvgpr_write_b32 a21, v209
v_accvgpr_write_b32 a22, v210
v_accvgpr_write_b32 a23, v211
v_pk_add_f32 v[224:225], v[224:225], v[228:229]
v_pk_add_f32 v[232:233], v[232:233], v[236:237]
v_pk_add_f32 v[226:227], v[226:227], v[230:231]
v_pk_add_f32 v[234:235], v[234:235], v[238:239]
v_pk_add_f32 v[224:225], v[224:225], v[232:233]
v_pk_add_f32 v[226:227], v[226:227], v[234:235]
v_accvgpr_write_b32 a24, v224
v_accvgpr_write_b32 a25, v225
v_accvgpr_write_b32 a26, v226
v_accvgpr_write_b32 a27, v227
v_pk_add_f32 v[240:241], v[240:241], v[244:245]
v_pk_add_f32 v[248:249], v[248:249], v[252:253]
v_pk_add_f32 v[242:243], v[242:243], v[246:247]
v_pk_add_f32 v[250:251], v[250:251], v[254:255]
v_pk_add_f32 v[240:241], v[240:241], v[248:249]
v_pk_add_f32 v[242:243], v[242:243], v[250:251]
v_accvgpr_write_b32 a28, v240
v_accvgpr_write_b32 a29, v241
v_accvgpr_write_b32 a30, v242
v_accvgpr_write_b32 a31, v243
v_add_u32 v57, 8192, v56
global_load_dwordx4 v[128:131], v57, s[14:15] offset:0 sc1
v_add_u32 v57, 73728, v56
global_load_dwordx4 v[132:135], v57, s[14:15] offset:0 sc1
v_add_u32 v57, 139264, v56
global_load_dwordx4 v[136:139], v57, s[14:15] offset:0 sc1
v_add_u32 v57, 204800, v56
global_load_dwordx4 v[140:143], v57, s[14:15] offset:0 sc1
v_add_u32 v57, 8192, v56
global_load_dwordx4 v[144:147], v57, s[14:15] offset:1024 sc1
v_add_u32 v57, 73728, v56
global_load_dwordx4 v[148:151], v57, s[14:15] offset:1024 sc1
v_add_u32 v57, 139264, v56
global_load_dwordx4 v[152:155], v57, s[14:15] offset:1024 sc1
v_add_u32 v57, 204800, v56
global_load_dwordx4 v[156:159], v57, s[14:15] offset:1024 sc1
v_add_u32 v57, 8192, v56
global_load_dwordx4 v[160:163], v57, s[14:15] offset:2048 sc1
v_add_u32 v57, 73728, v56
global_load_dwordx4 v[164:167], v57, s[14:15] offset:2048 sc1
v_add_u32 v57, 139264, v56
global_load_dwordx4 v[168:171], v57, s[14:15] offset:2048 sc1
v_add_u32 v57, 204800, v56
global_load_dwordx4 v[172:175], v57, s[14:15] offset:2048 sc1
v_add_u32 v57, 8192, v56
global_load_dwordx4 v[176:179], v57, s[14:15] offset:3072 sc1
v_add_u32 v57, 73728, v56
global_load_dwordx4 v[180:183], v57, s[14:15] offset:3072 sc1
v_add_u32 v57, 139264, v56
global_load_dwordx4 v[184:187], v57, s[14:15] offset:3072 sc1
v_add_u32 v57, 204800, v56
global_load_dwordx4 v[188:191], v57, s[14:15] offset:3072 sc1
v_add_u32 v57, 12288, v56
global_load_dwordx4 v[192:195], v57, s[14:15] offset:0 sc1
v_add_u32 v57, 77824, v56
global_load_dwordx4 v[196:199], v57, s[14:15] offset:0 sc1
v_add_u32 v57, 143360, v56
global_load_dwordx4 v[200:203], v57, s[14:15] offset:0 sc1
v_add_u32 v57, 208896, v56
global_load_dwordx4 v[204:207], v57, s[14:15] offset:0 sc1
v_add_u32 v57, 12288, v56
global_load_dwordx4 v[208:211], v57, s[14:15] offset:1024 sc1
v_add_u32 v57, 77824, v56
global_load_dwordx4 v[212:215], v57, s[14:15] offset:1024 sc1
v_add_u32 v57, 143360, v56
global_load_dwordx4 v[216:219], v57, s[14:15] offset:1024 sc1
v_add_u32 v57, 208896, v56
global_load_dwordx4 v[220:223], v57, s[14:15] offset:1024 sc1
v_add_u32 v57, 12288, v56
global_load_dwordx4 v[224:227], v57, s[14:15] offset:2048 sc1
v_add_u32 v57, 77824, v56
global_load_dwordx4 v[228:231], v57, s[14:15] offset:2048 sc1
v_add_u32 v57, 143360, v56
global_load_dwordx4 v[232:235], v57, s[14:15] offset:2048 sc1
v_add_u32 v57, 208896, v56
global_load_dwordx4 v[236:239], v57, s[14:15] offset:2048 sc1
v_add_u32 v57, 12288, v56
global_load_dwordx4 v[240:243], v57, s[14:15] offset:3072 sc1
v_add_u32 v57, 77824, v56
global_load_dwordx4 v[244:247], v57, s[14:15] offset:3072 sc1
v_add_u32 v57, 143360, v56
global_load_dwordx4 v[248:251], v57, s[14:15] offset:3072 sc1
v_add_u32 v57, 208896, v56
global_load_dwordx4 v[252:255], v57, s[14:15] offset:3072 sc1
s_waitcnt vmcnt(0)
v_pk_add_f32 v[128:129], v[128:129], v[132:133]
v_pk_add_f32 v[136:137], v[136:137], v[140:141]
v_pk_add_f32 v[130:131], v[130:131], v[134:135]
v_pk_add_f32 v[138:139], v[138:139], v[142:143]
v_pk_add_f32 v[128:129], v[128:129], v[136:137]
v_pk_add_f32 v[130:131], v[130:131], v[138:139]
v_accvgpr_write_b32 a32, v128
v_accvgpr_write_b32 a33, v129
v_accvgpr_write_b32 a34, v130
v_accvgpr_write_b32 a35, v131
v_pk_add_f32 v[144:145], v[144:145], v[148:149]
v_pk_add_f32 v[152:153], v[152:153], v[156:157]
v_pk_add_f32 v[146:147], v[146:147], v[150:151]
v_pk_add_f32 v[154:155], v[154:155], v[158:159]
v_pk_add_f32 v[144:145], v[144:145], v[152:153]
v_pk_add_f32 v[146:147], v[146:147], v[154:155]
v_accvgpr_write_b32 a36, v144
v_accvgpr_write_b32 a37, v145
v_accvgpr_write_b32 a38, v146
v_accvgpr_write_b32 a39, v147
v_pk_add_f32 v[160:161], v[160:161], v[164:165]
v_pk_add_f32 v[168:169], v[168:169], v[172:173]
v_pk_add_f32 v[162:163], v[162:163], v[166:167]
v_pk_add_f32 v[170:171], v[170:171], v[174:175]
v_pk_add_f32 v[160:161], v[160:161], v[168:169]
v_pk_add_f32 v[162:163], v[162:163], v[170:171]
v_accvgpr_write_b32 a40, v160
v_accvgpr_write_b32 a41, v161
v_accvgpr_write_b32 a42, v162
v_accvgpr_write_b32 a43, v163
v_pk_add_f32 v[176:177], v[176:177], v[180:181]
v_pk_add_f32 v[184:185], v[184:185], v[188:189]
v_pk_add_f32 v[178:179], v[178:179], v[182:183]
v_pk_add_f32 v[186:187], v[186:187], v[190:191]
v_pk_add_f32 v[176:177], v[176:177], v[184:185]
v_pk_add_f32 v[178:179], v[178:179], v[186:187]
v_accvgpr_write_b32 a44, v176
v_accvgpr_write_b32 a45, v177
v_accvgpr_write_b32 a46, v178
v_accvgpr_write_b32 a47, v179
v_pk_add_f32 v[192:193], v[192:193], v[196:197]
v_pk_add_f32 v[200:201], v[200:201], v[204:205]
v_pk_add_f32 v[194:195], v[194:195], v[198:199]
v_pk_add_f32 v[202:203], v[202:203], v[206:207]
v_pk_add_f32 v[192:193], v[192:193], v[200:201]
v_pk_add_f32 v[194:195], v[194:195], v[202:203]
v_accvgpr_write_b32 a48, v192
v_accvgpr_write_b32 a49, v193
v_accvgpr_write_b32 a50, v194
v_accvgpr_write_b32 a51, v195
v_pk_add_f32 v[208:209], v[208:209], v[212:213]
v_pk_add_f32 v[216:217], v[216:217], v[220:221]
v_pk_add_f32 v[210:211], v[210:211], v[214:215]
v_pk_add_f32 v[218:219], v[218:219], v[222:223]
v_pk_add_f32 v[208:209], v[208:209], v[216:217]
v_pk_add_f32 v[210:211], v[210:211], v[218:219]
v_accvgpr_write_b32 a52, v208
v_accvgpr_write_b32 a53, v209
v_accvgpr_write_b32 a54, v210
v_accvgpr_write_b32 a55, v211
v_pk_add_f32 v[224:225], v[224:225], v[228:229]
v_pk_add_f32 v[232:233], v[232:233], v[236:237]
v_pk_add_f32 v[226:227], v[226:227], v[230:231]
v_pk_add_f32 v[234:235], v[234:235], v[238:239]
v_pk_add_f32 v[224:225], v[224:225], v[232:233]
v_pk_add_f32 v[226:227], v[226:227], v[234:235]
v_accvgpr_write_b32 a56, v224
v_accvgpr_write_b32 a57, v225
v_accvgpr_write_b32 a58, v226
v_accvgpr_write_b32 a59, v227
v_pk_add_f32 v[240:241], v[240:241], v[244:245]
v_pk_add_f32 v[248:249], v[248:249], v[252:253]
v_pk_add_f32 v[242:243], v[242:243], v[246:247]
v_pk_add_f32 v[250:251], v[250:251], v[254:255]
v_pk_add_f32 v[240:241], v[240:241], v[248:249]
v_pk_add_f32 v[242:243], v[242:243], v[250:251]
v_accvgpr_write_b32 a60, v240
v_accvgpr_write_b32 a61, v241
v_accvgpr_write_b32 a62, v242
v_accvgpr_write_b32 a63, v243
s_lshl_b32 s64, s61, 17
s_lshl_b32 s65, s58, 9
s_add_u32 s64, s64, s65
s_add_u32 s12, s74, s64
s_addc_u32 s13, s75, 0
s_add_u32 s16, s72, s64
s_addc_u32 s17, s73, 0
s_add_u32 s64, s64, 75497472
s_add_u32 s14, s40, s64
s_addc_u32 s15, s41, 0
v_and_b32 v42, 15, v1
v_lshrrev_b32 v43, 4, v1
v_and_b32 v44, 1, v43
v_lshlrev_b32 v44, 1, v44
v_lshrrev_b32 v45, 1, v43
v_add_u32 v44, v44, v45
s_mov_b32 s21, 0
s_mov_b32 s22, s20
s_mul_i32 s21, s21, 131072
s_mul_i32 s22, s22, 128
s_add_u32 s21, s21, s22
v_mul_u32_u24 v45, 2048, v42
v_lshl_add_u32 v45, v44, 4, v45
v_add_u32 v56, s21, v45
global_load_dwordx4 v[88:91], v56, s[14:15] offset:0 sc1
global_load_dwordx4 v[92:95], v56, s[16:17] offset:0
global_load_dwordx4 v[96:99], v56, s[14:15] offset:64 sc1
global_load_dwordx4 v[100:103], v56, s[16:17] offset:64
v_accvgpr_read_b32 v64, a0
v_accvgpr_read_b32 v65, a1
v_accvgpr_read_b32 v66, a2
v_accvgpr_read_b32 v67, a3
v_accvgpr_read_b32 v68, a16
v_accvgpr_read_b32 v69, a17
v_accvgpr_read_b32 v70, a18
v_accvgpr_read_b32 v71, a19
v_cvt_pk_bf16_f32 v80, v64, v65
v_cvt_pk_bf16_f32 v81, v66, v67
v_cvt_pk_bf16_f32 v82, v68, v69
v_cvt_pk_bf16_f32 v83, v70, v71
s_nop 0
v_permlane16_swap_b32 v80, v82
v_permlane16_swap_b32 v81, v83
s_waitcnt vmcnt(2)
v_lshlrev_b32 v104, 16, v80
v_and_b32 v105, 0xffff0000, v80
v_lshlrev_b32 v106, 16, v88
v_and_b32 v107, 0xffff0000, v88
v_pk_mul_f32 v[104:105], v[104:105], v[106:107]
v_cvt_pk_bf16_f32 v104, v104, v105
v_and_b32 v105, 0xffff0000, v104
v_lshlrev_b32 v104, 16, v104
v_lshlrev_b32 v106, 16, v92
v_and_b32 v107, 0xffff0000, v92
v_pk_add_f32 v[104:105], v[104:105], v[106:107]
v_cvt_pk_bf16_f32 v80, v104, v105
v_lshlrev_b32 v104, 16, v81
v_and_b32 v105, 0xffff0000, v81
v_lshlrev_b32 v106, 16, v89
v_and_b32 v107, 0xffff0000, v89
v_pk_mul_f32 v[104:105], v[104:105], v[106:107]
v_cvt_pk_bf16_f32 v104, v104, v105
v_and_b32 v105, 0xffff0000, v104
v_lshlrev_b32 v104, 16, v104
v_lshlrev_b32 v106, 16, v93
v_and_b32 v107, 0xffff0000, v93
v_pk_add_f32 v[104:105], v[104:105], v[106:107]
v_cvt_pk_bf16_f32 v81, v104, v105
v_lshlrev_b32 v104, 16, v82
v_and_b32 v105, 0xffff0000, v82
v_lshlrev_b32 v106, 16, v90
v_and_b32 v107, 0xffff0000, v90
v_pk_mul_f32 v[104:105], v[104:105], v[106:107]
v_cvt_pk_bf16_f32 v104, v104, v105
v_and_b32 v105, 0xffff0000, v104
v_lshlrev_b32 v104, 16, v104
v_lshlrev_b32 v106, 16, v94
v_and_b32 v107, 0xffff0000, v94
v_pk_add_f32 v[104:105], v[104:105], v[106:107]
v_cvt_pk_bf16_f32 v82, v104, v105
v_lshlrev_b32 v104, 16, v83
v_and_b32 v105, 0xffff0000, v83
v_lshlrev_b32 v106, 16, v91
v_and_b32 v107, 0xffff0000, v91
v_pk_mul_f32 v[104:105], v[104:105], v[106:107]
v_cvt_pk_bf16_f32 v104, v104, v105
v_and_b32 v105, 0xffff0000, v104
v_lshlrev_b32 v104, 16, v104
v_lshlrev_b32 v106, 16, v95
v_and_b32 v107, 0xffff0000, v95
v_pk_add_f32 v[104:105], v[104:105], v[106:107]
v_cvt_pk_bf16_f32 v83, v104, v105
global_store_dwordx4 v56, v[80:83], s[12:13] offset:0
s_add_u32 s14, s14, 32768
s_addc_u32 s15, s15, 0
s_add_u32 s16, s16, 32768
s_addc_u32 s17, s17, 0
global_load_dwordx4 v[88:91], v56, s[14:15] offset:0 sc1
global_load_dwordx4 v[92:95], v56, s[16:17] offset:0
v_accvgpr_read_b32 v72, a32
v_accvgpr_read_b32 v73, a33
v_accvgpr_read_b32 v74, a34
v_accvgpr_read_b32 v75, a35
v_accvgpr_read_b32 v76, a48
v_accvgpr_read_b32 v77, a49
v_accvgpr_read_b32 v78, a50
v_accvgpr_read_b32 v79, a51
v_cvt_pk_bf16_f32 v84, v72, v73
v_cvt_pk_bf16_f32 v85, v74, v75
v_cvt_pk_bf16_f32 v86, v76, v77
v_cvt_pk_bf16_f32 v87, v78, v79
s_nop 0
v_permlane16_swap_b32 v84, v86
v_permlane16_swap_b32 v85, v87
s_waitcnt vmcnt(3)
v_lshlrev_b32 v104, 16, v84
v_and_b32 v105, 0xffff0000, v84
v_lshlrev_b32 v106, 16, v96
v_and_b32 v107, 0xffff0000, v96
v_pk_mul_f32 v[104:105], v[104:105], v[106:107]
v_cvt_pk_bf16_f32 v104, v104, v105
v_and_b32 v105, 0xffff0000, v104
v_lshlrev_b32 v104, 16, v104
v_lshlrev_b32 v106, 16, v100
v_and_b32 v107, 0xffff0000, v100
v_pk_add_f32 v[104:105], v[104:105], v[106:107]
v_cvt_pk_bf16_f32 v84, v104, v105
v_lshlrev_b32 v104, 16, v85
v_and_b32 v105, 0xffff0000, v85
v_lshlrev_b32 v106, 16, v97
v_and_b32 v107, 0xffff0000, v97
v_pk_mul_f32 v[104:105], v[104:105], v[106:107]
v_cvt_pk_bf16_f32 v104, v104, v105
v_and_b32 v105, 0xffff0000, v104
v_lshlrev_b32 v104, 16, v104
v_lshlrev_b32 v106, 16, v101
v_and_b32 v107, 0xffff0000, v101
v_pk_add_f32 v[104:105], v[104:105], v[106:107]
v_cvt_pk_bf16_f32 v85, v104, v105
v_lshlrev_b32 v104, 16, v86
v_and_b32 v105, 0xffff0000, v86
v_lshlrev_b32 v106, 16, v98
v_and_b32 v107, 0xffff0000, v98
v_pk_mul_f32 v[104:105], v[104:105], v[106:107]
v_cvt_pk_bf16_f32 v104, v104, v105
v_and_b32 v105, 0xffff0000, v104
v_lshlrev_b32 v104, 16, v104
v_lshlrev_b32 v106, 16, v102
v_and_b32 v107, 0xffff0000, v102
v_pk_add_f32 v[104:105], v[104:105], v[106:107]
v_cvt_pk_bf16_f32 v86, v104, v105
v_lshlrev_b32 v104, 16, v87
v_and_b32 v105, 0xffff0000, v87
v_lshlrev_b32 v106, 16, v99
v_and_b32 v107, 0xffff0000, v99
v_pk_mul_f32 v[104:105], v[104:105], v[106:107]
v_cvt_pk_bf16_f32 v104, v104, v105
v_and_b32 v105, 0xffff0000, v104
v_lshlrev_b32 v104, 16, v104
v_lshlrev_b32 v106, 16, v103
v_and_b32 v107, 0xffff0000, v103
v_pk_add_f32 v[104:105], v[104:105], v[106:107]
v_cvt_pk_bf16_f32 v87, v104, v105
global_store_dwordx4 v56, v[84:87], s[12:13] offset:64
global_load_dwordx4 v[96:99], v56, s[14:15] offset:64 sc1
global_load_dwordx4 v[100:103], v56, s[16:17] offset:64
v_accvgpr_read_b32 v64, a4
v_accvgpr_read_b32 v65, a5
v_accvgpr_read_b32 v66, a6
v_accvgpr_read_b32 v67, a7
v_accvgpr_read_b32 v68, a20
v_accvgpr_read_b32 v69, a21
v_accvgpr_read_b32 v70, a22
v_accvgpr_read_b32 v71, a23
v_cvt_pk_bf16_f32 v80, v64, v65
v_cvt_pk_bf16_f32 v81, v66, v67
v_cvt_pk_bf16_f32 v82, v68, v69
v_cvt_pk_bf16_f32 v83, v70, v71
s_nop 0
v_permlane16_swap_b32 v80, v82
v_permlane16_swap_b32 v81, v83
s_waitcnt vmcnt(3)
v_lshlrev_b32 v104, 16, v80
v_and_b32 v105, 0xffff0000, v80
v_lshlrev_b32 v106, 16, v88
v_and_b32 v107, 0xffff0000, v88
v_pk_mul_f32 v[104:105], v[104:105], v[106:107]
v_cvt_pk_bf16_f32 v104, v104, v105
v_and_b32 v105, 0xffff0000, v104
v_lshlrev_b32 v104, 16, v104
v_lshlrev_b32 v106, 16, v92
v_and_b32 v107, 0xffff0000, v92
v_pk_add_f32 v[104:105], v[104:105], v[106:107]
v_cvt_pk_bf16_f32 v80, v104, v105
v_lshlrev_b32 v104, 16, v81
v_and_b32 v105, 0xffff0000, v81
v_lshlrev_b32 v106, 16, v89
v_and_b32 v107, 0xffff0000, v89
v_pk_mul_f32 v[104:105], v[104:105], v[106:107]
v_cvt_pk_bf16_f32 v104, v104, v105
v_and_b32 v105, 0xffff0000, v104
v_lshlrev_b32 v104, 16, v104
v_lshlrev_b32 v106, 16, v93
v_and_b32 v107, 0xffff0000, v93
v_pk_add_f32 v[104:105], v[104:105], v[106:107]
v_cvt_pk_bf16_f32 v81, v104, v105
v_lshlrev_b32 v104, 16, v82
v_and_b32 v105, 0xffff0000, v82
v_lshlrev_b32 v106, 16, v90
v_and_b32 v107, 0xffff0000, v90
v_pk_mul_f32 v[104:105], v[104:105], v[106:107]
v_cvt_pk_bf16_f32 v104, v104, v105
v_and_b32 v105, 0xffff0000, v104
v_lshlrev_b32 v104, 16, v104
v_lshlrev_b32 v106, 16, v94
v_and_b32 v107, 0xffff0000, v94
v_pk_add_f32 v[104:105], v[104:105], v[106:107]
v_cvt_pk_bf16_f32 v82, v104, v105
v_lshlrev_b32 v104, 16, v83
v_and_b32 v105, 0xffff0000, v83
v_lshlrev_b32 v106, 16, v91
v_and_b32 v107, 0xffff0000, v91
v_pk_mul_f32 v[104:105], v[104:105], v[106:107]
v_cvt_pk_bf16_f32 v104, v104, v105
v_and_b32 v105, 0xffff0000, v104
v_lshlrev_b32 v104, 16, v104
v_lshlrev_b32 v106, 16, v95
v_and_b32 v107, 0xffff0000, v95
v_pk_add_f32 v[104:105], v[104:105], v[106:107]
v_cvt_pk_bf16_f32 v83, v104, v105
s_add_u32 s12, s12, 32768
s_addc_u32 s13, s13, 0
global_store_dwordx4 v56, v[80:83], s[12:13] offset:0
s_add_u32 s14, s14, 32768
s_addc_u32 s15, s15, 0
s_add_u32 s16, s16, 32768
s_addc_u32 s17, s17, 0
global_load_dwordx4 v[88:91], v56, s[14:15] offset:0 sc1
global_load_dwordx4 v[92:95], v56, s[16:17] offset:0
v_accvgpr_read_b32 v72, a36
v_accvgpr_read_b32 v73, a37
v_accvgpr_read_b32 v74, a38
v_accvgpr_read_b32 v75, a39
v_accvgpr_read_b32 v76, a52
v_accvgpr_read_b32 v77, a53
v_accvgpr_read_b32 v78, a54
v_accvgpr_read_b32 v79, a55
v_cvt_pk_bf16_f32 v84, v72, v73
v_cvt_pk_bf16_f32 v85, v74, v75
v_cvt_pk_bf16_f32 v86, v76, v77
v_cvt_pk_bf16_f32 v87, v78, v79
s_nop 0
v_permlane16_swap_b32 v84, v86
v_permlane16_swap_b32 v85, v87
s_waitcnt vmcnt(3)
v_lshlrev_b32 v104, 16, v84
v_and_b32 v105, 0xffff0000, v84
v_lshlrev_b32 v106, 16, v96
v_and_b32 v107, 0xffff0000, v96
v_pk_mul_f32 v[104:105], v[104:105], v[106:107]
v_cvt_pk_bf16_f32 v104, v104, v105
v_and_b32 v105, 0xffff0000, v104
v_lshlrev_b32 v104, 16, v104
v_lshlrev_b32 v106, 16, v100
v_and_b32 v107, 0xffff0000, v100
v_pk_add_f32 v[104:105], v[104:105], v[106:107]
v_cvt_pk_bf16_f32 v84, v104, v105
v_lshlrev_b32 v104, 16, v85
v_and_b32 v105, 0xffff0000, v85
v_lshlrev_b32 v106, 16, v97
v_and_b32 v107, 0xffff0000, v97
v_pk_mul_f32 v[104:105], v[104:105], v[106:107]
v_cvt_pk_bf16_f32 v104, v104, v105
v_and_b32 v105, 0xffff0000, v104
v_lshlrev_b32 v104, 16, v104
v_lshlrev_b32 v106, 16, v101
v_and_b32 v107, 0xffff0000, v101
v_pk_add_f32 v[104:105], v[104:105], v[106:107]
v_cvt_pk_bf16_f32 v85, v104, v105
v_lshlrev_b32 v104, 16, v86
v_and_b32 v105, 0xffff0000, v86
v_lshlrev_b32 v106, 16, v98
v_and_b32 v107, 0xffff0000, v98
v_pk_mul_f32 v[104:105], v[104:105], v[106:107]
v_cvt_pk_bf16_f32 v104, v104, v105
v_and_b32 v105, 0xffff0000, v104
v_lshlrev_b32 v104, 16, v104
v_lshlrev_b32 v106, 16, v102
v_and_b32 v107, 0xffff0000, v102
v_pk_add_f32 v[104:105], v[104:105], v[106:107]
v_cvt_pk_bf16_f32 v86, v104, v105
v_lshlrev_b32 v104, 16, v87
v_and_b32 v105, 0xffff0000, v87
v_lshlrev_b32 v106, 16, v99
v_and_b32 v107, 0xffff0000, v99
v_pk_mul_f32 v[104:105], v[104:105], v[106:107]
v_cvt_pk_bf16_f32 v104, v104, v105
v_and_b32 v105, 0xffff0000, v104
v_lshlrev_b32 v104, 16, v104
v_lshlrev_b32 v106, 16, v103
v_and_b32 v107, 0xffff0000, v103
v_pk_add_f32 v[104:105], v[104:105], v[106:107]
v_cvt_pk_bf16_f32 v87, v104, v105
global_store_dwordx4 v56, v[84:87], s[12:13] offset:64
global_load_dwordx4 v[96:99], v56, s[14:15] offset:64 sc1
global_load_dwordx4 v[100:103], v56, s[16:17] offset:64
v_accvgpr_read_b32 v64, a8
v_accvgpr_read_b32 v65, a9
v_accvgpr_read_b32 v66, a10
v_accvgpr_read_b32 v67, a11
v_accvgpr_read_b32 v68, a24
v_accvgpr_read_b32 v69, a25
v_accvgpr_read_b32 v70, a26
v_accvgpr_read_b32 v71, a27
v_cvt_pk_bf16_f32 v80, v64, v65
v_cvt_pk_bf16_f32 v81, v66, v67
v_cvt_pk_bf16_f32 v82, v68, v69
v_cvt_pk_bf16_f32 v83, v70, v71
s_nop 0
v_permlane16_swap_b32 v80, v82
v_permlane16_swap_b32 v81, v83
s_waitcnt vmcnt(3)
v_lshlrev_b32 v104, 16, v80
v_and_b32 v105, 0xffff0000, v80
v_lshlrev_b32 v106, 16, v88
v_and_b32 v107, 0xffff0000, v88
v_pk_mul_f32 v[104:105], v[104:105], v[106:107]
v_cvt_pk_bf16_f32 v104, v104, v105
v_and_b32 v105, 0xffff0000, v104
v_lshlrev_b32 v104, 16, v104
v_lshlrev_b32 v106, 16, v92
v_and_b32 v107, 0xffff0000, v92
v_pk_add_f32 v[104:105], v[104:105], v[106:107]
v_cvt_pk_bf16_f32 v80, v104, v105
v_lshlrev_b32 v104, 16, v81
v_and_b32 v105, 0xffff0000, v81
v_lshlrev_b32 v106, 16, v89
v_and_b32 v107, 0xffff0000, v89
v_pk_mul_f32 v[104:105], v[104:105], v[106:107]
v_cvt_pk_bf16_f32 v104, v104, v105
v_and_b32 v105, 0xffff0000, v104
v_lshlrev_b32 v104, 16, v104
v_lshlrev_b32 v106, 16, v93
v_and_b32 v107, 0xffff0000, v93
v_pk_add_f32 v[104:105], v[104:105], v[106:107]
v_cvt_pk_bf16_f32 v81, v104, v105
v_lshlrev_b32 v104, 16, v82
v_and_b32 v105, 0xffff0000, v82
v_lshlrev_b32 v106, 16, v90
v_and_b32 v107, 0xffff0000, v90
v_pk_mul_f32 v[104:105], v[104:105], v[106:107]
v_cvt_pk_bf16_f32 v104, v104, v105
v_and_b32 v105, 0xffff0000, v104
v_lshlrev_b32 v104, 16, v104
v_lshlrev_b32 v106, 16, v94
v_and_b32 v107, 0xffff0000, v94
v_pk_add_f32 v[104:105], v[104:105], v[106:107]
v_cvt_pk_bf16_f32 v82, v104, v105
v_lshlrev_b32 v104, 16, v83
v_and_b32 v105, 0xffff0000, v83
v_lshlrev_b32 v106, 16, v91
v_and_b32 v107, 0xffff0000, v91
v_pk_mul_f32 v[104:105], v[104:105], v[106:107]
v_cvt_pk_bf16_f32 v104, v104, v105
v_and_b32 v105, 0xffff0000, v104
v_lshlrev_b32 v104, 16, v104
v_lshlrev_b32 v106, 16, v95
v_and_b32 v107, 0xffff0000, v95
v_pk_add_f32 v[104:105], v[104:105], v[106:107]
v_cvt_pk_bf16_f32 v83, v104, v105
s_add_u32 s12, s12, 32768
s_addc_u32 s13, s13, 0
global_store_dwordx4 v56, v[80:83], s[12:13] offset:0
s_add_u32 s14, s14, 32768
s_addc_u32 s15, s15, 0
s_add_u32 s16, s16, 32768
s_addc_u32 s17, s17, 0
global_load_dwordx4 v[88:91], v56, s[14:15] offset:0 sc1
global_load_dwordx4 v[92:95], v56, s[16:17] offset:0
v_accvgpr_read_b32 v72, a40
v_accvgpr_read_b32 v73, a41
v_accvgpr_read_b32 v74, a42
v_accvgpr_read_b32 v75, a43
v_accvgpr_read_b32 v76, a56
v_accvgpr_read_b32 v77, a57
v_accvgpr_read_b32 v78, a58
v_accvgpr_read_b32 v79, a59
v_cvt_pk_bf16_f32 v84, v72, v73
v_cvt_pk_bf16_f32 v85, v74, v75
v_cvt_pk_bf16_f32 v86, v76, v77
v_cvt_pk_bf16_f32 v87, v78, v79
s_nop 0
v_permlane16_swap_b32 v84, v86
v_permlane16_swap_b32 v85, v87
s_waitcnt vmcnt(3)
v_lshlrev_b32 v104, 16, v84
v_and_b32 v105, 0xffff0000, v84
v_lshlrev_b32 v106, 16, v96
v_and_b32 v107, 0xffff0000, v96
v_pk_mul_f32 v[104:105], v[104:105], v[106:107]
v_cvt_pk_bf16_f32 v104, v104, v105
v_and_b32 v105, 0xffff0000, v104
v_lshlrev_b32 v104, 16, v104
v_lshlrev_b32 v106, 16, v100
v_and_b32 v107, 0xffff0000, v100
v_pk_add_f32 v[104:105], v[104:105], v[106:107]
v_cvt_pk_bf16_f32 v84, v104, v105
v_lshlrev_b32 v104, 16, v85
v_and_b32 v105, 0xffff0000, v85
v_lshlrev_b32 v106, 16, v97
v_and_b32 v107, 0xffff0000, v97
v_pk_mul_f32 v[104:105], v[104:105], v[106:107]
v_cvt_pk_bf16_f32 v104, v104, v105
v_and_b32 v105, 0xffff0000, v104
v_lshlrev_b32 v104, 16, v104
v_lshlrev_b32 v106, 16, v101
v_and_b32 v107, 0xffff0000, v101
v_pk_add_f32 v[104:105], v[104:105], v[106:107]
v_cvt_pk_bf16_f32 v85, v104, v105
v_lshlrev_b32 v104, 16, v86
v_and_b32 v105, 0xffff0000, v86
v_lshlrev_b32 v106, 16, v98
v_and_b32 v107, 0xffff0000, v98
v_pk_mul_f32 v[104:105], v[104:105], v[106:107]
v_cvt_pk_bf16_f32 v104, v104, v105
v_and_b32 v105, 0xffff0000, v104
v_lshlrev_b32 v104, 16, v104
v_lshlrev_b32 v106, 16, v102
v_and_b32 v107, 0xffff0000, v102
v_pk_add_f32 v[104:105], v[104:105], v[106:107]
v_cvt_pk_bf16_f32 v86, v104, v105
v_lshlrev_b32 v104, 16, v87
v_and_b32 v105, 0xffff0000, v87
v_lshlrev_b32 v106, 16, v99
v_and_b32 v107, 0xffff0000, v99
v_pk_mul_f32 v[104:105], v[104:105], v[106:107]
v_cvt_pk_bf16_f32 v104, v104, v105
v_and_b32 v105, 0xffff0000, v104
v_lshlrev_b32 v104, 16, v104
v_lshlrev_b32 v106, 16, v103
v_and_b32 v107, 0xffff0000, v103
v_pk_add_f32 v[104:105], v[104:105], v[106:107]
v_cvt_pk_bf16_f32 v87, v104, v105
global_store_dwordx4 v56, v[84:87], s[12:13] offset:64
global_load_dwordx4 v[96:99], v56, s[14:15] offset:64 sc1
global_load_dwordx4 v[100:103], v56, s[16:17] offset:64
v_accvgpr_read_b32 v64, a12
v_accvgpr_read_b32 v65, a13
v_accvgpr_read_b32 v66, a14
v_accvgpr_read_b32 v67, a15
v_accvgpr_read_b32 v68, a28
v_accvgpr_read_b32 v69, a29
v_accvgpr_read_b32 v70, a30
v_accvgpr_read_b32 v71, a31
v_cvt_pk_bf16_f32 v80, v64, v65
v_cvt_pk_bf16_f32 v81, v66, v67
v_cvt_pk_bf16_f32 v82, v68, v69
v_cvt_pk_bf16_f32 v83, v70, v71
s_nop 0
v_permlane16_swap_b32 v80, v82
v_permlane16_swap_b32 v81, v83
s_waitcnt vmcnt(3)
v_lshlrev_b32 v104, 16, v80
v_and_b32 v105, 0xffff0000, v80
v_lshlrev_b32 v106, 16, v88
v_and_b32 v107, 0xffff0000, v88
v_pk_mul_f32 v[104:105], v[104:105], v[106:107]
v_cvt_pk_bf16_f32 v104, v104, v105
v_and_b32 v105, 0xffff0000, v104
v_lshlrev_b32 v104, 16, v104
v_lshlrev_b32 v106, 16, v92
v_and_b32 v107, 0xffff0000, v92
v_pk_add_f32 v[104:105], v[104:105], v[106:107]
v_cvt_pk_bf16_f32 v80, v104, v105
v_lshlrev_b32 v104, 16, v81
v_and_b32 v105, 0xffff0000, v81
v_lshlrev_b32 v106, 16, v89
v_and_b32 v107, 0xffff0000, v89
v_pk_mul_f32 v[104:105], v[104:105], v[106:107]
v_cvt_pk_bf16_f32 v104, v104, v105
v_and_b32 v105, 0xffff0000, v104
v_lshlrev_b32 v104, 16, v104
v_lshlrev_b32 v106, 16, v93
v_and_b32 v107, 0xffff0000, v93
v_pk_add_f32 v[104:105], v[104:105], v[106:107]
v_cvt_pk_bf16_f32 v81, v104, v105
v_lshlrev_b32 v104, 16, v82
v_and_b32 v105, 0xffff0000, v82
v_lshlrev_b32 v106, 16, v90
v_and_b32 v107, 0xffff0000, v90
v_pk_mul_f32 v[104:105], v[104:105], v[106:107]
v_cvt_pk_bf16_f32 v104, v104, v105
v_and_b32 v105, 0xffff0000, v104
v_lshlrev_b32 v104, 16, v104
v_lshlrev_b32 v106, 16, v94
v_and_b32 v107, 0xffff0000, v94
v_pk_add_f32 v[104:105], v[104:105], v[106:107]
v_cvt_pk_bf16_f32 v82, v104, v105
v_lshlrev_b32 v104, 16, v83
v_and_b32 v105, 0xffff0000, v83
v_lshlrev_b32 v106, 16, v91
v_and_b32 v107, 0xffff0000, v91
v_pk_mul_f32 v[104:105], v[104:105], v[106:107]
v_cvt_pk_bf16_f32 v104, v104, v105
v_and_b32 v105, 0xffff0000, v104
v_lshlrev_b32 v104, 16, v104
v_lshlrev_b32 v106, 16, v95
v_and_b32 v107, 0xffff0000, v95
v_pk_add_f32 v[104:105], v[104:105], v[106:107]
v_cvt_pk_bf16_f32 v83, v104, v105
s_add_u32 s12, s12, 32768
s_addc_u32 s13, s13, 0
global_store_dwordx4 v56, v[80:83], s[12:13] offset:0
v_accvgpr_read_b32 v72, a44
v_accvgpr_read_b32 v73, a45
v_accvgpr_read_b32 v74, a46
v_accvgpr_read_b32 v75, a47
v_accvgpr_read_b32 v76, a60
v_accvgpr_read_b32 v77, a61
v_accvgpr_read_b32 v78, a62
v_accvgpr_read_b32 v79, a63
v_cvt_pk_bf16_f32 v84, v72, v73
v_cvt_pk_bf16_f32 v85, v74, v75
v_cvt_pk_bf16_f32 v86, v76, v77
v_cvt_pk_bf16_f32 v87, v78, v79
s_nop 0
v_permlane16_swap_b32 v84, v86
v_permlane16_swap_b32 v85, v87
s_waitcnt vmcnt(1)
v_lshlrev_b32 v104, 16, v84
v_and_b32 v105, 0xffff0000, v84
v_lshlrev_b32 v106, 16, v96
v_and_b32 v107, 0xffff0000, v96
v_pk_mul_f32 v[104:105], v[104:105], v[106:107]
v_cvt_pk_bf16_f32 v104, v104, v105
v_and_b32 v105, 0xffff0000, v104
v_lshlrev_b32 v104, 16, v104
v_lshlrev_b32 v106, 16, v100
v_and_b32 v107, 0xffff0000, v100
v_pk_add_f32 v[104:105], v[104:105], v[106:107]
v_cvt_pk_bf16_f32 v84, v104, v105
v_lshlrev_b32 v104, 16, v85
v_and_b32 v105, 0xffff0000, v85
v_lshlrev_b32 v106, 16, v97
v_and_b32 v107, 0xffff0000, v97
v_pk_mul_f32 v[104:105], v[104:105], v[106:107]
v_cvt_pk_bf16_f32 v104, v104, v105
v_and_b32 v105, 0xffff0000, v104
v_lshlrev_b32 v104, 16, v104
v_lshlrev_b32 v106, 16, v101
v_and_b32 v107, 0xffff0000, v101
v_pk_add_f32 v[104:105], v[104:105], v[106:107]
v_cvt_pk_bf16_f32 v85, v104, v105
v_lshlrev_b32 v104, 16, v86
v_and_b32 v105, 0xffff0000, v86
v_lshlrev_b32 v106, 16, v98
v_and_b32 v107, 0xffff0000, v98
v_pk_mul_f32 v[104:105], v[104:105], v[106:107]
v_cvt_pk_bf16_f32 v104, v104, v105
v_and_b32 v105, 0xffff0000, v104
v_lshlrev_b32 v104, 16, v104
v_lshlrev_b32 v106, 16, v102
v_and_b32 v107, 0xffff0000, v102
v_pk_add_f32 v[104:105], v[104:105], v[106:107]
v_cvt_pk_bf16_f32 v86, v104, v105
v_lshlrev_b32 v104, 16, v87
v_and_b32 v105, 0xffff0000, v87
v_lshlrev_b32 v106, 16, v99
v_and_b32 v107, 0xffff0000, v99
v_pk_mul_f32 v[104:105], v[104:105], v[106:107]
v_cvt_pk_bf16_f32 v104, v104, v105
v_and_b32 v105, 0xffff0000, v104
v_lshlrev_b32 v104, 16, v104
v_lshlrev_b32 v106, 16, v103
v_and_b32 v107, 0xffff0000, v103
v_pk_add_f32 v[104:105], v[104:105], v[106:107]
v_cvt_pk_bf16_f32 v87, v104, v105
global_store_dwordx4 v56, v[84:87], s[12:13] offset:64
s_waitcnt vmcnt(0)
s_barrier
s_branch W_loop
M_dist_145:
s_waitcnt vmcnt(0)
s_barrier
v_mov_b32 v44, 163824
s_cmp_lg_u32 s20, 0
s_cbranch_scc1 M_sw_147
s_add_u32 s64, s67, 176160768
v_mov_b32 v42, s64
v_mov_b32 v43, 1
s_mov_b64 exec, 1
global_atomic_add v42, v43, s[40:41]
s_mov_b64 exec, -1
M_sw_147:
s_cmp_lg_u32 s20, 0
s_cbranch_scc1 M_wwd_149
s_add_u32 s64, s67, 176160768
v_mov_b32 v42, s64
s_mov_b32 s65, 0
s_mov_b64 exec, 1
M_ww_148:
global_load_dword v43, v42, s[40:41] sc1
s_waitcnt vmcnt(0)
v_readfirstlane_b32 s64, v43
s_cmp_ge_u32 s64, 4
s_cbranch_scc1 M_wwd_149_x
s_sleep 2
s_add_u32 s65, s65, 1
s_cmp_lt_u32 s65, 400000
s_cbranch_scc1 M_ww_148
s_mov_b64 exec, -1
s_branch M_exit0
M_wwd_149_x:
s_mov_b64 exec, -1
M_wwd_149:
s_barrier
s_lshr_b32 s66, s62, 0
s_lshl_b32 s64, s66, 10
v_add_u32 v56, s64, v56
v_add_u32 v57, 0, v56
global_load_dwordx4 v[128:131], v57, s[14:15] sc1
v_add_u32 v57, 65536, v56
global_load_dwordx4 v[132:135], v57, s[14:15] sc1
v_add_u32 v57, 131072, v56
global_load_dwordx4 v[136:139], v57, s[14:15] sc1
v_add_u32 v57, 196608, v56
global_load_dwordx4 v[140:143], v57, s[14:15] sc1
v_add_u32 v57, 4096, v56
global_load_dwordx4 v[144:147], v57, s[14:15] sc1
v_add_u32 v57, 69632, v56
global_load_dwordx4 v[148:151], v57, s[14:15] sc1
v_add_u32 v57, 135168, v56
global_load_dwordx4 v[152:155], v57, s[14:15] sc1
v_add_u32 v57, 200704, v56
global_load_dwordx4 v[156:159], v57, s[14:15] sc1
v_add_u32 v57, 8192, v56
global_load_dwordx4 v[160:163], v57, s[14:15] sc1
v_add_u32 v57, 73728, v56
global_load_dwordx4 v[164:167], v57, s[14:15] sc1
v_add_u32 v57, 139264, v56
global_load_dwordx4 v[168:171], v57, s[14:15] sc1
v_add_u32 v57, 204800, v56
global_load_dwordx4 v[172:175], v57, s[14:15] sc1
v_add_u32 v57, 12288, v56
global_load_dwordx4 v[176:179], v57, s[14:15] sc1
v_add_u32 v57, 77824, v56
global_load_dwordx4 v[180:183], v57, s[14:15] sc1
v_add_u32 v57, 143360, v56
global_load_dwordx4 v[184:187], v57, s[14:15] sc1
v_add_u32 v57, 208896, v56
global_load_dwordx4 v[188:191], v57, s[14:15] sc1
s_waitcnt vmcnt(0)
v_pk_add_f32 v[128:129], v[128:129], v[132:133]
v_pk_add_f32 v[130:131], v[130:131], v[134:135]
v_pk_add_f32 v[136:137], v[136:137], v[140:141]
v_pk_add_f32 v[138:139], v[138:139], v[142:143]
v_pk_add_f32 v[128:129], v[128:129], v[136:137]
v_pk_add_f32 v[130:131], v[130:131], v[138:139]
v_accvgpr_write_b32 a0, v128
v_accvgpr_write_b32 a1, v129
v_accvgpr_write_b32 a2, v130
v_accvgpr_write_b32 a3, v131
v_pk_add_f32 v[144:145], v[144:145], v[148:149]
v_pk_add_f32 v[146:147], v[146:147], v[150:151]
v_pk_add_f32 v[152:153], v[152:153], v[156:157]
v_pk_add_f32 v[154:155], v[154:155], v[158:159]
v_pk_add_f32 v[144:145], v[144:145], v[152:153]
v_pk_add_f32 v[146:147], v[146:147], v[154:155]
v_accvgpr_write_b32 a4, v144
v_accvgpr_write_b32 a5, v145
v_accvgpr_write_b32 a6, v146
v_accvgpr_write_b32 a7, v147
v_pk_add_f32 v[160:161], v[160:161], v[164:165]
v_pk_add_f32 v[162:163], v[162:163], v[166:167]
v_pk_add_f32 v[168:169], v[168:169], v[172:173]
v_pk_add_f32 v[170:171], v[170:171], v[174:175]
v_pk_add_f32 v[160:161], v[160:161], v[168:169]
v_pk_add_f32 v[162:163], v[162:163], v[170:171]
v_accvgpr_write_b32 a8, v160
v_accvgpr_write_b32 a9, v161
v_accvgpr_write_b32 a10, v162
v_accvgpr_write_b32 a11, v163
v_pk_add_f32 v[176:177], v[176:177], v[180:181]
v_pk_add_f32 v[178:179], v[178:179], v[182:183]
v_pk_add_f32 v[184:185], v[184:185], v[188:189]
v_pk_add_f32 v[186:187], v[186:187], v[190:191]
v_pk_add_f32 v[176:177], v[176:177], v[184:185]
v_pk_add_f32 v[178:179], v[178:179], v[186:187]
v_accvgpr_write_b32 a12, v176
v_accvgpr_write_b32 a13, v177
v_accvgpr_write_b32 a14, v178
v_accvgpr_write_b32 a15, v179
s_lshl_b32 s64, s61, 17
s_lshl_b32 s65, s66, 15
s_add_u32 s64, s64, s65
s_lshl_b32 s65, s58, 9
s_add_u32 s64, s64, s65
s_add_u32 s12, s74, s64
s_addc_u32 s13, s75, 0
s_add_u32 s16, s72, s64
s_addc_u32 s17, s73, 0
s_add_u32 s64, s64, 75497472
s_add_u32 s14, s40, s64
s_addc_u32 s15, s41, 0
v_and_b32 v42, 15, v1
v_lshrrev_b32 v43, 4, v1
v_and_b32 v44, 1, v43
v_lshlrev_b32 v44, 1, v44
v_lshrrev_b32 v45, 1, v43
v_add_u32 v44, v44, v45
s_mov_b32 s21, 0
s_mov_b32 s22, s20
s_mul_i32 s21, s21, 32768
s_mul_i32 s22, s22, 128
s_add_u32 s21, s21, s22
v_mul_u32_u24 v45, 2048, v42
v_lshl_add_u32 v45, v44, 4, v45
v_add_u32 v56, s21, v45
global_load_dwordx4 v[88:91], v56, s[14:15] offset:0 sc1
global_load_dwordx4 v[92:95], v56, s[16:17] offset:0
global_load_dwordx4 v[96:99], v56, s[14:15] offset:64 sc1
global_load_dwordx4 v[100:103], v56, s[16:17] offset:64
v_accvgpr_read_b32 v64, a0
v_accvgpr_read_b32 v65, a1
v_accvgpr_read_b32 v66, a2
v_accvgpr_read_b32 v67, a3
v_accvgpr_read_b32 v68, a4
v_accvgpr_read_b32 v69, a5
v_accvgpr_read_b32 v70, a6
v_accvgpr_read_b32 v71, a7
v_cvt_pk_bf16_f32 v80, v64, v65
v_cvt_pk_bf16_f32 v81, v66, v67
v_cvt_pk_bf16_f32 v82, v68, v69
v_cvt_pk_bf16_f32 v83, v70, v71
s_nop 0
v_permlane16_swap_b32 v80, v82
v_permlane16_swap_b32 v81, v83
s_waitcnt vmcnt(2)
v_lshlrev_b32 v104, 16, v80
v_and_b32 v105, 0xffff0000, v80
v_lshlrev_b32 v106, 16, v88
v_and_b32 v107, 0xffff0000, v88
v_pk_mul_f32 v[104:105], v[104:105], v[106:107]
v_cvt_pk_bf16_f32 v104, v104, v105
v_and_b32 v105, 0xffff0000, v104
v_lshlrev_b32 v104, 16, v104
v_lshlrev_b32 v106, 16, v92
v_and_b32 v107, 0xffff0000, v92
v_pk_add_f32 v[104:105], v[104:105], v[106:107]
v_cvt_pk_bf16_f32 v80, v104, v105
v_lshlrev_b32 v104, 16, v81
v_and_b32 v105, 0xffff0000, v81
v_lshlrev_b32 v106, 16, v89
v_and_b32 v107, 0xffff0000, v89
v_pk_mul_f32 v[104:105], v[104:105], v[106:107]
v_cvt_pk_bf16_f32 v104, v104, v105
v_and_b32 v105, 0xffff0000, v104
v_lshlrev_b32 v104, 16, v104
v_lshlrev_b32 v106, 16, v93
v_and_b32 v107, 0xffff0000, v93
v_pk_add_f32 v[104:105], v[104:105], v[106:107]
v_cvt_pk_bf16_f32 v81, v104, v105
v_lshlrev_b32 v104, 16, v82
v_and_b32 v105, 0xffff0000, v82
v_lshlrev_b32 v106, 16, v90
v_and_b32 v107, 0xffff0000, v90
v_pk_mul_f32 v[104:105], v[104:105], v[106:107]
v_cvt_pk_bf16_f32 v104, v104, v105
v_and_b32 v105, 0xffff0000, v104
v_lshlrev_b32 v104, 16, v104
v_lshlrev_b32 v106, 16, v94
v_and_b32 v107, 0xffff0000, v94
v_pk_add_f32 v[104:105], v[104:105], v[106:107]
v_cvt_pk_bf16_f32 v82, v104, v105
v_lshlrev_b32 v104, 16, v83
v_and_b32 v105, 0xffff0000, v83
v_lshlrev_b32 v106, 16, v91
v_and_b32 v107, 0xffff0000, v91
v_pk_mul_f32 v[104:105], v[104:105], v[106:107]
v_cvt_pk_bf16_f32 v104, v104, v105
v_and_b32 v105, 0xffff0000, v104
v_lshlrev_b32 v104, 16, v104
v_lshlrev_b32 v106, 16, v95
v_and_b32 v107, 0xffff0000, v95
v_pk_add_f32 v[104:105], v[104:105], v[106:107]
v_cvt_pk_bf16_f32 v83, v104, v105
global_store_dwordx4 v56, v[80:83], s[12:13] offset:0
v_accvgpr_read_b32 v72, a8
v_accvgpr_read_b32 v73, a9
v_accvgpr_read_b32 v74, a10
v_accvgpr_read_b32 v75, a11
v_accvgpr_read_b32 v76, a12
v_accvgpr_read_b32 v77, a13
v_accvgpr_read_b32 v78, a14
v_accvgpr_read_b32 v79, a15
v_cvt_pk_bf16_f32 v84, v72, v73
v_cvt_pk_bf16_f32 v85, v74, v75
v_cvt_pk_bf16_f32 v86, v76, v77
v_cvt_pk_bf16_f32 v87, v78, v79
s_nop 0
v_permlane16_swap_b32 v84, v86
v_permlane16_swap_b32 v85, v87
s_waitcnt vmcnt(1)
v_lshlrev_b32 v104, 16, v84
v_and_b32 v105, 0xffff0000, v84
v_lshlrev_b32 v106, 16, v96
v_and_b32 v107, 0xffff0000, v96
v_pk_mul_f32 v[104:105], v[104:105], v[106:107]
v_cvt_pk_bf16_f32 v104, v104, v105
v_and_b32 v105, 0xffff0000, v104
v_lshlrev_b32 v104, 16, v104
v_lshlrev_b32 v106, 16, v100
v_and_b32 v107, 0xffff0000, v100
v_pk_add_f32 v[104:105], v[104:105], v[106:107]
v_cvt_pk_bf16_f32 v84, v104, v105
v_lshlrev_b32 v104, 16, v85
v_and_b32 v105, 0xffff0000, v85
v_lshlrev_b32 v106, 16, v97
v_and_b32 v107, 0xffff0000, v97
v_pk_mul_f32 v[104:105], v[104:105], v[106:107]
v_cvt_pk_bf16_f32 v104, v104, v105
v_and_b32 v105, 0xffff0000, v104
v_lshlrev_b32 v104, 16, v104
v_lshlrev_b32 v106, 16, v101
v_and_b32 v107, 0xffff0000, v101
v_pk_add_f32 v[104:105], v[104:105], v[106:107]
v_cvt_pk_bf16_f32 v85, v104, v105
v_lshlrev_b32 v104, 16, v86
v_and_b32 v105, 0xffff0000, v86
v_lshlrev_b32 v106, 16, v98
v_and_b32 v107, 0xffff0000, v98
v_pk_mul_f32 v[104:105], v[104:105], v[106:107]
v_cvt_pk_bf16_f32 v104, v104, v105
v_and_b32 v105, 0xffff0000, v104
v_lshlrev_b32 v104, 16, v104
v_lshlrev_b32 v106, 16, v102
v_and_b32 v107, 0xffff0000, v102
v_pk_add_f32 v[104:105], v[104:105], v[106:107]
v_cvt_pk_bf16_f32 v86, v104, v105
v_lshlrev_b32 v104, 16, v87
v_and_b32 v105, 0xffff0000, v87
v_lshlrev_b32 v106, 16, v99
v_and_b32 v107, 0xffff0000, v99
v_pk_mul_f32 v[104:105], v[104:105], v[106:107]
v_cvt_pk_bf16_f32 v104, v104, v105
v_and_b32 v105, 0xffff0000, v104
v_lshlrev_b32 v104, 16, v104
v_lshlrev_b32 v106, 16, v103
v_and_b32 v107, 0xffff0000, v103
v_pk_add_f32 v[104:105], v[104:105], v[106:107]
v_cvt_pk_bf16_f32 v87, v104, v105
global_store_dwordx4 v56, v[84:87], s[12:13] offset:64
s_waitcnt vmcnt(0)
s_barrier
s_branch W_loop
W_opp8:
s_lshl_b32 s66, s61, 4
s_lshr_b32 s67, s62, 1
s_lshl_b32 s67, s67, 2
s_add_u32 s66, s66, s67
s_lshl_b32 s64, s61, 12
s_lshl_b32 s65, s62, 21
s_add_u32 s64, s64, s65
s_add_u32 s64, s64, 83886080
s_add_u32 s4, s40, s64
s_addc_u32 s5, s41, 0
s_lshl_b32 s64, s58, 9
s_lshl_b32 s65, s62, 20
s_add_u32 s64, s64, s65
s_add_u32 s6, s70, s64
s_addc_u32 s7, s71, 0
s_mov_b32 s8, 131072
s_mov_b32 s31, 2048
s_mov_b32 s9, 65536
s_mov_b32 s10, 16
s_lshr_b32 s63, s61, 2
s_mul_i32 s21, s20, 1024
v_lshlrev_b32 v42, 4, v1
v_add_u32 v2, s21, v42
v_lshrrev_b32 v42, 5, v1
s_lshl_b32 s21, s20, 3
v_add_u32 v43, s21, v42
v_mul_lo_u32 v43, v43, s31
v_and_b32 v44, 31, v1
s_and_b32 s21, s20, 1
s_lshl_b32 s21, s21, 3
v_lshl_add_u32 v42, v42, 1, s21
v_xor_b32 v45, v44, v42
v_xor_b32 v46, 4, v45
v_lshl_add_u32 v45, v45, 4, v43
v_lshl_add_u32 v46, v46, 4, v43
s_lshl_b32 s22, s31, 1
s_mov_b32 s21, 0
v_add_u32 v6, s21, v45
s_add_u32 s21, s21, s22
v_add_u32 v7, s21, v46
s_add_u32 s21, s21, s22
v_add_u32 v8, s21, v45
s_add_u32 s21, s21, s22
v_add_u32 v9, s21, v46
s_mul_i32 s29, s20, 1024
s_add_u32 m0, s26, 0
s_nop 0
global_load_lds_dwordx4 v6, s[6:7]
s_add_u32 m0, s26, 1024
s_nop 0
global_load_lds_dwordx4 v7, s[6:7]
s_add_u32 m0, s26, 2048
s_nop 0
global_load_lds_dwordx4 v8, s[6:7]
s_add_u32 m0, s26, 3072
s_nop 0
global_load_lds_dwordx4 v9, s[6:7]
s_add_u32 s6, s6, s9
s_addc_u32 s7, s7, 0
s_add_u32 m0, s26, 32768
s_nop 0
global_load_lds_dwordx4 v6, s[6:7]
s_add_u32 m0, s26, 33792
s_nop 0
global_load_lds_dwordx4 v7, s[6:7]
s_add_u32 m0, s26, 34816
s_nop 0
global_load_lds_dwordx4 v8, s[6:7]
s_add_u32 m0, s26, 35840
s_nop 0
global_load_lds_dwordx4 v9, s[6:7]
s_add_u32 s6, s6, s9
s_addc_u32 s7, s7, 0
s_add_u32 m0, s26, 65536
s_nop 0
global_load_lds_dwordx4 v6, s[6:7]
s_add_u32 m0, s26, 66560
s_nop 0
global_load_lds_dwordx4 v7, s[6:7]
s_add_u32 m0, s26, 67584
s_nop 0
global_load_lds_dwordx4 v8, s[6:7]
s_add_u32 m0, s26, 68608
s_nop 0
global_load_lds_dwordx4 v9, s[6:7]
s_add_u32 s6, s6, s9
s_addc_u32 s7, s7, 0
s_add_u32 m0, s26, 98304
s_nop 0
global_load_lds_dwordx4 v6, s[6:7]
s_add_u32 m0, s26, 99328
s_nop 0
global_load_lds_dwordx4 v7, s[6:7]
s_add_u32 m0, s26, 100352
s_nop 0
global_load_lds_dwordx4 v8, s[6:7]
s_add_u32 m0, s26, 101376
s_nop 0
global_load_lds_dwordx4 v9, s[6:7]
s_add_u32 s6, s6, s9
s_addc_u32 s7, s7, 0
s_cmp_lg_u32 s20, 0
s_cbranch_scc1 M_wcd_151
s_lshl_b32 s64, s63, 2
s_add_u32 s64, s64, 192
v_mov_b32 v42, s64
s_mov_b32 s65, 0
s_mov_b64 exec, 1
M_wc_150:
global_load_dword v43, v42, s[56:57] sc1
s_waitcnt vmcnt(0)
v_readfirstlane_b32 s64, v43
s_cmp_ge_u32 s64, 8
s_cbranch_scc1 M_wcd_151_x
s_sleep 32
s_add_u32 s65, s65, 1
s_cmp_lt_u32 s65, 400000
s_cbranch_scc1 M_wc_150
s_mov_b64 exec, -1
s_branch M_exit0
M_wcd_151_x:
s_mov_b64 exec, -1
M_wcd_151:
s_barrier
s_cmp_eq_u32 s92, 1
s_cbranch_scc1 M_cs_152
s_cmp_lg_u32 s20, 0
s_cbranch_scc1 M_wcd_154
s_lshl_b32 s64, s58, 2
s_add_u32 s64, s64, 224
v_mov_b32 v42, s64
s_mov_b32 s65, 0
s_mov_b64 exec, 1
M_wc_153:
global_load_dword v43, v42, s[56:57] sc1
s_waitcnt vmcnt(0)
v_readfirstlane_b32 s64, v43
s_cmp_ge_u32 s64, 32
s_cbranch_scc1 M_wcd_154_x
s_sleep 32
s_add_u32 s65, s65, 1
s_cmp_lt_u32 s65, 400000
s_cbranch_scc1 M_wc_153
s_mov_b64 exec, -1
s_branch M_exit0
M_wcd_154_x:
s_mov_b64 exec, -1
M_wcd_154:
s_barrier
s_mov_b32 s92, 1
M_cs_152:
s_cmp_lg_u32 s20, 0
s_cbranch_scc1 M_wwd_156
s_add_u32 s64, s66, 176160768
v_mov_b32 v42, s64
s_mov_b32 s65, 0
s_mov_b64 exec, 1
M_ww_155:
global_load_dword v43, v42, s[40:41] sc1
s_waitcnt vmcnt(0)
v_readfirstlane_b32 s64, v43
s_cmp_ge_u32 s64, 4
s_cbranch_scc1 M_wwd_156_x
s_sleep 4
s_add_u32 s65, s65, 1
s_cmp_lt_u32 s65, 400000
s_cbranch_scc1 M_ww_155
s_mov_b64 exec, -1
s_branch M_exit0
M_wwd_156_x:
s_mov_b64 exec, -1
M_wwd_156:
s_barrier
s_add_u32 m0, s29, 0
s_nop 0
global_load_lds_dwordx4 v2, s[4:5] sc1
s_add_u32 s4, s4, s8
s_addc_u32 s5, s5, 0
s_add_u32 m0, s29, 32768
s_nop 0
global_load_lds_dwordx4 v2, s[4:5] sc1
s_add_u32 s4, s4, s8
s_addc_u32 s5, s5, 0
s_add_u32 m0, s29, 65536
s_nop 0
global_load_lds_dwordx4 v2, s[4:5] sc1
s_add_u32 s4, s4, s8
s_addc_u32 s5, s5, 0
s_add_u32 m0, s29, 98304
s_nop 0
global_load_lds_dwordx4 v2, s[4:5] sc1
s_add_u32 s4, s4, s8
s_addc_u32 s5, s5, 0
s_call_b64 s[94:95], W_sub_smalln2
s_sub_u32 s64, s61, 20
s_lshl_b32 s64, s64, 2
s_add_u32 s64, s64, s58
s_lshl_b32 s64, s64, 19
s_add_u32 s64, s64, 184549376
s_add_u32 s14, s40, s64
s_addc_u32 s15, s41, 0
s_lshl_b32 s64, s20, 14
v_lshlrev_b32 v56, 4, v1
v_add_u32 v56, s64, v56
s_lshl_b32 s64, s62, 16
v_add_u32 v57, s64, v56
global_store_dwordx4 v57, a[0:3], s[14:15] offset:0 sc1
global_store_dwordx4 v57, a[4:7], s[14:15] offset:1024 sc1
global_store_dwordx4 v57, a[8:11], s[14:15] offset:2048 sc1
global_store_dwordx4 v57, a[12:15], s[14:15] offset:3072 sc1
v_add_u32 v57, 4096, v57
global_store_dwordx4 v57, a[16:19], s[14:15] offset:0 sc1
global_store_dwordx4 v57, a[20:23], s[14:15] offset:1024 sc1
global_store_dwordx4 v57, a[24:27], s[14:15] offset:2048 sc1
global_store_dwordx4 v57, a[28:31], s[14:15] offset:3072 sc1
v_add_u32 v57, 4096, v57
global_store_dwordx4 v57, a[32:35], s[14:15] offset:0 sc1
global_store_dwordx4 v57, a[36:39], s[14:15] offset:1024 sc1
global_store_dwordx4 v57, a[40:43], s[14:15] offset:2048 sc1
global_store_dwordx4 v57, a[44:47], s[14:15] offset:3072 sc1
v_add_u32 v57, 4096, v57
global_store_dwordx4 v57, a[48:51], s[14:15] offset:0 sc1
global_store_dwordx4 v57, a[52:55], s[14:15] offset:1024 sc1
global_store_dwordx4 v57, a[56:59], s[14:15] offset:2048 sc1
global_store_dwordx4 v57, a[60:63], s[14:15] offset:3072 sc1
s_lshl_b32 s67, s61, 4
s_lshl_b32 s66, s58, 2
s_add_u32 s67, s67, s66
s_add_u32 s67, s67, 512
s_waitcnt vmcnt(0)
s_barrier
v_mov_b32 v44, 163824
s_cmp_lg_u32 s20, 0
s_cbranch_scc1 M_sw_157
s_add_u32 s64, s67, 176160768
v_mov_b32 v42, s64
v_mov_b32 v43, 1
s_mov_b64 exec, 1
global_atomic_add v42, v43, s[40:41]
s_mov_b64 exec, -1
M_sw_157:
s_cmp_lg_u32 s20, 0
s_cbranch_scc1 M_wwd_159
s_add_u32 s64, s67, 176160768
v_mov_b32 v42, s64
s_mov_b32 s65, 0
s_mov_b64 exec, 1
M_ww_158:
global_load_dword v43, v42, s[40:41] sc1
s_waitcnt vmcnt(0)
v_readfirstlane_b32 s64, v43
s_cmp_ge_u32 s64, 8
s_cbranch_scc1 M_wwd_159_x
s_sleep 2
s_add_u32 s65, s65, 1
s_cmp_lt_u32 s65, 400000
s_cbranch_scc1 M_ww_158
s_mov_b64 exec, -1
s_branch M_exit0
M_wwd_159_x:
s_mov_b64 exec, -1
M_wwd_159:
s_barrier
s_lshr_b32 s66, s62, 1
s_lshl_b32 s64, s66, 10
s_and_b32 s65, s62, 1
s_lshl_b32 s65, s65, 13
s_add_u32 s64, s64, s65
v_add_u32 v56, s64, v56
v_add_u32 v57, 0, v56
global_load_dwordx4 v[128:131], v57, s[14:15] sc1
v_add_u32 v57, 65536, v56
global_load_dwordx4 v[132:135], v57, s[14:15] sc1
v_add_u32 v57, 131072, v56
global_load_dwordx4 v[136:139], v57, s[14:15] sc1
v_add_u32 v57, 196608, v56
global_load_dwordx4 v[140:143], v57, s[14:15] sc1
v_add_u32 v57, 262144, v56
global_load_dwordx4 v[144:147], v57, s[14:15] sc1
v_add_u32 v57, 327680, v56
global_load_dwordx4 v[148:151], v57, s[14:15] sc1
v_add_u32 v57, 393216, v56
global_load_dwordx4 v[152:155], v57, s[14:15] sc1
v_add_u32 v57, 458752, v56
global_load_dwordx4 v[156:159], v57, s[14:15] sc1
v_add_u32 v57, 4096, v56
global_load_dwordx4 v[160:163], v57, s[14:15] sc1
v_add_u32 v57, 69632, v56
global_load_dwordx4 v[164:167], v57, s[14:15] sc1
v_add_u32 v57, 135168, v56
global_load_dwordx4 v[168:171], v57, s[14:15] sc1
v_add_u32 v57, 200704, v56
global_load_dwordx4 v[172:175], v57, s[14:15] sc1
v_add_u32 v57, 266240, v56
global_load_dwordx4 v[176:179], v57, s[14:15] sc1
v_add_u32 v57, 331776, v56
global_load_dwordx4 v[180:183], v57, s[14:15] sc1
v_add_u32 v57, 397312, v56
global_load_dwordx4 v[184:187], v57, s[14:15] sc1
v_add_u32 v57, 462848, v56
global_load_dwordx4 v[188:191], v57, s[14:15] sc1
s_waitcnt vmcnt(0)
v_pk_add_f32 v[128:129], v[128:129], v[132:133]
v_pk_add_f32 v[130:131], v[130:131], v[134:135]
v_pk_add_f32 v[136:137], v[136:137], v[140:141]
v_pk_add_f32 v[138:139], v[138:139], v[142:143]
v_pk_add_f32 v[144:145], v[144:145], v[148:149]
v_pk_add_f32 v[146:147], v[146:147], v[150:151]
v_pk_add_f32 v[152:153], v[152:153], v[156:157]
v_pk_add_f32 v[154:155], v[154:155], v[158:159]
v_pk_add_f32 v[128:129], v[128:129], v[136:137]
v_pk_add_f32 v[130:131], v[130:131], v[138:139]
v_pk_add_f32 v[144:145], v[144:145], v[152:153]
v_pk_add_f32 v[146:147], v[146:147], v[154:155]
v_pk_add_f32 v[128:129], v[128:129], v[144:145]
v_pk_add_f32 v[130:131], v[130:131], v[146:147]
v_accvgpr_write_b32 a0, v128
v_accvgpr_write_b32 a1, v129
v_accvgpr_write_b32 a2, v130
v_accvgpr_write_b32 a3, v131
v_pk_add_f32 v[160:161], v[160:161], v[164:165]
v_pk_add_f32 v[162:163], v[162:163], v[166:167]
v_pk_add_f32 v[168:169], v[168:169], v[172:173]
v_pk_add_f32 v[170:171], v[170:171], v[174:175]
v_pk_add_f32 v[176:177], v[176:177], v[180:181]
v_pk_add_f32 v[178:179], v[178:179], v[182:183]
v_pk_add_f32 v[184:185], v[184:185], v[188:189]
v_pk_add_f32 v[186:187], v[186:187], v[190:191]
v_pk_add_f32 v[160:161], v[160:161], v[168:169]
v_pk_add_f32 v[162:163], v[162:163], v[170:171]
v_pk_add_f32 v[176:177], v[176:177], v[184:185]
v_pk_add_f32 v[178:179], v[178:179], v[186:187]
v_pk_add_f32 v[160:161], v[160:161], v[176:177]
v_pk_add_f32 v[162:163], v[162:163], v[178:179]
v_accvgpr_write_b32 a4, v160
v_accvgpr_write_b32 a5, v161
v_accvgpr_write_b32 a6, v162
v_accvgpr_write_b32 a7, v163
s_lshl_b32 s64, s61, 17
s_lshl_b32 s65, s66, 15
s_add_u32 s64, s64, s65
s_lshl_b32 s65, s58, 9
s_add_u32 s64, s64, s65
s_and_b32 s65, s62, 1
s_lshl_b32 s65, s65, 6
s_add_u32 s64, s64, s65
s_add_u32 s12, s74, s64
s_addc_u32 s13, s75, 0
s_add_u32 s16, s72, s64
s_addc_u32 s17, s73, 0
s_add_u32 s64, s64, 75497472
s_add_u32 s14, s40, s64
s_addc_u32 s15, s41, 0
v_and_b32 v42, 15, v1
v_lshrrev_b32 v43, 4, v1
v_and_b32 v44, 1, v43
v_lshlrev_b32 v44, 1, v44
v_lshrrev_b32 v45, 1, v43
v_add_u32 v44, v44, v45
s_mov_b32 s21, 0
s_mov_b32 s22, s20
s_mul_i32 s21, s21, 32768
s_mul_i32 s22, s22, 128
s_add_u32 s21, s21, s22
v_mul_u32_u24 v45, 2048, v42
v_lshl_add_u32 v45, v44, 4, v45
v_add_u32 v56, s21, v45
global_load_dwordx4 v[88:91], v56, s[14:15] offset:0 sc1
global_load_dwordx4 v[92:95], v56, s[16:17] offset:0
v_accvgpr_read_b32 v64, a0
v_accvgpr_read_b32 v65, a1
v_accvgpr_read_b32 v66, a2
v_accvgpr_read_b32 v67, a3
v_accvgpr_read_b32 v68, a4
v_accvgpr_read_b32 v69, a5
v_accvgpr_read_b32 v70, a6
v_accvgpr_read_b32 v71, a7
v_cvt_pk_bf16_f32 v80, v64, v65
v_cvt_pk_bf16_f32 v81, v66, v67
v_cvt_pk_bf16_f32 v82, v68, v69
v_cvt_pk_bf16_f32 v83, v70, v71
s_nop 0
v_permlane16_swap_b32 v80, v82
v_permlane16_swap_b32 v81, v83
s_waitcnt vmcnt(0)
v_lshlrev_b32 v104, 16, v80
v_and_b32 v105, 0xffff0000, v80
v_lshlrev_b32 v106, 16, v88
v_and_b32 v107, 0xffff0000, v88
v_pk_mul_f32 v[104:105], v[104:105], v[106:107]
v_cvt_pk_bf16_f32 v104, v104, v105
v_and_b32 v105, 0xffff0000, v104
v_lshlrev_b32 v104, 16, v104
v_lshlrev_b32 v106, 16, v92
v_and_b32 v107, 0xffff0000, v92
v_pk_add_f32 v[104:105], v[104:105], v[106:107]
v_cvt_pk_bf16_f32 v80, v104, v105
v_lshlrev_b32 v104, 16, v81
v_and_b32 v105, 0xffff0000, v81
v_lshlrev_b32 v106, 16, v89
v_and_b32 v107, 0xffff0000, v89
v_pk_mul_f32 v[104:105], v[104:105], v[106:107]
v_cvt_pk_bf16_f32 v104, v104, v105
v_and_b32 v105, 0xffff0000, v104
v_lshlrev_b32 v104, 16, v104
v_lshlrev_b32 v106, 16, v93
v_and_b32 v107, 0xffff0000, v93
v_pk_add_f32 v[104:105], v[104:105], v[106:107]
v_cvt_pk_bf16_f32 v81, v104, v105
v_lshlrev_b32 v104, 16, v82
v_and_b32 v105, 0xffff0000, v82
v_lshlrev_b32 v106, 16, v90
v_and_b32 v107, 0xffff0000, v90
v_pk_mul_f32 v[104:105], v[104:105], v[106:107]
v_cvt_pk_bf16_f32 v104, v104, v105
v_and_b32 v105, 0xffff0000, v104
v_lshlrev_b32 v104, 16, v104
v_lshlrev_b32 v106, 16, v94
v_and_b32 v107, 0xffff0000, v94
v_pk_add_f32 v[104:105], v[104:105], v[106:107]
v_cvt_pk_bf16_f32 v82, v104, v105
v_lshlrev_b32 v104, 16, v83
v_and_b32 v105, 0xffff0000, v83
v_lshlrev_b32 v106, 16, v91
v_and_b32 v107, 0xffff0000, v91
v_pk_mul_f32 v[104:105], v[104:105], v[106:107]
v_cvt_pk_bf16_f32 v104, v104, v105
v_and_b32 v105, 0xffff0000, v104
v_lshlrev_b32 v104, 16, v104
v_lshlrev_b32 v106, 16, v95
v_and_b32 v107, 0xffff0000, v95
v_pk_add_f32 v[104:105], v[104:105], v[106:107]
v_cvt_pk_bf16_f32 v83, v104, v105
global_store_dwordx4 v56, v[80:83], s[12:13] offset:0
s_waitcnt vmcnt(0)
s_barrier
s_branch W_loop
W_sub_smalln:
s_mul_i32 s21, s20, 1024
v_lshlrev_b32 v42, 4, v1
v_add_u32 v2, s21, v42
v_lshrrev_b32 v42, 5, v1
s_lshl_b32 s21, s20, 3
v_add_u32 v43, s21, v42
v_mul_lo_u32 v43, v43, s31
v_and_b32 v44, 31, v1
s_and_b32 s21, s20, 1
s_lshl_b32 s21, s21, 3
v_lshl_add_u32 v42, v42, 1, s21
v_xor_b32 v45, v44, v42
v_xor_b32 v46, 4, v45
v_lshl_add_u32 v45, v45, 4, v43
v_lshl_add_u32 v46, v46, 4, v43
s_lshl_b32 s22, s31, 1
s_mov_b32 s21, 0
v_add_u32 v6, s21, v45
s_add_u32 s21, s21, s22
v_add_u32 v7, s21, v46
s_add_u32 s21, s21, s22
v_add_u32 v8, s21, v45
s_add_u32 s21, s21, s22
v_add_u32 v9, s21, v46
s_mul_i32 s29, s20, 1024
s_add_u32 m0, s29, 0
s_nop 0
global_load_lds_dwordx4 v2, s[4:5] sc1
s_add_u32 m0, s26, 0
s_nop 0
global_load_lds_dwordx4 v6, s[6:7]
s_add_u32 m0, s26, 1024
s_nop 0
global_load_lds_dwordx4 v7, s[6:7]
s_add_u32 m0, s26, 2048
s_nop 0
global_load_lds_dwordx4 v8, s[6:7]
s_add_u32 m0, s26, 3072
s_nop 0
global_load_lds_dwordx4 v9, s[6:7]
s_add_u32 s4, s4, s8
s_addc_u32 s5, s5, 0
s_add_u32 s6, s6, s9
s_addc_u32 s7, s7, 0
s_add_u32 m0, s29, 32768
s_nop 0
global_load_lds_dwordx4 v2, s[4:5] sc1
s_add_u32 m0, s26, 32768
s_nop 0
global_load_lds_dwordx4 v6, s[6:7]
s_add_u32 m0, s26, 33792
s_nop 0
global_load_lds_dwordx4 v7, s[6:7]
s_add_u32 m0, s26, 34816
s_nop 0
global_load_lds_dwordx4 v8, s[6:7]
s_add_u32 m0, s26, 35840
s_nop 0
global_load_lds_dwordx4 v9, s[6:7]
s_add_u32 s4, s4, s8
s_addc_u32 s5, s5, 0
s_add_u32 s6, s6, s9
s_addc_u32 s7, s7, 0
s_add_u32 m0, s29, 65536
s_nop 0
global_load_lds_dwordx4 v2, s[4:5] sc1
s_add_u32 m0, s26, 65536
s_nop 0
global_load_lds_dwordx4 v6, s[6:7]
s_add_u32 m0, s26, 66560
s_nop 0
global_load_lds_dwordx4 v7, s[6:7]
s_add_u32 m0, s26, 67584
s_nop 0
global_load_lds_dwordx4 v8, s[6:7]
s_add_u32 m0, s26, 68608
s_nop 0
global_load_lds_dwordx4 v9, s[6:7]
s_add_u32 s4, s4, s8
s_addc_u32 s5, s5, 0
s_add_u32 s6, s6, s9
s_addc_u32 s7, s7, 0
s_add_u32 m0, s29, 98304
s_nop 0
global_load_lds_dwordx4 v2, s[4:5] sc1
s_add_u32 m0, s26, 98304
s_nop 0
global_load_lds_dwordx4 v6, s[6:7]
s_add_u32 m0, s26, 99328
s_nop 0
global_load_lds_dwordx4 v7, s[6:7]
s_add_u32 m0, s26, 100352
s_nop 0
global_load_lds_dwordx4 v8, s[6:7]
s_add_u32 m0, s26, 101376
s_nop 0
global_load_lds_dwordx4 v9, s[6:7]
s_add_u32 s4, s4, s8
s_addc_u32 s5, s5, 0
s_add_u32 s6, s6, s9
s_addc_u32 s7, s7, 0
W_sub_smalln2:
s_mov_b32 s21, 0
s_mul_i32 s21, s21, 4096
v_and_b32 v42, 15, v1
v_lshlrev_b32 v43, 6, v42
v_add_u32 v43, s21, v43
v_lshrrev_b32 v42, 2, v42
v_lshrrev_b32 v44, 1, v42
v_xor_b32 v45, v42, v44
v_and_b32 v45, 1, v45
v_lshl_add_u32 v44, v45, 1, v44
v_lshrrev_b32 v45, 4, v1
v_xor_b32 v44, v44, v45
v_lshl_add_u32 v10, v44, 4, v43
v_add_u32 v11, 0x10000, v10
s_mov_b32 s21, s20
v_and_b32 v42, 15, v1
v_lshrrev_b32 v43, 2, v42
v_lshrrev_b32 v44, 4, v1
v_lshl_add_u32 v45, v44, 3, v43
v_lshlrev_b32 v45, 9, v45
v_and_b32 v46, 1, v42
v_lshl_add_u32 v45, v46, 3, v45
v_bfe_u32 v46, v42, 1, 1
v_lshl_add_u32 v45, v46, 4, v45
v_add_u32 v45, 16384, v45
v_and_b32 v44, 1, v44
v_lshl_add_u32 v43, v44, 2, v43
s_mul_i32 s22, s21, 4
s_add_u32 s23, s22, 0
s_and_b32 s24, s23, 7
s_and_b32 s23, s23, 8
v_xor_b32 v46, s24, v43
v_add_u32 v46, s23, v46
v_lshl_add_u32 v26, v46, 5, v45
v_add_u32 v34, 0x10000, v26
s_add_u32 s23, s22, 1
s_and_b32 s24, s23, 7
s_and_b32 s23, s23, 8
v_xor_b32 v46, s24, v43
v_add_u32 v46, s23, v46
v_lshl_add_u32 v27, v46, 5, v45
v_add_u32 v35, 0x10000, v27
s_add_u32 s23, s22, 2
s_and_b32 s24, s23, 7
s_and_b32 s23, s23, 8
v_xor_b32 v46, s24, v43
v_add_u32 v46, s23, v46
v_lshl_add_u32 v28, v46, 5, v45
v_add_u32 v36, 0x10000, v28
s_add_u32 s23, s22, 3
s_and_b32 s24, s23, 7
s_and_b32 s23, s23, 8
v_xor_b32 v46, s24, v43
v_add_u32 v46, s23, v46
v_lshl_add_u32 v29, v46, 5, v45
v_add_u32 v37, 0x10000, v29
s_waitcnt vmcnt(0)
s_barrier
ds_read_b64_tr_b16 v[160:161], v26 offset:0
ds_read_b64_tr_b16 v[162:163], v26 offset:2048
ds_read_b128 v[128:131], v10 offset:0
ds_read_b128 v[132:135], v10 offset:1024
ds_read_b128 v[136:139], v10 offset:2048
ds_read_b128 v[140:143], v10 offset:3072
ds_read_b64_tr_b16 v[164:165], v27 offset:0
ds_read_b64_tr_b16 v[166:167], v27 offset:2048
ds_read_b64_tr_b16 v[168:169], v28 offset:0
ds_read_b64_tr_b16 v[170:171], v28 offset:2048
ds_read_b64_tr_b16 v[172:173], v29 offset:0
ds_read_b64_tr_b16 v[174:175], v29 offset:2048
s_lshr_b32 s11, s10, 2
s_sub_u32 s11, s11, 1
s_waitcnt lgkmcnt(0)
v_mfma_f32_16x16x32_bf16 a[0:3], v[160:163], v[128:131], 0
v_mfma_f32_16x16x32_bf16 a[4:7], v[160:163], v[132:135], 0
v_mfma_f32_16x16x32_bf16 a[8:11], v[160:163], v[136:139], 0
v_mfma_f32_16x16x32_bf16 a[12:15], v[160:163], v[140:143], 0
v_mfma_f32_16x16x32_bf16 a[16:19], v[164:167], v[128:131], 0
v_mfma_f32_16x16x32_bf16 a[20:23], v[164:167], v[132:135], 0
v_mfma_f32_16x16x32_bf16 a[24:27], v[164:167], v[136:139], 0
v_mfma_f32_16x16x32_bf16 a[28:31], v[164:167], v[140:143], 0
s_barrier
v_mfma_f32_16x16x32_bf16 a[32:35], v[168:171], v[128:131], 0
ds_read_b64_tr_b16 v[224:225], v26 offset:32768
ds_read_b64_tr_b16 v[226:227], v26 offset:34816
v_mfma_f32_16x16x32_bf16 a[36:39], v[168:171], v[132:135], 0
s_add_u32 m0, s29, 0
ds_read_b128 v[192:195], v10 offset:32768
ds_read_b128 v[196:199], v10 offset:33792
v_mfma_f32_16x16x32_bf16 a[40:43], v[168:171], v[136:139], 0
global_load_lds_dwordx4 v2, s[4:5] sc1
ds_read_b128 v[200:203], v10 offset:34816
ds_read_b128 v[204:207], v10 offset:35840
v_mfma_f32_16x16x32_bf16 a[44:47], v[168:171], v[140:143], 0
ds_read_b64_tr_b16 v[228:229], v27 offset:32768
ds_read_b64_tr_b16 v[230:231], v27 offset:34816
v_mfma_f32_16x16x32_bf16 a[48:51], v[172:175], v[128:131], 0
ds_read_b64_tr_b16 v[232:233], v28 offset:32768
ds_read_b64_tr_b16 v[234:235], v28 offset:34816
v_mfma_f32_16x16x32_bf16 a[52:55], v[172:175], v[132:135], 0
ds_read_b64_tr_b16 v[236:237], v29 offset:32768
ds_read_b64_tr_b16 v[238:239], v29 offset:34816
v_mfma_f32_16x16x32_bf16 a[56:59], v[172:175], v[136:139], 0
v_mfma_f32_16x16x32_bf16 a[60:63], v[172:175], v[140:143], 0
s_add_u32 s4, s4, s8
s_addc_u32 s5, s5, 0
M_gl_160:
s_waitcnt lgkmcnt(0)
v_mfma_f32_16x16x32_bf16 a[0:3], v[224:227], v[192:195], a[0:3]
s_add_u32 m0, s26, 0
v_mfma_f32_16x16x32_bf16 a[4:7], v[224:227], v[196:199], a[4:7]
global_load_lds_dwordx4 v6, s[6:7]
v_mfma_f32_16x16x32_bf16 a[8:11], v[224:227], v[200:203], a[8:11]
s_add_u32 m0, s26, 1024
v_mfma_f32_16x16x32_bf16 a[12:15], v[224:227], v[204:207], a[12:15]
global_load_lds_dwordx4 v7, s[6:7]
v_mfma_f32_16x16x32_bf16 a[16:19], v[228:231], v[192:195], a[16:19]
s_add_u32 m0, s26, 2048
v_mfma_f32_16x16x32_bf16 a[20:23], v[228:231], v[196:199], a[20:23]
global_load_lds_dwordx4 v8, s[6:7]
v_mfma_f32_16x16x32_bf16 a[24:27], v[228:231], v[200:203], a[24:27]
s_add_u32 m0, s26, 3072
v_mfma_f32_16x16x32_bf16 a[28:31], v[228:231], v[204:207], a[28:31]
global_load_lds_dwordx4 v9, s[6:7]
s_add_u32 s6, s6, s9
s_addc_u32 s7, s7, 0
s_waitcnt vmcnt(10)
s_barrier
v_mfma_f32_16x16x32_bf16 a[32:35], v[232:235], v[192:195], a[32:35]
ds_read_b64_tr_b16 v[160:161], v34 offset:0
ds_read_b64_tr_b16 v[162:163], v34 offset:2048
v_mfma_f32_16x16x32_bf16 a[36:39], v[232:235], v[196:199], a[36:39]
s_add_u32 m0, s29, 32768
ds_read_b128 v[128:131], v11 offset:0
ds_read_b128 v[132:135], v11 offset:1024
v_mfma_f32_16x16x32_bf16 a[40:43], v[232:235], v[200:203], a[40:43]
global_load_lds_dwordx4 v2, s[4:5] sc1
ds_read_b128 v[136:139], v11 offset:2048
ds_read_b128 v[140:143], v11 offset:3072
v_mfma_f32_16x16x32_bf16 a[44:47], v[232:235], v[204:207], a[44:47]
ds_read_b64_tr_b16 v[164:165], v35 offset:0
ds_read_b64_tr_b16 v[166:167], v35 offset:2048
v_mfma_f32_16x16x32_bf16 a[48:51], v[236:239], v[192:195], a[48:51]
ds_read_b64_tr_b16 v[168:169], v36 offset:0
ds_read_b64_tr_b16 v[170:171], v36 offset:2048
v_mfma_f32_16x16x32_bf16 a[52:55], v[236:239], v[196:199], a[52:55]
ds_read_b64_tr_b16 v[172:173], v37 offset:0
ds_read_b64_tr_b16 v[174:175], v37 offset:2048
v_mfma_f32_16x16x32_bf16 a[56:59], v[236:239], v[200:203], a[56:59]
v_mfma_f32_16x16x32_bf16 a[60:63], v[236:239], v[204:207], a[60:63]
s_add_u32 s4, s4, s8
s_addc_u32 s5, s5, 0
s_waitcnt lgkmcnt(0)
v_mfma_f32_16x16x32_bf16 a[0:3], v[160:163], v[128:131], a[0:3]
s_add_u32 m0, s26, 32768
v_mfma_f32_16x16x32_bf16 a[4:7], v[160:163], v[132:135], a[4:7]
global_load_lds_dwordx4 v6, s[6:7]
v_mfma_f32_16x16x32_bf16 a[8:11], v[160:163], v[136:139], a[8:11]
s_add_u32 m0, s26, 33792
v_mfma_f32_16x16x32_bf16 a[12:15], v[160:163], v[140:143], a[12:15]
global_load_lds_dwordx4 v7, s[6:7]
v_mfma_f32_16x16x32_bf16 a[16:19], v[164:167], v[128:131], a[16:19]
s_add_u32 m0, s26, 34816
v_mfma_f32_16x16x32_bf16 a[20:23], v[164:167], v[132:135], a[20:23]
global_load_lds_dwordx4 v8, s[6:7]
v_mfma_f32_16x16x32_bf16 a[24:27], v[164:167], v[136:139], a[24:27]
s_add_u32 m0, s26, 35840
v_mfma_f32_16x16x32_bf16 a[28:31], v[164:167], v[140:143], a[28:31]
global_load_lds_dwordx4 v9, s[6:7]
s_add_u32 s6, s6, s9
s_addc_u32 s7, s7, 0
s_waitcnt vmcnt(10)
s_barrier
v_mfma_f32_16x16x32_bf16 a[32:35], v[168:171], v[128:131], a[32:35]
ds_read_b64_tr_b16 v[224:225], v34 offset:32768
ds_read_b64_tr_b16 v[226:227], v34 offset:34816
v_mfma_f32_16x16x32_bf16 a[36:39], v[168:171], v[132:135], a[36:39]
s_add_u32 m0, s29, 65536
ds_read_b128 v[192:195], v11 offset:32768
ds_read_b128 v[196:199], v11 offset:33792
v_mfma_f32_16x16x32_bf16 a[40:43], v[168:171], v[136:139], a[40:43]
global_load_lds_dwordx4 v2, s[4:5] sc1
ds_read_b128 v[200:203], v11 offset:34816
ds_read_b128 v[204:207], v11 offset:35840
v_mfma_f32_16x16x32_bf16 a[44:47], v[168:171], v[140:143], a[44:47]
ds_read_b64_tr_b16 v[228:229], v35 offset:32768
ds_read_b64_tr_b16 v[230:231], v35 offset:34816
v_mfma_f32_16x16x32_bf16 a[48:51], v[172:175], v[128:131], a[48:51]
ds_read_b64_tr_b16 v[232:233], v36 offset:32768
ds_read_b64_tr_b16 v[234:235], v36 offset:34816
v_mfma_f32_16x16x32_bf16 a[52:55], v[172:175], v[132:135], a[52:55]
ds_read_b64_tr_b16 v[236:237], v37 offset:32768
ds_read_b64_tr_b16 v[238:239], v37 offset:34816
v_mfma_f32_16x16x32_bf16 a[56:59], v[172:175], v[136:139], a[56:59]
v_mfma_f32_16x16x32_bf16 a[60:63], v[172:175], v[140:143], a[60:63]
s_add_u32 s4, s4, s8
s_addc_u32 s5, s5, 0
s_waitcnt lgkmcnt(0)
v_mfma_f32_16x16x32_bf16 a[0:3], v[224:227], v[192:195], a[0:3]
s_add_u32 m0, s26, 65536
v_mfma_f32_16x16x32_bf16 a[4:7], v[224:227], v[196:199], a[4:7]
global_load_lds_dwordx4 v6, s[6:7]
v_mfma_f32_16x16x32_bf16 a[8:11], v[224:227], v[200:203], a[8:11]
s_add_u32 m0, s26, 66560
v_mfma_f32_16x16x32_bf16 a[12:15], v[224:227], v[204:207], a[12:15]
global_load_lds_dwordx4 v7, s[6:7]
v_mfma_f32_16x16x32_bf16 a[16:19], v[228:231], v[192:195], a[16:19]
s_add_u32 m0, s26, 67584
v_mfma_f32_16x16x32_bf16 a[20:23], v[228:231], v[196:199], a[20:23]
global_load_lds_dwordx4 v8, s[6:7]
v_mfma_f32_16x16x32_bf16 a[24:27], v[228:231], v[200:203], a[24:27]
s_add_u32 m0, s26, 68608
v_mfma_f32_16x16x32_bf16 a[28:31], v[228:231], v[204:207], a[28:31]
global_load_lds_dwordx4 v9, s[6:7]
s_add_u32 s6, s6, s9
s_addc_u32 s7, s7, 0
s_waitcnt vmcnt(10)
s_barrier
v_mfma_f32_16x16x32_bf16 a[32:35], v[232:235], v[192:195], a[32:35]
ds_read_b64_tr_b16 v[160:161], v26 offset:0
ds_read_b64_tr_b16 v[162:163], v26 offset:2048
v_mfma_f32_16x16x32_bf16 a[36:39], v[232:235], v[196:199], a[36:39]
s_add_u32 m0, s29, 98304
ds_read_b128 v[128:131], v10 offset:0
ds_read_b128 v[132:135], v10 offset:1024
v_mfma_f32_16x16x32_bf16 a[40:43], v[232:235], v[200:203], a[40:43]
global_load_lds_dwordx4 v2, s[4:5] sc1
ds_read_b128 v[136:139], v10 offset:2048
ds_read_b128 v[140:143], v10 offset:3072
v_mfma_f32_16x16x32_bf16 a[44:47], v[232:235], v[204:207], a[44:47]
ds_read_b64_tr_b16 v[164:165], v27 offset:0
ds_read_b64_tr_b16 v[166:167], v27 offset:2048
v_mfma_f32_16x16x32_bf16 a[48:51], v[236:239], v[192:195], a[48:51]
ds_read_b64_tr_b16 v[168:169], v28 offset:0
ds_read_b64_tr_b16 v[170:171], v28 offset:2048
v_mfma_f32_16x16x32_bf16 a[52:55], v[236:239], v[196:199], a[52:55]
ds_read_b64_tr_b16 v[172:173], v29 offset:0
ds_read_b64_tr_b16 v[174:175], v29 offset:2048
v_mfma_f32_16x16x32_bf16 a[56:59], v[236:239], v[200:203], a[56:59]
v_mfma_f32_16x16x32_bf16 a[60:63], v[236:239], v[204:207], a[60:63]
s_add_u32 s4, s4, s8
s_addc_u32 s5, s5, 0
s_sub_u32 s11, s11, 1
s_cmp_eq_u32 s11, 0
s_cbranch_scc1 M_gle_161
s_waitcnt lgkmcnt(0)
v_mfma_f32_16x16x32_bf16 a[0:3], v[160:163], v[128:131], a[0:3]
s_add_u32 m0, s26, 98304
v_mfma_f32_16x16x32_bf16 a[4:7], v[160:163], v[132:135], a[4:7]
global_load_lds_dwordx4 v6, s[6:7]
v_mfma_f32_16x16x32_bf16 a[8:11], v[160:163], v[136:139], a[8:11]
s_add_u32 m0, s26, 99328
v_mfma_f32_16x16x32_bf16 a[12:15], v[160:163], v[140:143], a[12:15]
global_load_lds_dwordx4 v7, s[6:7]
v_mfma_f32_16x16x32_bf16 a[16:19], v[164:167], v[128:131], a[16:19]
s_add_u32 m0, s26, 100352
v_mfma_f32_16x16x32_bf16 a[20:23], v[164:167], v[132:135], a[20:23]
global_load_lds_dwordx4 v8, s[6:7]
v_mfma_f32_16x16x32_bf16 a[24:27], v[164:167], v[136:139], a[24:27]
s_add_u32 m0, s26, 101376
v_mfma_f32_16x16x32_bf16 a[28:31], v[164:167], v[140:143], a[28:31]
global_load_lds_dwordx4 v9, s[6:7]
s_add_u32 s6, s6, s9
s_addc_u32 s7, s7, 0
s_waitcnt vmcnt(10)
s_barrier
v_mfma_f32_16x16x32_bf16 a[32:35], v[168:171], v[128:131], a[32:35]
ds_read_b64_tr_b16 v[224:225], v26 offset:32768
ds_read_b64_tr_b16 v[226:227], v26 offset:34816
v_mfma_f32_16x16x32_bf16 a[36:39], v[168:171], v[132:135], a[36:39]
s_add_u32 m0, s29, 0
ds_read_b128 v[192:195], v10 offset:32768
ds_read_b128 v[196:199], v10 offset:33792
v_mfma_f32_16x16x32_bf16 a[40:43], v[168:171], v[136:139], a[40:43]
global_load_lds_dwordx4 v2, s[4:5] sc1
ds_read_b128 v[200:203], v10 offset:34816
ds_read_b128 v[204:207], v10 offset:35840
v_mfma_f32_16x16x32_bf16 a[44:47], v[168:171], v[140:143], a[44:47]
ds_read_b64_tr_b16 v[228:229], v27 offset:32768
ds_read_b64_tr_b16 v[230:231], v27 offset:34816
v_mfma_f32_16x16x32_bf16 a[48:51], v[172:175], v[128:131], a[48:51]
ds_read_b64_tr_b16 v[232:233], v28 offset:32768
ds_read_b64_tr_b16 v[234:235], v28 offset:34816
v_mfma_f32_16x16x32_bf16 a[52:55], v[172:175], v[132:135], a[52:55]
ds_read_b64_tr_b16 v[236:237], v29 offset:32768
ds_read_b64_tr_b16 v[238:239], v29 offset:34816
v_mfma_f32_16x16x32_bf16 a[56:59], v[172:175], v[136:139], a[56:59]
v_mfma_f32_16x16x32_bf16 a[60:63], v[172:175], v[140:143], a[60:63]
s_add_u32 s4, s4, s8
s_addc_u32 s5, s5, 0
s_branch M_gl_160
M_gle_161:
s_waitcnt lgkmcnt(0)
v_mfma_f32_16x16x32_bf16 a[0:3], v[160:163], v[128:131], a[0:3]
s_add_u32 m0, s26, 98304
v_mfma_f32_16x16x32_bf16 a[4:7], v[160:163], v[132:135], a[4:7]
global_load_lds_dwordx4 v6, s[6:7]
v_mfma_f32_16x16x32_bf16 a[8:11], v[160:163], v[136:139], a[8:11]
s_add_u32 m0, s26, 99328
v_mfma_f32_16x16x32_bf16 a[12:15], v[160:163], v[140:143], a[12:15]
global_load_lds_dwordx4 v7, s[6:7]
v_mfma_f32_16x16x32_bf16 a[16:19], v[164:167], v[128:131], a[16:19]
s_add_u32 m0, s26, 100352
v_mfma_f32_16x16x32_bf16 a[20:23], v[164:167], v[132:135], a[20:23]
global_load_lds_dwordx4 v8, s[6:7]
v_mfma_f32_16x16x32_bf16 a[24:27], v[164:167], v[136:139], a[24:27]
s_add_u32 m0, s26, 101376
v_mfma_f32_16x16x32_bf16 a[28:31], v[164:167], v[140:143], a[28:31]
global_load_lds_dwordx4 v9, s[6:7]
s_add_u32 s6, s6, s9
s_addc_u32 s7, s7, 0
s_waitcnt vmcnt(10)
s_barrier
v_mfma_f32_16x16x32_bf16 a[32:35], v[168:171], v[128:131], a[32:35]
ds_read_b64_tr_b16 v[224:225], v26 offset:32768
ds_read_b64_tr_b16 v[226:227], v26 offset:34816
v_mfma_f32_16x16x32_bf16 a[36:39], v[168:171], v[132:135], a[36:39]
ds_read_b128 v[192:195], v10 offset:32768
ds_read_b128 v[196:199], v10 offset:33792
v_mfma_f32_16x16x32_bf16 a[40:43], v[168:171], v[136:139], a[40:43]
ds_read_b128 v[200:203], v10 offset:34816
ds_read_b128 v[204:207], v10 offset:35840
v_mfma_f32_16x16x32_bf16 a[44:47], v[168:171], v[140:143], a[44:47]
ds_read_b64_tr_b16 v[228:229], v27 offset:32768
ds_read_b64_tr_b16 v[230:231], v27 offset:34816
v_mfma_f32_16x16x32_bf16 a[48:51], v[172:175], v[128:131], a[48:51]
ds_read_b64_tr_b16 v[232:233], v28 offset:32768
ds_read_b64_tr_b16 v[234:235], v28 offset:34816
v_mfma_f32_16x16x32_bf16 a[52:55], v[172:175], v[132:135], a[52:55]
ds_read_b64_tr_b16 v[236:237], v29 offset:32768
ds_read_b64_tr_b16 v[238:239], v29 offset:34816
v_mfma_f32_16x16x32_bf16 a[56:59], v[172:175], v[136:139], a[56:59]
v_mfma_f32_16x16x32_bf16 a[60:63], v[172:175], v[140:143], a[60:63]
s_waitcnt lgkmcnt(0)
v_mfma_f32_16x16x32_bf16 a[0:3], v[224:227], v[192:195], a[0:3]
v_mfma_f32_16x16x32_bf16 a[4:7], v[224:227], v[196:199], a[4:7]
v_mfma_f32_16x16x32_bf16 a[8:11], v[224:227], v[200:203], a[8:11]
v_mfma_f32_16x16x32_bf16 a[12:15], v[224:227], v[204:207], a[12:15]
v_mfma_f32_16x16x32_bf16 a[16:19], v[228:231], v[192:195], a[16:19]
v_mfma_f32_16x16x32_bf16 a[20:23], v[228:231], v[196:199], a[20:23]
v_mfma_f32_16x16x32_bf16 a[24:27], v[228:231], v[200:203], a[24:27]
v_mfma_f32_16x16x32_bf16 a[28:31], v[228:231], v[204:207], a[28:31]
s_waitcnt vmcnt(5)
s_barrier
v_mfma_f32_16x16x32_bf16 a[32:35], v[232:235], v[192:195], a[32:35]
ds_read_b64_tr_b16 v[160:161], v34 offset:0
ds_read_b64_tr_b16 v[162:163], v34 offset:2048
v_mfma_f32_16x16x32_bf16 a[36:39], v[232:235], v[196:199], a[36:39]
ds_read_b128 v[128:131], v11 offset:0
ds_read_b128 v[132:135], v11 offset:1024
v_mfma_f32_16x16x32_bf16 a[40:43], v[232:235], v[200:203], a[40:43]
ds_read_b128 v[136:139], v11 offset:2048
ds_read_b128 v[140:143], v11 offset:3072
v_mfma_f32_16x16x32_bf16 a[44:47], v[232:235], v[204:207], a[44:47]
ds_read_b64_tr_b16 v[164:165], v35 offset:0
ds_read_b64_tr_b16 v[166:167], v35 offset:2048
v_mfma_f32_16x16x32_bf16 a[48:51], v[236:239], v[192:195], a[48:51]
ds_read_b64_tr_b16 v[168:169], v36 offset:0
ds_read_b64_tr_b16 v[170:171], v36 offset:2048
v_mfma_f32_16x16x32_bf16 a[52:55], v[236:239], v[196:199], a[52:55]
ds_read_b64_tr_b16 v[172:173], v37 offset:0
ds_read_b64_tr_b16 v[174:175], v37 offset:2048
v_mfma_f32_16x16x32_bf16 a[56:59], v[236:239], v[200:203], a[56:59]
v_mfma_f32_16x16x32_bf16 a[60:63], v[236:239], v[204:207], a[60:63]
s_waitcnt lgkmcnt(0)
v_mfma_f32_16x16x32_bf16 a[0:3], v[160:163], v[128:131], a[0:3]
v_mfma_f32_16x16x32_bf16 a[4:7], v[160:163], v[132:135], a[4:7]
v_mfma_f32_16x16x32_bf16 a[8:11], v[160:163], v[136:139], a[8:11]
v_mfma_f32_16x16x32_bf16 a[12:15], v[160:163], v[140:143], a[12:15]
v_mfma_f32_16x16x32_bf16 a[16:19], v[164:167], v[128:131], a[16:19]
v_mfma_f32_16x16x32_bf16 a[20:23], v[164:167], v[132:135], a[20:23]
v_mfma_f32_16x16x32_bf16 a[24:27], v[164:167], v[136:139], a[24:27]
v_mfma_f32_16x16x32_bf16 a[28:31], v[164:167], v[140:143], a[28:31]
s_waitcnt vmcnt(0)
s_barrier
v_mfma_f32_16x16x32_bf16 a[32:35], v[168:171], v[128:131], a[32:35]
ds_read_b64_tr_b16 v[224:225], v34 offset:32768
ds_read_b64_tr_b16 v[226:227], v34 offset:34816
v_mfma_f32_16x16x32_bf16 a[36:39], v[168:171], v[132:135], a[36:39]
ds_read_b128 v[192:195], v11 offset:32768
ds_read_b128 v[196:199], v11 offset:33792
v_mfma_f32_16x16x32_bf16 a[40:43], v[168:171], v[136:139], a[40:43]
ds_read_b128 v[200:203], v11 offset:34816
ds_read_b128 v[204:207], v11 offset:35840
v_mfma_f32_16x16x32_bf16 a[44:47], v[168:171], v[140:143], a[44:47]
ds_read_b64_tr_b16 v[228:229], v35 offset:32768
ds_read_b64_tr_b16 v[230:231], v35 offset:34816
v_mfma_f32_16x16x32_bf16 a[48:51], v[172:175], v[128:131], a[48:51]
ds_read_b64_tr_b16 v[232:233], v36 offset:32768
ds_read_b64_tr_b16 v[234:235], v36 offset:34816
v_mfma_f32_16x16x32_bf16 a[52:55], v[172:175], v[132:135], a[52:55]
ds_read_b64_tr_b16 v[236:237], v37 offset:32768
ds_read_b64_tr_b16 v[238:239], v37 offset:34816
v_mfma_f32_16x16x32_bf16 a[56:59], v[172:175], v[136:139], a[56:59]
v_mfma_f32_16x16x32_bf16 a[60:63], v[172:175], v[140:143], a[60:63]
s_waitcnt lgkmcnt(0)
v_mfma_f32_16x16x32_bf16 a[0:3], v[224:227], v[192:195], a[0:3]
v_mfma_f32_16x16x32_bf16 a[4:7], v[224:227], v[196:199], a[4:7]
v_mfma_f32_16x16x32_bf16 a[8:11], v[224:227], v[200:203], a[8:11]
v_mfma_f32_16x16x32_bf16 a[12:15], v[224:227], v[204:207], a[12:15]
v_mfma_f32_16x16x32_bf16 a[16:19], v[228:231], v[192:195], a[16:19]
v_mfma_f32_16x16x32_bf16 a[20:23], v[228:231], v[196:199], a[20:23]
v_mfma_f32_16x16x32_bf16 a[24:27], v[228:231], v[200:203], a[24:27]
v_mfma_f32_16x16x32_bf16 a[28:31], v[228:231], v[204:207], a[28:31]
v_mfma_f32_16x16x32_bf16 a[32:35], v[232:235], v[192:195], a[32:35]
v_mfma_f32_16x16x32_bf16 a[36:39], v[232:235], v[196:199], a[36:39]
v_mfma_f32_16x16x32_bf16 a[40:43], v[232:235], v[200:203], a[40:43]
v_mfma_f32_16x16x32_bf16 a[44:47], v[232:235], v[204:207], a[44:47]
v_mfma_f32_16x16x32_bf16 a[48:51], v[236:239], v[192:195], a[48:51]
v_mfma_f32_16x16x32_bf16 a[52:55], v[236:239], v[196:199], a[52:55]
v_mfma_f32_16x16x32_bf16 a[56:59], v[236:239], v[200:203], a[56:59]
v_mfma_f32_16x16x32_bf16 a[60:63], v[236:239], v[204:207], a[60:63]
s_nop 7
s_nop 7
s_setpc_b64 s[94:95]
.p2align 2
M_tab:
.long 5
.long 6
.long 65541
.long 65542
.long 131077
.long 131078
.long 196613
.long 196614
.long 261
.long 262
.long 65797
.long 65798
.long 131333
.long 131334
.long 196869
.long 196870
.long 517
.long 518
.long 66053
.long 66054
.long 131589
.long 131590
.long 197125
.long 197126
.long 773
.long 774
.long 66309
.long 66310
.long 131845
.long 131846
.long 197381
.long 197382
.long 1029
.long 1030
.long 66565
.long 66566
.long 132101
.long 132102
.long 197637
.long 197638
.long 1285
.long 1286
.long 66821
.long 66822
.long 132357
.long 132358
.long 197893
.long 197894
.long 1541
.long 1542
.long 67077
.long 67078
.long 132613
.long 132614
.long 198149
.long 198150
.long 1797
.long 1798
.long 67333
.long 67334
.long 132869
.long 132870
.long 198405
.long 198406
.long 3
.long 65539
.long 131075
.long 196611
.long 262147
.long 327683
.long 393219
.long 458755
.long 524291
.long 589827
.long 655363
.long 720899
.long 786435
.long 851971
.long 512
.long 513
.long 66048
.long 66049
.long 131584
.long 131585
.long 197120
.long 197121
.long 768
.long 769
.long 66304
.long 66305
.long 131840
.long 131841
.long 197376
.long 197377
.long 2
.long 65538
.long 131074
.long 196610
.long 1024
.long 1025
.long 66560
.long 66561
.long 132096
.long 132097
.long 197632
.long 197633
.long 258
.long 65794
.long 131330
.long 196866
.long 1280
.long 1281
.long 66816
.long 66817
.long 132352
.long 132353
.long 197888
.long 197889
.long 514
.long 66050
.long 131586
.long 197122
.long 1536
.long 1537
.long 67072
.long 67073
.long 132608
.long 132609
.long 198144
.long 198145
.long 770
.long 66306
.long 7
.long 263
.long 519
.long 775
.long 1031
.long 1287
.long 1543
.long 1799
.long 131842
.long 197378
.long 1792
.long 1793
.long 67328
.long 67329
.long 4
.long 260
.long 516
.long 772
.long 1028
.long 1284
.long 1540
.long 1796
.long 65540
.long 65796
.long 66052
.long 66308
.long 66564
.long 66820
.long 67076
.long 67332
.long 132864
.long 132865
.long 198400
.long 198401
.long 1026
.long 66562
.long 132098
.long 197634
.long 1282
.long 66818
.long 2055
.long 2311
.long 2567
.long 2823
.long 132354
.long 197890
.long 3079
.long 3335
.long 3591
.long 3847
.long 1538
.long 67074
.long 132610
.long 198146
.long 1794
.long 67330
.long 132866
.long 198402
.long 4103
.long 4359
.long 4615
.long 4871
.long 5127
.long 5383
.long 8
.long 264
.long 520
.long 776
.long 1032
.long 1288
.long 1544
.long 1800
.long 2056
.long 2312
.long 5639
.long 5129
.long 70665
.long 136201
.long 201737
.long 5895
.long 5385
.long 70921
.long 136457
.long 201993
.long 6151
.long 5641
.long 71177
.long 136713
.long 202249
.long 6407
.long 5897
.long 71433
.long 136969
.long 202505
.long 6666
.long 72202
.long 137738
.long 203274
.long 6153
.long 71689
.long 137225
.long 202761
.long 6922
.long 72458
.long 137994
.long 203530
.long 6665
.long 72201
.long 137737
.long 203273
.long 6409
.long 71945
.long 137481
.long 203017
.long 7178
.long 72714
.long 138250
.long 203786
.long 6921
.long 72457
.long 137993
.long 203529
.long 7434
.long 72970
.long 138506
.long 204042
.long 7177
.long 72713
.long 138249
.long 203785
.long 7690
.long 73226
.long 138762
.long 204298
.long 7946
.long 73482
.long 139018
.long 204554
.long 7433
.long 72969
.long 138505
.long 204041

.section .rodata,"a"
.p2align 6
.amdhsa_kernel recurrent_scan__memory_aug_recurrent_mem_tr__mixer_token_mlp__prompt_kernel
  .amdhsa_next_free_vgpr 512
  .amdhsa_next_free_sgpr 102
  .amdhsa_accum_offset 256
  .amdhsa_group_segment_fixed_size 0
  .amdhsa_kernarg_size 120
  .amdhsa_user_sgpr_count 2
  .amdhsa_user_sgpr_kernarg_segment_ptr 1
  .amdhsa_system_sgpr_workgroup_id_x 1
.end_amdhsa_kernel
```
